```python
import torch

def _softmax(x, axis=-1):
    return torch.softmax(x, dim=axis)

def _gelu(x):
    return torch.nn.functional.gelu(x, approximate='tanh')

def _silu(x):
    return torch.nn.functional.silu(x)

def _sigmoid(x):
    return torch.sigmoid(x)

def _layernorm(x, axis=-1, eps=1e-05):
    m = x.mean(dim=axis, keepdim=True)
    v = x.var(dim=axis, keepdim=True, unbiased=False)
    return (x - m) / torch.sqrt(v + eps)

def _scatter_add(tgt, idx, src, axis=0):
    return tgt.clone().index_add_(axis, idx, src)

def _segment_sum(src, seg, n):
    out = torch.zeros((n,) + src.shape[1:], dtype=src.dtype)
    return out.index_add_(0, seg, src)

def _pad(x, pw):
    flat = tuple((v for pair in reversed(pw) for v in pair))
    return torch.nn.functional.pad(x, flat)
kernel_name = 'adaLN_cond__spectral_fnet__moe_arch_mod__prompt'

def setup_inputs():

    _w = lambda a: (lambda t: t.to(torch.bfloat16) if t.is_floating_point() else t)(torch.as_tensor(a))

    def _A_setup():
        B, S, D = (1, 2048, 1024)
        ns = torch.arange(S)[:, None] * torch.arange(S)[None, :]
        nd = torch.arange(D)[:, None] * torch.arange(D)[None, :]
        Ws_re = torch.cos(-2.0 * torch.pi * ns / S).to(float)
        Ws_im = torch.sin(-2.0 * torch.pi * ns / S).to(float)
        Wd_re = torch.cos(-2.0 * torch.pi * nd / D).to(float)
        Wd_im = torch.sin(-2.0 * torch.pi * nd / D).to(float)
        return {'x': _w((lambda *s: torch.randn(*s, dtype=torch.bfloat16) * 0.1)(B, S, D)), 'dft_seq_re': _w(Ws_re), 'dft_seq_im': _w(Ws_im), 'dft_hid_re': _w(Wd_re), 'dft_hid_im': _w(Wd_im)}
    _A_in = _A_setup()

    def _B_setup():
        B, S, D, F, C = (1, 2048, 1024, 3584, 2)
        return {'x': _w((lambda *s: torch.randn(*s, dtype=torch.bfloat16) * 0.1)(B, S, D)), 'w_r': _w((lambda *s: torch.randn(*s, dtype=torch.bfloat16) * 1.6)(D)), 'w_gate': _w((lambda *s: torch.randn(*s, dtype=torch.bfloat16) * 0.8)(D, F)), 'w_up': _w((lambda *s: torch.randn(*s, dtype=torch.bfloat16) * 0.8)(D, F)), 'w_down': _w((lambda *s: torch.randn(*s, dtype=torch.bfloat16) * 0.8)(F, D))}
    _B_in = _B_setup()
    return {'A_x': _A_in['x'], 'A_dft_seq_re': _A_in['dft_seq_re'], 'A_dft_seq_im': _A_in['dft_seq_im'], 'A_dft_hid_re': _A_in['dft_hid_re'], 'A_dft_hid_im': _A_in['dft_hid_im'], 'B_x': _B_in['x'], 'B_w_r': _B_in['w_r'], 'B_w_gate': _B_in['w_gate'], 'B_w_up': _B_in['w_up'], 'B_w_down': _B_in['w_down'], 'c': _w((lambda *s: torch.randn(*s, dtype=torch.bfloat16) * 0.1)(1, 1024) * 8.0), 'w_mod': _w((lambda *s: torch.randn(*s, dtype=torch.bfloat16) * 0.1)(1024, 6 * 1024) * 1024 ** (-0.5) * 8.0)}

def reference(A_x, A_dft_seq_re, A_dft_seq_im, A_dft_hid_re, A_dft_hid_im, B_x, B_w_r, B_w_gate, B_w_up, B_w_down, c, w_mod):

    def _A_ref(x, dft_seq_re, dft_seq_im, dft_hid_re, dft_hid_im):
        a = torch.einsum('bsd,ed->bse', x, dft_hid_re)
        b = torch.einsum('bsd,ed->bse', x, dft_hid_im)
        y = torch.einsum('ts,bse->bte', dft_seq_re, a) - torch.einsum('ts,bse->bte', dft_seq_im, b)
        return y

    def _B_ref(x, w_r, w_gate, w_up, w_down):
        B, S, D = x.shape
        C = 2
        r = x @ w_r
        idx = torch.argsort(-r, axis=-1)[:, :C]
        idx_e = (lambda x, n, axis: torch.repeat_interleave(x, n, dim=axis))(idx.reshape(B, C, 1), D, axis=2)
        x_sel = (lambda x, i, axis: torch.take_along_dim(x, i, dim=axis))(x, idx_e, axis=1)
        g = _silu(x_sel @ w_gate)
        u = x_sel @ w_up
        y = g * u @ w_down
        r_sel = _sigmoid((lambda x, i, axis: torch.take_along_dim(x, i, dim=axis))(r, idx, axis=1))
        y = y * r_sel.reshape(B, C, 1)
        b_off = (torch.arange(B) * S).reshape(B, 1)
        flat_idx = (idx + b_off).reshape(B * C)
        zero = (x * 0.0).reshape(B * S, D)
        upd = _scatter_add(zero, flat_idx, y.reshape(B * C, D), axis=0)
        return x + upd.reshape(B, S, D)
    x = A_x
    mod = (_silu(c) @ w_mod).reshape(c.shape[0], 6, 1, -1)
    sa, ca, ga, sb, cb, gb = (mod[:, 0].clone(), mod[:, 1].clone(), mod[:, 2].clone(), mod[:, 3].clone(), mod[:, 4].clone(), mod[:, 5].clone())
    h = _layernorm(x, axis=-1) * (1 + ca) + sa
    x = x + ga * _A_ref(h, A_dft_seq_re, A_dft_seq_im, A_dft_hid_re, A_dft_hid_im)
    h = _layernorm(x, axis=-1) * (1 + cb) + sb
    x = x + gb * _B_ref(h, B_w_r, B_w_gate, B_w_up, B_w_down)
    return x
```

```asm
; @launch grid=(256,1,1) block=(512,1,1) lds=163840
.amdgcn_target "amdgcn-amd-amdhsa--gfx950"
.text
.globl adaLN_cond__spectral_fnet__moe_arch_mod__prompt_kernel
.p2align 8
.type adaLN_cond__spectral_fnet__moe_arch_mod__prompt_kernel,@function
adaLN_cond__spectral_fnet__moe_arch_mod__prompt_kernel:
    s_cmp_ge_u32 s2, 256
    s_cbranch_scc1 k_done
    s_load_dwordx2 s[4:5], s[0:1], 0
    s_load_dwordx4 s[24:27], s[0:1], 96
    s_load_dwordx2 s[6:7], s[0:1], 112
    s_load_dwordx4 s[56:59], s[0:1], 80
    s_load_dwordx4 s[48:51], s[0:1], 48
    s_load_dwordx4 s[52:55], s[0:1], 64
    s_memrealtime s[32:33]
    v_lshrrev_b32 v1, 6, v0
    v_and_b32 v2, 63, v0
    v_readfirstlane_b32 s16, v1
    v_lshlrev_b32 v3, 4, v2
    v_mov_b32 v4, 0
    s_getpc_b64 s[36:37]
h_pc:
    s_and_b32 s34, s2, 7
    s_bfe_u32 s35, s2, 0x40003
    s_cmp_lg_u32 s16, 7
    s_cbranch_scc1 h_npf
    s_lshr_b32 s42, s2, 3
    s_lshl_b32 s42, s42, 11
    v_lshl_add_u32 v4, v2, 7, s42
    v_min_u32 v4, all_end-h_pc-4, v4
    s_mov_b64 exec, 0xffff
    global_load_dword v246, v4, s[36:37]
    s_mov_b64 exec, -1
h_npf:
    s_mov_b32 s11, 0x00020000
    s_mov_b32 s14, 268435456
    s_mov_b32 s15, 0x00020000
    s_bitcmp0_b32 s2, 7
    s_cbranch_scc1 g_start
    s_lshl_b32 s60, s16, 19
    s_lshl_b32 s61, s35, 14
    s_add_u32 s60, s60, s61
    s_lshl_b32 s61, s34, 11
    s_add_u32 s60, s60, s61
    s_add_u32 s61, s60, 262144
    s_lshl_b32 s62, s34, 11
    s_lshl_b32 s63, s35, 7
    s_add_u32 s62, s62, s63
    s_lshl_b32 s63, s16, 4
    s_add_u32 s62, s62, s63
    s_add_u32 s62, s62, 16777216
    s_add_u32 s63, s62, 32768
    v_mov_b32 v116, 0
    s_mov_b32 s10, 4194304
    s_waitcnt lgkmcnt(0)
    s_mov_b32 s8, s4
    s_mov_b32 s9, s5
    s_mov_b32 s12, s6
    s_mov_b32 s13, s7
    buffer_load_dwordx4 v[64:67], v3, s[8:11], s60 offen offset:0
    buffer_load_dwordx4 v[72:75], v3, s[8:11], s61 offen offset:0
    buffer_load_dwordx4 v[68:71], v3, s[8:11], s60 offen offset:1024
    buffer_load_dwordx4 v[76:79], v3, s[8:11], s61 offen offset:1024
    s_mov_b64 exec, 1
    buffer_load_dword v247, v116, s[12:15], s62 offen sc1
    s_mov_b64 exec, -1
    s_branch f_start
g_start:
    s_lshr_b32 s40, s35, 3
    s_lshl_b32 s41, s34, 1
    s_add_u32 s40, s40, s41
    s_and_b32 s29, s35, 7
    v_lshlrev_b32 v13, 2, v2
    s_cmp_lt_u32 s16, 4
    s_cbranch_scc1 g_cons
g_load:
    v_lshrrev_b32 v5, 4, v2
    v_lshlrev_b32 v6, 1, v5
    v_xor_b32 v6, v6, v0
    v_and_b32 v6, 15, v6
    v_lshlrev_b32 v6, 4, v6
    s_movk_i32 s42, 12288
    v_mad_u32_u24 v6, v5, s42, v6
    v_xor_b32 v7, 128, v6
    s_and_b32 s69, s16, 3
    s_and_b32 s41, s40, 3
    s_lshl_b32 s41, s41, 3
    s_add_u32 s41, s41, s69
    s_mul_i32 s18, s41, 393216
    s_lshr_b32 s41, s34, 1
    s_cmp_eq_u32 s41, 3
    s_cselect_b32 s41, 4, s41
    s_lshl_b32 s41, s41, 11
    s_add_u32 s18, s18, s41
    s_lshl_b32 s42, s29, 8
    s_add_u32 s18, s18, s42
    s_lshl_b32 s68, s69, 13
    s_mov_b32 s10, 12582912
    s_waitcnt lgkmcnt(0)
    s_mov_b32 s8, s58
    s_mov_b32 s9, s59
    s_mov_b32 s12, s6
    s_mov_b32 s13, s7
    s_barrier
    s_add_u32 s43, s68, 32768
    s_mov_b32 m0, s43
    s_add_u32 s42, s18, 0
    buffer_load_dwordx4 v6, s[8:11], s42 offen nt lds
    s_add_u32 s43, s68, 33792
    s_mov_b32 m0, s43
    s_add_u32 s42, s18, 49152
    buffer_load_dwordx4 v6, s[8:11], s42 offen nt lds
    s_add_u32 s43, s68, 34816
    s_mov_b32 m0, s43
    s_add_u32 s42, s18, 98304
    buffer_load_dwordx4 v7, s[8:11], s42 offen nt lds
    s_add_u32 s43, s68, 35840
    s_mov_b32 m0, s43
    s_add_u32 s42, s18, 147456
    buffer_load_dwordx4 v7, s[8:11], s42 offen nt lds
    s_add_u32 s43, s68, 36864
    s_mov_b32 m0, s43
    s_add_u32 s42, s18, 196608
    buffer_load_dwordx4 v6, s[8:11], s42 offen nt lds
    s_add_u32 s43, s68, 37888
    s_mov_b32 m0, s43
    s_add_u32 s42, s18, 245760
    buffer_load_dwordx4 v6, s[8:11], s42 offen nt lds
    s_add_u32 s43, s68, 38912
    s_mov_b32 m0, s43
    s_add_u32 s42, s18, 294912
    buffer_load_dwordx4 v7, s[8:11], s42 offen nt lds
    s_add_u32 s43, s68, 39936
    s_mov_b32 m0, s43
    s_add_u32 s42, s18, 344064
    buffer_load_dwordx4 v7, s[8:11], s42 offen nt lds
    s_and_b32 s41, s40, 7
    s_lshl_b32 s19, s41, 2
    s_add_u32 s19, s19, s69
    s_mul_i32 s19, s19, 393216
    s_xor_b32 s42, s29, 1
    s_lshl_b32 s42, s42, 8
    s_add_u32 s19, s19, s42
    s_and_b32 s42, s34, 4
    s_lshl_b32 s42, s42, 10
    s_add_u32 s19, s19, s42
    s_add_u32 s19, s19, 6144
    v_bfe_u32 v5, v0, 5, 1
    v_lshlrev_b32 v5, 3, v5
    v_bfe_u32 v12, v0, 3, 2
    v_add_u32 v5, v5, v12
    v_bfe_u32 v12, v0, 4, 2
    v_lshlrev_b32 v12, 1, v12
    v_xor_b32 v12, v12, v0
    v_and_b32 v12, 7, v12
    v_lshlrev_b32 v12, 4, v12
    s_movk_i32 s42, 7168
    v_mad_u32_u24 v5, v5, s42, v12
    s_mov_b32 s20, s26
    s_mov_b32 s21, s27
    s_mov_b32 s26, 4194304
    s_mov_b32 s27, 0x00020000
    s_and_b32 s65, s35, 1
    s_lshr_b32 s40, s35, 1
    s_mul_i32 s64, s34, 7
    s_add_u32 s64, s64, s40
    s_lshl_b32 s41, s34, 1
    s_add_u32 s41, s41, s65
    s_cmp_ge_u32 s35, 14
    s_cselect_b32 s66, 1, 0
    s_cselect_b32 s64, s41, s64
    v_lshrrev_b32 v10, 2, v2
    v_and_b32 v15, 3, v0
    v_bfe_u32 v11, v0, 3, 2
    v_xor_b32 v12, v11, v1
    v_and_b32 v12, 3, v12
    v_lshlrev_b32 v12, 5, v12
    v_lshl_add_u32 v12, v10, 7, v12
    v_lshl_add_u32 v12, v15, 3, v12
    v_lshrrev_b32 v16, 2, v1
    v_lshl_add_u32 v12, v16, 15, v12
    v_add_u32 v21, 65536, v12
    s_cmp_eq_u32 s66, 0
    s_cbranch_scc1 g_c1
    v_and_b32 v204, 255, v0
    v_lshlrev_b32 v204, 2, v204
    v_bfe_u32 v200, v204, 4, 1
    v_lshlrev_b32 v200, 5, v200
    v_bfe_u32 v201, v204, 7, 2
    v_lshl_add_u32 v200, v201, 3, v200
    v_bfe_u32 v201, v204, 9, 1
    v_lshl_add_u32 v200, v201, 2, v200
    v_bfe_u32 v201, v204, 5, 2
    v_add_lshl_u32 v200, v201, v200, 4
    v_xor_b32 v202, 1008, v200
    v_and_b32 v206, 3, v0
    v_lshl_add_u32 v200, v206, 10, v200
    v_sub_u32 v205, 4, v206
    v_and_b32 v205, 3, v205
    v_lshl_add_u32 v201, v205, 10, v202
    v_sub_u32 v205, 3, v206
    v_lshl_add_u32 v202, v205, 10, v202
    v_bfe_u32 v203, v204, 7, 1
    v_lshlrev_b32 v203, 9, v203
    v_and_b32 v205, 31, v204
    v_lshl_add_u32 v203, v205, 4, v203
    v_bfe_u32 v205, v204, 8, 1
    v_lshl_add_u32 v203, v205, 3, v203
    v_lshrrev_b32 v205, 9, v204
    v_lshl_add_u32 v203, v205, 10, v203
    v_bfe_u32 v205, v204, 5, 2
    v_lshl_add_u32 v203, v205, 1, v203
    s_lshl_b32 s22, s34, 17
    s_add_u32 s22, s22, 19922944
    s_lshl_b32 s79, s34, 10
    s_lshl_b32 s23, s65, 7
    s_add_u32 s79, s79, s23
    s_add_u32 s79, s79, 16850944
g_c1:
    s_lshl_b32 s67, s65, 3
    s_add_u32 s67, s67, s69
    s_mul_i32 s67, s67, 458752
    s_lshl_b32 s42, s64, 7
    s_add_u32 s67, s67, s42
    s_lshl_b32 s42, s64, 6
    s_and_b32 s43, s16, 1
    s_lshl_b32 s43, s43, 4
    s_add_u32 s42, s42, s43
    s_and_b32 s43, s16, 2
    s_lshl_b32 s43, s43, 1
    s_add_u32 s42, s42, s43
    s_lshl_b32 s70, s42, 11
    s_lshl_b32 s43, s65, 10
    s_add_u32 s70, s70, s43
    s_mov_b32 s56, s50
    s_mov_b32 s57, s51
    s_mov_b32 s58, 7340032
    s_mov_b32 s59, 0x00020000
    s_mov_b32 s44, s52
    s_mov_b32 s45, s53
    s_mov_b32 s46, 7340032
    s_mov_b32 s47, 0x00020000
    s_mov_b32 s60, s54
    s_mov_b32 s61, s55
    s_mov_b32 s62, 7340032
    s_mov_b32 s63, 0x00020000
    s_waitcnt vmcnt(7)
    s_add_u32 s43, s68, 65536
    s_mov_b32 m0, s43
    s_add_u32 s42, s18, 1572864
    buffer_load_dwordx4 v6, s[8:11], s42 offen nt lds
    s_waitcnt vmcnt(7)
    s_add_u32 s43, s68, 66560
    s_mov_b32 m0, s43
    s_add_u32 s42, s18, 1622016
    buffer_load_dwordx4 v6, s[8:11], s42 offen nt lds
    s_load_dwordx2 s[32:33], s[20:21], 128
    s_waitcnt vmcnt(7)
    s_add_u32 s43, s68, 67584
    s_mov_b32 m0, s43
    s_add_u32 s42, s18, 1671168
    buffer_load_dwordx4 v7, s[8:11], s42 offen nt lds
    s_waitcnt vmcnt(7)
    s_add_u32 s43, s68, 68608
    s_mov_b32 m0, s43
    s_add_u32 s42, s18, 1720320
    buffer_load_dwordx4 v7, s[8:11], s42 offen nt lds
    s_waitcnt vmcnt(7)
    s_add_u32 s43, s68, 69632
    s_mov_b32 m0, s43
    s_add_u32 s42, s18, 1769472
    buffer_load_dwordx4 v6, s[8:11], s42 offen nt lds
    s_waitcnt vmcnt(7)
    s_add_u32 s43, s68, 70656
    s_mov_b32 m0, s43
    s_add_u32 s42, s18, 1818624
    buffer_load_dwordx4 v6, s[8:11], s42 offen nt lds
    s_waitcnt vmcnt(7)
    s_add_u32 s43, s68, 71680
    s_mov_b32 m0, s43
    s_add_u32 s42, s18, 1867776
    buffer_load_dwordx4 v7, s[8:11], s42 offen nt lds
    s_waitcnt vmcnt(7)
    s_barrier
    s_add_u32 s43, s68, 72704
    s_mov_b32 m0, s43
    s_add_u32 s42, s18, 1916928
    buffer_load_dwordx4 v7, s[8:11], s42 offen nt lds
    s_waitcnt lgkmcnt(0)
    s_cmp_lg_u32 s32, 0
    s_cbranch_scc1 g_n2x
    s_load_dwordx2 s[32:33], s[20:21], 192
    s_mov_b32 s83, 0
    v_mov_b32 v122, 0
    s_waitcnt lgkmcnt(0)
g_n2:
    s_cmp_lg_u32 s32, 0
    s_cbranch_scc1 g_n2x
    global_load_dwordx2 v[120:121], v122, s[20:21] sc1
    s_waitcnt vmcnt(0)
    v_readfirstlane_b32 s32, v120
    v_readfirstlane_b32 s33, v121
    s_add_u32 s83, s83, 1
    s_cmp_lt_u32 s83, 0x40000
    s_cbranch_scc1 g_n2
g_n2x:
    s_cmp_eq_u32 s66, 0
    s_cbranch_scc1 m_load
    s_waitcnt vmcnt(7)
    s_add_u32 s43, s68, 98304
    s_mov_b32 m0, s43
    s_add_u32 s42, s19, 0
    buffer_load_dwordx4 v6, s[8:11], s42 offen nt lds
    s_waitcnt vmcnt(7)
    s_add_u32 s43, s68, 99328
    s_mov_b32 m0, s43
    s_add_u32 s42, s19, 49152
    buffer_load_dwordx4 v6, s[8:11], s42 offen nt lds
    s_waitcnt vmcnt(7)
    s_add_u32 s43, s68, 100352
    s_mov_b32 m0, s43
    s_add_u32 s42, s19, 98304
    buffer_load_dwordx4 v7, s[8:11], s42 offen nt lds
    s_waitcnt vmcnt(7)
    s_add_u32 s43, s68, 101376
    s_mov_b32 m0, s43
    s_add_u32 s42, s19, 147456
    buffer_load_dwordx4 v7, s[8:11], s42 offen nt lds
    s_waitcnt vmcnt(7)
    s_add_u32 s43, s68, 102400
    s_mov_b32 m0, s43
    s_add_u32 s42, s19, 196608
    buffer_load_dwordx4 v6, s[8:11], s42 offen nt lds
    s_waitcnt vmcnt(7)
    s_add_u32 s43, s68, 103424
    s_mov_b32 m0, s43
    s_add_u32 s42, s19, 245760
    buffer_load_dwordx4 v6, s[8:11], s42 offen nt lds
    s_waitcnt vmcnt(7)
    s_add_u32 s43, s68, 104448
    s_mov_b32 m0, s43
    s_add_u32 s42, s19, 294912
    buffer_load_dwordx4 v7, s[8:11], s42 offen nt lds
    s_waitcnt vmcnt(7)
    s_add_u32 s43, s68, 105472
    s_mov_b32 m0, s43
    s_add_u32 s42, s19, 344064
    buffer_load_dwordx4 v7, s[8:11], s42 offen nt lds
    s_waitcnt vmcnt(8)
    s_barrier
    s_barrier
    s_branch x_start
m_load:
    s_waitcnt vmcnt(7)
    s_add_u32 s43, s68, 98304
    s_mov_b32 m0, s43
    s_add_u32 s42, s19, 0
    buffer_load_dwordx4 v6, s[8:11], s42 offen nt lds
    s_waitcnt vmcnt(7)
    s_add_u32 s43, s68, 99328
    s_mov_b32 m0, s43
    s_add_u32 s42, s19, 49152
    buffer_load_dwordx4 v6, s[8:11], s42 offen nt lds
    s_waitcnt vmcnt(2)
    s_barrier
    s_barrier
    s_waitcnt vmcnt(7)
    s_add_u32 s43, s68, 100352
    s_mov_b32 m0, s43
    s_add_u32 s42, s19, 98304
    buffer_load_dwordx4 v7, s[8:11], s42 offen nt lds
    s_waitcnt vmcnt(7)
    s_add_u32 s43, s68, 101376
    s_mov_b32 m0, s43
    s_add_u32 s42, s19, 147456
    buffer_load_dwordx4 v7, s[8:11], s42 offen nt lds
    s_waitcnt vmcnt(7)
    s_add_u32 s43, s68, 102400
    s_mov_b32 m0, s43
    s_add_u32 s42, s19, 196608
    buffer_load_dwordx4 v6, s[8:11], s42 offen nt lds
    s_waitcnt vmcnt(7)
    s_add_u32 s43, s68, 103424
    s_mov_b32 m0, s43
    s_add_u32 s42, s19, 245760
    buffer_load_dwordx4 v6, s[8:11], s42 offen nt lds
    s_waitcnt vmcnt(7)
    s_add_u32 s43, s68, 104448
    s_mov_b32 m0, s43
    s_add_u32 s42, s19, 294912
    buffer_load_dwordx4 v7, s[8:11], s42 offen nt lds
    s_waitcnt vmcnt(7)
    s_add_u32 s43, s68, 105472
    s_mov_b32 m0, s43
    s_add_u32 s42, s19, 344064
    buffer_load_dwordx4 v7, s[8:11], s42 offen nt lds
    s_waitcnt vmcnt(7)
    s_add_u32 s43, s68, 0
    s_mov_b32 m0, s43
    s_add_u32 s42, s67, 0
    buffer_load_dwordx4 v5, s[56:59], s42 offen nt lds
    s_waitcnt vmcnt(7)
    s_add_u32 s43, s68, 1024
    s_mov_b32 m0, s43
    s_add_u32 s42, s67, 114688
    buffer_load_dwordx4 v5, s[56:59], s42 offen nt lds
    s_waitcnt vmcnt(2)
    s_barrier
    s_barrier
    s_waitcnt vmcnt(7)
    s_add_u32 s43, s68, 2048
    s_mov_b32 m0, s43
    s_add_u32 s42, s67, 28672
    buffer_load_dwordx4 v5, s[56:59], s42 offen nt lds
    s_waitcnt vmcnt(7)
    s_add_u32 s43, s68, 3072
    s_mov_b32 m0, s43
    s_add_u32 s42, s67, 143360
    buffer_load_dwordx4 v5, s[56:59], s42 offen nt lds
    s_waitcnt vmcnt(7)
    s_add_u32 s43, s68, 4096
    s_mov_b32 m0, s43
    s_add_u32 s42, s67, 229376
    buffer_load_dwordx4 v5, s[56:59], s42 offen nt lds
    s_waitcnt vmcnt(7)
    s_add_u32 s43, s68, 5120
    s_mov_b32 m0, s43
    s_add_u32 s42, s67, 344064
    buffer_load_dwordx4 v5, s[56:59], s42 offen nt lds
    s_waitcnt vmcnt(7)
    s_add_u32 s43, s68, 6144
    s_mov_b32 m0, s43
    s_add_u32 s42, s67, 258048
    buffer_load_dwordx4 v5, s[56:59], s42 offen nt lds
    s_waitcnt vmcnt(7)
    s_add_u32 s43, s68, 7168
    s_mov_b32 m0, s43
    s_add_u32 s42, s67, 372736
    buffer_load_dwordx4 v5, s[56:59], s42 offen nt lds
    s_waitcnt vmcnt(9)
    s_add_u32 s43, s68, 32768
    s_mov_b32 m0, s43
    s_add_u32 s42, s67, 1835008
    buffer_load_dwordx4 v5, s[56:59], s42 offen nt lds
    s_waitcnt vmcnt(9)
    s_add_u32 s43, s68, 33792
    s_mov_b32 m0, s43
    s_add_u32 s42, s67, 1949696
    buffer_load_dwordx4 v5, s[56:59], s42 offen nt lds
    s_waitcnt vmcnt(9)
    s_add_u32 s43, s68, 34816
    s_mov_b32 m0, s43
    s_add_u32 s42, s67, 1863680
    buffer_load_dwordx4 v5, s[56:59], s42 offen nt lds
    s_waitcnt vmcnt(9)
    s_add_u32 s43, s68, 35840
    s_mov_b32 m0, s43
    s_add_u32 s42, s67, 1978368
    buffer_load_dwordx4 v5, s[56:59], s42 offen nt lds
    s_waitcnt vmcnt(9)
    s_add_u32 s43, s68, 36864
    s_mov_b32 m0, s43
    s_add_u32 s42, s67, 2064384
    buffer_load_dwordx4 v5, s[56:59], s42 offen nt lds
    s_waitcnt vmcnt(9)
    s_add_u32 s43, s68, 37888
    s_mov_b32 m0, s43
    s_add_u32 s42, s67, 2179072
    buffer_load_dwordx4 v5, s[56:59], s42 offen nt lds
    s_waitcnt vmcnt(9)
    s_add_u32 s43, s68, 38912
    s_mov_b32 m0, s43
    s_add_u32 s42, s67, 2093056
    buffer_load_dwordx4 v5, s[56:59], s42 offen nt lds
    s_waitcnt vmcnt(9)
    s_add_u32 s43, s68, 39936
    s_mov_b32 m0, s43
    s_add_u32 s42, s67, 2207744
    buffer_load_dwordx4 v5, s[56:59], s42 offen nt lds
    s_waitcnt vmcnt(9)
    s_add_u32 s43, s68, 65536
    s_mov_b32 m0, s43
    s_add_u32 s42, s67, 0
    buffer_load_dwordx4 v5, s[44:47], s42 offen nt lds
    s_waitcnt vmcnt(9)
    s_barrier
    s_add_u32 s43, s68, 66560
    s_mov_b32 m0, s43
    s_add_u32 s42, s67, 114688
    buffer_load_dwordx4 v5, s[44:47], s42 offen nt lds
    s_waitcnt vmcnt(9)
    s_add_u32 s43, s68, 67584
    s_mov_b32 m0, s43
    s_add_u32 s42, s67, 28672
    buffer_load_dwordx4 v5, s[44:47], s42 offen nt lds
    s_waitcnt vmcnt(9)
    s_add_u32 s43, s68, 68608
    s_mov_b32 m0, s43
    s_add_u32 s42, s67, 143360
    buffer_load_dwordx4 v5, s[44:47], s42 offen nt lds
    s_waitcnt vmcnt(9)
    s_add_u32 s43, s68, 69632
    s_mov_b32 m0, s43
    s_add_u32 s42, s67, 229376
    buffer_load_dwordx4 v5, s[44:47], s42 offen nt lds
    s_waitcnt vmcnt(9)
    s_add_u32 s43, s68, 70656
    s_mov_b32 m0, s43
    s_add_u32 s42, s67, 344064
    buffer_load_dwordx4 v5, s[44:47], s42 offen nt lds
    s_waitcnt vmcnt(9)
    s_add_u32 s43, s68, 71680
    s_mov_b32 m0, s43
    s_add_u32 s42, s67, 258048
    buffer_load_dwordx4 v5, s[44:47], s42 offen nt lds
    s_waitcnt vmcnt(9)
    s_add_u32 s43, s68, 72704
    s_mov_b32 m0, s43
    s_add_u32 s42, s67, 372736
    buffer_load_dwordx4 v5, s[44:47], s42 offen nt lds
    s_waitcnt vmcnt(9)
    s_add_u32 s43, s68, 98304
    s_mov_b32 m0, s43
    s_add_u32 s42, s67, 1835008
    buffer_load_dwordx4 v5, s[44:47], s42 offen nt lds
    s_waitcnt vmcnt(9)
    s_barrier
    ds_read_b64_tr_b16 v[64:65], v12 offset:0
    ds_read_b64_tr_b16 v[66:67], v12 offset:2048
    ds_read_b64_tr_b16 v[68:69], v12 offset:4096
    ds_read_b64_tr_b16 v[70:71], v12 offset:6144
    ds_read_b64_tr_b16 v[72:73], v12 offset:8192
    ds_read_b64_tr_b16 v[74:75], v12 offset:10240
    ds_read_b64_tr_b16 v[76:77], v12 offset:12288
    ds_read_b64_tr_b16 v[78:79], v12 offset:14336
    ds_read_b64_tr_b16 v[80:81], v12 offset:16384
    ds_read_b64_tr_b16 v[82:83], v12 offset:18432
    ds_read_b64_tr_b16 v[84:85], v12 offset:20480
    ds_read_b64_tr_b16 v[86:87], v12 offset:22528
    ds_read_b64_tr_b16 v[88:89], v12 offset:24576
    ds_read_b64_tr_b16 v[90:91], v12 offset:26624
    ds_read_b64_tr_b16 v[92:93], v12 offset:28672
    ds_read_b64_tr_b16 v[94:95], v12 offset:30720
    s_add_u32 s43, s68, 99328
    s_mov_b32 m0, s43
    s_add_u32 s42, s67, 1949696
    buffer_load_dwordx4 v5, s[44:47], s42 offen nt lds
    s_waitcnt vmcnt(9)
    s_add_u32 s43, s68, 100352
    s_mov_b32 m0, s43
    s_add_u32 s42, s67, 1863680
    buffer_load_dwordx4 v5, s[44:47], s42 offen nt lds
    s_waitcnt vmcnt(9)
    s_add_u32 s43, s68, 101376
    s_mov_b32 m0, s43
    s_add_u32 s42, s67, 1978368
    buffer_load_dwordx4 v5, s[44:47], s42 offen nt lds
    s_waitcnt vmcnt(9)
    s_add_u32 s43, s68, 102400
    s_mov_b32 m0, s43
    s_add_u32 s42, s67, 2064384
    buffer_load_dwordx4 v5, s[44:47], s42 offen nt lds
    s_waitcnt vmcnt(9)
    s_add_u32 s43, s68, 103424
    s_mov_b32 m0, s43
    s_add_u32 s42, s67, 2179072
    buffer_load_dwordx4 v5, s[44:47], s42 offen nt lds
    s_waitcnt vmcnt(9)
    s_add_u32 s43, s68, 104448
    s_mov_b32 m0, s43
    s_add_u32 s42, s67, 2093056
    buffer_load_dwordx4 v5, s[44:47], s42 offen nt lds
    s_waitcnt vmcnt(9)
    s_add_u32 s43, s68, 105472
    s_mov_b32 m0, s43
    s_add_u32 s42, s67, 2207744
    buffer_load_dwordx4 v5, s[44:47], s42 offen nt lds
    s_waitcnt vmcnt(9)
    s_add_u32 s43, s68, 0
    s_mov_b32 m0, s43
    s_add_u32 s42, s70, 0
    buffer_load_dwordx4 v3, s[60:63], s42 offen nt lds
    s_waitcnt vmcnt(9)
    s_waitcnt lgkmcnt(0)
    s_barrier
    v_xor_b32 v4, 32, v3
    s_add_u32 s43, s68, 1024
    s_mov_b32 m0, s43
    s_add_u32 s42, s70, 2048
    buffer_load_dwordx4 v4, s[60:63], s42 offen nt lds
    s_waitcnt vmcnt(9)
    v_xor_b32 v4, 64, v3
    s_add_u32 s43, s68, 2048
    s_mov_b32 m0, s43
    s_add_u32 s42, s70, 4096
    buffer_load_dwordx4 v4, s[60:63], s42 offen nt lds
    s_waitcnt vmcnt(9)
    v_xor_b32 v4, 96, v3
    s_add_u32 s43, s68, 3072
    s_mov_b32 m0, s43
    s_add_u32 s42, s70, 6144
    buffer_load_dwordx4 v4, s[60:63], s42 offen nt lds
    s_waitcnt vmcnt(9)
    v_xor_b32 v4, 128, v3
    s_add_u32 s43, s68, 4096
    s_mov_b32 m0, s43
    s_add_u32 s42, s70, 16384
    buffer_load_dwordx4 v4, s[60:63], s42 offen nt lds
    s_waitcnt vmcnt(9)
    v_xor_b32 v4, 160, v3
    s_add_u32 s43, s68, 5120
    s_mov_b32 m0, s43
    s_add_u32 s42, s70, 18432
    buffer_load_dwordx4 v4, s[60:63], s42 offen nt lds
    s_waitcnt vmcnt(9)
    v_xor_b32 v4, 192, v3
    s_add_u32 s43, s68, 6144
    s_mov_b32 m0, s43
    s_add_u32 s42, s70, 20480
    buffer_load_dwordx4 v4, s[60:63], s42 offen nt lds
    s_waitcnt vmcnt(9)
    v_xor_b32 v4, 224, v3
    s_add_u32 s43, s68, 7168
    s_mov_b32 m0, s43
    s_add_u32 s42, s70, 22528
    buffer_load_dwordx4 v4, s[60:63], s42 offen nt lds
    s_waitcnt vmcnt(9)
    s_add_u32 s43, s68, 32768
    s_mov_b32 m0, s43
    s_add_u32 s42, s70, 65536
    buffer_load_dwordx4 v3, s[60:63], s42 offen nt lds
    s_waitcnt vmcnt(9)
    s_barrier
    ds_read_b64_tr_b16 v[96:97], v21 offset:0
    ds_read_b64_tr_b16 v[98:99], v21 offset:2048
    ds_read_b64_tr_b16 v[100:101], v21 offset:4096
    ds_read_b64_tr_b16 v[102:103], v21 offset:6144
    ds_read_b64_tr_b16 v[104:105], v21 offset:8192
    ds_read_b64_tr_b16 v[106:107], v21 offset:10240
    ds_read_b64_tr_b16 v[108:109], v21 offset:12288
    ds_read_b64_tr_b16 v[110:111], v21 offset:14336
    ds_read_b64_tr_b16 v[112:113], v21 offset:16384
    ds_read_b64_tr_b16 v[114:115], v21 offset:18432
    ds_read_b64_tr_b16 v[116:117], v21 offset:20480
    ds_read_b64_tr_b16 v[118:119], v21 offset:22528
    ds_read_b64_tr_b16 v[120:121], v21 offset:24576
    ds_read_b64_tr_b16 v[122:123], v21 offset:26624
    ds_read_b64_tr_b16 v[124:125], v21 offset:28672
    ds_read_b64_tr_b16 v[126:127], v21 offset:30720
    v_xor_b32 v4, 32, v3
    s_add_u32 s43, s68, 33792
    s_mov_b32 m0, s43
    s_add_u32 s42, s70, 67584
    buffer_load_dwordx4 v4, s[60:63], s42 offen nt lds
    s_waitcnt vmcnt(9)
    v_xor_b32 v4, 64, v3
    s_add_u32 s43, s68, 34816
    s_mov_b32 m0, s43
    s_add_u32 s42, s70, 69632
    buffer_load_dwordx4 v4, s[60:63], s42 offen nt lds
    s_waitcnt vmcnt(9)
    v_xor_b32 v4, 96, v3
    s_add_u32 s43, s68, 35840
    s_mov_b32 m0, s43
    s_add_u32 s42, s70, 71680
    buffer_load_dwordx4 v4, s[60:63], s42 offen nt lds
    s_waitcnt vmcnt(9)
    v_xor_b32 v4, 128, v3
    s_add_u32 s43, s68, 36864
    s_mov_b32 m0, s43
    s_add_u32 s42, s70, 81920
    buffer_load_dwordx4 v4, s[60:63], s42 offen nt lds
    s_waitcnt vmcnt(9)
    v_xor_b32 v4, 160, v3
    s_add_u32 s43, s68, 37888
    s_mov_b32 m0, s43
    s_add_u32 s42, s70, 83968
    buffer_load_dwordx4 v4, s[60:63], s42 offen nt lds
    s_waitcnt vmcnt(9)
    v_xor_b32 v4, 192, v3
    s_add_u32 s43, s68, 38912
    s_mov_b32 m0, s43
    s_add_u32 s42, s70, 86016
    buffer_load_dwordx4 v4, s[60:63], s42 offen nt lds
    s_waitcnt vmcnt(9)
    v_xor_b32 v4, 224, v3
    s_add_u32 s43, s68, 39936
    s_mov_b32 m0, s43
    s_add_u32 s42, s70, 88064
    buffer_load_dwordx4 v4, s[60:63], s42 offen nt lds
    s_waitcnt vmcnt(8)
    s_waitcnt lgkmcnt(0)
    v_mov_b32 v22, 0
    s_branch m_join
g_cons:
    s_lshl_b32 s38, s2, 13
    s_lshl_b32 s39, s16, 11
    s_add_u32 s38, s38, s39
    s_add_u32 s38, s38, 17825792
    s_lshl_b32 s30, s40, 12
    s_lshl_b32 s31, s29, 9
    s_add_u32 s30, s30, s31
    s_lshl_b32 s31, s16, 7
    s_add_u32 s30, s30, s31
    s_xor_b32 s31, s30, 512
    s_add_u32 s31, s31, 16973824
    s_add_u32 s30, s30, 16908288
    v_lshlrev_b32 v8, 1, v0
    v_and_b32 v9, 0xff, v8
    s_and_b32 s41, s40, 7
    s_lshl_b32 s41, s41, 8
    s_and_b32 s40, s40, 3
    s_lshl_b32 s40, s40, 9
    v_mov_b32 v104, -1
    v_mov_b32 v105, -1
    v_mov_b32 v106, -1
    v_mov_b32 v107, -1
    s_or_b32 s42, s2, s16
    s_waitcnt lgkmcnt(0)
    s_mov_b32 s12, s6
    s_mov_b32 s13, s7
    s_cmp_lg_u32 s42, 0
    s_cbranch_scc1 h_non
    s_mul_i32 s42, s32, 0x9e3779b1
    s_lshr_b32 s43, s42, 15
    s_xor_b32 s42, s42, s43
    s_mul_i32 s42, s42, 0x85ebca6b
    s_xor_b32 s33, s33, s42
    s_lshr_b32 s43, s42, 13
    s_xor_b32 s42, s42, s43
    s_mul_i32 s33, s33, 0xc2b2ae35
    s_add_u32 s33, s33, s32
    s_lshr_b32 s43, s33, 16
    s_xor_b32 s33, s33, s43
    s_mul_i32 s33, s33, 0x27d4eb2f
    s_or_b32 s32, s42, 1
    s_andn2_b32 s33, s33, 7
    v_mov_b32 v10, s32
    v_mov_b32 v11, s33
    v_lshlrev_b32 v12, 3, v2
    s_mov_b32 exec_hi, 0
    global_store_dwordx2 v12, v[10:11], s[26:27] sc1
    s_mov_b32 exec_hi, -1
h_non:
    s_mov_b32 s44, s56
    s_mov_b32 s45, s57
    s_mov_b32 s46, 2048
    s_mov_b32 s47, 0x00020000
    buffer_load_ushort v6, v8, s[44:47], s40 offen
    buffer_load_ushort v7, v9, s[44:47], s41 offen
    s_barrier
    s_mov_b32 s8, s58
    s_mov_b32 s9, s59
    s_mov_b32 s10, 12582912
    s_mov_b32 s11, 0x00020000
    s_mov_b32 s20, s26
    s_mov_b32 s21, s27
    s_mov_b32 s26, 4194304
    s_mov_b32 s27, 0x00020000
    s_and_b32 s65, s35, 1
    s_lshr_b32 s40, s35, 1
    s_mul_i32 s64, s34, 7
    s_add_u32 s64, s64, s40
    s_lshl_b32 s41, s34, 1
    s_add_u32 s41, s41, s65
    s_cmp_ge_u32 s35, 14
    s_cselect_b32 s66, 1, 0
    s_cselect_b32 s64, s41, s64
    v_lshrrev_b32 v10, 2, v2
    v_and_b32 v15, 3, v0
    v_bfe_u32 v11, v0, 3, 2
    v_xor_b32 v12, v11, v1
    v_and_b32 v12, 3, v12
    v_lshlrev_b32 v12, 5, v12
    v_lshl_add_u32 v12, v10, 7, v12
    v_lshl_add_u32 v12, v15, 3, v12
    v_lshrrev_b32 v16, 2, v1
    v_lshl_add_u32 v12, v16, 15, v12
    v_add_u32 v21, 65536, v12
    s_cmp_eq_u32 s66, 0
    s_cbranch_scc1 g_c0
    v_and_b32 v204, 255, v0
    v_lshlrev_b32 v204, 2, v204
    v_bfe_u32 v200, v204, 4, 1
    v_lshlrev_b32 v200, 5, v200
    v_bfe_u32 v201, v204, 7, 2
    v_lshl_add_u32 v200, v201, 3, v200
    v_bfe_u32 v201, v204, 9, 1
    v_lshl_add_u32 v200, v201, 2, v200
    v_bfe_u32 v201, v204, 5, 2
    v_add_lshl_u32 v200, v201, v200, 4
    v_xor_b32 v202, 1008, v200
    v_and_b32 v206, 3, v0
    v_lshl_add_u32 v200, v206, 10, v200
    v_sub_u32 v205, 4, v206
    v_and_b32 v205, 3, v205
    v_lshl_add_u32 v201, v205, 10, v202
    v_sub_u32 v205, 3, v206
    v_lshl_add_u32 v202, v205, 10, v202
    v_bfe_u32 v203, v204, 7, 1
    v_lshlrev_b32 v203, 9, v203
    v_and_b32 v205, 31, v204
    v_lshl_add_u32 v203, v205, 4, v203
    v_bfe_u32 v205, v204, 8, 1
    v_lshl_add_u32 v203, v205, 3, v203
    v_lshrrev_b32 v205, 9, v204
    v_lshl_add_u32 v203, v205, 10, v203
    v_bfe_u32 v205, v204, 5, 2
    v_lshl_add_u32 v203, v205, 1, v203
    s_lshl_b32 s22, s34, 17
    s_add_u32 s22, s22, 19922944
    s_lshl_b32 s79, s34, 10
    s_lshl_b32 s23, s65, 7
    s_add_u32 s79, s79, s23
    s_add_u32 s79, s79, 16850944
g_c0:
    v_bfe_u32 v22, v0, 2, 3
    v_lshlrev_b32 v23, 1, v1
    v_xor_b32 v22, v22, v23
    v_lshlrev_b32 v22, 5, v22
    v_lshl_add_u32 v22, v15, 3, v22
    v_bfe_u32 v23, v0, 2, 2
    v_lshl_add_u32 v22, v23, 8, v22
    v_bfe_u32 v23, v0, 4, 2
    v_lshl_add_u32 v22, v23, 11, v22
    v_add_u32 v22, 32768, v22
    v_xor_b32 v23, 32, v22
    v_add_u32 v208, 65536, v22
    v_add_u32 v209, 65536, v23
    v_and_b32 v10, 48, v0
    v_cmp_eq_u32 s[72:73], 16, v10
    v_add_u32 v10, 139264, v10
    v_add_u32 v8, 139264, v8
    v_add_u32 v9, 139264, v9
    s_waitcnt vmcnt(0)
    s_load_dwordx2 s[32:33], s[20:21], 128
    v_lshlrev_b32 v6, 16, v6
    v_lshlrev_b32 v7, 16, v7
    v_mul_f32 v24, 0xbfb8aa3b, v6
    v_mul_f32 v25, 0xbfb8aa3b, v7
    v_exp_f32 v24, v24
    v_exp_f32 v25, v25
    v_add_f32 v24, 1.0, v24
    v_add_f32 v25, 1.0, v25
    v_rcp_f32 v24, v24
    v_rcp_f32 v25, v25
    v_mul_f32 v6, v6, v24
    v_mul_f32 v7, v7, v25
    v_cvt_pk_bf16_f32 v6, v6, v7
    ds_write_b16 v8, v6
    ds_write_b16_d16_hi v9, v6 offset:512
    buffer_store_dwordx4 v[104:107], v3, s[12:15], s38 offen offset:0 sc1
    buffer_store_dwordx4 v[104:107], v3, s[12:15], s38 offen offset:1024 sc1
    s_waitcnt lgkmcnt(0)
    s_cmp_lg_u32 s32, 0
    s_cbranch_scc1 g_nnx
    s_load_dwordx2 s[32:33], s[20:21], 192
    s_mov_b32 s83, 0
    v_mov_b32 v122, 0
    s_waitcnt lgkmcnt(0)
g_nn:
    s_cmp_lg_u32 s32, 0
    s_cbranch_scc1 g_nnx
    global_load_dwordx2 v[120:121], v122, s[20:21] sc1
    s_waitcnt vmcnt(0)
    v_readfirstlane_b32 s32, v120
    v_readfirstlane_b32 s33, v121
    s_add_u32 s83, s83, 1
    s_cmp_lt_u32 s83, 0x40000
    s_cbranch_scc1 g_nn
g_nnx:
    v_mov_b32 v210, s32
    v_mov_b32 v211, s33
    v_and_b32 v212, 7, v0
    v_lshlrev_b32 v212, 3, v212
    v_lshrrev_b64 v[210:211], v212, v[210:211]
    v_and_b32 v210, 0xff, v210
    s_movk_i32 s74, 0xff00
    v_not_b32 v24, v210
    s_mov_b32 exec_hi, 0
    buffer_store_dword v24, v13, s[12:15], s30 offen sc1
    buffer_store_dword v24, v13, s[12:15], s31 offen sc1
    s_mov_b32 exec_hi, -1
    s_barrier
    ds_read_b128 v[68:71], v10 offset:0
    ds_read_b128 v[72:75], v10 offset:64
    ds_read_b128 v[76:79], v10 offset:128
    ds_read_b128 v[80:83], v10 offset:192
    ds_read_b128 v[84:87], v10 offset:256
    ds_read_b128 v[88:91], v10 offset:320
    ds_read_b128 v[92:95], v10 offset:384
    ds_read_b128 v[96:99], v10 offset:448
    ds_read_b128 v[100:103], v10 offset:512
    ds_read_b128 v[104:107], v10 offset:576
    ds_read_b128 v[108:111], v10 offset:640
    ds_read_b128 v[112:115], v10 offset:704
    ds_read_b64_tr_b16 v[128:129], v22 offset:0
    ds_read_b64_tr_b16 v[130:131], v22 offset:1024
    ds_read_b64_tr_b16 v[132:133], v23 offset:0
    ds_read_b64_tr_b16 v[134:135], v23 offset:1024
    ds_read_b64_tr_b16 v[136:137], v22 offset:8192
    ds_read_b64_tr_b16 v[138:139], v22 offset:9216
    ds_read_b64_tr_b16 v[140:141], v23 offset:8192
    ds_read_b64_tr_b16 v[142:143], v23 offset:9216
    ds_read_b64_tr_b16 v[144:145], v22 offset:16384
    ds_read_b64_tr_b16 v[146:147], v22 offset:17408
    ds_read_b64_tr_b16 v[148:149], v23 offset:16384
    ds_read_b64_tr_b16 v[150:151], v23 offset:17408
    ds_read_b64_tr_b16 v[152:153], v22 offset:24576
    ds_read_b64_tr_b16 v[154:155], v22 offset:25600
    s_waitcnt lgkmcnt(12)
    v_mfma_f32_16x16x32_bf16 v[24:27], v[68:71], v[128:131], 0
    ds_read_b64_tr_b16 v[156:157], v23 offset:24576
    ds_read_b64_tr_b16 v[158:159], v23 offset:25600
    s_waitcnt lgkmcnt(12)
    v_mfma_f32_16x16x32_bf16 v[28:31], v[68:71], v[132:135], 0
    s_waitcnt lgkmcnt(10)
    v_mfma_f32_16x16x32_bf16 v[24:27], v[72:75], v[136:139], v[24:27]
    s_waitcnt lgkmcnt(8)
    v_mfma_f32_16x16x32_bf16 v[28:31], v[72:75], v[140:143], v[28:31]
    s_waitcnt lgkmcnt(6)
    v_mfma_f32_16x16x32_bf16 v[24:27], v[76:79], v[144:147], v[24:27]
    s_waitcnt lgkmcnt(4)
    v_mfma_f32_16x16x32_bf16 v[28:31], v[76:79], v[148:151], v[28:31]
    s_waitcnt lgkmcnt(2)
    v_mfma_f32_16x16x32_bf16 v[24:27], v[80:83], v[152:155], v[24:27]
    s_waitcnt lgkmcnt(0)
    v_mfma_f32_16x16x32_bf16 v[28:31], v[80:83], v[156:159], v[28:31]
    s_waitcnt vmcnt(0)
    s_barrier
    ds_read_b64_tr_b16 v[128:129], v22 offset:32768
    ds_read_b64_tr_b16 v[130:131], v22 offset:33792
    ds_read_b64_tr_b16 v[132:133], v23 offset:32768
    ds_read_b64_tr_b16 v[134:135], v23 offset:33792
    ds_read_b64_tr_b16 v[136:137], v22 offset:40960
    ds_read_b64_tr_b16 v[138:139], v22 offset:41984
    ds_read_b64_tr_b16 v[140:141], v23 offset:40960
    ds_read_b64_tr_b16 v[142:143], v23 offset:41984
    ds_read_b64_tr_b16 v[144:145], v22 offset:49152
    ds_read_b64_tr_b16 v[146:147], v22 offset:50176
    ds_read_b64_tr_b16 v[148:149], v23 offset:49152
    ds_read_b64_tr_b16 v[150:151], v23 offset:50176
    ds_read_b64_tr_b16 v[152:153], v22 offset:57344
    ds_read_b64_tr_b16 v[154:155], v22 offset:58368
    s_waitcnt lgkmcnt(12)
    v_mfma_f32_16x16x32_bf16 v[24:27], v[84:87], v[128:131], v[24:27]
    ds_read_b64_tr_b16 v[156:157], v23 offset:57344
    ds_read_b64_tr_b16 v[158:159], v23 offset:58368
    s_waitcnt lgkmcnt(12)
    v_mfma_f32_16x16x32_bf16 v[28:31], v[84:87], v[132:135], v[28:31]
    s_waitcnt lgkmcnt(10)
    v_mfma_f32_16x16x32_bf16 v[24:27], v[88:91], v[136:139], v[24:27]
    s_waitcnt lgkmcnt(8)
    v_mfma_f32_16x16x32_bf16 v[28:31], v[88:91], v[140:143], v[28:31]
    s_waitcnt lgkmcnt(6)
    v_mfma_f32_16x16x32_bf16 v[24:27], v[92:95], v[144:147], v[24:27]
    s_waitcnt lgkmcnt(4)
    v_mfma_f32_16x16x32_bf16 v[28:31], v[92:95], v[148:151], v[28:31]
    s_waitcnt lgkmcnt(2)
    v_mfma_f32_16x16x32_bf16 v[24:27], v[96:99], v[152:155], v[24:27]
    s_waitcnt lgkmcnt(0)
    v_mfma_f32_16x16x32_bf16 v[28:31], v[96:99], v[156:159], v[28:31]
    s_nop 7
    v_cndmask_b32 v24, v24, v28, s[72:73]
    v_and_or_b32 v24, v24, s74, v210
    s_mov_b32 exec_hi, 0
    buffer_store_dword v24, v13, s[12:15], s30 offen sc1
    s_mov_b32 exec_hi, -1
    s_barrier
    s_cmp_eq_u32 s66, 1
    s_cbranch_scc1 x_start
    s_barrier
    ds_read_b64_tr_b16 v[128:129], v208 offset:0
    ds_read_b64_tr_b16 v[130:131], v208 offset:1024
    ds_read_b64_tr_b16 v[132:133], v209 offset:0
    ds_read_b64_tr_b16 v[134:135], v209 offset:1024
    ds_read_b64_tr_b16 v[136:137], v208 offset:8192
    ds_read_b64_tr_b16 v[138:139], v208 offset:9216
    ds_read_b64_tr_b16 v[140:141], v209 offset:8192
    ds_read_b64_tr_b16 v[142:143], v209 offset:9216
    ds_read_b64_tr_b16 v[144:145], v208 offset:16384
    ds_read_b64_tr_b16 v[146:147], v208 offset:17408
    ds_read_b64_tr_b16 v[148:149], v209 offset:16384
    ds_read_b64_tr_b16 v[150:151], v209 offset:17408
    ds_read_b64_tr_b16 v[152:153], v208 offset:24576
    ds_read_b64_tr_b16 v[154:155], v208 offset:25600
    s_waitcnt lgkmcnt(12)
    v_mfma_f32_16x16x32_bf16 v[24:27], v[100:103], v[128:131], 0
    ds_read_b64_tr_b16 v[156:157], v209 offset:24576
    ds_read_b64_tr_b16 v[158:159], v209 offset:25600
    s_waitcnt lgkmcnt(12)
    v_mfma_f32_16x16x32_bf16 v[28:31], v[100:103], v[132:135], 0
    s_waitcnt lgkmcnt(10)
    v_mfma_f32_16x16x32_bf16 v[24:27], v[104:107], v[136:139], v[24:27]
    s_waitcnt lgkmcnt(8)
    v_mfma_f32_16x16x32_bf16 v[28:31], v[104:107], v[140:143], v[28:31]
    s_waitcnt lgkmcnt(6)
    v_mfma_f32_16x16x32_bf16 v[24:27], v[108:111], v[144:147], v[24:27]
    s_waitcnt lgkmcnt(4)
    v_mfma_f32_16x16x32_bf16 v[28:31], v[108:111], v[148:151], v[28:31]
    s_waitcnt lgkmcnt(2)
    v_mfma_f32_16x16x32_bf16 v[24:27], v[112:115], v[152:155], v[24:27]
    s_waitcnt lgkmcnt(0)
    v_mfma_f32_16x16x32_bf16 v[28:31], v[112:115], v[156:159], v[28:31]
    s_nop 7
    v_cndmask_b32 v24, v24, v28, s[72:73]
    v_and_or_b32 v24, v24, s74, v210
    s_mov_b32 exec_hi, 0
    buffer_store_dword v24, v13, s[12:15], s31 offen sc1
    s_mov_b32 exec_hi, -1
    s_barrier
    s_getreg_b32 s39, hwreg(HW_REG_XCC_ID)
    s_and_b32 s39, s39, 7
    s_or_b32 s39, s39, s33
    s_lshl_b32 s38, s64, 1
    s_add_u32 s38, s38, s65
    s_lshl_b32 s38, s38, 7
    s_add_u32 s38, s38, 16859136
    v_mov_b32 v22, 0
    s_cmp_lg_u32 s16, 1
    s_cbranch_scc1 m_nx
    v_mov_b32 v24, s32
    v_mov_b32 v25, s39
    s_mov_b64 exec, 1
    buffer_store_dwordx2 v[24:25], v22, s[12:15], s38 offen sc1
    s_mov_b64 exec, -1
m_nx:
    s_xor_b32 s38, s38, 128
    s_barrier
    ds_read_b64_tr_b16 v[64:65], v12 offset:0
    ds_read_b64_tr_b16 v[66:67], v12 offset:2048
    ds_read_b64_tr_b16 v[68:69], v12 offset:4096
    ds_read_b64_tr_b16 v[70:71], v12 offset:6144
    ds_read_b64_tr_b16 v[72:73], v12 offset:8192
    ds_read_b64_tr_b16 v[74:75], v12 offset:10240
    ds_read_b64_tr_b16 v[76:77], v12 offset:12288
    ds_read_b64_tr_b16 v[78:79], v12 offset:14336
    ds_read_b64_tr_b16 v[80:81], v12 offset:16384
    ds_read_b64_tr_b16 v[82:83], v12 offset:18432
    ds_read_b64_tr_b16 v[84:85], v12 offset:20480
    ds_read_b64_tr_b16 v[86:87], v12 offset:22528
    ds_read_b64_tr_b16 v[88:89], v12 offset:24576
    ds_read_b64_tr_b16 v[90:91], v12 offset:26624
    ds_read_b64_tr_b16 v[92:93], v12 offset:28672
    ds_read_b64_tr_b16 v[94:95], v12 offset:30720
    s_waitcnt lgkmcnt(0)
    s_barrier
    s_barrier
    ds_read_b64_tr_b16 v[96:97], v21 offset:0
    ds_read_b64_tr_b16 v[98:99], v21 offset:2048
    ds_read_b64_tr_b16 v[100:101], v21 offset:4096
    ds_read_b64_tr_b16 v[102:103], v21 offset:6144
    ds_read_b64_tr_b16 v[104:105], v21 offset:8192
    ds_read_b64_tr_b16 v[106:107], v21 offset:10240
    ds_read_b64_tr_b16 v[108:109], v21 offset:12288
    ds_read_b64_tr_b16 v[110:111], v21 offset:14336
    ds_read_b64_tr_b16 v[112:113], v21 offset:16384
    ds_read_b64_tr_b16 v[114:115], v21 offset:18432
    ds_read_b64_tr_b16 v[116:117], v21 offset:20480
    ds_read_b64_tr_b16 v[118:119], v21 offset:22528
    ds_read_b64_tr_b16 v[120:121], v21 offset:24576
    ds_read_b64_tr_b16 v[122:123], v21 offset:26624
    ds_read_b64_tr_b16 v[124:125], v21 offset:28672
    ds_read_b64_tr_b16 v[126:127], v21 offset:30720
    s_barrier
m_join:
    v_lshrrev_b32 v6, 2, v2
    v_and_b32 v7, 7, v6
    v_lshlrev_b32 v8, 2, v1
    v_xor_b32 v8, v8, v7
    v_lshlrev_b32 v8, 5, v8
    v_lshl_add_u32 v8, v6, 10, v8
    v_lshl_add_u32 v8, v15, 3, v8
    v_xor_b32 v9, 32, v8
    v_xor_b32 v10, 64, v8
    v_xor_b32 v11, 96, v8
    v_bfe_u32 v7, v0, 4, 2
    v_and_b32 v6, 1, v0
    v_lshlrev_b32 v17, 10, v6
    v_lshl_add_u32 v17, v16, 9, v17
    v_lshl_add_u32 v17, v7, 4, v17
    v_add_u32 v17, 131072, v17
    v_lshlrev_b32 v19, 7, v6
    v_lshl_add_u32 v19, v7, 4, v19
    v_add_u32 v19, 133120, v19
    v_and_b32 v6, 15, v0
    v_lshlrev_b32 v18, 1, v6
    v_lshl_add_u32 v18, v1, 5, v18
    v_lshl_add_u32 v18, v7, 7, v18
    v_add_u32 v18, 133120, v18
    v_lshlrev_b32 v20, 2, v6
    v_lshl_add_u32 v20, v1, 14, v20
    v_lshl_add_u32 v20, v7, 12, v20
    v_cmp_eq_u32 s[60:61], 1, v7
    v_cmp_eq_u32 s[62:63], 2, v7
    v_cmp_eq_u32 s[72:73], 3, v7
    v_lshlrev_b32 v13, 6, v6
    v_bfe_u32 v22, v0, 4, 1
    v_lshl_add_u32 v13, v22, 5, v13
    v_bfe_u32 v22, v0, 5, 1
    v_lshl_add_u32 v13, v22, 4, v13
    v_add_u32 v13, 131072, v13
    s_lshl_b32 s70, s65, 10
    s_add_u32 s70, s70, 18874368
    s_lshl_b32 s74, s65, 17
    s_lshl_b32 s75, s64, 6
    s_add_u32 s74, s74, s75
    s_add_u32 s74, s74, 17825792
    s_add_u32 s75, s74, 262144
    s_lshl_b32 s69, s64, 2
    s_and_b32 s42, s16, 3
    s_add_u32 s69, s69, s42
    s_lshl_b32 s69, s69, 10
    s_add_u32 s81, s69, 18350080
    s_add_u32 s82, s69, 18612224
    s_lshl_b32 s76, s65, 1
    s_lshr_b32 s42, s16, 2
    s_add_u32 s76, s76, s42
    s_lshl_b32 s76, s76, 8
    s_add_u32 s77, s76, s82
    s_add_u32 s76, s76, s81
    s_lshl_b32 s78, s34, 11
    s_lshl_b32 s79, s34, 7
    s_add_u32 s79, s79, 16842752
    s_add_u32 s78, s78, 18857984
    s_barrier
    s_cmp_lg_u32 s16, 0
    s_cbranch_scc1 m_n0
    v_lshlrev_b32 v4, 6, v2
    buffer_load_dword v5, v4, s[12:15], s81 offen sc1
    s_mov_b64 exec, 1
    buffer_load_dwordx2 v[188:189], v22, s[12:15], s38 offen sc1
    buffer_load_dwordx2 v[28:29], v22, s[12:15], s79 offen sc1
    s_mov_b64 exec, -1
m_n0:
    s_waitcnt vmcnt(0)
    s_barrier
    v_mov_b32 v190, 134144
    s_cmp_lg_u32 s16, 0
    s_cbranch_scc1 m_n1
    s_mov_b64 exec, 1
    v_xor_b32 v188, s32, v188
    v_xor_b32 v189, s39, v189
    v_or_b32 v188, v188, v189
    ds_write_b32 v190, v188
    v_cmp_ne_u64 vcc, s[32:33], v[28:29]
    s_cbranch_vccnz m_n1
    s_mov_b64 exec, -1
    buffer_load_dwordx4 v[24:27], v3, s[12:15], s78 offen sc1
m_n1:
    s_mov_b64 exec, -1
    ds_read_b64_tr_b16 v[32:33], v8 offset:0
    ds_read_b64_tr_b16 v[34:35], v8 offset:16384
    ds_read_b64_tr_b16 v[36:37], v9 offset:0
    ds_read_b64_tr_b16 v[38:39], v9 offset:16384
    ds_read_b64_tr_b16 v[40:41], v10 offset:0
    ds_read_b64_tr_b16 v[42:43], v10 offset:16384
    ds_read_b64_tr_b16 v[44:45], v11 offset:0
    ds_read_b64_tr_b16 v[46:47], v11 offset:16384
    ds_read_b64_tr_b16 v[48:49], v8 offset:32768
    ds_read_b64_tr_b16 v[50:51], v8 offset:49152
    ds_read_b64_tr_b16 v[52:53], v9 offset:32768
    ds_read_b64_tr_b16 v[54:55], v9 offset:49152
    ds_read_b64_tr_b16 v[56:57], v10 offset:32768
    ds_read_b64_tr_b16 v[58:59], v10 offset:49152
    ds_read_b64_tr_b16 v[60:61], v11 offset:32768
    ds_read_b64_tr_b16 v[62:63], v11 offset:49152
    s_cmp_lg_u32 s16, 0
    s_cbranch_scc1 m_nk
    s_cbranch_vccnz m_slowk
    s_waitcnt vmcnt(0)
    v_max3_u32 v4, v24, v25, v26
    v_max_u32 v4, v4, v27
    v_cmp_eq_u32 vcc, -1, v4
    s_cbranch_vccz m_pkx
    s_branch m_gox
m_slowk:
    s_mov_b32 s83, 0
    s_mov_b64 exec, 1
m_go:
    buffer_load_dwordx2 v[28:29], v22, s[12:15], s79 offen sc1
    s_waitcnt vmcnt(0)
    v_cmp_ne_u64 vcc, s[32:33], v[28:29]
    s_cbranch_vccz m_goy
    s_sleep 3
    s_add_u32 s83, s83, 1
    s_cmp_lt_u32 s83, 0x40000
    s_cbranch_scc1 m_go
m_goy:
    s_mov_b64 exec, -1
m_gox:
    s_sleep 1
    s_mov_b32 s83, 0
m_pk:
    buffer_load_dwordx4 v[24:27], v3, s[12:15], s78 offen sc1
    s_waitcnt vmcnt(0)
    v_max3_u32 v4, v24, v25, v26
    v_max_u32 v4, v4, v27
    v_cmp_eq_u32 vcc, -1, v4
    s_cbranch_vccz m_pkx
    s_sleep 4
    s_add_u32 s83, s83, 1
    s_cmp_lt_u32 s83, 0x40000
    s_cbranch_scc1 m_pk
m_pkx:
    v_max_u32 v28, v24, v26
    v_min_u32 v29, v24, v26
    v_max3_u32 v29, v29, v25, v27
    v_mov_b32 v30, v28
    s_nop 1
    v_max_u32_dpp v30, v30, v30 row_ror:8 row_mask:0xf bank_mask:0xf
    s_nop 1
    v_max_u32_dpp v30, v30, v30 row_ror:4 row_mask:0xf bank_mask:0xf
    s_nop 1
    v_max_u32_dpp v30, v30, v30 row_ror:2 row_mask:0xf bank_mask:0xf
    s_nop 1
    v_max_u32_dpp v30, v30, v30 row_ror:1 row_mask:0xf bank_mask:0xf
    s_nop 1
    v_max_u32_dpp v30, v30, v30 row_bcast:15 row_mask:0xa bank_mask:0xf
    s_nop 1
    v_max_u32_dpp v30, v30, v30 row_bcast:31 row_mask:0xc bank_mask:0xf
    s_nop 0
    v_readlane_b32 s40, v30, 63
    s_nop 1
    v_cmp_eq_u32 vcc, s40, v28
    s_nop 1
    v_cndmask_b32 v30, v28, v29, vcc
    s_nop 1
    v_max_u32_dpp v30, v30, v30 row_ror:8 row_mask:0xf bank_mask:0xf
    s_nop 1
    v_max_u32_dpp v30, v30, v30 row_ror:4 row_mask:0xf bank_mask:0xf
    s_nop 1
    v_max_u32_dpp v30, v30, v30 row_ror:2 row_mask:0xf bank_mask:0xf
    s_nop 1
    v_max_u32_dpp v30, v30, v30 row_ror:1 row_mask:0xf bank_mask:0xf
    s_nop 1
    v_max_u32_dpp v30, v30, v30 row_bcast:15 row_mask:0xa bank_mask:0xf
    s_nop 1
    v_max_u32_dpp v30, v30, v30 row_bcast:31 row_mask:0xc bank_mask:0xf
    s_nop 0
    v_readlane_b32 s41, v30, 63
    s_bfe_u32 s42, s40, 0x70005
    s_lshl_b32 s42, s42, 13
    s_and_b32 s40, s40, 1
    s_lshl_b32 s40, s40, 12
    s_add_u32 s42, s42, s40
    s_bfe_u32 s43, s41, 0x70005
    s_lshl_b32 s43, s43, 13
    s_and_b32 s41, s41, 1
    s_lshl_b32 s41, s41, 12
    s_add_u32 s43, s43, s41
    s_add_u32 s42, s42, s70
    s_add_u32 s43, s43, s70
    s_mov_b32 s83, 0
m_ph:
    buffer_load_dwordx4 v[176:179], v3, s[12:15], s42 offen sc1
    buffer_load_dwordx4 v[180:183], v3, s[12:15], s43 offen sc1
    s_waitcnt vmcnt(0)
    ds_write_b128 v13, v[176:179]
    ds_write_b128 v13, v[180:183] offset:1024
    v_max3_u32 v4, v176, v177, v178
    v_max3_u32 v4, v4, v179, v180
    v_max3_u32 v4, v4, v181, v182
    v_max_u32 v4, v4, v183
    v_cmp_eq_u32 vcc, -1, v4
    s_cbranch_vccz m_phx
    s_add_u32 s83, s83, 1
    s_cmp_lt_u32 s83, 0x40000
    s_cbranch_scc1 m_ph
m_phx:
    s_waitcnt lgkmcnt(0)
m_nk:
    s_barrier
    ds_read_b32 v188, v190
    ds_read_b128 v[128:131], v17 offset:0
    ds_read_b128 v[132:135], v17 offset:64
    ds_read_b128 v[136:139], v17 offset:128
    ds_read_b128 v[140:143], v17 offset:192
    ds_read_b128 v[144:147], v17 offset:256
    ds_read_b128 v[148:151], v17 offset:320
    ds_read_b128 v[152:155], v17 offset:384
    ds_read_b128 v[156:159], v17 offset:448
    s_waitcnt lgkmcnt(7)
    v_mfma_f32_16x16x32_bf16 v[160:163], v[128:131], v[64:67], 0
    v_mfma_f32_16x16x32_bf16 v[164:167], v[128:131], v[96:99], 0
    s_waitcnt lgkmcnt(6)
    v_mfma_f32_16x16x32_bf16 v[160:163], v[132:135], v[68:71], v[160:163]
    v_mfma_f32_16x16x32_bf16 v[164:167], v[132:135], v[100:103], v[164:167]
    s_waitcnt lgkmcnt(5)
    v_mfma_f32_16x16x32_bf16 v[160:163], v[136:139], v[72:75], v[160:163]
    v_mfma_f32_16x16x32_bf16 v[164:167], v[136:139], v[104:107], v[164:167]
    s_waitcnt lgkmcnt(4)
    v_mfma_f32_16x16x32_bf16 v[160:163], v[140:143], v[76:79], v[160:163]
    v_mfma_f32_16x16x32_bf16 v[164:167], v[140:143], v[108:111], v[164:167]
    s_waitcnt lgkmcnt(3)
    v_mfma_f32_16x16x32_bf16 v[160:163], v[144:147], v[80:83], v[160:163]
    v_mfma_f32_16x16x32_bf16 v[164:167], v[144:147], v[112:115], v[164:167]
    s_waitcnt lgkmcnt(2)
    v_mfma_f32_16x16x32_bf16 v[160:163], v[148:151], v[84:87], v[160:163]
    v_mfma_f32_16x16x32_bf16 v[164:167], v[148:151], v[116:119], v[164:167]
    s_waitcnt lgkmcnt(1)
    v_mfma_f32_16x16x32_bf16 v[160:163], v[152:155], v[88:91], v[160:163]
    v_mfma_f32_16x16x32_bf16 v[164:167], v[152:155], v[120:123], v[164:167]
    s_waitcnt lgkmcnt(0)
    v_mfma_f32_16x16x32_bf16 v[160:163], v[156:159], v[92:95], v[160:163]
    v_mfma_f32_16x16x32_bf16 v[164:167], v[156:159], v[124:127], v[164:167]
    v_readfirstlane_b32 s71, v188
    s_nop 5
    v_min_u32 v184, -2, v160
    v_min_u32 v185, -2, v161
    v_min_u32 v186, -2, v164
    v_min_u32 v187, -2, v165
    s_mov_b64 exec, 0xffff
    buffer_store_dwordx4 v[184:187], v3, s[12:15], s76 offen
    s_cmp_eq_u32 s71, 0
    s_cbranch_scc1 m_same
    buffer_store_dwordx4 v[184:187], v3, s[12:15], s77 offen sc1
m_same:
    s_mov_b64 exec, -1
    s_cmp_ge_u32 s16, 4
    s_cbranch_scc1 m_na
    s_sleep 2
    s_mov_b32 s83, 0
m_px:
    buffer_load_dwordx4 v[24:27], v3, s[12:15], s81 offen sc1
    s_waitcnt vmcnt(0)
    v_max3_u32 v4, v24, v25, v26
    v_max_u32 v4, v4, v27
    v_cmp_eq_u32 vcc, -1, v4
    s_cbranch_vccz m_pxx
    buffer_load_dwordx4 v[24:27], v3, s[12:15], s81 offen sc1
    s_waitcnt vmcnt(0)
    v_max3_u32 v4, v24, v25, v26
    v_max_u32 v4, v4, v27
    v_cmp_eq_u32 vcc, -1, v4
    s_cbranch_vccz m_pxx
    buffer_load_dwordx4 v[24:27], v3, s[12:15], s82 offen sc1
    s_waitcnt vmcnt(0)
    v_max3_u32 v4, v24, v25, v26
    v_max_u32 v4, v4, v27
    v_cmp_eq_u32 vcc, -1, v4
    s_cbranch_vccz m_pxx
    s_add_u32 s83, s83, 1
    s_cmp_lt_u32 s83, 0x40000
    s_cbranch_scc1 m_px
m_pxx:
    v_permlane32_swap_b32 v24, v26
    v_permlane32_swap_b32 v25, v27
    v_pk_add_f32 v[24:25], v[24:25], v[26:27]
    s_nop 1
    v_permlane16_swap_b32 v24, v25
    v_add_f32 v24, v24, v25
    v_cvt_pk_bf16_f32 v24, v24, v24
    v_lshlrev_b32 v24, 16, v24
    v_mul_f32 v25, 0xbfb8aa3b, v24
    v_exp_f32 v25, v25
    v_mov_b32 v26, v24
    v_add_f32 v25, 1.0, v25
    v_rcp_f32 v25, v25
    v_mov_b32 v27, v24
    v_mul_f32 v25, v24, v25
    s_nop 0
    v_permlane32_swap_b32 v26, v27
    v_cvt_pk_bf16_f32 v25, v25, v25
    v_lshlrev_b32 v25, 16, v25
    v_mul_f32 v25, v25, v27
    v_cvt_pk_bf16_f32 v25, v25, v25
    ds_write_b16 v18, v25
m_na:
    s_waitcnt lgkmcnt(0)
    s_barrier
    ds_read_b128 v[128:131], v19 offset:0
    ds_read_b128 v[132:135], v19 offset:64
    s_waitcnt lgkmcnt(1)
    v_mfma_f32_16x16x32_bf16 v[160:163], v[128:131], v[32:35], 0
    v_mfma_f32_16x16x32_bf16 v[164:167], v[128:131], v[36:39], 0
    v_mfma_f32_16x16x32_bf16 v[168:171], v[128:131], v[40:43], 0
    v_mfma_f32_16x16x32_bf16 v[172:175], v[128:131], v[44:47], 0
    s_waitcnt lgkmcnt(0)
    v_mfma_f32_16x16x32_bf16 v[160:163], v[132:135], v[48:51], v[160:163]
    v_mfma_f32_16x16x32_bf16 v[164:167], v[132:135], v[52:55], v[164:167]
    v_mfma_f32_16x16x32_bf16 v[168:171], v[132:135], v[56:59], v[168:171]
    v_mfma_f32_16x16x32_bf16 v[172:175], v[132:135], v[60:63], v[172:175]
    s_nop 5
    v_cndmask_b32 v24, v160, v164, s[60:61]
    v_cndmask_b32 v25, v161, v165, s[60:61]
    v_cndmask_b32 v24, v24, v168, s[62:63]
    v_cndmask_b32 v25, v25, v169, s[62:63]
    v_cndmask_b32 v24, v24, v172, s[72:73]
    v_cndmask_b32 v25, v25, v173, s[72:73]
    v_min_u32 v24, -2, v24
    v_min_u32 v25, -2, v25
    buffer_store_dword v24, v20, s[12:15], s74 offen sc1
    buffer_store_dword v25, v20, s[12:15], s75 offen sc1
    s_endpgm
x_start:
    s_mov_b32 s56, s48
    s_mov_b32 s57, s49
    s_mov_b32 s58, 2048
    s_mov_b32 s59, 0x00020000
    v_mov_b32 v212, s32
    v_mov_b32 v213, s33
    v_and_b32 v214, 7, v204
    v_lshlrev_b32 v214, 3, v214
    v_lshrrev_b64 v[212:213], v214, v[212:213]
    v_bfe_u32 v213, v212, 8, 8
    v_bfe_u32 v214, v212, 16, 8
    v_lshrrev_b32 v215, 24, v212
    v_and_b32 v212, 0xff, v212
    v_lshlrev_b32 v8, 4, v0
    v_lshlrev_b32 v9, 2, v1
    v_add_u32 v9, 135168, v9
    v_mov_b32 v10, 135168
    v_lshlrev_b32 v11, 2, v204
    v_lshlrev_b32 v12, 1, v204
    s_getreg_b32 s39, hwreg(HW_REG_XCC_ID)
    s_and_b32 s39, s39, 7
    s_or_b32 s39, s39, s33
    s_lshr_b32 s40, s16, 2
    buffer_load_dwordx2 v[64:65], v12, s[56:59], 0 offen
    s_lshl_b32 s41, s65, 1
    s_add_u32 s41, s41, s40
    s_lshl_b32 s41, s41, 14
    s_add_u32 s41, s41, 16908288
    s_cmp_eq_u32 s40, 1
    s_cselect_b32 s43, 1.0, 0
    s_sleep 8
    s_mov_b32 s83, 0
x_g0:
    s_mov_b32 s42, s41
    buffer_load_dwordx4 v[32:35], v11, s[12:15], s42 offen sc1
    s_add_u32 s42, s42, 4096
    buffer_load_dwordx4 v[36:39], v11, s[12:15], s42 offen sc1
    s_add_u32 s42, s42, 4096
    buffer_load_dwordx4 v[40:43], v11, s[12:15], s42 offen sc1
    s_add_u32 s42, s42, 4096
    buffer_load_dwordx4 v[44:47], v11, s[12:15], s42 offen sc1
    s_cmp_lg_u32 s83, 0
    s_cbranch_scc1 x_t2
    s_waitcnt vmcnt(5)
    s_barrier
    s_cmp_ge_u32 s16, 4
    s_cbranch_scc1 x_t2
    ds_read_b64_tr_b16 v[128:129], v208 offset:0
    ds_read_b64_tr_b16 v[130:131], v208 offset:1024
    ds_read_b64_tr_b16 v[132:133], v209 offset:0
    ds_read_b64_tr_b16 v[134:135], v209 offset:1024
    ds_read_b64_tr_b16 v[136:137], v208 offset:8192
    ds_read_b64_tr_b16 v[138:139], v208 offset:9216
    ds_read_b64_tr_b16 v[140:141], v209 offset:8192
    ds_read_b64_tr_b16 v[142:143], v209 offset:9216
    ds_read_b64_tr_b16 v[144:145], v208 offset:16384
    ds_read_b64_tr_b16 v[146:147], v208 offset:17408
    ds_read_b64_tr_b16 v[148:149], v209 offset:16384
    ds_read_b64_tr_b16 v[150:151], v209 offset:17408
    ds_read_b64_tr_b16 v[152:153], v208 offset:24576
    ds_read_b64_tr_b16 v[154:155], v208 offset:25600
    s_waitcnt lgkmcnt(12)
    v_mfma_f32_16x16x32_bf16 v[24:27], v[100:103], v[128:131], 0
    ds_read_b64_tr_b16 v[156:157], v209 offset:24576
    ds_read_b64_tr_b16 v[158:159], v209 offset:25600
    s_waitcnt lgkmcnt(12)
    v_mfma_f32_16x16x32_bf16 v[28:31], v[100:103], v[132:135], 0
    s_waitcnt lgkmcnt(10)
    v_mfma_f32_16x16x32_bf16 v[24:27], v[104:107], v[136:139], v[24:27]
    s_waitcnt lgkmcnt(8)
    v_mfma_f32_16x16x32_bf16 v[28:31], v[104:107], v[140:143], v[28:31]
    s_waitcnt lgkmcnt(6)
    v_mfma_f32_16x16x32_bf16 v[24:27], v[108:111], v[144:147], v[24:27]
    s_waitcnt lgkmcnt(4)
    v_mfma_f32_16x16x32_bf16 v[28:31], v[108:111], v[148:151], v[28:31]
    s_waitcnt lgkmcnt(2)
    v_mfma_f32_16x16x32_bf16 v[24:27], v[112:115], v[152:155], v[24:27]
    s_waitcnt lgkmcnt(0)
    v_mfma_f32_16x16x32_bf16 v[28:31], v[112:115], v[156:159], v[28:31]
    s_nop 7
    v_cndmask_b32 v24, v24, v28, s[72:73]
    v_and_or_b32 v24, v24, s74, v210
    s_mov_b32 exec_hi, 0
    buffer_store_dword v24, v13, s[12:15], s31 offen sc1
    s_mov_b32 exec_hi, -1
x_t2:
    s_waitcnt vmcnt(3)
    v_xor_b32 v32, v212, v32
    v_xor_b32 v33, v213, v33
    v_xor_b32 v34, v214, v34
    v_xor_b32 v35, v215, v35
    v_or3_b32 v17, v32, v33, 0
    v_or3_b32 v17, v34, v35, v17
    s_waitcnt vmcnt(2)
    v_xor_b32 v36, v212, v36
    v_xor_b32 v37, v213, v37
    v_xor_b32 v38, v214, v38
    v_xor_b32 v39, v215, v39
    v_or3_b32 v17, v36, v37, v17
    v_or3_b32 v17, v38, v39, v17
    s_waitcnt vmcnt(1)
    v_xor_b32 v40, v212, v40
    v_xor_b32 v41, v213, v41
    v_xor_b32 v42, v214, v42
    v_xor_b32 v43, v215, v43
    v_or3_b32 v17, v40, v41, v17
    v_or3_b32 v17, v42, v43, v17
    s_waitcnt vmcnt(0)
    v_xor_b32 v44, v212, v44
    v_xor_b32 v45, v213, v45
    v_xor_b32 v46, v214, v46
    v_xor_b32 v47, v215, v47
    v_or3_b32 v17, v44, v45, v17
    v_or3_b32 v17, v46, v47, v17
    v_and_b32 v17, 0xff, v17
    v_cmp_ne_u32 vcc, 0, v17
    s_cbranch_vccz x_g0x
    s_sleep 2
    s_add_u32 s83, s83, 1
    s_cmp_lt_u32 s83, 0x40000
    s_cbranch_scc1 x_g0
x_g0x:
    v_pk_add_f32 v[32:33], v[32:33], v[36:37]
    v_pk_add_f32 v[40:41], v[40:41], v[44:45]
    v_pk_add_f32 v[34:35], v[34:35], v[38:39]
    v_pk_add_f32 v[42:43], v[42:43], v[46:47]
    v_pk_add_f32 v[60:61], v[32:33], v[40:41]
    v_pk_add_f32 v[62:63], v[34:35], v[42:43]
    v_cvt_pk_bf16_f32 v17, v60, v61
    v_lshlrev_b32 v60, 16, v17
    v_and_b32 v61, 0xffff0000, v17
    v_cvt_pk_bf16_f32 v18, v62, v63
    v_lshlrev_b32 v62, 16, v18
    v_and_b32 v63, 0xffff0000, v18
    v_add_f32 v60, s43, v60
    v_add_f32 v61, s43, v61
    v_add_f32 v62, s43, v62
    v_add_f32 v63, s43, v63
    v_cvt_pk_bf16_f32 v17, v60, v61
    v_lshlrev_b32 v60, 16, v17
    v_and_b32 v61, 0xffff0000, v17
    v_cvt_pk_bf16_f32 v18, v62, v63
    v_lshlrev_b32 v62, 16, v18
    v_and_b32 v63, 0xffff0000, v18
    s_cmp_eq_u32 s65, 1
    s_cbranch_scc1 x_f1
    v_max3_f32 v17, abs(v60), abs(v61), abs(v62)
    v_max_f32_e64 v17, v17, abs(v63)
    s_nop 1
    v_max_f32_dpp v17, v17, v17 row_ror:8 row_mask:0xf bank_mask:0xf
    s_nop 1
    v_max_f32_dpp v17, v17, v17 row_ror:4 row_mask:0xf bank_mask:0xf
    s_nop 1
    v_max_f32_dpp v17, v17, v17 row_ror:2 row_mask:0xf bank_mask:0xf
    s_nop 1
    v_max_f32_dpp v17, v17, v17 row_ror:1 row_mask:0xf bank_mask:0xf
    s_nop 1
    v_max_f32_dpp v17, v17, v17 row_bcast:15 row_mask:0xa bank_mask:0xf
    s_nop 1
    v_max_f32_dpp v17, v17, v17 row_bcast:31 row_mask:0xc bank_mask:0xf
    s_mov_b32 exec_lo, 0
    s_mov_b32 exec_hi, 0x80000000
    ds_write_b32 v9, v17
    s_mov_b64 exec, -1
    s_cmp_eq_u32 s40, 1
    s_cselect_b32 s43, -1, 5
    s_cselect_b32 s42, 0, 2048
    v_add_u32 v203, s42, v203
    s_waitcnt lgkmcnt(0)
    s_barrier
    ds_read_b128 v[24:27], v10
    ds_read_b128 v[28:31], v10 offset:16
    s_waitcnt lgkmcnt(0)
    v_max3_f32 v24, v24, v25, v26
    v_max3_f32 v27, v27, v28, v29
    v_max3_f32 v24, v24, v30, v31
    v_max_f32 v24, v24, v27
    v_frexp_exp_i32_f32 v24, v24
    v_sub_u32 v25, s43, v24
    v_add_u32 v24, 5, v24
    v_ldexp_f32 v60, v60, v25
    v_ldexp_f32 v61, v61, v25
    v_ldexp_f32 v62, v62, v25
    v_ldexp_f32 v63, v63, v25
    v_cvt_pk_f16_f32 v60, v60, v61
    v_cvt_pk_f16_f32 v62, v62, v63
    v_ldexp_f32 v50, 1.0, v24
    ds_write_b16 v203, v60
    ds_write_b16_d16_hi v203, v60 offset:16
    ds_write_b16 v203, v62 offset:32
    ds_write_b16_d16_hi v203, v62 offset:48
    s_waitcnt lgkmcnt(0)
    s_barrier
    ds_read_b128 v[128:131], v8 offset:0
    v_mov_b32 v48, s32
    v_mov_b32 v49, s39
    s_cmp_ge_u32 s16, 4
    s_cbranch_scc1 x_paa
    s_waitcnt lgkmcnt(0)
    s_add_u32 s42, s22, 0
    buffer_store_dwordx4 v[128:131], v8, s[12:15], s42 offen
x_paa:
    s_waitcnt vmcnt(0)
    s_barrier
    s_cmp_lg_u32 s16, 0
    s_cbranch_scc1 x_pab
    s_mov_b64 exec, 0xff
    buffer_store_dwordx4 v[48:51], v3, s[12:15], s79 offen offset:0
    s_mov_b64 exec, -1
x_pab:
    s_branch x_p2nd
x_f1:
    s_cmp_eq_u32 s40, 1
    s_cbranch_scc1 x_f2
    ds_write_b128 v200, v[60:63] offset:4096
    ds_write_b32 v201, v60 offset:8192
    ds_write_b32 v202, v61 offset:8204
    ds_write_b32 v202, v62 offset:8200
    ds_write_b32 v202, v63 offset:8196
    s_branch x_f3
x_f2:
    ds_write_b128 v200, v[60:63] offset:20480
    ds_write_b32 v201, v60 offset:24576
    ds_write_b32 v202, v61 offset:24588
    ds_write_b32 v202, v62 offset:24584
    ds_write_b32 v202, v63 offset:24580
    v_lshlrev_b32 v56, 16, v64
    v_and_b32 v57, 0xffff0000, v64
    v_lshlrev_b32 v58, 16, v65
    v_and_b32 v59, 0xffff0000, v65
    v_pk_mul_f32 v[56:57], v[56:57], v[60:61]
    v_pk_mul_f32 v[58:59], v[58:59], v[62:63]
    ds_write_b128 v200, v[56:59] offset:12288
    ds_write_b32 v201, v56 offset:16384
    ds_write_b32 v202, v57 offset:16396
    ds_write_b32 v202, v58 offset:16392
    ds_write_b32 v202, v59 offset:16388
    v_pk_add_f32 v[18:19], v[56:57], v[58:59]
    v_add_f32 v17, v18, v19
    s_nop 1
    v_add_f32_dpp v17, v17, v17 row_ror:8 row_mask:0xf bank_mask:0xf
    s_nop 1
    v_add_f32_dpp v17, v17, v17 row_ror:4 row_mask:0xf bank_mask:0xf
    s_nop 1
    v_add_f32_dpp v17, v17, v17 row_ror:2 row_mask:0xf bank_mask:0xf
    s_nop 1
    v_add_f32_dpp v17, v17, v17 row_ror:1 row_mask:0xf bank_mask:0xf
    s_nop 1
    v_add_f32_dpp v17, v17, v17 row_bcast:15 row_mask:0xa bank_mask:0xf
    s_nop 1
    v_add_f32_dpp v17, v17, v17 row_bcast:31 row_mask:0xc bank_mask:0xf
    s_mov_b32 exec_lo, 0
    s_mov_b32 exec_hi, 0x80000000
    ds_write_b32 v9, v17
    s_mov_b64 exec, -1
x_f3:
    s_waitcnt lgkmcnt(0)
    s_barrier
    ds_read_b128 v[28:31], v10 offset:16
    s_waitcnt lgkmcnt(0)
    v_pk_add_f32 v[28:29], v[28:29], v[30:31]
    v_add_f32 v50, v28, v29
    ds_read_b128 v[128:131], v8 offset:4096
    ds_read_b128 v[132:135], v8 offset:12288
    ds_read_b128 v[136:139], v8 offset:20480
    v_mov_b32 v48, s32
    v_mov_b32 v49, s39
    s_waitcnt lgkmcnt(2)
    s_add_u32 s42, s22, 4096
    buffer_store_dwordx4 v[128:131], v8, s[12:15], s42 offen
    s_waitcnt lgkmcnt(1)
    s_add_u32 s42, s22, 12288
    buffer_store_dwordx4 v[132:135], v8, s[12:15], s42 offen
    s_waitcnt lgkmcnt(0)
    s_add_u32 s42, s22, 20480
    buffer_store_dwordx4 v[136:139], v8, s[12:15], s42 offen
x_pba:
    s_waitcnt vmcnt(0)
    s_barrier
    s_cmp_lg_u32 s16, 0
    s_cbranch_scc1 x_pbb
    s_mov_b64 exec, 0xff
    buffer_store_dwordx4 v[48:51], v3, s[12:15], s79 offen offset:0
    s_mov_b64 exec, -1
x_pbb:
x_p2nd:
    s_add_u32 s41, s41, 65536
    s_mov_b32 s83, 0
x_g1:
    s_mov_b32 s42, s41
    buffer_load_dwordx4 v[32:35], v11, s[12:15], s42 offen sc1
    s_add_u32 s42, s42, 4096
    buffer_load_dwordx4 v[36:39], v11, s[12:15], s42 offen sc1
    s_add_u32 s42, s42, 4096
    buffer_load_dwordx4 v[40:43], v11, s[12:15], s42 offen sc1
    s_add_u32 s42, s42, 4096
    buffer_load_dwordx4 v[44:47], v11, s[12:15], s42 offen sc1
    s_waitcnt vmcnt(3)
    v_xor_b32 v32, v212, v32
    v_xor_b32 v33, v213, v33
    v_xor_b32 v34, v214, v34
    v_xor_b32 v35, v215, v35
    v_or3_b32 v17, v32, v33, 0
    v_or3_b32 v17, v34, v35, v17
    s_waitcnt vmcnt(2)
    v_xor_b32 v36, v212, v36
    v_xor_b32 v37, v213, v37
    v_xor_b32 v38, v214, v38
    v_xor_b32 v39, v215, v39
    v_or3_b32 v17, v36, v37, v17
    v_or3_b32 v17, v38, v39, v17
    s_waitcnt vmcnt(1)
    v_xor_b32 v40, v212, v40
    v_xor_b32 v41, v213, v41
    v_xor_b32 v42, v214, v42
    v_xor_b32 v43, v215, v43
    v_or3_b32 v17, v40, v41, v17
    v_or3_b32 v17, v42, v43, v17
    s_waitcnt vmcnt(0)
    v_xor_b32 v44, v212, v44
    v_xor_b32 v45, v213, v45
    v_xor_b32 v46, v214, v46
    v_xor_b32 v47, v215, v47
    v_or3_b32 v17, v44, v45, v17
    v_or3_b32 v17, v46, v47, v17
    v_and_b32 v17, 0xff, v17
    v_cmp_ne_u32 vcc, 0, v17
    s_cbranch_vccz x_g1x
    s_sleep 2
    s_add_u32 s83, s83, 1
    s_cmp_lt_u32 s83, 0x40000
    s_cbranch_scc1 x_g1
x_g1x:
    v_pk_add_f32 v[32:33], v[32:33], v[36:37]
    v_pk_add_f32 v[40:41], v[40:41], v[44:45]
    v_pk_add_f32 v[34:35], v[34:35], v[38:39]
    v_pk_add_f32 v[42:43], v[42:43], v[46:47]
    v_pk_add_f32 v[60:61], v[32:33], v[40:41]
    v_pk_add_f32 v[62:63], v[34:35], v[42:43]
    s_cmp_eq_u32 s40, 0
    s_cbranch_scc1 x_h0
    ds_write_b128 v11, v[60:63] offset:45056
    s_waitcnt lgkmcnt(0)
x_h0:
    s_barrier
    s_cbranch_scc0 x_h1
    ds_read_b128 v[56:59], v11 offset:45056
    s_waitcnt lgkmcnt(0)
    v_pk_add_f32 v[60:61], v[60:61], v[56:57]
    v_pk_add_f32 v[62:63], v[62:63], v[58:59]
    v_cvt_pk_bf16_f32 v17, v60, v61
    v_lshlrev_b32 v60, 16, v17
    v_and_b32 v61, 0xffff0000, v17
    v_cvt_pk_bf16_f32 v18, v62, v63
    v_lshlrev_b32 v62, 16, v18
    v_and_b32 v63, 0xffff0000, v18
    ds_write_b128 v200, v[60:63] offset:28672
    ds_write_b32 v201, v60 offset:32768
    ds_write_b32 v202, v61 offset:32780
    ds_write_b32 v202, v62 offset:32776
    ds_write_b32 v202, v63 offset:32772
    s_waitcnt lgkmcnt(0)
x_h1:
    s_barrier
    s_lshl_b32 s42, s65, 13
    s_add_u32 s23, s22, s42
    ds_read_b128 v[140:143], v8 offset:28672
    v_mov_b32 v48, s32
    v_mov_b32 v49, s39
    s_waitcnt lgkmcnt(0)
    s_add_u32 s42, s23, 28672
    buffer_store_dwordx4 v[140:143], v8, s[12:15], s42 offen
x_pca:
    s_waitcnt vmcnt(0)
    s_barrier
    s_cmp_lg_u32 s16, 0
    s_cbranch_scc1 x_pcb
    s_mov_b64 exec, 0xff
    buffer_store_dwordx4 v[48:51], v3, s[12:15], s79 offen offset:256
    s_mov_b64 exec, -1
x_pcb:
    s_cmp_eq_u32 s65, 1
    s_cbranch_scc1 x_w1
    v_mov_b32 v48, s32
    v_mov_b32 v49, s33
    s_cmp_ge_u32 s16, 4
    s_cbranch_scc1 x_pda
    s_add_u32 s42, s22, 65536
    buffer_store_dwordx4 v[128:131], v8, s[12:15], s42 offen sc1
x_pda:
    s_branch x_w2
x_w1:
    v_mov_b32 v48, s32
    v_mov_b32 v49, s33
    s_add_u32 s42, s22, 69632
    buffer_store_dwordx4 v[128:131], v8, s[12:15], s42 offen sc1
    s_add_u32 s42, s22, 77824
    buffer_store_dwordx4 v[132:135], v8, s[12:15], s42 offen sc1
    s_add_u32 s42, s22, 86016
    buffer_store_dwordx4 v[136:139], v8, s[12:15], s42 offen sc1
x_pea:
x_w2:
    v_mov_b32 v48, s32
    v_mov_b32 v49, s33
    s_add_u32 s42, s23, 94208
    buffer_store_dwordx4 v[140:143], v8, s[12:15], s42 offen sc1
x_pfa:
    s_waitcnt vmcnt(0)
    s_barrier
    s_cmp_lg_u32 s16, 0
    s_cbranch_scc1 x_pfb
    s_mov_b64 exec, 0xff
    buffer_store_dwordx4 v[48:51], v3, s[12:15], s79 offen offset:768 sc1
    buffer_store_dwordx4 v[48:51], v3, s[12:15], s79 offen offset:512 sc1
    s_mov_b64 exec, -1
x_pfb:
    s_lshl_b32 s17, s64, 3
    s_add_u32 s17, s17, s16
    s_and_b32 s18, s17, 63
    s_lshl_b32 s78, s34, 11
    s_add_u32 s78, s78, 18857984
    v_and_b32 v4, 3, v0
    v_lshrrev_b32 v7, 4, v2
    v_lshlrev_b32 v5, 3, v4
    v_lshl_add_u32 v5, v7, 1, v5
    v_lshlrev_b32 v6, 10, v4
    v_lshl_add_u32 v6, v7, 2, v6
    v_lshrrev_b32 v86, 1, v4
    v_lshlrev_b32 v86, 9, v86
    v_and_b32 v87, 12, v5
    v_add_u32 v86, v86, v87
    v_and_b32 v87, 2, v5
    v_lshlrev_b32 v87, 3, v87
    s_and_b32 s30, s18, 1
    s_bfe_u32 s31, s18, 0x20001
    s_bfe_u32 s40, s18, 0x20003
    s_lshr_b32 s41, s18, 5
    s_lshl_b32 s45, s41, 10
    s_lshl_b32 s42, s30, 8
    s_add_u32 s45, s45, s42
    s_lshl_b32 s42, s40, 6
    s_add_u32 s45, s45, s42
    s_lshl_b32 s31, s31, 4
    s_add_u32 s45, s45, s31
    s_lshl_b32 s30, s30, 9
    s_add_u32 s31, s31, s30
    s_lshl_b32 s40, s40, 7
    s_add_u32 s31, s31, s40
    s_lshl_b32 s41, s41, 6
    s_add_u32 s31, s31, s41
    s_lshl_b32 s41, s34, 17
    s_add_u32 s31, s31, s41
    s_add_u32 s31, s31, 20025344
    s_lshl_b32 s44, s17, 12
    s_add_u32 s44, s44, 17825792
    v_cmp_gt_u32 vcc, 32, v2
    v_mov_b32 v7, 0x7ff00000
    s_nop 0
    v_cndmask_b32 v7, v7, v3, vcc
    v_and_b32 v9, 15, v0
    v_lshlrev_b32 v9, 6, v9
    v_bfe_u32 v10, v0, 4, 1
    v_lshl_add_u32 v9, v10, 5, v9
    v_bfe_u32 v10, v0, 5, 1
    v_lshl_add_u32 v9, v10, 4, v9
    v_mov_b32 v10, 135232
    v_mov_b32 v22, 0
    buffer_load_dwordx4 v[40:43], v9, s[56:59], 0 offen offset:0
    buffer_load_dwordx4 v[44:47], v9, s[56:59], 0 offen offset:1024
    s_waitcnt vmcnt(0)
    v_lshlrev_b32 v48, 16, v40
    v_and_b32 v49, 0xffff0000, v40
    v_lshlrev_b32 v50, 16, v41
    v_and_b32 v51, 0xffff0000, v41
    v_lshlrev_b32 v52, 16, v42
    v_and_b32 v53, 0xffff0000, v42
    v_lshlrev_b32 v54, 16, v43
    v_and_b32 v55, 0xffff0000, v43
    v_lshlrev_b32 v56, 16, v44
    v_and_b32 v57, 0xffff0000, v44
    v_lshlrev_b32 v58, 16, v45
    v_and_b32 v59, 0xffff0000, v45
    v_lshlrev_b32 v60, 16, v46
    v_and_b32 v61, 0xffff0000, v46
    v_lshlrev_b32 v62, 16, v47
    v_and_b32 v63, 0xffff0000, v47
    s_cmp_lg_u32 s16, 0
    s_cbranch_scc1 x_ng
    s_lshl_b32 s79, s34, 10
    s_add_u32 s79, s79, 16851840
    s_mov_b32 s83, 0
    s_mov_b64 exec, 1
x_gb:
    buffer_load_dwordx2 v[28:29], v22, s[12:15], s79 offen sc1
    s_waitcnt vmcnt(0)
    v_cmp_ne_u64 vcc, s[32:33], v[28:29]
    s_cbranch_vccz x_gby
    s_sleep 4
    s_add_u32 s83, s83, 1
    s_cmp_lt_u32 s83, 0x40000
    s_cbranch_scc1 x_gb
x_gby:
    s_mov_b64 exec, -1
x_gbx:
    s_lshl_b32 s79, s34, 7
    s_add_u32 s79, s79, 16842752
    s_mov_b32 s83, 0
    s_mov_b64 exec, 1
x_go:
    buffer_load_dwordx2 v[28:29], v22, s[12:15], s79 offen sc1
    s_waitcnt vmcnt(0)
    v_cmp_ne_u64 vcc, s[32:33], v[28:29]
    s_cbranch_vccz x_goy
    s_sleep 3
    s_add_u32 s83, s83, 1
    s_cmp_lt_u32 s83, 0x40000
    s_cbranch_scc1 x_go
x_goy:
    s_mov_b64 exec, -1
x_gox:
    s_sleep 1
    s_sleep 4
    s_mov_b32 s83, 0
x_pk:
    buffer_load_dwordx4 v[24:27], v3, s[12:15], s78 offen sc1
    s_waitcnt vmcnt(0)
    v_max3_u32 v4, v24, v25, v26
    v_max_u32 v4, v4, v27
    v_cmp_eq_u32 vcc, -1, v4
    s_cbranch_vccz x_pkx
    s_sleep 4
    s_add_u32 s83, s83, 1
    s_cmp_lt_u32 s83, 0x40000
    s_cbranch_scc1 x_pk
x_pkx:
    v_max_u32 v28, v24, v26
    v_min_u32 v29, v24, v26
    v_max3_u32 v29, v29, v25, v27
    v_mov_b32 v30, v28
    s_nop 1
    v_max_u32_dpp v30, v30, v30 row_ror:8 row_mask:0xf bank_mask:0xf
    s_nop 1
    v_max_u32_dpp v30, v30, v30 row_ror:4 row_mask:0xf bank_mask:0xf
    s_nop 1
    v_max_u32_dpp v30, v30, v30 row_ror:2 row_mask:0xf bank_mask:0xf
    s_nop 1
    v_max_u32_dpp v30, v30, v30 row_ror:1 row_mask:0xf bank_mask:0xf
    s_nop 1
    v_max_u32_dpp v30, v30, v30 row_bcast:15 row_mask:0xa bank_mask:0xf
    s_nop 1
    v_max_u32_dpp v30, v30, v30 row_bcast:31 row_mask:0xc bank_mask:0xf
    s_nop 0
    v_readlane_b32 s40, v30, 63
    s_nop 1
    v_cmp_eq_u32 vcc, s40, v28
    s_nop 1
    v_cndmask_b32 v30, v28, v29, vcc
    s_nop 1
    v_max_u32_dpp v30, v30, v30 row_ror:8 row_mask:0xf bank_mask:0xf
    s_nop 1
    v_max_u32_dpp v30, v30, v30 row_ror:4 row_mask:0xf bank_mask:0xf
    s_nop 1
    v_max_u32_dpp v30, v30, v30 row_ror:2 row_mask:0xf bank_mask:0xf
    s_nop 1
    v_max_u32_dpp v30, v30, v30 row_ror:1 row_mask:0xf bank_mask:0xf
    s_nop 1
    v_max_u32_dpp v30, v30, v30 row_bcast:15 row_mask:0xa bank_mask:0xf
    s_nop 1
    v_max_u32_dpp v30, v30, v30 row_bcast:31 row_mask:0xc bank_mask:0xf
    s_nop 0
    v_readlane_b32 s41, v30, 63
    v_mov_b32 v28, s40
    s_nop 0
    v_mov_b32 v29, s41
    ds_write_b64 v10, v[28:29]
    s_waitcnt lgkmcnt(0)
x_ng:
    s_barrier
    ds_read_b64 v[28:29], v10
    s_waitcnt lgkmcnt(0)
    v_readfirstlane_b32 s40, v28
    v_readfirstlane_b32 s41, v29
    s_cmp_lt_u32 s17, 64
    s_cselect_b32 s40, s40, s41
    s_bfe_u32 s46, s40, 0x70005
    s_bfe_u32 s47, s40, 0x30002
    s_bfe_u32 s48, s40, 0x10001
    s_bfe_u32 s42, s40, 0x70005
    s_lshl_b32 s42, s42, 13
    s_and_b32 s40, s40, 1
    s_lshl_b32 s40, s40, 12
    s_add_u32 s42, s42, s40
    s_add_u32 s42, s42, 18874368
    s_add_u32 s43, s42, s45
    s_mov_b32 s83, 0
x_ps:
    buffer_load_dwordx4 v[32:35], v3, s[12:15], s42 offen offset:0 sc1
    buffer_load_dwordx4 v[36:39], v3, s[12:15], s42 offen offset:1024 sc1
    buffer_load_dword v40, v86, s[12:15], s43 offen offset:2048 sc1
    buffer_load_dword v41, v6, s[12:15], s31 offen sc1
    s_lshr_b32 s49, s46, 4
    s_and_b32 s41, s46, 15
    s_lshl_b32 s41, s41, 4
    s_add_u32 s41, s41, s49
    s_lshr_b32 s49, s46, 3
    s_cmp_eq_u32 s49, 1
    s_cselect_b32 s49, 120, 0
    s_sub_u32 s41, s41, s49
    s_lshl_b32 s49, s47, 8
    s_add_u32 s41, s41, s49
    s_cmp_ge_u32 s47, 4
    s_cselect_b32 s49, 896, 0
    s_cmp_eq_u32 s46, 0
    s_cselect_b32 s49, s49, 0
    s_sub_u32 s41, s41, s49
    s_sub_u32 s49, 2048, s41
    s_cmp_eq_u32 s41, 0
    s_cselect_b32 s49, 1024, s49
    s_cmp_eq_u32 s48, 1
    s_cselect_b32 s41, s49, s41
    s_lshl_b32 s41, s41, 11
    s_lshl_b32 s49, s18, 5
    s_add_u32 s41, s41, s49
    s_waitcnt vmcnt(0)
    v_max3_u32 v9, v32, v33, v34
    v_max3_u32 v9, v9, v35, v36
    v_max3_u32 v9, v9, v37, v38
    v_max3_u32 v9, v9, v39, v40
    v_cmp_eq_u32 vcc, -1, v9
    s_cbranch_vccz x_psx
    s_sleep 1
    s_add_u32 s83, s83, 1
    s_cmp_lt_u32 s83, 0x40000
    s_cbranch_scc1 x_ps
x_psx:
    v_lshlrev_b32 v64, 16, v32
    v_and_b32 v65, 0xffff0000, v32
    v_lshlrev_b32 v66, 16, v33
    v_and_b32 v67, 0xffff0000, v33
    v_lshlrev_b32 v68, 16, v34
    v_and_b32 v69, 0xffff0000, v34
    v_lshlrev_b32 v70, 16, v35
    v_and_b32 v71, 0xffff0000, v35
    v_lshlrev_b32 v72, 16, v36
    v_and_b32 v73, 0xffff0000, v36
    v_lshlrev_b32 v74, 16, v37
    v_and_b32 v75, 0xffff0000, v37
    v_lshlrev_b32 v76, 16, v38
    v_and_b32 v77, 0xffff0000, v38
    v_lshlrev_b32 v78, 16, v39
    v_and_b32 v79, 0xffff0000, v39
    v_pk_mul_f32 v[8:9], v[48:49], v[64:65]
    v_pk_fma_f32 v[8:9], v[50:51], v[66:67], v[8:9]
    v_pk_fma_f32 v[8:9], v[52:53], v[68:69], v[8:9]
    v_pk_fma_f32 v[8:9], v[54:55], v[70:71], v[8:9]
    v_pk_fma_f32 v[8:9], v[56:57], v[72:73], v[8:9]
    v_pk_fma_f32 v[8:9], v[58:59], v[74:75], v[8:9]
    v_pk_fma_f32 v[8:9], v[60:61], v[76:77], v[8:9]
    v_pk_fma_f32 v[8:9], v[62:63], v[78:79], v[8:9]
    v_add_f32 v8, v8, v9
    s_nop 1
    v_add_f32_dpp v8, v8, v8 row_ror:8 row_mask:0xf bank_mask:0xf
    s_nop 1
    v_add_f32_dpp v8, v8, v8 row_ror:4 row_mask:0xf bank_mask:0xf
    s_nop 1
    v_add_f32_dpp v8, v8, v8 row_ror:2 row_mask:0xf bank_mask:0xf
    s_nop 1
    v_add_f32_dpp v8, v8, v8 row_ror:1 row_mask:0xf bank_mask:0xf
    s_nop 1
    v_add_f32_dpp v8, v8, v8 row_bcast:15 row_mask:0xa bank_mask:0xf
    s_nop 1
    v_add_f32_dpp v8, v8, v8 row_bcast:31 row_mask:0xc bank_mask:0xf
    v_cvt_pk_bf16_f32 v8, v8, v8
    v_lshlrev_b32 v8, 16, v8
    v_mul_f32 v8, 0xbfb8aa3b, v8
    v_exp_f32 v8, v8
    s_nop 0
    v_add_f32 v8, 1.0, v8
    v_rcp_f32 v8, v8
    s_nop 0
    v_cvt_pk_bf16_f32 v8, v8, v8
    v_lshlrev_b32 v8, 16, v8
    s_nop 0
    v_readlane_b32 s46, v8, 63
    v_lshrrev_b32 v44, v87, v40
    v_lshlrev_b32 v44, 16, v44
    v_mul_f32 v80, s46, v41
    s_sleep 24
    s_mov_b32 s83, 0
x_p2:
    buffer_load_dwordx4 v[16:19], v3, s[12:15], s44 offen offset:0 sc1
    buffer_load_dwordx4 v[20:23], v3, s[12:15], s44 offen offset:1024 sc1
    buffer_load_dwordx4 v[24:27], v3, s[12:15], s44 offen offset:2048 sc1
    buffer_load_dwordx4 v[28:31], v7, s[12:15], s44 offen offset:3072 sc1
    s_waitcnt vmcnt(0)
    v_max3_u32 v12, v16, v17, v18
    v_max3_u32 v12, v12, v19, v20
    v_max3_u32 v12, v12, v21, v22
    v_max3_u32 v12, v12, v23, v24
    v_max3_u32 v12, v12, v25, v26
    v_max3_u32 v12, v12, v27, v28
    v_max3_u32 v12, v12, v29, v30
    v_max_u32 v12, v12, v31
    v_cmp_eq_u32 vcc, -1, v12
    s_cbranch_vccz x_p3
    s_add_u32 s83, s83, 1
    s_cmp_lt_u32 s83, 0x40000
    s_cbranch_scc1 x_p2
x_p3:
    v_pk_add_f32 v[16:17], v[16:17], v[20:21]
    v_pk_add_f32 v[24:25], v[24:25], v[28:29]
    v_pk_add_f32 v[18:19], v[18:19], v[22:23]
    v_pk_add_f32 v[26:27], v[26:27], v[30:31]
    v_pk_add_f32 v[16:17], v[16:17], v[24:25]
    v_pk_add_f32 v[18:19], v[18:19], v[26:27]
    s_nop 1
    v_permlane32_swap_b32 v16, v18
    v_permlane32_swap_b32 v17, v19
    v_pk_add_f32 v[16:17], v[16:17], v[18:19]
    s_nop 1
    v_permlane16_swap_b32 v16, v17
    v_add_f32 v16, v16, v17
    s_nop 1
    v_add_f32_dpp v16, v16, v16 row_ror:4 row_mask:0xf bank_mask:0xf
    s_nop 1
    v_add_f32_dpp v16, v16, v16 row_ror:8 row_mask:0xf bank_mask:0xf
    v_fmac_f32 v44, v16, v80
    s_mov_b32 exec_lo, 0x000f000f
    s_mov_b32 exec_hi, 0x000f000f
    v_cvt_pk_bf16_f32 v44, v44, v44
    buffer_store_short v44, v5, s[24:27], s41 offen
    s_endpgm
f_start:
    s_mov_b32 s20, s26
    s_mov_b32 s21, s27
    s_mov_b32 s26, 4194304
    s_mov_b32 s27, 0x00020000
    s_mov_b32 s22, s50
    s_mov_b32 s23, s51
    s_mov_b32 s28, s54
    s_mov_b32 s29, s55
    s_add_u32 s58, s36, tables-h_pc
    s_addc_u32 s59, s37, 0
    s_lshr_b32 s36, s35, 1
    s_and_b32 s36, s36, 4
    s_xor_b32 s36, s36, s16
    s_and_b32 s37, s34, 4
    s_xor_b32 s37, s37, s16
    s_lshl_b32 s3, s34, 4
    s_add_u32 s3, s3, s35
    v_and_b32 v4, 15, v0
    v_bfe_u32 v5, v0, 4, 2
    v_lshrrev_b32 v248, 3, v2
    v_lshlrev_b32 v248, 18, v248
    v_lshlrev_b32 v249, 1, v5
    v_xor_b32 v249, v249, v0
    v_and_b32 v249, 7, v249
    v_lshl_add_u32 v255, v249, 4, v248
    v_lshlrev_b32 v6, 16, v5
    v_lshl_add_u32 v6, v4, 4, v6
    s_lshl_b32 s60, s16, 15
    s_lshl_b32 s61, s34, 11
    s_add_u32 s60, s60, s61
    s_lshl_b32 s61, s35, 7
    s_add_u32 s60, s60, s61
    s_lshl_b32 s61, s16, 12
    s_add_u32 s61, s61, 61440
    s_lshl_b32 s64, s36, 19
    s_lshl_b32 s65, s35, 3
    s_and_b32 s66, s34, 1
    s_lshl_b32 s66, s66, 2
    s_add_u32 s65, s65, s66
    s_lshr_b32 s66, s34, 1
    s_add_u32 s65, s65, s66
    s_lshl_b32 s65, s65, 8
    s_add_u32 s64, s64, s65
    s_add_u32 s64, s64, 1048576
    s_add_u32 s65, s64, 32768
    s_add_u32 s66, s64, 262144
    s_add_u32 s67, s64, 294912
    s_barrier
    s_cmp_eq_u32 s36, 0
    s_cselect_b32 s42, 2048, 0
    s_add_u32 s42, s42, 16384
    v_add_u32 v248, s42, v3
    global_load_dwordx4 v[236:239], v248, s[58:59]
    global_load_dwordx4 v[240:243], v248, s[58:59] offset:1024
    v_lshrrev_b32 v248, 1, v4
    v_and_b32 v249, 1, v0
    v_cmp_eq_u32 vcc, 1, v4
    s_nop 1
    v_cndmask_b32_e64 v250, v248, 0, vcc
    v_cndmask_b32_e64 v248, v248, 8, vcc
    v_cndmask_b32_e64 v249, v249, 0, vcc
    v_mad_u32_u24 v251, v248, v5, v249
    v_lshlrev_b32 v251, 5, v251
    v_mad_u32_u24 v251, v250, v1, v251
    v_cvt_f32_u32 v248, v248
    v_cvt_f32_u32 v250, v250
    v_cvt_f32_u32 v251, v251
    v_mul_f32 v248, 0x3d800000, v248
    v_mul_f32 v250, 0x3b800000, v250
    v_mul_f32 v216, 0x3c000000, v251
    v_add_f32 v217, v216, v248
    v_add_f32 v218, v217, v248
    v_add_f32 v219, v218, v248
    v_add_f32 v220, v216, v250
    v_add_f32 v221, v217, v250
    v_add_f32 v222, v218, v250
    v_add_f32 v223, v219, v250
    v_cos_f32 v216, v216
    v_cos_f32 v217, v217
    v_cos_f32 v218, v218
    v_cos_f32 v219, v219
    v_cos_f32 v220, v220
    v_cos_f32 v221, v221
    v_cos_f32 v222, v222
    v_cos_f32 v223, v223
    v_lshrrev_b32 v248, 2, v2
    v_lshlrev_b32 v8, 7, v248
    v_bfe_u32 v248, v0, 3, 2
    v_lshl_add_u32 v8, v248, 5, v8
    v_and_b32 v248, 3, v0
    v_lshl_add_u32 v8, v248, 3, v8
    v_lshl_add_u32 v8, v1, 12, v8
    v_xor_b32 v9, 32, v8
    v_xor_b32 v10, 64, v8
    v_xor_b32 v11, 96, v8
    v_lshlrev_b32 v12, 13, v5
    v_lshl_add_u32 v12, v4, 4, v12
    v_lshlrev_b32 v7, 5, v5
    v_and_b32 v248, 1, v0
    v_lshl_add_u32 v7, v248, 4, v7
    v_and_b32 v248, 2, v0
    v_lshl_add_u32 v7, v248, 6, v7
    s_lshl_b32 s70, s34, 11
    s_lshl_b32 s71, s16, 8
    s_add_u32 s71, s71, s70
    s_add_u32 s71, s71, 16777216
    s_lshr_b32 s42, s16, 1
    s_lshl_b32 s42, s42, 8
    s_and_b32 s43, s16, 1
    s_lshl_b32 s43, s43, 3
    s_add_u32 s42, s42, s43
    s_add_u32 s42, s42, 94208
    v_add_u32 v252, s42, v12
    s_lshl_b32 s42, s36, 12
    s_add_u32 s42, s42, 94208
    v_add_u32 v253, s42, v3
    s_mov_b32 s4, 0x3f803f80
    s_mov_b32 s5, 0x3a800000
    s_waitcnt vmcnt(6)
    s_load_dwordx2 s[32:33], s[20:21], 0
    v_dot2_f32_bf16 v108, v64, s4, 0
    v_dot2_f32_bf16 v110, v64, v64, 0
    v_dot2_f32_bf16 v108, v65, s4, v108
    v_dot2_f32_bf16 v110, v65, v65, v110
    v_dot2_f32_bf16 v108, v66, s4, v108
    v_dot2_f32_bf16 v110, v66, v66, v110
    v_dot2_f32_bf16 v108, v67, s4, v108
    v_dot2_f32_bf16 v110, v67, v67, v110
    s_waitcnt vmcnt(5)
    v_dot2_f32_bf16 v109, v72, s4, 0
    v_dot2_f32_bf16 v111, v72, v72, 0
    v_dot2_f32_bf16 v109, v73, s4, v109
    v_dot2_f32_bf16 v111, v73, v73, v111
    v_dot2_f32_bf16 v109, v74, s4, v109
    v_dot2_f32_bf16 v111, v74, v74, v111
    v_dot2_f32_bf16 v109, v75, s4, v109
    v_dot2_f32_bf16 v111, v75, v75, v111
    s_waitcnt vmcnt(4)
    v_dot2_f32_bf16 v108, v68, s4, v108
    v_dot2_f32_bf16 v110, v68, v68, v110
    v_dot2_f32_bf16 v108, v69, s4, v108
    v_dot2_f32_bf16 v110, v69, v69, v110
    v_dot2_f32_bf16 v108, v70, s4, v108
    v_dot2_f32_bf16 v110, v70, v70, v110
    v_dot2_f32_bf16 v108, v71, s4, v108
    v_dot2_f32_bf16 v110, v71, v71, v110
    s_waitcnt vmcnt(3)
    v_dot2_f32_bf16 v109, v76, s4, v109
    v_dot2_f32_bf16 v111, v76, v76, v111
    v_dot2_f32_bf16 v109, v77, s4, v109
    v_dot2_f32_bf16 v111, v77, v77, v111
    v_dot2_f32_bf16 v109, v78, s4, v109
    v_dot2_f32_bf16 v111, v78, v78, v111
    v_dot2_f32_bf16 v109, v79, s4, v109
    v_dot2_f32_bf16 v111, v79, v79, v111
    s_nop 1
    v_permlane32_swap_b32 v108, v109
    v_permlane32_swap_b32 v110, v111
    v_add_f32 v108, v108, v109
    v_add_f32 v110, v110, v111
    s_nop 0
    v_add_f32_dpp v108, v108, v108 row_ror:8 row_mask:0xf bank_mask:0xf
    v_add_f32_dpp v110, v110, v110 row_ror:8 row_mask:0xf bank_mask:0xf
    s_nop 0
    v_add_f32_dpp v108, v108, v108 row_ror:4 row_mask:0xf bank_mask:0xf
    v_add_f32_dpp v110, v110, v110 row_ror:4 row_mask:0xf bank_mask:0xf
    s_nop 0
    v_add_f32_dpp v108, v108, v108 row_ror:2 row_mask:0xf bank_mask:0xf
    v_add_f32_dpp v110, v110, v110 row_ror:2 row_mask:0xf bank_mask:0xf
    s_nop 0
    v_add_f32_dpp v108, v108, v108 row_ror:1 row_mask:0xf bank_mask:0xf
    v_add_f32_dpp v110, v110, v110 row_ror:1 row_mask:0xf bank_mask:0xf
    s_nop 0
    v_add_f32_dpp v108, v108, v108 row_bcast:15 row_mask:0xa bank_mask:0xf
    v_add_f32_dpp v110, v110, v110 row_bcast:15 row_mask:0xa bank_mask:0xf
    v_mul_f32 v108, s5, v108
    v_mul_f32 v110, s5, v110
    v_mul_f32 v116, v108, v108
    v_cvt_pk_bf16_f32 v117, -v108, -v108
    v_sub_f32 v110, v110, v116
    v_mul_f32 v118, 0x44000000, v110
    v_cmp_gt_f32 vcc, v116, v118
    v_readlane_b32 s40, v117, 31
    s_or_b32 s41, vcc_lo, vcc_hi
    s_bitcmp1_b32 s41, 31
    s_cbranch_scc1 f_slowvar
f_var:
    v_cvt_pk_bf16_f32 v110, v110, v110
    v_lshlrev_b32 v110, 16, v110
    v_add_f32 v110, 0x3727c5ac, v110
    v_cvt_pk_bf16_f32 v110, v110, v110
    v_lshlrev_b32 v110, 16, v110
    v_sqrt_f32 v110, v110
    s_and_b32 s40, s40, 0xffff
    v_mov_b32 v114, 0xffff0000
    v_cvt_pk_bf16_f32 v110, v110, v110
    v_lshlrev_b32 v110, 16, v110
    v_mul_f32 v110, 0x41800000, v110
    v_and_or_b32 v114, v117, v114, s40
    v_rcp_f32 v113, v110
    s_waitcnt lgkmcnt(0)
    s_cmp_lg_u32 s32, 0
    s_cbranch_scc1 f_nnx
    s_load_dwordx2 s[32:33], s[20:21], 64
    s_mov_b32 s83, 0
    v_mov_b32 v122, 0
    s_waitcnt lgkmcnt(0)
f_nn:
    s_cmp_lg_u32 s32, 0
    s_cbranch_scc1 f_nnx
    global_load_dwordx2 v[120:121], v122, s[20:21] sc1
    s_waitcnt vmcnt(0)
    v_readfirstlane_b32 s32, v120
    v_readfirstlane_b32 s33, v121
    s_add_u32 s83, s83, 1
    s_cmp_lt_u32 s83, 0x40000
    s_cbranch_scc1 f_nn
f_nnx:
    v_mov_b32 v115, s32
    v_mov_b32_dpp v112, v113 row_bcast:31 row_mask:0xc bank_mask:0xf
    v_mov_b32 v116, 0
    s_mov_b32 exec_lo, 0
    s_mov_b32 exec_hi, 0x80000000
    buffer_store_dwordx4 v[112:115], v116, s[12:15], s62 offen
    s_mov_b64 exec, -1
    s_mov_b32 m0, s61
    s_add_u32 s42, s60, 0
    s_add_u32 s61, s61, 1024
    buffer_load_dwordx4 v255, s[8:11], s42 offen lds
    s_mov_b32 m0, s61
    s_add_u32 s42, s60, 2097152
    s_add_u32 s61, s61, 1024
    buffer_load_dwordx4 v255, s[8:11], s42 offen lds
    s_mov_b32 m0, s61
    s_add_u32 s42, s60, 16384
    s_add_u32 s61, s61, 1024
    buffer_load_dwordx4 v255, s[8:11], s42 offen lds
    s_mov_b32 m0, s61
    s_add_u32 s42, s60, 2113536
    s_add_u32 s61, s61, 1024
    buffer_load_dwordx4 v255, s[8:11], s42 offen lds
    s_lshl_b32 s77, s34, 17
    s_add_u32 s77, s77, 19922944
    s_lshl_b32 s42, s35, 3
    s_add_u32 s42, s42, s16
    s_mul_i32 s42, s42, 384
    s_add_u32 s73, s42, s77
    v_lshlrev_b32 v17, 7, v2
    s_lshr_b32 s42, s3, 4
    s_and_b32 s30, s3, 15
    s_lshl_b32 s30, s30, 4
    s_add_u32 s30, s30, s42
    s_lshr_b32 s42, s3, 3
    s_cmp_eq_u32 s42, 1
    s_cselect_b32 s42, 120, 0
    s_sub_u32 s30, s30, s42
    s_lshl_b32 s42, s16, 8
    s_add_u32 s30, s30, s42
    s_cmp_ge_u32 s16, 4
    s_cselect_b32 s42, 896, 0
    s_cmp_eq_u32 s3, 0
    s_cselect_b32 s42, s42, 0
    s_sub_u32 s30, s30, s42
    s_sub_u32 s31, 2048, s30
    s_cmp_eq_u32 s30, 0
    s_cselect_b32 s31, 1024, s31
    s_lshl_b32 s18, s30, 11
    s_lshl_b32 s19, s31, 11
    s_sub_u32 s75, s19, 2048
    s_lshl_b32 s68, s16, 12
    s_add_u32 s68, s68, 126976
    s_waitcnt vmcnt(0)
    ds_read_b64_tr_b16 v[40:41], v8 offset:61440
    ds_read_b64_tr_b16 v[42:43], v9 offset:61440
    ds_read_b64_tr_b16 v[44:45], v10 offset:61440
    ds_read_b64_tr_b16 v[46:47], v11 offset:61440
    ds_read_b64_tr_b16 v[48:49], v8 offset:63488
    ds_read_b64_tr_b16 v[50:51], v9 offset:63488
    ds_read_b64_tr_b16 v[52:53], v10 offset:63488
    ds_read_b64_tr_b16 v[54:55], v11 offset:63488
    s_waitcnt lgkmcnt(0)
    v_mov_b32 v8, s32
    v_mov_b32 v9, s33
    v_and_b32 v248, 4, v0
    v_cmp_eq_u32 vcc, 4, v248
    v_and_b32 v248, 3, v0
    v_lshlrev_b32 v248, 2, v248
    v_cndmask_b32 v8, v8, v9, vcc
    v_lshrrev_b32 v8, v248, v8
    s_mov_b32 s54, 0x00010001
    s_mov_b32 s55, 0xfffefffe
    v_lshrrev_b32 v9, 1, v8
    v_lshrrev_b32 v10, 2, v8
    v_lshrrev_b32 v11, 3, v8
    v_and_b32 v8, s54, v8
    v_and_b32 v9, s54, v9
    v_and_b32 v10, s54, v10
    v_and_b32 v11, s54, v11
    s_mov_b32 s83, 0
    s_mov_b32 s42, s71
f_st:
    s_mov_b32 exec_lo, 0x000f000f
    s_mov_b32 exec_hi, 0x000f000f
    buffer_load_dwordx4 v[24:27], v7, s[12:15], s42 offen sc1
    s_waitcnt vmcnt(0)
    v_cmp_ne_u32 vcc, s32, v27
    s_mov_b64 exec, -1
    s_cbranch_vccz f_stx
    s_and_b32 s42, s83, 15
    s_cmp_eq_u32 s42, 15
    s_cselect_b32 s42, 32768, 0
    s_add_u32 s42, s42, s71
    s_cmp_lg_u32 s83, 7
    s_cbranch_scc1 f_sb1
    s_mov_b32 exec_lo, 0
    s_mov_b32 exec_hi, 0x80000000
    buffer_store_dwordx4 v[112:115], v116, s[12:15], s63 offen sc1
    s_mov_b64 exec, -1
f_sb1:
    s_sleep 1
    s_add_u32 s83, s83, 1
    s_cmp_lt_u32 s83, 0x40000
    s_cbranch_scc1 f_st
f_stx:
    s_setprio 3
    v_mul_f32_dpp v216, v24, v216 row_newbcast:0 row_mask:0xf bank_mask:0xf
    v_mul_f32_dpp v217, v25, v217 row_newbcast:0 row_mask:0xf bank_mask:0xf
    v_mul_f32_dpp v218, v24, v218 row_newbcast:1 row_mask:0xf bank_mask:0xf
    v_mul_f32_dpp v219, v25, v219 row_newbcast:1 row_mask:0xf bank_mask:0xf
    v_mov_b32_dpp v28, v26 row_newbcast:0 row_mask:0xf bank_mask:0xf
    v_mov_b32_dpp v29, v26 row_newbcast:1 row_mask:0xf bank_mask:0xf
    v_cvt_pk_bf16_f32 v224, v216, v217
    v_cvt_pk_bf16_f32 v225, v218, v219
    s_nop 1
    v_mfma_f32_16x16x16_bf16 v[228:231], v[224:225], v[28:29], 0
    v_mul_f32_dpp v220, v24, v220 row_newbcast:2 row_mask:0xf bank_mask:0xf
    v_mul_f32_dpp v221, v25, v221 row_newbcast:2 row_mask:0xf bank_mask:0xf
    v_mul_f32_dpp v222, v24, v222 row_newbcast:3 row_mask:0xf bank_mask:0xf
    v_mul_f32_dpp v223, v25, v223 row_newbcast:3 row_mask:0xf bank_mask:0xf
    v_mov_b32_dpp v30, v26 row_newbcast:2 row_mask:0xf bank_mask:0xf
    v_mov_b32_dpp v31, v26 row_newbcast:3 row_mask:0xf bank_mask:0xf
    v_cvt_pk_bf16_f32 v226, v220, v221
    v_cvt_pk_bf16_f32 v227, v222, v223
    s_nop 1
    v_mfma_f32_16x16x16_bf16 v[232:235], v[226:227], v[30:31], 0
    v_mfma_f32_16x16x16_bf16 v[56:59], v[224:225], v[40:41], v[228:231]
    v_mfma_f32_16x16x16_bf16 v[60:63], v[226:227], v[48:49], v[232:235]
    v_mfma_f32_16x16x16_bf16 v[64:67], v[224:225], v[42:43], v[228:231]
    v_mfma_f32_16x16x16_bf16 v[68:71], v[226:227], v[50:51], v[232:235]
    v_mfma_f32_16x16x16_bf16 v[72:75], v[224:225], v[44:45], v[228:231]
    v_mfma_f32_16x16x16_bf16 v[76:79], v[226:227], v[52:53], v[232:235]
    v_mfma_f32_16x16x16_bf16 v[80:83], v[224:225], v[46:47], v[228:231]
    v_mfma_f32_16x16x16_bf16 v[84:87], v[226:227], v[54:55], v[232:235]
    s_mov_b32 exec_lo, 0
    s_mov_b32 exec_hi, 0x80000000
    buffer_store_dwordx4 v[112:115], v116, s[12:15], s63 offen sc1
    s_mov_b64 exec, -1
f_sb2:
    v_cvt_pk_f16_f32 v184, v56, v57
    v_cvt_pk_f16_f32 v185, v60, v61
    ds_write_b64 v252, v[184:185] offset:0
    v_cvt_pk_f16_f32 v186, v58, v59
    v_cvt_pk_f16_f32 v187, v62, v63
    ds_write_b64 v252, v[186:187] offset:4096
    v_cvt_pk_f16_f32 v188, v64, v65
    v_cvt_pk_f16_f32 v189, v68, v69
    ds_write_b64 v252, v[188:189] offset:1024
    v_cvt_pk_f16_f32 v190, v66, v67
    v_cvt_pk_f16_f32 v191, v70, v71
    ds_write_b64 v252, v[190:191] offset:5120
    v_cvt_pk_f16_f32 v192, v72, v73
    v_cvt_pk_f16_f32 v193, v76, v77
    ds_write_b64 v252, v[192:193] offset:2048
    v_cvt_pk_f16_f32 v194, v74, v75
    v_cvt_pk_f16_f32 v195, v78, v79
    ds_write_b64 v252, v[194:195] offset:6144
    v_cvt_pk_f16_f32 v196, v80, v81
    v_cvt_pk_f16_f32 v197, v84, v85
    ds_write_b64 v252, v[196:197] offset:3072
    v_cvt_pk_f16_f32 v198, v82, v83
    v_cvt_pk_f16_f32 v199, v86, v87
    ds_write_b64 v252, v[198:199] offset:7168
    s_waitcnt lgkmcnt(0)
    s_barrier
    ds_read_b128 v[200:203], v253 offset:0
    ds_read_b128 v[204:207], v253 offset:1024
    ds_read_b128 v[208:211], v253 offset:2048
    ds_read_b128 v[212:215], v253 offset:3072
    s_waitcnt lgkmcnt(3)
    v_mfma_f32_16x16x32_f16 v[56:59], v[236:239], v[200:203], 0
    s_waitcnt lgkmcnt(2)
    v_mfma_f32_16x16x32_f16 v[60:63], v[236:239], v[204:207], 0
    s_waitcnt lgkmcnt(1)
    v_mfma_f32_16x16x32_f16 v[64:67], v[236:239], v[208:211], 0
    s_waitcnt lgkmcnt(0)
    v_mfma_f32_16x16x32_f16 v[68:71], v[236:239], v[212:215], 0
    v_mfma_f32_16x16x32_f16 v[72:75], v[240:243], v[200:203], 0
    v_mfma_f32_16x16x32_f16 v[76:79], v[240:243], v[204:207], 0
    v_mfma_f32_16x16x32_f16 v[80:83], v[240:243], v[208:211], 0
    v_mfma_f32_16x16x32_f16 v[84:87], v[240:243], v[212:215], 0
    v_cvt_pk_f16_f32 v184, v56, v57
    v_cvt_pk_f16_f32 v185, v60, v61
    v_cvt_pk_f16_f32 v186, v64, v65
    s_nop 0
    v_cvt_pk_f16_f32 v187, v68, v69
    v_and_or_b32 v184, v184, s55, v8
    v_and_or_b32 v185, v185, s55, v9
    v_and_or_b32 v186, v186, s55, v10
    v_and_or_b32 v187, v187, s55, v11
    buffer_store_dwordx4 v[184:187], v6, s[12:15], s64 offen sc1
    v_cvt_pk_f16_f32 v188, v58, v59
    v_cvt_pk_f16_f32 v189, v62, v63
    v_cvt_pk_f16_f32 v190, v66, v67
    v_cvt_pk_f16_f32 v191, v70, v71
    v_and_or_b32 v188, v188, s55, v8
    v_and_or_b32 v189, v189, s55, v9
    v_and_or_b32 v190, v190, s55, v10
    v_and_or_b32 v191, v191, s55, v11
    buffer_store_dwordx4 v[188:191], v6, s[12:15], s65 offen sc1
    v_cvt_pk_f16_f32 v192, v72, v73
    v_cvt_pk_f16_f32 v193, v76, v77
    v_cvt_pk_f16_f32 v194, v80, v81
    v_cvt_pk_f16_f32 v195, v84, v85
    v_and_or_b32 v192, v192, s55, v8
    v_and_or_b32 v193, v193, s55, v9
    v_and_or_b32 v194, v194, s55, v10
    v_and_or_b32 v195, v195, s55, v11
    buffer_store_dwordx4 v[192:195], v6, s[12:15], s66 offen sc1
    v_cvt_pk_f16_f32 v196, v74, v75
    v_cvt_pk_f16_f32 v197, v78, v79
    v_cvt_pk_f16_f32 v198, v82, v83
    v_cvt_pk_f16_f32 v199, v86, v87
    v_and_or_b32 v196, v196, s55, v8
    v_and_or_b32 v197, v197, s55, v9
    v_and_or_b32 v198, v198, s55, v10
    v_and_or_b32 v199, v199, s55, v11
    buffer_store_dwordx4 v[196:199], v6, s[12:15], s67 offen sc1
    s_setprio 0
    s_mov_b32 s44, s58
    s_mov_b32 s45, s59
    v_mov_b32 v247, 0
    s_mov_b32 s42, 0
    s_cmp_lg_u32 s16, 6
    s_cbranch_scc1 f_PF06
    s_mul_i32 s43, s34, 7
    s_lshr_b32 s41, s22, 7
    s_sub_u32 s41, 3, s41
    s_add_u32 s41, s41, s34
    s_and_b32 s41, s41, 7
    s_cmp_eq_u32 s41, 7
    s_cbranch_scc1 f_PF06
    s_add_u32 s42, s41, s43
    s_lshl_b32 s42, s42, 7
    s_mul_i32 s43, s35, 458752
    v_mul_u32_u24 v247, 7168, v2
    s_add_u32 s42, s42, s43
    s_mov_b32 s44, s22
    s_mov_b32 s45, s23
f_PF06:
    s_cmp_lg_u32 s16, 7
    s_cbranch_scc1 f_PF07
    s_mul_i32 s43, s34, 7
    s_lshr_b32 s41, s52, 7
    s_sub_u32 s41, 3, s41
    s_add_u32 s41, s41, s34
    s_and_b32 s41, s41, 7
    s_cmp_eq_u32 s41, 7
    s_cbranch_scc1 f_PF07
    s_add_u32 s42, s41, s43
    s_lshl_b32 s42, s42, 7
    s_mul_i32 s43, s35, 458752
    v_mul_u32_u24 v247, 7168, v2
    s_add_u32 s42, s42, s43
    s_mov_b32 s44, s52
    s_mov_b32 s45, s53
f_PF07:
    v_add_u32 v246, s42, v247
    s_mov_b32 s64, s44
    s_mov_b32 s65, s45
    s_waitcnt vmcnt(3)
    s_mov_b64 exec, 7
    buffer_load_dword v6, v17, s[12:15], s73 offen sc1
    s_mov_b64 exec, -1
    s_lshl_b32 s42, s16, 11
    s_mov_b32 m0, s42
    v_add_u32 v248, s42, v3
    global_load_lds_dwordx4 v248, s[58:59]
    global_load_lds_dwordx4 v248, s[58:59] offset:1024
    s_lshl_b32 s76, s34, 10
    s_add_u32 s76, s76, 16850944
    s_getreg_b32 s79, hwreg(HW_REG_XCC_ID)
    s_and_b32 s79, s79, 7
    s_or_b32 s79, s79, s33
    s_mov_b32 s78, s32
    s_lshl_b32 s72, s3, 15
    s_lshl_b32 s73, s37, 12
    s_add_u32 s72, s72, s73
    s_add_u32 s72, s72, 1048576
    s_mov_b32 m0, s68
    s_nop 0
    buffer_load_dwordx4 v3, s[8:11], s18 offen offset:0 lds
    buffer_load_dwordx4 v3, s[8:11], s18 offen offset:1024 lds
    buffer_load_dwordx4 v3, s[8:11], s75 offen offset:2048 lds
    buffer_load_dwordx4 v3, s[8:11], s75 offen offset:3072 lds
    global_load_dword v6, v246, s[64:65]
    s_waitcnt vmcnt(8)
    buffer_load_dwordx4 v[24:27], v3, s[12:15], s72 offen offset:0 sc1
    buffer_load_dwordx4 v[28:31], v3, s[12:15], s72 offen offset:1024 sc1
    buffer_load_dwordx4 v[32:35], v3, s[12:15], s72 offen offset:2048 sc1
    buffer_load_dwordx4 v[36:39], v3, s[12:15], s72 offen offset:3072 sc1
    s_mov_b32 s43, 0
    s_lshr_b32 s42, s3, 4
    s_and_b32 s40, s3, 15
    s_lshl_b32 s40, s40, 4
    s_add_u32 s40, s40, s42
    s_lshr_b32 s42, s3, 3
    s_cmp_eq_u32 s42, 1
    s_cselect_b32 s42, 120, 0
    s_sub_u32 s40, s40, s42
    s_lshl_b32 s42, s43, 8
    s_add_u32 s40, s40, s42
    s_cmp_ge_u32 s43, 4
    s_cselect_b32 s42, 896, 0
    s_cmp_eq_u32 s3, 0
    s_cselect_b32 s42, s42, 0
    s_sub_u32 s40, s40, s42
    v_lshrrev_b32 v248, 1, v4
    v_and_b32 v249, 1, v0
    v_lshlrev_b32 v250, 8, v248
    v_add_u32 v250, s40, v250
    s_cmp_lg_u32 s3, 0
    s_cbranch_scc1 f_a3n
    v_cmp_lt_u32 s[44:45], 3, v248
    v_subrev_u32 v251, 896, v250
    s_nop 0
    v_cndmask_b32 v250, v250, v251, s[44:45]
    v_cmp_eq_u32 vcc, 1, v4
    v_mov_b32 v251, 1024
    s_nop 0
    v_cndmask_b32 v250, v250, v251, vcc
    v_cndmask_b32_e64 v249, v249, 0, vcc
f_a3n:
    v_lshlrev_b32 v251, 1, v5
    v_mul_u32_u24 v251, v251, v250
    v_lshl_add_u32 v251, v249, 9, v251
    v_add_u32 v253, v251, v250
    v_add_u32 v252, 1536, v251
    v_add_u32 v254, 1536, v253
    v_and_b32 v251, 2047, v251
    v_and_b32 v252, 2047, v252
    v_and_b32 v253, 2047, v253
    v_and_b32 v254, 2047, v254
    v_cvt_f32_u32 v251, v251
    v_cvt_f32_u32 v252, v252
    v_cvt_f32_u32 v253, v253
    v_cvt_f32_u32 v254, v254
    v_mul_f32 v251, 0x3a000000, v251
    v_mul_f32 v252, 0x3a000000, v252
    v_mul_f32 v253, 0x3a000000, v253
    v_mul_f32 v254, 0x3a000000, v254
    v_cos_f32 v251, v251
    v_cos_f32 v252, v252
    v_cos_f32 v253, v253
    v_cos_f32 v254, v254
    s_cbranch_scc1 f_a3m
    v_cmp_gt_u32 vcc, 2, v4
    s_nop 1
    v_cndmask_b32_e64 v249, 1.0, 0.5, vcc
    v_mul_f32 v251, v251, v249
    v_mul_f32 v253, v253, v249
    v_cndmask_b32 v252, 0, v251, s[44:45]
    v_cndmask_b32 v254, 0, v253, s[44:45]
    v_cndmask_b32 v251, v251, 0, s[44:45]
    v_cndmask_b32 v253, v253, 0, s[44:45]
f_a3m:
    v_cvt_pk_f16_f32 v22, v251, v252
    v_cvt_pk_f16_f32 v23, v253, v254
    v_and_b32 v248, 3, v0
    v_bfe_u32 v249, v0, 2, 1
    v_bfe_u32 v250, v0, 3, 2
    v_bfe_u32 v251, v0, 5, 1
    v_lshlrev_b32 v13, 10, v249
    v_lshl_add_u32 v15, v251, 8, v13
    v_lshl_add_u32 v15, v250, 6, v15
    v_lshl_add_u32 v15, v248, 4, v15
    v_lshl_add_u32 v13, v250, 8, v13
    v_lshl_add_u32 v13, v248, 6, v13
    v_lshl_add_u32 v13, v251, 5, v13
    v_xor_b32 v14, 2016, v13
    v_add_u32 v13, s68, v13
    v_add_u32 v14, s68, v14
    s_waitcnt vmcnt(5)
    ds_read_b128 v[200:203], v13 offset:0
    ds_read_b128 v[204:207], v13 offset:16
    ds_read_b128 v[208:211], v14 offset:2048
    ds_read_b128 v[212:215], v14 offset:2064
    v_xor_b32 v16, 1520, v15
    v_subrev_u32 v248, s68, v13
    v_add_u32 v248, 32, v248
    v_bfe_u32 v19, v248, 5, 1
    v_lshlrev_b32 v19, 5, v19
    v_bfe_u32 v249, v248, 8, 2
    v_lshl_add_u32 v19, v249, 3, v19
    v_bfe_u32 v249, v248, 10, 1
    v_lshl_add_u32 v19, v249, 2, v19
    v_bfe_u32 v249, v248, 6, 2
    v_add_lshl_u32 v19, v249, v19, 2
    v_lshlrev_b32 v18, 11, v2
    v_lshrrev_b32 v248, 5, v0
    v_lshlrev_b32 v20, 2, v248
    v_add_u32 v20, 159744, v20
    v_lshlrev_b32 v21, 2, v4
    v_add_u32 v21, 159744, v21
    s_add_u32 s74, s70, 18857984
    s_lshl_b32 s80, s3, 3
    s_add_u32 s80, s80, 18857984
    s_lshl_b32 s42, s37, 9
    s_add_u32 s42, s42, 61440
    v_add_u32 v12, s42, v12
    s_waitcnt lgkmcnt(0)
    v_lshlrev_b32 v152, 16, v200
    v_and_b32 v153, 0xffff0000, v200
    v_lshlrev_b32 v154, 16, v201
    v_and_b32 v155, 0xffff0000, v201
    v_lshlrev_b32 v156, 16, v202
    v_and_b32 v157, 0xffff0000, v202
    v_lshlrev_b32 v158, 16, v203
    v_and_b32 v159, 0xffff0000, v203
    v_lshlrev_b32 v160, 16, v204
    v_and_b32 v161, 0xffff0000, v204
    v_lshlrev_b32 v162, 16, v205
    v_and_b32 v163, 0xffff0000, v205
    v_lshlrev_b32 v164, 16, v206
    v_and_b32 v165, 0xffff0000, v206
    v_lshlrev_b32 v166, 16, v207
    v_and_b32 v167, 0xffff0000, v207
    v_lshlrev_b32 v168, 16, v208
    v_and_b32 v183, 0xffff0000, v208
    v_lshlrev_b32 v182, 16, v209
    v_and_b32 v181, 0xffff0000, v209
    v_lshlrev_b32 v180, 16, v210
    v_and_b32 v179, 0xffff0000, v210
    v_lshlrev_b32 v178, 16, v211
    v_and_b32 v177, 0xffff0000, v211
    v_lshlrev_b32 v176, 16, v212
    v_and_b32 v175, 0xffff0000, v212
    v_lshlrev_b32 v174, 16, v213
    v_and_b32 v173, 0xffff0000, v213
    v_lshlrev_b32 v172, 16, v214
    v_and_b32 v171, 0xffff0000, v214
    v_lshlrev_b32 v170, 16, v215
    v_and_b32 v169, 0xffff0000, v215
    s_waitcnt vmcnt(9)
    s_barrier
    ds_read_b128 v[88:91], v3 offset:0
    ds_read_b128 v[92:95], v3 offset:1024
    ds_read_b128 v[96:99], v3 offset:2048
    ds_read_b128 v[100:103], v3 offset:3072
    ds_read_b128 v[104:107], v3 offset:4096
    ds_read_b128 v[108:111], v3 offset:5120
    ds_read_b128 v[112:115], v3 offset:6144
    ds_read_b128 v[116:119], v3 offset:7168
    ds_read_b128 v[120:123], v3 offset:8192
    ds_read_b128 v[124:127], v3 offset:9216
    ds_read_b128 v[128:131], v3 offset:10240
    ds_read_b128 v[132:135], v3 offset:11264
    ds_read_b128 v[136:139], v3 offset:12288
    ds_read_b128 v[140:143], v3 offset:13312
    ds_read_b128 v[144:147], v3 offset:14336
    ds_read_b128 v[148:151], v3 offset:15360
    s_lshl_b32 s42, s3, 13
    s_lshl_b32 s43, s16, 10
    s_add_u32 s42, s42, s43
    s_add_u32 s42, s42, 18874368
    v_mov_b32 v40, -1
    v_mov_b32 v41, -1
    v_mov_b32 v42, -1
    v_mov_b32 v43, -1
    buffer_store_dwordx4 v[40:43], v3, s[12:15], s42 offen sc1
    s_mul_i32 s46, s16, 5120
    s_add_u32 s47, s46, s77
    s_add_u32 s46, s46, 16384
    s_waitcnt vmcnt(1)
    s_cmp_ge_u32 s16, 4
    s_cbranch_scc1 f_pd
    s_mov_b64 exec, 3
    buffer_load_dwordx4 v[240:243], v17, s[12:15], s76 offen offset:0 sc1
    s_mov_b64 exec, -1
f_pd:
    s_mov_b32 s83, 0
f_zc:
    v_xor_b32 v40, v24, v8
    v_xor_b32 v41, v28, v8
    v_xor_b32 v42, v25, v9
    v_xor_b32 v43, v29, v9
    v_xor_b32 v44, v26, v10
    v_xor_b32 v45, v30, v10
    v_xor_b32 v46, v27, v11
    v_xor_b32 v47, v31, v11
    v_xor_b32 v48, v32, v8
    v_xor_b32 v49, v36, v8
    v_xor_b32 v50, v33, v9
    v_xor_b32 v51, v37, v9
    v_xor_b32 v52, v34, v10
    v_xor_b32 v53, v38, v10
    v_xor_b32 v54, v35, v11
    v_xor_b32 v55, v39, v11
    v_or3_b32 v248, v40, v41, 0
    v_or3_b32 v248, v42, v43, v248
    v_or3_b32 v248, v44, v45, v248
    v_or3_b32 v248, v46, v47, v248
    v_or3_b32 v248, v48, v49, v248
    v_or3_b32 v248, v50, v51, v248
    v_or3_b32 v248, v52, v53, v248
    v_or3_b32 v248, v54, v55, v248
    v_and_b32 v248, s54, v248
    v_cmp_ne_u32 vcc, 0, v248
    s_cbranch_vccnz f_zr
f_zx:
    v_mfma_f32_16x16x16_f16 v[56:59], v[22:23], v[40:41], 0
    v_mfma_f32_16x16x16_f16 v[64:67], v[22:23], v[44:45], 0
    v_mfma_f32_16x16x16_f16 v[72:75], v[22:23], v[48:49], 0
    v_mfma_f32_16x16x16_f16 v[80:83], v[22:23], v[52:53], 0
    v_mfma_f32_16x16x16_f16 v[60:63], v[22:23], v[42:43], 0
    v_mfma_f32_16x16x16_f16 v[68:71], v[22:23], v[46:47], 0
    v_mfma_f32_16x16x16_f16 v[76:79], v[22:23], v[50:51], 0
    v_mfma_f32_16x16x16_f16 v[84:87], v[22:23], v[54:55], 0
    s_nop 0
    v_cvt_pk_f16_f32 v24, v56, v57
    v_cvt_pk_f16_f32 v25, v64, v65
    v_cvt_pk_f16_f32 v26, v72, v73
    v_cvt_pk_f16_f32 v27, v80, v81
    ds_write_b128 v12, v[24:27] offset:0
    v_cvt_pk_f16_f32 v28, v58, v59
    v_cvt_pk_f16_f32 v29, v66, v67
    v_cvt_pk_f16_f32 v30, v74, v75
    v_cvt_pk_f16_f32 v31, v82, v83
    ds_write_b128 v12, v[28:31] offset:4096
    v_cvt_pk_f16_f32 v32, v60, v61
    v_cvt_pk_f16_f32 v33, v68, v69
    v_cvt_pk_f16_f32 v34, v76, v77
    v_cvt_pk_f16_f32 v35, v84, v85
    ds_write_b128 v12, v[32:35] offset:256
    v_cvt_pk_f16_f32 v36, v62, v63
    v_cvt_pk_f16_f32 v37, v70, v71
    v_cvt_pk_f16_f32 v38, v78, v79
    v_cvt_pk_f16_f32 v39, v86, v87
    ds_write_b128 v12, v[36:39] offset:4352
    s_cmp_ge_u32 s16, 4
    s_cbranch_scc1 f_pvx
    s_waitcnt vmcnt(0)
    s_mov_b64 exec, 3
    v_cmp_ne_u64 vcc, s[78:79], v[240:241]
    s_cbranch_vccz f_p1y
    s_mov_b32 s83, 0
    s_mov_b64 exec, 3
f_p1:
    buffer_load_dwordx4 v[240:243], v17, s[12:15], s76 offen offset:0 sc1
    s_waitcnt vmcnt(0)
    v_cmp_ne_u64 vcc, s[78:79], v[240:241]
    s_cbranch_vccz f_p1y
    s_and_b32 s42, s83, 7
    s_cmp_lg_u32 s42, 7
    s_cbranch_scc1 f_p1n
    buffer_load_dwordx4 v[240:243], v17, s[12:15], s76 offen offset:512 sc1
    s_waitcnt vmcnt(0)
    v_cmp_ne_u64 vcc, s[32:33], v[240:241]
    s_cbranch_vccnz f_p1n
    s_add_u32 s47, s47, 65536
    s_branch f_p1y
f_p1n:
    s_sleep 1
    s_add_u32 s83, s83, 1
    s_cmp_lt_u32 s83, 0x40000
    s_cbranch_scc1 f_p1
f_p1y:
    ds_write_b32 v21, v242 offset:64
    s_mov_b64 exec, -1
    s_mov_b32 m0, s46
    s_nop 0
    buffer_load_dwordx4 v3, s[12:15], s47 offen offset:0 sc1 lds
    buffer_load_dwordx4 v3, s[12:15], s47 offen offset:1024 sc1 lds
    buffer_load_dwordx4 v3, s[12:15], s47 offen offset:2048 sc1 lds
    buffer_load_dwordx4 v3, s[12:15], s47 offen offset:3072 sc1 lds
    s_add_u32 s42, s46, 4096
    s_add_u32 s43, s47, 4096
    s_mov_b32 m0, s42
    s_nop 0
    buffer_load_dwordx4 v3, s[12:15], s43 offen offset:0 sc1 lds
    s_waitcnt vmcnt(0)
f_pvx:
    s_lshl_b32 s42, s16, 12
    s_add_u32 s42, s42, 61440
    v_add_u32 v7, s42, v3
    s_waitcnt vmcnt(1) lgkmcnt(0)
    s_barrier
    ds_read_b128 v[248:251], v3 offset:16384
    ds_read_b128 v[24:27], v7 offset:0
    ds_read_b128 v[28:31], v7 offset:1024
    ds_read_b128 v[252:255], v3 offset:17408
    ds_read_b128 v[32:35], v7 offset:2048
    ds_read_b128 v[36:39], v7 offset:3072
    s_cmp_eq_u32 s30, 0
    s_cbranch_scc1 f_sp
    s_waitcnt lgkmcnt(4)
    v_pk_mul_f16 v40, v24, v248 op_sel:[0,0] op_sel_hi:[1,0]
    v_pk_mul_f16 v41, v25, v248 op_sel:[0,1] op_sel_hi:[1,1]
    v_pk_mul_f16 v42, v26, v249 op_sel:[0,0] op_sel_hi:[1,0]
    v_pk_mul_f16 v43, v27, v249 op_sel:[0,1] op_sel_hi:[1,1]
    s_nop 1
    v_mfma_f32_32x32x16_f16 v[56:71], v[40:43], v[88:91], 0
    s_waitcnt lgkmcnt(3)
    v_pk_mul_f16 v44, v28, v250 op_sel:[0,0] op_sel_hi:[1,0]
    v_pk_mul_f16 v45, v29, v250 op_sel:[0,1] op_sel_hi:[1,1]
    v_pk_mul_f16 v46, v30, v251 op_sel:[0,0] op_sel_hi:[1,0]
    v_pk_mul_f16 v47, v31, v251 op_sel:[0,1] op_sel_hi:[1,1]
    v_mfma_f32_32x32x16_f16 v[72:87], v[40:43], v[104:107], 0
    s_waitcnt lgkmcnt(1)
    v_pk_mul_f16 v48, v32, v252 op_sel:[0,0] op_sel_hi:[1,0]
    v_pk_mul_f16 v49, v33, v252 op_sel:[0,1] op_sel_hi:[1,1]
    v_pk_mul_f16 v50, v34, v253 op_sel:[0,0] op_sel_hi:[1,0]
    v_pk_mul_f16 v51, v35, v253 op_sel:[0,1] op_sel_hi:[1,1]
    v_mfma_f32_32x32x16_f16 v[56:71], v[44:47], v[92:95], v[56:71]
    s_waitcnt lgkmcnt(0)
    v_pk_mul_f16 v52, v36, v254 op_sel:[0,0] op_sel_hi:[1,0]
    v_pk_mul_f16 v53, v37, v254 op_sel:[0,1] op_sel_hi:[1,1]
    v_pk_mul_f16 v54, v38, v255 op_sel:[0,0] op_sel_hi:[1,0]
    v_pk_mul_f16 v55, v39, v255 op_sel:[0,1] op_sel_hi:[1,1]
    v_mfma_f32_32x32x16_f16 v[72:87], v[44:47], v[108:111], v[72:87]
f_st1:
    v_mov_b32 v22, 159808
    ds_read_b64 v[22:23], v22
    v_mfma_f32_32x32x16_f16 v[56:71], v[48:51], v[96:99], v[56:71]
    ds_read_b128 v[184:187], v3 offset:20480
    ds_read_b128 v[188:191], v3 offset:21504
    ds_read_b128 v[192:195], v3 offset:22528
    ds_read_b128 v[196:199], v3 offset:23552
    v_mfma_f32_32x32x16_f16 v[72:87], v[48:51], v[112:115], v[72:87]
    ds_read_b128 v[200:203], v3 offset:24576
    ds_read_b128 v[204:207], v3 offset:25600
    ds_read_b128 v[208:211], v3 offset:26624
    ds_read_b128 v[212:215], v3 offset:27648
    v_mfma_f32_32x32x16_f16 v[56:71], v[52:55], v[100:103], v[56:71]
    ds_read_b128 v[216:219], v3 offset:28672
    ds_read_b128 v[220:223], v3 offset:29696
    ds_read_b128 v[224:227], v3 offset:30720
    ds_read_b128 v[228:231], v3 offset:31744
    v_mfma_f32_32x32x16_f16 v[72:87], v[52:55], v[116:119], v[72:87]
    ds_read_b128 v[232:235], v3 offset:32768
    ds_read_b128 v[236:239], v3 offset:33792
    ds_read_b128 v[240:243], v3 offset:34816
    ds_read_b128 v[244:247], v3 offset:35840
    s_waitcnt lgkmcnt(8)
    v_pk_mul_f32 v[184:185], v[184:185], v[22:23] op_sel_hi:[1,0]
    v_pk_mul_f32 v[186:187], v[186:187], v[22:23] op_sel_hi:[1,0]
    v_pk_mul_f32 v[188:189], v[188:189], v[22:23] op_sel_hi:[1,0]
    v_pk_mul_f32 v[190:191], v[190:191], v[22:23] op_sel_hi:[1,0]
    v_pk_mul_f32 v[192:193], v[192:193], v[22:23] op_sel_hi:[1,0]
    v_pk_mul_f32 v[194:195], v[194:195], v[22:23] op_sel_hi:[1,0]
    v_pk_mul_f32 v[196:197], v[196:197], v[22:23] op_sel_hi:[1,0]
    v_pk_mul_f32 v[198:199], v[198:199], v[22:23] op_sel_hi:[1,0]
    v_pk_mul_f32 v[200:201], v[200:201], v[22:23] op_sel_hi:[1,0]
    v_pk_mul_f32 v[202:203], v[202:203], v[22:23] op_sel_hi:[1,0]
    v_pk_mul_f32 v[204:205], v[204:205], v[22:23] op_sel_hi:[1,0]
    v_pk_mul_f32 v[206:207], v[206:207], v[22:23] op_sel_hi:[1,0]
    v_pk_mul_f32 v[208:209], v[208:209], v[22:23] op_sel_hi:[1,0]
    v_pk_mul_f32 v[210:211], v[210:211], v[22:23] op_sel_hi:[1,0]
    v_pk_mul_f32 v[212:213], v[212:213], v[22:23] op_sel_hi:[1,0]
    v_pk_mul_f32 v[214:215], v[214:215], v[22:23] op_sel_hi:[1,0]
    s_mul_i32 s46, s16, 3072
    s_add_u32 s46, s46, 20480
    s_add_u32 s47, s46, s77
    s_add_u32 s46, s46, 16384
    s_mov_b32 m0, s46
    s_waitcnt vmcnt(0)
    s_cmp_eq_u32 s30, 0
    s_cbranch_scc1 f_sp2
    v_pk_mul_f32 v[24:25], v[56:57], v[120:121]
    v_pk_mul_f32 v[28:29], v[72:73], v[120:121]
    v_pk_mul_f32 v[26:27], v[58:59], v[122:123]
    v_pk_mul_f32 v[30:31], v[74:75], v[122:123]
    v_pk_fma_f32 v[24:25], v[72:73], v[136:137], v[24:25]
    v_pk_fma_f32 v[28:29], v[56:57], v[136:137], v[28:29] neg_lo:[1,0,0] neg_hi:[1,0,0]
    v_pk_fma_f32 v[26:27], v[74:75], v[138:139], v[26:27]
    v_pk_fma_f32 v[30:31], v[58:59], v[138:139], v[30:31] neg_lo:[1,0,0] neg_hi:[1,0,0]
    v_cvt_pk_f16_f32 v40, v24, v28
    v_cvt_pk_f16_f32 v41, v25, v29
    v_cvt_pk_f16_f32 v42, v26, v30
    v_cvt_pk_f16_f32 v43, v27, v31
    v_pk_mul_f32 v[32:33], v[60:61], v[124:125]
    v_pk_mul_f32 v[36:37], v[76:77], v[124:125]
    v_pk_mul_f32 v[34:35], v[62:63], v[126:127]
    v_pk_mul_f32 v[38:39], v[78:79], v[126:127]
    v_pk_fma_f32 v[32:33], v[76:77], v[140:141], v[32:33]
    v_pk_fma_f32 v[36:37], v[60:61], v[140:141], v[36:37] neg_lo:[1,0,0] neg_hi:[1,0,0]
    v_pk_fma_f32 v[34:35], v[78:79], v[142:143], v[34:35]
    v_pk_fma_f32 v[38:39], v[62:63], v[142:143], v[38:39] neg_lo:[1,0,0] neg_hi:[1,0,0]
    v_cvt_pk_f16_f32 v44, v32, v36
    v_cvt_pk_f16_f32 v45, v33, v37
    v_cvt_pk_f16_f32 v46, v34, v38
    v_cvt_pk_f16_f32 v47, v35, v39
    v_mfma_f32_32x32x16_f16 v[104:119], v[40:43], v[88:91], 0
    v_pk_mul_f32 v[24:25], v[64:65], v[128:129]
    v_pk_mul_f32 v[28:29], v[80:81], v[128:129]
    v_pk_mul_f32 v[26:27], v[66:67], v[130:131]
    v_pk_mul_f32 v[30:31], v[82:83], v[130:131]
    v_pk_fma_f32 v[24:25], v[80:81], v[144:145], v[24:25]
    v_pk_fma_f32 v[28:29], v[64:65], v[144:145], v[28:29] neg_lo:[1,0,0] neg_hi:[1,0,0]
    v_pk_fma_f32 v[26:27], v[82:83], v[146:147], v[26:27]
    v_pk_fma_f32 v[30:31], v[66:67], v[146:147], v[30:31] neg_lo:[1,0,0] neg_hi:[1,0,0]
    v_cvt_pk_f16_f32 v48, v24, v28
    v_cvt_pk_f16_f32 v49, v25, v29
    v_cvt_pk_f16_f32 v50, v26, v30
    v_cvt_pk_f16_f32 v51, v27, v31
    v_mfma_f32_32x32x16_f16 v[104:119], v[44:47], v[92:95], v[104:119]
    v_pk_mul_f32 v[32:33], v[68:69], v[132:133]
    v_pk_mul_f32 v[36:37], v[84:85], v[132:133]
    v_pk_mul_f32 v[34:35], v[70:71], v[134:135]
    v_pk_mul_f32 v[38:39], v[86:87], v[134:135]
    v_pk_fma_f32 v[32:33], v[84:85], v[148:149], v[32:33]
    v_pk_fma_f32 v[36:37], v[68:69], v[148:149], v[36:37] neg_lo:[1,0,0] neg_hi:[1,0,0]
    v_pk_fma_f32 v[34:35], v[86:87], v[150:151], v[34:35]
    v_pk_fma_f32 v[38:39], v[70:71], v[150:151], v[38:39] neg_lo:[1,0,0] neg_hi:[1,0,0]
    v_cvt_pk_f16_f32 v52, v32, v36
    v_cvt_pk_f16_f32 v53, v33, v37
    v_cvt_pk_f16_f32 v54, v34, v38
    v_cvt_pk_f16_f32 v55, v35, v39
    v_mfma_f32_32x32x16_f16 v[104:119], v[48:51], v[96:99], v[104:119]
    s_nop 0
    v_mfma_f32_32x32x16_f16 v[104:119], v[52:55], v[100:103], v[104:119]
    s_nop 11
    ds_bpermute_b32 v248, v19, v104
    s_waitcnt lgkmcnt(1)
    v_pk_fma_f32 v[152:153], v[184:185], v[104:105], v[152:153]
    v_pk_fma_f32 v[154:155], v[186:187], v[106:107], v[154:155]
    v_pk_fma_f32 v[156:157], v[188:189], v[108:109], v[156:157]
    v_pk_fma_f32 v[158:159], v[190:191], v[110:111], v[158:159]
    v_pk_fma_f32 v[160:161], v[192:193], v[112:113], v[160:161]
    v_pk_fma_f32 v[162:163], v[194:195], v[114:115], v[162:163]
    v_pk_fma_f32 v[164:165], v[196:197], v[116:117], v[164:165]
    v_pk_fma_f32 v[166:167], v[198:199], v[118:119], v[166:167]
    v_pk_fma_f32 v[170:171], v[202:203], v[106:107], v[170:171]
    v_pk_fma_f32 v[172:173], v[204:205], v[108:109], v[172:173]
    v_pk_fma_f32 v[174:175], v[206:207], v[110:111], v[174:175]
    v_pk_fma_f32 v[176:177], v[208:209], v[112:113], v[176:177]
    v_pk_fma_f32 v[178:179], v[210:211], v[114:115], v[178:179]
    v_pk_fma_f32 v[180:181], v[212:213], v[116:117], v[180:181]
    v_pk_fma_f32 v[182:183], v[214:215], v[118:119], v[182:183]
    v_fmac_f32 v169, v201, v105
    s_waitcnt lgkmcnt(0)
    v_fmac_f32 v168, v200, v248
f_join:
    s_mov_b64 exec, 14
    buffer_load_dwordx4 v[8:11], v17, s[12:15], s76 offen offset:0 sc1
    s_mov_b64 exec, -1
    v_pk_add_f32 v[40:41], v[166:167], v[164:165]
    v_pk_add_f32 v[48:49], v[182:183], v[180:181]
    v_pk_add_f32 v[40:41], v[40:41], v[162:163]
    v_pk_add_f32 v[48:49], v[48:49], v[178:179]
    v_pk_add_f32 v[40:41], v[40:41], v[160:161]
    v_pk_add_f32 v[48:49], v[48:49], v[176:177]
    v_pk_add_f32 v[40:41], v[40:41], v[158:159]
    v_pk_add_f32 v[48:49], v[48:49], v[174:175]
    v_pk_add_f32 v[40:41], v[40:41], v[156:157]
    v_pk_add_f32 v[48:49], v[48:49], v[172:173]
    v_pk_add_f32 v[40:41], v[40:41], v[154:155]
    v_pk_add_f32 v[48:49], v[48:49], v[170:171]
    v_pk_add_f32 v[40:41], v[40:41], v[152:153]
    v_pk_add_f32 v[48:49], v[48:49], v[168:169]
    v_pk_mul_f32 v[42:43], v[166:167], v[166:167]
    v_pk_mul_f32 v[44:45], v[166:167], v[230:231]
    v_pk_mul_f32 v[50:51], v[182:183], v[182:183]
    v_pk_mul_f32 v[52:53], v[182:183], v[246:247]
    v_pk_fma_f32 v[42:43], v[164:165], v[164:165], v[42:43]
    v_pk_fma_f32 v[44:45], v[164:165], v[228:229], v[44:45]
    v_pk_fma_f32 v[50:51], v[180:181], v[180:181], v[50:51]
    v_pk_fma_f32 v[52:53], v[180:181], v[244:245], v[52:53]
    v_pk_fma_f32 v[42:43], v[162:163], v[162:163], v[42:43]
    v_pk_fma_f32 v[44:45], v[162:163], v[226:227], v[44:45]
    v_pk_fma_f32 v[50:51], v[178:179], v[178:179], v[50:51]
    v_pk_fma_f32 v[52:53], v[178:179], v[242:243], v[52:53]
    v_pk_fma_f32 v[42:43], v[160:161], v[160:161], v[42:43]
    v_pk_fma_f32 v[44:45], v[160:161], v[224:225], v[44:45]
    v_pk_fma_f32 v[50:51], v[176:177], v[176:177], v[50:51]
    v_pk_fma_f32 v[52:53], v[176:177], v[240:241], v[52:53]
    v_pk_fma_f32 v[42:43], v[158:159], v[158:159], v[42:43]
    v_pk_fma_f32 v[44:45], v[158:159], v[222:223], v[44:45]
    v_pk_fma_f32 v[50:51], v[174:175], v[174:175], v[50:51]
    v_pk_fma_f32 v[52:53], v[174:175], v[238:239], v[52:53]
    v_pk_fma_f32 v[42:43], v[156:157], v[156:157], v[42:43]
    v_pk_fma_f32 v[44:45], v[156:157], v[220:221], v[44:45]
    v_pk_fma_f32 v[50:51], v[172:173], v[172:173], v[50:51]
    v_pk_fma_f32 v[52:53], v[172:173], v[236:237], v[52:53]
    v_pk_fma_f32 v[42:43], v[154:155], v[154:155], v[42:43]
    v_pk_fma_f32 v[44:45], v[154:155], v[218:219], v[44:45]
    v_pk_fma_f32 v[50:51], v[170:171], v[170:171], v[50:51]
    v_pk_fma_f32 v[52:53], v[170:171], v[234:235], v[52:53]
    v_pk_fma_f32 v[42:43], v[152:153], v[152:153], v[42:43]
    v_pk_fma_f32 v[44:45], v[152:153], v[216:217], v[44:45]
    v_pk_fma_f32 v[50:51], v[168:169], v[168:169], v[50:51]
    v_pk_fma_f32 v[52:53], v[168:169], v[232:233], v[52:53]
    v_add_f32 v24, v40, v41
    v_add_f32 v25, v42, v43
    v_add_f32 v26, v44, v45
    v_add_f32 v28, v48, v49
    v_add_f32 v29, v50, v51
    v_add_f32 v30, v52, v53
    s_waitcnt vmcnt(0)
    s_mov_b64 exec, 14
    v_cmp_ne_u64 vcc, s[78:79], v[8:9]
    s_mov_b64 exec, -1
    s_mov_b32 s55, vcc_lo
    s_cbranch_vccnz f_p2l
    buffer_load_dwordx4 v3, s[12:15], s47 offen offset:0 sc1 lds
    buffer_load_dwordx4 v3, s[12:15], s47 offen offset:1024 sc1 lds
    buffer_load_dwordx4 v3, s[12:15], s47 offen offset:2048 sc1 lds
f_p2l:
    s_xor_b32 s42, s35, 1
    s_xor_b32 s43, s16, 1
    s_or_b32 s42, s42, s43
    s_cmp_lg_u32 s42, 0
    s_cbranch_scc1 f_ngo
    s_lshl_b32 s41, s34, 7
    s_mov_b32 s38, 1
    s_add_u32 s41, s41, 16842752
    v_mov_b32 v252, s32
    v_mov_b32 v253, s33
    s_mov_b64 exec, 0xff
    buffer_store_dwordx4 v[252:255], v3, s[12:15], s41 offen sc1
    s_mov_b64 exec, -1
f_ngo:
    v_permlane32_swap_b32 v24, v28
    v_permlane32_swap_b32 v25, v29
    v_permlane32_swap_b32 v26, v30
    v_add_f32 v24, v24, v28
    v_add_f32 v25, v25, v29
    v_add_f32 v26, v26, v30
    v_add_f32_dpp v24, v24, v24 row_ror:8 row_mask:0xf bank_mask:0xf
    v_add_f32_dpp v25, v25, v25 row_ror:8 row_mask:0xf bank_mask:0xf
    v_add_f32_dpp v26, v26, v26 row_ror:8 row_mask:0xf bank_mask:0xf
    v_add_f32_dpp v24, v24, v24 row_ror:4 row_mask:0xf bank_mask:0xf
    v_add_f32_dpp v25, v25, v25 row_ror:4 row_mask:0xf bank_mask:0xf
    v_add_f32_dpp v26, v26, v26 row_ror:4 row_mask:0xf bank_mask:0xf
    v_add_f32_dpp v24, v24, v24 row_ror:2 row_mask:0xf bank_mask:0xf
    v_add_f32_dpp v25, v25, v25 row_ror:2 row_mask:0xf bank_mask:0xf
    v_add_f32_dpp v26, v26, v26 row_ror:2 row_mask:0xf bank_mask:0xf
    v_add_f32_dpp v24, v24, v24 row_ror:1 row_mask:0xf bank_mask:0xf
    v_add_f32_dpp v25, v25, v25 row_ror:1 row_mask:0xf bank_mask:0xf
    v_add_f32_dpp v26, v26, v26 row_ror:1 row_mask:0xf bank_mask:0xf
    v_add_f32_dpp v24, v24, v24 row_bcast:15 row_mask:0xa bank_mask:0xf
    v_add_f32_dpp v25, v25, v25 row_bcast:15 row_mask:0xa bank_mask:0xf
    v_add_f32_dpp v26, v26, v26 row_bcast:15 row_mask:0xa bank_mask:0xf
    v_mul_f32 v24, 0x3a800000, v24
    v_mul_f32 v25, 0x3a800000, v25
    v_mul_f32 v28, v24, v24
    v_fma_f32 v26, -v24, v23, v26
    v_sub_f32 v25, v25, v28
    v_mul_f32 v29, 4.0, v25
    v_cmp_gt_f32 vcc, v28, v29
    v_lshrrev_b32 v30, 4, v0
    s_lshl_b32 s43, s3, 5
    v_and_or_b32 v30, v30, 30, s43
    s_or_b32 s42, vcc_lo, vcc_hi
    s_bitcmp1_b32 s42, 31
    s_cbranch_scc1 f_slow2
f_var2:
    v_cvt_pk_bf16_f32 v25, v25, v25
    v_lshlrev_b32 v25, 16, v25
    v_add_f32 v25, 0x3727c5ac, v25
    v_cvt_pk_bf16_f32 v25, v25, v25
    v_lshlrev_b32 v25, 16, v25
    v_sqrt_f32 v25, v25
    s_nop 0
    v_cvt_pk_bf16_f32 v25, v25, v25
    v_lshlrev_b32 v25, 16, v25
    v_rcp_f32 v25, v25
    s_mov_b32 s42, 0x80000000
    s_movk_i32 s43, 0xf000
    s_mov_b32 exec_lo, s42
    s_mov_b32 exec_hi, s42
    v_mul_f32 v26, v26, v25
    v_ashrrev_i32 v28, 31, v26
    v_or_b32 v28, s42, v28
    v_xor_b32 v26, v26, v28
    v_min_u32 v26, 0xffffe000, v26
    v_and_or_b32 v26, v26, s43, v30
    ds_write_b32 v20, v26
    s_mov_b64 exec, -1
    v_readlane_b32 s60, v26, 31
    v_readlane_b32 s56, v24, 31
    v_readlane_b32 s57, v25, 31
    v_readlane_b32 s61, v26, 63
    v_readlane_b32 s58, v24, 63
    v_readlane_b32 s59, v25, 63
    s_waitcnt lgkmcnt(0)
    s_barrier
    ds_read_b32 v32, v21
    s_cmp_lg_u32 s16, 0
    s_waitcnt vmcnt(0) lgkmcnt(0)
    s_cbranch_scc1 f_nkey
    s_setprio 3
    v_mov_b32 v34, v32
    s_nop 1
    v_max_u32_dpp v34, v34, v34 row_ror:8 row_mask:0xf bank_mask:0xf
    s_nop 1
    v_max_u32_dpp v34, v34, v34 row_ror:4 row_mask:0xf bank_mask:0xf
    s_nop 1
    v_max_u32_dpp v34, v34, v34 row_ror:2 row_mask:0xf bank_mask:0xf
    s_nop 1
    v_max_u32_dpp v34, v34, v34 row_ror:1 row_mask:0xf bank_mask:0xf
    v_cmp_eq_u32 vcc, v34, v32
    s_nop 1
    v_cndmask_b32_e64 v35, v32, 0, vcc
    s_nop 1
    v_max_u32_dpp v35, v35, v35 row_ror:8 row_mask:0xf bank_mask:0xf
    s_nop 1
    v_max_u32_dpp v35, v35, v35 row_ror:4 row_mask:0xf bank_mask:0xf
    s_nop 1
    v_max_u32_dpp v35, v35, v35 row_ror:2 row_mask:0xf bank_mask:0xf
    s_nop 1
    v_max_u32_dpp v35, v35, v35 row_ror:1 row_mask:0xf bank_mask:0xf
    v_or_b32 v35, 1, v35
    s_mov_b64 exec, 0xff
    buffer_store_dwordx2 v[34:35], v18, s[12:15], s80 offen sc1
    s_mov_b64 exec, -1
    s_setprio 0
f_nkey:
    s_cmp_lg_u32 s55, 0
    s_cbranch_scc1 f_p2w
f_p2d:
    s_barrier
    ds_read_b128 v[88:91], v3 offset:36864
    ds_read_b128 v[92:95], v3 offset:37888
    ds_read_b128 v[96:99], v3 offset:38912
    ds_read_b128 v[100:103], v3 offset:39936
    ds_read_b128 v[120:123], v3 offset:40960
    ds_read_b128 v[124:127], v3 offset:41984
    ds_read_b128 v[128:131], v3 offset:43008
    ds_read_b128 v[132:135], v3 offset:44032
    ds_read_b128 v[136:139], v3 offset:45056
    ds_read_b128 v[140:143], v3 offset:46080
    ds_read_b128 v[144:147], v3 offset:47104
    ds_read_b128 v[148:151], v3 offset:48128
    ds_read_b128 v[104:107], v3 offset:49152
    ds_read_b128 v[108:111], v3 offset:50176
    ds_read_b128 v[112:115], v3 offset:51200
    ds_read_b128 v[116:119], v3 offset:52224
    s_waitcnt lgkmcnt(8)
    ds_read_b128 v[184:187], v3 offset:53248
    ds_read_b128 v[188:191], v3 offset:54272
    ds_read_b128 v[192:195], v3 offset:55296
    ds_read_b128 v[196:199], v3 offset:56320
    ds_read_b128 v[200:203], v3 offset:57344
    ds_read_b128 v[204:207], v3 offset:58368
    ds_read_b128 v[208:211], v3 offset:59392
    ds_read_b128 v[212:215], v3 offset:60416
    s_mov_b32 s62, 0
    v_cmp_lt_u32 vcc, s60, v32
    s_and_b32 s42, vcc_lo, 0xffff
    s_bcnt1_i32_b32 s42, s42
    s_cmp_ge_u32 s42, 2
    s_cbranch_scc1 f_nc0
    s_setprio 2
    s_mov_b32 s62, 1
    s_lshl_b32 s43, s3, 1
    s_add_u32 s42, s42, s43
    s_lshl_b32 s42, s42, 12
    s_add_u32 s42, s42, 18874368
    v_pk_add_f32 v[56:57], v[152:153], s[56:57] op_sel:[0,0] op_sel_hi:[1,0] neg_lo:[0,1] neg_hi:[0,1]
    v_pk_add_f32 v[58:59], v[154:155], s[56:57] op_sel:[0,0] op_sel_hi:[1,0] neg_lo:[0,1] neg_hi:[0,1]
    v_pk_add_f32 v[60:61], v[156:157], s[56:57] op_sel:[0,0] op_sel_hi:[1,0] neg_lo:[0,1] neg_hi:[0,1]
    v_pk_add_f32 v[62:63], v[158:159], s[56:57] op_sel:[0,0] op_sel_hi:[1,0] neg_lo:[0,1] neg_hi:[0,1]
    v_pk_add_f32 v[64:65], v[160:161], s[56:57] op_sel:[0,0] op_sel_hi:[1,0] neg_lo:[0,1] neg_hi:[0,1]
    v_pk_add_f32 v[66:67], v[162:163], s[56:57] op_sel:[0,0] op_sel_hi:[1,0] neg_lo:[0,1] neg_hi:[0,1]
    v_pk_add_f32 v[68:69], v[164:165], s[56:57] op_sel:[0,0] op_sel_hi:[1,0] neg_lo:[0,1] neg_hi:[0,1]
    v_pk_add_f32 v[70:71], v[166:167], s[56:57] op_sel:[0,0] op_sel_hi:[1,0] neg_lo:[0,1] neg_hi:[0,1]
    v_pk_mul_f32 v[56:57], v[56:57], v[88:89]
    v_pk_mul_f32 v[58:59], v[58:59], v[90:91]
    v_pk_mul_f32 v[60:61], v[60:61], v[92:93]
    v_pk_mul_f32 v[62:63], v[62:63], v[94:95]
    v_pk_mul_f32 v[64:65], v[64:65], v[96:97]
    v_pk_mul_f32 v[66:67], v[66:67], v[98:99]
    v_pk_mul_f32 v[68:69], v[68:69], v[100:101]
    v_pk_mul_f32 v[70:71], v[70:71], v[102:103]
    s_waitcnt lgkmcnt(8)
    v_pk_fma_f32 v[56:57], v[56:57], s[56:57], v[136:137] op_sel:[0,1,0] op_sel_hi:[1,1,1]
    v_pk_fma_f32 v[58:59], v[58:59], s[56:57], v[138:139] op_sel:[0,1,0] op_sel_hi:[1,1,1]
    v_pk_fma_f32 v[60:61], v[60:61], s[56:57], v[140:141] op_sel:[0,1,0] op_sel_hi:[1,1,1]
    v_pk_fma_f32 v[62:63], v[62:63], s[56:57], v[142:143] op_sel:[0,1,0] op_sel_hi:[1,1,1]
    v_pk_fma_f32 v[64:65], v[64:65], s[56:57], v[144:145] op_sel:[0,1,0] op_sel_hi:[1,1,1]
    v_pk_fma_f32 v[66:67], v[66:67], s[56:57], v[146:147] op_sel:[0,1,0] op_sel_hi:[1,1,1]
    v_pk_fma_f32 v[68:69], v[68:69], s[56:57], v[148:149] op_sel:[0,1,0] op_sel_hi:[1,1,1]
    v_pk_fma_f32 v[70:71], v[70:71], s[56:57], v[150:151] op_sel:[0,1,0] op_sel_hi:[1,1,1]
    v_cvt_pk_bf16_f32 v40, v56, v57
    v_cvt_pk_bf16_f32 v41, v58, v59
    v_cvt_pk_bf16_f32 v42, v60, v61
    v_cvt_pk_bf16_f32 v43, v62, v63
    v_cvt_pk_bf16_f32 v44, v64, v65
    v_cvt_pk_bf16_f32 v45, v66, v67
    v_cvt_pk_bf16_f32 v46, v68, v69
    v_cvt_pk_bf16_f32 v47, v70, v71
    v_min_u32 v40, -2, v40
    v_min_u32 v41, -2, v41
    v_min_u32 v42, -2, v42
    v_min_u32 v43, -2, v43
    v_min_u32 v44, -2, v44
    v_min_u32 v45, -2, v45
    v_min_u32 v46, -2, v46
    v_min_u32 v47, -2, v47
    buffer_store_dwordx4 v[40:43], v15, s[12:15], s42 offen offset:0 sc1
    buffer_store_dwordx4 v[44:47], v15, s[12:15], s42 offen offset:512 sc1
    s_waitcnt lgkmcnt(0)
    v_pk_fma_f32 v[152:153], v[184:185], v[56:57], v[152:153]
    v_pk_fma_f32 v[154:155], v[186:187], v[58:59], v[154:155]
    v_pk_fma_f32 v[156:157], v[188:189], v[60:61], v[156:157]
    v_pk_fma_f32 v[158:159], v[190:191], v[62:63], v[158:159]
    v_pk_fma_f32 v[160:161], v[192:193], v[64:65], v[160:161]
    v_pk_fma_f32 v[162:163], v[194:195], v[66:67], v[162:163]
    v_pk_fma_f32 v[164:165], v[196:197], v[68:69], v[164:165]
    v_pk_fma_f32 v[166:167], v[198:199], v[70:71], v[166:167]
    v_cvt_pk_bf16_f32 v216, v152, v153
    v_cvt_pk_bf16_f32 v217, v154, v155
    v_cvt_pk_bf16_f32 v218, v156, v157
    v_cvt_pk_bf16_f32 v219, v158, v159
    v_cvt_pk_bf16_f32 v220, v160, v161
    v_cvt_pk_bf16_f32 v221, v162, v163
    v_cvt_pk_bf16_f32 v222, v164, v165
    v_cvt_pk_bf16_f32 v223, v166, v167
    v_min_u32 v40, -2, v216
    v_min_u32 v41, -2, v217
    v_min_u32 v42, -2, v218
    v_min_u32 v43, -2, v219
    v_min_u32 v44, -2, v220
    v_min_u32 v45, -2, v221
    v_min_u32 v46, -2, v222
    v_min_u32 v47, -2, v223
    buffer_store_dwordx4 v[40:43], v15, s[12:15], s42 offen offset:2048 sc1
    buffer_store_dwordx4 v[44:47], v15, s[12:15], s42 offen offset:2560 sc1
    s_setprio 0
f_nc0:
    s_mov_b32 s63, 0
    v_cmp_lt_u32 vcc, s61, v32
    s_and_b32 s42, vcc_lo, 0xffff
    s_bcnt1_i32_b32 s42, s42
    s_cmp_ge_u32 s42, 2
    s_cbranch_scc1 f_nc1
    s_setprio 2
    s_mov_b32 s63, 1
    s_lshl_b32 s43, s3, 1
    s_add_u32 s42, s42, s43
    s_lshl_b32 s42, s42, 12
    s_add_u32 s42, s42, 18874368
    v_pk_add_f32 v[72:73], v[168:169], s[58:59] op_sel:[0,0] op_sel_hi:[1,0] neg_lo:[0,1] neg_hi:[0,1]
    v_pk_add_f32 v[74:75], v[170:171], s[58:59] op_sel:[0,0] op_sel_hi:[1,0] neg_lo:[0,1] neg_hi:[0,1]
    v_pk_add_f32 v[76:77], v[172:173], s[58:59] op_sel:[0,0] op_sel_hi:[1,0] neg_lo:[0,1] neg_hi:[0,1]
    v_pk_add_f32 v[78:79], v[174:175], s[58:59] op_sel:[0,0] op_sel_hi:[1,0] neg_lo:[0,1] neg_hi:[0,1]
    v_pk_add_f32 v[80:81], v[176:177], s[58:59] op_sel:[0,0] op_sel_hi:[1,0] neg_lo:[0,1] neg_hi:[0,1]
    v_pk_add_f32 v[82:83], v[178:179], s[58:59] op_sel:[0,0] op_sel_hi:[1,0] neg_lo:[0,1] neg_hi:[0,1]
    v_pk_add_f32 v[84:85], v[180:181], s[58:59] op_sel:[0,0] op_sel_hi:[1,0] neg_lo:[0,1] neg_hi:[0,1]
    v_pk_add_f32 v[86:87], v[182:183], s[58:59] op_sel:[0,0] op_sel_hi:[1,0] neg_lo:[0,1] neg_hi:[0,1]
    v_pk_mul_f32 v[72:73], v[72:73], v[120:121]
    v_pk_mul_f32 v[74:75], v[74:75], v[122:123]
    v_pk_mul_f32 v[76:77], v[76:77], v[124:125]
    v_pk_mul_f32 v[78:79], v[78:79], v[126:127]
    v_pk_mul_f32 v[80:81], v[80:81], v[128:129]
    v_pk_mul_f32 v[82:83], v[82:83], v[130:131]
    v_pk_mul_f32 v[84:85], v[84:85], v[132:133]
    v_pk_mul_f32 v[86:87], v[86:87], v[134:135]
    s_waitcnt lgkmcnt(8)
    v_pk_fma_f32 v[72:73], v[72:73], s[58:59], v[104:105] op_sel:[0,1,0] op_sel_hi:[1,1,1]
    v_pk_fma_f32 v[74:75], v[74:75], s[58:59], v[106:107] op_sel:[0,1,0] op_sel_hi:[1,1,1]
    v_pk_fma_f32 v[76:77], v[76:77], s[58:59], v[108:109] op_sel:[0,1,0] op_sel_hi:[1,1,1]
    v_pk_fma_f32 v[78:79], v[78:79], s[58:59], v[110:111] op_sel:[0,1,0] op_sel_hi:[1,1,1]
    v_pk_fma_f32 v[80:81], v[80:81], s[58:59], v[112:113] op_sel:[0,1,0] op_sel_hi:[1,1,1]
    v_pk_fma_f32 v[82:83], v[82:83], s[58:59], v[114:115] op_sel:[0,1,0] op_sel_hi:[1,1,1]
    v_pk_fma_f32 v[84:85], v[84:85], s[58:59], v[116:117] op_sel:[0,1,0] op_sel_hi:[1,1,1]
    v_pk_fma_f32 v[86:87], v[86:87], s[58:59], v[118:119] op_sel:[0,1,0] op_sel_hi:[1,1,1]
    v_cvt_pk_bf16_f32 v48, v72, v87
    v_cvt_pk_bf16_f32 v49, v86, v85
    v_cvt_pk_bf16_f32 v50, v84, v83
    v_cvt_pk_bf16_f32 v51, v82, v81
    v_cvt_pk_bf16_f32 v52, v80, v79
    v_cvt_pk_bf16_f32 v53, v78, v77
    v_cvt_pk_bf16_f32 v54, v76, v75
    v_cvt_pk_bf16_f32 v55, v74, v73
    v_min_u32 v48, -2, v48
    v_min_u32 v49, -2, v49
    v_min_u32 v50, -2, v50
    v_min_u32 v51, -2, v51
    v_min_u32 v52, -2, v52
    v_min_u32 v53, -2, v53
    v_min_u32 v54, -2, v54
    v_min_u32 v55, -2, v55
    buffer_store_dwordx4 v[48:51], v16, s[12:15], s42 offen offset:0 sc1
    buffer_store_dwordx4 v[52:55], v16, s[12:15], s42 offen offset:512 sc1
    s_waitcnt lgkmcnt(0)
    v_pk_fma_f32 v[168:169], v[200:201], v[72:73], v[168:169]
    v_pk_fma_f32 v[170:171], v[202:203], v[74:75], v[170:171]
    v_pk_fma_f32 v[172:173], v[204:205], v[76:77], v[172:173]
    v_pk_fma_f32 v[174:175], v[206:207], v[78:79], v[174:175]
    v_pk_fma_f32 v[176:177], v[208:209], v[80:81], v[176:177]
    v_pk_fma_f32 v[178:179], v[210:211], v[82:83], v[178:179]
    v_pk_fma_f32 v[180:181], v[212:213], v[84:85], v[180:181]
    v_pk_fma_f32 v[182:183], v[214:215], v[86:87], v[182:183]
    v_cvt_pk_bf16_f32 v224, v168, v183
    v_cvt_pk_bf16_f32 v225, v182, v181
    v_cvt_pk_bf16_f32 v226, v180, v179
    v_cvt_pk_bf16_f32 v227, v178, v177
    v_cvt_pk_bf16_f32 v228, v176, v175
    v_cvt_pk_bf16_f32 v229, v174, v173
    v_cvt_pk_bf16_f32 v230, v172, v171
    v_cvt_pk_bf16_f32 v231, v170, v169
    v_min_u32 v48, -2, v224
    v_min_u32 v49, -2, v225
    v_min_u32 v50, -2, v226
    v_min_u32 v51, -2, v227
    v_min_u32 v52, -2, v228
    v_min_u32 v53, -2, v229
    v_min_u32 v54, -2, v230
    v_min_u32 v55, -2, v231
    buffer_store_dwordx4 v[48:51], v16, s[12:15], s42 offen offset:2048 sc1
    buffer_store_dwordx4 v[52:55], v16, s[12:15], s42 offen offset:2560 sc1
    s_setprio 0
f_nc1:
    s_cmp_eq_u32 s62, 1
    s_cbranch_scc1 f_op0
    v_pk_add_f32 v[56:57], v[152:153], s[56:57] op_sel:[0,0] op_sel_hi:[1,0] neg_lo:[0,1] neg_hi:[0,1]
    v_pk_add_f32 v[58:59], v[154:155], s[56:57] op_sel:[0,0] op_sel_hi:[1,0] neg_lo:[0,1] neg_hi:[0,1]
    v_pk_add_f32 v[60:61], v[156:157], s[56:57] op_sel:[0,0] op_sel_hi:[1,0] neg_lo:[0,1] neg_hi:[0,1]
    v_pk_add_f32 v[62:63], v[158:159], s[56:57] op_sel:[0,0] op_sel_hi:[1,0] neg_lo:[0,1] neg_hi:[0,1]
    v_pk_add_f32 v[64:65], v[160:161], s[56:57] op_sel:[0,0] op_sel_hi:[1,0] neg_lo:[0,1] neg_hi:[0,1]
    v_pk_add_f32 v[66:67], v[162:163], s[56:57] op_sel:[0,0] op_sel_hi:[1,0] neg_lo:[0,1] neg_hi:[0,1]
    v_pk_add_f32 v[68:69], v[164:165], s[56:57] op_sel:[0,0] op_sel_hi:[1,0] neg_lo:[0,1] neg_hi:[0,1]
    v_pk_add_f32 v[70:71], v[166:167], s[56:57] op_sel:[0,0] op_sel_hi:[1,0] neg_lo:[0,1] neg_hi:[0,1]
    v_pk_mul_f32 v[56:57], v[56:57], v[88:89]
    v_pk_mul_f32 v[58:59], v[58:59], v[90:91]
    v_pk_mul_f32 v[60:61], v[60:61], v[92:93]
    v_pk_mul_f32 v[62:63], v[62:63], v[94:95]
    v_pk_mul_f32 v[64:65], v[64:65], v[96:97]
    v_pk_mul_f32 v[66:67], v[66:67], v[98:99]
    v_pk_mul_f32 v[68:69], v[68:69], v[100:101]
    v_pk_mul_f32 v[70:71], v[70:71], v[102:103]
    s_waitcnt lgkmcnt(8)
    v_pk_fma_f32 v[56:57], v[56:57], s[56:57], v[136:137] op_sel:[0,1,0] op_sel_hi:[1,1,1]
    v_pk_fma_f32 v[58:59], v[58:59], s[56:57], v[138:139] op_sel:[0,1,0] op_sel_hi:[1,1,1]
    v_pk_fma_f32 v[60:61], v[60:61], s[56:57], v[140:141] op_sel:[0,1,0] op_sel_hi:[1,1,1]
    v_pk_fma_f32 v[62:63], v[62:63], s[56:57], v[142:143] op_sel:[0,1,0] op_sel_hi:[1,1,1]
    v_pk_fma_f32 v[64:65], v[64:65], s[56:57], v[144:145] op_sel:[0,1,0] op_sel_hi:[1,1,1]
    v_pk_fma_f32 v[66:67], v[66:67], s[56:57], v[146:147] op_sel:[0,1,0] op_sel_hi:[1,1,1]
    v_pk_fma_f32 v[68:69], v[68:69], s[56:57], v[148:149] op_sel:[0,1,0] op_sel_hi:[1,1,1]
    v_pk_fma_f32 v[70:71], v[70:71], s[56:57], v[150:151] op_sel:[0,1,0] op_sel_hi:[1,1,1]
    s_waitcnt lgkmcnt(0)
    v_pk_fma_f32 v[152:153], v[184:185], v[56:57], v[152:153]
    v_pk_fma_f32 v[154:155], v[186:187], v[58:59], v[154:155]
    v_pk_fma_f32 v[156:157], v[188:189], v[60:61], v[156:157]
    v_pk_fma_f32 v[158:159], v[190:191], v[62:63], v[158:159]
    v_pk_fma_f32 v[160:161], v[192:193], v[64:65], v[160:161]
    v_pk_fma_f32 v[162:163], v[194:195], v[66:67], v[162:163]
    v_pk_fma_f32 v[164:165], v[196:197], v[68:69], v[164:165]
    v_pk_fma_f32 v[166:167], v[198:199], v[70:71], v[166:167]
    v_cvt_pk_bf16_f32 v216, v152, v153
    v_cvt_pk_bf16_f32 v217, v154, v155
    v_cvt_pk_bf16_f32 v218, v156, v157
    v_cvt_pk_bf16_f32 v219, v158, v159
    v_cvt_pk_bf16_f32 v220, v160, v161
    v_cvt_pk_bf16_f32 v221, v162, v163
    v_cvt_pk_bf16_f32 v222, v164, v165
    v_cvt_pk_bf16_f32 v223, v166, v167
f_op0:
    s_cmp_eq_u32 s63, 1
    s_cbranch_scc1 f_op1
    v_pk_add_f32 v[72:73], v[168:169], s[58:59] op_sel:[0,0] op_sel_hi:[1,0] neg_lo:[0,1] neg_hi:[0,1]
    v_pk_add_f32 v[74:75], v[170:171], s[58:59] op_sel:[0,0] op_sel_hi:[1,0] neg_lo:[0,1] neg_hi:[0,1]
    v_pk_add_f32 v[76:77], v[172:173], s[58:59] op_sel:[0,0] op_sel_hi:[1,0] neg_lo:[0,1] neg_hi:[0,1]
    v_pk_add_f32 v[78:79], v[174:175], s[58:59] op_sel:[0,0] op_sel_hi:[1,0] neg_lo:[0,1] neg_hi:[0,1]
    v_pk_add_f32 v[80:81], v[176:177], s[58:59] op_sel:[0,0] op_sel_hi:[1,0] neg_lo:[0,1] neg_hi:[0,1]
    v_pk_add_f32 v[82:83], v[178:179], s[58:59] op_sel:[0,0] op_sel_hi:[1,0] neg_lo:[0,1] neg_hi:[0,1]
    v_pk_add_f32 v[84:85], v[180:181], s[58:59] op_sel:[0,0] op_sel_hi:[1,0] neg_lo:[0,1] neg_hi:[0,1]
    v_pk_add_f32 v[86:87], v[182:183], s[58:59] op_sel:[0,0] op_sel_hi:[1,0] neg_lo:[0,1] neg_hi:[0,1]
    v_pk_mul_f32 v[72:73], v[72:73], v[120:121]
    v_pk_mul_f32 v[74:75], v[74:75], v[122:123]
    v_pk_mul_f32 v[76:77], v[76:77], v[124:125]
    v_pk_mul_f32 v[78:79], v[78:79], v[126:127]
    v_pk_mul_f32 v[80:81], v[80:81], v[128:129]
    v_pk_mul_f32 v[82:83], v[82:83], v[130:131]
    v_pk_mul_f32 v[84:85], v[84:85], v[132:133]
    v_pk_mul_f32 v[86:87], v[86:87], v[134:135]
    s_waitcnt lgkmcnt(8)
    v_pk_fma_f32 v[72:73], v[72:73], s[58:59], v[104:105] op_sel:[0,1,0] op_sel_hi:[1,1,1]
    v_pk_fma_f32 v[74:75], v[74:75], s[58:59], v[106:107] op_sel:[0,1,0] op_sel_hi:[1,1,1]
    v_pk_fma_f32 v[76:77], v[76:77], s[58:59], v[108:109] op_sel:[0,1,0] op_sel_hi:[1,1,1]
    v_pk_fma_f32 v[78:79], v[78:79], s[58:59], v[110:111] op_sel:[0,1,0] op_sel_hi:[1,1,1]
    v_pk_fma_f32 v[80:81], v[80:81], s[58:59], v[112:113] op_sel:[0,1,0] op_sel_hi:[1,1,1]
    v_pk_fma_f32 v[82:83], v[82:83], s[58:59], v[114:115] op_sel:[0,1,0] op_sel_hi:[1,1,1]
    v_pk_fma_f32 v[84:85], v[84:85], s[58:59], v[116:117] op_sel:[0,1,0] op_sel_hi:[1,1,1]
    v_pk_fma_f32 v[86:87], v[86:87], s[58:59], v[118:119] op_sel:[0,1,0] op_sel_hi:[1,1,1]
    s_waitcnt lgkmcnt(0)
    v_pk_fma_f32 v[168:169], v[200:201], v[72:73], v[168:169]
    v_pk_fma_f32 v[170:171], v[202:203], v[74:75], v[170:171]
    v_pk_fma_f32 v[172:173], v[204:205], v[76:77], v[172:173]
    v_pk_fma_f32 v[174:175], v[206:207], v[78:79], v[174:175]
    v_pk_fma_f32 v[176:177], v[208:209], v[80:81], v[176:177]
    v_pk_fma_f32 v[178:179], v[210:211], v[82:83], v[178:179]
    v_pk_fma_f32 v[180:181], v[212:213], v[84:85], v[180:181]
    v_pk_fma_f32 v[182:183], v[214:215], v[86:87], v[182:183]
    v_cvt_pk_bf16_f32 v224, v168, v183
    v_cvt_pk_bf16_f32 v225, v182, v181
    v_cvt_pk_bf16_f32 v226, v180, v179
    v_cvt_pk_bf16_f32 v227, v178, v177
    v_cvt_pk_bf16_f32 v228, v176, v175
    v_cvt_pk_bf16_f32 v229, v174, v173
    v_cvt_pk_bf16_f32 v230, v172, v171
    v_cvt_pk_bf16_f32 v231, v170, v169
f_op1:
    v_add_u32 v7, s68, v3
    ds_write_b128 v13, v[216:219] offset:0
    ds_write_b128 v13, v[220:223] offset:16
    ds_write_b128 v14, v[224:227] offset:2048
    ds_write_b128 v14, v[228:231] offset:2064
    s_waitcnt lgkmcnt(0)
    ds_read_b128 v[232:235], v7 offset:0
    ds_read_b128 v[236:239], v7 offset:1024
    ds_read_b128 v[240:243], v7 offset:2048
    ds_read_b128 v[244:247], v7 offset:3072
    v_mov_b32 v5, 159848
    s_cmp_lg_u32 s16, 0
    s_cbranch_scc1 f_nrs
    s_sleep 8
    s_mov_b32 s83, 0
f_kq:
    buffer_load_dwordx4 v[32:35], v3, s[12:15], s74 offen sc1
    s_waitcnt vmcnt(0)
    v_max3_u32 v4, v32, v33, v34
    v_max_u32 v4, v4, v35
    v_cmp_eq_u32 vcc, -1, v4
    s_cbranch_vccz f_kqx
    s_sleep 4
    s_add_u32 s83, s83, 1
    s_cmp_lt_u32 s83, 0x40000
    s_cbranch_scc1 f_kq
f_kqx:
    v_max_u32 v36, v32, v34
    v_min_u32 v37, v32, v34
    v_max3_u32 v37, v37, v33, v35
    v_mov_b32 v38, v36
    s_nop 1
    v_max_u32_dpp v38, v38, v38 row_ror:8 row_mask:0xf bank_mask:0xf
    s_nop 1
    v_max_u32_dpp v38, v38, v38 row_ror:4 row_mask:0xf bank_mask:0xf
    s_nop 1
    v_max_u32_dpp v38, v38, v38 row_ror:2 row_mask:0xf bank_mask:0xf
    s_nop 1
    v_max_u32_dpp v38, v38, v38 row_ror:1 row_mask:0xf bank_mask:0xf
    s_nop 1
    v_max_u32_dpp v38, v38, v38 row_bcast:15 row_mask:0xa bank_mask:0xf
    s_nop 1
    v_max_u32_dpp v38, v38, v38 row_bcast:31 row_mask:0xc bank_mask:0xf
    s_nop 0
    v_readlane_b32 s40, v38, 63
    s_nop 1
    v_cmp_eq_u32 vcc, s40, v36
    s_nop 1
    v_cndmask_b32 v38, v36, v37, vcc
    s_nop 1
    v_max_u32_dpp v38, v38, v38 row_ror:8 row_mask:0xf bank_mask:0xf
    s_nop 1
    v_max_u32_dpp v38, v38, v38 row_ror:4 row_mask:0xf bank_mask:0xf
    s_nop 1
    v_max_u32_dpp v38, v38, v38 row_ror:2 row_mask:0xf bank_mask:0xf
    s_nop 1
    v_max_u32_dpp v38, v38, v38 row_ror:1 row_mask:0xf bank_mask:0xf
    s_nop 1
    v_max_u32_dpp v38, v38, v38 row_bcast:15 row_mask:0xa bank_mask:0xf
    s_nop 1
    v_max_u32_dpp v38, v38, v38 row_bcast:31 row_mask:0xc bank_mask:0xf
    s_nop 0
    v_readlane_b32 s41, v38, 63
    v_mov_b32 v28, s40
    s_nop 0
    v_mov_b32 v29, s41
    ds_write_b64 v5, v[28:29]
    s_waitcnt lgkmcnt(0)
f_nrs:
    s_barrier
    ds_read_b64 v[28:29], v5
    s_waitcnt lgkmcnt(0)
    v_readfirstlane_b32 s40, v28
    v_readfirstlane_b32 s41, v29
    s_andn2_b32 s40, s40, 1
    s_andn2_b32 s41, s41, 1
    s_cmp_eq_u32 s60, s40
    s_cbranch_scc1 f_e0
    s_cmp_eq_u32 s60, s41
    s_cbranch_scc1 f_e0
    buffer_store_dwordx4 v[232:235], v3, s[24:27], s18 offen offset:0 sc1
    buffer_store_dwordx4 v[236:239], v3, s[24:27], s18 offen offset:1024 sc1
f_e0:
    s_cmp_eq_u32 s61, s40
    s_cbranch_scc1 f_e1
    s_cmp_eq_u32 s61, s41
    s_cbranch_scc1 f_e1
    buffer_store_dwordx4 v[240:243], v3, s[24:27], s19 offen offset:0 sc1
    buffer_store_dwordx4 v[244:247], v3, s[24:27], s19 offen offset:1024 sc1
f_e1:
    s_endpgm
f_zr:
    v_or3_b32 v248, v40, v42, v44
    v_or_b32 v248, v248, v46
    v_and_b32 v248, s54, v248
    v_cmp_ne_u32 vcc, 0, v248
    s_cbranch_vccz f_zr0
    buffer_load_dwordx4 v[24:27], v3, s[12:15], s72 offen offset:0 sc1
f_zr0:
    v_or3_b32 v248, v41, v43, v45
    v_or_b32 v248, v248, v47
    v_and_b32 v248, s54, v248
    v_cmp_ne_u32 vcc, 0, v248
    s_cbranch_vccz f_zr1
    buffer_load_dwordx4 v[28:31], v3, s[12:15], s72 offen offset:1024 sc1
f_zr1:
    v_or3_b32 v248, v48, v50, v52
    v_or_b32 v248, v248, v54
    v_and_b32 v248, s54, v248
    v_cmp_ne_u32 vcc, 0, v248
    s_cbranch_vccz f_zr2
    buffer_load_dwordx4 v[32:35], v3, s[12:15], s72 offen offset:2048 sc1
f_zr2:
    v_or3_b32 v248, v49, v51, v53
    v_or_b32 v248, v248, v55
    v_and_b32 v248, s54, v248
    v_cmp_ne_u32 vcc, 0, v248
    s_cbranch_vccz f_zr3
    buffer_load_dwordx4 v[36:39], v3, s[12:15], s72 offen offset:3072 sc1
f_zr3:
    s_waitcnt vmcnt(0)
    s_add_u32 s83, s83, 1
    s_cmp_lt_u32 s83, 0x40000
    s_cbranch_scc1 f_zc
    s_branch f_zx
f_p2w:
    s_mov_b32 s83, 0
    s_mov_b64 exec, 14
f_p2p:
    buffer_load_dwordx4 v[8:11], v17, s[12:15], s76 offen offset:0 sc1
    s_waitcnt vmcnt(0)
    v_cmp_ne_u64 vcc, s[78:79], v[8:9]
    s_cbranch_vccz f_p2py
    s_and_b32 s42, s83, 7
    s_cmp_lg_u32 s42, 7
    s_cbranch_scc1 f_p2pn
    buffer_load_dwordx4 v[8:11], v17, s[12:15], s76 offen offset:512 sc1
    s_waitcnt vmcnt(0)
    v_cmp_ne_u64 vcc, s[32:33], v[8:9]
    s_cbranch_vccnz f_p2pn
    s_add_u32 s47, s47, 65536
    s_branch f_p2py
f_p2pn:
    s_sleep 1
    s_add_u32 s83, s83, 1
    s_cmp_lt_u32 s83, 0x40000
    s_cbranch_scc1 f_p2p
f_p2py:
    s_mov_b64 exec, -1
    buffer_load_dwordx4 v3, s[12:15], s47 offen offset:0 sc1 lds
    buffer_load_dwordx4 v3, s[12:15], s47 offen offset:1024 sc1 lds
    buffer_load_dwordx4 v3, s[12:15], s47 offen offset:2048 sc1 lds
    s_waitcnt vmcnt(0)
    s_branch f_p2d
f_slow2:
    v_cvt_pk_bf16_f32 v40, v152, v153
    v_lshlrev_b32 v152, 16, v40
    v_and_b32 v153, 0xffff0000, v40
    v_cvt_pk_bf16_f32 v40, v154, v155
    v_lshlrev_b32 v154, 16, v40
    v_and_b32 v155, 0xffff0000, v40
    v_cvt_pk_bf16_f32 v40, v156, v157
    v_lshlrev_b32 v156, 16, v40
    v_and_b32 v157, 0xffff0000, v40
    v_cvt_pk_bf16_f32 v40, v158, v159
    v_lshlrev_b32 v158, 16, v40
    v_and_b32 v159, 0xffff0000, v40
    v_cvt_pk_bf16_f32 v40, v160, v161
    v_lshlrev_b32 v160, 16, v40
    v_and_b32 v161, 0xffff0000, v40
    v_cvt_pk_bf16_f32 v40, v162, v163
    v_lshlrev_b32 v162, 16, v40
    v_and_b32 v163, 0xffff0000, v40
    v_cvt_pk_bf16_f32 v40, v164, v165
    v_lshlrev_b32 v164, 16, v40
    v_and_b32 v165, 0xffff0000, v40
    v_cvt_pk_bf16_f32 v40, v166, v167
    v_lshlrev_b32 v166, 16, v40
    v_and_b32 v167, 0xffff0000, v40
    v_pk_add_f32 v[40:41], v[152:153], v[154:155]
    v_pk_add_f32 v[40:41], v[40:41], v[156:157]
    v_pk_add_f32 v[40:41], v[40:41], v[158:159]
    v_pk_add_f32 v[40:41], v[40:41], v[160:161]
    v_pk_add_f32 v[40:41], v[40:41], v[162:163]
    v_pk_add_f32 v[40:41], v[40:41], v[164:165]
    v_pk_add_f32 v[40:41], v[40:41], v[166:167]
    v_cvt_pk_bf16_f32 v48, v168, v169
    v_lshlrev_b32 v168, 16, v48
    v_and_b32 v169, 0xffff0000, v48
    v_cvt_pk_bf16_f32 v48, v170, v171
    v_lshlrev_b32 v170, 16, v48
    v_and_b32 v171, 0xffff0000, v48
    v_cvt_pk_bf16_f32 v48, v172, v173
    v_lshlrev_b32 v172, 16, v48
    v_and_b32 v173, 0xffff0000, v48
    v_cvt_pk_bf16_f32 v48, v174, v175
    v_lshlrev_b32 v174, 16, v48
    v_and_b32 v175, 0xffff0000, v48
    v_cvt_pk_bf16_f32 v48, v176, v177
    v_lshlrev_b32 v176, 16, v48
    v_and_b32 v177, 0xffff0000, v48
    v_cvt_pk_bf16_f32 v48, v178, v179
    v_lshlrev_b32 v178, 16, v48
    v_and_b32 v179, 0xffff0000, v48
    v_cvt_pk_bf16_f32 v48, v180, v181
    v_lshlrev_b32 v180, 16, v48
    v_and_b32 v181, 0xffff0000, v48
    v_cvt_pk_bf16_f32 v48, v182, v183
    v_lshlrev_b32 v182, 16, v48
    v_and_b32 v183, 0xffff0000, v48
    v_pk_add_f32 v[48:49], v[168:169], v[170:171]
    v_pk_add_f32 v[48:49], v[48:49], v[172:173]
    v_pk_add_f32 v[48:49], v[48:49], v[174:175]
    v_pk_add_f32 v[48:49], v[48:49], v[176:177]
    v_pk_add_f32 v[48:49], v[48:49], v[178:179]
    v_pk_add_f32 v[48:49], v[48:49], v[180:181]
    v_pk_add_f32 v[48:49], v[48:49], v[182:183]
    v_add_f32 v24, v40, v41
    v_add_f32 v28, v48, v49
    s_nop 1
    v_permlane32_swap_b32 v24, v28
    v_add_f32 v24, v24, v28
    s_nop 1
    v_add_f32_dpp v24, v24, v24 row_ror:8 row_mask:0xf bank_mask:0xf
    s_nop 1
    v_add_f32_dpp v24, v24, v24 row_ror:4 row_mask:0xf bank_mask:0xf
    s_nop 1
    v_add_f32_dpp v24, v24, v24 row_ror:2 row_mask:0xf bank_mask:0xf
    s_nop 1
    v_add_f32_dpp v24, v24, v24 row_ror:1 row_mask:0xf bank_mask:0xf
    s_nop 1
    v_add_f32_dpp v24, v24, v24 row_bcast:15 row_mask:0xa bank_mask:0xf
    v_mul_f32 v27, 0x3a800000, v24
    v_cvt_pk_bf16_f32 v24, v27, v27
    v_lshlrev_b32 v24, 16, v24
    v_sub_f32 v27, v27, v24
    v_readlane_b32 s56, v24, 31
    v_readlane_b32 s58, v24, 63
    s_nop 0
    v_pk_add_f32 v[56:57], v[152:153], s[56:57] op_sel:[0,0] op_sel_hi:[1,0] neg_lo:[0,1] neg_hi:[0,1]
    v_pk_add_f32 v[58:59], v[154:155], s[56:57] op_sel:[0,0] op_sel_hi:[1,0] neg_lo:[0,1] neg_hi:[0,1]
    v_pk_add_f32 v[60:61], v[156:157], s[56:57] op_sel:[0,0] op_sel_hi:[1,0] neg_lo:[0,1] neg_hi:[0,1]
    v_pk_add_f32 v[62:63], v[158:159], s[56:57] op_sel:[0,0] op_sel_hi:[1,0] neg_lo:[0,1] neg_hi:[0,1]
    v_pk_add_f32 v[64:65], v[160:161], s[56:57] op_sel:[0,0] op_sel_hi:[1,0] neg_lo:[0,1] neg_hi:[0,1]
    v_pk_add_f32 v[66:67], v[162:163], s[56:57] op_sel:[0,0] op_sel_hi:[1,0] neg_lo:[0,1] neg_hi:[0,1]
    v_pk_add_f32 v[68:69], v[164:165], s[56:57] op_sel:[0,0] op_sel_hi:[1,0] neg_lo:[0,1] neg_hi:[0,1]
    v_pk_add_f32 v[70:71], v[166:167], s[56:57] op_sel:[0,0] op_sel_hi:[1,0] neg_lo:[0,1] neg_hi:[0,1]
    v_pk_add_f32 v[72:73], v[168:169], s[58:59] op_sel:[0,0] op_sel_hi:[1,0] neg_lo:[0,1] neg_hi:[0,1]
    v_pk_add_f32 v[74:75], v[170:171], s[58:59] op_sel:[0,0] op_sel_hi:[1,0] neg_lo:[0,1] neg_hi:[0,1]
    v_pk_add_f32 v[76:77], v[172:173], s[58:59] op_sel:[0,0] op_sel_hi:[1,0] neg_lo:[0,1] neg_hi:[0,1]
    v_pk_add_f32 v[78:79], v[174:175], s[58:59] op_sel:[0,0] op_sel_hi:[1,0] neg_lo:[0,1] neg_hi:[0,1]
    v_pk_add_f32 v[80:81], v[176:177], s[58:59] op_sel:[0,0] op_sel_hi:[1,0] neg_lo:[0,1] neg_hi:[0,1]
    v_pk_add_f32 v[82:83], v[178:179], s[58:59] op_sel:[0,0] op_sel_hi:[1,0] neg_lo:[0,1] neg_hi:[0,1]
    v_pk_add_f32 v[84:85], v[180:181], s[58:59] op_sel:[0,0] op_sel_hi:[1,0] neg_lo:[0,1] neg_hi:[0,1]
    v_pk_add_f32 v[86:87], v[182:183], s[58:59] op_sel:[0,0] op_sel_hi:[1,0] neg_lo:[0,1] neg_hi:[0,1]
    v_mov_b32 v31, v30
    v_pk_mul_f32 v[42:43], v[70:71], v[70:71]
    v_pk_mul_f32 v[44:45], v[70:71], v[230:231]
    v_pk_mul_f32 v[50:51], v[86:87], v[86:87]
    v_pk_mul_f32 v[52:53], v[86:87], v[246:247]
    v_pk_fma_f32 v[42:43], v[68:69], v[68:69], v[42:43]
    v_pk_fma_f32 v[44:45], v[68:69], v[228:229], v[44:45]
    v_pk_fma_f32 v[50:51], v[84:85], v[84:85], v[50:51]
    v_pk_fma_f32 v[52:53], v[84:85], v[244:245], v[52:53]
    v_pk_fma_f32 v[42:43], v[66:67], v[66:67], v[42:43]
    v_pk_fma_f32 v[44:45], v[66:67], v[226:227], v[44:45]
    v_pk_fma_f32 v[50:51], v[82:83], v[82:83], v[50:51]
    v_pk_fma_f32 v[52:53], v[82:83], v[242:243], v[52:53]
    v_pk_fma_f32 v[42:43], v[64:65], v[64:65], v[42:43]
    v_pk_fma_f32 v[44:45], v[64:65], v[224:225], v[44:45]
    v_pk_fma_f32 v[50:51], v[80:81], v[80:81], v[50:51]
    v_pk_fma_f32 v[52:53], v[80:81], v[240:241], v[52:53]
    v_pk_fma_f32 v[42:43], v[62:63], v[62:63], v[42:43]
    v_pk_fma_f32 v[44:45], v[62:63], v[222:223], v[44:45]
    v_pk_fma_f32 v[50:51], v[78:79], v[78:79], v[50:51]
    v_pk_fma_f32 v[52:53], v[78:79], v[238:239], v[52:53]
    v_pk_fma_f32 v[42:43], v[60:61], v[60:61], v[42:43]
    v_pk_fma_f32 v[44:45], v[60:61], v[220:221], v[44:45]
    v_pk_fma_f32 v[50:51], v[76:77], v[76:77], v[50:51]
    v_pk_fma_f32 v[52:53], v[76:77], v[236:237], v[52:53]
    v_pk_fma_f32 v[42:43], v[58:59], v[58:59], v[42:43]
    v_pk_fma_f32 v[44:45], v[58:59], v[218:219], v[44:45]
    v_pk_fma_f32 v[50:51], v[74:75], v[74:75], v[50:51]
    v_pk_fma_f32 v[52:53], v[74:75], v[234:235], v[52:53]
    v_pk_fma_f32 v[42:43], v[56:57], v[56:57], v[42:43]
    v_pk_fma_f32 v[44:45], v[56:57], v[216:217], v[44:45]
    v_pk_fma_f32 v[50:51], v[72:73], v[72:73], v[50:51]
    v_pk_fma_f32 v[52:53], v[72:73], v[232:233], v[52:53]
    v_add_f32 v25, v42, v43
    v_add_f32 v26, v44, v45
    v_add_f32 v29, v50, v51
    v_add_f32 v30, v52, v53
    s_nop 0
    v_permlane32_swap_b32 v25, v29
    v_permlane32_swap_b32 v26, v30
    v_add_f32 v25, v25, v29
    v_add_f32 v26, v26, v30
    s_nop 0
    v_add_f32_dpp v25, v25, v25 row_ror:8 row_mask:0xf bank_mask:0xf
    v_add_f32_dpp v26, v26, v26 row_ror:8 row_mask:0xf bank_mask:0xf
    s_nop 0
    v_add_f32_dpp v25, v25, v25 row_ror:4 row_mask:0xf bank_mask:0xf
    v_add_f32_dpp v26, v26, v26 row_ror:4 row_mask:0xf bank_mask:0xf
    s_nop 0
    v_add_f32_dpp v25, v25, v25 row_ror:2 row_mask:0xf bank_mask:0xf
    v_add_f32_dpp v26, v26, v26 row_ror:2 row_mask:0xf bank_mask:0xf
    s_nop 0
    v_add_f32_dpp v25, v25, v25 row_ror:1 row_mask:0xf bank_mask:0xf
    v_add_f32_dpp v26, v26, v26 row_ror:1 row_mask:0xf bank_mask:0xf
    s_nop 0
    v_add_f32_dpp v25, v25, v25 row_bcast:15 row_mask:0xa bank_mask:0xf
    v_add_f32_dpp v26, v26, v26 row_bcast:15 row_mask:0xa bank_mask:0xf
    v_mul_f32 v25, 0x3a800000, v25
    v_fma_f32 v25, -v27, v27, v25
    v_max_f32 v25, 0, v25
    v_mov_b32 v30, v31
    s_branch f_var2
f_slowvar:
    v_lshlrev_b32 v118, 16, v117
    s_nop 0
    v_readlane_b32 s44, v118, 31
    v_readlane_b32 s46, v118, 63
    v_lshlrev_b32 v120, 16, v64
    v_and_b32 v121, 0xffff0000, v64
    v_pk_add_f32 v[120:121], v[120:121], s[44:45] op_sel_hi:[1,0]
    v_pk_mul_f32 v[122:123], v[120:121], v[120:121]
    v_lshlrev_b32 v120, 16, v65
    v_and_b32 v121, 0xffff0000, v65
    v_pk_add_f32 v[120:121], v[120:121], s[44:45] op_sel_hi:[1,0]
    v_pk_fma_f32 v[122:123], v[120:121], v[120:121], v[122:123]
    v_lshlrev_b32 v120, 16, v66
    v_and_b32 v121, 0xffff0000, v66
    v_pk_add_f32 v[120:121], v[120:121], s[44:45] op_sel_hi:[1,0]
    v_pk_fma_f32 v[122:123], v[120:121], v[120:121], v[122:123]
    v_lshlrev_b32 v120, 16, v67
    v_and_b32 v121, 0xffff0000, v67
    v_pk_add_f32 v[120:121], v[120:121], s[44:45] op_sel_hi:[1,0]
    v_pk_fma_f32 v[122:123], v[120:121], v[120:121], v[122:123]
    v_lshlrev_b32 v120, 16, v68
    v_and_b32 v121, 0xffff0000, v68
    v_pk_add_f32 v[120:121], v[120:121], s[44:45] op_sel_hi:[1,0]
    v_pk_fma_f32 v[122:123], v[120:121], v[120:121], v[122:123]
    v_lshlrev_b32 v120, 16, v69
    v_and_b32 v121, 0xffff0000, v69
    v_pk_add_f32 v[120:121], v[120:121], s[44:45] op_sel_hi:[1,0]
    v_pk_fma_f32 v[122:123], v[120:121], v[120:121], v[122:123]
    v_lshlrev_b32 v120, 16, v70
    v_and_b32 v121, 0xffff0000, v70
    v_pk_add_f32 v[120:121], v[120:121], s[44:45] op_sel_hi:[1,0]
    v_pk_fma_f32 v[122:123], v[120:121], v[120:121], v[122:123]
    v_lshlrev_b32 v120, 16, v71
    v_and_b32 v121, 0xffff0000, v71
    v_pk_add_f32 v[120:121], v[120:121], s[44:45] op_sel_hi:[1,0]
    v_pk_fma_f32 v[122:123], v[120:121], v[120:121], v[122:123]
    v_add_f32 v110, v122, v123
    v_lshlrev_b32 v120, 16, v72
    v_and_b32 v121, 0xffff0000, v72
    v_pk_add_f32 v[120:121], v[120:121], s[46:47] op_sel_hi:[1,0]
    v_pk_mul_f32 v[122:123], v[120:121], v[120:121]
    v_lshlrev_b32 v120, 16, v73
    v_and_b32 v121, 0xffff0000, v73
    v_pk_add_f32 v[120:121], v[120:121], s[46:47] op_sel_hi:[1,0]
    v_pk_fma_f32 v[122:123], v[120:121], v[120:121], v[122:123]
    v_lshlrev_b32 v120, 16, v74
    v_and_b32 v121, 0xffff0000, v74
    v_pk_add_f32 v[120:121], v[120:121], s[46:47] op_sel_hi:[1,0]
    v_pk_fma_f32 v[122:123], v[120:121], v[120:121], v[122:123]
    v_lshlrev_b32 v120, 16, v75
    v_and_b32 v121, 0xffff0000, v75
    v_pk_add_f32 v[120:121], v[120:121], s[46:47] op_sel_hi:[1,0]
    v_pk_fma_f32 v[122:123], v[120:121], v[120:121], v[122:123]
    v_lshlrev_b32 v120, 16, v76
    v_and_b32 v121, 0xffff0000, v76
    v_pk_add_f32 v[120:121], v[120:121], s[46:47] op_sel_hi:[1,0]
    v_pk_fma_f32 v[122:123], v[120:121], v[120:121], v[122:123]
    v_lshlrev_b32 v120, 16, v77
    v_and_b32 v121, 0xffff0000, v77
    v_pk_add_f32 v[120:121], v[120:121], s[46:47] op_sel_hi:[1,0]
    v_pk_fma_f32 v[122:123], v[120:121], v[120:121], v[122:123]
    v_lshlrev_b32 v120, 16, v78
    v_and_b32 v121, 0xffff0000, v78
    v_pk_add_f32 v[120:121], v[120:121], s[46:47] op_sel_hi:[1,0]
    v_pk_fma_f32 v[122:123], v[120:121], v[120:121], v[122:123]
    v_lshlrev_b32 v120, 16, v79
    v_and_b32 v121, 0xffff0000, v79
    v_pk_add_f32 v[120:121], v[120:121], s[46:47] op_sel_hi:[1,0]
    v_pk_fma_f32 v[122:123], v[120:121], v[120:121], v[122:123]
    v_add_f32 v111, v122, v123
    v_add_f32 v118, v118, v108
    s_nop 0
    v_permlane32_swap_b32 v110, v111
    v_add_f32 v110, v110, v111
    s_nop 1
    v_add_f32_dpp v110, v110, v110 row_ror:8 row_mask:0xf bank_mask:0xf
    s_nop 1
    v_add_f32_dpp v110, v110, v110 row_ror:4 row_mask:0xf bank_mask:0xf
    s_nop 1
    v_add_f32_dpp v110, v110, v110 row_ror:2 row_mask:0xf bank_mask:0xf
    s_nop 1
    v_add_f32_dpp v110, v110, v110 row_ror:1 row_mask:0xf bank_mask:0xf
    s_nop 1
    v_add_f32_dpp v110, v110, v110 row_bcast:15 row_mask:0xa bank_mask:0xf
    v_mul_f32 v110, s5, v110
    v_fma_f32 v110, -v118, v118, v110
    v_max_f32 v110, 0, v110
    s_branch f_var
f_sp:
    s_setprio 2
    ds_read_b128 v[56:59], v3 offset:18432
    ds_read_b128 v[60:63], v3 offset:19456
    s_waitcnt lgkmcnt(2)
    v_pk_mul_f16 v40, v24, v248 op_sel:[0,0] op_sel_hi:[1,0]
    v_pk_mul_f16 v41, v25, v248 op_sel:[0,1] op_sel_hi:[1,1]
    v_pk_mul_f16 v42, v26, v249 op_sel:[0,0] op_sel_hi:[1,0]
    v_pk_mul_f16 v43, v27, v249 op_sel:[0,1] op_sel_hi:[1,1]
    v_pk_mul_f16 v44, v28, v250 op_sel:[0,0] op_sel_hi:[1,0]
    v_pk_mul_f16 v45, v29, v250 op_sel:[0,1] op_sel_hi:[1,1]
    v_pk_mul_f16 v46, v30, v251 op_sel:[0,0] op_sel_hi:[1,0]
    v_pk_mul_f16 v47, v31, v251 op_sel:[0,1] op_sel_hi:[1,1]
    v_pk_mul_f16 v48, v32, v252 op_sel:[0,0] op_sel_hi:[1,0]
    v_pk_mul_f16 v49, v33, v252 op_sel:[0,1] op_sel_hi:[1,1]
    v_pk_mul_f16 v50, v34, v253 op_sel:[0,0] op_sel_hi:[1,0]
    v_pk_mul_f16 v51, v35, v253 op_sel:[0,1] op_sel_hi:[1,1]
    v_pk_mul_f16 v52, v36, v254 op_sel:[0,0] op_sel_hi:[1,0]
    v_pk_mul_f16 v53, v37, v254 op_sel:[0,1] op_sel_hi:[1,1]
    v_pk_mul_f16 v54, v38, v255 op_sel:[0,0] op_sel_hi:[1,0]
    v_pk_mul_f16 v55, v39, v255 op_sel:[0,1] op_sel_hi:[1,1]
    s_waitcnt lgkmcnt(0)
    v_and_b32 v24, 0xffff, v56
    v_lshrrev_b32 v32, 16, v56
    v_and_b32 v25, 0xffff, v57
    v_lshrrev_b32 v33, 16, v57
    v_and_b32 v26, 0xffff, v58
    v_lshrrev_b32 v34, 16, v58
    v_and_b32 v27, 0xffff, v59
    v_lshrrev_b32 v35, 16, v59
    v_and_b32 v28, 0xffff, v60
    v_lshrrev_b32 v36, 16, v60
    v_and_b32 v29, 0xffff, v61
    v_lshrrev_b32 v37, 16, v61
    v_and_b32 v30, 0xffff, v62
    v_lshrrev_b32 v38, 16, v62
    v_and_b32 v31, 0xffff, v63
    v_lshrrev_b32 v39, 16, v63
    v_pk_add_f16 v40, v40, v24
    v_pk_add_f16 v41, v41, v32
    v_pk_add_f16 v42, v42, v25
    v_pk_add_f16 v43, v43, v33
    v_pk_add_f16 v44, v44, v26
    v_pk_add_f16 v45, v45, v34
    v_pk_add_f16 v46, v46, v27
    v_pk_add_f16 v47, v47, v35
    v_pk_add_f16 v48, v48, v28
    v_pk_add_f16 v49, v49, v36
    v_pk_add_f16 v50, v50, v29
    v_pk_add_f16 v51, v51, v37
    v_pk_add_f16 v52, v52, v30
    v_pk_add_f16 v53, v53, v38
    v_pk_add_f16 v54, v54, v31
    v_pk_add_f16 v55, v55, v39
    v_mfma_f32_32x32x16_f16 v[56:71], v[40:43], v[88:91], 0
    v_mfma_f32_32x32x16_f16 v[72:87], v[40:43], v[104:107], 0
    v_mfma_f32_32x32x16_f16 v[56:71], v[44:47], v[92:95], v[56:71]
    v_mfma_f32_32x32x16_f16 v[72:87], v[44:47], v[108:111], v[72:87]
    s_branch f_st1
f_sp2:
    s_nop 9
    v_pk_mul_f32 v[24:25], v[56:57], v[120:121]
    v_pk_mul_f32 v[28:29], v[72:73], v[120:121]
    v_pk_mul_f32 v[26:27], v[58:59], v[122:123]
    v_pk_mul_f32 v[30:31], v[74:75], v[122:123]
    v_pk_fma_f32 v[24:25], v[72:73], v[136:137], v[24:25]
    v_pk_fma_f32 v[28:29], v[56:57], v[136:137], v[28:29] neg_lo:[1,0,0] neg_hi:[1,0,0]
    v_pk_fma_f32 v[26:27], v[74:75], v[138:139], v[26:27]
    v_pk_fma_f32 v[30:31], v[58:59], v[138:139], v[30:31] neg_lo:[1,0,0] neg_hi:[1,0,0]
    v_cvt_pk_f16_f32 v40, v24, v28
    v_cvt_pk_f16_f32 v41, v25, v29
    v_cvt_pk_f16_f32 v42, v26, v30
    v_cvt_pk_f16_f32 v43, v27, v31
    v_pk_mul_f32 v[32:33], v[60:61], v[124:125]
    v_pk_mul_f32 v[36:37], v[76:77], v[124:125]
    v_pk_mul_f32 v[34:35], v[62:63], v[126:127]
    v_pk_mul_f32 v[38:39], v[78:79], v[126:127]
    v_pk_fma_f32 v[32:33], v[76:77], v[140:141], v[32:33]
    v_pk_fma_f32 v[36:37], v[60:61], v[140:141], v[36:37] neg_lo:[1,0,0] neg_hi:[1,0,0]
    v_pk_fma_f32 v[34:35], v[78:79], v[142:143], v[34:35]
    v_pk_fma_f32 v[38:39], v[62:63], v[142:143], v[38:39] neg_lo:[1,0,0] neg_hi:[1,0,0]
    v_cvt_pk_f16_f32 v44, v32, v36
    v_cvt_pk_f16_f32 v45, v33, v37
    v_cvt_pk_f16_f32 v46, v34, v38
    v_cvt_pk_f16_f32 v47, v35, v39
    v_pk_mul_f32 v[24:25], v[64:65], v[128:129]
    v_pk_mul_f32 v[28:29], v[80:81], v[128:129]
    v_pk_mul_f32 v[26:27], v[66:67], v[130:131]
    v_pk_mul_f32 v[30:31], v[82:83], v[130:131]
    v_pk_fma_f32 v[24:25], v[80:81], v[144:145], v[24:25]
    v_pk_fma_f32 v[28:29], v[64:65], v[144:145], v[28:29] neg_lo:[1,0,0] neg_hi:[1,0,0]
    v_pk_fma_f32 v[26:27], v[82:83], v[146:147], v[26:27]
    v_pk_fma_f32 v[30:31], v[66:67], v[146:147], v[30:31] neg_lo:[1,0,0] neg_hi:[1,0,0]
    v_cvt_pk_f16_f32 v48, v24, v28
    v_cvt_pk_f16_f32 v49, v25, v29
    v_cvt_pk_f16_f32 v50, v26, v30
    v_cvt_pk_f16_f32 v51, v27, v31
    v_pk_mul_f32 v[32:33], v[68:69], v[132:133]
    v_pk_mul_f32 v[36:37], v[84:85], v[132:133]
    v_pk_mul_f32 v[34:35], v[70:71], v[134:135]
    v_pk_mul_f32 v[38:39], v[86:87], v[134:135]
    v_pk_fma_f32 v[32:33], v[84:85], v[148:149], v[32:33]
    v_pk_fma_f32 v[36:37], v[68:69], v[148:149], v[36:37] neg_lo:[1,0,0] neg_hi:[1,0,0]
    v_pk_fma_f32 v[34:35], v[86:87], v[150:151], v[34:35]
    v_pk_fma_f32 v[38:39], v[70:71], v[150:151], v[38:39] neg_lo:[1,0,0] neg_hi:[1,0,0]
    v_cvt_pk_f16_f32 v52, v32, v36
    v_cvt_pk_f16_f32 v53, v33, v37
    v_cvt_pk_f16_f32 v54, v34, v38
    v_cvt_pk_f16_f32 v55, v35, v39
    v_mfma_f32_32x32x16_f16 v[120:135], v[40:43], v[88:91], 0
    v_mfma_f32_32x32x16_f16 v[120:135], v[44:47], v[92:95], v[120:135]
    v_mfma_f32_32x32x16_f16 v[120:135], v[48:51], v[96:99], v[120:135]
    v_mfma_f32_32x32x16_f16 v[120:135], v[52:55], v[100:103], v[120:135]
    v_mfma_f32_32x32x16_f16 v[136:151], v[40:43], v[104:107], 0
    v_mfma_f32_32x32x16_f16 v[136:151], v[44:47], v[108:111], v[136:151]
    v_mfma_f32_32x32x16_f16 v[136:151], v[48:51], v[112:115], v[136:151]
    v_mfma_f32_32x32x16_f16 v[136:151], v[52:55], v[116:119], v[136:151]
    v_subrev_u32 v249, s68, v13
    v_subrev_u32 v250, s68, v14
    v_lshlrev_b32 v249, 1, v249
    v_lshlrev_b32 v250, 1, v250
    v_sub_u32 v251, 4096, v249
    v_and_b32 v251, 4095, v251
    v_add_u32 v249, 94208, v249
    v_add_u32 v250, 94208, v250
    v_add_u32 v251, 94208, v251
    ds_write_b128 v249, v[120:123] offset:0
    ds_write_b128 v249, v[124:127] offset:16
    ds_write_b128 v249, v[128:131] offset:32
    ds_write_b128 v249, v[132:135] offset:48
    ds_write_b128 v249, v[136:139] offset:4096
    ds_write_b128 v249, v[140:143] offset:4112
    ds_write_b128 v249, v[144:147] offset:4128
    ds_write_b128 v249, v[148:151] offset:4144
    s_waitcnt lgkmcnt(0)
    ds_read_b128 v[56:59], v250 offset:0
    ds_read_b128 v[60:63], v250 offset:16
    ds_read_b128 v[64:67], v250 offset:32
    ds_read_b128 v[68:71], v250 offset:48
    ds_read_b128 v[72:75], v250 offset:4096
    ds_read_b128 v[76:79], v250 offset:4112
    ds_read_b128 v[80:83], v250 offset:4128
    ds_read_b128 v[84:87], v250 offset:4144
    s_waitcnt lgkmcnt(0)
    ds_read_b32 v56, v251 offset:0
    ds_read_b32 v72, v251 offset:4096
    v_add_f32 v121, v121, v71
    v_add_f32 v122, v122, v70
    v_add_f32 v123, v123, v69
    v_add_f32 v124, v124, v68
    v_add_f32 v125, v125, v67
    v_add_f32 v126, v126, v66
    v_add_f32 v127, v127, v65
    v_add_f32 v128, v128, v64
    v_add_f32 v129, v129, v63
    v_add_f32 v130, v130, v62
    v_add_f32 v131, v131, v61
    v_add_f32 v132, v132, v60
    v_add_f32 v133, v133, v59
    v_add_f32 v134, v134, v58
    v_add_f32 v135, v135, v57
    v_add_f32 v137, v137, v87
    v_add_f32 v138, v138, v86
    v_add_f32 v139, v139, v85
    v_add_f32 v140, v140, v84
    v_add_f32 v141, v141, v83
    v_add_f32 v142, v142, v82
    v_add_f32 v143, v143, v81
    v_add_f32 v144, v144, v80
    v_add_f32 v145, v145, v79
    v_add_f32 v146, v146, v78
    v_add_f32 v147, v147, v77
    v_add_f32 v148, v148, v76
    v_add_f32 v149, v149, v75
    v_add_f32 v150, v150, v74
    v_add_f32 v151, v151, v73
    s_waitcnt lgkmcnt(0)
    v_add_f32 v120, v120, v56
    v_add_f32 v136, v136, v72
    ds_bpermute_b32 v248, v19, v136
    s_waitcnt lgkmcnt(1)
    v_pk_fma_f32 v[152:153], v[184:185], v[120:121], v[152:153]
    v_pk_fma_f32 v[154:155], v[186:187], v[122:123], v[154:155]
    v_pk_fma_f32 v[156:157], v[188:189], v[124:125], v[156:157]
    v_pk_fma_f32 v[158:159], v[190:191], v[126:127], v[158:159]
    v_pk_fma_f32 v[160:161], v[192:193], v[128:129], v[160:161]
    v_pk_fma_f32 v[162:163], v[194:195], v[130:131], v[162:163]
    v_pk_fma_f32 v[164:165], v[196:197], v[132:133], v[164:165]
    v_pk_fma_f32 v[166:167], v[198:199], v[134:135], v[166:167]
    v_pk_fma_f32 v[170:171], v[202:203], v[138:139], v[170:171]
    v_pk_fma_f32 v[172:173], v[204:205], v[140:141], v[172:173]
    v_pk_fma_f32 v[174:175], v[206:207], v[142:143], v[174:175]
    v_pk_fma_f32 v[176:177], v[208:209], v[144:145], v[176:177]
    v_pk_fma_f32 v[178:179], v[210:211], v[146:147], v[178:179]
    v_pk_fma_f32 v[180:181], v[212:213], v[148:149], v[180:181]
    v_pk_fma_f32 v[182:183], v[214:215], v[150:151], v[182:183]
    v_fmac_f32 v169, v201, v137
    s_waitcnt lgkmcnt(0)
    v_fmac_f32 v168, v200, v248
    s_setprio 0
    s_branch f_join
k_done:
    s_endpgm
code_end:
.p2align 8
.type tables,@object
tables:
.long 0x3c00,0x3c00,0x3c00,0x3c00,0x3c00,0x323e3bd9,0x361f3b64,0x38723aa7
.long 0x3c00,0x361f3b64,0x39a839a8,0x3b64361f,0x3c00,0x38723aa7,0x3b64361f,0x3bd9b23e
.long 0x3c00,0xbc00,0x3c00,0xbc00,0x3c00,0xb23ebbd9,0x361f3b64,0xb872baa7
.long 0x3c00,0xb61fbb64,0x39a839a8,0xbb64b61f,0x3c00,0xb872baa7,0x3b64361f,0xbbd9323e
.long 0x3c00,0x39a839a8,0x3c000000,0x39a8b9a8,0x3c00,0x3aa73872,0x3b64b61f,0x323ebbd9
.long 0x3c00,0x3b64361f,0x39a8b9a8,0xb61fbb64,0x3c00,0x3bd9323e,0x361fbb64,0xbaa7b872
.long 0x3c00,0xb9a8b9a8,0x3c000000,0xb9a839a8,0x3c00,0xbaa7b872,0x3b64b61f,0xb23e3bd9
.long 0x3c00,0xbb64b61f,0x39a8b9a8,0x361f3b64,0x3c00,0xbbd9b23e,0x361fbb64,0x3aa73872
.long 0x3c00,0x3c000000,0xbc00,0xbc008000,0x3c00,0x3bd9b23e,0xb61fbb64,0xbaa73872
.long 0x3c00,0x3b64b61f,0xb9a8b9a8,0xb61f3b64,0x3c00,0x3aa7b872,0xbb64b61f,0x323e3bd9
.long 0x3c00,0xbc008000,0xbc00,0x3c000000,0x3c00,0xbbd9323e,0xb61fbb64,0x3aa7b872
.long 0x3c00,0xbb64361f,0xb9a8b9a8,0x361fbb64,0x3c00,0xbaa73872,0xbb64b61f,0xb23ebbd9
.long 0x3c00,0x39a8b9a8,0xbc008000,0x39a839a8,0x3c00,0x3872baa7,0xbb64361f,0x3bd9323e
.long 0x3c00,0x361fbb64,0xb9a839a8,0x3b64b61f,0x3c00,0x323ebbd9,0xb61f3b64,0x3872baa7
.long 0x3c00,0xb9a839a8,0xbc008000,0xb9a8b9a8,0x3c00,0xb8723aa7,0xbb64361f,0xbbd9b23e
.long 0x3c00,0xb61f3b64,0xb9a839a8,0xbb64361f,0x3c00,0xb23e3bd9,0xb61f3b64,0xb8723aa7
.long 0x3c00,0x3c00,0x3c00,0x3c00,0x39a839a8,0x3aa73872,0x3b64361f,0x3bd9323e
.long 0x3c000000,0x3b64b61f,0x39a8b9a8,0x361fbb64,0x39a8b9a8,0x323ebbd9,0xb61fbb64,0xbaa7b872
.long 0x3c00,0xbc00,0x3c00,0xbc00,0x39a839a8,0xbaa7b872,0x3b64361f,0xbbd9b23e
.long 0x3c000000,0xbb64361f,0x39a8b9a8,0xb61f3b64,0x39a8b9a8,0xb23e3bd9,0xb61fbb64,0x3aa73872
.long 0xbc00,0xb9a8b9a8,0xbc008000,0xb9a839a8,0xb9a8b9a8,0xbbd9323e,0xb61f3b64,0x38723aa7
.long 0xbc008000,0xb61f3b64,0x39a839a8,0x3b64b61f,0xb9a839a8,0x38723aa7,0x3b64b61f,0xb23ebbd9
.long 0xbc00,0x39a839a8,0xbc008000,0x39a8b9a8,0xb9a8b9a8,0x3bd9b23e,0xb61f3b64,0xb872baa7
.long 0xbc008000,0x361fbb64,0x39a839a8,0xbb64361f,0xb9a839a8,0xb872baa7,0x3b64b61f,0x323e3bd9
.long 0x3c00,0x3c000000,0xbc00,0xbc008000,0x39a839a8,0x3872baa7,0xbb64b61f,0xb23e3bd9
.long 0x3c000000,0xb61fbb64,0xb9a839a8,0x3b64361f,0x39a8b9a8,0xbbd9b23e,0x361f3b64,0x3872baa7
.long 0x3c00,0xbc008000,0xbc00,0x3c000000,0x39a839a8,0xb8723aa7,0xbb64b61f,0x323ebbd9
.long 0x3c000000,0x361f3b64,0xb9a839a8,0xbb64b61f,0x39a8b9a8,0x3bd9323e,0x361f3b64,0xb8723aa7
.long 0xbc00,0xb9a839a8,0x3c000000,0xb9a8b9a8,0xb9a8b9a8,0x323e3bd9,0x361fbb64,0xbaa73872
.long 0xbc008000,0x3b64361f,0xb9a8b9a8,0x361f3b64,0xb9a839a8,0x3aa7b872,0xbb64361f,0x3bd9b23e
.long 0xbc00,0x39a8b9a8,0x3c000000,0x39a839a8,0xb9a8b9a8,0xb23ebbd9,0x361fbb64,0x3aa7b872
.long 0xbc008000,0xbb64b61f,0xb9a8b9a8,0xb61fbb64,0xb9a839a8,0xbaa73872,0xbb64361f,0xbbd9323e
.long 0x3c00,0x3c00,0x3c00,0x3c00,0x3c000000,0x3bd9b23e,0x3b64b61f,0x3aa7b872
.long 0xbc00,0xb61fbb64,0xb9a8b9a8,0xbb64b61f,0xbc008000,0xbaa73872,0xb61f3b64,0x323e3bd9
.long 0x3c00,0xbc00,0x3c00,0xbc00,0x3c000000,0xbbd9323e,0x3b64b61f,0xbaa73872
.long 0xbc00,0x361f3b64,0xb9a8b9a8,0x3b64361f,0xbc008000,0x3aa7b872,0xb61f3b64,0xb23ebbd9
.long 0x3c00,0x39a839a8,0x3c000000,0x39a8b9a8,0x3c000000,0x3872baa7,0xb61fbb64,0xbbd9b23e
.long 0xbc00,0xbb64b61f,0xb9a839a8,0x361f3b64,0xbc008000,0xb23e3bd9,0x3b64361f,0x3872baa7
.long 0x3c00,0xb9a8b9a8,0x3c000000,0xb9a839a8,0x3c000000,0xb8723aa7,0xb61fbb64,0x3bd9323e
.long 0xbc00,0x3b64361f,0xb9a839a8,0xb61fbb64,0xbc008000,0x323ebbd9,0x3b64361f,0xb8723aa7
.long 0x3c00,0x3c000000,0xbc00,0xbc008000,0x3c000000,0xb23ebbd9,0xbb64361f,0x38723aa7
.long 0xbc00,0xbb64361f,0x39a839a8,0x361fbb64,0xbc008000,0x38723aa7,0x361fbb64,0xbbd9323e
.long 0x3c00,0xbc008000,0xbc00,0x3c000000,0x3c000000,0x323e3bd9,0xbb64361f,0xb872baa7
.long 0xbc00,0x3b64b61f,0x39a839a8,0xb61f3b64,0xbc008000,0xb872baa7,0x361fbb64,0x3bd9b23e
.long 0x3c00,0x39a8b9a8,0xbc008000,0x39a839a8,0x3c000000,0xbaa7b872,0x361f3b64,0x323ebbd9
.long 0xbc00,0xb61f3b64,0x39a8b9a8,0xbb64361f,0xbc008000,0x3bd9323e,0xbb64b61f,0x3aa73872
.long 0x3c00,0xb9a839a8,0xbc008000,0xb9a8b9a8,0x3c000000,0x3aa73872,0x361f3b64,0xb23e3bd9
.long 0xbc00,0x361fbb64,0x39a8b9a8,0x3b64b61f,0xbc008000,0xbbd9b23e,0xbb64b61f,0xbaa7b872
.long 0x3c00,0x3c00,0x3c00,0x3c00,0x39a8b9a8,0x3872baa7,0x361fbb64,0x323ebbd9
.long 0xbc008000,0xbb64361f,0xb9a839a8,0xb61f3b64,0x39a839a8,0x3bd9323e,0x3b64b61f,0x3872baa7
.long 0x3c00,0xbc00,0x3c00,0xbc00,0x39a8b9a8,0xb8723aa7,0x361fbb64,0xb23e3bd9
.long 0xbc008000,0x3b64b61f,0xb9a839a8,0x361fbb64,0x39a839a8,0xbbd9b23e,0x3b64b61f,0xb8723aa7
.long 0xbc00,0xb9a8b9a8,0xbc008000,0xb9a839a8,0xb9a839a8,0x323e3bd9,0x3b64361f,0x3aa7b872
.long 0x3c000000,0x361fbb64,0xb9a8b9a8,0xbb64361f,0xb9a8b9a8,0xbaa73872,0x361f3b64,0x3bd9b23e
.long 0xbc00,0x39a839a8,0xbc008000,0x39a8b9a8,0xb9a839a8,0xb23ebbd9,0x3b64361f,0xbaa73872
.long 0x3c000000,0xb61f3b64,0xb9a8b9a8,0x3b64b61f,0xb9a8b9a8,0x3aa7b872,0x361f3b64,0xbbd9323e
.long 0x3c00,0x3c000000,0xbc00,0xbc008000,0x39a8b9a8,0xbaa7b872,0xb61f3b64,0x3bd9323e
.long 0xbc008000,0x361f3b64,0x39a8b9a8,0xbb64b61f,0x39a839a8,0x323ebbd9,0xbb64361f,0x3aa73872
.long 0x3c00,0xbc008000,0xbc00,0x3c000000,0x39a8b9a8,0x3aa73872,0xb61f3b64,0xbbd9b23e
.long 0xbc008000,0xb61fbb64,0x39a8b9a8,0x3b64361f,0x39a839a8,0xb23e3bd9,0xbb64361f,0xbaa7b872
.long 0xbc00,0xb9a839a8,0x3c000000,0xb9a8b9a8,0xb9a839a8,0x3bd9b23e,0xbb64b61f,0x38723aa7
.long 0x3c000000,0xbb64b61f,0x39a839a8,0xb61fbb64,0xb9a8b9a8,0x38723aa7,0xb61fbb64,0x323e3bd9
.long 0xbc00,0x39a8b9a8,0x3c000000,0x39a839a8,0xb9a839a8,0xbbd9323e,0xbb64b61f,0xb872baa7
.long 0x3c000000,0x3b64361f,0x39a839a8,0x361f3b64,0xb9a8b9a8,0xb872baa7,0xb61fbb64,0xb23ebbd9
.long 0x3c00,0x3c00,0x3c00,0x3c00,0xbc00,0xb23ebbd9,0xb61fbb64,0xb872baa7
.long 0x3c00,0x361f3b64,0x39a839a8,0x3b64361f,0xbc00,0xb872baa7,0xbb64b61f,0xbbd9323e
.long 0x3c00,0xbc00,0x3c00,0xbc00,0xbc00,0x323e3bd9,0xb61fbb64,0x38723aa7
.long 0x3c00,0xb61fbb64,0x39a839a8,0xbb64b61f,0xbc00,0x38723aa7,0xbb64b61f,0x3bd9b23e
.long 0x3c00,0x39a839a8,0x3c000000,0x39a8b9a8,0xbc00,0xbaa7b872,0xbb64361f,0xb23e3bd9
.long 0x3c00,0x3b64361f,0x39a8b9a8,0xb61fbb64,0xbc00,0xbbd9b23e,0xb61f3b64,0x3aa73872
.long 0x3c00,0xb9a8b9a8,0x3c000000,0xb9a839a8,0xbc00,0x3aa73872,0xbb64361f,0x323ebbd9
.long 0x3c00,0xbb64b61f,0x39a8b9a8,0x361f3b64,0xbc00,0x3bd9323e,0xb61f3b64,0xbaa7b872
.long 0x3c00,0x3c000000,0xbc00,0xbc008000,0xbc00,0xbbd9323e,0x361f3b64,0x3aa7b872
.long 0x3c00,0x3b64b61f,0xb9a8b9a8,0xb61f3b64,0xbc00,0xbaa73872,0x3b64361f,0xb23ebbd9
.long 0x3c00,0xbc008000,0xbc00,0x3c000000,0xbc00,0x3bd9b23e,0x361f3b64,0xbaa73872
.long 0x3c00,0xbb64361f,0xb9a8b9a8,0x361fbb64,0xbc00,0x3aa7b872,0x3b64361f,0x323e3bd9
.long 0x3c00,0x39a8b9a8,0xbc008000,0x39a839a8,0xbc00,0xb8723aa7,0x3b64b61f,0xbbd9b23e
.long 0x3c00,0x361fbb64,0xb9a839a8,0x3b64b61f,0xbc00,0xb23e3bd9,0x361fbb64,0xb8723aa7
.long 0x3c00,0xb9a839a8,0xbc008000,0xb9a8b9a8,0xbc00,0x3872baa7,0x3b64b61f,0x3bd9323e
.long 0x3c00,0xb61f3b64,0xb9a839a8,0xbb64361f,0xbc00,0x323ebbd9,0x361fbb64,0x3872baa7
.long 0x3c00,0x3c00,0x3c00,0x3c00,0xb9a8b9a8,0xbaa7b872,0xbb64b61f,0xbbd9b23e
.long 0x3c000000,0x3b64b61f,0x39a8b9a8,0x361fbb64,0xb9a839a8,0xb23e3bd9,0x361f3b64,0x3aa73872
.long 0x3c00,0xbc00,0x3c00,0xbc00,0xb9a8b9a8,0x3aa73872,0xbb64b61f,0x3bd9323e
.long 0x3c000000,0xbb64361f,0x39a8b9a8,0xb61f3b64,0xb9a839a8,0x323ebbd9,0x361f3b64,0xbaa7b872
.long 0xbc00,0xb9a8b9a8,0xbc008000,0xb9a839a8,0x39a839a8,0x3bd9b23e,0x361fbb64,0xb872baa7
.long 0xbc008000,0xb61f3b64,0x39a839a8,0x3b64b61f,0x39a8b9a8,0xb872baa7,0xbb64361f,0x323e3bd9
.long 0xbc00,0x39a839a8,0xbc008000,0x39a8b9a8,0x39a839a8,0xbbd9323e,0x361fbb64,0x38723aa7
.long 0xbc008000,0x361fbb64,0x39a839a8,0xbb64361f,0x39a8b9a8,0x38723aa7,0xbb64361f,0xb23ebbd9
.long 0x3c00,0x3c000000,0xbc00,0xbc008000,0xb9a8b9a8,0xb8723aa7,0x3b64361f,0x323ebbd9
.long 0x3c000000,0xb61fbb64,0xb9a839a8,0x3b64361f,0xb9a839a8,0x3bd9323e,0xb61fbb64,0xb8723aa7
.long 0x3c00,0xbc008000,0xbc00,0x3c000000,0xb9a8b9a8,0x3872baa7,0x3b64361f,0xb23e3bd9
.long 0x3c000000,0x361f3b64,0xb9a839a8,0xbb64b61f,0xb9a839a8,0xbbd9b23e,0xb61fbb64,0x3872baa7
.long 0xbc00,0xb9a839a8,0x3c000000,0xb9a8b9a8,0x39a839a8,0xb23ebbd9,0xb61f3b64,0x3aa7b872
.long 0xbc008000,0x3b64361f,0xb9a8b9a8,0x361f3b64,0x39a8b9a8,0xbaa73872,0x3b64b61f,0xbbd9323e
.long 0xbc00,0x39a8b9a8,0x3c000000,0x39a839a8,0x39a839a8,0x323e3bd9,0xb61f3b64,0xbaa73872
.long 0xbc008000,0xbb64b61f,0xb9a8b9a8,0xb61fbb64,0x39a8b9a8,0x3aa7b872,0x3b64b61f,0x3bd9b23e
.long 0x3c00,0x3c00,0x3c00,0x3c00,0xbc008000,0xbbd9323e,0xbb64361f,0xbaa73872
.long 0xbc00,0xb61fbb64,0xb9a8b9a8,0xbb64b61f,0x3c000000,0x3aa7b872,0x361fbb64,0xb23ebbd9
.long 0x3c00,0xbc00,0x3c00,0xbc00,0xbc008000,0x3bd9b23e,0xbb64361f,0x3aa7b872
.long 0xbc00,0x361f3b64,0xb9a8b9a8,0x3b64361f,0x3c000000,0xbaa73872,0x361fbb64,0x323e3bd9
.long 0x3c00,0x39a839a8,0x3c000000,0x39a8b9a8,0xbc008000,0xb8723aa7,0x361f3b64,0x3bd9323e
.long 0xbc00,0xbb64b61f,0xb9a839a8,0x361f3b64,0x3c000000,0x323ebbd9,0xbb64b61f,0xb8723aa7
.long 0x3c00,0xb9a8b9a8,0x3c000000,0xb9a839a8,0xbc008000,0x3872baa7,0x361f3b64,0xbbd9b23e
.long 0xbc00,0x3b64361f,0xb9a839a8,0xb61fbb64,0x3c000000,0xb23e3bd9,0xbb64b61f,0x3872baa7
.long 0x3c00,0x3c000000,0xbc00,0xbc008000,0xbc008000,0x323e3bd9,0x3b64b61f,0xb872baa7
.long 0xbc00,0xbb64361f,0x39a839a8,0x361fbb64,0x3c000000,0xb872baa7,0xb61f3b64,0x3bd9b23e
.long 0x3c00,0xbc008000,0xbc00,0x3c000000,0xbc008000,0xb23ebbd9,0x3b64b61f,0x38723aa7
.long 0xbc00,0x3b64b61f,0x39a839a8,0xb61f3b64,0x3c000000,0x38723aa7,0xb61f3b64,0xbbd9323e
.long 0x3c00,0x39a8b9a8,0xbc008000,0x39a839a8,0xbc008000,0x3aa73872,0xb61fbb64,0xb23e3bd9
.long 0xbc00,0xb61f3b64,0x39a8b9a8,0xbb64361f,0x3c000000,0xbbd9b23e,0x3b64361f,0xbaa7b872
.long 0x3c00,0xb9a839a8,0xbc008000,0xb9a8b9a8,0xbc008000,0xbaa7b872,0xb61fbb64,0x323ebbd9
.long 0xbc00,0x361fbb64,0x39a8b9a8,0x3b64b61f,0x3c000000,0x3bd9323e,0x3b64361f,0x3aa73872
.long 0x3c00,0x3c00,0x3c00,0x3c00,0xb9a839a8,0xb8723aa7,0xb61f3b64,0xb23e3bd9
.long 0xbc008000,0xbb64361f,0xb9a839a8,0xb61f3b64,0xb9a8b9a8,0xbbd9b23e,0xbb64361f,0xb8723aa7
.long 0x3c00,0xbc00,0x3c00,0xbc00,0xb9a839a8,0x3872baa7,0xb61f3b64,0x323ebbd9
.long 0xbc008000,0x3b64b61f,0xb9a839a8,0x361fbb64,0xb9a8b9a8,0x3bd9323e,0xbb64361f,0x3872baa7
.long 0xbc00,0xb9a8b9a8,0xbc008000,0xb9a839a8,0x39a8b9a8,0xb23ebbd9,0xbb64b61f,0xbaa73872
.long 0x3c000000,0x361fbb64,0xb9a8b9a8,0xbb64361f,0x39a839a8,0x3aa7b872,0xb61fbb64,0xbbd9323e
.long 0xbc00,0x39a839a8,0xbc008000,0x39a8b9a8,0x39a8b9a8,0x323e3bd9,0xbb64b61f,0x3aa7b872
.long 0x3c000000,0xb61f3b64,0xb9a8b9a8,0x3b64b61f,0x39a839a8,0xbaa73872,0xb61fbb64,0x3bd9b23e
.long 0x3c00,0x3c000000,0xbc00,0xbc008000,0xb9a839a8,0x3aa73872,0x361fbb64,0xbbd9b23e
.long 0xbc008000,0x361f3b64,0x39a8b9a8,0xbb64b61f,0xb9a8b9a8,0xb23e3bd9,0x3b64b61f,0xbaa7b872
.long 0x3c00,0xbc008000,0xbc00,0x3c000000,0xb9a839a8,0xbaa7b872,0x361fbb64,0x3bd9323e
.long 0xbc008000,0xb61fbb64,0x39a8b9a8,0x3b64361f,0xb9a8b9a8,0x323ebbd9,0x3b64b61f,0x3aa73872
.long 0xbc00,0xb9a839a8,0x3c000000,0xb9a8b9a8,0x39a8b9a8,0xbbd9323e,0x3b64361f,0xb872baa7
.long 0x3c000000,0xbb64b61f,0x39a839a8,0xb61fbb64,0x39a839a8,0xb872baa7,0x361f3b64,0xb23ebbd9
.long 0xbc00,0x39a8b9a8,0x3c000000,0x39a839a8,0x39a8b9a8,0x3bd9b23e,0x3b64361f,0x38723aa7
.long 0x3c000000,0x3b64361f,0x39a839a8,0x361f3b64,0x39a839a8,0x38723aa7,0x361f3b64,0x323e3bd9
.long 0x3c008000,0x3c008000,0x3c008000,0x3c008000,0x3c008000,0x3bd9b23e,0x3b64b61f,0x3aa7b872
.long 0x3c008000,0x3b64b61f,0x39a8b9a8,0x361fbb64,0x3c008000,0x3aa7b872,0x361fbb64,0xb23ebbd9
.long 0x3c008000,0xbc008000,0x3c008000,0xbc008000,0x3c008000,0xbbd9323e,0x3b64b61f,0xbaa73872
.long 0x3c008000,0xbb64361f,0x39a8b9a8,0xb61f3b64,0x3c008000,0xbaa73872,0x361fbb64,0x323e3bd9
.long 0x3c008000,0x39a8b9a8,0xbc00,0xb9a8b9a8,0x3c008000,0x3872baa7,0xb61fbb64,0xbbd9b23e
.long 0x3c008000,0x361fbb64,0xb9a8b9a8,0xbb64361f,0x3c008000,0x323ebbd9,0xbb64b61f,0xb8723aa7
.long 0x3c008000,0xb9a839a8,0xbc00,0x39a839a8,0x3c008000,0xb8723aa7,0xb61fbb64,0x3bd9323e
.long 0x3c008000,0xb61f3b64,0xb9a8b9a8,0x3b64b61f,0x3c008000,0xb23e3bd9,0xbb64b61f,0x3872baa7
.long 0x3c008000,0xbc00,0xbc008000,0x80003c00,0x3c008000,0xb23ebbd9,0xbb64361f,0x38723aa7
.long 0x3c008000,0xb61fbb64,0xb9a839a8,0x3b64361f,0x3c008000,0xb872baa7,0xb61f3b64,0x3bd9b23e
.long 0x3c008000,0x80003c00,0xbc008000,0xbc00,0x3c008000,0x323e3bd9,0xbb64361f,0xb872baa7
.long 0x3c008000,0x361f3b64,0xb9a839a8,0xbb64b61f,0x3c008000,0x38723aa7,0xb61f3b64,0xbbd9323e
.long 0x3c008000,0xb9a8b9a8,0x80003c00,0x39a8b9a8,0x3c008000,0xbaa7b872,0x361f3b64,0x323ebbd9
.long 0x3c008000,0xbb64b61f,0x39a839a8,0xb61fbb64,0x3c008000,0xbbd9b23e,0x3b64361f,0xbaa7b872
.long 0x3c008000,0x39a839a8,0x80003c00,0xb9a839a8,0x3c008000,0x3aa73872,0x361f3b64,0xb23e3bd9
.long 0x3c008000,0x3b64361f,0x39a839a8,0x361f3b64,0x3c008000,0x3bd9323e,0x3b64361f,0x3aa73872
.long 0x3c008000,0x3c008000,0x3c008000,0x3c008000,0x39a8b9a8,0x3872baa7,0x361fbb64,0x323ebbd9
.long 0xbc00,0xb61fbb64,0xb9a8b9a8,0xbb64b61f,0xb9a8b9a8,0xbbd9b23e,0xbb64361f,0xb8723aa7
.long 0x3c008000,0xbc008000,0x3c008000,0xbc008000,0x39a8b9a8,0xb8723aa7,0x361fbb64,0xb23e3bd9
.long 0xbc00,0x361f3b64,0xb9a8b9a8,0x3b64361f,0xb9a8b9a8,0x3bd9323e,0xbb64361f,0x3872baa7
.long 0xbc008000,0xb9a839a8,0x80003c00,0x39a839a8,0xb9a839a8,0x323e3bd9,0x3b64361f,0x3aa7b872
.long 0x80003c00,0x3b64361f,0x39a8b9a8,0xb61fbb64,0x39a839a8,0x3aa7b872,0xb61fbb64,0xbbd9323e
.long 0xbc008000,0x39a8b9a8,0x80003c00,0xb9a8b9a8,0xb9a839a8,0xb23ebbd9,0x3b64361f,0xbaa73872
.long 0x80003c00,0xbb64b61f,0x39a8b9a8,0x361f3b64,0x39a839a8,0xbaa73872,0xb61fbb64,0x3bd9b23e
.long 0x3c008000,0xbc00,0xbc008000,0x80003c00,0x39a8b9a8,0xbaa7b872,0xb61f3b64,0x3bd9323e
.long 0xbc00,0xbb64361f,0x39a839a8,0x361fbb64,0xb9a8b9a8,0xb23e3bd9,0x3b64b61f,0xbaa7b872
.long 0x3c008000,0x80003c00,0xbc008000,0xbc00,0x39a8b9a8,0x3aa73872,0xb61f3b64,0xbbd9b23e
.long 0xbc00,0x3b64b61f,0x39a839a8,0xb61f3b64,0xb9a8b9a8,0x323ebbd9,0x3b64b61f,0x3aa73872
.long 0xbc008000,0x39a839a8,0xbc00,0xb9a839a8,0xb9a839a8,0x3bd9b23e,0xbb64b61f,0x38723aa7
.long 0x80003c00,0x361fbb64,0xb9a839a8,0x3b64b61f,0x39a839a8,0xb872baa7,0x361f3b64,0xb23ebbd9
.long 0xbc008000,0xb9a8b9a8,0xbc00,0x39a8b9a8,0xb9a839a8,0xbbd9323e,0xbb64b61f,0xb872baa7
.long 0x80003c00,0xb61f3b64,0xb9a839a8,0xbb64361f,0x39a839a8,0x38723aa7,0x361f3b64,0x323e3bd9
.long 0x3c008000,0x3c008000,0x3c008000,0x3c008000,0xbc00,0xb23ebbd9,0xb61fbb64,0xb872baa7
.long 0xbc008000,0xbb64361f,0xb9a839a8,0xb61f3b64,0x80003c00,0x38723aa7,0x3b64361f,0x3bd9b23e
.long 0x3c008000,0xbc008000,0x3c008000,0xbc008000,0xbc00,0x323e3bd9,0xb61fbb64,0x38723aa7
.long 0xbc008000,0x3b64b61f,0xb9a839a8,0x361fbb64,0x80003c00,0xb872baa7,0x3b64361f,0xbbd9323e
.long 0x3c008000,0x39a8b9a8,0xbc00,0xb9a8b9a8,0xbc00,0xbaa7b872,0xbb64361f,0xb23e3bd9
.long 0xbc008000,0xb61f3b64,0x39a839a8,0x3b64b61f,0x80003c00,0x3bd9323e,0x361fbb64,0xbaa7b872
.long 0x3c008000,0xb9a839a8,0xbc00,0x39a839a8,0xbc00,0x3aa73872,0xbb64361f,0x323ebbd9
.long 0xbc008000,0x361fbb64,0x39a839a8,0xbb64361f,0x80003c00,0xbbd9b23e,0x361fbb64,0x3aa73872
.long 0x3c008000,0xbc00,0xbc008000,0x80003c00,0xbc00,0xbbd9323e,0x361f3b64,0x3aa7b872
.long 0xbc008000,0x361f3b64,0x39a8b9a8,0xbb64b61f,0x80003c00,0x3aa7b872,0xbb64b61f,0x323e3bd9
.long 0x3c008000,0x80003c00,0xbc008000,0xbc00,0xbc00,0x3bd9b23e,0x361f3b64,0xbaa73872
.long 0xbc008000,0xb61fbb64,0x39a8b9a8,0x3b64361f,0x80003c00,0xbaa73872,0xbb64b61f,0xb23ebbd9
.long 0x3c008000,0xb9a8b9a8,0x80003c00,0x39a8b9a8,0xbc00,0xb8723aa7,0x3b64b61f,0xbbd9b23e
.long 0xbc008000,0x3b64361f,0xb9a8b9a8,0x361f3b64,0x80003c00,0x323ebbd9,0xb61f3b64,0x3872baa7
.long 0x3c008000,0x39a839a8,0x80003c00,0xb9a839a8,0xbc00,0x3872baa7,0x3b64b61f,0x3bd9323e
.long 0xbc008000,0xbb64b61f,0xb9a8b9a8,0xb61fbb64,0x80003c00,0xb23e3bd9,0xb61f3b64,0xb8723aa7
.long 0x3c008000,0x3c008000,0x3c008000,0x3c008000,0xb9a8b9a8,0xbaa7b872,0xbb64b61f,0xbbd9b23e
.long 0x80003c00,0x361f3b64,0x39a839a8,0x3b64361f,0x39a8b9a8,0x323ebbd9,0xb61fbb64,0xbaa7b872
.long 0x3c008000,0xbc008000,0x3c008000,0xbc008000,0xb9a8b9a8,0x3aa73872,0xbb64b61f,0x3bd9323e
.long 0x80003c00,0xb61fbb64,0x39a839a8,0xbb64b61f,0x39a8b9a8,0xb23e3bd9,0xb61fbb64,0x3aa73872
.long 0xbc008000,0xb9a839a8,0x80003c00,0x39a839a8,0x39a839a8,0x3bd9b23e,0x361fbb64,0xb872baa7
.long 0xbc00,0xbb64b61f,0xb9a839a8,0x361f3b64,0xb9a839a8,0x38723aa7,0x3b64b61f,0xb23ebbd9
.long 0xbc008000,0x39a8b9a8,0x80003c00,0xb9a8b9a8,0x39a839a8,0xbbd9323e,0x361fbb64,0x38723aa7
.long 0xbc00,0x3b64361f,0xb9a839a8,0xb61fbb64,0xb9a839a8,0xb872baa7,0x3b64b61f,0x323e3bd9
.long 0x3c008000,0xbc00,0xbc008000,0x80003c00,0xb9a8b9a8,0xb8723aa7,0x3b64361f,0x323ebbd9
.long 0x80003c00,0x3b64b61f,0xb9a8b9a8,0xb61f3b64,0x39a8b9a8,0xbbd9b23e,0x361f3b64,0x3872baa7
.long 0x3c008000,0x80003c00,0xbc008000,0xbc00,0xb9a8b9a8,0x3872baa7,0x3b64361f,0xb23e3bd9
.long 0x80003c00,0xbb64361f,0xb9a8b9a8,0x361fbb64,0x39a8b9a8,0x3bd9323e,0x361f3b64,0xb8723aa7
.long 0xbc008000,0x39a839a8,0xbc00,0xb9a839a8,0x39a839a8,0xb23ebbd9,0xb61f3b64,0x3aa7b872
.long 0xbc00,0xb61f3b64,0x39a8b9a8,0xbb64361f,0xb9a839a8,0x3aa7b872,0xbb64361f,0x3bd9b23e
.long 0xbc008000,0xb9a8b9a8,0xbc00,0x39a8b9a8,0x39a839a8,0x323e3bd9,0xb61f3b64,0xbaa73872
.long 0xbc00,0x361fbb64,0x39a8b9a8,0x3b64b61f,0xb9a839a8,0xbaa73872,0xbb64361f,0xbbd9323e
.long 0x3c008000,0x3c008000,0x3c008000,0x3c008000,0xbc008000,0xbbd9323e,0xbb64361f,0xbaa73872
.long 0x3c008000,0x3b64b61f,0x39a8b9a8,0x361fbb64,0xbc008000,0xbaa73872,0xb61f3b64,0x323e3bd9
.long 0x3c008000,0xbc008000,0x3c008000,0xbc008000,0xbc008000,0x3bd9b23e,0xbb64361f,0x3aa7b872
.long 0x3c008000,0xbb64361f,0x39a8b9a8,0xb61f3b64,0xbc008000,0x3aa7b872,0xb61f3b64,0xb23ebbd9
.long 0x3c008000,0x39a8b9a8,0xbc00,0xb9a8b9a8,0xbc008000,0xb8723aa7,0x361f3b64,0x3bd9323e
.long 0x3c008000,0x361fbb64,0xb9a8b9a8,0xbb64361f,0xbc008000,0xb23e3bd9,0x3b64361f,0x3872baa7
.long 0x3c008000,0xb9a839a8,0xbc00,0x39a839a8,0xbc008000,0x3872baa7,0x361f3b64,0xbbd9b23e
.long 0x3c008000,0xb61f3b64,0xb9a8b9a8,0x3b64b61f,0xbc008000,0x323ebbd9,0x3b64361f,0xb8723aa7
.long 0x3c008000,0xbc00,0xbc008000,0x80003c00,0xbc008000,0x323e3bd9,0x3b64b61f,0xb872baa7
.long 0x3c008000,0xb61fbb64,0xb9a839a8,0x3b64361f,0xbc008000,0x38723aa7,0x361fbb64,0xbbd9323e
.long 0x3c008000,0x80003c00,0xbc008000,0xbc00,0xbc008000,0xb23ebbd9,0x3b64b61f,0x38723aa7
.long 0x3c008000,0x361f3b64,0xb9a839a8,0xbb64b61f,0xbc008000,0xb872baa7,0x361fbb64,0x3bd9b23e
.long 0x3c008000,0xb9a8b9a8,0x80003c00,0x39a8b9a8,0xbc008000,0x3aa73872,0xb61fbb64,0xb23e3bd9
.long 0x3c008000,0xbb64b61f,0x39a839a8,0xb61fbb64,0xbc008000,0x3bd9323e,0xbb64b61f,0x3aa73872
.long 0x3c008000,0x39a839a8,0x80003c00,0xb9a839a8,0xbc008000,0xbaa7b872,0xb61fbb64,0x323ebbd9
.long 0x3c008000,0x3b64361f,0x39a839a8,0x361f3b64,0xbc008000,0xbbd9b23e,0xbb64b61f,0xbaa7b872
.long 0x3c008000,0x3c008000,0x3c008000,0x3c008000,0xb9a839a8,0xb8723aa7,0xb61f3b64,0xb23e3bd9
.long 0xbc00,0xb61fbb64,0xb9a8b9a8,0xbb64b61f,0x39a839a8,0x3bd9323e,0x3b64b61f,0x3872baa7
.long 0x3c008000,0xbc008000,0x3c008000,0xbc008000,0xb9a839a8,0x3872baa7,0xb61f3b64,0x323ebbd9
.long 0xbc00,0x361f3b64,0xb9a8b9a8,0x3b64361f,0x39a839a8,0xbbd9b23e,0x3b64b61f,0xb8723aa7
.long 0xbc008000,0xb9a839a8,0x80003c00,0x39a839a8,0x39a8b9a8,0xb23ebbd9,0xbb64b61f,0xbaa73872
.long 0x80003c00,0x3b64361f,0x39a8b9a8,0xb61fbb64,0xb9a8b9a8,0xbaa73872,0x361f3b64,0x3bd9b23e
.long 0xbc008000,0x39a8b9a8,0x80003c00,0xb9a8b9a8,0x39a8b9a8,0x323e3bd9,0xbb64b61f,0x3aa7b872
.long 0x80003c00,0xbb64b61f,0x39a8b9a8,0x361f3b64,0xb9a8b9a8,0x3aa7b872,0x361f3b64,0xbbd9323e
.long 0x3c008000,0xbc00,0xbc008000,0x80003c00,0xb9a839a8,0x3aa73872,0x361fbb64,0xbbd9b23e
.long 0xbc00,0xbb64361f,0x39a839a8,0x361fbb64,0x39a839a8,0x323ebbd9,0xbb64361f,0x3aa73872
.long 0x3c008000,0x80003c00,0xbc008000,0xbc00,0xb9a839a8,0xbaa7b872,0x361fbb64,0x3bd9323e
.long 0xbc00,0x3b64b61f,0x39a839a8,0xb61f3b64,0x39a839a8,0xb23e3bd9,0xbb64361f,0xbaa7b872
.long 0xbc008000,0x39a839a8,0xbc00,0xb9a839a8,0x39a8b9a8,0xbbd9323e,0x3b64361f,0xb872baa7
.long 0x80003c00,0x361fbb64,0xb9a839a8,0x3b64b61f,0xb9a8b9a8,0x38723aa7,0xb61fbb64,0x323e3bd9
.long 0xbc008000,0xb9a8b9a8,0xbc00,0x39a8b9a8,0x39a8b9a8,0x3bd9b23e,0x3b64361f,0x38723aa7
.long 0x80003c00,0xb61f3b64,0xb9a839a8,0xbb64361f,0xb9a8b9a8,0xb872baa7,0xb61fbb64,0xb23ebbd9
.long 0x3c008000,0x3c008000,0x3c008000,0x3c008000,0x80003c00,0x323e3bd9,0x361f3b64,0x38723aa7
.long 0xbc008000,0xbb64361f,0xb9a839a8,0xb61f3b64,0xbc00,0xb872baa7,0xbb64b61f,0xbbd9323e
.long 0x3c008000,0xbc008000,0x3c008000,0xbc008000,0x80003c00,0xb23ebbd9,0x361f3b64,0xb872baa7
.long 0xbc008000,0x3b64b61f,0xb9a839a8,0x361fbb64,0xbc00,0x38723aa7,0xbb64b61f,0x3bd9b23e
.long 0x3c008000,0x39a8b9a8,0xbc00,0xb9a8b9a8,0x80003c00,0x3aa73872,0x3b64b61f,0x323ebbd9
.long 0xbc008000,0xb61f3b64,0x39a839a8,0x3b64b61f,0xbc00,0xbbd9b23e,0xb61f3b64,0x3aa73872
.long 0x3c008000,0xb9a839a8,0xbc00,0x39a839a8,0x80003c00,0xbaa7b872,0x3b64b61f,0xb23e3bd9
.long 0xbc008000,0x361fbb64,0x39a839a8,0xbb64361f,0xbc00,0x3bd9323e,0xb61f3b64,0xbaa7b872
.long 0x3c008000,0xbc00,0xbc008000,0x80003c00,0x80003c00,0x3bd9b23e,0xb61fbb64,0xbaa73872
.long 0xbc008000,0x361f3b64,0x39a8b9a8,0xbb64b61f,0xbc00,0xbaa73872,0x3b64361f,0xb23ebbd9
.long 0x3c008000,0x80003c00,0xbc008000,0xbc00,0x80003c00,0xbbd9323e,0xb61fbb64,0x3aa7b872
.long 0xbc008000,0xb61fbb64,0x39a8b9a8,0x3b64361f,0xbc00,0x3aa7b872,0x3b64361f,0x323e3bd9
.long 0x3c008000,0xb9a8b9a8,0x80003c00,0x39a8b9a8,0x80003c00,0x3872baa7,0xbb64361f,0x3bd9323e
.long 0xbc008000,0x3b64361f,0xb9a8b9a8,0x361f3b64,0xbc00,0xb23e3bd9,0x361fbb64,0xb8723aa7
.long 0x3c008000,0x39a839a8,0x80003c00,0xb9a839a8,0x80003c00,0xb8723aa7,0xbb64361f,0xbbd9b23e
.long 0xbc008000,0xbb64b61f,0xb9a8b9a8,0xb61fbb64,0xbc00,0x323ebbd9,0x361fbb64,0x3872baa7
.long 0x3c008000,0x3c008000,0x3c008000,0x3c008000,0x39a839a8,0x3aa73872,0x3b64361f,0x3bd9323e
.long 0x80003c00,0x361f3b64,0x39a839a8,0x3b64361f,0xb9a839a8,0xb23e3bd9,0x361f3b64,0x3aa73872
.long 0x3c008000,0xbc008000,0x3c008000,0xbc008000,0x39a839a8,0xbaa7b872,0x3b64361f,0xbbd9b23e
.long 0x80003c00,0xb61fbb64,0x39a839a8,0xbb64b61f,0xb9a839a8,0x323ebbd9,0x361f3b64,0xbaa7b872
.long 0xbc008000,0xb9a839a8,0x80003c00,0x39a839a8,0xb9a8b9a8,0xbbd9323e,0xb61f3b64,0x38723aa7
.long 0xbc00,0xbb64b61f,0xb9a839a8,0x361f3b64,0x39a8b9a8,0xb872baa7,0xbb64361f,0x323e3bd9
.long 0xbc008000,0x39a8b9a8,0x80003c00,0xb9a8b9a8,0xb9a8b9a8,0x3bd9b23e,0xb61f3b64,0xb872baa7
.long 0xbc00,0x3b64361f,0xb9a839a8,0xb61fbb64,0x39a8b9a8,0x38723aa7,0xbb64361f,0xb23ebbd9
.long 0x3c008000,0xbc00,0xbc008000,0x80003c00,0x39a839a8,0x3872baa7,0xbb64b61f,0xb23e3bd9
.long 0x80003c00,0x3b64b61f,0xb9a8b9a8,0xb61f3b64,0xb9a839a8,0x3bd9323e,0xb61fbb64,0xb8723aa7
.long 0x3c008000,0x80003c00,0xbc008000,0xbc00,0x39a839a8,0xb8723aa7,0xbb64b61f,0x323ebbd9
.long 0x80003c00,0xbb64361f,0xb9a8b9a8,0x361fbb64,0xb9a839a8,0xbbd9b23e,0xb61fbb64,0x3872baa7
.long 0xbc008000,0x39a839a8,0xbc00,0xb9a839a8,0xb9a8b9a8,0x323e3bd9,0x361fbb64,0xbaa73872
.long 0xbc00,0xb61f3b64,0x39a8b9a8,0xbb64361f,0x39a8b9a8,0xbaa73872,0x3b64b61f,0xbbd9323e
.long 0xbc008000,0xb9a8b9a8,0xbc00,0x39a8b9a8,0xb9a8b9a8,0xb23ebbd9,0x361fbb64,0x3aa7b872
.long 0xbc00,0x361fbb64,0x39a8b9a8,0x3b64b61f,0x39a8b9a8,0x3aa7b872,0x3b64b61f,0x3bd9b23e
.long 0x3f800000,0x3f800000,0x3f800000,0x3f800000,0x3f800000,0x3f7ffec4,0x3f7ffb11,0x3f7ff4e6
.long 0x3f800000,0x3f7ffb11,0x3f7fec43,0x3f7fd397,0x3f800000,0x3f7ff4e6,0x3f7fd397,0x3f7f9c18
.long 0x3f800000,0x3f7ec46d,0x3f7b14be,0x3f74fa0b,0x3f800000,0x3f7e9bc9,0x3f7a7302,0x3f73913f
.long 0x3f800000,0x3f7e70b0,0x3f79c79d,0x3f721352,0x3f800000,0x3f7e4323,0x3f791298,0x3f708066
.long 0x3f800000,0x3f7fec43,0x3f7fb10f,0x3f7f4e6d,0x3f800000,0x3f7fe129,0x3f7f84ab,0x3f7eea9d
.long 0x3f800000,0x3f7fd397,0x3f7f4e6d,0x3f7e70b0,0x3f800000,0x3f7fc38f,0x3f7f0e58,0x3f7de0b1
.long 0x3f800000,0x3f7e1324,0x3f7853f8,0x3f6ed89e,0x3f800000,0x3f7de0b1,0x3f778bc5,0x3f6d1c1d
.long 0x3f800000,0x3f7dabcc,0x3f76ba07,0x3f6b4b0c,0x3f800000,0x3f7d7474,0x3f75dec6,0x3f696591
.long 0x3f800000,0x3f7fb10f,0x3f7ec46d,0x3f7d3aac,0x3f800000,0x3f7f9c18,0x3f7e70b0,0x3f7c7eb0
.long 0x3f800000,0x3f7f84ab,0x3f7e1324,0x3f7baccd,0x3f800000,0x3f7f6ac7,0x3f7dabcc,0x3f7ac516
.long 0x3f800000,0x3f7d3aac,0x3f74fa0b,0x3f676bd8,0x3f800000,0x3f7cfe73,0x3f740bdd,0x3f655e0b
.long 0x3f800000,0x3f7cbfc9,0x3f731447,0x3f633c5a,0x3f800000,0x3f7c7eb0,0x3f721352,0x3f6106f2
.long 0x3f800000,0x3f7f4e6d,0x3f7d3aac,0x3f79c79d,0x3f800000,0x3f7f2f9d,0x3f7cbfc9,0x3f78b47b
.long 0x3f800000,0x3f7f0e58,0x3f7c3b28,0x3f778bc5,0x3f800000,0x3f7eea9d,0x3f7baccd,0x3f764d97
.long 0x3f800000,0x3f7c3b28,0x3f710908,0x3f5ebe05,0x3f800000,0x3f7bf531,0x3f6ff573,0x3f5c61c7
.long 0x3f800000,0x3f7baccd,0x3f6ed89e,0x3f59f26a,0x3f800000,0x3f7b61fc,0x3f6db293,0x3f577026
.long 0x3f800000,0x3f800000,0x3f800000,0x3f800000,0x3f7fec43,0x3f7fe129,0x3f7fd397,0x3f7fc38f
.long 0x3f7fb10f,0x3f7f84ab,0x3f7f4e6d,0x3f7f0e58,0x3f7f4e6d,0x3f7eea9d,0x3f7e70b0,0x3f7de0b1
.long 0x3f6c835e,0x3f61c598,0x3f54db31,0x3f45e403,0x3f6a09a7,0x3f5df6be,0x3f4f7a1f,0x3f3ebc1b
.long 0x3f676bd8,0x3f59f26a,0x3f49d112,0x3f373a23,0x3f64aa59,0x3f55b993,0x3f43e200,0x3f2f61a5
.long 0x3f7ec46d,0x3f7e1324,0x3f7d3aac,0x3f7c3b28,0x3f7e1324,0x3f7cfe73,0x3f7baccd,0x3f7a1e84
.long 0x3f7d3aac,0x3f7baccd,0x3f79c79d,0x3f778bc5,0x3f7c3b28,0x3f7a1e84,0x3f778bc5,0x3f748422
.long 0x3f61c598,0x3f514d3d,0x3f3daef9,0x3f273656,0x3f5ebe05,0x3f4cae79,0x3f373a23,0x3f1ebc12
.long 0x3f5b941a,0x3f47de65,0x3f3085bb,0x3f15f6d9,0x3f584853,0x3f42de29,0x3f299415,0x3f0cead0
.long 0x3f7b14be,0x3f7853f8,0x3f74fa0b,0x3f710908,0x3f79c79d,0x3f764d97,0x3f721352,0x3f6d1c1d
.long 0x3f7853f8,0x3f740bdd,0x3f6ed89e,0x3f68bf3c,0x3f76ba07,0x3f718f57,0x3f6b4b0c,0x3f63f473
.long 0x3f54db31,0x3f3daef9,0x3f226799,0x3f039c3d,0x3f514d3d,0x3f385216,0x3f1b02c6,0x3ef41f07
.long 0x3f4d9f02,0x3f32c8c9,0x3f13682a,0x3ee0924f,0x3f49d112,0x3f2d1469,0x3f0b9a6b,0x3ecc9b8b
.long 0x3f74fa0b,0x3f6ed89e,0x3f676bd8,0x3f5ebe05,0x3f731447,0x3f6be858,0x3f633c5a,0x3f591e6a
.long 0x3f710908,0x3f68bf3c,0x3f5ebe05,0x3f531849,0x3f6ed89e,0x3f655e0b,0x3f59f26a,0x3f4cae79
.long 0x3f45e403,0x3f273656,0x3f039c3d,0x3eb8442a,0x3f41d870,0x3f212ff9,0x3ef6e0cb,0x3ea395c5
.long 0x3f3daef9,0x3f1b02c6,0x3ee63375,0x3e8e9a22,0x3f396842,0x3f14b039,0x3ed53641,0x3e72b651
.long 0x3f800000,0x3f800000,0x3f800000,0x3f800000,0x3f7fb10f,0x3f7f9c18,0x3f7f84ab,0x3f7f6ac7
.long 0x3f7ec46d,0x3f7e70b0,0x3f7e1324,0x3f7dabcc,0x3f7d3aac,0x3f7c7eb0,0x3f7baccd,0x3f7ac516
.long 0x3f3504f3,0x3f226799,0x3f0e39da,0x3ef15aea,0x3f2beb4a,0x3f173c07,0x3f00e7e4,0x3ed25a09
.long 0x3f226799,0x3f0b9a6b,0x3ee63375,0x3eb263ef,0x3f187fc0,0x3eff17b2,0x3ec9b953,0x3e919ddd
.long 0x3f7b14be,0x3f79c79d,0x3f7853f8,0x3f76ba07,0x3f7853f8,0x3f764d97,0x3f740bdd,0x3f718f57
.long 0x3f74fa0b,0x3f721352,0x3f6ed89e,0x3f6b4b0c,0x3f710908,0x3f6d1c1d,0x3f68bf3c,0x3f63f473
.long 0x3f0e39da,0x3ee63375,0x3eac7cd4,0x3e605c13,0x3f039c3d,0x3ecc9b8b,0x3e8e9a22,0x3e1c76de
.long 0x3ef15aea,0x3eb263ef,0x3e605c13,0x3dafb680,0x3edae880,0x3e97a117,0x3e22abb6,0x3c96c9b6
.long 0x3f6c835e,0x3f676bd8,0x3f61c598,0x3f5b941a,0x3f676bd8,0x3f6106f2,0x3f59f26a,0x3f5233c6
.long 0x3f61c598,0x3f59f26a,0x3f514d3d,0x3f47de65,0x3f5b941a,0x3f5233c6,0x3f47de65,0x3f3ca003
.long 0x3ec3ef15,0x3e78cfcc,0x3dc8bd36,0xbd48fb30,0x3eac7cd4,0x3e419b37,0x3d16c32c,0xbdee3876
.long 0x3e94a031,0x3e09cf86,0xbcc90ab0,0xbe3b6ecf,0x3e78cfcc,0x3da3308c,0xbdafb680,0xbe7ee6e1
.long 0x3f54db31,0x3f49d112,0x3f3daef9,0x3f3085bb,0x3f4d9f02,0x3f40d0da,0x3f32c8c9,0x3f239da9
.long 0x3f45e403,0x3f373a23,0x3f273656,0x3f15f6d9,0x3f3daef9,0x3f2d1469,0x3f1b02c6,0x3f07a136
.long 0x3e47c5c2,0x3cc90ab0,0xbe164083,0xbea09ae5,0x3e164083,0xbcfb49ba,0xbe541501,0xbec1071e
.long 0x3dc8bd36,0xbdafb680,0xbe888e93,0xbee0924f,0x3d48fb30,0xbe1008b7,0xbea68f12,0xbeff17b2
.long 0x3f800000,0x3f800000,0x3f800000,0x3f800000,0x3f7f4e6d,0x3f7f2f9d,0x3f7f0e58,0x3f7eea9d
.long 0x3f7d3aac,0x3f7cbfc9,0x3f7c3b28,0x3f7baccd,0x3f79c79d,0x3f78b47b,0x3f778bc5,0x3f764d97
.long 0x3ec3ef15,0x3e94a031,0x3e47c5c2,0x3dc8bd36,0x3ea09ae5,0x3e5a3997,0x3de1bc2e,0x3bc90f88
.long 0x3e78cfcc,0x3e09cf86,0x3cc90ab0,0xbdafb680,0x3e2f10a2,0x3d621469,0xbd7b2b74,0xbe354098
.long 0x3f74fa0b,0x3f731447,0x3f710908,0x3f6ed89e,0x3f6ed89e,0x3f6be858,0x3f68bf3c,0x3f655e0b
.long 0x3f676bd8,0x3f633c5a,0x3f5ebe05,0x3f59f26a,0x3f5ebe05,0x3f591e6a,0x3f531849,0x3f4cae79
.long 0x3dc8bd36,0xbcc90ab0,0xbe164083,0xbe888e93,0x3cc90ab0,0xbdd53db9,0xbe6c9a7f,0xbeb554ec
.long 0xbd48fb30,0xbe3b6ecf,0xbea09ae5,0xbee0924f,0xbdfab273,0xbe8586ce,0xbec9b953,0xbf04f484
.long 0x3f54db31,0x3f4d9f02,0x3f45e403,0x3f3daef9,0x3f49d112,0x3f40d0da,0x3f373a23,0x3f2d1469
.long 0x3f3daef9,0x3f32c8c9,0x3f273656,0x3f1b02c6,0x3f3085bb,0x3f239da9,0x3f15f6d9,0x3f07a136
.long 0xbe47c5c2,0xbeac7cd4,0xbef15aea,0xbf187fc0,0xbe888e93,0xbed25a09,0xbf0b9a6b,0xbf2ac082
.long 0xbeac7cd4,0xbef6e0cb,0xbf1d7fd1,0xbf3b8f3b,0xbecf7bca,0xbf0cead0,0xbf2e3bde,0xbf4ac77f
.long 0x3f226799,0x3f13682a,0x3f039c3d,0x3ee63375,0x3f13682a,0x3f0242b1,0x3ee0924f,0x3ebb31a0
.long 0x3f039c3d,0x3ee0924f,0x3eb8442a,0x3e8e9a22,0x3ee63375,0x3ebb31a0,0x3e8e9a22,0x3e419b37
.long 0xbef15aea,0xbf1d7fd1,0xbf3daef9,0xbf584853,0xbf08f59b,0xbf2d1469,0xbf4bbbf8,0xbf63f473
.long 0xbf187fc0,0xbf3b8f3b,0xbf584853,0xbf6db293,0xbf273656,0xbf48d8b3,0xbf633c5a,0xbf756d97
.long 0x3f800000,0x3f800000,0x3f800000,0x3f800000,0x3f7ec46d,0x3f7e9bc9,0x3f7e70b0,0x3f7e4323
.long 0x3f7b14be,0x3f7a7302,0x3f79c79d,0x3f791298,0x3f74fa0b,0x3f73913f,0x3f721352,0x3f708066
.long 0x248d3132,0xbdc8bd36,0xbe47c5c2,0xbe94a031,0xbdc8bd36,0xbe4dee60,0xbe9aa086,0xbecc9b8b
.long 0xbe47c5c2,0xbe9aa086,0xbecf7bca,0xbf00e7e4,0xbe94a031,0xbecc9b8b,0xbf00e7e4,0xbf19c200
.long 0x3f6c835e,0x3f6a09a7,0x3f676bd8,0x3f64aa59,0x3f61c598,0x3f5df6be,0x3f59f26a,0x3f55b993
.long 0x3f54db31,0x3f4f7a1f,0x3f49d112,0x3f43e200,0x3f45e403,0x3f3ebc1b,0x3f373a23,0x3f2f61a5
.long 0xbec3ef15,0xbefc5d27,0xbf187fc0,0xbf3085bb,0xbef15aea,0xbf14b039,0xbf2e3bde,0xbf44e3f5
.long 0xbf0e39da,0xbf299415,0xbf41d870,0xbf5695e5,0xbf226799,0xbf3ca003,0xbf531849,0xbf655e0b
.long 0x3f3504f3,0x3f2beb4a,0x3f226799,0x3f187fc0,0x3f226799,0x3f173c07,0x3f0b9a6b,0x3eff17b2
.long 0x3f0e39da,0x3f00e7e4,0x3ee63375,0x3ec9b953,0x3ef15aea,0x3ed25a09,0x3eb263ef,0x3e919ddd
.long 0xbf3504f3,0xbf4d9f02,0xbf61c598,0xbf710908,0xbf45e403,0xbf5c61c7,0xbf6db293,0xbf796e4e
.long 0xbf54db31,0xbf68bf3c,0xbf76ba07,0xbf7e70b0,0xbf61c598,0xbf7294f8,0xbf7cbfc9,0xbf7ffec4
.long 0x3ec3ef15,0x3ea09ae5,0x3e78cfcc,0x3e2f10a2,0x3e94a031,0x3e5a3997,0x3e09cf86,0x3d621469
.long 0x3e47c5c2,0x3de1bc2e,0x3cc90ab0,0xbd7b2b74,0x3dc8bd36,0x3bc90f88,0xbdafb680,0xbe354098
.long 0xbf6c835e,0xbf79c79d,0xbf7fb10f,0xbf7e1324,0xbf74fa0b,0xbf7e4323,0xbf7f84ab,0xbf78b47b
.long 0xbf7b14be,0xbf7ffb11,0xbf7c3b28,0xbf6ff573,0xbf7ec46d,0xbf7eea9d,0xbf75dec6,0xbf63f473
.long 0x3f800000,0x3f800000,0x3f800000,0x3f800000,0x3f7e1324,0x3f7de0b1,0x3f7dabcc,0x3f7d7474
.long 0x3f7853f8,0x3f778bc5,0x3f76ba07,0x3f75dec6,0x3f6ed89e,0x3f6d1c1d,0x3f6b4b0c,0x3f696591
.long 0xbec3ef15,0xbef15aea,0xbf0e39da,0xbf226799,0xbefc5d27,0xbf14b039,0xbf299415,0xbf3ca003
.long 0xbf187fc0,0xbf2e3bde,0xbf41d870,0xbf531849,0xbf3085bb,0xbf44e3f5,0xbf5695e5,0xbf655e0b
.long 0x3f61c598,0x3f5ebe05,0x3f5b941a,0x3f584853,0x3f514d3d,0x3f4cae79,0x3f47de65,0x3f42de29
.long 0x3f3daef9,0x3f373a23,0x3f3085bb,0x3f299415,0x3f273656,0x3f1ebc12,0x3f15f6d9,0x3f0cead0
.long 0xbf45e403,0xbf584853,0xbf676bd8,0xbf731447,0xbf584853,0xbf6816a8,0xbf740bdd,0xbf7bf531
.long 0xbf676bd8,0xbf740bdd,0xbf7c3b28,0xbf7fd397,0xbf731447,0xbf7bf531,0xbf7fd397,0xbf7e9bc9
.long 0x3f0e39da,0x3f039c3d,0x3ef15aea,0x3edae880,0x3ee63375,0x3ecc9b8b,0x3eb263ef,0x3e97a117
.long 0x3eac7cd4,0x3e8e9a22,0x3e605c13,0x3e22abb6,0x3e605c13,0x3e1c76de,0x3dafb680,0x3c96c9b6
.long 0xbf7b14be,0xbf7fb10f,0xbf7ec46d,0xbf7853f8,0xbf7f4e6d,0xbf7f2f9d,0xbf791298,0xbf6d1c1d
.long 0xbf7fb10f,0xbf7a7302,0xbf6ed89e,0xbf5d2d53,0xbf7c3b28,0xbf718f57,0xbf604621,0xbf48d8b3
.long 0x3dc8bd36,0x3cc90ab0,0xbd48fb30,0xbdfab273,0xbcc90ab0,0xbdd53db9,0xbe3b6ecf,0xbe8586ce
.long 0xbe164083,0xbe6c9a7f,0xbea09ae5,0xbec9b953,0xbe888e93,0xbeb554ec,0xbee0924f,0xbf04f484
.long 0xbf74fa0b,0xbf64aa59,0xbf4d9f02,0xbf3085bb,0xbf6a09a7,0xbf53fac3,0xbf373a23,0xbf14b039
.long 0xbf5b941a,0xbf3fc767,0xbf1d7fd1,0xbeebcbbb,0xbf49d112,0xbf286605,0xbf00e7e4,0xbea986c4
.long 0x3f800000,0x3f800000,0x3f800000,0x3f800000,0x3f7d3aac,0x3f7cfe73,0x3f7cbfc9,0x3f7c7eb0
.long 0x3f74fa0b,0x3f740bdd,0x3f731447,0x3f721352,0x3f676bd8,0x3f655e0b,0x3f633c5a,0x3f6106f2
.long 0xbf3504f3,0xbf45e403,0xbf54db31,0xbf61c598,0xbf4d9f02,0xbf5c61c7,0xbf68bf3c,0xbf7294f8
.long 0xbf61c598,0xbf6db293,0xbf76ba07,0xbf7cbfc9,0xbf710908,0xbf796e4e,0xbf7e70b0,0xbf7ffec4
.long 0x3f54db31,0x3f514d3d,0x3f4d9f02,0x3f49d112,0x3f3daef9,0x3f385216,0x3f32c8c9,0x3f2d1469
.long 0x3f226799,0x3f1b02c6,0x3f13682a,0x3f0b9a6b,0x3f039c3d,0x3ef41f07,0x3ee0924f,0x3ecc9b8b
.long 0xbf7b14be,0xbf7f4e6d,0xbf7fb10f,0xbf7c3b28,0xbf7fb10f,0xbf7f2f9d,0xbf7a7302,0xbf718f57
.long 0xbf7ec46d,0xbf791298,0xbf6ed89e,0xbf604621,0xbf7853f8,0xbf6d1c1d,0xbf5d2d53,0xbf48d8b3
.long 0x3ec3ef15,0x3eac7cd4,0x3e94a031,0x3e78cfcc,0x3e78cfcc,0x3e419b37,0x3e09cf86,0x3da3308c
.long 0x3dc8bd36,0x3d16c32c,0xbcc90ab0,0xbdafb680,0xbd48fb30,0xbdee3876,0xbe3b6ecf,0xbe7ee6e1
.long 0xbf6c835e,0xbf5b941a,0xbf45e403,0xbf2beb4a,0xbf5b941a,0xbf44e3f5,0xbf299415,0xbf0a48ad
.long 0xbf45e403,0xbf299415,0xbf08f59b,0xbec9b953,0xbf2beb4a,0xbf0a48ad,0xbec9b953,0xbe72b651
.long 0xbe47c5c2,0xbe888e93,0xbeac7cd4,0xbecf7bca,0xbeac7cd4,0xbed25a09,0xbef6e0cb,0xbf0cead0
.long 0xbef15aea,0xbf0b9a6b,0xbf1d7fd1,0xbf2e3bde,0xbf187fc0,0xbf2ac082,0xbf3b8f3b,0xbf4ac77f
.long 0xbf0e39da,0xbecf7bca,0xbe78cfcc,0xbd96a905,0xbedae880,0xbe8586ce,0xbdafb680,0x3dbc3ac3
.long 0xbe94a031,0xbde1bc2e,0x3d96a905,0x3e827dc0,0xbe164083,0x3d2fe007,0x3e6c9a7f,0x3ed25a09
.long 0x3f800000,0x3f800000,0x3f800000,0x3f800000,0x3f7c3b28,0x3f7bf531,0x3f7baccd,0x3f7b61fc
.long 0x3f710908,0x3f6ff573,0x3f6ed89e,0x3f6db293,0x3f5ebe05,0x3f5c61c7,0x3f59f26a,0x3f577026
.long 0xbf6c835e,0xbf74fa0b,0xbf7b14be,0xbf7ec46d,0xbf79c79d,0xbf7e4323,0xbf7ffb11,0xbf7eea9d
.long 0xbf7fb10f,0xbf7f84ab,0xbf7c3b28,0xbf75dec6,0xbf7e1324,0xbf78b47b,0xbf6ff573,0xbf63f473
.long 0x3f45e403,0x3f41d870,0x3f3daef9,0x3f396842,0x3f273656,0x3f212ff9,0x3f1b02c6,0x3f14b039
.long 0x3f039c3d,0x3ef6e0cb,0x3ee63375,0x3ed53641,0x3eb8442a,0x3ea395c5,0x3e8e9a22,0x3e72b651
.long 0xbf74fa0b,0xbf6a09a7,0xbf5b941a,0xbf49d112,0xbf64aa59,0xbf53fac3,0xbf3fc767,0xbf286605
.long 0xbf4d9f02,0xbf373a23,0xbf1d7fd1,0xbf00e7e4,0xbf3085bb,0xbf14b039,0xbeebcbbb,0xbea986c4
.long 0x3e47c5c2,0x3e164083,0x3dc8bd36,0x3d48fb30,0x3cc90ab0,0xbcfb49ba,0xbdafb680,0xbe1008b7
.long 0xbe164083,0xbe541501,0xbe888e93,0xbea68f12,0xbea09ae5,0xbec1071e,0xbee0924f,0xbeff17b2
.long 0xbf0e39da,0xbedae880,0xbe94a031,0xbe164083,0xbecf7bca,0xbe8586ce,0xbde1bc2e,0x3d2fe007
.long 0xbe78cfcc,0xbdafb680,0x3d96a905,0x3e6c9a7f,0xbd96a905,0x3dbc3ac3,0x3e827dc0,0x3ed25a09
.long 0xbef15aea,0xbf08f59b,0xbf187fc0,0xbf273656,0xbf1d7fd1,0xbf2d1469,0xbf3b8f3b,0xbf48d8b3
.long 0xbf3daef9,0xbf4bbbf8,0xbf584853,0xbf633c5a,0xbf584853,0xbf63f473,0xbf6db293,0xbf756d97
.long 0x3dc8bd36,0x3e888e93,0x3edae880,0x3f13682a,0x3e888e93,0x3eddbe79,0x3f15f6d9,0x3f385216
.long 0x3edae880,0x3f15f6d9,0x3f396842,0x3f5695e5,0x3f13682a,0x3f385216,0x3f5695e5,0x3f6d1c1d
.long 0x0,0x0,0x0,0x0,0x0,0x3bc90f88,0x3c490e90,0x3c96c9b6
.long 0x0,0x3c490e90,0x3cc90ab0,0x3d16c32c,0x0,0x3c96c9b6,0x3d16c32c,0x3d621469
.long 0x0,0x3dc8bd36,0x3e47c5c2,0x3e94a031,0x0,0x3dd53db9,0x3e541501,0x3e9d9e78
.long 0x0,0x3de1bc2e,0x3e605c13,0x3ea68f12,0x0,0x3dee3876,0x3e6c9a7f,0x3eaf713a
.long 0x0,0x3cc90ab0,0x3d48fb30,0x3d96a905,0x0,0x3cfb49ba,0x3d7b2b74,0x3dbc3ac3
.long 0x0,0x3d16c32c,0x3d96a905,0x3de1bc2e,0x0,0x3d2fe007,0x3dafb680,0x3e039502
.long 0x0,0x3dfab273,0x3e78cfcc,0x3eb8442a,0x0,0x3e039502,0x3e827dc0,0x3ec1071e
.long 0x0,0x3e09cf86,0x3e888e93,0x3ec9b953,0x0,0x3e1008b7,0x3e8e9a22,0x3ed25a09
.long 0x0,0x3d48fb30,0x3dc8bd36,0x3e164083,0x0,0x3d621469,0x3de1bc2e,0x3e28defc
.long 0x0,0x3d7b2b74,0x3dfab273,0x3e3b6ecf,0x0,0x3d8a200a,0x3e09cf86,0x3e4dee60
.long 0x0,0x3e164083,0x3e94a031,0x3edae880,0x0,0x3e1c76de,0x3e9aa086,0x3ee363fa
.long 0x0,0x3e22abb6,0x3ea09ae5,0x3eebcbbb,0x0,0x3e28defc,0x3ea68f12,0x3ef41f07
.long 0x0,0x3d96a905,0x3e164083,0x3e605c13,0x0,0x3da3308c,0x3e22abb6,0x3e72b651
.long 0x0,0x3dafb680,0x3e2f10a2,0x3e827dc0,0x0,0x3dbc3ac3,0x3e3b6ecf,0x3e8b9507
.long 0x0,0x3e2f10a2,0x3eac7cd4,0x3efc5d27,0x0,0x3e354098,0x3eb263ef,0x3f0242b1
.long 0x0,0x3e3b6ecf,0x3eb8442a,0x3f064b82,0x0,0x3e419b37,0x3ebe1d4a,0x3f0a48ad
.long 0x0,0x0,0x0,0x0,0x3cc90ab0,0x3cfb49ba,0x3d16c32c,0x3d2fe007
.long 0x3d48fb30,0x3d7b2b74,0x3d96a905,0x3dafb680,0x3d96a905,0x3dbc3ac3,0x3de1bc2e,0x3e039502
.long 0x3ec3ef15,0x3ef15aea,0x3f0e39da,0x3f226799,0x3ecf7bca,0x3eff17b2,0x3f15f6d9,0x3f2ac082
.long 0x3edae880,0x3f064b82,0x3f1d7fd1,0x3f32c8c9,0x3ee63375,0x3f0cead0,0x3f24d225,0x3f3a7ca4
.long 0x3dc8bd36,0x3dfab273,0x3e164083,0x3e2f10a2,0x3dfab273,0x3e1c76de,0x3e3b6ecf,0x3e5a3997
.long 0x3e164083,0x3e3b6ecf,0x3e605c13,0x3e827dc0,0x3e2f10a2,0x3e5a3997,0x3e827dc0,0x3e97a117
.long 0x3ef15aea,0x3f13682a,0x3f2beb4a,0x3f41d870,0x3efc5d27,0x3f19c200,0x3f32c8c9,0x3f48d8b3
.long 0x3f039c3d,0x3f1ff6cb,0x3f396842,0x3f4f7a1f,0x3f08f59b,0x3f26050a,0x3f3fc767,0x3f55b993
.long 0x3e47c5c2,0x3e78cfcc,0x3e94a031,0x3eac7cd4,0x3e605c13,0x3e8b9507,0x3ea68f12,0x3ec1071e
.long 0x3e78cfcc,0x3e9aa086,0x3eb8442a,0x3ed53641,0x3e888e93,0x3ea986c4,0x3ec9b953,0x3ee900b7
.long 0x3f0e39da,0x3f2beb4a,0x3f45e403,0x3f5b941a,0x3f13682a,0x3f31a81d,0x3f4bbbf8,0x3f6106f2
.long 0x3f187fc0,0x3f373a23,0x3f514d3d,0x3f660f88,0x3f1d7fd1,0x3f3ca003,0x3f5695e5,0x3f6aab7b
.long 0x3e94a031,0x3eb8442a,0x3edae880,0x3efc5d27,0x3ea09ae5,0x3ec6d529,0x3eebcbbb,0x3f07a136
.long 0x3eac7cd4,0x3ed53641,0x3efc5d27,0x3f10d3cd,0x3eb8442a,0x3ee363fa,0x3f064b82,0x3f19c200
.long 0x3f226799,0x3f41d870,0x3f5b941a,0x3f6ed89e,0x3f273656,0x3f46e22a,0x3f604621,0x3f7294f8
.long 0x3f2beb4a,0x3f4bbbf8,0x3f64aa59,0x3f75dec6,0x3f3085bb,0x3f5064af,0x3f68bf3c,0x3f78b47b
.long 0x0,0x0,0x0,0x0,0x3d48fb30,0x3d621469,0x3d7b2b74,0x3d8a200a
.long 0x3dc8bd36,0x3de1bc2e,0x3dfab273,0x3e09cf86,0x3e164083,0x3e28defc,0x3e3b6ecf,0x3e4dee60
.long 0x3f3504f3,0x3f45e403,0x3f54db31,0x3f61c598,0x3f3daef9,0x3f4e8d90,0x3f5d2d53,0x3f696591
.long 0x3f45e403,0x3f5695e5,0x3f64aa59,0x3f6ff573,0x3f4d9f02,0x3f5df6be,0x3f6b4b0c,0x3f756d97
.long 0x3e47c5c2,0x3e605c13,0x3e78cfcc,0x3e888e93,0x3e78cfcc,0x3e8b9507,0x3e9aa086,0x3ea986c4
.long 0x3e94a031,0x3ea68f12,0x3eb8442a,0x3ec9b953,0x3eac7cd4,0x3ec1071e,0x3ed53641,0x3ee900b7
.long 0x3f54db31,0x3f64aa59,0x3f710908,0x3f79c79d,0x3f5b941a,0x3f6aab7b,0x3f75dec6,0x3f7cfe73
.long 0x3f61c598,0x3f6ff573,0x3f79c79d,0x3f7f0e58,0x3f676bd8,0x3f748422,0x3f7cbfc9,0x3f7ff4e6
.long 0x3ec3ef15,0x3edae880,0x3ef15aea,0x3f039c3d,0x3edae880,0x3ef41f07,0x3f064b82,0x3f121eb0
.long 0x3ef15aea,0x3f064b82,0x3f13682a,0x3f1ff6cb,0x3f039c3d,0x3f121eb0,0x3f1ff6cb,0x3f2d1469
.long 0x3f6c835e,0x3f7853f8,0x3f7ec46d,0x3f7fb10f,0x3f710908,0x3f7b61fc,0x3f7fd397,0x3f7e4323
.long 0x3f74fa0b,0x3f7dabcc,0x3f7fec43,0x3f7baccd,0x3f7853f8,0x3f7f2f9d,0x3f7f0e58,0x3f77f110
.long 0x3f0e39da,0x3f1d7fd1,0x3f2beb4a,0x3f396842,0x3f187fc0,0x3f286605,0x3f373a23,0x3f44e3f5
.long 0x3f226799,0x3f32c8c9,0x3f41d870,0x3f4f7a1f,0x3f2beb4a,0x3f3ca003,0x3f4bbbf8,0x3f591e6a
.long 0x3f7b14be,0x3f7fec43,0x3f7d3aac,0x3f731447,0x3f7d3aac,0x3f7fe129,0x3f7a7302,0x3f6d1c1d
.long 0x3f7ec46d,0x3f7f0e58,0x3f76ba07,0x3f660f88,0x3f7fb10f,0x3f7d7474,0x3f721352,0x3f5df6be
.long 0x0,0x0,0x0,0x0,0x3d96a905,0x3da3308c,0x3dafb680,0x3dbc3ac3
.long 0x3e164083,0x3e22abb6,0x3e2f10a2,0x3e3b6ecf,0x3e605c13,0x3e72b651,0x3e827dc0,0x3e8b9507
.long 0x3f6c835e,0x3f74fa0b,0x3f7b14be,0x3f7ec46d,0x3f731447,0x3f7a1e84,0x3f7e70b0,0x3f7ffec4
.long 0x3f7853f8,0x3f7dabcc,0x3f7fec43,0x3f7f0e58,0x3f7c3b28,0x3f7f9c18,0x3f7f84ab,0x3f7bf531
.long 0x3e94a031,0x3ea09ae5,0x3eac7cd4,0x3eb8442a,0x3eb8442a,0x3ec6d529,0x3ed53641,0x3ee363fa
.long 0x3edae880,0x3eebcbbb,0x3efc5d27,0x3f064b82,0x3efc5d27,0x3f07a136,0x3f10d3cd,0x3f19c200
.long 0x3f7ec46d,0x3f7fec43,0x3f7d3aac,0x3f76ba07,0x3f7fec43,0x3f7e9bc9,0x3f791298,0x3f6f6830
.long 0x3f7fb10f,0x3f7baccd,0x3f731447,0x3f660f88,0x3f7e1324,0x3f772417,0x3f6b4b0c,0x3f5ac450
.long 0x3f0e39da,0x3f187fc0,0x3f226799,0x3f2beb4a,0x3f1d7fd1,0x3f286605,0x3f32c8c9,0x3f3ca003
.long 0x3f2beb4a,0x3f373a23,0x3f41d870,0x3f4bbbf8,0x3f396842,0x3f44e3f5,0x3f4f7a1f,0x3f591e6a
.long 0x3f7b14be,0x3f710908,0x3f61c598,0x3f4d9f02,0x3f76ba07,0x3f696591,0x3f5695e5,0x3f3ebc1b
.long 0x3f710908,0x3f604621,0x3f49d112,0x3f2e3bde,0x3f6a09a7,0x3f55b993,0x3f3b8f3b,0x3f1c420c
.long 0x3f45e403,0x3f514d3d,0x3f5b941a,0x3f64aa59,0x3f514d3d,0x3f5c61c7,0x3f660f88,0x3f6e46be
.long 0x3f5b941a,0x3f660f88,0x3f6ed89e,0x3f75dec6,0x3f64aa59,0x3f6e46be,0x3f75dec6,0x3f7b61fc
.long 0x3f61c598,0x3f49d112,0x3f2beb4a,0x3f08f59b,0x3f584853,0x3f3ca003,0x3f1b02c6,0x3ee900b7
.long 0x3f4d9f02,0x3f2e3bde,0x3f08f59b,0x3ebe1d4a,0x3f41d870,0x3f1ebc12,0x3eebcbbb,0x3e919ddd
.long 0x0,0x0,0x0,0x0,0x3dc8bd36,0x3dd53db9,0x3de1bc2e,0x3dee3876
.long 0x3e47c5c2,0x3e541501,0x3e605c13,0x3e6c9a7f,0x3e94a031,0x3e9d9e78,0x3ea68f12,0x3eaf713a
.long 0x3f800000,0x3f7ec46d,0x3f7b14be,0x3f74fa0b,0x3f7ec46d,0x3f7ac516,0x3f740bdd,0x3f6aab7b
.long 0x3f7b14be,0x3f740bdd,0x3f6a09a7,0x3f5d2d53,0x3f74fa0b,0x3f6aab7b,0x3f5d2d53,0x3f4cae79
.long 0x3ec3ef15,0x3ecf7bca,0x3edae880,0x3ee63375,0x3ef15aea,0x3eff17b2,0x3f064b82,0x3f0cead0
.long 0x3f0e39da,0x3f15f6d9,0x3f1d7fd1,0x3f24d225,0x3f226799,0x3f2ac082,0x3f32c8c9,0x3f3a7ca4
.long 0x3f6c835e,0x3f5ebe05,0x3f4d9f02,0x3f396842,0x3f61c598,0x3f5064af,0x3f3b8f3b,0x3f239da9
.long 0x3f54db31,0x3f3fc767,0x3f273656,0x3f0b9a6b,0x3f45e403,0x3f2d1469,0x3f10d3cd,0x3ee363fa
.long 0x3f3504f3,0x3f3daef9,0x3f45e403,0x3f4d9f02,0x3f45e403,0x3f4e8d90,0x3f5695e5,0x3f5df6be
.long 0x3f54db31,0x3f5d2d53,0x3f64aa59,0x3f6b4b0c,0x3f61c598,0x3f696591,0x3f6ff573,0x3f756d97
.long 0x3f3504f3,0x3f187fc0,0x3ef15aea,0x3eac7cd4,0x3f226799,0x3f0242b1,0x3ebe1d4a,0x3e667c66
.long 0x3f0e39da,0x3ed53641,0x3e888e93,0x3de1bc2e,0x3ef15aea,0x3ea395c5,0x3e22abb6,0xbbc90f88
.long 0x3f6c835e,0x3f731447,0x3f7853f8,0x3f7c3b28,0x3f74fa0b,0x3f7a1e84,0x3f7dabcc,0x3f7f9c18
.long 0x3f7b14be,0x3f7e70b0,0x3f7fec43,0x3f7f84ab,0x3f7ec46d,0x3f7ffec4,0x3f7f0e58,0x3f7bf531
.long 0x3ec3ef15,0x3e605c13,0x3d48fb30,0xbdfab273,0x3e94a031,0x3dee3876,0xbd7b2b74,0xbe72b651
.long 0x3e47c5c2,0x3c490e90,0xbe2f10a2,0xbeb263ef,0x3dc8bd36,0xbdbc3ac3,0xbe8e9a22,0xbee900b7
.long 0x0,0x0,0x0,0x0,0x3dfab273,0x3e039502,0x3e09cf86,0x3e1008b7
.long 0x3e78cfcc,0x3e827dc0,0x3e888e93,0x3e8e9a22,0x3eb8442a,0x3ec1071e,0x3ec9b953,0x3ed25a09
.long 0x3f6c835e,0x3f61c598,0x3f54db31,0x3f45e403,0x3f5ebe05,0x3f5064af,0x3f3fc767,0x3f2d1469
.long 0x3f4d9f02,0x3f3b8f3b,0x3f273656,0x3f10d3cd,0x3f396842,0x3f239da9,0x3f0b9a6b,0x3ee363fa
.long 0x3ef15aea,0x3efc5d27,0x3f039c3d,0x3f08f59b,0x3f13682a,0x3f19c200,0x3f1ff6cb,0x3f26050a
.long 0x3f2beb4a,0x3f32c8c9,0x3f396842,0x3f3fc767,0x3f41d870,0x3f48d8b3,0x3f4f7a1f,0x3f55b993
.long 0x3f226799,0x3f08f59b,0x3edae880,0x3ea09ae5,0x3f08f59b,0x3ed8106b,0x3e9aa086,0x3e354098
.long 0x3edae880,0x3e9aa086,0x3e2f10a2,0x3d16c32c,0x3ea09ae5,0x3e354098,0x3d16c32c,0xbdd53db9
.long 0x3f54db31,0x3f5b941a,0x3f61c598,0x3f676bd8,0x3f64aa59,0x3f6aab7b,0x3f6ff573,0x3f748422
.long 0x3f710908,0x3f75dec6,0x3f79c79d,0x3f7cbfc9,0x3f79c79d,0x3f7cfe73,0x3f7f0e58,0x3f7ff4e6
.long 0x3e47c5c2,0x3d48fb30,0xbdc8bd36,0xbe78cfcc,0x3d96a905,0xbda3308c,0xbe6c9a7f,0xbec1071e
.long 0xbd48fb30,0xbe541501,0xbeb8442a,0xbf00e7e4,0xbe2f10a2,0xbea986c4,0xbef6e0cb,0xbf1ebc12
.long 0x3f7ec46d,0x3f7fec43,0x3f7fb10f,0x3f7e1324,0x3f7fec43,0x3f7e9bc9,0x3f7baccd,0x3f772417
.long 0x3f7d3aac,0x3f791298,0x3f731447,0x3f6b4b0c,0x3f76ba07,0x3f6f6830,0x3f660f88,0x3f5ac450
.long 0xbe94a031,0xbee63375,0xbf187fc0,0xbf396842,0xbecf7bca,0xbf0f8784,0xbf32c8c9,0xbf5064af
.long 0xbf039c3d,0xbf299415,0xbf49d112,0xbf633c5a,0xbf1d7fd1,0xbf40d0da,0xbf5d2d53,0xbf718f57
.long 0x0,0x0,0x0,0x0,0x3e164083,0x3e1c76de,0x3e22abb6,0x3e28defc
.long 0x3e94a031,0x3e9aa086,0x3ea09ae5,0x3ea68f12,0x3edae880,0x3ee363fa,0x3eebcbbb,0x3ef41f07
.long 0x3f3504f3,0x3f226799,0x3f0e39da,0x3ef15aea,0x3f187fc0,0x3f0242b1,0x3ed53641,0x3ea395c5
.long 0x3ef15aea,0x3ebe1d4a,0x3e888e93,0x3e22abb6,0x3eac7cd4,0x3e667c66,0x3de1bc2e,0xbbc90f88
.long 0x3f0e39da,0x3f13682a,0x3f187fc0,0x3f1d7fd1,0x3f2beb4a,0x3f31a81d,0x3f373a23,0x3f3ca003
.long 0x3f45e403,0x3f4bbbf8,0x3f514d3d,0x3f5695e5,0x3f5b941a,0x3f6106f2,0x3f660f88,0x3f6aab7b
.long 0x3e47c5c2,0x3d96a905,0xbd48fb30,0xbe2f10a2,0x3d48fb30,0xbda3308c,0xbe541501,0xbea986c4
.long 0xbdc8bd36,0xbe6c9a7f,0xbeb8442a,0xbef6e0cb,0xbe78cfcc,0xbec1071e,0xbf00e7e4,0xbf1ebc12
.long 0x3f6c835e,0x3f710908,0x3f74fa0b,0x3f7853f8,0x3f7853f8,0x3f7b61fc,0x3f7dabcc,0x3f7f2f9d
.long 0x3f7ec46d,0x3f7fd397,0x3f7fec43,0x3f7f0e58,0x3f7fb10f,0x3f7e4323,0x3f7baccd,0x3f77f110
.long 0xbec3ef15,0xbf039c3d,0xbf226799,0xbf3daef9,0xbf039c3d,0xbf239da9,0xbf3fc767,0xbf577026
.long 0xbf226799,0xbf3fc767,0xbf584853,0xbf6b4b0c,0xbf3daef9,0xbf577026,0xbf6b4b0c,0xbf78b47b
.long 0x3f7b14be,0x3f76ba07,0x3f710908,0x3f6a09a7,0x3f710908,0x3f696591,0x3f604621,0x3f55b993
.long 0x3f61c598,0x3f5695e5,0x3f49d112,0x3f3b8f3b,0x3f4d9f02,0x3f3ebc1b,0x3f2e3bde,0x3f1c420c
.long 0xbf54db31,0xbf6a09a7,0xbf7853f8,0xbf7f4e6d,0xbf676bd8,0xbf772417,0xbf7f0e58,0xbf7eea9d
.long 0xbf74fa0b,0xbf7e70b0,0xbf7f4e6d,0xbf778bc5,0xbf7d3aac,0xbf7fc38f,0xbf791298,0xbf696591
.long 0x0,0x0,0x0,0x0,0x3e2f10a2,0x3e354098,0x3e3b6ecf,0x3e419b37
.long 0x3eac7cd4,0x3eb263ef,0x3eb8442a,0x3ebe1d4a,0x3efc5d27,0x3f0242b1,0x3f064b82,0x3f0a48ad
.long 0x3ec3ef15,0x3e94a031,0x3e47c5c2,0x3dc8bd36,0x3e605c13,0x3dee3876,0x3c490e90,0xbdbc3ac3
.long 0x3d48fb30,0xbd7b2b74,0xbe2f10a2,0xbe8e9a22,0xbdfab273,0xbe72b651,0xbeb263ef,0xbee900b7
.long 0x3f226799,0x3f273656,0x3f2beb4a,0x3f3085bb,0x3f41d870,0x3f46e22a,0x3f4bbbf8,0x3f5064af
.long 0x3f5b941a,0x3f604621,0x3f64aa59,0x3f68bf3c,0x3f6ed89e,0x3f7294f8,0x3f75dec6,0x3f78b47b
.long 0xbe94a031,0xbecf7bca,0xbf039c3d,0xbf1d7fd1,0xbee63375,0xbf0f8784,0xbf299415,0xbf40d0da
.long 0xbf187fc0,0xbf32c8c9,0xbf49d112,0xbf5d2d53,0xbf396842,0xbf5064af,0xbf633c5a,0xbf718f57
.long 0x3f7b14be,0x3f7d3aac,0x3f7ec46d,0x3f7fb10f,0x3f7fec43,0x3f7fe129,0x3f7f0e58,0x3f7d7474
.long 0x3f7d3aac,0x3f7a7302,0x3f76ba07,0x3f721352,0x3f731447,0x3f6d1c1d,0x3f660f88,0x3f5df6be
.long 0xbf54db31,0xbf676bd8,0xbf74fa0b,0xbf7d3aac,0xbf6a09a7,0xbf772417,0xbf7e70b0,0xbf7fc38f
.long 0xbf7853f8,0xbf7f0e58,0xbf7f4e6d,0xbf791298,0xbf7f4e6d,0xbf7eea9d,0xbf778bc5,0xbf696591
.long 0x3f61c598,0x3f584853,0x3f4d9f02,0x3f41d870,0x3f49d112,0x3f3ca003,0x3f2e3bde,0x3f1ebc12
.long 0x3f2beb4a,0x3f1b02c6,0x3f08f59b,0x3eebcbbb,0x3f08f59b,0x3ee900b7,0x3ebe1d4a,0x3e919ddd
.long 0xbf7ec46d,0xbf76ba07,0xbf676bd8,0xbf514d3d,0xbf76ba07,0xbf66becc,0xbf4f7a1f,0xbf31a81d
.long 0xbf676bd8,0xbf4f7a1f,0xbf3085bb,0xbf0b9a6b,0xbf514d3d,0xbf31a81d,0xbf0b9a6b,0xbec1071e
.long 0x3c00,0x3c00,0x3c00,0x3c00,0x3c008000,0x3c008000,0x3c008000,0x3c008000
.long 0x3c00,0x361f3b64,0x39a839a8,0x3b64361f,0x3c008000,0x3b64b61f,0x39a8b9a8,0x361fbb64
.long 0x3c00,0x39a839a8,0x3c000000,0x39a8b9a8,0x3c008000,0x39a8b9a8,0xbc00,0xb9a8b9a8
.long 0x3c00,0x3b64361f,0x39a8b9a8,0xb61fbb64,0x3c008000,0x361fbb64,0xb9a8b9a8,0xbb64361f
.long 0x3c00,0x3c000000,0xbc00,0xbc008000,0x3c008000,0xbc00,0xbc008000,0x80003c00
.long 0x3c00,0x3b64b61f,0xb9a8b9a8,0xb61f3b64,0x3c008000,0xb61fbb64,0xb9a839a8,0x3b64361f
.long 0x3c00,0x39a8b9a8,0xbc008000,0x39a839a8,0x3c008000,0xb9a8b9a8,0x80003c00,0x39a8b9a8
.long 0x3c00,0x361fbb64,0xb9a839a8,0x3b64b61f,0x3c008000,0xbb64b61f,0x39a839a8,0xb61fbb64
.long 0x3c00,0x3c00,0x3c00,0x3c00,0x3c008000,0x3c008000,0x3c008000,0x3c008000
.long 0x3c000000,0x3b64b61f,0x39a8b9a8,0x361fbb64,0xbc00,0xb61fbb64,0xb9a8b9a8,0xbb64b61f
.long 0xbc00,0xb9a8b9a8,0xbc008000,0xb9a839a8,0xbc008000,0xb9a839a8,0x80003c00,0x39a839a8
.long 0xbc008000,0xb61f3b64,0x39a839a8,0x3b64b61f,0x80003c00,0x3b64361f,0x39a8b9a8,0xb61fbb64
.long 0x3c00,0x3c000000,0xbc00,0xbc008000,0x3c008000,0xbc00,0xbc008000,0x80003c00
.long 0x3c000000,0xb61fbb64,0xb9a839a8,0x3b64361f,0xbc00,0xbb64361f,0x39a839a8,0x361fbb64
.long 0xbc00,0xb9a839a8,0x3c000000,0xb9a8b9a8,0xbc008000,0x39a839a8,0xbc00,0xb9a839a8
.long 0xbc008000,0x3b64361f,0xb9a8b9a8,0x361f3b64,0x80003c00,0x361fbb64,0xb9a839a8,0x3b64b61f
.long 0x3c00,0x3c00,0x3c00,0x3c00,0x3c008000,0x3c008000,0x3c008000,0x3c008000
.long 0xbc00,0xb61fbb64,0xb9a8b9a8,0xbb64b61f,0xbc008000,0xbb64361f,0xb9a839a8,0xb61f3b64
.long 0x3c00,0x39a839a8,0x3c000000,0x39a8b9a8,0x3c008000,0x39a8b9a8,0xbc00,0xb9a8b9a8
.long 0xbc00,0xbb64b61f,0xb9a839a8,0x361f3b64,0xbc008000,0xb61f3b64,0x39a839a8,0x3b64b61f
.long 0x3c00,0x3c000000,0xbc00,0xbc008000,0x3c008000,0xbc00,0xbc008000,0x80003c00
.long 0xbc00,0xbb64361f,0x39a839a8,0x361fbb64,0xbc008000,0x361f3b64,0x39a8b9a8,0xbb64b61f
.long 0x3c00,0x39a8b9a8,0xbc008000,0x39a839a8,0x3c008000,0xb9a8b9a8,0x80003c00,0x39a8b9a8
.long 0xbc00,0xb61f3b64,0x39a8b9a8,0xbb64361f,0xbc008000,0x3b64361f,0xb9a8b9a8,0x361f3b64
.long 0x3c00,0x3c00,0x3c00,0x3c00,0x3c008000,0x3c008000,0x3c008000,0x3c008000
.long 0xbc008000,0xbb64361f,0xb9a839a8,0xb61f3b64,0x80003c00,0x361f3b64,0x39a839a8,0x3b64361f
.long 0xbc00,0xb9a8b9a8,0xbc008000,0xb9a839a8,0xbc008000,0xb9a839a8,0x80003c00,0x39a839a8
.long 0x3c000000,0x361fbb64,0xb9a8b9a8,0xbb64361f,0xbc00,0xbb64b61f,0xb9a839a8,0x361f3b64
.long 0x3c00,0x3c000000,0xbc00,0xbc008000,0x3c008000,0xbc00,0xbc008000,0x80003c00
.long 0xbc008000,0x361f3b64,0x39a8b9a8,0xbb64b61f,0x80003c00,0x3b64b61f,0xb9a8b9a8,0xb61f3b64
.long 0xbc00,0xb9a839a8,0x3c000000,0xb9a8b9a8,0xbc008000,0x39a839a8,0xbc00,0xb9a839a8
.long 0x3c000000,0xbb64b61f,0x39a839a8,0xb61fbb64,0xbc00,0xb61f3b64,0x39a8b9a8,0xbb64361f
.long 0x3c00,0xbc00,0x3c00,0xbc00,0x3c008000,0xbc008000,0x3c008000,0xbc008000
.long 0x3c00,0xb61fbb64,0x39a839a8,0xbb64b61f,0x3c008000,0xbb64361f,0x39a8b9a8,0xb61f3b64
.long 0x3c00,0xb9a8b9a8,0x3c000000,0xb9a839a8,0x3c008000,0xb9a839a8,0xbc00,0x39a839a8
.long 0x3c00,0xbb64b61f,0x39a8b9a8,0x361f3b64,0x3c008000,0xb61f3b64,0xb9a8b9a8,0x3b64b61f
.long 0x3c00,0xbc008000,0xbc00,0x3c000000,0x3c008000,0x80003c00,0xbc008000,0xbc00
.long 0x3c00,0xbb64361f,0xb9a8b9a8,0x361fbb64,0x3c008000,0x361f3b64,0xb9a839a8,0xbb64b61f
.long 0x3c00,0xb9a839a8,0xbc008000,0xb9a8b9a8,0x3c008000,0x39a839a8,0x80003c00,0xb9a839a8
.long 0x3c00,0xb61f3b64,0xb9a839a8,0xbb64361f,0x3c008000,0x3b64361f,0x39a839a8,0x361f3b64
.long 0x3c00,0xbc00,0x3c00,0xbc00,0x3c008000,0xbc008000,0x3c008000,0xbc008000
.long 0x3c000000,0xbb64361f,0x39a8b9a8,0xb61f3b64,0xbc00,0x361f3b64,0xb9a8b9a8,0x3b64361f
.long 0xbc00,0x39a839a8,0xbc008000,0x39a8b9a8,0xbc008000,0x39a8b9a8,0x80003c00,0xb9a8b9a8
.long 0xbc008000,0x361fbb64,0x39a839a8,0xbb64361f,0x80003c00,0xbb64b61f,0x39a8b9a8,0x361f3b64
.long 0x3c00,0xbc008000,0xbc00,0x3c000000,0x3c008000,0x80003c00,0xbc008000,0xbc00
.long 0x3c000000,0x361f3b64,0xb9a839a8,0xbb64b61f,0xbc00,0x3b64b61f,0x39a839a8,0xb61f3b64
.long 0xbc00,0x39a8b9a8,0x3c000000,0x39a839a8,0xbc008000,0xb9a8b9a8,0xbc00,0x39a8b9a8
.long 0xbc008000,0xbb64b61f,0xb9a8b9a8,0xb61fbb64,0x80003c00,0xb61f3b64,0xb9a839a8,0xbb64361f
.long 0x3c00,0xbc00,0x3c00,0xbc00,0x3c008000,0xbc008000,0x3c008000,0xbc008000
.long 0xbc00,0x361f3b64,0xb9a8b9a8,0x3b64361f,0xbc008000,0x3b64b61f,0xb9a839a8,0x361fbb64
.long 0x3c00,0xb9a8b9a8,0x3c000000,0xb9a839a8,0x3c008000,0xb9a839a8,0xbc00,0x39a839a8
.long 0xbc00,0x3b64361f,0xb9a839a8,0xb61fbb64,0xbc008000,0x361fbb64,0x39a839a8,0xbb64361f
.long 0x3c00,0xbc008000,0xbc00,0x3c000000,0x3c008000,0x80003c00,0xbc008000,0xbc00
.long 0xbc00,0x3b64b61f,0x39a839a8,0xb61f3b64,0xbc008000,0xb61fbb64,0x39a8b9a8,0x3b64361f
.long 0x3c00,0xb9a839a8,0xbc008000,0xb9a8b9a8,0x3c008000,0x39a839a8,0x80003c00,0xb9a839a8
.long 0xbc00,0x361fbb64,0x39a8b9a8,0x3b64b61f,0xbc008000,0xbb64b61f,0xb9a8b9a8,0xb61fbb64
.long 0x3c00,0xbc00,0x3c00,0xbc00,0x3c008000,0xbc008000,0x3c008000,0xbc008000
.long 0xbc008000,0x3b64b61f,0xb9a839a8,0x361fbb64,0x80003c00,0xb61fbb64,0x39a839a8,0xbb64b61f
.long 0xbc00,0x39a839a8,0xbc008000,0x39a8b9a8,0xbc008000,0x39a8b9a8,0x80003c00,0xb9a8b9a8
.long 0x3c000000,0xb61f3b64,0xb9a8b9a8,0x3b64b61f,0xbc00,0x3b64361f,0xb9a839a8,0xb61fbb64
.long 0x3c00,0xbc008000,0xbc00,0x3c000000,0x3c008000,0x80003c00,0xbc008000,0xbc00
.long 0xbc008000,0xb61fbb64,0x39a8b9a8,0x3b64361f,0x80003c00,0xbb64361f,0xb9a8b9a8,0x361fbb64
.long 0xbc00,0x39a8b9a8,0x3c000000,0x39a839a8,0xbc008000,0xb9a8b9a8,0xbc00,0x39a8b9a8
.long 0x3c000000,0x3b64361f,0x39a839a8,0x361f3b64,0xbc00,0x361fbb64,0x39a8b9a8,0x3b64b61f
.long 0x3c00,0x3c00,0x3c00,0x3c00,0x3c00,0xbc00,0x3c00,0xbc00
.long 0x3c00,0x3b64,0x39a8,0x361f,0x8000,0xb61f,0xb9a8,0xbb64
.long 0x3c00,0x39a8,0x0,0xb9a8,0x8000,0xb9a8,0xbc00,0xb9a8
.long 0x3c00,0x361f,0xb9a8,0xbb64,0x8000,0xbb64,0xb9a8,0x361f
.long 0x3c00,0x0,0xbc00,0x8000,0x8000,0xbc00,0x8000,0x3c00
.long 0x3c00,0xb61f,0xb9a8,0x3b64,0x8000,0xbb64,0x39a8,0x361f
.long 0x3c00,0xb9a8,0x8000,0x39a8,0x8000,0xb9a8,0x3c00,0xb9a8
.long 0x3c00,0xbb64,0x39a8,0xb61f,0x8000,0xb61f,0x39a8,0xbb64
.long 0x3c00,0x3c00,0x3c00,0x3c00,0x3c00,0xbc00,0x3c00,0xbc00
.long 0x0,0xb61f,0xb9a8,0xbb64,0xbc00,0xbb64,0xb9a8,0xb61f
.long 0xbc00,0xb9a8,0x8000,0x39a8,0x8000,0x39a8,0x3c00,0x39a8
.long 0x8000,0x3b64,0x39a8,0xb61f,0x3c00,0x361f,0xb9a8,0xbb64
.long 0x3c00,0x0,0xbc00,0x8000,0x8000,0xbc00,0x8000,0x3c00
.long 0x0,0xbb64,0x39a8,0x361f,0xbc00,0x361f,0x39a8,0xbb64
.long 0xbc00,0x39a8,0x0,0xb9a8,0x8000,0x39a8,0xbc00,0x39a8
.long 0x8000,0x361f,0xb9a8,0x3b64,0x3c00,0xbb64,0x39a8,0xb61f
.long 0x3c00,0x3c00,0x3c00,0x3c00,0x3c00,0xbc00,0x3c00,0xbc00
.long 0xbc00,0xbb64,0xb9a8,0xb61f,0x8000,0x361f,0x39a8,0x3b64
.long 0x3c00,0x39a8,0x0,0xb9a8,0x8000,0xb9a8,0xbc00,0xb9a8
.long 0xbc00,0xb61f,0x39a8,0x3b64,0x8000,0x3b64,0x39a8,0xb61f
.long 0x3c00,0x0,0xbc00,0x8000,0x8000,0xbc00,0x8000,0x3c00
.long 0xbc00,0x361f,0x39a8,0xbb64,0x8000,0x3b64,0xb9a8,0xb61f
.long 0x3c00,0xb9a8,0x8000,0x39a8,0x8000,0xb9a8,0x3c00,0xb9a8
.long 0xbc00,0x3b64,0xb9a8,0x361f,0x8000,0x361f,0xb9a8,0x3b64
.long 0x3c00,0x3c00,0x3c00,0x3c00,0x3c00,0xbc00,0x3c00,0xbc00
.long 0x8000,0x361f,0x39a8,0x3b64,0x3c00,0x3b64,0x39a8,0x361f
.long 0xbc00,0xb9a8,0x8000,0x39a8,0x8000,0x39a8,0x3c00,0x39a8
.long 0x0,0xbb64,0xb9a8,0x361f,0xbc00,0xb61f,0x39a8,0x3b64
.long 0x3c00,0x0,0xbc00,0x8000,0x8000,0xbc00,0x8000,0x3c00
.long 0x8000,0x3b64,0xb9a8,0xb61f,0x3c00,0xb61f,0xb9a8,0x3b64
.long 0xbc00,0x39a8,0x0,0xb9a8,0x8000,0x39a8,0xbc00,0x39a8
.long 0x0,0xb61f,0x39a8,0xbb64,0xbc00,0x3b64,0xb9a8,0x361f
.long 0x3c000000,0x3bd90000,0x3b640000,0x3aa70000,0x80000000,0xb23e0000,0xb61f0000,0xb8720000
.long 0x3c000000,0x3aa70000,0x361f0000,0xb23e0000,0x80000000,0xb8720000,0xbb640000,0xbbd90000
.long 0x3c000000,0x38720000,0xb61f0000,0xbbd90000,0x80000000,0xbaa70000,0xbb640000,0xb23e0000
.long 0x3c000000,0x323e0000,0xbb640000,0xb8720000,0x80000000,0xbbd90000,0xb61f0000,0x3aa70000
.long 0x3c000000,0xb23e0000,0xbb640000,0x38720000,0x80000000,0xbbd90000,0x361f0000,0x3aa70000
.long 0x3c000000,0xb8720000,0xb61f0000,0x3bd90000,0x80000000,0xbaa70000,0x3b640000,0xb23e0000
.long 0x3c000000,0xbaa70000,0x361f0000,0x323e0000,0x80000000,0xb8720000,0x3b640000,0xbbd90000
.long 0x3c000000,0xbbd90000,0x3b640000,0xbaa70000,0x80000000,0xb23e0000,0x361f0000,0xb8720000
.long 0x39a80000,0x38720000,0x361f0000,0x323e0000,0xb9a80000,0xbaa70000,0xbb640000,0xbbd90000
.long 0xb9a80000,0xbbd90000,0xbb640000,0xb8720000,0xb9a80000,0xb23e0000,0x361f0000,0x3aa70000
.long 0xb9a80000,0x323e0000,0x3b640000,0x3aa70000,0x39a80000,0x3bd90000,0x361f0000,0xb8720000
.long 0x39a80000,0x3aa70000,0xb61f0000,0xbbd90000,0x39a80000,0xb8720000,0xbb640000,0x323e0000
.long 0x39a80000,0xbaa70000,0xb61f0000,0x3bd90000,0xb9a80000,0xb8720000,0x3b640000,0x323e0000
.long 0xb9a80000,0xb23e0000,0x3b640000,0xbaa70000,0xb9a80000,0x3bd90000,0xb61f0000,0xb8720000
.long 0xb9a80000,0x3bd90000,0xbb640000,0x38720000,0x39a80000,0xb23e0000,0xb61f0000,0x3aa70000
.long 0x39a80000,0xb8720000,0x361f0000,0xb23e0000,0x39a80000,0xbaa70000,0x3b640000,0xbbd90000
.long 0x0,0xb23e0000,0xb61f0000,0xb8720000,0xbc000000,0xbbd90000,0xbb640000,0xbaa70000
.long 0x80000000,0x38720000,0x3b640000,0x3bd90000,0x3c000000,0x3aa70000,0x361f0000,0xb23e0000
.long 0x0,0xbaa70000,0xbb640000,0xb23e0000,0xbc000000,0xb8720000,0x361f0000,0x3bd90000
.long 0x80000000,0x3bd90000,0x361f0000,0xbaa70000,0x3c000000,0x323e0000,0xbb640000,0xb8720000
.long 0x0,0xbbd90000,0x361f0000,0x3aa70000,0xbc000000,0x323e0000,0x3b640000,0xb8720000
.long 0x80000000,0x3aa70000,0xbb640000,0x323e0000,0x3c000000,0xb8720000,0xb61f0000,0x3bd90000
.long 0x80000000,0xb8720000,0x3b640000,0xbbd90000,0xbc000000,0x3aa70000,0xb61f0000,0xb23e0000
.long 0x80000000,0x323e0000,0xb61f0000,0x38720000,0x3c000000,0xbbd90000,0x3b640000,0xbaa70000
.long 0xb9a80000,0xbaa70000,0xbb640000,0xbbd90000,0xb9a80000,0xb8720000,0xb61f0000,0xb23e0000
.long 0x39a80000,0x323e0000,0xb61f0000,0xbaa70000,0xb9a80000,0xbbd90000,0xbb640000,0xb8720000
.long 0x39a80000,0x3bd90000,0x361f0000,0xb8720000,0x39a80000,0xb23e0000,0xbb640000,0xbaa70000
.long 0xb9a80000,0x38720000,0x3b640000,0xb23e0000,0x39a80000,0x3aa70000,0xb61f0000,0xbbd90000
.long 0xb9a80000,0xb8720000,0x3b640000,0x323e0000,0xb9a80000,0x3aa70000,0x361f0000,0xbbd90000
.long 0x39a80000,0xbbd90000,0x361f0000,0x38720000,0xb9a80000,0xb23e0000,0x3b640000,0xbaa70000
.long 0x39a80000,0xb23e0000,0xb61f0000,0x3aa70000,0x39a80000,0xbbd90000,0x3b640000,0xb8720000
.long 0xb9a80000,0x3aa70000,0xbb640000,0x3bd90000,0x39a80000,0xb8720000,0x361f0000,0xb23e0000
.size tables, 20480
all_end:
.section .rodata,"a"
.p2align 6
.amdhsa_kernel adaLN_cond__spectral_fnet__moe_arch_mod__prompt_kernel
  .amdhsa_next_free_vgpr 256
  .amdhsa_next_free_sgpr 84
  .amdhsa_accum_offset 256
  .amdhsa_group_segment_fixed_size 0
  .amdhsa_kernarg_size 120
  .amdhsa_user_sgpr_count 2
  .amdhsa_user_sgpr_kernarg_segment_ptr 1
  .amdhsa_system_sgpr_workgroup_id_x 1
  .amdhsa_float_denorm_mode_32 3
  .amdhsa_float_denorm_mode_16_64 3
.end_amdhsa_kernel
```

```asm
; @launch grid=(256,1,1) block=(512,1,1) lds=163840
.amdgcn_target "amdgcn-amd-amdhsa--gfx950"
.text
.globl adaLN_cond__spectral_fnet__moe_arch_mod__prompt_kernel
.p2align 8
.type adaLN_cond__spectral_fnet__moe_arch_mod__prompt_kernel,@function
adaLN_cond__spectral_fnet__moe_arch_mod__prompt_kernel:
    s_cmp_ge_u32 s2, 256
    s_cbranch_scc1 k_done
    s_load_dwordx2 s[4:5], s[0:1], 0
    s_load_dwordx4 s[24:27], s[0:1], 96
    s_load_dwordx2 s[6:7], s[0:1], 112
    s_load_dwordx4 s[56:59], s[0:1], 80
    s_load_dwordx4 s[48:51], s[0:1], 48
    s_load_dwordx4 s[52:55], s[0:1], 64
    s_memrealtime s[32:33]
    v_lshrrev_b32 v1, 6, v0
    v_and_b32 v2, 63, v0
    v_readfirstlane_b32 s16, v1
    v_lshlrev_b32 v3, 4, v2
    v_mov_b32 v4, 0
    s_getpc_b64 s[36:37]
h_pc:
    s_and_b32 s34, s2, 7
    s_bfe_u32 s35, s2, 0x40003
    s_cmp_lg_u32 s16, 7
    s_cbranch_scc1 h_npf
    s_lshr_b32 s42, s2, 3
    s_lshl_b32 s42, s42, 11
    v_lshl_add_u32 v4, v2, 7, s42
    v_min_u32 v4, all_end-h_pc-4, v4
    s_mov_b64 exec, 0xffff
    global_load_dword v199, v4, s[36:37]
    s_mov_b64 exec, -1
h_npf:
    s_mov_b32 s11, 0x00020000
    s_mov_b32 s14, 268435456
    s_mov_b32 s15, 0x00020000
    s_bitcmp0_b32 s2, 7
    s_cbranch_scc1 g_start
    s_lshl_b32 s60, s16, 19
    s_lshl_b32 s61, s35, 15
    s_add_u32 s60, s60, s61
    s_lshl_b32 s61, s34, 11
    s_add_u32 s60, s60, s61
    s_add_u32 s61, s60, 16384
    s_lshl_b32 s62, s34, 11
    s_lshl_b32 s63, s35, 7
    s_add_u32 s62, s62, s63
    s_add_u32 s63, s62, 16809984
    s_lshl_b32 s42, s16, 4
    s_add_u32 s62, s62, s42
    s_add_u32 s62, s62, 16777216
    v_mov_b32 v116, 0
    s_mov_b32 s10, 4194304
    s_waitcnt lgkmcnt(0)
    s_mov_b32 s8, s4
    s_mov_b32 s9, s5
    s_mov_b32 s12, s6
    s_mov_b32 s13, s7
    buffer_load_dwordx4 v[64:67], v3, s[8:11], s60 offen offset:0
    buffer_load_dwordx4 v[72:75], v3, s[8:11], s61 offen offset:0
    buffer_load_dwordx4 v[68:71], v3, s[8:11], s60 offen offset:1024
    buffer_load_dwordx4 v[76:79], v3, s[8:11], s61 offen offset:1024
    s_mov_b64 exec, 1
    buffer_load_dword v215, v116, s[12:15], s62 offen sc1
    s_mov_b64 exec, -1
    s_branch f_start
h_non:
    s_mul_i32 s42, s32, 0x9e3779b1
    s_lshr_b32 s43, s42, 15
    s_xor_b32 s42, s42, s43
    s_mul_i32 s42, s42, 0x85ebca6b
    s_xor_b32 s33, s33, s42
    s_lshr_b32 s43, s42, 13
    s_xor_b32 s42, s42, s43
    s_mul_i32 s33, s33, 0xc2b2ae35
    s_add_u32 s33, s33, s32
    s_lshr_b32 s43, s33, 16
    s_xor_b32 s33, s33, s43
    s_mul_i32 s33, s33, 0x27d4eb2f
    s_or_b32 s32, s42, 1
    s_andn2_b32 s33, s33, 7
    v_mov_b32 v10, s32
    v_mov_b32 v11, s33
    v_lshlrev_b32 v12, 3, v2
    s_mov_b32 exec_hi, 0
    global_store_dwordx2 v12, v[10:11], s[26:27] sc1
    s_mov_b32 exec_hi, -1
    s_branch h_nonx
g_start:
    s_or_b32 s40, s2, s16
    s_xor_b32 s16, s16, 4
    v_xor_b32 v1, 4, v1
    v_xor_b32 v0, 0x100, v0
    v_lshlrev_b32 v13, 2, v2
    v_mov_b32 v220, 0
    v_mov_b32 v221, 0
    s_cmp_lt_u32 s16, 4
    s_cbranch_scc1 g_cons
g_load:
    s_and_b32 s69, s16, 3
    s_and_b32 s42, s16, 1
    s_lshl_b32 s42, s42, 7
    v_xor_b32 v6, s42, v3
    v_xor_b32 v7, 32, v6
    v_xor_b32 v8, 64, v6
    v_xor_b32 v9, 96, v6
    s_lshl_b32 s41, s35, 3
    s_add_u32 s41, s41, s69
    s_mul_i32 s18, s41, 98304
    s_lshl_b32 s41, s34, 10
    s_cmp_ge_u32 s34, 6
    s_cselect_b32 s42, 2048, 0
    s_add_u32 s18, s18, s41
    s_add_u32 s18, s18, s42
    s_lshl_b32 s68, s69, 13
    s_mov_b32 s10, 12582912
    s_waitcnt lgkmcnt(0)
    s_mov_b32 s8, s58
    s_mov_b32 s9, s59
    s_mov_b32 s12, s6
    s_mov_b32 s13, s7
    s_cmp_eq_u32 s40, 0
    s_cbranch_scc1 h_non
h_nonx:
    s_lshl_b32 s42, s69, 7
    s_add_u32 s42, s42, 139264
    s_mov_b32 m0, s42
    s_lshl_b32 s42, s35, 7
    v_add_u32 v10, s42, v13
    s_mov_b32 exec_hi, 0
    global_load_lds_dword v10, s[56:57]
    s_mov_b32 exec_hi, -1
    s_add_u32 s43, s68, 32768
    s_mov_b32 m0, s43
    s_add_u32 s42, s18, 0
    buffer_load_dwordx4 v6, s[8:11], s42 offen nt lds
    s_add_u32 s43, s68, 33792
    s_mov_b32 m0, s43
    s_add_u32 s42, s18, 12288
    buffer_load_dwordx4 v7, s[8:11], s42 offen nt lds
    s_add_u32 s43, s68, 34816
    s_mov_b32 m0, s43
    s_add_u32 s42, s18, 24576
    buffer_load_dwordx4 v8, s[8:11], s42 offen nt lds
    s_add_u32 s43, s68, 35840
    s_mov_b32 m0, s43
    s_add_u32 s42, s18, 36864
    buffer_load_dwordx4 v9, s[8:11], s42 offen nt lds
    s_add_u32 s43, s68, 36864
    s_mov_b32 m0, s43
    s_add_u32 s42, s18, 49152
    buffer_load_dwordx4 v6, s[8:11], s42 offen nt lds
    s_add_u32 s43, s68, 37888
    s_mov_b32 m0, s43
    s_add_u32 s42, s18, 61440
    buffer_load_dwordx4 v7, s[8:11], s42 offen nt lds
    s_add_u32 s43, s68, 38912
    s_mov_b32 m0, s43
    s_add_u32 s42, s18, 73728
    buffer_load_dwordx4 v8, s[8:11], s42 offen nt lds
    s_add_u32 s43, s68, 39936
    s_mov_b32 m0, s43
    s_add_u32 s42, s18, 86016
    buffer_load_dwordx4 v9, s[8:11], s42 offen nt lds
    s_lshl_b32 s19, s35, 2
    s_add_u32 s19, s19, s69
    s_mul_i32 s19, s19, 196608
    s_lshl_b32 s42, s34, 9
    s_add_u32 s19, s19, s42
    s_and_b32 s42, s34, 4
    s_lshl_b32 s42, s42, 9
    s_add_u32 s19, s19, s42
    s_add_u32 s19, s19, 6144
    v_lshrrev_b32 v5, 5, v2
    v_and_b32 v14, 0x1f0, v3
    v_lshlrev_b32 v12, 5, v5
    v_xor_b32 v14, v14, v12
    s_movk_i32 s42, 12288
    v_mad_u32_u24 v14, v5, s42, v14
    v_bfe_u32 v5, v0, 5, 1
    v_lshlrev_b32 v5, 3, v5
    v_bfe_u32 v12, v0, 3, 2
    v_add_u32 v5, v5, v12
    v_bfe_u32 v12, v0, 4, 2
    v_lshlrev_b32 v12, 1, v12
    v_xor_b32 v12, v12, v0
    v_and_b32 v12, 7, v12
    v_lshlrev_b32 v12, 4, v12
    s_movk_i32 s42, 7168
    v_mad_u32_u24 v5, v5, s42, v12
    s_mov_b32 s20, s26
    s_mov_b32 s21, s27
    s_mov_b32 s26, 4194304
    s_mov_b32 s27, 0x00020000
    s_and_b32 s65, s35, 1
    s_lshr_b32 s40, s35, 1
    s_mul_i32 s64, s34, 7
    s_add_u32 s64, s64, s40
    s_lshl_b32 s41, s34, 1
    s_add_u32 s41, s41, s65
    s_cmp_ge_u32 s35, 14
    s_cselect_b32 s66, 1, 0
    s_cselect_b32 s64, s41, s64
    v_lshrrev_b32 v10, 2, v2
    v_and_b32 v15, 3, v0
    v_bfe_u32 v11, v0, 3, 2
    v_xor_b32 v12, v11, v1
    v_and_b32 v12, 3, v12
    v_lshlrev_b32 v12, 5, v12
    v_lshl_add_u32 v12, v10, 7, v12
    v_lshl_add_u32 v12, v15, 3, v12
    v_lshrrev_b32 v16, 2, v1
    v_lshl_add_u32 v12, v16, 15, v12
    v_add_u32 v21, 65536, v12
    s_lshl_b32 s67, s65, 3
    s_add_u32 s67, s67, s69
    s_mul_i32 s67, s67, 458752
    s_lshl_b32 s42, s64, 7
    s_add_u32 s67, s67, s42
    s_mov_b32 s56, s50
    s_mov_b32 s57, s51
    s_mov_b32 s58, 7340032
    s_mov_b32 s59, 0x00020000
    s_mov_b32 s44, s52
    s_mov_b32 s45, s53
    s_mov_b32 s46, 7340032
    s_mov_b32 s47, 0x00020000
    s_waitcnt vmcnt(7)
    s_add_u32 s43, s68, 65536
    s_mov_b32 m0, s43
    s_add_u32 s42, s18, 393216
    buffer_load_dwordx4 v6, s[8:11], s42 offen nt lds
    s_waitcnt vmcnt(7)
    s_add_u32 s43, s68, 66560
    s_mov_b32 m0, s43
    s_add_u32 s42, s18, 405504
    buffer_load_dwordx4 v7, s[8:11], s42 offen nt lds
    s_load_dwordx2 s[32:33], s[20:21], 128
    s_waitcnt vmcnt(7)
    s_add_u32 s43, s68, 67584
    s_mov_b32 m0, s43
    s_add_u32 s42, s18, 417792
    buffer_load_dwordx4 v8, s[8:11], s42 offen nt lds
    s_waitcnt vmcnt(7)
    s_add_u32 s43, s68, 68608
    s_mov_b32 m0, s43
    s_add_u32 s42, s18, 430080
    buffer_load_dwordx4 v9, s[8:11], s42 offen nt lds
    s_waitcnt vmcnt(7)
    s_add_u32 s43, s68, 69632
    s_mov_b32 m0, s43
    s_add_u32 s42, s18, 442368
    buffer_load_dwordx4 v6, s[8:11], s42 offen nt lds
    s_waitcnt vmcnt(7)
    s_add_u32 s43, s68, 70656
    s_mov_b32 m0, s43
    s_add_u32 s42, s18, 454656
    buffer_load_dwordx4 v7, s[8:11], s42 offen nt lds
    s_waitcnt vmcnt(7)
    s_add_u32 s43, s68, 71680
    s_mov_b32 m0, s43
    s_add_u32 s42, s18, 466944
    buffer_load_dwordx4 v8, s[8:11], s42 offen nt lds
    s_waitcnt vmcnt(7)
    s_barrier
    s_add_u32 s43, s68, 72704
    s_mov_b32 m0, s43
    s_add_u32 s42, s18, 479232
    buffer_load_dwordx4 v9, s[8:11], s42 offen nt lds
    s_waitcnt lgkmcnt(0)
    s_cmp_lg_u32 s32, 0
    s_cbranch_scc1 g_n2x
    s_load_dwordx2 s[32:33], s[20:21], 192
    s_mov_b32 s83, 0
    v_mov_b32 v122, 0
    s_waitcnt lgkmcnt(0)
g_n2:
    s_cmp_lg_u32 s32, 0
    s_cbranch_scc1 g_n2x
    global_load_dwordx2 v[120:121], v122, s[20:21] sc1
    s_waitcnt vmcnt(0)
    v_readfirstlane_b32 s32, v120
    v_readfirstlane_b32 s33, v121
    s_add_u32 s83, s83, 1
    s_cmp_lt_u32 s83, 0x40000
    s_cbranch_scc1 g_n2
g_n2x:
    s_cmp_eq_u32 s66, 0
    s_cbranch_scc1 m_load
    s_waitcnt vmcnt(0)
    s_barrier
    s_barrier
    s_branch x_start
m_load:
    s_waitcnt vmcnt(0)
    s_barrier
    s_barrier
    s_waitcnt vmcnt(7)
    v_xor_b32 v4, 0, v14
    s_add_u32 s43, s68, 98304
    s_mov_b32 m0, s43
    s_add_u32 s42, s19, 0
    buffer_load_dwordx4 v4, s[8:11], s42 offen nt lds
    s_waitcnt vmcnt(7)
    v_xor_b32 v4, 64, v14
    s_add_u32 s43, s68, 99328
    s_mov_b32 m0, s43
    s_add_u32 s42, s19, 24576
    buffer_load_dwordx4 v4, s[8:11], s42 offen nt lds
    s_waitcnt vmcnt(7)
    v_xor_b32 v4, 0, v14
    s_add_u32 s43, s68, 100352
    s_mov_b32 m0, s43
    s_add_u32 s42, s19, 49152
    buffer_load_dwordx4 v4, s[8:11], s42 offen nt lds
    s_waitcnt vmcnt(7)
    v_xor_b32 v4, 64, v14
    s_add_u32 s43, s68, 101376
    s_mov_b32 m0, s43
    s_add_u32 s42, s19, 73728
    buffer_load_dwordx4 v4, s[8:11], s42 offen nt lds
    s_waitcnt vmcnt(7)
    v_xor_b32 v4, 128, v14
    s_add_u32 s43, s68, 102400
    s_mov_b32 m0, s43
    s_add_u32 s42, s19, 98304
    buffer_load_dwordx4 v4, s[8:11], s42 offen nt lds
    s_waitcnt vmcnt(7)
    v_xor_b32 v4, 192, v14
    s_add_u32 s43, s68, 103424
    s_mov_b32 m0, s43
    s_add_u32 s42, s19, 122880
    buffer_load_dwordx4 v4, s[8:11], s42 offen nt lds
    s_waitcnt vmcnt(7)
    v_xor_b32 v4, 128, v14
    s_add_u32 s43, s68, 104448
    s_mov_b32 m0, s43
    s_add_u32 s42, s19, 147456
    buffer_load_dwordx4 v4, s[8:11], s42 offen nt lds
    s_waitcnt vmcnt(7)
    v_xor_b32 v4, 192, v14
    s_add_u32 s43, s68, 105472
    s_mov_b32 m0, s43
    s_add_u32 s42, s19, 172032
    buffer_load_dwordx4 v4, s[8:11], s42 offen nt lds
    s_waitcnt vmcnt(7)
    s_add_u32 s43, s68, 0
    s_mov_b32 m0, s43
    s_add_u32 s42, s67, 0
    buffer_load_dwordx4 v5, s[56:59], s42 offen nt lds
    s_waitcnt vmcnt(7)
    s_add_u32 s43, s68, 1024
    s_mov_b32 m0, s43
    s_add_u32 s42, s67, 114688
    buffer_load_dwordx4 v5, s[56:59], s42 offen nt lds
    s_waitcnt vmcnt(7)
    s_add_u32 s43, s68, 2048
    s_mov_b32 m0, s43
    s_add_u32 s42, s67, 28672
    buffer_load_dwordx4 v5, s[56:59], s42 offen nt lds
    s_waitcnt vmcnt(7)
    s_add_u32 s43, s68, 3072
    s_mov_b32 m0, s43
    s_add_u32 s42, s67, 143360
    buffer_load_dwordx4 v5, s[56:59], s42 offen nt lds
    s_waitcnt vmcnt(4)
    s_barrier
    s_barrier
    s_waitcnt vmcnt(7)
    s_add_u32 s43, s68, 4096
    s_mov_b32 m0, s43
    s_add_u32 s42, s67, 229376
    buffer_load_dwordx4 v5, s[56:59], s42 offen nt lds
    s_waitcnt vmcnt(7)
    s_add_u32 s43, s68, 5120
    s_mov_b32 m0, s43
    s_add_u32 s42, s67, 344064
    buffer_load_dwordx4 v5, s[56:59], s42 offen nt lds
    s_waitcnt vmcnt(7)
    s_add_u32 s43, s68, 6144
    s_mov_b32 m0, s43
    s_add_u32 s42, s67, 258048
    buffer_load_dwordx4 v5, s[56:59], s42 offen nt lds
    s_waitcnt vmcnt(7)
    s_add_u32 s43, s68, 7168
    s_mov_b32 m0, s43
    s_add_u32 s42, s67, 372736
    buffer_load_dwordx4 v5, s[56:59], s42 offen nt lds
    s_waitcnt vmcnt(9)
    s_add_u32 s43, s68, 32768
    s_mov_b32 m0, s43
    s_add_u32 s42, s67, 1835008
    buffer_load_dwordx4 v5, s[56:59], s42 offen nt lds
    s_waitcnt vmcnt(9)
    s_add_u32 s43, s68, 33792
    s_mov_b32 m0, s43
    s_add_u32 s42, s67, 1949696
    buffer_load_dwordx4 v5, s[56:59], s42 offen nt lds
    s_waitcnt vmcnt(9)
    s_add_u32 s43, s68, 34816
    s_mov_b32 m0, s43
    s_add_u32 s42, s67, 1863680
    buffer_load_dwordx4 v5, s[56:59], s42 offen nt lds
    s_waitcnt vmcnt(9)
    s_add_u32 s43, s68, 35840
    s_mov_b32 m0, s43
    s_add_u32 s42, s67, 1978368
    buffer_load_dwordx4 v5, s[56:59], s42 offen nt lds
    s_waitcnt vmcnt(9)
    s_add_u32 s43, s68, 36864
    s_mov_b32 m0, s43
    s_add_u32 s42, s67, 2064384
    buffer_load_dwordx4 v5, s[56:59], s42 offen nt lds
    s_waitcnt vmcnt(9)
    s_add_u32 s43, s68, 37888
    s_mov_b32 m0, s43
    s_add_u32 s42, s67, 2179072
    buffer_load_dwordx4 v5, s[56:59], s42 offen nt lds
    s_waitcnt vmcnt(9)
    s_add_u32 s43, s68, 38912
    s_mov_b32 m0, s43
    s_add_u32 s42, s67, 2093056
    buffer_load_dwordx4 v5, s[56:59], s42 offen nt lds
    s_waitcnt vmcnt(9)
    s_add_u32 s43, s68, 39936
    s_mov_b32 m0, s43
    s_add_u32 s42, s67, 2207744
    buffer_load_dwordx4 v5, s[56:59], s42 offen nt lds
    s_waitcnt vmcnt(9)
    s_add_u32 s43, s68, 65536
    s_mov_b32 m0, s43
    s_add_u32 s42, s67, 0
    buffer_load_dwordx4 v5, s[44:47], s42 offen nt lds
    s_waitcnt vmcnt(9)
    s_barrier
    s_add_u32 s43, s68, 66560
    s_mov_b32 m0, s43
    s_add_u32 s42, s67, 114688
    buffer_load_dwordx4 v5, s[44:47], s42 offen nt lds
    s_waitcnt vmcnt(9)
    s_add_u32 s43, s68, 67584
    s_mov_b32 m0, s43
    s_add_u32 s42, s67, 28672
    buffer_load_dwordx4 v5, s[44:47], s42 offen nt lds
    s_waitcnt vmcnt(9)
    s_add_u32 s43, s68, 68608
    s_mov_b32 m0, s43
    s_add_u32 s42, s67, 143360
    buffer_load_dwordx4 v5, s[44:47], s42 offen nt lds
    s_waitcnt vmcnt(9)
    s_add_u32 s43, s68, 69632
    s_mov_b32 m0, s43
    s_add_u32 s42, s67, 229376
    buffer_load_dwordx4 v5, s[44:47], s42 offen nt lds
    s_waitcnt vmcnt(9)
    s_add_u32 s43, s68, 70656
    s_mov_b32 m0, s43
    s_add_u32 s42, s67, 344064
    buffer_load_dwordx4 v5, s[44:47], s42 offen nt lds
    s_waitcnt vmcnt(9)
    s_add_u32 s43, s68, 71680
    s_mov_b32 m0, s43
    s_add_u32 s42, s67, 258048
    buffer_load_dwordx4 v5, s[44:47], s42 offen nt lds
    s_waitcnt vmcnt(9)
    s_add_u32 s43, s68, 72704
    s_mov_b32 m0, s43
    s_add_u32 s42, s67, 372736
    buffer_load_dwordx4 v5, s[44:47], s42 offen nt lds
    s_waitcnt vmcnt(9)
    s_add_u32 s43, s68, 98304
    s_mov_b32 m0, s43
    s_add_u32 s42, s67, 1835008
    buffer_load_dwordx4 v5, s[44:47], s42 offen nt lds
    s_waitcnt vmcnt(9)
    s_barrier
    ds_read_b64_tr_b16 v[64:65], v12 offset:0
    ds_read_b64_tr_b16 v[66:67], v12 offset:2048
    ds_read_b64_tr_b16 v[68:69], v12 offset:4096
    ds_read_b64_tr_b16 v[70:71], v12 offset:6144
    ds_read_b64_tr_b16 v[72:73], v12 offset:8192
    ds_read_b64_tr_b16 v[74:75], v12 offset:10240
    ds_read_b64_tr_b16 v[76:77], v12 offset:12288
    ds_read_b64_tr_b16 v[78:79], v12 offset:14336
    ds_read_b64_tr_b16 v[80:81], v12 offset:16384
    ds_read_b64_tr_b16 v[82:83], v12 offset:18432
    ds_read_b64_tr_b16 v[84:85], v12 offset:20480
    ds_read_b64_tr_b16 v[86:87], v12 offset:22528
    ds_read_b64_tr_b16 v[88:89], v12 offset:24576
    ds_read_b64_tr_b16 v[90:91], v12 offset:26624
    ds_read_b64_tr_b16 v[92:93], v12 offset:28672
    ds_read_b64_tr_b16 v[94:95], v12 offset:30720
    s_add_u32 s43, s68, 99328
    s_mov_b32 m0, s43
    s_add_u32 s42, s67, 1949696
    buffer_load_dwordx4 v5, s[44:47], s42 offen nt lds
    s_waitcnt vmcnt(9)
    s_add_u32 s43, s68, 100352
    s_mov_b32 m0, s43
    s_add_u32 s42, s67, 1863680
    buffer_load_dwordx4 v5, s[44:47], s42 offen nt lds
    s_waitcnt vmcnt(9)
    s_add_u32 s43, s68, 101376
    s_mov_b32 m0, s43
    s_add_u32 s42, s67, 1978368
    buffer_load_dwordx4 v5, s[44:47], s42 offen nt lds
    s_waitcnt vmcnt(9)
    s_add_u32 s43, s68, 102400
    s_mov_b32 m0, s43
    s_add_u32 s42, s67, 2064384
    buffer_load_dwordx4 v5, s[44:47], s42 offen nt lds
    s_waitcnt vmcnt(9)
    s_add_u32 s43, s68, 103424
    s_mov_b32 m0, s43
    s_add_u32 s42, s67, 2179072
    buffer_load_dwordx4 v5, s[44:47], s42 offen nt lds
    s_waitcnt vmcnt(9)
    s_add_u32 s43, s68, 104448
    s_mov_b32 m0, s43
    s_add_u32 s42, s67, 2093056
    buffer_load_dwordx4 v5, s[44:47], s42 offen nt lds
    s_waitcnt vmcnt(9)
    s_add_u32 s43, s68, 105472
    s_mov_b32 m0, s43
    s_add_u32 s42, s67, 2207744
    buffer_load_dwordx4 v5, s[44:47], s42 offen nt lds
    s_branch m_join
g_cons:
    s_lshl_b32 s38, s2, 13
    s_lshl_b32 s39, s16, 11
    s_add_u32 s38, s38, s39
    s_add_u32 s38, s38, 17825792
    s_lshl_b32 s29, s34, 4
    s_add_u32 s29, s29, s35
    s_lshl_b32 s29, s29, 12
    s_add_u32 s29, s29, 19922944
    s_lshl_b32 s30, s16, 9
    s_add_u32 s30, s30, s29
    s_lshl_b32 s31, s16, 8
    s_add_u32 s31, s31, s29
    s_add_u32 s31, s31, 2048
    v_lshlrev_b32 v8, 1, v2
    v_lshlrev_b32 v9, 7, v2
    v_mov_b32 v104, -1
    v_mov_b32 v105, -1
    v_mov_b32 v106, -1
    v_mov_b32 v107, -1
    s_waitcnt lgkmcnt(0)
    s_mov_b32 s12, s6
    s_mov_b32 s13, s7
    s_cmp_eq_u32 s16, 1
    s_cselect_b64 exec, 0xffffff, 1
    buffer_load_dword v245, v9, s[12:15], s29 offen sc1
    s_mov_b64 exec, -1
    v_mov_b32 v14, 0
    s_mov_b32 s8, s58
    s_mov_b32 s9, s59
    s_mov_b32 s10, 12582912
    s_mov_b32 s11, 0x00020000
    s_mov_b32 s20, s26
    s_mov_b32 s21, s27
    s_mov_b32 s26, 4194304
    s_mov_b32 s27, 0x00020000
    s_and_b32 s65, s35, 1
    s_lshr_b32 s40, s35, 1
    s_mul_i32 s64, s34, 7
    s_add_u32 s64, s64, s40
    s_lshl_b32 s41, s34, 1
    s_add_u32 s41, s41, s65
    s_cmp_ge_u32 s35, 14
    s_cselect_b32 s66, 1, 0
    s_cselect_b32 s64, s41, s64
    v_lshrrev_b32 v10, 2, v2
    v_and_b32 v15, 3, v0
    v_bfe_u32 v11, v0, 3, 2
    v_xor_b32 v12, v11, v1
    v_and_b32 v12, 3, v12
    v_lshlrev_b32 v12, 5, v12
    v_lshl_add_u32 v12, v10, 7, v12
    v_lshl_add_u32 v12, v15, 3, v12
    v_lshrrev_b32 v16, 2, v1
    v_lshl_add_u32 v12, v16, 15, v12
    v_add_u32 v21, 65536, v12
    v_bfe_u32 v22, v0, 2, 3
    v_lshlrev_b32 v22, 5, v22
    v_lshl_add_u32 v22, v15, 3, v22
    v_bfe_u32 v23, v0, 2, 2
    v_bfe_u32 v24, v0, 4, 2
    v_lshl_add_u32 v23, v24, 3, v23
    v_lshl_add_u32 v200, v23, 10, v22
    v_lshl_add_u32 v200, v1, 8, v200
    v_add_u32 v200, 32768, v200
    v_lshlrev_b32 v25, 7, v1
    v_xor_b32 v22, v22, v25
    v_lshl_add_u32 v208, v23, 9, v22
    v_add_u32 v208, 98304, v208
    v_cmp_eq_u32 s[60:61], 1, v24
    v_cmp_eq_u32 s[62:63], 2, v24
    v_cmp_eq_u32 s[72:73], 3, v24
    v_add_u32 v8, v8, v25
    v_add_u32 v8, 139264, v8
    v_lshl_add_u32 v10, v24, 4, v25
    v_add_u32 v10, 139264, v10
    v_xor_b32 v201, 32, v200
    v_xor_b32 v202, 64, v200
    v_xor_b32 v203, 96, v200
    v_xor_b32 v204, 128, v200
    v_xor_b32 v205, 160, v200
    v_xor_b32 v206, 192, v200
    v_xor_b32 v207, 224, v200
    v_xor_b32 v209, 32, v208
    v_xor_b32 v210, 64, v208
    v_xor_b32 v211, 96, v208
    s_sleep 8
    s_load_dwordx2 s[32:33], s[20:21], 128
    buffer_store_dwordx4 v[104:107], v3, s[12:15], s38 offen offset:0 sc1
    buffer_store_dwordx4 v[104:107], v3, s[12:15], s38 offen offset:1024 sc1
    s_waitcnt lgkmcnt(0)
    s_cmp_lg_u32 s32, 0
    s_cbranch_scc1 g_nnx
    s_load_dwordx2 s[32:33], s[20:21], 192
    s_mov_b32 s83, 0
    v_mov_b32 v114, 0
    s_waitcnt lgkmcnt(0)
g_nn:
    s_cmp_lg_u32 s32, 0
    s_cbranch_scc1 g_nnx
    global_load_dwordx2 v[112:113], v114, s[20:21] sc1
    s_waitcnt vmcnt(0)
    v_readfirstlane_b32 s32, v112
    v_readfirstlane_b32 s33, v113
    s_add_u32 s83, s83, 1
    s_cmp_lt_u32 s83, 0x40000
    s_cbranch_scc1 g_nn
g_nnx:
    v_mov_b32 v212, s32
    v_mov_b32 v213, s33
    v_and_b32 v214, 7, v0
    v_lshlrev_b32 v214, 3, v214
    v_lshrrev_b64 v[212:213], v214, v[212:213]
    v_and_b32 v212, 0xff, v212
    s_movk_i32 s74, 0xff00
    s_lshr_b32 s22, s64, 2
    s_lshl_b32 s22, s22, 12
    s_and_b32 s42, s64, 1
    s_lshl_b32 s42, s42, 8
    s_add_u32 s22, s22, s42
    s_and_b32 s42, s64, 2
    s_lshl_b32 s42, s42, 5
    s_add_u32 s22, s22, s42
    s_add_u32 s22, s22, 16875520
    s_lshr_b32 s23, s64, 3
    s_lshl_b32 s23, s23, 12
    s_and_b32 s42, s64, 3
    s_lshl_b32 s42, s42, 7
    s_add_u32 s23, s23, s42
    s_and_b32 s42, s64, 4
    s_lshl_b32 s42, s42, 4
    s_add_u32 s23, s23, s42
    s_add_u32 s23, s23, 16896000
    v_bfe_u32 v24, v0, 2, 1
    v_bfe_u32 v25, v0, 3, 2
    v_bfe_u32 v26, v0, 5, 1
    v_lshlrev_b32 v220, 4, v15
    v_lshl_add_u32 v220, v24, 9, v220
    v_lshl_add_u32 v220, v25, 10, v220
    v_lshl_add_u32 v220, v26, 7, v220
    v_lshlrev_b32 v221, 7, v15
    v_lshl_add_u32 v221, v24, 6, v221
    v_lshl_add_u32 v221, v25, 4, v221
    v_lshl_add_u32 v221, v26, 9, v221
    s_lshl_b32 s79, s64, 7
    s_add_u32 s79, s79, 16850944
    s_cmp_ge_u32 s16, s66
    s_cbranch_scc1 g_nw
    s_mov_b32 s44, s48
    s_mov_b32 s45, s49
    s_mov_b32 s46, 2048
    s_mov_b32 s47, 0x00020000
    v_lshrrev_b32 v11, 1, v221
    s_and_b32 s42, s64, 3
    s_lshl_b32 s42, s42, 9
    buffer_load_dwordx2 v[52:53], v11, s[44:47], s42 offen
    v_mov_b32 v216, s32
    v_mov_b32 v217, s33
    v_and_b32 v218, 1, v0
    v_cmp_eq_u32 vcc, 1, v218
    s_nop 1
    v_cndmask_b32 v216, v216, v217, vcc
    v_bfe_u32 v217, v216, 8, 8
    v_bfe_u32 v218, v216, 16, 8
    v_lshrrev_b32 v219, 24, v216
    v_and_b32 v216, 0xff, v216
    v_not_b32 v24, v216
    v_not_b32 v25, v217
    v_not_b32 v26, v218
    v_not_b32 v27, v219
    buffer_store_dwordx4 v[24:27], v220, s[12:15], s22 offen sc1
    s_add_u32 s42, s22, 4096
    s_cmp_ge_u32 s64, 12
    s_cselect_b32 s42, s42, s22
    buffer_store_dwordx4 v[24:27], v220, s[12:15], s42 offen sc1
    s_mov_b32 exec_hi, 0
    buffer_store_dwordx4 v[24:27], v220, s[12:15], s23 offen sc1
    s_mov_b64 exec, 0xff
    buffer_store_dwordx4 v[104:107], v3, s[12:15], s79 offen sc1
    s_mov_b64 exec, -1
g_nw:
    s_barrier
    ds_read_u16 v6, v8
    s_waitcnt lgkmcnt(0)
    v_lshlrev_b32 v6, 16, v6
    v_mul_f32 v24, 0xbfb8aa3b, v6
    v_exp_f32 v24, v24
    s_nop 0
    v_add_f32 v24, 1.0, v24
    v_rcp_f32 v24, v24
    s_nop 0
    v_mul_f32 v6, v6, v24
    v_cvt_pk_bf16_f32 v6, v6, v6
    ds_write_b16 v8, v6
    ds_read_b128 v[120:123], v10
    ds_read_b128 v[124:127], v10 offset:64
    ds_read_b64_tr_b16 v[128:129], v200 offset:0
    ds_read_b64_tr_b16 v[130:131], v200 offset:4096
    ds_read_b64_tr_b16 v[132:133], v201 offset:0
    ds_read_b64_tr_b16 v[134:135], v201 offset:4096
    ds_read_b64_tr_b16 v[136:137], v202 offset:0
    ds_read_b64_tr_b16 v[138:139], v202 offset:4096
    ds_read_b64_tr_b16 v[140:141], v203 offset:0
    ds_read_b64_tr_b16 v[142:143], v203 offset:4096
    ds_read_b64_tr_b16 v[144:145], v204 offset:0
    ds_read_b64_tr_b16 v[146:147], v204 offset:4096
    ds_read_b64_tr_b16 v[148:149], v205 offset:0
    ds_read_b64_tr_b16 v[150:151], v205 offset:4096
    ds_read_b64_tr_b16 v[152:153], v206 offset:0
    ds_read_b64_tr_b16 v[154:155], v206 offset:4096
    s_waitcnt lgkmcnt(12)
    v_mfma_f32_16x16x32_bf16 v[64:67], v[120:123], v[128:131], 0
    ds_read_b64_tr_b16 v[156:157], v207 offset:0
    ds_read_b64_tr_b16 v[158:159], v207 offset:4096
    s_waitcnt lgkmcnt(12)
    v_mfma_f32_16x16x32_bf16 v[68:71], v[120:123], v[132:135], 0
    s_waitcnt lgkmcnt(10)
    v_mfma_f32_16x16x32_bf16 v[72:75], v[120:123], v[136:139], 0
    s_waitcnt lgkmcnt(8)
    v_mfma_f32_16x16x32_bf16 v[76:79], v[120:123], v[140:143], 0
    s_waitcnt lgkmcnt(6)
    v_mfma_f32_16x16x32_bf16 v[80:83], v[120:123], v[144:147], 0
    s_waitcnt lgkmcnt(4)
    v_mfma_f32_16x16x32_bf16 v[84:87], v[120:123], v[148:151], 0
    s_waitcnt lgkmcnt(2)
    v_mfma_f32_16x16x32_bf16 v[88:91], v[120:123], v[152:155], 0
    s_waitcnt lgkmcnt(0)
    v_mfma_f32_16x16x32_bf16 v[92:95], v[120:123], v[156:159], 0
    s_waitcnt vmcnt(0)
    s_barrier
    ds_read_b64_tr_b16 v[128:129], v200 offset:32768
    ds_read_b64_tr_b16 v[130:131], v200 offset:36864
    ds_read_b64_tr_b16 v[132:133], v201 offset:32768
    ds_read_b64_tr_b16 v[134:135], v201 offset:36864
    ds_read_b64_tr_b16 v[136:137], v202 offset:32768
    ds_read_b64_tr_b16 v[138:139], v202 offset:36864
    ds_read_b64_tr_b16 v[140:141], v203 offset:32768
    ds_read_b64_tr_b16 v[142:143], v203 offset:36864
    ds_read_b64_tr_b16 v[144:145], v204 offset:32768
    ds_read_b64_tr_b16 v[146:147], v204 offset:36864
    ds_read_b64_tr_b16 v[148:149], v205 offset:32768
    ds_read_b64_tr_b16 v[150:151], v205 offset:36864
    ds_read_b64_tr_b16 v[152:153], v206 offset:32768
    ds_read_b64_tr_b16 v[154:155], v206 offset:36864
    s_waitcnt lgkmcnt(12)
    v_mfma_f32_16x16x32_bf16 v[64:67], v[124:127], v[128:131], v[64:67]
    ds_read_b64_tr_b16 v[156:157], v207 offset:32768
    ds_read_b64_tr_b16 v[158:159], v207 offset:36864
    s_waitcnt lgkmcnt(12)
    v_mfma_f32_16x16x32_bf16 v[68:71], v[124:127], v[132:135], v[68:71]
    s_waitcnt lgkmcnt(10)
    v_mfma_f32_16x16x32_bf16 v[72:75], v[124:127], v[136:139], v[72:75]
    s_waitcnt lgkmcnt(8)
    v_mfma_f32_16x16x32_bf16 v[76:79], v[124:127], v[140:143], v[76:79]
    s_waitcnt lgkmcnt(6)
    v_mfma_f32_16x16x32_bf16 v[80:83], v[124:127], v[144:147], v[80:83]
    s_waitcnt lgkmcnt(4)
    v_mfma_f32_16x16x32_bf16 v[84:87], v[124:127], v[148:151], v[84:87]
    s_waitcnt lgkmcnt(2)
    v_mfma_f32_16x16x32_bf16 v[88:91], v[124:127], v[152:155], v[88:91]
    s_waitcnt lgkmcnt(0)
    v_mfma_f32_16x16x32_bf16 v[92:95], v[124:127], v[156:159], v[92:95]
    v_cndmask_b32 v64, v64, v68, s[60:61]
    v_cndmask_b32 v64, v64, v72, s[62:63]
    v_cndmask_b32 v64, v64, v76, s[72:73]
    v_and_or_b32 v224, v64, s74, v212
    v_cndmask_b32 v80, v80, v84, s[60:61]
    s_nop 0
    v_cndmask_b32 v80, v80, v88, s[62:63]
    s_nop 0
    v_cndmask_b32 v80, v80, v92, s[72:73]
    v_and_or_b32 v225, v80, s74, v212
    buffer_store_dword v224, v13, s[12:15], s30 offen offset:0
    buffer_store_dword v225, v13, s[12:15], s30 offen offset:256
    s_barrier
    s_cmp_eq_u32 s66, 1
    s_cbranch_scc1 x_start
    s_barrier
    ds_read_b64_tr_b16 v[128:129], v208 offset:0
    ds_read_b64_tr_b16 v[130:131], v208 offset:2048
    ds_read_b64_tr_b16 v[132:133], v209 offset:0
    ds_read_b64_tr_b16 v[134:135], v209 offset:2048
    ds_read_b64_tr_b16 v[136:137], v210 offset:0
    ds_read_b64_tr_b16 v[138:139], v210 offset:2048
    ds_read_b64_tr_b16 v[140:141], v211 offset:0
    ds_read_b64_tr_b16 v[142:143], v211 offset:2048
    ds_read_b64_tr_b16 v[144:145], v208 offset:16384
    ds_read_b64_tr_b16 v[146:147], v208 offset:18432
    ds_read_b64_tr_b16 v[148:149], v209 offset:16384
    ds_read_b64_tr_b16 v[150:151], v209 offset:18432
    ds_read_b64_tr_b16 v[152:153], v210 offset:16384
    ds_read_b64_tr_b16 v[154:155], v210 offset:18432
    s_waitcnt lgkmcnt(12)
    v_mfma_f32_16x16x32_bf16 v[64:67], v[120:123], v[128:131], 0
    ds_read_b64_tr_b16 v[156:157], v211 offset:16384
    ds_read_b64_tr_b16 v[158:159], v211 offset:18432
    s_waitcnt lgkmcnt(12)
    v_mfma_f32_16x16x32_bf16 v[68:71], v[120:123], v[132:135], 0
    s_waitcnt lgkmcnt(10)
    v_mfma_f32_16x16x32_bf16 v[72:75], v[120:123], v[136:139], 0
    s_waitcnt lgkmcnt(8)
    v_mfma_f32_16x16x32_bf16 v[76:79], v[120:123], v[140:143], 0
    s_waitcnt lgkmcnt(6)
    v_mfma_f32_16x16x32_bf16 v[64:67], v[124:127], v[144:147], v[64:67]
    s_waitcnt lgkmcnt(4)
    v_mfma_f32_16x16x32_bf16 v[68:71], v[124:127], v[148:151], v[68:71]
    s_waitcnt lgkmcnt(2)
    v_mfma_f32_16x16x32_bf16 v[72:75], v[124:127], v[152:155], v[72:75]
    s_waitcnt lgkmcnt(0)
    v_mfma_f32_16x16x32_bf16 v[76:79], v[124:127], v[156:159], v[76:79]
    s_nop 3
    v_cndmask_b32 v64, v64, v68, s[60:61]
    s_nop 0
    v_cndmask_b32 v64, v64, v72, s[62:63]
    s_nop 0
    v_cndmask_b32 v64, v64, v76, s[72:73]
    v_and_or_b32 v226, v64, s74, v212
    buffer_store_dword v226, v13, s[12:15], s31 offen offset:0
    s_barrier
    s_bitcmp1_b32 s16, 0
    s_cselect_b32 s8, s52, s50
    s_cselect_b32 s9, s53, s51
    s_mov_b32 s10, 7340032
    s_lshr_b32 s42, s8, 7
    s_sub_u32 s42, 3, s42
    s_add_u32 s42, s42, s34
    s_and_b32 s42, s42, 7
    s_cmp_eq_u32 s42, 7
    s_cbranch_scc1 m_nh2
    s_mul_i32 s43, s34, 7
    s_add_u32 s42, s42, s43
    s_lshl_b32 s42, s42, 7
    s_lshl_b32 s43, s35, 1
    s_lshr_b32 s40, s16, 1
    s_add_u32 s43, s43, s40
    s_mul_i32 s43, s43, 265216
    s_add_u32 s42, s42, s43
    v_mul_u32_u24 v24, 7168, v2
    s_mov_b32 exec_lo, 4294967295
    s_mov_b32 exec_hi, 31
    buffer_load_dword v245, v24, s[8:11], s42 offen
    s_mov_b64 exec, -1
m_nh2:
    s_barrier
    ds_read_b64_tr_b16 v[64:65], v12 offset:0
    ds_read_b64_tr_b16 v[66:67], v12 offset:2048
    ds_read_b64_tr_b16 v[68:69], v12 offset:4096
    ds_read_b64_tr_b16 v[70:71], v12 offset:6144
    ds_read_b64_tr_b16 v[72:73], v12 offset:8192
    ds_read_b64_tr_b16 v[74:75], v12 offset:10240
    ds_read_b64_tr_b16 v[76:77], v12 offset:12288
    ds_read_b64_tr_b16 v[78:79], v12 offset:14336
    ds_read_b64_tr_b16 v[80:81], v12 offset:16384
    ds_read_b64_tr_b16 v[82:83], v12 offset:18432
    ds_read_b64_tr_b16 v[84:85], v12 offset:20480
    ds_read_b64_tr_b16 v[86:87], v12 offset:22528
    ds_read_b64_tr_b16 v[88:89], v12 offset:24576
    ds_read_b64_tr_b16 v[90:91], v12 offset:26624
    ds_read_b64_tr_b16 v[92:93], v12 offset:28672
    ds_read_b64_tr_b16 v[94:95], v12 offset:30720
    s_waitcnt vmcnt(0)
    s_barrier
    s_sub_u32 s42, s16, 1
    s_cmp_ge_u32 s42, 3
    s_cbranch_scc1 m_nb
    s_lshl_b32 s42, s42, 10
    s_add_u32 s42, s42, s29
    s_add_u32 s43, s42, 524288
    buffer_load_dwordx4 v[44:47], v3, s[12:15], s42 offen sc1
    s_waitcnt vmcnt(0)
    buffer_store_dwordx4 v[44:47], v3, s[12:15], s43 offen sc1
m_nb:
m_join:
    v_bfe_u32 v7, v0, 4, 2
    v_and_b32 v6, 1, v0
    v_lshlrev_b32 v17, 10, v6
    v_lshl_add_u32 v17, v16, 9, v17
    v_lshl_add_u32 v17, v7, 4, v17
    v_add_u32 v17, 131072, v17
    v_and_b32 v6, 15, v0
    v_lshlrev_b32 v13, 6, v6
    v_bfe_u32 v22, v0, 4, 1
    v_lshl_add_u32 v13, v22, 5, v13
    v_bfe_u32 v22, v0, 5, 1
    v_lshl_add_u32 v13, v22, 4, v13
    v_add_u32 v13, 131072, v13
    v_lshlrev_b32 v18, 11, v22
    v_bfe_u32 v22, v0, 4, 1
    v_lshl_add_u32 v18, v22, 9, v18
    v_bfe_u32 v22, v0, 2, 2
    v_lshl_add_u32 v18, v22, 7, v18
    v_lshl_add_u32 v18, v15, 4, v18
    s_lshl_b32 s71, s65, 6
    s_add_u32 s71, s71, 16896000
    v_mov_b32 v22, 0
    s_lshl_b32 s70, s65, 10
    s_add_u32 s70, s70, 18874368
    s_lshl_b32 s69, s64, 2
    s_and_b32 s42, s16, 3
    s_add_u32 s69, s69, s42
    s_lshl_b32 s69, s69, 10
    s_lshl_b32 s76, s65, 1
    s_lshr_b32 s42, s16, 2
    s_add_u32 s76, s76, s42
    s_lshl_b32 s76, s76, 8
    s_add_u32 s76, s76, s69
    s_add_u32 s77, s76, 18612224
    s_add_u32 s76, s76, 18350080
    s_add_u32 s69, s69, 18350080
    s_lshl_b32 s78, s34, 14
    s_lshl_b32 s79, s34, 7
    s_add_u32 s79, s79, 16842752
    s_add_u32 s78, s78, 17039360
    s_cmp_lg_u32 s16, 1
    s_cbranch_scc1 m_n0
    v_lshlrev_b32 v4, 7, v2
    s_sub_u32 s69, s69, 1024
    s_mov_b32 exec_hi, 0
    buffer_load_dword v5, v4, s[12:15], s69 offen sc1
    s_mov_b32 exec_hi, -1
m_n0:
    s_waitcnt vmcnt(0)
    s_cmp_lg_u32 s16, 0
    s_cbranch_scc1 m_nk
    v_mov_b32 v216, s32
    v_mov_b32 v217, s33
    v_and_b32 v218, 1, v0
    v_cmp_eq_u32 vcc, 1, v218
    s_nop 1
    v_cndmask_b32 v216, v216, v217, vcc
    v_bfe_u32 v217, v216, 8, 8
    v_bfe_u32 v218, v216, 16, 8
    v_lshrrev_b32 v219, 24, v216
    v_and_b32 v216, 0xff, v216
    s_mov_b32 s83, 0
    s_mov_b64 exec, 1
m_go:
    buffer_load_dwordx2 v[28:29], v22, s[12:15], s79 offen sc1
    s_waitcnt vmcnt(0)
    v_cmp_ne_u64 vcc, s[32:33], v[28:29]
    s_cbranch_vccz m_goy
    s_sleep 3
    s_add_u32 s83, s83, 1
    s_cmp_lt_u32 s83, 0x40000
    s_cbranch_scc1 m_go
m_goy:
    s_mov_b64 exec, -1
m_gox:
    s_mov_b32 s83, 0
m_sb:
    buffer_load_dwordx4 v[192:195], v18, s[12:15], s71 offen sc1
    buffer_load_dwordx4 v[196:199], v18, s[12:15], s71 offen offset:1024 sc1
    s_waitcnt vmcnt(0)
    v_xor_b32 v192, v216, v192
    v_xor_b32 v193, v217, v193
    v_xor_b32 v194, v218, v194
    v_xor_b32 v195, v219, v195
    v_xor_b32 v196, v216, v196
    v_xor_b32 v197, v217, v197
    v_xor_b32 v198, v218, v198
    v_xor_b32 v199, v219, v199
    v_or3_b32 v4, v192, v193, 0
    v_or3_b32 v4, v194, v195, v4
    v_or3_b32 v4, v196, v197, v4
    v_or3_b32 v4, v198, v199, v4
    v_and_b32 v4, 0xff, v4
    v_cmp_ne_u32 vcc, 0, v4
    s_cbranch_vccz m_sbx
    s_sleep 8
    s_add_u32 s83, s83, 1
    s_cmp_lt_u32 s83, 0x40000
    s_cbranch_scc1 m_sb
m_sbx:
    v_lshlrev_b32 v4, 7, v2
    s_add_u32 s42, s78, 8192
    s_mov_b32 s83, 0
    s_mov_b64 vcc, -1
    s_mov_b64 s[40:41], -1
m_pk:
    s_mov_b64 exec, vcc
    s_cbranch_execz m_pka
    buffer_load_dwordx4 v[24:27], v4, s[12:15], s78 offen sc1
m_pka:
    s_mov_b64 exec, s[40:41]
    s_cbranch_execz m_pkb
    buffer_load_dwordx4 v[28:31], v4, s[12:15], s42 offen sc1
m_pkb:
    s_mov_b64 exec, -1
    s_waitcnt vmcnt(0)
    v_cmp_ne_u64 vcc, s[32:33], v[26:27]
    v_cmp_ne_u64 s[40:41], s[32:33], v[30:31]
    v_max_u32 v5, v24, v28
    v_min_u32 v6, v24, v28
    s_or_b64 s[20:21], vcc, s[40:41]
    s_cbranch_scc0 m_pkx
    s_add_u32 s83, s83, 1
    s_cmp_lt_u32 s83, 0x40000
    s_cbranch_scc1 m_pk
m_pkx:
    v_mov_b32 v7, v5
    v_max3_u32 v6, v6, v25, v29
    s_nop 0
    v_max_u32_dpp v7, v7, v7 row_ror:8 row_mask:0xf bank_mask:0xf
    s_nop 1
    v_max_u32_dpp v7, v7, v7 row_ror:4 row_mask:0xf bank_mask:0xf
    s_nop 1
    v_max_u32_dpp v7, v7, v7 row_ror:2 row_mask:0xf bank_mask:0xf
    s_nop 1
    v_max_u32_dpp v7, v7, v7 row_ror:1 row_mask:0xf bank_mask:0xf
    s_nop 1
    v_max_u32_dpp v7, v7, v7 row_bcast:15 row_mask:0xa bank_mask:0xf
    s_nop 1
    v_max_u32_dpp v7, v7, v7 row_bcast:31 row_mask:0xc bank_mask:0xf
    s_nop 0
    v_readlane_b32 s40, v7, 63
    s_nop 1
    v_cmp_eq_u32 vcc, s40, v5
    s_nop 1
    v_cndmask_b32 v7, v5, v6, vcc
    s_nop 1
    v_max_u32_dpp v7, v7, v7 row_ror:8 row_mask:0xf bank_mask:0xf
    s_nop 1
    v_max_u32_dpp v7, v7, v7 row_ror:4 row_mask:0xf bank_mask:0xf
    s_nop 1
    v_max_u32_dpp v7, v7, v7 row_ror:2 row_mask:0xf bank_mask:0xf
    s_nop 1
    v_max_u32_dpp v7, v7, v7 row_ror:1 row_mask:0xf bank_mask:0xf
    s_nop 1
    v_max_u32_dpp v7, v7, v7 row_bcast:15 row_mask:0xa bank_mask:0xf
    s_nop 1
    v_max_u32_dpp v7, v7, v7 row_bcast:31 row_mask:0xc bank_mask:0xf
    s_nop 0
    v_readlane_b32 s41, v7, 63
    s_bfe_u32 s42, s40, 0x70005
    s_lshl_b32 s42, s42, 13
    s_and_b32 s40, s40, 1
    s_lshl_b32 s40, s40, 12
    s_add_u32 s42, s42, s40
    s_bfe_u32 s43, s41, 0x70005
    s_lshl_b32 s43, s43, 13
    s_and_b32 s41, s41, 1
    s_lshl_b32 s41, s41, 12
    s_add_u32 s43, s43, s41
    s_add_u32 s42, s42, s70
    s_add_u32 s43, s43, s70
    s_mov_b32 s83, 0
m_ph:
    buffer_load_dwordx4 v[176:179], v3, s[12:15], s42 offen sc1
    buffer_load_dwordx4 v[180:183], v3, s[12:15], s43 offen sc1
    s_waitcnt vmcnt(1)
    v_lshlrev_b32 v200, 16, v176
    v_and_b32 v201, 0xffff0000, v176
    v_lshlrev_b32 v202, 16, v177
    v_and_b32 v203, 0xffff0000, v177
    v_lshlrev_b32 v204, 16, v178
    v_and_b32 v205, 0xffff0000, v178
    v_lshlrev_b32 v206, 16, v179
    v_and_b32 v207, 0xffff0000, v179
    v_pk_add_f32 v[200:201], v[200:201], v[192:193]
    v_pk_add_f32 v[202:203], v[202:203], v[194:195]
    v_pk_add_f32 v[204:205], v[204:205], v[196:197]
    v_pk_add_f32 v[206:207], v[206:207], v[198:199]
    v_cvt_pk_bf16_f32 v208, v200, v201
    v_cvt_pk_bf16_f32 v209, v202, v203
    v_cvt_pk_bf16_f32 v210, v204, v205
    v_cvt_pk_bf16_f32 v211, v206, v207
    ds_write_b128 v13, v[208:211] offset:0
    s_waitcnt vmcnt(0)
    v_lshlrev_b32 v200, 16, v180
    v_and_b32 v201, 0xffff0000, v180
    v_lshlrev_b32 v202, 16, v181
    v_and_b32 v203, 0xffff0000, v181
    v_lshlrev_b32 v204, 16, v182
    v_and_b32 v205, 0xffff0000, v182
    v_lshlrev_b32 v206, 16, v183
    v_and_b32 v207, 0xffff0000, v183
    v_pk_add_f32 v[200:201], v[200:201], v[192:193]
    v_pk_add_f32 v[202:203], v[202:203], v[194:195]
    v_pk_add_f32 v[204:205], v[204:205], v[196:197]
    v_pk_add_f32 v[206:207], v[206:207], v[198:199]
    v_cvt_pk_bf16_f32 v212, v200, v201
    v_cvt_pk_bf16_f32 v213, v202, v203
    v_cvt_pk_bf16_f32 v214, v204, v205
    v_cvt_pk_bf16_f32 v215, v206, v207
    ds_write_b128 v13, v[212:215] offset:1024
    v_max3_u32 v4, v176, v177, v178
    v_max3_u32 v4, v4, v179, v180
    v_max3_u32 v4, v4, v181, v182
    v_max_u32 v4, v4, v183
    v_cmp_eq_u32 vcc, -1, v4
    s_cbranch_vccz m_phx
    s_add_u32 s83, s83, 1
    s_cmp_lt_u32 s83, 0x40000
    s_cbranch_scc1 m_ph
m_phx:
    s_waitcnt lgkmcnt(0)
m_nk:
    s_barrier
    ds_read_b128 v[128:131], v17 offset:0
    ds_read_b128 v[132:135], v17 offset:64
    ds_read_b128 v[136:139], v17 offset:128
    ds_read_b128 v[140:143], v17 offset:192
    ds_read_b128 v[144:147], v17 offset:256
    ds_read_b128 v[148:151], v17 offset:320
    ds_read_b128 v[152:155], v17 offset:384
    ds_read_b128 v[156:159], v17 offset:448
    s_waitcnt lgkmcnt(7)
    v_mfma_f32_16x16x32_bf16 v[160:163], v[128:131], v[64:67], 0
    ds_read_b64_tr_b16 v[96:97], v21 offset:0
    ds_read_b64_tr_b16 v[98:99], v21 offset:2048
    s_waitcnt lgkmcnt(8)
    v_mfma_f32_16x16x32_bf16 v[160:163], v[132:135], v[68:71], v[160:163]
    ds_read_b64_tr_b16 v[100:101], v21 offset:4096
    ds_read_b64_tr_b16 v[102:103], v21 offset:6144
    s_waitcnt lgkmcnt(9)
    v_mfma_f32_16x16x32_bf16 v[160:163], v[136:139], v[72:75], v[160:163]
    ds_read_b64_tr_b16 v[104:105], v21 offset:8192
    ds_read_b64_tr_b16 v[106:107], v21 offset:10240
    s_waitcnt lgkmcnt(10)
    v_mfma_f32_16x16x32_bf16 v[160:163], v[140:143], v[76:79], v[160:163]
    ds_read_b64_tr_b16 v[108:109], v21 offset:12288
    ds_read_b64_tr_b16 v[110:111], v21 offset:14336
    s_waitcnt lgkmcnt(11)
    v_mfma_f32_16x16x32_bf16 v[160:163], v[144:147], v[80:83], v[160:163]
    ds_read_b64_tr_b16 v[112:113], v21 offset:16384
    ds_read_b64_tr_b16 v[114:115], v21 offset:18432
    s_waitcnt lgkmcnt(12)
    v_mfma_f32_16x16x32_bf16 v[160:163], v[148:151], v[84:87], v[160:163]
    ds_read_b64_tr_b16 v[116:117], v21 offset:20480
    ds_read_b64_tr_b16 v[118:119], v21 offset:22528
    s_waitcnt lgkmcnt(13)
    v_mfma_f32_16x16x32_bf16 v[160:163], v[152:155], v[88:91], v[160:163]
    ds_read_b64_tr_b16 v[120:121], v21 offset:24576
    ds_read_b64_tr_b16 v[122:123], v21 offset:26624
    s_waitcnt lgkmcnt(14)
    v_mfma_f32_16x16x32_bf16 v[160:163], v[156:159], v[92:95], v[160:163]
    ds_read_b64_tr_b16 v[124:125], v21 offset:28672
    ds_read_b64_tr_b16 v[126:127], v21 offset:30720
    s_waitcnt lgkmcnt(14)
    v_mfma_f32_16x16x32_bf16 v[164:167], v[128:131], v[96:99], 0
    s_waitcnt lgkmcnt(12)
    v_mfma_f32_16x16x32_bf16 v[164:167], v[132:135], v[100:103], v[164:167]
    s_waitcnt lgkmcnt(10)
    v_mfma_f32_16x16x32_bf16 v[164:167], v[136:139], v[104:107], v[164:167]
    s_waitcnt lgkmcnt(8)
    v_mfma_f32_16x16x32_bf16 v[164:167], v[140:143], v[108:111], v[164:167]
    s_waitcnt lgkmcnt(6)
    v_mfma_f32_16x16x32_bf16 v[164:167], v[144:147], v[112:115], v[164:167]
    s_waitcnt lgkmcnt(4)
    v_mfma_f32_16x16x32_bf16 v[164:167], v[148:151], v[116:119], v[164:167]
    s_waitcnt lgkmcnt(2)
    v_mfma_f32_16x16x32_bf16 v[164:167], v[152:155], v[120:123], v[164:167]
    s_waitcnt lgkmcnt(0)
    v_mfma_f32_16x16x32_bf16 v[164:167], v[156:159], v[124:127], v[164:167]
    v_min_u32 v184, -2, v160
    v_min_u32 v185, -2, v161
    s_nop 5
    v_min_u32 v186, -2, v164
    v_min_u32 v187, -2, v165
    s_mov_b64 exec, 0xffff
    buffer_store_dwordx4 v[184:187], v3, s[12:15], s76 offen
    buffer_store_dwordx4 v[184:187], v3, s[12:15], s77 offen sc1
    s_endpgm
x_start:
    s_mov_b32 s56, s48
    s_mov_b32 s57, s49
    s_mov_b32 s58, 2048
    s_mov_b32 s59, 0x00020000
    v_mov_b32 v216, s32
    v_mov_b32 v217, s33
    v_and_b32 v218, 1, v0
    v_cmp_eq_u32 vcc, 1, v218
    s_nop 1
    v_cndmask_b32 v216, v216, v217, vcc
    v_bfe_u32 v217, v216, 8, 8
    v_bfe_u32 v218, v216, 16, 8
    v_lshrrev_b32 v219, 24, v216
    v_and_b32 v216, 0xff, v216
    s_lshl_b32 s41, s34, 16
    s_lshl_b32 s42, s16, 13
    s_add_u32 s41, s41, s42
    s_add_u32 s41, s41, 19922944
    s_lshl_b32 s42, s65, 9
    s_add_u32 s40, s41, s42
    s_add_u32 s41, s40, s42
    v_lshlrev_b32 v10, 4, v0
    v_lshrrev_b32 v11, 5, v2
    v_and_b32 v12, 0x1f0, v3
    v_lshl_add_u32 v11, v11, 12, v12
    s_lshl_b32 s39, s34, 4
    s_add_u32 s39, s39, s35
    s_lshl_b32 s39, s39, 12
    s_add_u32 s39, s39, 19922944
    s_bitcmp1_b32 s64, 2
    s_cselect_b32 s28, 1.0, 0
    s_mov_b32 s83, 0
x_g0:
    s_and_b32 s42, s83, 31
    s_cmp_eq_u32 s42, 31
    s_cselect_b32 s42, 524288, 0
    s_add_u32 s42, s42, s41
    s_add_u32 s43, s42, 4096
    buffer_load_dwordx4 v[32:35], v3, s[12:15], s42 offen sc1
    buffer_load_dwordx4 v[36:39], v3, s[12:15], s43 offen sc1
    s_waitcnt vmcnt(0)
    v_xor_b32 v32, v216, v32
    v_xor_b32 v33, v217, v33
    v_xor_b32 v34, v218, v34
    v_xor_b32 v35, v219, v35
    v_xor_b32 v36, v216, v36
    v_xor_b32 v37, v217, v37
    v_xor_b32 v38, v218, v38
    v_xor_b32 v39, v219, v39
    v_or3_b32 v17, v32, v33, 0
    v_or3_b32 v17, v34, v35, v17
    v_or3_b32 v17, v36, v37, v17
    v_or3_b32 v17, v38, v39, v17
    v_and_b32 v17, 0xff, v17
    v_cmp_ne_u32 vcc, 0, v17
    s_cbranch_vccz x_g0x
    s_and_b32 s42, s83, 31
    s_cmp_lg_u32 s42, 24
    s_cbranch_scc1 x_g0n
    s_add_u32 s43, s39, 524288
    buffer_load_dwordx4 v[44:47], v3, s[12:15], s39 offen offset:0 sc1
    s_waitcnt vmcnt(0)
    buffer_store_dwordx4 v[44:47], v3, s[12:15], s43 offen offset:0 sc1
    s_waitcnt vmcnt(0)
    buffer_load_dwordx4 v[44:47], v3, s[12:15], s39 offen offset:1024 sc1
    s_waitcnt vmcnt(0)
    buffer_store_dwordx4 v[44:47], v3, s[12:15], s43 offen offset:1024 sc1
    s_waitcnt vmcnt(0)
x_g0n:
    s_add_u32 s83, s83, 1
    s_cmp_lt_u32 s83, 0x40000
    s_cbranch_scc1 x_g0
x_g0x:
    v_pk_add_f32 v[32:33], v[32:33], v[36:37]
    v_pk_add_f32 v[34:35], v[34:35], v[38:39]
    ds_write_b128 v10, v[32:35] offset:0
    s_waitcnt lgkmcnt(0)
    s_barrier
    s_cmp_lg_u32 s16, 0
    s_cbranch_scc1 x_g0e
    ds_read_b128 v[160:163], v221 offset:0
    ds_read_b128 v[164:167], v221 offset:1024
    ds_read_b128 v[168:171], v221 offset:2048
    ds_read_b128 v[172:175], v221 offset:3072
    ds_read_b128 v[176:179], v221 offset:4096
    ds_read_b128 v[180:183], v221 offset:5120
    ds_read_b128 v[184:187], v221 offset:6144
    ds_read_b128 v[188:191], v221 offset:7168
    s_waitcnt lgkmcnt(6)
    v_pk_add_f32 v[160:161], v[160:161], v[164:165]
    v_pk_add_f32 v[162:163], v[162:163], v[166:167]
    s_waitcnt lgkmcnt(4)
    v_pk_add_f32 v[168:169], v[168:169], v[172:173]
    v_pk_add_f32 v[170:171], v[170:171], v[174:175]
    s_waitcnt lgkmcnt(2)
    v_pk_add_f32 v[176:177], v[176:177], v[180:181]
    v_pk_add_f32 v[178:179], v[178:179], v[182:183]
    s_waitcnt lgkmcnt(0)
    v_pk_add_f32 v[184:185], v[184:185], v[188:189]
    v_pk_add_f32 v[186:187], v[186:187], v[190:191]
    v_pk_add_f32 v[160:161], v[160:161], v[168:169]
    v_pk_add_f32 v[176:177], v[176:177], v[184:185]
    v_pk_add_f32 v[162:163], v[162:163], v[170:171]
    v_pk_add_f32 v[178:179], v[178:179], v[186:187]
    v_pk_add_f32 v[160:161], v[160:161], v[176:177]
    v_pk_add_f32 v[162:163], v[162:163], v[178:179]
    v_cvt_pk_bf16_f32 v17, v160, v161
    v_lshlrev_b32 v160, 16, v17
    v_and_b32 v161, 0xffff0000, v17
    v_cvt_pk_bf16_f32 v18, v162, v163
    v_lshlrev_b32 v162, 16, v18
    v_and_b32 v163, 0xffff0000, v18
    v_add_f32 v160, s28, v160
    v_add_f32 v161, s28, v161
    v_add_f32 v162, s28, v162
    v_add_f32 v163, s28, v163
    v_cvt_pk_bf16_f32 v17, v160, v161
    v_lshlrev_b32 v160, 16, v17
    v_and_b32 v161, 0xffff0000, v17
    v_cvt_pk_bf16_f32 v18, v162, v163
    v_lshlrev_b32 v162, 16, v18
    v_and_b32 v163, 0xffff0000, v18
    v_and_or_b32 v40, v160, s74, v216
    v_and_or_b32 v41, v161, s74, v217
    v_and_or_b32 v42, v162, s74, v218
    v_and_or_b32 v43, v163, s74, v219
    buffer_store_dwordx4 v[40:43], v220, s[12:15], s22 offen sc1
    v_mov_b32 v48, s32
    v_mov_b32 v49, s33
    s_cmp_ge_u32 s64, 12
    s_cbranch_scc1 x_q
    v_max3_f32 v50, abs(v160), abs(v161), abs(v162)
    v_max_f32_e64 v50, v50, abs(v163)
    s_nop 1
    v_max_f32_dpp v50, v50, v50 row_ror:8 row_mask:0xf bank_mask:0xf
    s_nop 1
    v_max_f32_dpp v50, v50, v50 row_ror:4 row_mask:0xf bank_mask:0xf
    s_nop 1
    v_max_f32_dpp v50, v50, v50 row_ror:2 row_mask:0xf bank_mask:0xf
    s_nop 1
    v_max_f32_dpp v50, v50, v50 row_ror:1 row_mask:0xf bank_mask:0xf
    s_nop 1
    v_max_f32_dpp v50, v50, v50 row_bcast:15 row_mask:0xa bank_mask:0xf
    s_nop 1
    v_max_f32_dpp v50, v50, v50 row_bcast:31 row_mask:0xc bank_mask:0xf
    s_branch x_r
x_q:
    v_lshlrev_b32 v164, 16, v52
    v_and_b32 v165, 0xffff0000, v52
    v_lshlrev_b32 v166, 16, v53
    v_and_b32 v167, 0xffff0000, v53
    v_pk_mul_f32 v[164:165], v[164:165], v[160:161]
    v_pk_mul_f32 v[166:167], v[166:167], v[162:163]
    s_add_u32 s42, s22, 4096
    v_and_or_b32 v40, v164, s74, v216
    v_and_or_b32 v41, v165, s74, v217
    v_and_or_b32 v42, v166, s74, v218
    v_and_or_b32 v43, v167, s74, v219
    buffer_store_dwordx4 v[40:43], v220, s[12:15], s42 offen sc1
    v_and_b32 v164, s74, v164
    v_and_b32 v165, s74, v165
    v_and_b32 v166, s74, v166
    v_and_b32 v167, s74, v167
    v_pk_add_f32 v[164:165], v[164:165], v[166:167]
    v_add_f32 v50, v164, v165
    s_nop 1
    v_add_f32_dpp v50, v50, v50 row_ror:8 row_mask:0xf bank_mask:0xf
    s_nop 1
    v_add_f32_dpp v50, v50, v50 row_ror:4 row_mask:0xf bank_mask:0xf
    s_nop 1
    v_add_f32_dpp v50, v50, v50 row_ror:2 row_mask:0xf bank_mask:0xf
    s_nop 1
    v_add_f32_dpp v50, v50, v50 row_ror:1 row_mask:0xf bank_mask:0xf
    s_nop 1
    v_add_f32_dpp v50, v50, v50 row_bcast:15 row_mask:0xa bank_mask:0xf
    s_nop 1
    v_add_f32_dpp v50, v50, v50 row_bcast:31 row_mask:0xc bank_mask:0xf
x_r:
    s_nop 0
    v_readlane_b32 s42, v50, 63
    s_nop 1
    v_mov_b32 v50, s42
    s_mov_b64 exec, 0xff
    buffer_store_dwordx4 v[48:51], v3, s[12:15], s79 offen sc1
    s_mov_b64 exec, -1
x_g0e:
    s_barrier
    s_cmp_lt_u32 s16, 4
    s_cbranch_scc1 x_t1
    v_xor_b32 v4, 0, v14
    s_add_u32 s43, s68, 98304
    s_mov_b32 m0, s43
    s_add_u32 s42, s19, 0
    buffer_load_dwordx4 v4, s[8:11], s42 offen nt lds
    v_xor_b32 v4, 64, v14
    s_add_u32 s43, s68, 99328
    s_mov_b32 m0, s43
    s_add_u32 s42, s19, 24576
    buffer_load_dwordx4 v4, s[8:11], s42 offen nt lds
    v_xor_b32 v4, 0, v14
    s_add_u32 s43, s68, 100352
    s_mov_b32 m0, s43
    s_add_u32 s42, s19, 49152
    buffer_load_dwordx4 v4, s[8:11], s42 offen nt lds
    v_xor_b32 v4, 64, v14
    s_add_u32 s43, s68, 101376
    s_mov_b32 m0, s43
    s_add_u32 s42, s19, 73728
    buffer_load_dwordx4 v4, s[8:11], s42 offen nt lds
    v_xor_b32 v4, 128, v14
    s_add_u32 s43, s68, 102400
    s_mov_b32 m0, s43
    s_add_u32 s42, s19, 98304
    buffer_load_dwordx4 v4, s[8:11], s42 offen nt lds
    v_xor_b32 v4, 192, v14
    s_add_u32 s43, s68, 103424
    s_mov_b32 m0, s43
    s_add_u32 s42, s19, 122880
    buffer_load_dwordx4 v4, s[8:11], s42 offen nt lds
    v_xor_b32 v4, 128, v14
    s_add_u32 s43, s68, 104448
    s_mov_b32 m0, s43
    s_add_u32 s42, s19, 147456
    buffer_load_dwordx4 v4, s[8:11], s42 offen nt lds
    v_xor_b32 v4, 192, v14
    s_add_u32 s43, s68, 105472
    s_mov_b32 m0, s43
    s_add_u32 s42, s19, 172032
    buffer_load_dwordx4 v4, s[8:11], s42 offen nt lds
    s_waitcnt vmcnt(0)
    s_barrier
    s_branch x_t2
x_t1:
    s_barrier
    ds_read_b64_tr_b16 v[128:129], v208 offset:0
    ds_read_b64_tr_b16 v[130:131], v208 offset:2048
    ds_read_b64_tr_b16 v[132:133], v209 offset:0
    ds_read_b64_tr_b16 v[134:135], v209 offset:2048
    ds_read_b64_tr_b16 v[136:137], v210 offset:0
    ds_read_b64_tr_b16 v[138:139], v210 offset:2048
    ds_read_b64_tr_b16 v[140:141], v211 offset:0
    ds_read_b64_tr_b16 v[142:143], v211 offset:2048
    ds_read_b64_tr_b16 v[144:145], v208 offset:16384
    ds_read_b64_tr_b16 v[146:147], v208 offset:18432
    ds_read_b64_tr_b16 v[148:149], v209 offset:16384
    ds_read_b64_tr_b16 v[150:151], v209 offset:18432
    ds_read_b64_tr_b16 v[152:153], v210 offset:16384
    ds_read_b64_tr_b16 v[154:155], v210 offset:18432
    s_waitcnt lgkmcnt(12)
    v_mfma_f32_16x16x32_bf16 v[64:67], v[120:123], v[128:131], 0
    ds_read_b64_tr_b16 v[156:157], v211 offset:16384
    ds_read_b64_tr_b16 v[158:159], v211 offset:18432
    s_waitcnt lgkmcnt(12)
    v_mfma_f32_16x16x32_bf16 v[68:71], v[120:123], v[132:135], 0
    s_waitcnt lgkmcnt(10)
    v_mfma_f32_16x16x32_bf16 v[72:75], v[120:123], v[136:139], 0
    s_waitcnt lgkmcnt(8)
    v_mfma_f32_16x16x32_bf16 v[76:79], v[120:123], v[140:143], 0
    s_waitcnt lgkmcnt(6)
    v_mfma_f32_16x16x32_bf16 v[64:67], v[124:127], v[144:147], v[64:67]
    s_waitcnt lgkmcnt(4)
    v_mfma_f32_16x16x32_bf16 v[68:71], v[124:127], v[148:151], v[68:71]
    s_waitcnt lgkmcnt(2)
    v_mfma_f32_16x16x32_bf16 v[72:75], v[124:127], v[152:155], v[72:75]
    s_waitcnt lgkmcnt(0)
    v_mfma_f32_16x16x32_bf16 v[76:79], v[124:127], v[156:159], v[76:79]
    s_nop 3
    v_cndmask_b32 v64, v64, v68, s[60:61]
    s_nop 0
    v_cndmask_b32 v64, v64, v72, s[62:63]
    s_nop 0
    v_cndmask_b32 v64, v64, v76, s[72:73]
    v_and_or_b32 v226, v64, s74, v212
    buffer_store_dword v226, v13, s[12:15], s31 offen offset:0
x_t2:
    s_mov_b32 s83, 0
x_g1:
    s_and_b32 s42, s83, 31
    s_cmp_eq_u32 s42, 31
    s_cselect_b32 s42, 524288, 0
    s_add_u32 s42, s42, s40
    buffer_load_dwordx4 v[32:35], v11, s[12:15], s42 offen offset:2048 sc1
    s_waitcnt vmcnt(0)
    v_xor_b32 v32, v216, v32
    v_xor_b32 v33, v217, v33
    v_xor_b32 v34, v218, v34
    v_xor_b32 v35, v219, v35
    v_or3_b32 v17, v32, v33, 0
    v_or3_b32 v17, v34, v35, v17
    v_and_b32 v17, 0xff, v17
    v_cmp_ne_u32 vcc, 0, v17
    s_cbranch_vccz x_g1x
    s_and_b32 s42, s83, 31
    s_cmp_lg_u32 s42, 24
    s_cbranch_scc1 x_g1n
    s_add_u32 s43, s39, 524288
    buffer_load_dwordx4 v[44:47], v3, s[12:15], s39 offen offset:0 sc1
    s_waitcnt vmcnt(0)
    buffer_store_dwordx4 v[44:47], v3, s[12:15], s43 offen offset:0 sc1
    s_waitcnt vmcnt(0)
    buffer_load_dwordx4 v[44:47], v3, s[12:15], s39 offen offset:1024 sc1
    s_waitcnt vmcnt(0)
    buffer_store_dwordx4 v[44:47], v3, s[12:15], s43 offen offset:1024 sc1
    s_waitcnt vmcnt(0)
    buffer_load_dwordx4 v[44:47], v3, s[12:15], s39 offen offset:2048 sc1
    s_waitcnt vmcnt(0)
    buffer_store_dwordx4 v[44:47], v3, s[12:15], s43 offen offset:2048 sc1
    s_waitcnt vmcnt(0)
x_g1n:
    s_add_u32 s83, s83, 1
    s_cmp_lt_u32 s83, 0x40000
    s_cbranch_scc1 x_g1
x_g1x:
    ds_write_b128 v10, v[32:35] offset:8192
    s_waitcnt lgkmcnt(0)
    s_barrier
    s_cmp_lg_u32 s16, 0
    s_cbranch_scc1 x_g1e
    ds_read_b128 v[160:163], v221 offset:8192
    ds_read_b128 v[164:167], v221 offset:9216
    ds_read_b128 v[168:171], v221 offset:10240
    ds_read_b128 v[172:175], v221 offset:11264
    ds_read_b128 v[176:179], v221 offset:12288
    ds_read_b128 v[180:183], v221 offset:13312
    ds_read_b128 v[184:187], v221 offset:14336
    ds_read_b128 v[188:191], v221 offset:15360
    s_waitcnt lgkmcnt(6)
    v_pk_add_f32 v[160:161], v[160:161], v[164:165]
    v_pk_add_f32 v[162:163], v[162:163], v[166:167]
    s_waitcnt lgkmcnt(4)
    v_pk_add_f32 v[168:169], v[168:169], v[172:173]
    v_pk_add_f32 v[170:171], v[170:171], v[174:175]
    s_waitcnt lgkmcnt(2)
    v_pk_add_f32 v[176:177], v[176:177], v[180:181]
    v_pk_add_f32 v[178:179], v[178:179], v[182:183]
    s_waitcnt lgkmcnt(0)
    v_pk_add_f32 v[184:185], v[184:185], v[188:189]
    v_pk_add_f32 v[186:187], v[186:187], v[190:191]
    v_pk_add_f32 v[160:161], v[160:161], v[168:169]
    v_pk_add_f32 v[176:177], v[176:177], v[184:185]
    v_pk_add_f32 v[162:163], v[162:163], v[170:171]
    v_pk_add_f32 v[178:179], v[178:179], v[186:187]
    v_pk_add_f32 v[160:161], v[160:161], v[176:177]
    v_pk_add_f32 v[162:163], v[162:163], v[178:179]
    v_mov_b32 v164, v160
    v_mov_b32 v165, v161
    v_mov_b32 v166, v162
    v_mov_b32 v167, v163
    v_permlane32_swap_b32 v160, v164
    v_permlane32_swap_b32 v161, v165
    v_permlane32_swap_b32 v162, v166
    v_permlane32_swap_b32 v163, v167
    v_pk_add_f32 v[160:161], v[160:161], v[164:165]
    v_pk_add_f32 v[162:163], v[162:163], v[166:167]
    v_cvt_pk_bf16_f32 v17, v160, v161
    v_lshlrev_b32 v160, 16, v17
    v_and_b32 v161, 0xffff0000, v17
    v_cvt_pk_bf16_f32 v18, v162, v163
    v_lshlrev_b32 v162, 16, v18
    v_and_b32 v163, 0xffff0000, v18
    s_mov_b32 exec_hi, 0
    v_and_or_b32 v40, v160, s74, v216
    v_and_or_b32 v41, v161, s74, v217
    v_and_or_b32 v42, v162, s74, v218
    v_and_or_b32 v43, v163, s74, v219
    buffer_store_dwordx4 v[40:43], v220, s[12:15], s23 offen sc1
    s_mov_b32 exec_hi, -1
x_g1e:
    s_sub_u32 s42, s16, 0
    s_cmp_ge_u32 s42, 3
    s_cbranch_scc1 x_nb
    s_lshl_b32 s42, s42, 10
    s_add_u32 s42, s42, s29
    s_add_u32 s43, s42, 524288
    buffer_load_dwordx4 v[44:47], v3, s[12:15], s42 offen sc1
    s_waitcnt vmcnt(0)
    buffer_store_dwordx4 v[44:47], v3, s[12:15], s43 offen sc1
x_nb:
    s_lshl_b32 s17, s64, 3
    s_add_u32 s17, s17, s16
    s_and_b32 s18, s17, 63
    s_lshl_b32 s78, s34, 14
    s_add_u32 s78, s78, 17039360
    v_and_b32 v4, 3, v0
    v_lshrrev_b32 v7, 4, v2
    v_lshlrev_b32 v5, 3, v4
    v_lshl_add_u32 v5, v7, 1, v5
    v_lshlrev_b32 v6, 10, v4
    v_lshl_add_u32 v6, v7, 2, v6
    v_lshrrev_b32 v86, 1, v4
    v_lshlrev_b32 v86, 9, v86
    v_and_b32 v87, 12, v5
    v_add_u32 v86, v86, v87
    v_and_b32 v87, 2, v5
    v_lshlrev_b32 v87, 3, v87
    s_and_b32 s30, s18, 1
    s_bfe_u32 s31, s18, 0x20001
    s_bfe_u32 s40, s18, 0x20003
    s_lshr_b32 s41, s18, 5
    s_lshl_b32 s45, s41, 10
    s_lshl_b32 s42, s30, 8
    s_add_u32 s45, s45, s42
    s_lshl_b32 s42, s40, 6
    s_add_u32 s45, s45, s42
    s_lshl_b32 s31, s31, 4
    s_add_u32 s45, s45, s31
    s_lshl_b32 s30, s30, 9
    s_add_u32 s31, s31, s30
    s_lshl_b32 s40, s40, 7
    s_add_u32 s31, s31, s40
    s_lshl_b32 s41, s41, 6
    s_add_u32 s31, s31, s41
    s_add_u32 s31, s31, 16900096
    s_lshl_b32 s44, s17, 12
    s_add_u32 s44, s44, 17825792
    s_bitcmp1_b32 s18, 1
    s_cselect_b32 s42, s33, s32
    v_lshlrev_b32 v88, 3, v7
    v_lshrrev_b32_e64 v88, v88, s42
    v_and_b32 v88, 0xff, v88
    v_cmp_gt_u32 vcc, 32, v2
    v_mov_b32 v7, 0x7ff00000
    s_nop 0
    v_cndmask_b32 v7, v7, v3, vcc
    v_and_b32 v9, 15, v0
    v_lshlrev_b32 v9, 6, v9
    v_bfe_u32 v10, v0, 4, 1
    v_lshl_add_u32 v9, v10, 5, v9
    v_bfe_u32 v10, v0, 5, 1
    v_lshl_add_u32 v9, v10, 4, v9
    v_mov_b32 v10, 135232
    v_mov_b32 v22, 0
    buffer_load_dwordx4 v[40:43], v9, s[56:59], 0 offen offset:0
    buffer_load_dwordx4 v[44:47], v9, s[56:59], 0 offen offset:1024
    s_waitcnt vmcnt(0)
    v_lshlrev_b32 v48, 16, v40
    v_and_b32 v49, 0xffff0000, v40
    v_lshlrev_b32 v50, 16, v41
    v_and_b32 v51, 0xffff0000, v41
    v_lshlrev_b32 v52, 16, v42
    v_and_b32 v53, 0xffff0000, v42
    v_lshlrev_b32 v54, 16, v43
    v_and_b32 v55, 0xffff0000, v43
    v_lshlrev_b32 v56, 16, v44
    v_and_b32 v57, 0xffff0000, v44
    v_lshlrev_b32 v58, 16, v45
    v_and_b32 v59, 0xffff0000, v45
    v_lshlrev_b32 v60, 16, v46
    v_and_b32 v61, 0xffff0000, v46
    v_lshlrev_b32 v62, 16, v47
    v_and_b32 v63, 0xffff0000, v47
    s_cmp_lg_u32 s16, 0
    s_cbranch_scc1 x_gox
    s_lshl_b32 s79, s34, 7
    s_add_u32 s79, s79, 16842752
    s_mov_b32 s83, 0
    s_mov_b64 exec, 1
x_go:
    buffer_load_dwordx2 v[28:29], v22, s[12:15], s79 offen sc1
    s_waitcnt vmcnt(0)
    v_cmp_ne_u64 vcc, s[32:33], v[28:29]
    s_cbranch_vccz x_goy
    s_sleep 3
    s_add_u32 s83, s83, 1
    s_cmp_lt_u32 s83, 0x40000
    s_cbranch_scc1 x_go
x_goy:
    s_mov_b64 exec, -1
x_gox:
    s_barrier
    v_bfe_u32 v18, v0, 5, 1
    v_lshlrev_b32 v18, 11, v18
    v_bfe_u32 v19, v0, 4, 1
    v_lshl_add_u32 v18, v19, 9, v18
    v_bfe_u32 v19, v0, 2, 2
    v_lshl_add_u32 v18, v19, 7, v18
    v_lshl_add_u32 v18, v4, 4, v18
    s_mov_b32 s42, 16896000
    s_sub_u32 s43, s31, 4096
    s_mov_b32 s83, 0
x_sb:
    buffer_load_dwordx4 v[100:103], v18, s[12:15], s42 offen offset:0 sc1
    buffer_load_dwordx4 v[104:107], v18, s[12:15], s42 offen offset:1024 sc1
    buffer_load_dwordx4 v[108:111], v18, s[12:15], s42 offen offset:64 sc1
    buffer_load_dwordx4 v[112:115], v18, s[12:15], s42 offen offset:1088 sc1
    buffer_load_dword v90, v6, s[12:15], s43 offen sc1
    buffer_load_dword v91, v6, s[12:15], s31 offen sc1
    s_waitcnt vmcnt(0)
    v_xor_b32 v100, v216, v100
    v_xor_b32 v101, v217, v101
    v_xor_b32 v102, v218, v102
    v_xor_b32 v103, v219, v103
    v_xor_b32 v104, v216, v104
    v_xor_b32 v105, v217, v105
    v_xor_b32 v106, v218, v106
    v_xor_b32 v107, v219, v107
    v_xor_b32 v108, v216, v108
    v_xor_b32 v109, v217, v109
    v_xor_b32 v110, v218, v110
    v_xor_b32 v111, v219, v111
    v_xor_b32 v112, v216, v112
    v_xor_b32 v113, v217, v113
    v_xor_b32 v114, v218, v114
    v_xor_b32 v115, v219, v115
    v_or3_b32 v19, v100, v101, 0
    v_or3_b32 v19, v102, v103, v19
    v_or3_b32 v19, v104, v105, v19
    v_or3_b32 v19, v106, v107, v19
    v_or3_b32 v19, v108, v109, v19
    v_or3_b32 v19, v110, v111, v19
    v_or3_b32 v19, v112, v113, v19
    v_or3_b32 v19, v114, v115, v19
    v_xor_b32 v90, v88, v90
    v_xor_b32 v91, v88, v91
    v_or3_b32 v19, v19, v90, v91
    v_and_b32 v19, 0xff, v19
    v_cmp_ne_u32 vcc, 0, v19
    s_cbranch_vccz x_sbx
    s_sleep 12
    s_add_u32 s83, s83, 1
    s_cmp_lt_u32 s83, 0x40000
    s_cbranch_scc1 x_sb
x_sbx:
    s_cmp_lg_u32 s16, 0
    s_cbranch_scc1 x_ng
    s_sleep 4
    v_lshlrev_b32 v32, 7, v2
    s_add_u32 s42, s78, 8192
    s_mov_b32 s83, 0
    s_mov_b64 vcc, -1
    s_mov_b64 s[40:41], -1
x_pk:
    s_mov_b64 exec, vcc
    s_cbranch_execz x_pka
    buffer_load_dwordx4 v[24:27], v32, s[12:15], s78 offen sc1
x_pka:
    s_mov_b64 exec, s[40:41]
    s_cbranch_execz x_pkb
    buffer_load_dwordx4 v[28:31], v32, s[12:15], s42 offen sc1
x_pkb:
    s_mov_b64 exec, -1
    s_waitcnt vmcnt(0)
    v_cmp_ne_u64 vcc, s[32:33], v[26:27]
    v_cmp_ne_u64 s[40:41], s[32:33], v[30:31]
    v_max_u32 v33, v24, v28
    v_min_u32 v34, v24, v28
    s_or_b64 s[20:21], vcc, s[40:41]
    s_cbranch_scc0 x_pkx
    s_sleep 2
    s_add_u32 s83, s83, 1
    s_cmp_lt_u32 s83, 0x40000
    s_cbranch_scc1 x_pk
x_pkx:
    v_mov_b32 v35, v33
    v_max3_u32 v34, v34, v25, v29
    s_nop 0
    v_max_u32_dpp v35, v35, v35 row_ror:8 row_mask:0xf bank_mask:0xf
    s_nop 1
    v_max_u32_dpp v35, v35, v35 row_ror:4 row_mask:0xf bank_mask:0xf
    s_nop 1
    v_max_u32_dpp v35, v35, v35 row_ror:2 row_mask:0xf bank_mask:0xf
    s_nop 1
    v_max_u32_dpp v35, v35, v35 row_ror:1 row_mask:0xf bank_mask:0xf
    s_nop 1
    v_max_u32_dpp v35, v35, v35 row_bcast:15 row_mask:0xa bank_mask:0xf
    s_nop 1
    v_max_u32_dpp v35, v35, v35 row_bcast:31 row_mask:0xc bank_mask:0xf
    s_nop 0
    v_readlane_b32 s40, v35, 63
    s_nop 1
    v_cmp_eq_u32 vcc, s40, v33
    s_nop 1
    v_cndmask_b32 v35, v33, v34, vcc
    s_nop 1
    v_max_u32_dpp v35, v35, v35 row_ror:8 row_mask:0xf bank_mask:0xf
    s_nop 1
    v_max_u32_dpp v35, v35, v35 row_ror:4 row_mask:0xf bank_mask:0xf
    s_nop 1
    v_max_u32_dpp v35, v35, v35 row_ror:2 row_mask:0xf bank_mask:0xf
    s_nop 1
    v_max_u32_dpp v35, v35, v35 row_ror:1 row_mask:0xf bank_mask:0xf
    s_nop 1
    v_max_u32_dpp v35, v35, v35 row_bcast:15 row_mask:0xa bank_mask:0xf
    s_nop 1
    v_max_u32_dpp v35, v35, v35 row_bcast:31 row_mask:0xc bank_mask:0xf
    s_nop 0
    v_readlane_b32 s41, v35, 63
    v_mov_b32 v28, s40
    s_nop 0
    v_mov_b32 v29, s41
    ds_write_b64 v10, v[28:29]
    s_waitcnt lgkmcnt(0)
x_ng:
    s_barrier
    ds_read_b64 v[28:29], v10
    s_waitcnt lgkmcnt(0)
    v_readfirstlane_b32 s40, v28
    v_readfirstlane_b32 s41, v29
    s_cmp_lt_u32 s17, 64
    s_cselect_b32 s40, s40, s41
    s_bfe_u32 s46, s40, 0x70005
    s_bfe_u32 s47, s40, 0x30002
    s_bfe_u32 s48, s40, 0x10001
    s_bfe_u32 s42, s40, 0x70005
    s_lshl_b32 s42, s42, 13
    s_and_b32 s40, s40, 1
    s_lshl_b32 s40, s40, 12
    s_add_u32 s42, s42, s40
    s_add_u32 s42, s42, 18874368
    s_add_u32 s43, s42, s45
    s_mov_b32 s83, 0
x_ps:
    buffer_load_dwordx4 v[32:35], v3, s[12:15], s42 offen offset:0 sc1
    buffer_load_dwordx4 v[36:39], v3, s[12:15], s42 offen offset:1024 sc1
    buffer_load_dword v40, v86, s[12:15], s43 offen offset:2048 sc1
    buffer_load_dword v41, v86, s[12:15], s43 offen sc1
    s_lshr_b32 s49, s46, 4
    s_and_b32 s41, s46, 15
    s_lshl_b32 s41, s41, 4
    s_add_u32 s41, s41, s49
    s_lshr_b32 s49, s46, 3
    s_cmp_eq_u32 s49, 1
    s_cselect_b32 s49, 120, 0
    s_sub_u32 s41, s41, s49
    s_lshl_b32 s49, s47, 8
    s_add_u32 s41, s41, s49
    s_cmp_ge_u32 s47, 4
    s_cselect_b32 s49, 896, 0
    s_cmp_eq_u32 s46, 0
    s_cselect_b32 s49, s49, 0
    s_sub_u32 s41, s41, s49
    s_sub_u32 s49, 2048, s41
    s_cmp_eq_u32 s41, 0
    s_cselect_b32 s49, 1024, s49
    s_cmp_eq_u32 s48, 1
    s_cselect_b32 s41, s49, s41
    s_lshl_b32 s41, s41, 11
    s_lshl_b32 s49, s18, 5
    s_add_u32 s41, s41, s49
    s_waitcnt vmcnt(0)
    v_max3_u32 v9, v32, v33, v34
    v_max3_u32 v9, v9, v35, v36
    v_max3_u32 v9, v9, v37, v38
    v_max3_u32 v9, v9, v39, v40
    v_max_u32 v9, v9, v41
    v_cmp_eq_u32 vcc, -1, v9
    s_cbranch_vccz x_psx
    s_sleep 1
    s_add_u32 s83, s83, 1
    s_cmp_lt_u32 s83, 0x40000
    s_cbranch_scc1 x_ps
x_psx:
    v_lshlrev_b32 v64, 16, v32
    v_and_b32 v65, 0xffff0000, v32
    v_lshlrev_b32 v66, 16, v33
    v_and_b32 v67, 0xffff0000, v33
    v_lshlrev_b32 v68, 16, v34
    v_and_b32 v69, 0xffff0000, v34
    v_lshlrev_b32 v70, 16, v35
    v_and_b32 v71, 0xffff0000, v35
    v_lshlrev_b32 v72, 16, v36
    v_and_b32 v73, 0xffff0000, v36
    v_lshlrev_b32 v74, 16, v37
    v_and_b32 v75, 0xffff0000, v37
    v_lshlrev_b32 v76, 16, v38
    v_and_b32 v77, 0xffff0000, v38
    v_lshlrev_b32 v78, 16, v39
    v_and_b32 v79, 0xffff0000, v39
    v_pk_add_f32 v[64:65], v[64:65], v[100:101]
    v_pk_add_f32 v[66:67], v[66:67], v[102:103]
    v_pk_add_f32 v[68:69], v[68:69], v[104:105]
    v_pk_add_f32 v[70:71], v[70:71], v[106:107]
    v_pk_add_f32 v[72:73], v[72:73], v[108:109]
    v_pk_add_f32 v[74:75], v[74:75], v[110:111]
    v_pk_add_f32 v[76:77], v[76:77], v[112:113]
    v_pk_add_f32 v[78:79], v[78:79], v[114:115]
    v_cvt_pk_bf16_f32 v9, v64, v65
    v_lshlrev_b32 v64, 16, v9
    v_and_b32 v65, 0xffff0000, v9
    v_cvt_pk_bf16_f32 v9, v66, v67
    v_lshlrev_b32 v66, 16, v9
    v_and_b32 v67, 0xffff0000, v9
    v_cvt_pk_bf16_f32 v9, v68, v69
    v_lshlrev_b32 v68, 16, v9
    v_and_b32 v69, 0xffff0000, v9
    v_cvt_pk_bf16_f32 v9, v70, v71
    v_lshlrev_b32 v70, 16, v9
    v_and_b32 v71, 0xffff0000, v9
    v_cvt_pk_bf16_f32 v9, v72, v73
    v_lshlrev_b32 v72, 16, v9
    v_and_b32 v73, 0xffff0000, v9
    v_cvt_pk_bf16_f32 v9, v74, v75
    v_lshlrev_b32 v74, 16, v9
    v_and_b32 v75, 0xffff0000, v9
    v_cvt_pk_bf16_f32 v9, v76, v77
    v_lshlrev_b32 v76, 16, v9
    v_and_b32 v77, 0xffff0000, v9
    v_cvt_pk_bf16_f32 v9, v78, v79
    v_lshlrev_b32 v78, 16, v9
    v_and_b32 v79, 0xffff0000, v9
    v_pk_mul_f32 v[8:9], v[48:49], v[64:65]
    v_pk_fma_f32 v[8:9], v[50:51], v[66:67], v[8:9]
    v_pk_fma_f32 v[8:9], v[52:53], v[68:69], v[8:9]
    v_pk_fma_f32 v[8:9], v[54:55], v[70:71], v[8:9]
    v_pk_fma_f32 v[8:9], v[56:57], v[72:73], v[8:9]
    v_pk_fma_f32 v[8:9], v[58:59], v[74:75], v[8:9]
    v_pk_fma_f32 v[8:9], v[60:61], v[76:77], v[8:9]
    v_pk_fma_f32 v[8:9], v[62:63], v[78:79], v[8:9]
    v_add_f32 v8, v8, v9
    s_nop 1
    v_add_f32_dpp v8, v8, v8 row_ror:8 row_mask:0xf bank_mask:0xf
    s_nop 1
    v_add_f32_dpp v8, v8, v8 row_ror:4 row_mask:0xf bank_mask:0xf
    s_nop 1
    v_add_f32_dpp v8, v8, v8 row_ror:2 row_mask:0xf bank_mask:0xf
    s_nop 1
    v_add_f32_dpp v8, v8, v8 row_ror:1 row_mask:0xf bank_mask:0xf
    s_nop 1
    v_add_f32_dpp v8, v8, v8 row_bcast:15 row_mask:0xa bank_mask:0xf
    s_nop 1
    v_add_f32_dpp v8, v8, v8 row_bcast:31 row_mask:0xc bank_mask:0xf
    v_cvt_pk_bf16_f32 v8, v8, v8
    v_lshlrev_b32 v8, 16, v8
    v_mul_f32 v8, 0xbfb8aa3b, v8
    v_exp_f32 v8, v8
    s_nop 0
    v_add_f32 v8, 1.0, v8
    v_rcp_f32 v8, v8
    s_nop 0
    v_cvt_pk_bf16_f32 v8, v8, v8
    v_lshlrev_b32 v8, 16, v8
    s_nop 0
    v_readlane_b32 s46, v8, 63
    v_lshrrev_b32 v44, v87, v40
    v_lshlrev_b32 v44, 16, v44
    v_mul_f32 v80, s46, v91
    v_lshrrev_b32 v41, v87, v41
    v_lshlrev_b32 v41, 16, v41
    v_add_f32 v41, v41, v90
    v_cvt_pk_bf16_f32 v41, v41, v41
    v_lshlrev_b32 v41, 16, v41
    v_fmac_f32 v44, v91, v41
    s_sleep 44
    s_mov_b32 s83, 0
    buffer_load_dwordx4 v[16:19], v3, s[12:15], s44 offen offset:0 sc1
    buffer_load_dwordx4 v[20:23], v3, s[12:15], s44 offen offset:1024 sc1
    buffer_load_dwordx4 v[24:27], v3, s[12:15], s44 offen offset:2048 sc1
    buffer_load_dwordx4 v[28:31], v7, s[12:15], s44 offen offset:3072 sc1
x_p2:
    s_waitcnt vmcnt(0)
    v_max3_u32 v12, v16, v17, v18
    v_max3_u32 v12, v12, v19, v20
    v_max3_u32 v12, v12, v21, v22
    v_max3_u32 v12, v12, v23, v24
    v_max3_u32 v12, v12, v25, v26
    v_max3_u32 v12, v12, v27, v28
    v_max3_u32 v12, v12, v29, v30
    v_max_u32 v12, v12, v31
    v_cmp_eq_u32 vcc, -1, v12
    s_cbranch_vccz x_p3
    v_max3_u32 v12, v16, v17, v18
    v_max_u32 v12, v12, v19
    v_cmp_eq_u32 vcc, -1, v12
    s_and_saveexec_b64 s[50:51], vcc
    s_cbranch_execz x_q0
    buffer_load_dwordx4 v[16:19], v3, s[12:15], s44 offen offset:0 sc1
x_q0:
    s_mov_b64 exec, -1
    v_max3_u32 v12, v20, v21, v22
    v_max_u32 v12, v12, v23
    v_cmp_eq_u32 vcc, -1, v12
    s_and_saveexec_b64 s[50:51], vcc
    s_cbranch_execz x_q1
    buffer_load_dwordx4 v[20:23], v3, s[12:15], s44 offen offset:1024 sc1
x_q1:
    s_mov_b64 exec, -1
    v_max3_u32 v12, v24, v25, v26
    v_max_u32 v12, v12, v27
    v_cmp_eq_u32 vcc, -1, v12
    s_and_saveexec_b64 s[50:51], vcc
    s_cbranch_execz x_q2
    buffer_load_dwordx4 v[24:27], v3, s[12:15], s44 offen offset:2048 sc1
x_q2:
    s_mov_b64 exec, -1
    v_max3_u32 v12, v28, v29, v30
    v_max_u32 v12, v12, v31
    v_cmp_eq_u32 vcc, -1, v12
    s_and_saveexec_b64 s[50:51], vcc
    s_cbranch_execz x_q3
    buffer_load_dwordx4 v[28:31], v7, s[12:15], s44 offen offset:3072 sc1
x_q3:
    s_mov_b64 exec, -1
    s_add_u32 s83, s83, 1
    s_cmp_lt_u32 s83, 0x40000
    s_cbranch_scc1 x_p2
    s_waitcnt vmcnt(0)
x_p3:
    v_pk_add_f32 v[16:17], v[16:17], v[20:21]
    v_pk_add_f32 v[24:25], v[24:25], v[28:29]
    v_pk_add_f32 v[18:19], v[18:19], v[22:23]
    v_pk_add_f32 v[26:27], v[26:27], v[30:31]
    v_pk_add_f32 v[16:17], v[16:17], v[24:25]
    v_pk_add_f32 v[18:19], v[18:19], v[26:27]
    s_nop 1
    v_permlane32_swap_b32 v16, v18
    v_permlane32_swap_b32 v17, v19
    v_pk_add_f32 v[16:17], v[16:17], v[18:19]
    s_nop 1
    v_permlane16_swap_b32 v16, v17
    v_add_f32 v16, v16, v17
    s_nop 1
    v_add_f32_dpp v16, v16, v16 row_ror:4 row_mask:0xf bank_mask:0xf
    s_nop 1
    v_add_f32_dpp v16, v16, v16 row_ror:8 row_mask:0xf bank_mask:0xf
    v_fmac_f32 v44, v16, v80
    s_mov_b32 exec_lo, 0x000f000f
    s_mov_b32 exec_hi, 0x000f000f
    v_cvt_pk_bf16_f32 v44, v44, v44
    buffer_store_short v44, v5, s[24:27], s41 offen
    s_endpgm
f_start:
    s_mov_b32 s20, s26
    s_mov_b32 s21, s27
    s_mov_b32 s26, 4194304
    s_mov_b32 s27, 0x00020000
    s_mov_b32 s22, s50
    s_mov_b32 s23, s51
    s_mov_b32 s28, s54
    s_mov_b32 s29, s55
    s_add_u32 s58, s36, tables-h_pc
    s_addc_u32 s59, s37, 0
    s_lshr_b32 s36, s35, 1
    s_and_b32 s36, s36, 4
    s_xor_b32 s36, s36, s16
    s_and_b32 s37, s34, 4
    s_xor_b32 s37, s37, s16
    s_lshl_b32 s3, s34, 4
    s_add_u32 s3, s3, s35
    v_and_b32 v4, 15, v0
    v_bfe_u32 v5, v0, 4, 2
    v_lshrrev_b32 v248, 3, v2
    v_lshlrev_b32 v248, 18, v248
    v_lshlrev_b32 v249, 1, v5
    v_xor_b32 v249, v249, v0
    v_and_b32 v249, 7, v249
    v_lshl_add_u32 v255, v249, 4, v248
    v_lshlrev_b32 v6, 16, v5
    v_lshl_add_u32 v6, v4, 4, v6
    s_lshl_b32 s60, s16, 15
    s_lshl_b32 s61, s34, 11
    s_add_u32 s60, s60, s61
    s_lshl_b32 s61, s35, 7
    s_add_u32 s60, s60, s61
    s_lshl_b32 s61, s16, 12
    s_add_u32 s61, s61, 61440
    s_lshl_b32 s64, s36, 19
    s_lshl_b32 s65, s35, 3
    s_and_b32 s66, s34, 1
    s_lshl_b32 s66, s66, 2
    s_add_u32 s65, s65, s66
    s_lshr_b32 s66, s34, 1
    s_add_u32 s65, s65, s66
    s_lshl_b32 s65, s65, 8
    s_add_u32 s64, s64, s65
    s_add_u32 s64, s64, 1048576
    s_add_u32 s65, s64, 32768
    s_add_u32 s66, s64, 262144
    s_add_u32 s67, s64, 294912
    s_barrier
    s_cmp_eq_u32 s36, 0
    s_cselect_b32 s42, 2048, 0
    s_add_u32 s42, s42, 16384
    v_add_u32 v248, s42, v3
    global_load_dwordx4 v[236:239], v248, s[58:59]
    global_load_dwordx4 v[240:243], v248, s[58:59] offset:1024
    s_lshr_b32 s42, s3, 4
    s_and_b32 s30, s3, 15
    s_lshl_b32 s30, s30, 4
    s_add_u32 s30, s30, s42
    s_lshr_b32 s42, s3, 3
    s_cmp_eq_u32 s42, 1
    s_cselect_b32 s42, 120, 0
    s_sub_u32 s30, s30, s42
    s_lshl_b32 s42, s16, 8
    s_add_u32 s30, s30, s42
    s_cmp_ge_u32 s16, 4
    s_cselect_b32 s42, 896, 0
    s_cmp_eq_u32 s3, 0
    s_cselect_b32 s42, s42, 0
    s_sub_u32 s30, s30, s42
    s_sub_u32 s31, 2048, s30
    s_cmp_eq_u32 s30, 0
    s_cselect_b32 s31, 1024, s31
    s_lshl_b32 s18, s30, 11
    s_lshl_b32 s19, s31, 11
    s_sub_u32 s75, s19, 2048
    s_lshl_b32 s68, s16, 12
    s_add_u32 s68, s68, 126976
    v_lshrrev_b32 v248, 1, v4
    v_and_b32 v249, 1, v0
    v_cmp_eq_u32 vcc, 1, v4
    s_nop 1
    v_cndmask_b32_e64 v250, v248, 0, vcc
    v_cndmask_b32_e64 v248, v248, 8, vcc
    v_cndmask_b32_e64 v249, v249, 0, vcc
    v_mad_u32_u24 v251, v248, v5, v249
    v_lshlrev_b32 v251, 5, v251
    v_mad_u32_u24 v251, v250, v1, v251
    v_cvt_f32_u32 v248, v248
    v_cvt_f32_u32 v250, v250
    v_cvt_f32_u32 v251, v251
    v_mul_f32 v248, 0x3d800000, v248
    v_mul_f32 v250, 0x3b800000, v250
    v_mul_f32 v216, 0x3c000000, v251
    v_add_f32 v217, v216, v248
    v_add_f32 v218, v217, v248
    v_add_f32 v219, v218, v248
    v_add_f32 v220, v216, v250
    v_add_f32 v221, v217, v250
    v_add_f32 v222, v218, v250
    v_add_f32 v223, v219, v250
    v_cos_f32 v216, v216
    v_cos_f32 v217, v217
    v_cos_f32 v218, v218
    v_cos_f32 v219, v219
    v_cos_f32 v220, v220
    v_cos_f32 v221, v221
    v_cos_f32 v222, v222
    v_cos_f32 v223, v223
    v_lshrrev_b32 v248, 2, v2
    v_lshlrev_b32 v8, 7, v248
    v_bfe_u32 v248, v0, 3, 2
    v_lshl_add_u32 v8, v248, 5, v8
    v_and_b32 v248, 3, v0
    v_lshl_add_u32 v8, v248, 3, v8
    v_lshl_add_u32 v8, v1, 12, v8
    v_xor_b32 v9, 32, v8
    v_xor_b32 v10, 64, v8
    v_xor_b32 v11, 96, v8
    v_lshlrev_b32 v12, 13, v5
    v_lshl_add_u32 v12, v4, 4, v12
    v_lshlrev_b32 v7, 5, v5
    v_and_b32 v248, 1, v0
    v_lshl_add_u32 v7, v248, 10, v7
    v_and_b32 v248, 2, v0
    v_lshl_add_u32 v7, v248, 3, v7
    s_lshl_b32 s70, s34, 11
    s_lshl_b32 s71, s16, 7
    s_add_u32 s71, s71, s70
    s_add_u32 s71, s71, 16777216
    s_lshr_b32 s42, s16, 1
    s_lshl_b32 s42, s42, 8
    s_and_b32 s43, s16, 1
    s_lshl_b32 s43, s43, 3
    s_add_u32 s42, s42, s43
    s_add_u32 s42, s42, 94208
    v_add_u32 v212, s42, v12
    s_lshl_b32 s42, s36, 12
    s_add_u32 s42, s42, 94208
    v_add_u32 v213, s42, v3
    s_mov_b32 s4, 0x3f803f80
    s_mov_b32 s5, 0x3a800000
    s_waitcnt vmcnt(6)
    s_load_dwordx2 s[32:33], s[20:21], 0
    v_dot2_f32_bf16 v108, v64, s4, 0
    v_dot2_f32_bf16 v110, v64, v64, 0
    v_dot2_f32_bf16 v108, v65, s4, v108
    v_dot2_f32_bf16 v110, v65, v65, v110
    v_dot2_f32_bf16 v108, v66, s4, v108
    v_dot2_f32_bf16 v110, v66, v66, v110
    v_dot2_f32_bf16 v108, v67, s4, v108
    v_dot2_f32_bf16 v110, v67, v67, v110
    s_waitcnt vmcnt(5)
    v_dot2_f32_bf16 v109, v72, s4, 0
    v_dot2_f32_bf16 v111, v72, v72, 0
    v_dot2_f32_bf16 v109, v73, s4, v109
    v_dot2_f32_bf16 v111, v73, v73, v111
    v_dot2_f32_bf16 v109, v74, s4, v109
    v_dot2_f32_bf16 v111, v74, v74, v111
    v_dot2_f32_bf16 v109, v75, s4, v109
    v_dot2_f32_bf16 v111, v75, v75, v111
    s_waitcnt vmcnt(4)
    v_dot2_f32_bf16 v108, v68, s4, v108
    v_dot2_f32_bf16 v110, v68, v68, v110
    v_dot2_f32_bf16 v108, v69, s4, v108
    v_dot2_f32_bf16 v110, v69, v69, v110
    v_dot2_f32_bf16 v108, v70, s4, v108
    v_dot2_f32_bf16 v110, v70, v70, v110
    v_dot2_f32_bf16 v108, v71, s4, v108
    v_dot2_f32_bf16 v110, v71, v71, v110
    s_waitcnt vmcnt(3)
    v_dot2_f32_bf16 v109, v76, s4, v109
    v_dot2_f32_bf16 v111, v76, v76, v111
    v_dot2_f32_bf16 v109, v77, s4, v109
    v_dot2_f32_bf16 v111, v77, v77, v111
    v_dot2_f32_bf16 v109, v78, s4, v109
    v_dot2_f32_bf16 v111, v78, v78, v111
    v_dot2_f32_bf16 v109, v79, s4, v109
    v_dot2_f32_bf16 v111, v79, v79, v111
    s_nop 1
    v_permlane32_swap_b32 v108, v109
    v_permlane32_swap_b32 v110, v111
    v_add_f32 v108, v108, v109
    v_add_f32 v110, v110, v111
    s_nop 0
    v_add_f32_dpp v108, v108, v108 row_ror:8 row_mask:0xf bank_mask:0xf
    v_add_f32_dpp v110, v110, v110 row_ror:8 row_mask:0xf bank_mask:0xf
    s_nop 0
    v_add_f32_dpp v108, v108, v108 row_ror:4 row_mask:0xf bank_mask:0xf
    v_add_f32_dpp v110, v110, v110 row_ror:4 row_mask:0xf bank_mask:0xf
    s_nop 0
    v_add_f32_dpp v108, v108, v108 row_ror:2 row_mask:0xf bank_mask:0xf
    v_add_f32_dpp v110, v110, v110 row_ror:2 row_mask:0xf bank_mask:0xf
    s_nop 0
    v_add_f32_dpp v108, v108, v108 row_ror:1 row_mask:0xf bank_mask:0xf
    v_add_f32_dpp v110, v110, v110 row_ror:1 row_mask:0xf bank_mask:0xf
    s_nop 0
    v_add_f32_dpp v108, v108, v108 row_bcast:15 row_mask:0xa bank_mask:0xf
    v_add_f32_dpp v110, v110, v110 row_bcast:15 row_mask:0xa bank_mask:0xf
    v_mul_f32 v108, s5, v108
    v_mul_f32 v110, s5, v110
    v_mul_f32 v116, v108, v108
    v_cvt_pk_bf16_f32 v117, -v108, -v108
    v_sub_f32 v110, v110, v116
    v_mul_f32 v118, 0x44000000, v110
    v_cmp_gt_f32 vcc, v116, v118
    v_readlane_b32 s40, v117, 31
    s_or_b32 s41, vcc_lo, vcc_hi
    s_bitcmp1_b32 s41, 31
    s_cbranch_scc1 f_slowvar
f_var:
    v_cvt_pk_bf16_f32 v110, v110, v110
    v_lshlrev_b32 v110, 16, v110
    v_add_f32 v110, 0x3727c5ac, v110
    v_cvt_pk_bf16_f32 v110, v110, v110
    v_lshlrev_b32 v110, 16, v110
    v_sqrt_f32 v110, v110
    s_and_b32 s40, s40, 0xffff
    v_mov_b32 v114, 0xffff0000
    v_cvt_pk_bf16_f32 v110, v110, v110
    v_lshlrev_b32 v110, 16, v110
    v_mul_f32 v110, 0x41800000, v110
    v_and_or_b32 v114, v117, v114, s40
    v_rcp_f32 v113, v110
    s_waitcnt lgkmcnt(0)
    s_cmp_lg_u32 s32, 0
    s_cbranch_scc1 f_nnx
    s_load_dwordx2 s[32:33], s[20:21], 64
    s_mov_b32 s83, 0
    v_mov_b32 v122, 0
    s_waitcnt lgkmcnt(0)
f_nn:
    s_cmp_lg_u32 s32, 0
    s_cbranch_scc1 f_nnx
    global_load_dwordx2 v[120:121], v122, s[20:21] sc1
    s_waitcnt vmcnt(0)
    v_readfirstlane_b32 s32, v120
    v_readfirstlane_b32 s33, v121
    s_add_u32 s83, s83, 1
    s_cmp_lt_u32 s83, 0x40000
    s_cbranch_scc1 f_nn
f_nnx:
    v_mov_b32 v115, s32
    v_mov_b32_dpp v112, v113 row_bcast:31 row_mask:0xc bank_mask:0xf
    v_mov_b32 v116, 0
    s_mov_b32 exec_lo, 0
    s_mov_b32 exec_hi, 0x80000000
    buffer_store_dwordx4 v[112:115], v116, s[12:15], s62 offen
    v_lshlrev_b32 v117, 4, v1
    v_add_u32 v117, 160768, v117
    ds_write_b128 v117, v[112:115]
    s_mov_b64 exec, -1
    s_mov_b32 m0, s61
    s_add_u32 s42, s60, 0
    s_add_u32 s61, s61, 1024
    buffer_load_dwordx4 v255, s[8:11], s42 offen lds
    s_mov_b32 m0, s61
    s_add_u32 s42, s60, 2097152
    s_add_u32 s61, s61, 1024
    buffer_load_dwordx4 v255, s[8:11], s42 offen lds
    s_mov_b32 m0, s61
    s_add_u32 s42, s60, 16384
    s_add_u32 s61, s61, 1024
    buffer_load_dwordx4 v255, s[8:11], s42 offen lds
    s_mov_b32 m0, s61
    s_add_u32 s42, s60, 2113536
    s_add_u32 s61, s61, 1024
    buffer_load_dwordx4 v255, s[8:11], s42 offen lds
    s_lshl_b32 s69, s16, 11
    v_add_u32 v254, s69, v3
    v_add_u32 v248, s68, v3
    ds_write_b128 v248, v[64:67] offset:0
    ds_write_b128 v248, v[68:71] offset:1024
    v_mov_b32 v244, s32
    v_mov_b32 v245, s33
    v_and_b32 v248, 4, v0
    v_cmp_eq_u32 vcc, 4, v248
    v_and_b32 v248, 3, v0
    v_lshlrev_b32 v248, 2, v248
    v_cndmask_b32 v244, v244, v245, vcc
    v_lshrrev_b32 v244, v248, v244
    s_mov_b32 s54, 0x00010001
    s_mov_b32 s55, 0xfffefffe
    s_mov_b32 s46, 0x05040100
    s_mov_b32 s47, 0x07060302
    v_lshrrev_b32 v245, 1, v244
    v_lshrrev_b32 v246, 2, v244
    v_lshrrev_b32 v247, 3, v244
    v_and_b32 v244, s54, v244
    v_and_b32 v245, s54, v245
    v_and_b32 v246, s54, v246
    v_and_b32 v247, s54, v247
    s_waitcnt vmcnt(2)
    s_mov_b32 exec_lo, 0x000f000f
    s_mov_b32 exec_hi, 0x000f000f
    buffer_load_dwordx4 v[24:27], v7, s[12:15], s71 offen sc1
    s_mov_b64 exec, -1
    s_mov_b32 s83, 0
    s_waitcnt vmcnt(1)
    ds_read_b64_tr_b16 v[40:41], v8 offset:61440
    ds_read_b64_tr_b16 v[42:43], v9 offset:61440
    ds_read_b64_tr_b16 v[44:45], v10 offset:61440
    ds_read_b64_tr_b16 v[46:47], v11 offset:61440
    ds_read_b64_tr_b16 v[48:49], v8 offset:63488
    ds_read_b64_tr_b16 v[50:51], v9 offset:63488
    ds_read_b64_tr_b16 v[52:53], v10 offset:63488
    ds_read_b64_tr_b16 v[54:55], v11 offset:63488
    s_mov_b32 exec_lo, 0x000f000f
    s_mov_b32 exec_hi, 0x000f000f
f_st:
    s_waitcnt vmcnt(0)
    v_cmp_ne_u32 vcc, s32, v27
    s_mov_b64 exec, -1
    s_cbranch_vccnz f_str
f_stx:
    s_setprio 3
    v_mov_b32_dpp v32, v26 row_newbcast:0 row_mask:0xf bank_mask:0xf
    v_mov_b32_dpp v33, v26 row_newbcast:1 row_mask:0xf bank_mask:0xf
    v_mov_b32_dpp v34, v26 row_newbcast:2 row_mask:0xf bank_mask:0xf
    v_mov_b32_dpp v35, v26 row_newbcast:3 row_mask:0xf bank_mask:0xf
    v_mul_f32_dpp v216, v24, v216 row_newbcast:0 row_mask:0xf bank_mask:0xf
    v_mul_f32_dpp v217, v24, v217 row_newbcast:1 row_mask:0xf bank_mask:0xf
    v_mul_f32_dpp v218, v24, v218 row_newbcast:2 row_mask:0xf bank_mask:0xf
    v_mul_f32_dpp v219, v24, v219 row_newbcast:3 row_mask:0xf bank_mask:0xf
    v_perm_b32 v28, v33, v32, s46
    v_perm_b32 v29, v35, v34, s46
    v_cvt_pk_bf16_f32 v224, v216, v217
    v_cvt_pk_bf16_f32 v225, v218, v219
    s_nop 1
    v_mfma_f32_16x16x16_bf16 v[228:231], v[224:225], v[28:29], 0
    v_mul_f32_dpp v220, v25, v220 row_newbcast:0 row_mask:0xf bank_mask:0xf
    v_mul_f32_dpp v221, v25, v221 row_newbcast:1 row_mask:0xf bank_mask:0xf
    v_mul_f32_dpp v222, v25, v222 row_newbcast:2 row_mask:0xf bank_mask:0xf
    v_mul_f32_dpp v223, v25, v223 row_newbcast:3 row_mask:0xf bank_mask:0xf
    v_perm_b32 v30, v33, v32, s47
    v_perm_b32 v31, v35, v34, s47
    v_cvt_pk_bf16_f32 v226, v220, v221
    v_cvt_pk_bf16_f32 v227, v222, v223
    s_nop 1
    v_mfma_f32_16x16x16_bf16 v[232:235], v[226:227], v[30:31], 0
    s_waitcnt lgkmcnt(0)
    v_mfma_f32_16x16x16_bf16 v[56:59], v[224:225], v[40:41], v[228:231]
    v_mfma_f32_16x16x16_bf16 v[60:63], v[226:227], v[48:49], v[232:235]
    v_mfma_f32_16x16x16_bf16 v[64:67], v[224:225], v[42:43], v[228:231]
    v_mfma_f32_16x16x16_bf16 v[68:71], v[226:227], v[50:51], v[232:235]
    s_mov_b32 m0, s68
    s_cmp_eq_u32 s34, 0
    s_cbranch_scc1 f_r0
f_nr:
    buffer_load_dwordx4 v3, s[8:11], s75 offen offset:2048 lds
    buffer_load_dwordx4 v3, s[8:11], s75 offen offset:3072 lds
    s_mov_b32 m0, s69
    s_nop 0
    global_load_lds_dwordx4 v254, s[58:59] offset:0
    global_load_lds_dwordx4 v254, s[58:59] offset:1024
    v_mfma_f32_16x16x16_bf16 v[72:75], v[224:225], v[44:45], v[228:231]
    v_mfma_f32_16x16x16_bf16 v[76:79], v[226:227], v[52:53], v[232:235]
    v_cvt_pk_f16_f32 v184, v56, v57
    v_cvt_pk_f16_f32 v185, v60, v61
    ds_write_b64 v212, v[184:185] offset:0
    v_cvt_pk_f16_f32 v186, v58, v59
    v_cvt_pk_f16_f32 v187, v62, v63
    ds_write_b64 v212, v[186:187] offset:4096
    v_mfma_f32_16x16x16_bf16 v[80:83], v[224:225], v[46:47], v[228:231]
    v_mfma_f32_16x16x16_bf16 v[84:87], v[226:227], v[54:55], v[232:235]
    v_cvt_pk_f16_f32 v188, v64, v65
    v_cvt_pk_f16_f32 v189, v68, v69
    ds_write_b64 v212, v[188:189] offset:1024
    v_cvt_pk_f16_f32 v190, v66, v67
    v_cvt_pk_f16_f32 v191, v70, v71
    ds_write_b64 v212, v[190:191] offset:5120
    v_cvt_pk_f16_f32 v192, v72, v73
    v_cvt_pk_f16_f32 v193, v76, v77
    ds_write_b64 v212, v[192:193] offset:2048
    v_cvt_pk_f16_f32 v194, v74, v75
    v_cvt_pk_f16_f32 v195, v78, v79
    ds_write_b64 v212, v[194:195] offset:6144
    v_cvt_pk_f16_f32 v196, v80, v81
    v_cvt_pk_f16_f32 v197, v84, v85
    ds_write_b64 v212, v[196:197] offset:3072
    v_cvt_pk_f16_f32 v198, v82, v83
    v_cvt_pk_f16_f32 v199, v86, v87
    ds_write_b64 v212, v[198:199] offset:7168
    s_waitcnt lgkmcnt(0)
    s_barrier
    ds_read_b128 v[152:155], v213 offset:0
    ds_read_b128 v[156:159], v213 offset:1024
    ds_read_b128 v[160:163], v213 offset:2048
    ds_read_b128 v[164:167], v213 offset:3072
    s_waitcnt lgkmcnt(3)
    v_mfma_f32_16x16x32_f16 v[56:59], v[236:239], v[152:155], 0
    s_waitcnt lgkmcnt(2)
    v_mfma_f32_16x16x32_f16 v[60:63], v[236:239], v[156:159], 0
    s_waitcnt lgkmcnt(1)
    v_mfma_f32_16x16x32_f16 v[64:67], v[236:239], v[160:163], 0
    s_waitcnt lgkmcnt(0)
    v_mfma_f32_16x16x32_f16 v[68:71], v[236:239], v[164:167], 0
    v_mfma_f32_16x16x32_f16 v[72:75], v[240:243], v[152:155], 0
    v_mfma_f32_16x16x32_f16 v[76:79], v[240:243], v[156:159], 0
    v_mfma_f32_16x16x32_f16 v[80:83], v[240:243], v[160:163], 0
    v_mfma_f32_16x16x32_f16 v[84:87], v[240:243], v[164:167], 0
    v_cvt_pk_f16_f32 v184, v56, v57
    v_cvt_pk_f16_f32 v185, v60, v61
    v_cvt_pk_f16_f32 v186, v64, v65
    s_nop 0
    v_cvt_pk_f16_f32 v187, v68, v69
    v_and_or_b32 v184, v184, s55, v244
    v_and_or_b32 v185, v185, s55, v245
    v_and_or_b32 v186, v186, s55, v246
    v_and_or_b32 v187, v187, s55, v247
    buffer_store_dwordx4 v[184:187], v6, s[12:15], s64 offen sc1
    v_cvt_pk_f16_f32 v188, v58, v59
    v_cvt_pk_f16_f32 v189, v62, v63
    v_cvt_pk_f16_f32 v190, v66, v67
    v_cvt_pk_f16_f32 v191, v70, v71
    v_and_or_b32 v188, v188, s55, v244
    v_and_or_b32 v189, v189, s55, v245
    v_and_or_b32 v190, v190, s55, v246
    v_and_or_b32 v191, v191, s55, v247
    buffer_store_dwordx4 v[188:191], v6, s[12:15], s65 offen sc1
    v_cvt_pk_f16_f32 v192, v72, v73
    v_cvt_pk_f16_f32 v193, v76, v77
    v_cvt_pk_f16_f32 v194, v80, v81
    v_cvt_pk_f16_f32 v195, v84, v85
    v_and_or_b32 v192, v192, s55, v244
    v_and_or_b32 v193, v193, s55, v245
    v_and_or_b32 v194, v194, s55, v246
    v_and_or_b32 v195, v195, s55, v247
    buffer_store_dwordx4 v[192:195], v6, s[12:15], s66 offen sc1
    v_cvt_pk_f16_f32 v196, v74, v75
    v_cvt_pk_f16_f32 v197, v78, v79
    v_cvt_pk_f16_f32 v198, v82, v83
    v_cvt_pk_f16_f32 v199, v86, v87
    v_and_or_b32 v196, v196, s55, v244
    v_and_or_b32 v197, v197, s55, v245
    v_and_or_b32 v198, v198, s55, v246
    v_and_or_b32 v199, v199, s55, v247
    buffer_store_dwordx4 v[196:199], v6, s[12:15], s67 offen sc1
    s_setprio 0
    s_mov_b32 s43, 0
    s_lshr_b32 s42, s3, 4
    s_and_b32 s40, s3, 15
    s_lshl_b32 s40, s40, 4
    s_add_u32 s40, s40, s42
    s_lshr_b32 s42, s3, 3
    s_cmp_eq_u32 s42, 1
    s_cselect_b32 s42, 120, 0
    s_sub_u32 s40, s40, s42
    s_lshl_b32 s42, s43, 8
    s_add_u32 s40, s40, s42
    s_cmp_ge_u32 s43, 4
    s_cselect_b32 s42, 896, 0
    s_cmp_eq_u32 s3, 0
    s_cselect_b32 s42, s42, 0
    s_sub_u32 s40, s40, s42
    v_lshrrev_b32 v248, 1, v4
    v_and_b32 v249, 1, v0
    v_lshlrev_b32 v250, 8, v248
    v_add_u32 v250, s40, v250
    s_cmp_lg_u32 s3, 0
    s_cbranch_scc1 f_a3n
    v_cmp_lt_u32 s[44:45], 3, v248
    v_subrev_u32 v251, 896, v250
    s_nop 0
    v_cndmask_b32 v250, v250, v251, s[44:45]
    v_cmp_eq_u32 vcc, 1, v4
    v_mov_b32 v251, 1024
    s_nop 0
    v_cndmask_b32 v250, v250, v251, vcc
    v_cndmask_b32_e64 v249, v249, 0, vcc
f_a3n:
    v_lshlrev_b32 v251, 1, v5
    v_mul_u32_u24 v251, v251, v250
    v_lshl_add_u32 v251, v249, 9, v251
    v_add_u32 v253, v251, v250
    v_add_u32 v252, 1536, v251
    v_add_u32 v254, 1536, v253
    v_and_b32 v251, 2047, v251
    v_and_b32 v252, 2047, v252
    v_and_b32 v253, 2047, v253
    v_and_b32 v254, 2047, v254
    v_cvt_f32_u32 v251, v251
    v_cvt_f32_u32 v252, v252
    v_cvt_f32_u32 v253, v253
    v_cvt_f32_u32 v254, v254
    v_mul_f32 v251, 0x3a000000, v251
    v_mul_f32 v252, 0x3a000000, v252
    v_mul_f32 v253, 0x3a000000, v253
    v_mul_f32 v254, 0x3a000000, v254
    v_cos_f32 v251, v251
    v_cos_f32 v252, v252
    v_cos_f32 v253, v253
    v_cos_f32 v254, v254
    s_cbranch_scc1 f_a3m
    v_cmp_gt_u32 vcc, 2, v4
    s_nop 1
    v_cndmask_b32_e64 v249, 1.0, 0.5, vcc
    v_mul_f32 v251, v251, v249
    v_mul_f32 v253, v253, v249
    v_cndmask_b32 v252, 0, v251, s[44:45]
    v_cndmask_b32 v254, 0, v253, s[44:45]
    v_cndmask_b32 v251, v251, 0, s[44:45]
    v_cndmask_b32 v253, v253, 0, s[44:45]
f_a3m:
    v_cvt_pk_f16_f32 v22, v251, v252
    v_cvt_pk_f16_f32 v23, v253, v254
    v_and_b32 v248, 3, v0
    v_bfe_u32 v249, v0, 2, 1
    v_bfe_u32 v250, v0, 3, 2
    v_bfe_u32 v251, v0, 5, 1
    v_lshlrev_b32 v13, 10, v249
    v_lshl_add_u32 v15, v251, 8, v13
    v_lshl_add_u32 v15, v250, 6, v15
    v_lshl_add_u32 v15, v248, 4, v15
    v_lshl_add_u32 v13, v250, 8, v13
    v_lshl_add_u32 v13, v248, 6, v13
    v_lshl_add_u32 v13, v251, 5, v13
    v_xor_b32 v14, 2016, v13
    v_add_u32 v13, s68, v13
    v_add_u32 v14, s68, v14
    s_waitcnt vmcnt(4)
    s_barrier
    ds_read_b128 v[200:203], v13 offset:0
    ds_read_b128 v[204:207], v13 offset:16
    ds_read_b128 v[208:211], v14 offset:2048
    ds_read_b128 v[212:215], v14 offset:2064
    s_cmp_lg_u32 s16, 0
    s_cbranch_scc1 f_sb2
    v_add_u32 v116, 160768, v3
    s_mov_b64 exec, 0xff
    ds_read_b128 v[112:115], v116
    s_waitcnt lgkmcnt(0)
    buffer_store_dwordx4 v[112:115], v3, s[12:15], s63 offen sc1
    s_mov_b64 exec, -1
f_sb2:
    s_lshl_b32 s42, s3, 13
    s_lshl_b32 s43, s16, 10
    s_add_u32 s42, s42, s43
    s_add_u32 s42, s42, 18874368
    v_mov_b32 v40, -1
    v_mov_b32 v41, -1
    v_mov_b32 v42, -1
    v_mov_b32 v43, -1
    buffer_store_dwordx4 v[40:43], v3, s[12:15], s42 offen sc1
    v_lshrrev_b32 v18, 3, v2
    v_lshlrev_b32 v18, 14, v18
    v_and_b32 v248, 0x70, v3
    v_add_u32 v18, v18, v248
    s_lshl_b32 s80, s3, 7
    s_add_u32 s80, s80, 17039360
    s_cmp_lg_u32 s16, 0
    s_cbranch_scc1 f_nkw
    buffer_store_dwordx4 v[40:43], v18, s[12:15], s80 offen sc1
f_nkw:
    s_lshl_b32 s72, s3, 15
    s_lshl_b32 s73, s37, 12
    s_add_u32 s72, s72, s73
    s_add_u32 s72, s72, 1048576
    s_waitcnt lgkmcnt(0)
    ds_read_b128 v[88:91], v3 offset:0
    ds_read_b128 v[92:95], v3 offset:1024
    ds_read_b128 v[96:99], v3 offset:2048
    ds_read_b128 v[100:103], v3 offset:3072
    ds_read_b128 v[104:107], v3 offset:4096
    ds_read_b128 v[108:111], v3 offset:5120
    ds_read_b128 v[112:115], v3 offset:6144
    ds_read_b128 v[116:119], v3 offset:7168
    ds_read_b128 v[120:123], v3 offset:8192
    ds_read_b128 v[124:127], v3 offset:9216
    ds_read_b128 v[128:131], v3 offset:10240
    ds_read_b128 v[132:135], v3 offset:11264
    ds_read_b128 v[136:139], v3 offset:12288
    ds_read_b128 v[140:143], v3 offset:13312
    ds_read_b128 v[144:147], v3 offset:14336
    ds_read_b128 v[148:151], v3 offset:15360
    v_lshlrev_b32 v152, 16, v200
    v_and_b32 v153, 0xffff0000, v200
    v_lshlrev_b32 v154, 16, v201
    v_and_b32 v155, 0xffff0000, v201
    v_lshlrev_b32 v156, 16, v202
    v_and_b32 v157, 0xffff0000, v202
    v_lshlrev_b32 v158, 16, v203
    v_and_b32 v159, 0xffff0000, v203
    v_lshlrev_b32 v160, 16, v204
    v_and_b32 v161, 0xffff0000, v204
    v_lshlrev_b32 v162, 16, v205
    v_and_b32 v163, 0xffff0000, v205
    v_lshlrev_b32 v164, 16, v206
    v_and_b32 v165, 0xffff0000, v206
    v_lshlrev_b32 v166, 16, v207
    v_and_b32 v167, 0xffff0000, v207
    v_lshlrev_b32 v168, 16, v208
    v_and_b32 v183, 0xffff0000, v208
    v_lshlrev_b32 v182, 16, v209
    v_and_b32 v181, 0xffff0000, v209
    v_lshlrev_b32 v180, 16, v210
    v_and_b32 v179, 0xffff0000, v210
    v_lshlrev_b32 v178, 16, v211
    v_and_b32 v177, 0xffff0000, v211
    v_lshlrev_b32 v176, 16, v212
    v_and_b32 v175, 0xffff0000, v212
    v_lshlrev_b32 v174, 16, v213
    v_and_b32 v173, 0xffff0000, v213
    v_lshlrev_b32 v172, 16, v214
    v_and_b32 v171, 0xffff0000, v214
    v_lshlrev_b32 v170, 16, v215
    v_and_b32 v169, 0xffff0000, v215
    s_waitcnt vmcnt(1)
    s_barrier
    buffer_load_dwordx4 v[24:27], v3, s[12:15], s72 offen offset:0 sc1
    buffer_load_dwordx4 v[28:31], v3, s[12:15], s72 offen offset:1024 sc1
    buffer_load_dwordx4 v[32:35], v3, s[12:15], s72 offen offset:2048 sc1
    buffer_load_dwordx4 v[36:39], v3, s[12:15], s72 offen offset:3072 sc1
    v_xor_b32 v16, 1520, v15
    v_subrev_u32 v248, s68, v13
    v_add_u32 v248, 32, v248
    v_bfe_u32 v19, v248, 5, 1
    v_lshlrev_b32 v19, 5, v19
    v_bfe_u32 v249, v248, 8, 2
    v_lshl_add_u32 v19, v249, 3, v19
    v_bfe_u32 v249, v248, 10, 1
    v_lshl_add_u32 v19, v249, 2, v19
    v_bfe_u32 v249, v248, 6, 2
    v_add_lshl_u32 v19, v249, v19, 2
    s_lshl_b32 s74, s34, 14
    s_add_u32 s74, s74, 17039360
    s_lshl_b32 s42, s37, 9
    s_add_u32 s42, s42, 61440
    v_add_u32 v12, s42, v12
    s_mul_i32 s17, s34, 7
    s_lshr_b32 s42, s35, 1
    s_add_u32 s17, s17, s42
    s_lshl_b32 s42, s17, 6
    s_lshr_b32 s43, s16, 2
    s_lshl_b32 s43, s43, 5
    s_add_u32 s42, s42, s43
    s_and_b32 s43, s16, 1
    s_lshl_b32 s43, s43, 4
    s_add_u32 s42, s42, s43
    s_and_b32 s43, s16, 2
    s_lshl_b32 s43, s43, 1
    s_add_u32 s42, s42, s43
    s_lshl_b32 s38, s42, 11
    s_and_b32 s43, s35, 1
    s_lshl_b32 s43, s43, 10
    s_add_u32 s38, s38, s43
    s_lshl_b32 s39, s16, 13
    s_add_u32 s39, s39, 94208
    s_mov_b32 s48, s28
    s_mov_b32 s49, s29
    s_mov_b32 s50, 7340032
    s_mov_b32 s51, 0x00020000
    v_lshlrev_b32 v17, 7, v4
    s_and_b32 s40, s16, 3
    s_lshl_b32 s76, s40, 10
    v_add_u32 v4, s76, v3
    v_xor_b32 v6, 1008, v3
    s_sub_u32 s42, 4096, s76
    s_and_b32 s42, s42, 3072
    v_add_u32 v5, s42, v6
    s_sub_u32 s42, 3072, s76
    v_add_u32 v6, s42, v6
    v_subrev_u32 v248, s68, v13
    v_lshrrev_b32 v248, 1, v248
    s_lshl_b32 s42, s40, 2
    v_add_u32 v248, s42, v248
    v_bfe_u32 v235, v248, 7, 1
    v_lshlrev_b32 v235, 9, v235
    v_and_b32 v249, 31, v248
    v_lshl_add_u32 v235, v249, 4, v235
    v_bfe_u32 v249, v248, 8, 1
    v_lshl_add_u32 v235, v249, 3, v235
    v_lshrrev_b32 v249, 9, v248
    v_lshl_add_u32 v235, v249, 10, v235
    v_bfe_u32 v249, v248, 5, 2
    v_lshl_add_u32 v235, v249, 1, v235
    v_mov_b32 v8, s32
    v_mov_b32 v9, s33
    v_and_b32 v10, 1, v0
    v_cmp_eq_u32 vcc, 1, v10
    s_nop 1
    v_cndmask_b32 v8, v8, v9, vcc
    v_bfe_u32 v9, v8, 8, 8
    v_bfe_u32 v10, v8, 16, 8
    v_lshrrev_b32 v11, 24, v8
    v_and_b32 v8, 0xff, v8
    s_add_u32 s76, s76, 16875520
    s_mov_b32 s77, 16850944
    s_xor_b32 s79, s35, 1
    s_xor_b32 s43, s16, 1
    s_or_b32 s79, s79, s43
    s_cmp_ge_u32 s16, 4
    s_cselect_b32 s64, 4, 1
    s_cselect_b32 s65, 3, 2
    s_lshl_b32 s64, s64, 12
    s_lshl_b32 s65, s65, 12
    s_add_u32 s64, s64, s76
    s_add_u32 s65, s65, s76
    s_lshl_b32 s42, s16, 12
    s_add_u32 s42, s42, 61440
    v_add_u32 v7, s42, v3
    s_cmp_eq_u32 s3, 0
    s_cselect_b64 s[52:53], -1, 1
    v_mov_b32 v192, v8
    v_mov_b32 v193, v9
    v_mov_b32 v194, v10
    v_mov_b32 v195, v11
    s_waitcnt vmcnt(3)
    buffer_load_dwordx4 v[184:187], v3, s[12:15], s64 offen sc1
    buffer_load_dwordx4 v[188:191], v3, s[12:15], s65 offen sc1
    s_mov_b64 exec, 0xffff
    buffer_load_dwordx4 v[236:239], v17, s[12:15], s77 offen sc1
    s_mov_b64 exec, s[52:53]
    buffer_load_dwordx4 v[192:195], v3, s[12:15], s76 offen sc1
    s_mov_b64 exec, -1
    s_mov_b32 s83, 0
    s_waitcnt vmcnt(6)
f_zc:
    v_xor_b32 v40, v24, v244
    v_xor_b32 v41, v28, v244
    v_xor_b32 v42, v25, v245
    v_xor_b32 v43, v29, v245
    v_xor_b32 v44, v26, v246
    v_xor_b32 v45, v30, v246
    v_xor_b32 v46, v27, v247
    v_xor_b32 v47, v31, v247
    v_mfma_f32_16x16x16_f16 v[56:59], v[22:23], v[40:41], 0
    v_or3_b32 v248, v40, v41, 0
    v_mfma_f32_16x16x16_f16 v[64:67], v[22:23], v[44:45], 0
    v_or3_b32 v248, v44, v45, v248
    v_mfma_f32_16x16x16_f16 v[60:63], v[22:23], v[42:43], 0
    v_or3_b32 v248, v42, v43, v248
    v_mfma_f32_16x16x16_f16 v[68:71], v[22:23], v[46:47], 0
    v_or3_b32 v248, v46, v47, v248
    s_waitcnt vmcnt(4)
    v_xor_b32 v48, v32, v244
    v_xor_b32 v49, v36, v244
    v_xor_b32 v50, v33, v245
    v_xor_b32 v51, v37, v245
    v_xor_b32 v52, v34, v246
    v_xor_b32 v53, v38, v246
    v_xor_b32 v54, v35, v247
    v_xor_b32 v55, v39, v247
    v_mfma_f32_16x16x16_f16 v[72:75], v[22:23], v[48:49], 0
    v_or3_b32 v248, v48, v49, v248
    v_mfma_f32_16x16x16_f16 v[80:83], v[22:23], v[52:53], 0
    v_or3_b32 v248, v52, v53, v248
    v_mfma_f32_16x16x16_f16 v[76:79], v[22:23], v[50:51], 0
    v_or3_b32 v248, v50, v51, v248
    v_mfma_f32_16x16x16_f16 v[84:87], v[22:23], v[54:55], 0
    v_or3_b32 v248, v54, v55, v248
    v_and_b32 v248, s54, v248
    v_cmp_ne_u32 vcc, 0, v248
    s_cbranch_vccnz f_zr
f_zx:
    v_cvt_pk_f16_f32 v24, v56, v57
    v_cvt_pk_f16_f32 v25, v64, v65
    v_cvt_pk_f16_f32 v26, v72, v73
    v_cvt_pk_f16_f32 v27, v80, v81
    ds_write_b128 v12, v[24:27] offset:0
    v_cvt_pk_f16_f32 v28, v58, v59
    v_cvt_pk_f16_f32 v29, v66, v67
    v_cvt_pk_f16_f32 v30, v74, v75
    v_cvt_pk_f16_f32 v31, v82, v83
    ds_write_b128 v12, v[28:31] offset:4096
    v_cvt_pk_f16_f32 v32, v60, v61
    v_cvt_pk_f16_f32 v33, v68, v69
    v_cvt_pk_f16_f32 v34, v76, v77
    v_cvt_pk_f16_f32 v35, v84, v85
    ds_write_b128 v12, v[32:35] offset:256
    v_cvt_pk_f16_f32 v36, v62, v63
    v_cvt_pk_f16_f32 v37, v70, v71
    v_cvt_pk_f16_f32 v38, v78, v79
    v_cvt_pk_f16_f32 v39, v86, v87
    ds_write_b128 v12, v[36:39] offset:4352
    s_mov_b32 s83, 0
    s_waitcnt vmcnt(0)
f_pv:
    v_xor_b32 v184, v8, v184
    v_xor_b32 v185, v9, v185
    v_xor_b32 v186, v10, v186
    v_xor_b32 v187, v11, v187
    v_xor_b32 v188, v8, v188
    v_xor_b32 v189, v9, v189
    v_xor_b32 v190, v10, v190
    v_xor_b32 v191, v11, v191
    v_xor_b32 v192, v8, v192
    v_xor_b32 v193, v9, v193
    v_xor_b32 v194, v10, v194
    v_xor_b32 v195, v11, v195
    v_or3_b32 v248, v184, v185, 0
    v_or3_b32 v248, v186, v187, v248
    v_or3_b32 v248, v188, v189, v248
    v_or3_b32 v248, v190, v191, v248
    v_or3_b32 v248, v192, v193, v248
    v_or3_b32 v248, v194, v195, v248
    v_cmp_ne_u64 s[44:45], s[32:33], v[236:237]
    v_and_b32 v248, 0xff, v248
    v_cmp_ne_u32 vcc, 0, v248
    v_add_f32_dpp v239, v238, v238 quad_perm:[1,0,3,2] row_mask:0xf bank_mask:0xf
    s_and_b32 s44, s44, 0xffff
    s_or_b32 vcc_lo, vcc_lo, s44
    s_cbranch_vccnz f_pr
f_pw:
    v_add_f32_dpp v239, v239, v239 quad_perm:[2,3,0,1] row_mask:0xf bank_mask:0xf
    s_cmp_ge_u32 s16, 4
    s_cbranch_scc1 f_ph
    v_max_f32_dpp v238, v238, v238 quad_perm:[1,0,3,2] row_mask:0xf bank_mask:0xf
    s_nop 1
    v_max_f32_dpp v238, v238, v238 quad_perm:[2,3,0,1] row_mask:0xf bank_mask:0xf
    s_nop 1
    v_max_f32_dpp v238, v238, v238 row_half_mirror row_mask:0xf bank_mask:0xf
    v_frexp_exp_i32_f32 v238, v238
    s_nop 0
    v_readfirstlane_b32 s42, v238
    s_sub_u32 s43, -1, s42
    s_add_u32 s44, s42, 5
    s_sub_u32 s45, 5, s42
    v_ldexp_f32 v184, v184, s43
    v_ldexp_f32 v185, v185, s43
    v_ldexp_f32 v186, v186, s43
    v_ldexp_f32 v187, v187, s43
    v_cvt_pk_f16_f32 v184, v184, v185
    v_cvt_pk_f16_f32 v186, v186, v187
    ds_write_b16 v235, v184 offset:16384
    ds_write_b16_d16_hi v235, v184 offset:16400
    ds_write_b16 v235, v186 offset:16416
    ds_write_b16_d16_hi v235, v186 offset:16432
    v_ldexp_f32 v188, v188, s44
    v_ldexp_f32 v189, v189, s44
    v_ldexp_f32 v190, v190, s44
    v_ldexp_f32 v191, v191, s44
    ds_write_b128 v4, v[188:191] offset:20480
    ds_write_b32 v5, v188 offset:24576
    ds_write_b32 v6, v189 offset:24588
    ds_write_b32 v6, v190 offset:24584
    ds_write_b32 v6, v191 offset:24580
    s_cmp_lg_u32 s3, 0
    s_cbranch_scc1 f_pvx
    v_ldexp_f32 v192, v192, s45
    v_ldexp_f32 v193, v193, s45
    v_ldexp_f32 v194, v194, s45
    v_ldexp_f32 v195, v195, s45
    v_cvt_pk_f16_f32 v192, v192, v193
    v_cvt_pk_f16_f32 v194, v194, v195
    ds_write_b16 v235, v192 offset:18432
    ds_write_b16_d16_hi v235, v192 offset:18448
    ds_write_b16 v235, v194 offset:18464
    ds_write_b16_d16_hi v235, v194 offset:18480
    s_branch f_pvx
f_ph:
    ds_write_b128 v4, v[184:187] offset:28672
    ds_write_b32 v5, v184 offset:32768
    ds_write_b32 v6, v185 offset:32780
    ds_write_b32 v6, v186 offset:32776
    ds_write_b32 v6, v187 offset:32772
    ds_write_b128 v4, v[188:191] offset:36864
    ds_write_b32 v5, v188 offset:40960
    ds_write_b32 v6, v189 offset:40972
    ds_write_b32 v6, v190 offset:40968
    ds_write_b32 v6, v191 offset:40964
f_pvx:
    v_readlane_b32 s66, v239, 12
    s_waitcnt lgkmcnt(0)
    s_barrier
    ds_read_b128 v[248:251], v3 offset:16384
    ds_read_b128 v[24:27], v7 offset:0
    ds_read_b128 v[28:31], v7 offset:1024
    ds_read_b128 v[252:255], v3 offset:17408
    ds_read_b128 v[32:35], v7 offset:2048
    ds_read_b128 v[36:39], v7 offset:3072
    s_cmp_eq_u32 s30, 0
    s_cbranch_scc1 f_sp
    s_waitcnt lgkmcnt(4)
    v_pk_mul_f16 v40, v24, v248 op_sel:[0,0] op_sel_hi:[1,0]
    v_pk_mul_f16 v41, v25, v248 op_sel:[0,1] op_sel_hi:[1,1]
    v_pk_mul_f16 v42, v26, v249 op_sel:[0,0] op_sel_hi:[1,0]
    v_pk_mul_f16 v43, v27, v249 op_sel:[0,1] op_sel_hi:[1,1]
    s_nop 1
    v_mfma_f32_32x32x16_f16 v[56:71], v[40:43], v[88:91], 0
    s_waitcnt lgkmcnt(3)
    v_pk_mul_f16 v44, v28, v250 op_sel:[0,0] op_sel_hi:[1,0]
    v_pk_mul_f16 v45, v29, v250 op_sel:[0,1] op_sel_hi:[1,1]
    v_pk_mul_f16 v46, v30, v251 op_sel:[0,0] op_sel_hi:[1,0]
    v_pk_mul_f16 v47, v31, v251 op_sel:[0,1] op_sel_hi:[1,1]
    v_mfma_f32_32x32x16_f16 v[72:87], v[40:43], v[104:107], 0
    s_waitcnt lgkmcnt(1)
    v_pk_mul_f16 v48, v32, v252 op_sel:[0,0] op_sel_hi:[1,0]
    v_pk_mul_f16 v49, v33, v252 op_sel:[0,1] op_sel_hi:[1,1]
    v_pk_mul_f16 v50, v34, v253 op_sel:[0,0] op_sel_hi:[1,0]
    v_pk_mul_f16 v51, v35, v253 op_sel:[0,1] op_sel_hi:[1,1]
    v_mfma_f32_32x32x16_f16 v[56:71], v[44:47], v[92:95], v[56:71]
    s_waitcnt lgkmcnt(0)
    v_pk_mul_f16 v52, v36, v254 op_sel:[0,0] op_sel_hi:[1,0]
    v_pk_mul_f16 v53, v37, v254 op_sel:[0,1] op_sel_hi:[1,1]
    v_pk_mul_f16 v54, v38, v255 op_sel:[0,0] op_sel_hi:[1,0]
    v_pk_mul_f16 v55, v39, v255 op_sel:[0,1] op_sel_hi:[1,1]
    v_mfma_f32_32x32x16_f16 v[72:87], v[44:47], v[108:111], v[72:87]
f_st1:
    v_mfma_f32_32x32x16_f16 v[56:71], v[48:51], v[96:99], v[56:71]
    ds_read_b128 v[184:187], v3 offset:20480
    ds_read_b128 v[188:191], v3 offset:21504
    v_mfma_f32_32x32x16_f16 v[72:87], v[48:51], v[112:115], v[72:87]
    ds_read_b128 v[192:195], v3 offset:22528
    ds_read_b128 v[196:199], v3 offset:23552
    v_mfma_f32_32x32x16_f16 v[56:71], v[52:55], v[100:103], v[56:71]
    ds_read_b128 v[200:203], v3 offset:24576
    ds_read_b128 v[204:207], v3 offset:25600
    v_mfma_f32_32x32x16_f16 v[72:87], v[52:55], v[116:119], v[72:87]
    ds_read_b128 v[208:211], v3 offset:26624
    ds_read_b128 v[212:215], v3 offset:27648
    s_cmp_ge_u32 s35, 14
    s_cbranch_scc1 f_nd1
    s_add_u32 s43, s39, 0
    s_mov_b32 m0, s43
    s_add_u32 s42, s38, 0
    buffer_load_dwordx4 v3, s[48:51], s42 offen nt lds
    s_add_u32 s43, s39, 1024
    s_mov_b32 m0, s43
    s_add_u32 s42, s38, 2048
    v_xor_b32 v7, 32, v3
    buffer_load_dwordx4 v7, s[48:51], s42 offen nt lds
    s_add_u32 s43, s39, 2048
    s_mov_b32 m0, s43
    s_add_u32 s42, s38, 4096
    v_xor_b32 v7, 64, v3
    buffer_load_dwordx4 v7, s[48:51], s42 offen nt lds
    s_add_u32 s43, s39, 3072
    s_mov_b32 m0, s43
    s_add_u32 s42, s38, 6144
    v_xor_b32 v7, 96, v3
    buffer_load_dwordx4 v7, s[48:51], s42 offen nt lds
f_nd1:
    s_cmp_eq_u32 s30, 0
    s_cbranch_scc1 f_sp2
    v_pk_mul_f32 v[24:25], v[56:57], v[120:121]
    v_pk_mul_f32 v[28:29], v[72:73], v[120:121]
    v_pk_mul_f32 v[26:27], v[58:59], v[122:123]
    v_pk_mul_f32 v[30:31], v[74:75], v[122:123]
    v_pk_fma_f32 v[24:25], v[72:73], v[136:137], v[24:25]
    v_pk_fma_f32 v[28:29], v[56:57], v[136:137], v[28:29] neg_lo:[1,0,0] neg_hi:[1,0,0]
    v_pk_fma_f32 v[26:27], v[74:75], v[138:139], v[26:27]
    v_pk_fma_f32 v[30:31], v[58:59], v[138:139], v[30:31] neg_lo:[1,0,0] neg_hi:[1,0,0]
    v_cvt_pk_f16_f32 v40, v24, v28
    v_cvt_pk_f16_f32 v41, v25, v29
    v_cvt_pk_f16_f32 v42, v26, v30
    v_cvt_pk_f16_f32 v43, v27, v31
    ds_read_b128 v[216:219], v3 offset:28672
    ds_read_b128 v[220:223], v3 offset:29696
    ds_read_b128 v[224:227], v3 offset:30720
    ds_read_b128 v[228:231], v3 offset:31744
    v_pk_mul_f32 v[32:33], v[60:61], v[124:125]
    v_pk_mul_f32 v[36:37], v[76:77], v[124:125]
    v_pk_mul_f32 v[34:35], v[62:63], v[126:127]
    v_pk_mul_f32 v[38:39], v[78:79], v[126:127]
    v_pk_fma_f32 v[32:33], v[76:77], v[140:141], v[32:33]
    v_pk_fma_f32 v[36:37], v[60:61], v[140:141], v[36:37] neg_lo:[1,0,0] neg_hi:[1,0,0]
    v_pk_fma_f32 v[34:35], v[78:79], v[142:143], v[34:35]
    v_pk_fma_f32 v[38:39], v[62:63], v[142:143], v[38:39] neg_lo:[1,0,0] neg_hi:[1,0,0]
    v_cvt_pk_f16_f32 v44, v32, v36
    v_cvt_pk_f16_f32 v45, v33, v37
    v_cvt_pk_f16_f32 v46, v34, v38
    v_cvt_pk_f16_f32 v47, v35, v39
    v_mfma_f32_32x32x16_f16 v[104:119], v[40:43], v[88:91], 0
    ds_read_b128 v[232:235], v3 offset:32768
    ds_read_b128 v[236:239], v3 offset:33792
    ds_read_b128 v[240:243], v3 offset:34816
    ds_read_b128 v[244:247], v3 offset:35840
    v_pk_mul_f32 v[24:25], v[64:65], v[128:129]
    v_pk_mul_f32 v[28:29], v[80:81], v[128:129]
    v_pk_mul_f32 v[26:27], v[66:67], v[130:131]
    v_pk_mul_f32 v[30:31], v[82:83], v[130:131]
    v_pk_fma_f32 v[24:25], v[80:81], v[144:145], v[24:25]
    v_pk_fma_f32 v[28:29], v[64:65], v[144:145], v[28:29] neg_lo:[1,0,0] neg_hi:[1,0,0]
    v_pk_fma_f32 v[26:27], v[82:83], v[146:147], v[26:27]
    v_pk_fma_f32 v[30:31], v[66:67], v[146:147], v[30:31] neg_lo:[1,0,0] neg_hi:[1,0,0]
    v_cvt_pk_f16_f32 v48, v24, v28
    v_cvt_pk_f16_f32 v49, v25, v29
    v_cvt_pk_f16_f32 v50, v26, v30
    v_cvt_pk_f16_f32 v51, v27, v31
    v_mfma_f32_32x32x16_f16 v[104:119], v[44:47], v[92:95], v[104:119]
    v_pk_mul_f32 v[32:33], v[68:69], v[132:133]
    v_pk_mul_f32 v[36:37], v[84:85], v[132:133]
    v_pk_mul_f32 v[34:35], v[70:71], v[134:135]
    v_pk_mul_f32 v[38:39], v[86:87], v[134:135]
    v_pk_fma_f32 v[32:33], v[84:85], v[148:149], v[32:33]
    v_pk_fma_f32 v[36:37], v[68:69], v[148:149], v[36:37] neg_lo:[1,0,0] neg_hi:[1,0,0]
    v_pk_fma_f32 v[34:35], v[86:87], v[150:151], v[34:35]
    v_pk_fma_f32 v[38:39], v[70:71], v[150:151], v[38:39] neg_lo:[1,0,0] neg_hi:[1,0,0]
    v_cvt_pk_f16_f32 v52, v32, v36
    v_cvt_pk_f16_f32 v53, v33, v37
    v_cvt_pk_f16_f32 v54, v34, v38
    v_cvt_pk_f16_f32 v55, v35, v39
    v_mfma_f32_32x32x16_f16 v[104:119], v[48:51], v[96:99], v[104:119]
    s_nop 0
    v_mfma_f32_32x32x16_f16 v[104:119], v[52:55], v[100:103], v[104:119]
    s_nop 11
    ds_bpermute_b32 v12, v19, v104
    s_waitcnt lgkmcnt(1)
    v_pk_fma_f32 v[152:153], v[184:185], v[104:105], v[152:153]
    v_pk_fma_f32 v[154:155], v[186:187], v[106:107], v[154:155]
    v_pk_fma_f32 v[156:157], v[188:189], v[108:109], v[156:157]
    v_pk_fma_f32 v[158:159], v[190:191], v[110:111], v[158:159]
    v_pk_fma_f32 v[160:161], v[192:193], v[112:113], v[160:161]
    v_pk_fma_f32 v[162:163], v[194:195], v[114:115], v[162:163]
    v_pk_fma_f32 v[164:165], v[196:197], v[116:117], v[164:165]
    v_pk_fma_f32 v[166:167], v[198:199], v[118:119], v[166:167]
    v_pk_fma_f32 v[170:171], v[202:203], v[106:107], v[170:171]
    v_pk_fma_f32 v[172:173], v[204:205], v[108:109], v[172:173]
    v_pk_fma_f32 v[174:175], v[206:207], v[110:111], v[174:175]
    v_pk_fma_f32 v[176:177], v[208:209], v[112:113], v[176:177]
    v_pk_fma_f32 v[178:179], v[210:211], v[114:115], v[178:179]
    v_pk_fma_f32 v[180:181], v[212:213], v[116:117], v[180:181]
    v_pk_fma_f32 v[182:183], v[214:215], v[118:119], v[182:183]
    v_fmac_f32 v169, v201, v105
    s_waitcnt lgkmcnt(0)
    v_fmac_f32 v168, v200, v12
f_join:
    ds_read_b128 v[88:91], v3 offset:36864
    ds_read_b128 v[92:95], v3 offset:37888
    ds_read_b128 v[96:99], v3 offset:38912
    ds_read_b128 v[100:103], v3 offset:39936
    ds_read_b128 v[120:123], v3 offset:40960
    ds_read_b128 v[124:127], v3 offset:41984
    ds_read_b128 v[128:131], v3 offset:43008
    ds_read_b128 v[132:135], v3 offset:44032
    v_lshrrev_b32 v17, 3, v0
    v_and_b32 v17, 60, v17
    v_add_u32 v17, 159744, v17
    v_and_b32 v7, 0xf0, v3
    v_lshrrev_b32 v7, 2, v7
    v_add_u32 v7, 159744, v7
    v_pk_add_f32 v[40:41], v[166:167], v[164:165]
    v_pk_add_f32 v[48:49], v[182:183], v[180:181]
    v_pk_add_f32 v[40:41], v[40:41], v[162:163]
    v_pk_add_f32 v[48:49], v[48:49], v[178:179]
    v_pk_add_f32 v[40:41], v[40:41], v[160:161]
    v_pk_add_f32 v[48:49], v[48:49], v[176:177]
    v_pk_add_f32 v[40:41], v[40:41], v[158:159]
    v_pk_add_f32 v[48:49], v[48:49], v[174:175]
    v_pk_add_f32 v[40:41], v[40:41], v[156:157]
    v_pk_add_f32 v[48:49], v[48:49], v[172:173]
    v_pk_add_f32 v[40:41], v[40:41], v[154:155]
    v_pk_add_f32 v[48:49], v[48:49], v[170:171]
    v_pk_add_f32 v[40:41], v[40:41], v[152:153]
    v_pk_add_f32 v[48:49], v[48:49], v[168:169]
    v_pk_mul_f32 v[42:43], v[166:167], v[166:167]
    v_pk_mul_f32 v[44:45], v[166:167], v[230:231]
    v_pk_mul_f32 v[50:51], v[182:183], v[182:183]
    v_pk_mul_f32 v[52:53], v[182:183], v[246:247]
    v_pk_fma_f32 v[42:43], v[164:165], v[164:165], v[42:43]
    v_pk_fma_f32 v[44:45], v[164:165], v[228:229], v[44:45]
    v_pk_fma_f32 v[50:51], v[180:181], v[180:181], v[50:51]
    v_pk_fma_f32 v[52:53], v[180:181], v[244:245], v[52:53]
    v_pk_fma_f32 v[42:43], v[162:163], v[162:163], v[42:43]
    v_pk_fma_f32 v[44:45], v[162:163], v[226:227], v[44:45]
    v_pk_fma_f32 v[50:51], v[178:179], v[178:179], v[50:51]
    v_pk_fma_f32 v[52:53], v[178:179], v[242:243], v[52:53]
    v_pk_fma_f32 v[42:43], v[160:161], v[160:161], v[42:43]
    v_pk_fma_f32 v[44:45], v[160:161], v[224:225], v[44:45]
    v_pk_fma_f32 v[50:51], v[176:177], v[176:177], v[50:51]
    v_pk_fma_f32 v[52:53], v[176:177], v[240:241], v[52:53]
    v_pk_fma_f32 v[42:43], v[158:159], v[158:159], v[42:43]
    v_pk_fma_f32 v[44:45], v[158:159], v[222:223], v[44:45]
    v_pk_fma_f32 v[50:51], v[174:175], v[174:175], v[50:51]
    v_pk_fma_f32 v[52:53], v[174:175], v[238:239], v[52:53]
    v_pk_fma_f32 v[42:43], v[156:157], v[156:157], v[42:43]
    v_pk_fma_f32 v[44:45], v[156:157], v[220:221], v[44:45]
    v_pk_fma_f32 v[50:51], v[172:173], v[172:173], v[50:51]
    v_pk_fma_f32 v[52:53], v[172:173], v[236:237], v[52:53]
    v_pk_fma_f32 v[42:43], v[154:155], v[154:155], v[42:43]
    v_pk_fma_f32 v[44:45], v[154:155], v[218:219], v[44:45]
    v_pk_fma_f32 v[50:51], v[170:171], v[170:171], v[50:51]
    v_pk_fma_f32 v[52:53], v[170:171], v[234:235], v[52:53]
    v_pk_fma_f32 v[42:43], v[152:153], v[152:153], v[42:43]
    v_pk_fma_f32 v[44:45], v[152:153], v[216:217], v[44:45]
    v_pk_fma_f32 v[50:51], v[168:169], v[168:169], v[50:51]
    v_pk_fma_f32 v[52:53], v[168:169], v[232:233], v[52:53]
    v_add_f32 v24, v40, v41
    v_add_f32 v25, v42, v43
    v_add_f32 v26, v44, v45
    v_add_f32 v28, v48, v49
    v_add_f32 v29, v50, v51
    v_add_f32 v30, v52, v53
    s_cmp_eq_u32 s79, 0
    s_cbranch_scc1 f_go
f_ngo:
    v_permlane32_swap_b32 v24, v28
    v_permlane32_swap_b32 v25, v29
    v_permlane32_swap_b32 v26, v30
    v_add_f32 v24, v24, v28
    v_add_f32 v25, v25, v29
    v_add_f32 v26, v26, v30
    v_add_f32_dpp v24, v24, v24 row_ror:8 row_mask:0xf bank_mask:0xf
    v_add_f32_dpp v25, v25, v25 row_ror:8 row_mask:0xf bank_mask:0xf
    v_add_f32_dpp v26, v26, v26 row_ror:8 row_mask:0xf bank_mask:0xf
    v_add_f32_dpp v24, v24, v24 row_ror:4 row_mask:0xf bank_mask:0xf
    v_add_f32_dpp v25, v25, v25 row_ror:4 row_mask:0xf bank_mask:0xf
    v_add_f32_dpp v26, v26, v26 row_ror:4 row_mask:0xf bank_mask:0xf
    v_add_f32_dpp v24, v24, v24 row_ror:2 row_mask:0xf bank_mask:0xf
    v_add_f32_dpp v25, v25, v25 row_ror:2 row_mask:0xf bank_mask:0xf
    v_add_f32_dpp v26, v26, v26 row_ror:2 row_mask:0xf bank_mask:0xf
    v_add_f32_dpp v24, v24, v24 row_ror:1 row_mask:0xf bank_mask:0xf
    v_add_f32_dpp v25, v25, v25 row_ror:1 row_mask:0xf bank_mask:0xf
    v_add_f32_dpp v26, v26, v26 row_ror:1 row_mask:0xf bank_mask:0xf
    v_add_f32_dpp v24, v24, v24 row_bcast:15 row_mask:0xa bank_mask:0xf
    v_add_f32_dpp v25, v25, v25 row_bcast:15 row_mask:0xa bank_mask:0xf
    v_add_f32_dpp v26, v26, v26 row_bcast:15 row_mask:0xa bank_mask:0xf
    v_mul_f32 v24, 0x3a800000, v24
    v_mul_f32 v25, 0x3a800000, v25
    v_mul_f32 v28, v24, v24
    v_fma_f32 v26, -v24, s66, v26
    v_sub_f32 v25, v25, v28
    v_mul_f32 v29, 4.0, v25
    v_cmp_gt_f32 vcc, v28, v29
    v_lshrrev_b32 v30, 4, v0
    s_lshl_b32 s43, s3, 5
    v_and_or_b32 v30, v30, 30, s43
    s_or_b32 s42, vcc_lo, vcc_hi
    s_bitcmp1_b32 s42, 31
    s_cbranch_scc1 f_slow2
f_var2:
    v_cvt_pk_bf16_f32 v25, v25, v25
    v_lshlrev_b32 v25, 16, v25
    v_add_f32 v25, 0x3727c5ac, v25
    v_cvt_pk_bf16_f32 v25, v25, v25
    v_lshlrev_b32 v25, 16, v25
    v_sqrt_f32 v25, v25
    s_nop 0
    v_cvt_pk_bf16_f32 v25, v25, v25
    v_lshlrev_b32 v25, 16, v25
    v_rcp_f32 v25, v25
    s_mov_b32 s42, 0x80000000
    s_movk_i32 s43, 0xf000
    s_mov_b32 exec_lo, s42
    s_mov_b32 exec_hi, s42
    v_mul_f32 v26, v26, v25
    v_ashrrev_i32 v28, 31, v26
    v_or_b32 v28, s42, v28
    v_xor_b32 v26, v26, v28
    v_and_or_b32 v26, v26, s43, v30
    ds_write_b32 v17, v26
    v_mul_f32 v24, -v24, v25
    s_mov_b64 exec, -1
    v_readlane_b32 s60, v26, 31
    v_readlane_b32 s56, v24, 31
    v_readlane_b32 s57, v25, 31
    v_readlane_b32 s61, v26, 63
    v_readlane_b32 s58, v24, 63
    v_readlane_b32 s59, v25, 63
    s_waitcnt lgkmcnt(0)
    s_barrier
    ds_read_b32 v32, v7
    s_cmp_eq_u32 s16, 0
    s_waitcnt lgkmcnt(0)
    s_cbranch_scc1 f_key
f_nkey:
    v_cmp_lt_u32 vcc, s60, v32
    v_cmp_lt_u32 s[44:45], s61, v32
    s_and_b32 s62, vcc_lo, 0xffff
    s_and_b32 s63, s44, 0xffff
    s_bcnt1_i32_b32 s62, s62
    s_bcnt1_i32_b32 s63, s63
    s_cmp_lt_u32 s62, 2
    s_cbranch_scc1 f_cand0
f_nc0:
    s_cmp_lt_u32 s63, 2
    s_cbranch_scc1 f_cand1
f_nc1:
    s_lshr_b32 s42, s16, 2
    s_lshl_b32 s43, s42, 13
    s_lshl_b32 s42, s42, 12
    s_add_u32 s64, s76, s42
    s_add_u32 s64, s64, 20480
    v_add_u32 v4, s43, v4
    v_add_u32 v5, s43, v5
    v_add_u32 v6, s43, v6
    buffer_load_dwordx4 v[248:251], v3, s[12:15], s64 offen sc1
    s_barrier
    s_cmp_ge_u32 s35, 14
    s_cbranch_scc1 f_nd2
    s_add_u32 s43, s39, 4096
    s_mov_b32 m0, s43
    s_add_u32 s42, s38, 16384
    v_xor_b32 v7, 128, v3
    buffer_load_dwordx4 v7, s[48:51], s42 offen nt lds
    s_add_u32 s43, s39, 5120
    s_mov_b32 m0, s43
    s_add_u32 s42, s38, 18432
    v_xor_b32 v7, 160, v3
    buffer_load_dwordx4 v7, s[48:51], s42 offen nt lds
    s_add_u32 s43, s39, 6144
    s_mov_b32 m0, s43
    s_add_u32 s42, s38, 20480
    v_xor_b32 v7, 192, v3
    buffer_load_dwordx4 v7, s[48:51], s42 offen nt lds
    s_add_u32 s43, s39, 7168
    s_mov_b32 m0, s43
    s_add_u32 s42, s38, 22528
    v_xor_b32 v7, 224, v3
    buffer_load_dwordx4 v7, s[48:51], s42 offen nt lds
f_nd2:
    v_pk_fma_f32 v[56:57], v[152:153], s[56:57], s[56:57] op_sel:[0,1,0] op_sel_hi:[1,1,0]
    v_pk_fma_f32 v[58:59], v[154:155], s[56:57], s[56:57] op_sel:[0,1,0] op_sel_hi:[1,1,0]
    v_pk_fma_f32 v[60:61], v[156:157], s[56:57], s[56:57] op_sel:[0,1,0] op_sel_hi:[1,1,0]
    v_pk_fma_f32 v[62:63], v[158:159], s[56:57], s[56:57] op_sel:[0,1,0] op_sel_hi:[1,1,0]
    v_pk_fma_f32 v[64:65], v[160:161], s[56:57], s[56:57] op_sel:[0,1,0] op_sel_hi:[1,1,0]
    v_pk_fma_f32 v[66:67], v[162:163], s[56:57], s[56:57] op_sel:[0,1,0] op_sel_hi:[1,1,0]
    v_pk_fma_f32 v[68:69], v[164:165], s[56:57], s[56:57] op_sel:[0,1,0] op_sel_hi:[1,1,0]
    v_pk_fma_f32 v[70:71], v[166:167], s[56:57], s[56:57] op_sel:[0,1,0] op_sel_hi:[1,1,0]
    v_pk_fma_f32 v[72:73], v[168:169], s[58:59], s[58:59] op_sel:[0,1,0] op_sel_hi:[1,1,0]
    v_pk_fma_f32 v[74:75], v[170:171], s[58:59], s[58:59] op_sel:[0,1,0] op_sel_hi:[1,1,0]
    v_pk_fma_f32 v[76:77], v[172:173], s[58:59], s[58:59] op_sel:[0,1,0] op_sel_hi:[1,1,0]
    v_pk_fma_f32 v[78:79], v[174:175], s[58:59], s[58:59] op_sel:[0,1,0] op_sel_hi:[1,1,0]
    v_pk_fma_f32 v[80:81], v[176:177], s[58:59], s[58:59] op_sel:[0,1,0] op_sel_hi:[1,1,0]
    v_pk_fma_f32 v[82:83], v[178:179], s[58:59], s[58:59] op_sel:[0,1,0] op_sel_hi:[1,1,0]
    v_pk_fma_f32 v[84:85], v[180:181], s[58:59], s[58:59] op_sel:[0,1,0] op_sel_hi:[1,1,0]
    v_pk_fma_f32 v[86:87], v[182:183], s[58:59], s[58:59] op_sel:[0,1,0] op_sel_hi:[1,1,0]
    s_mov_b32 s83, 0
    s_cmp_ge_u32 s35, 14
    s_cbranch_scc1 f_p2c
    s_waitcnt vmcnt(4)
f_p2e:
    v_xor_b32 v248, v8, v248
    v_xor_b32 v249, v9, v249
    v_xor_b32 v250, v10, v250
    v_xor_b32 v251, v11, v251
    v_or3_b32 v12, v248, v249, 0
    v_or3_b32 v12, v250, v251, v12
    v_and_b32 v12, 0xff, v12
    v_cmp_ne_u32 vcc, 0, v12
    s_cbranch_vccnz f_p2r
f_p2w:
    ds_write_b128 v4, v[248:251] offset:45056
    ds_write_b32 v5, v248 offset:49152
    ds_write_b32 v6, v249 offset:49164
    ds_write_b32 v6, v250 offset:49160
    ds_write_b32 v6, v251 offset:49156
    s_waitcnt lgkmcnt(0)
    s_barrier
    ds_read_b128 v[136:139], v3 offset:45056
    ds_read_b128 v[140:143], v3 offset:46080
    ds_read_b128 v[144:147], v3 offset:47104
    ds_read_b128 v[148:151], v3 offset:48128
    ds_read_b128 v[184:187], v3 offset:53248
    ds_read_b128 v[188:191], v3 offset:54272
    ds_read_b128 v[192:195], v3 offset:55296
    ds_read_b128 v[196:199], v3 offset:56320
    ds_read_b128 v[104:107], v3 offset:49152
    ds_read_b128 v[108:111], v3 offset:50176
    ds_read_b128 v[112:115], v3 offset:51200
    ds_read_b128 v[116:119], v3 offset:52224
    ds_read_b128 v[200:203], v3 offset:57344
    ds_read_b128 v[204:207], v3 offset:58368
    ds_read_b128 v[208:211], v3 offset:59392
    ds_read_b128 v[212:215], v3 offset:60416
    s_waitcnt lgkmcnt(12)
    v_pk_fma_f32 v[56:57], v[56:57], v[88:89], v[136:137]
    v_pk_fma_f32 v[58:59], v[58:59], v[90:91], v[138:139]
    v_pk_fma_f32 v[60:61], v[60:61], v[92:93], v[140:141]
    v_pk_fma_f32 v[62:63], v[62:63], v[94:95], v[142:143]
    v_pk_fma_f32 v[64:65], v[64:65], v[96:97], v[144:145]
    v_pk_fma_f32 v[66:67], v[66:67], v[98:99], v[146:147]
    v_pk_fma_f32 v[68:69], v[68:69], v[100:101], v[148:149]
    v_pk_fma_f32 v[70:71], v[70:71], v[102:103], v[150:151]
    s_waitcnt lgkmcnt(8)
    v_pk_fma_f32 v[152:153], v[184:185], v[56:57], v[152:153]
    v_pk_fma_f32 v[154:155], v[186:187], v[58:59], v[154:155]
    v_pk_fma_f32 v[156:157], v[188:189], v[60:61], v[156:157]
    v_pk_fma_f32 v[158:159], v[190:191], v[62:63], v[158:159]
    v_pk_fma_f32 v[160:161], v[192:193], v[64:65], v[160:161]
    v_pk_fma_f32 v[162:163], v[194:195], v[66:67], v[162:163]
    v_pk_fma_f32 v[164:165], v[196:197], v[68:69], v[164:165]
    v_pk_fma_f32 v[166:167], v[198:199], v[70:71], v[166:167]
    v_cvt_pk_bf16_f32 v216, v152, v153
    v_cvt_pk_bf16_f32 v217, v154, v155
    v_cvt_pk_bf16_f32 v218, v156, v157
    v_cvt_pk_bf16_f32 v219, v158, v159
    v_cvt_pk_bf16_f32 v220, v160, v161
    v_cvt_pk_bf16_f32 v221, v162, v163
    v_cvt_pk_bf16_f32 v222, v164, v165
    v_cvt_pk_bf16_f32 v223, v166, v167
    s_waitcnt lgkmcnt(4)
    v_pk_fma_f32 v[72:73], v[72:73], v[120:121], v[104:105]
    v_pk_fma_f32 v[74:75], v[74:75], v[122:123], v[106:107]
    v_pk_fma_f32 v[76:77], v[76:77], v[124:125], v[108:109]
    v_pk_fma_f32 v[78:79], v[78:79], v[126:127], v[110:111]
    v_pk_fma_f32 v[80:81], v[80:81], v[128:129], v[112:113]
    v_pk_fma_f32 v[82:83], v[82:83], v[130:131], v[114:115]
    v_pk_fma_f32 v[84:85], v[84:85], v[132:133], v[116:117]
    v_pk_fma_f32 v[86:87], v[86:87], v[134:135], v[118:119]
    s_waitcnt lgkmcnt(0)
    v_pk_fma_f32 v[168:169], v[200:201], v[72:73], v[168:169]
    v_pk_fma_f32 v[170:171], v[202:203], v[74:75], v[170:171]
    v_pk_fma_f32 v[172:173], v[204:205], v[76:77], v[172:173]
    v_pk_fma_f32 v[174:175], v[206:207], v[78:79], v[174:175]
    v_pk_fma_f32 v[176:177], v[208:209], v[80:81], v[176:177]
    v_pk_fma_f32 v[178:179], v[210:211], v[82:83], v[178:179]
    v_pk_fma_f32 v[180:181], v[212:213], v[84:85], v[180:181]
    v_pk_fma_f32 v[182:183], v[214:215], v[86:87], v[182:183]
    v_cvt_pk_bf16_f32 v224, v168, v183
    v_cvt_pk_bf16_f32 v225, v182, v181
    v_cvt_pk_bf16_f32 v226, v180, v179
    v_cvt_pk_bf16_f32 v227, v178, v177
    v_cvt_pk_bf16_f32 v228, v176, v175
    v_cvt_pk_bf16_f32 v229, v174, v173
    v_cvt_pk_bf16_f32 v230, v172, v171
    v_cvt_pk_bf16_f32 v231, v170, v169
    v_subrev_u32 v13, 65536, v13
    v_subrev_u32 v14, 65536, v14
    s_sub_u32 s68, s68, 65536
    v_add_u32 v7, s68, v3
    ds_write_b128 v13, v[216:219] offset:0
    ds_write_b128 v13, v[220:223] offset:16
    ds_write_b128 v14, v[224:227] offset:2048
    ds_write_b128 v14, v[228:231] offset:2064
    s_waitcnt lgkmcnt(0)
    ds_read_b128 v[232:235], v7 offset:0
    ds_read_b128 v[236:239], v7 offset:1024
    ds_read_b128 v[240:243], v7 offset:2048
    ds_read_b128 v[244:247], v7 offset:3072
    v_lshrrev_b32 v144, 2, v2
    v_and_b32 v145, 7, v144
    v_and_b32 v146, 3, v0
    v_lshl_add_u32 v148, v1, 2, v146
    v_xor_b32 v148, v148, v145
    v_lshlrev_b32 v148, 5, v148
    v_lshl_add_u32 v148, v144, 10, v148
    v_add_u32 v148, 94208, v148
    v_cmp_eq_u32 s[44:45], 1, v146
    v_cmp_eq_u32 s[46:47], 2, v146
    v_cmp_eq_u32 s[72:73], 3, v146
    v_bfe_u32 v145, v0, 4, 2
    v_and_b32 v144, 1, v144
    v_lshlrev_b32 v153, 7, v144
    v_lshl_add_u32 v153, v145, 4, v153
    v_add_u32 v153, 159872, v153
    v_lshlrev_b32 v154, 4, v146
    v_lshl_add_u32 v154, v144, 18, v154
    v_lshl_add_u32 v154, v1, 14, v154
    v_lshl_add_u32 v154, v145, 12, v154
    v_and_b32 v144, 15, v0
    v_lshlrev_b32 v152, 1, v144
    v_lshl_add_u32 v152, v1, 5, v152
    v_lshl_add_u32 v152, v145, 7, v152
    v_add_u32 v152, 159872, v152
    s_and_b32 s76, s35, 1
    s_lshl_b32 s76, s76, 17
    s_lshl_b32 s77, s17, 6
    s_add_u32 s76, s76, s77
    s_add_u32 s76, s76, 17825792
    s_lshl_b32 s81, s17, 2
    s_and_b32 s42, s16, 3
    s_add_u32 s81, s81, s42
    s_lshl_b32 s81, s81, 10
    s_add_u32 s82, s81, 18612224
    s_add_u32 s81, s81, 18350080
    v_mov_b32 v5, 159848
    s_waitcnt vmcnt(0)
    s_barrier
    ds_read_b64_tr_b16 v[88:89], v148 offset:0
    ds_read_b64_tr_b16 v[90:91], v148 offset:16384
    ds_read_b64_tr_b16 v[92:93], v148 offset:8
    ds_read_b64_tr_b16 v[94:95], v148 offset:16392
    ds_read_b64_tr_b16 v[96:97], v148 offset:16
    ds_read_b64_tr_b16 v[98:99], v148 offset:16400
    ds_read_b64_tr_b16 v[100:101], v148 offset:24
    ds_read_b64_tr_b16 v[102:103], v148 offset:16408
    ds_read_b64_tr_b16 v[104:105], v148 offset:32768
    ds_read_b64_tr_b16 v[106:107], v148 offset:49152
    ds_read_b64_tr_b16 v[108:109], v148 offset:32776
    ds_read_b64_tr_b16 v[110:111], v148 offset:49160
    ds_read_b64_tr_b16 v[112:113], v148 offset:32784
    ds_read_b64_tr_b16 v[114:115], v148 offset:49168
    ds_read_b64_tr_b16 v[116:117], v148 offset:32792
    ds_read_b64_tr_b16 v[118:119], v148 offset:49176
    s_cmp_eq_u32 s16, 7
    s_cbranch_scc1 f_sel
    s_cmp_ge_u32 s35, 14
    s_cbranch_scc1 f_na
    s_cmp_ge_u32 s16, 4
    s_cbranch_scc1 f_na
    s_mov_b32 s83, 0
f_px:
    s_and_b32 s42, s83, 31
    s_cmp_eq_u32 s42, 31
    s_cselect_b32 s42, s82, s81
    buffer_load_dwordx4 v[144:147], v3, s[12:15], s42 offen sc1
    s_waitcnt vmcnt(0)
    v_max3_u32 v4, v144, v145, v146
    v_max_u32 v4, v4, v147
    v_cmp_eq_u32 vcc, -1, v4
    s_cbranch_vccz f_pxx
    s_add_u32 s83, s83, 1
    s_cmp_lt_u32 s83, 0x40000
    s_cbranch_scc1 f_px
f_pxx:
    v_permlane32_swap_b32 v144, v146
    v_permlane32_swap_b32 v145, v147
    v_pk_add_f32 v[144:145], v[144:145], v[146:147]
    s_nop 1
    v_permlane16_swap_b32 v144, v145
    v_add_f32 v144, v144, v145
    v_cvt_pk_bf16_f32 v144, v144, v144
    v_lshlrev_b32 v144, 16, v144
    v_mul_f32 v145, 0xbfb8aa3b, v144
    v_exp_f32 v145, v145
    v_mov_b32 v146, v144
    v_add_f32 v145, 1.0, v145
    v_rcp_f32 v145, v145
    v_mov_b32 v147, v144
    v_mul_f32 v145, v144, v145
    s_nop 0
    v_permlane32_swap_b32 v146, v147
    v_cvt_pk_bf16_f32 v145, v145, v145
    v_lshlrev_b32 v145, 16, v145
    v_mul_f32 v145, v145, v147
    v_cvt_pk_bf16_f32 v145, v145, v145
    ds_write_b16 v152, v145
f_na:
    s_waitcnt lgkmcnt(0)
    s_barrier
    s_cmp_ge_u32 s35, 14
    s_cbranch_scc1 f_fin
    ds_read_b128 v[120:123], v153 offset:0
    ds_read_b128 v[124:127], v153 offset:64
    s_waitcnt lgkmcnt(1)
    v_mfma_f32_16x16x32_bf16 v[128:131], v[88:91], v[120:123], 0
    v_mfma_f32_16x16x32_bf16 v[132:135], v[92:95], v[120:123], 0
    v_mfma_f32_16x16x32_bf16 v[136:139], v[96:99], v[120:123], 0
    v_mfma_f32_16x16x32_bf16 v[140:143], v[100:103], v[120:123], 0
    s_waitcnt lgkmcnt(0)
    v_mfma_f32_16x16x32_bf16 v[128:131], v[104:107], v[124:127], v[128:131]
    v_mfma_f32_16x16x32_bf16 v[132:135], v[108:111], v[124:127], v[132:135]
    v_mfma_f32_16x16x32_bf16 v[136:139], v[112:115], v[124:127], v[136:139]
    v_mfma_f32_16x16x32_bf16 v[140:143], v[116:119], v[124:127], v[140:143]
    s_nop 5
    v_cndmask_b32 v128, v128, v132, s[44:45]
    v_cndmask_b32 v129, v129, v133, s[44:45]
    v_cndmask_b32 v130, v130, v134, s[44:45]
    v_cndmask_b32 v131, v131, v135, s[44:45]
    v_cndmask_b32 v128, v128, v136, s[46:47]
    v_cndmask_b32 v129, v129, v137, s[46:47]
    v_cndmask_b32 v130, v130, v138, s[46:47]
    v_cndmask_b32 v131, v131, v139, s[46:47]
    v_cndmask_b32 v128, v128, v140, s[72:73]
    v_cndmask_b32 v129, v129, v141, s[72:73]
    v_cndmask_b32 v130, v130, v142, s[72:73]
    v_cndmask_b32 v131, v131, v143, s[72:73]
    v_min_u32 v128, -2, v128
    v_min_u32 v129, -2, v129
    v_min_u32 v130, -2, v130
    v_min_u32 v131, -2, v131
    s_mov_b32 exec_lo, 0x00ff00ff
    s_mov_b32 exec_hi, 0x00ff00ff
    buffer_store_dwordx4 v[128:131], v154, s[12:15], s76 offen sc1
    s_mov_b64 exec, -1
    s_barrier
f_fin:
    ds_read_b64 v[28:29], v5
    s_waitcnt lgkmcnt(0)
    v_readfirstlane_b32 s40, v28
    v_readfirstlane_b32 s41, v29
    s_cmp_eq_u32 s60, s40
    s_cbranch_scc1 f_e0
    s_cmp_eq_u32 s60, s41
    s_cbranch_scc1 f_e0
    buffer_store_dwordx4 v[232:235], v3, s[24:27], s18 offen offset:0 sc1
    buffer_store_dwordx4 v[236:239], v3, s[24:27], s18 offen offset:1024 sc1
f_e0:
    s_cmp_eq_u32 s61, s40
    s_cbranch_scc1 f_e1
    s_cmp_eq_u32 s61, s41
    s_cbranch_scc1 f_e1
    buffer_store_dwordx4 v[240:243], v3, s[24:27], s19 offen offset:0 sc1
    buffer_store_dwordx4 v[244:247], v3, s[24:27], s19 offen offset:1024 sc1
f_e1:
    s_endpgm
f_sel:
    v_lshlrev_b32 v40, 7, v2
    s_add_u32 s42, s74, 8192
    s_mov_b32 s83, 0
    s_mov_b64 vcc, -1
    s_mov_b64 s[40:41], -1
f_kq:
    s_mov_b64 exec, vcc
    s_cbranch_execz f_kqa
    buffer_load_dwordx4 v[32:35], v40, s[12:15], s74 offen sc1
f_kqa:
    s_mov_b64 exec, s[40:41]
    s_cbranch_execz f_kqb
    buffer_load_dwordx4 v[36:39], v40, s[12:15], s42 offen sc1
f_kqb:
    s_mov_b64 exec, -1
    s_waitcnt vmcnt(0)
    v_cmp_ne_u64 vcc, s[32:33], v[34:35]
    v_cmp_ne_u64 s[40:41], s[32:33], v[38:39]
    v_max_u32 v41, v32, v36
    v_min_u32 v42, v32, v36
    s_or_b64 s[20:21], vcc, s[40:41]
    s_cbranch_scc0 f_kqx
    s_sleep 4
    s_add_u32 s83, s83, 1
    s_cmp_lt_u32 s83, 0x40000
    s_cbranch_scc1 f_kq
f_kqx:
    v_mov_b32 v43, v41
    v_max3_u32 v42, v42, v33, v37
    s_nop 0
    v_max_u32_dpp v43, v43, v43 row_ror:8 row_mask:0xf bank_mask:0xf
    s_nop 1
    v_max_u32_dpp v43, v43, v43 row_ror:4 row_mask:0xf bank_mask:0xf
    s_nop 1
    v_max_u32_dpp v43, v43, v43 row_ror:2 row_mask:0xf bank_mask:0xf
    s_nop 1
    v_max_u32_dpp v43, v43, v43 row_ror:1 row_mask:0xf bank_mask:0xf
    s_nop 1
    v_max_u32_dpp v43, v43, v43 row_bcast:15 row_mask:0xa bank_mask:0xf
    s_nop 1
    v_max_u32_dpp v43, v43, v43 row_bcast:31 row_mask:0xc bank_mask:0xf
    s_nop 0
    v_readlane_b32 s40, v43, 63
    s_nop 1
    v_cmp_eq_u32 vcc, s40, v41
    s_nop 1
    v_cndmask_b32 v43, v41, v42, vcc
    s_nop 1
    v_max_u32_dpp v43, v43, v43 row_ror:8 row_mask:0xf bank_mask:0xf
    s_nop 1
    v_max_u32_dpp v43, v43, v43 row_ror:4 row_mask:0xf bank_mask:0xf
    s_nop 1
    v_max_u32_dpp v43, v43, v43 row_ror:2 row_mask:0xf bank_mask:0xf
    s_nop 1
    v_max_u32_dpp v43, v43, v43 row_ror:1 row_mask:0xf bank_mask:0xf
    s_nop 1
    v_max_u32_dpp v43, v43, v43 row_bcast:15 row_mask:0xa bank_mask:0xf
    s_nop 1
    v_max_u32_dpp v43, v43, v43 row_bcast:31 row_mask:0xc bank_mask:0xf
    s_nop 0
    v_readlane_b32 s41, v43, 63
    s_andn2_b32 s40, s40, 1
    s_andn2_b32 s41, s41, 1
    v_mov_b32 v28, s40
    v_mov_b32 v29, s41
    ds_write_b64 v5, v[28:29]
    s_branch f_na
f_p2r:
    s_add_u32 s83, s83, 1
    s_cmp_ge_u32 s83, 0x40000
    s_cbranch_scc1 f_p2w
    s_sleep 12
    buffer_load_dwordx4 v[248:251], v3, s[12:15], s64 offen sc1
f_p2c:
    s_waitcnt vmcnt(0)
    s_branch f_p2e
f_key:
    s_setprio 3
    v_mov_b32 v36, v32
    v_mov_b32 v38, s32
    s_nop 0
    v_max_u32_dpp v36, v36, v36 row_ror:8 row_mask:0xf bank_mask:0xf
    s_nop 1
    v_max_u32_dpp v36, v36, v36 row_ror:4 row_mask:0xf bank_mask:0xf
    s_nop 1
    v_max_u32_dpp v36, v36, v36 row_ror:2 row_mask:0xf bank_mask:0xf
    s_nop 1
    v_max_u32_dpp v36, v36, v36 row_ror:1 row_mask:0xf bank_mask:0xf
    v_cmp_eq_u32 vcc, v36, v32
    v_mov_b32 v39, s33
    s_nop 0
    v_cndmask_b32_e64 v37, v32, 0, vcc
    s_nop 1
    v_max_u32_dpp v37, v37, v37 row_ror:8 row_mask:0xf bank_mask:0xf
    s_nop 1
    v_max_u32_dpp v37, v37, v37 row_ror:4 row_mask:0xf bank_mask:0xf
    s_nop 1
    v_max_u32_dpp v37, v37, v37 row_ror:2 row_mask:0xf bank_mask:0xf
    s_nop 1
    v_max_u32_dpp v37, v37, v37 row_ror:1 row_mask:0xf bank_mask:0xf
    v_or_b32 v37, 1, v37
    buffer_store_dwordx4 v[36:39], v18, s[12:15], s80 offen sc1
    s_setprio 0
    s_branch f_nkey
f_cand0:
    s_setprio 2
    s_lshl_b32 s43, s3, 1
    s_add_u32 s42, s62, s43
    s_lshl_b32 s42, s42, 12
    s_add_u32 s42, s42, 18874368
    v_pk_fma_f32 v[56:57], v[152:153], s[56:57], s[56:57] op_sel:[0,1,0] op_sel_hi:[1,1,0]
    v_pk_fma_f32 v[58:59], v[154:155], s[56:57], s[56:57] op_sel:[0,1,0] op_sel_hi:[1,1,0]
    v_pk_fma_f32 v[60:61], v[156:157], s[56:57], s[56:57] op_sel:[0,1,0] op_sel_hi:[1,1,0]
    v_pk_fma_f32 v[62:63], v[158:159], s[56:57], s[56:57] op_sel:[0,1,0] op_sel_hi:[1,1,0]
    v_pk_fma_f32 v[64:65], v[160:161], s[56:57], s[56:57] op_sel:[0,1,0] op_sel_hi:[1,1,0]
    v_pk_fma_f32 v[66:67], v[162:163], s[56:57], s[56:57] op_sel:[0,1,0] op_sel_hi:[1,1,0]
    v_pk_fma_f32 v[68:69], v[164:165], s[56:57], s[56:57] op_sel:[0,1,0] op_sel_hi:[1,1,0]
    v_pk_fma_f32 v[70:71], v[166:167], s[56:57], s[56:57] op_sel:[0,1,0] op_sel_hi:[1,1,0]
    v_pk_mul_f32 v[56:57], v[56:57], v[88:89]
    v_pk_mul_f32 v[58:59], v[58:59], v[90:91]
    v_pk_mul_f32 v[60:61], v[60:61], v[92:93]
    v_pk_mul_f32 v[62:63], v[62:63], v[94:95]
    v_pk_mul_f32 v[64:65], v[64:65], v[96:97]
    v_pk_mul_f32 v[66:67], v[66:67], v[98:99]
    v_pk_mul_f32 v[68:69], v[68:69], v[100:101]
    v_pk_mul_f32 v[70:71], v[70:71], v[102:103]
    v_cvt_pk_bf16_f32 v216, v56, v57
    v_cvt_pk_bf16_f32 v217, v58, v59
    v_cvt_pk_bf16_f32 v218, v60, v61
    v_cvt_pk_bf16_f32 v219, v62, v63
    v_cvt_pk_bf16_f32 v220, v64, v65
    v_cvt_pk_bf16_f32 v221, v66, v67
    v_cvt_pk_bf16_f32 v222, v68, v69
    v_cvt_pk_bf16_f32 v223, v70, v71
    v_min_u32 v216, -2, v216
    v_min_u32 v217, -2, v217
    v_min_u32 v218, -2, v218
    v_min_u32 v219, -2, v219
    buffer_store_dwordx4 v[216:219], v15, s[12:15], s42 offen offset:0 sc1
    v_min_u32 v220, -2, v220
    v_min_u32 v221, -2, v221
    v_min_u32 v222, -2, v222
    v_min_u32 v223, -2, v223
    buffer_store_dwordx4 v[220:223], v15, s[12:15], s42 offen offset:512 sc1
    v_cvt_pk_bf16_f32 v40, v152, v153
    v_cvt_pk_bf16_f32 v41, v154, v155
    v_cvt_pk_bf16_f32 v42, v156, v157
    v_cvt_pk_bf16_f32 v43, v158, v159
    v_cvt_pk_bf16_f32 v44, v160, v161
    v_cvt_pk_bf16_f32 v45, v162, v163
    v_cvt_pk_bf16_f32 v46, v164, v165
    v_cvt_pk_bf16_f32 v47, v166, v167
    v_min_u32 v40, -2, v40
    v_min_u32 v41, -2, v41
    v_min_u32 v42, -2, v42
    v_min_u32 v43, -2, v43
    v_min_u32 v44, -2, v44
    v_min_u32 v45, -2, v45
    v_min_u32 v46, -2, v46
    v_min_u32 v47, -2, v47
    buffer_store_dwordx4 v[40:43], v15, s[12:15], s42 offen offset:2048 sc1
    buffer_store_dwordx4 v[44:47], v15, s[12:15], s42 offen offset:2560 sc1
    s_setprio 0
    s_branch f_nc0
f_cand1:
    s_setprio 2
    s_lshl_b32 s43, s3, 1
    s_add_u32 s42, s63, s43
    s_lshl_b32 s42, s42, 12
    s_add_u32 s42, s42, 18874368
    v_pk_fma_f32 v[72:73], v[168:169], s[58:59], s[58:59] op_sel:[0,1,0] op_sel_hi:[1,1,0]
    v_pk_fma_f32 v[74:75], v[170:171], s[58:59], s[58:59] op_sel:[0,1,0] op_sel_hi:[1,1,0]
    v_pk_fma_f32 v[76:77], v[172:173], s[58:59], s[58:59] op_sel:[0,1,0] op_sel_hi:[1,1,0]
    v_pk_fma_f32 v[78:79], v[174:175], s[58:59], s[58:59] op_sel:[0,1,0] op_sel_hi:[1,1,0]
    v_pk_fma_f32 v[80:81], v[176:177], s[58:59], s[58:59] op_sel:[0,1,0] op_sel_hi:[1,1,0]
    v_pk_fma_f32 v[82:83], v[178:179], s[58:59], s[58:59] op_sel:[0,1,0] op_sel_hi:[1,1,0]
    v_pk_fma_f32 v[84:85], v[180:181], s[58:59], s[58:59] op_sel:[0,1,0] op_sel_hi:[1,1,0]
    v_pk_fma_f32 v[86:87], v[182:183], s[58:59], s[58:59] op_sel:[0,1,0] op_sel_hi:[1,1,0]
    v_pk_mul_f32 v[72:73], v[72:73], v[120:121]
    v_pk_mul_f32 v[74:75], v[74:75], v[122:123]
    v_pk_mul_f32 v[76:77], v[76:77], v[124:125]
    v_pk_mul_f32 v[78:79], v[78:79], v[126:127]
    v_pk_mul_f32 v[80:81], v[80:81], v[128:129]
    v_pk_mul_f32 v[82:83], v[82:83], v[130:131]
    v_pk_mul_f32 v[84:85], v[84:85], v[132:133]
    v_pk_mul_f32 v[86:87], v[86:87], v[134:135]
    v_cvt_pk_bf16_f32 v224, v72, v87
    v_cvt_pk_bf16_f32 v225, v86, v85
    v_cvt_pk_bf16_f32 v226, v84, v83
    v_cvt_pk_bf16_f32 v227, v82, v81
    v_cvt_pk_bf16_f32 v228, v80, v79
    v_cvt_pk_bf16_f32 v229, v78, v77
    v_cvt_pk_bf16_f32 v230, v76, v75
    v_cvt_pk_bf16_f32 v231, v74, v73
    v_min_u32 v224, -2, v224
    v_min_u32 v225, -2, v225
    v_min_u32 v226, -2, v226
    v_min_u32 v227, -2, v227
    buffer_store_dwordx4 v[224:227], v16, s[12:15], s42 offen offset:0 sc1
    v_min_u32 v228, -2, v228
    v_min_u32 v229, -2, v229
    v_min_u32 v230, -2, v230
    v_min_u32 v231, -2, v231
    buffer_store_dwordx4 v[228:231], v16, s[12:15], s42 offen offset:512 sc1
    v_cvt_pk_bf16_f32 v48, v168, v183
    v_cvt_pk_bf16_f32 v49, v182, v181
    v_cvt_pk_bf16_f32 v50, v180, v179
    v_cvt_pk_bf16_f32 v51, v178, v177
    v_cvt_pk_bf16_f32 v52, v176, v175
    v_cvt_pk_bf16_f32 v53, v174, v173
    v_cvt_pk_bf16_f32 v54, v172, v171
    v_cvt_pk_bf16_f32 v55, v170, v169
    v_min_u32 v48, -2, v48
    v_min_u32 v49, -2, v49
    v_min_u32 v50, -2, v50
    v_min_u32 v51, -2, v51
    v_min_u32 v52, -2, v52
    v_min_u32 v53, -2, v53
    v_min_u32 v54, -2, v54
    v_min_u32 v55, -2, v55
    buffer_store_dwordx4 v[48:51], v16, s[12:15], s42 offen offset:2048 sc1
    buffer_store_dwordx4 v[52:55], v16, s[12:15], s42 offen offset:2560 sc1
    s_setprio 0
    s_branch f_nc1
f_zr:
    v_or3_b32 v248, v40, v42, v44
    v_or_b32 v248, v248, v46
    v_and_b32 v248, s54, v248
    v_cmp_ne_u32 vcc, 0, v248
    s_cbranch_vccz f_zr0
    buffer_load_dwordx4 v[24:27], v3, s[12:15], s72 offen offset:0 sc1
f_zr0:
    v_or3_b32 v248, v41, v43, v45
    v_or_b32 v248, v248, v47
    v_and_b32 v248, s54, v248
    v_cmp_ne_u32 vcc, 0, v248
    s_cbranch_vccz f_zr1
    buffer_load_dwordx4 v[28:31], v3, s[12:15], s72 offen offset:1024 sc1
f_zr1:
    v_or3_b32 v248, v48, v50, v52
    v_or_b32 v248, v248, v54
    v_and_b32 v248, s54, v248
    v_cmp_ne_u32 vcc, 0, v248
    s_cbranch_vccz f_zr2
    buffer_load_dwordx4 v[32:35], v3, s[12:15], s72 offen offset:2048 sc1
f_zr2:
    v_or3_b32 v248, v49, v51, v53
    v_or_b32 v248, v248, v55
    v_and_b32 v248, s54, v248
    v_cmp_ne_u32 vcc, 0, v248
    s_cbranch_vccz f_zr3
    buffer_load_dwordx4 v[36:39], v3, s[12:15], s72 offen offset:3072 sc1
f_zr3:
    s_waitcnt vmcnt(0)
    s_add_u32 s83, s83, 1
    s_cmp_lt_u32 s83, 0x40000
    s_cbranch_scc1 f_zc
    s_branch f_zx
f_r0:
    buffer_load_dwordx4 v3, s[8:11], s18 offen offset:0 lds
    buffer_load_dwordx4 v3, s[8:11], s18 offen offset:1024 lds
    s_branch f_nr
f_str:
    s_and_b32 s42, s83, 31
    s_cmp_lg_u32 s42, 24
    s_cbranch_scc1 f_sb1
    v_add_u32 v116, 160768, v3
    s_mov_b64 exec, 0xff
    ds_read_b128 v[112:115], v116
    s_waitcnt lgkmcnt(0)
    buffer_store_dwordx4 v[112:115], v3, s[12:15], s63 offen sc1
    s_mov_b64 exec, -1
f_sb1:
    s_cmp_eq_u32 s42, 31
    s_cselect_b32 s42, 32768, 0
    s_add_u32 s42, s42, s71
    s_mov_b32 exec_lo, 0x000f000f
    s_mov_b32 exec_hi, 0x000f000f
    buffer_load_dwordx4 v[24:27], v7, s[12:15], s42 offen sc1
    s_add_u32 s83, s83, 1
    s_cmp_lt_u32 s83, 0x40000
    s_cbranch_scc1 f_st
    s_waitcnt vmcnt(0)
    s_mov_b64 exec, -1
    s_branch f_stx
f_pr:
    s_sleep 6
    v_mov_b32 v192, v8
    v_mov_b32 v193, v9
    v_mov_b32 v194, v10
    v_mov_b32 v195, v11
    buffer_load_dwordx4 v[184:187], v3, s[12:15], s64 offen sc1
    buffer_load_dwordx4 v[188:191], v3, s[12:15], s65 offen sc1
    s_mov_b64 exec, 0xffff
    buffer_load_dwordx4 v[236:239], v17, s[12:15], s77 offen sc1
    s_mov_b64 exec, s[52:53]
    buffer_load_dwordx4 v[192:195], v3, s[12:15], s76 offen sc1
    s_mov_b64 exec, -1
    s_waitcnt vmcnt(0)
    s_add_u32 s83, s83, 1
    s_cmp_lt_u32 s83, 0x40000
    s_cbranch_scc1 f_pv
    s_branch f_pw
f_go:
    s_lshl_b32 s41, s34, 7
    s_add_u32 s41, s41, 16842752
    v_mov_b32 v56, s32
    v_mov_b32 v57, s33
    s_mov_b64 exec, 0xff
    buffer_store_dwordx4 v[56:59], v3, s[12:15], s41 offen sc1
    s_mov_b64 exec, -1
    s_branch f_ngo
f_slow2:
    v_cvt_pk_bf16_f32 v40, v152, v153
    v_lshlrev_b32 v152, 16, v40
    v_and_b32 v153, 0xffff0000, v40
    v_cvt_pk_bf16_f32 v40, v154, v155
    v_lshlrev_b32 v154, 16, v40
    v_and_b32 v155, 0xffff0000, v40
    v_cvt_pk_bf16_f32 v40, v156, v157
    v_lshlrev_b32 v156, 16, v40
    v_and_b32 v157, 0xffff0000, v40
    v_cvt_pk_bf16_f32 v40, v158, v159
    v_lshlrev_b32 v158, 16, v40
    v_and_b32 v159, 0xffff0000, v40
    v_cvt_pk_bf16_f32 v40, v160, v161
    v_lshlrev_b32 v160, 16, v40
    v_and_b32 v161, 0xffff0000, v40
    v_cvt_pk_bf16_f32 v40, v162, v163
    v_lshlrev_b32 v162, 16, v40
    v_and_b32 v163, 0xffff0000, v40
    v_cvt_pk_bf16_f32 v40, v164, v165
    v_lshlrev_b32 v164, 16, v40
    v_and_b32 v165, 0xffff0000, v40
    v_cvt_pk_bf16_f32 v40, v166, v167
    v_lshlrev_b32 v166, 16, v40
    v_and_b32 v167, 0xffff0000, v40
    v_pk_add_f32 v[40:41], v[152:153], v[154:155]
    v_pk_add_f32 v[40:41], v[40:41], v[156:157]
    v_pk_add_f32 v[40:41], v[40:41], v[158:159]
    v_pk_add_f32 v[40:41], v[40:41], v[160:161]
    v_pk_add_f32 v[40:41], v[40:41], v[162:163]
    v_pk_add_f32 v[40:41], v[40:41], v[164:165]
    v_pk_add_f32 v[40:41], v[40:41], v[166:167]
    v_cvt_pk_bf16_f32 v48, v168, v169
    v_lshlrev_b32 v168, 16, v48
    v_and_b32 v169, 0xffff0000, v48
    v_cvt_pk_bf16_f32 v48, v170, v171
    v_lshlrev_b32 v170, 16, v48
    v_and_b32 v171, 0xffff0000, v48
    v_cvt_pk_bf16_f32 v48, v172, v173
    v_lshlrev_b32 v172, 16, v48
    v_and_b32 v173, 0xffff0000, v48
    v_cvt_pk_bf16_f32 v48, v174, v175
    v_lshlrev_b32 v174, 16, v48
    v_and_b32 v175, 0xffff0000, v48
    v_cvt_pk_bf16_f32 v48, v176, v177
    v_lshlrev_b32 v176, 16, v48
    v_and_b32 v177, 0xffff0000, v48
    v_cvt_pk_bf16_f32 v48, v178, v179
    v_lshlrev_b32 v178, 16, v48
    v_and_b32 v179, 0xffff0000, v48
    v_cvt_pk_bf16_f32 v48, v180, v181
    v_lshlrev_b32 v180, 16, v48
    v_and_b32 v181, 0xffff0000, v48
    v_cvt_pk_bf16_f32 v48, v182, v183
    v_lshlrev_b32 v182, 16, v48
    v_and_b32 v183, 0xffff0000, v48
    v_pk_add_f32 v[48:49], v[168:169], v[170:171]
    v_pk_add_f32 v[48:49], v[48:49], v[172:173]
    v_pk_add_f32 v[48:49], v[48:49], v[174:175]
    v_pk_add_f32 v[48:49], v[48:49], v[176:177]
    v_pk_add_f32 v[48:49], v[48:49], v[178:179]
    v_pk_add_f32 v[48:49], v[48:49], v[180:181]
    v_pk_add_f32 v[48:49], v[48:49], v[182:183]
    v_add_f32 v24, v40, v41
    v_add_f32 v28, v48, v49
    s_nop 1
    v_permlane32_swap_b32 v24, v28
    v_add_f32 v24, v24, v28
    s_nop 1
    v_add_f32_dpp v24, v24, v24 row_ror:8 row_mask:0xf bank_mask:0xf
    s_nop 1
    v_add_f32_dpp v24, v24, v24 row_ror:4 row_mask:0xf bank_mask:0xf
    s_nop 1
    v_add_f32_dpp v24, v24, v24 row_ror:2 row_mask:0xf bank_mask:0xf
    s_nop 1
    v_add_f32_dpp v24, v24, v24 row_ror:1 row_mask:0xf bank_mask:0xf
    s_nop 1
    v_add_f32_dpp v24, v24, v24 row_bcast:15 row_mask:0xa bank_mask:0xf
    v_mul_f32 v27, 0x3a800000, v24
    v_cvt_pk_bf16_f32 v24, v27, v27
    v_lshlrev_b32 v24, 16, v24
    v_sub_f32 v27, v27, v24
    v_readlane_b32 s56, v24, 31
    v_readlane_b32 s58, v24, 63
    s_nop 0
    v_pk_add_f32 v[56:57], v[152:153], s[56:57] op_sel:[0,0] op_sel_hi:[1,0] neg_lo:[0,1] neg_hi:[0,1]
    v_pk_add_f32 v[58:59], v[154:155], s[56:57] op_sel:[0,0] op_sel_hi:[1,0] neg_lo:[0,1] neg_hi:[0,1]
    v_pk_add_f32 v[60:61], v[156:157], s[56:57] op_sel:[0,0] op_sel_hi:[1,0] neg_lo:[0,1] neg_hi:[0,1]
    v_pk_add_f32 v[62:63], v[158:159], s[56:57] op_sel:[0,0] op_sel_hi:[1,0] neg_lo:[0,1] neg_hi:[0,1]
    v_pk_add_f32 v[64:65], v[160:161], s[56:57] op_sel:[0,0] op_sel_hi:[1,0] neg_lo:[0,1] neg_hi:[0,1]
    v_pk_add_f32 v[66:67], v[162:163], s[56:57] op_sel:[0,0] op_sel_hi:[1,0] neg_lo:[0,1] neg_hi:[0,1]
    v_pk_add_f32 v[68:69], v[164:165], s[56:57] op_sel:[0,0] op_sel_hi:[1,0] neg_lo:[0,1] neg_hi:[0,1]
    v_pk_add_f32 v[70:71], v[166:167], s[56:57] op_sel:[0,0] op_sel_hi:[1,0] neg_lo:[0,1] neg_hi:[0,1]
    v_pk_add_f32 v[72:73], v[168:169], s[58:59] op_sel:[0,0] op_sel_hi:[1,0] neg_lo:[0,1] neg_hi:[0,1]
    v_pk_add_f32 v[74:75], v[170:171], s[58:59] op_sel:[0,0] op_sel_hi:[1,0] neg_lo:[0,1] neg_hi:[0,1]
    v_pk_add_f32 v[76:77], v[172:173], s[58:59] op_sel:[0,0] op_sel_hi:[1,0] neg_lo:[0,1] neg_hi:[0,1]
    v_pk_add_f32 v[78:79], v[174:175], s[58:59] op_sel:[0,0] op_sel_hi:[1,0] neg_lo:[0,1] neg_hi:[0,1]
    v_pk_add_f32 v[80:81], v[176:177], s[58:59] op_sel:[0,0] op_sel_hi:[1,0] neg_lo:[0,1] neg_hi:[0,1]
    v_pk_add_f32 v[82:83], v[178:179], s[58:59] op_sel:[0,0] op_sel_hi:[1,0] neg_lo:[0,1] neg_hi:[0,1]
    v_pk_add_f32 v[84:85], v[180:181], s[58:59] op_sel:[0,0] op_sel_hi:[1,0] neg_lo:[0,1] neg_hi:[0,1]
    v_pk_add_f32 v[86:87], v[182:183], s[58:59] op_sel:[0,0] op_sel_hi:[1,0] neg_lo:[0,1] neg_hi:[0,1]
    v_mov_b32 v31, v30
    v_pk_mul_f32 v[42:43], v[70:71], v[70:71]
    v_pk_mul_f32 v[44:45], v[70:71], v[230:231]
    v_pk_mul_f32 v[50:51], v[86:87], v[86:87]
    v_pk_mul_f32 v[52:53], v[86:87], v[246:247]
    v_pk_fma_f32 v[42:43], v[68:69], v[68:69], v[42:43]
    v_pk_fma_f32 v[44:45], v[68:69], v[228:229], v[44:45]
    v_pk_fma_f32 v[50:51], v[84:85], v[84:85], v[50:51]
    v_pk_fma_f32 v[52:53], v[84:85], v[244:245], v[52:53]
    v_pk_fma_f32 v[42:43], v[66:67], v[66:67], v[42:43]
    v_pk_fma_f32 v[44:45], v[66:67], v[226:227], v[44:45]
    v_pk_fma_f32 v[50:51], v[82:83], v[82:83], v[50:51]
    v_pk_fma_f32 v[52:53], v[82:83], v[242:243], v[52:53]
    v_pk_fma_f32 v[42:43], v[64:65], v[64:65], v[42:43]
    v_pk_fma_f32 v[44:45], v[64:65], v[224:225], v[44:45]
    v_pk_fma_f32 v[50:51], v[80:81], v[80:81], v[50:51]
    v_pk_fma_f32 v[52:53], v[80:81], v[240:241], v[52:53]
    v_pk_fma_f32 v[42:43], v[62:63], v[62:63], v[42:43]
    v_pk_fma_f32 v[44:45], v[62:63], v[222:223], v[44:45]
    v_pk_fma_f32 v[50:51], v[78:79], v[78:79], v[50:51]
    v_pk_fma_f32 v[52:53], v[78:79], v[238:239], v[52:53]
    v_pk_fma_f32 v[42:43], v[60:61], v[60:61], v[42:43]
    v_pk_fma_f32 v[44:45], v[60:61], v[220:221], v[44:45]
    v_pk_fma_f32 v[50:51], v[76:77], v[76:77], v[50:51]
    v_pk_fma_f32 v[52:53], v[76:77], v[236:237], v[52:53]
    v_pk_fma_f32 v[42:43], v[58:59], v[58:59], v[42:43]
    v_pk_fma_f32 v[44:45], v[58:59], v[218:219], v[44:45]
    v_pk_fma_f32 v[50:51], v[74:75], v[74:75], v[50:51]
    v_pk_fma_f32 v[52:53], v[74:75], v[234:235], v[52:53]
    v_pk_fma_f32 v[42:43], v[56:57], v[56:57], v[42:43]
    v_pk_fma_f32 v[44:45], v[56:57], v[216:217], v[44:45]
    v_pk_fma_f32 v[50:51], v[72:73], v[72:73], v[50:51]
    v_pk_fma_f32 v[52:53], v[72:73], v[232:233], v[52:53]
    v_add_f32 v25, v42, v43
    v_add_f32 v26, v44, v45
    v_add_f32 v29, v50, v51
    v_add_f32 v30, v52, v53
    s_nop 0
    v_permlane32_swap_b32 v25, v29
    v_permlane32_swap_b32 v26, v30
    v_add_f32 v25, v25, v29
    v_add_f32 v26, v26, v30
    s_nop 0
    v_add_f32_dpp v25, v25, v25 row_ror:8 row_mask:0xf bank_mask:0xf
    v_add_f32_dpp v26, v26, v26 row_ror:8 row_mask:0xf bank_mask:0xf
    s_nop 0
    v_add_f32_dpp v25, v25, v25 row_ror:4 row_mask:0xf bank_mask:0xf
    v_add_f32_dpp v26, v26, v26 row_ror:4 row_mask:0xf bank_mask:0xf
    s_nop 0
    v_add_f32_dpp v25, v25, v25 row_ror:2 row_mask:0xf bank_mask:0xf
    v_add_f32_dpp v26, v26, v26 row_ror:2 row_mask:0xf bank_mask:0xf
    s_nop 0
    v_add_f32_dpp v25, v25, v25 row_ror:1 row_mask:0xf bank_mask:0xf
    v_add_f32_dpp v26, v26, v26 row_ror:1 row_mask:0xf bank_mask:0xf
    s_nop 0
    v_add_f32_dpp v25, v25, v25 row_bcast:15 row_mask:0xa bank_mask:0xf
    v_add_f32_dpp v26, v26, v26 row_bcast:15 row_mask:0xa bank_mask:0xf
    v_mul_f32 v25, 0x3a800000, v25
    v_fma_f32 v25, -v27, v27, v25
    v_max_f32 v25, 0, v25
    v_mov_b32 v30, v31
    s_branch f_var2
f_slowvar:
    v_lshlrev_b32 v118, 16, v117
    s_nop 0
    v_readlane_b32 s44, v118, 31
    v_readlane_b32 s46, v118, 63
    v_lshlrev_b32 v120, 16, v64
    v_and_b32 v121, 0xffff0000, v64
    v_pk_add_f32 v[120:121], v[120:121], s[44:45] op_sel_hi:[1,0]
    v_pk_mul_f32 v[122:123], v[120:121], v[120:121]
    v_lshlrev_b32 v120, 16, v65
    v_and_b32 v121, 0xffff0000, v65
    v_pk_add_f32 v[120:121], v[120:121], s[44:45] op_sel_hi:[1,0]
    v_pk_fma_f32 v[122:123], v[120:121], v[120:121], v[122:123]
    v_lshlrev_b32 v120, 16, v66
    v_and_b32 v121, 0xffff0000, v66
    v_pk_add_f32 v[120:121], v[120:121], s[44:45] op_sel_hi:[1,0]
    v_pk_fma_f32 v[122:123], v[120:121], v[120:121], v[122:123]
    v_lshlrev_b32 v120, 16, v67
    v_and_b32 v121, 0xffff0000, v67
    v_pk_add_f32 v[120:121], v[120:121], s[44:45] op_sel_hi:[1,0]
    v_pk_fma_f32 v[122:123], v[120:121], v[120:121], v[122:123]
    v_lshlrev_b32 v120, 16, v68
    v_and_b32 v121, 0xffff0000, v68
    v_pk_add_f32 v[120:121], v[120:121], s[44:45] op_sel_hi:[1,0]
    v_pk_fma_f32 v[122:123], v[120:121], v[120:121], v[122:123]
    v_lshlrev_b32 v120, 16, v69
    v_and_b32 v121, 0xffff0000, v69
    v_pk_add_f32 v[120:121], v[120:121], s[44:45] op_sel_hi:[1,0]
    v_pk_fma_f32 v[122:123], v[120:121], v[120:121], v[122:123]
    v_lshlrev_b32 v120, 16, v70
    v_and_b32 v121, 0xffff0000, v70
    v_pk_add_f32 v[120:121], v[120:121], s[44:45] op_sel_hi:[1,0]
    v_pk_fma_f32 v[122:123], v[120:121], v[120:121], v[122:123]
    v_lshlrev_b32 v120, 16, v71
    v_and_b32 v121, 0xffff0000, v71
    v_pk_add_f32 v[120:121], v[120:121], s[44:45] op_sel_hi:[1,0]
    v_pk_fma_f32 v[122:123], v[120:121], v[120:121], v[122:123]
    v_add_f32 v110, v122, v123
    v_lshlrev_b32 v120, 16, v72
    v_and_b32 v121, 0xffff0000, v72
    v_pk_add_f32 v[120:121], v[120:121], s[46:47] op_sel_hi:[1,0]
    v_pk_mul_f32 v[122:123], v[120:121], v[120:121]
    v_lshlrev_b32 v120, 16, v73
    v_and_b32 v121, 0xffff0000, v73
    v_pk_add_f32 v[120:121], v[120:121], s[46:47] op_sel_hi:[1,0]
    v_pk_fma_f32 v[122:123], v[120:121], v[120:121], v[122:123]
    v_lshlrev_b32 v120, 16, v74
    v_and_b32 v121, 0xffff0000, v74
    v_pk_add_f32 v[120:121], v[120:121], s[46:47] op_sel_hi:[1,0]
    v_pk_fma_f32 v[122:123], v[120:121], v[120:121], v[122:123]
    v_lshlrev_b32 v120, 16, v75
    v_and_b32 v121, 0xffff0000, v75
    v_pk_add_f32 v[120:121], v[120:121], s[46:47] op_sel_hi:[1,0]
    v_pk_fma_f32 v[122:123], v[120:121], v[120:121], v[122:123]
    v_lshlrev_b32 v120, 16, v76
    v_and_b32 v121, 0xffff0000, v76
    v_pk_add_f32 v[120:121], v[120:121], s[46:47] op_sel_hi:[1,0]
    v_pk_fma_f32 v[122:123], v[120:121], v[120:121], v[122:123]
    v_lshlrev_b32 v120, 16, v77
    v_and_b32 v121, 0xffff0000, v77
    v_pk_add_f32 v[120:121], v[120:121], s[46:47] op_sel_hi:[1,0]
    v_pk_fma_f32 v[122:123], v[120:121], v[120:121], v[122:123]
    v_lshlrev_b32 v120, 16, v78
    v_and_b32 v121, 0xffff0000, v78
    v_pk_add_f32 v[120:121], v[120:121], s[46:47] op_sel_hi:[1,0]
    v_pk_fma_f32 v[122:123], v[120:121], v[120:121], v[122:123]
    v_lshlrev_b32 v120, 16, v79
    v_and_b32 v121, 0xffff0000, v79
    v_pk_add_f32 v[120:121], v[120:121], s[46:47] op_sel_hi:[1,0]
    v_pk_fma_f32 v[122:123], v[120:121], v[120:121], v[122:123]
    v_add_f32 v111, v122, v123
    v_add_f32 v118, v118, v108
    s_nop 0
    v_permlane32_swap_b32 v110, v111
    v_add_f32 v110, v110, v111
    s_nop 1
    v_add_f32_dpp v110, v110, v110 row_ror:8 row_mask:0xf bank_mask:0xf
    s_nop 1
    v_add_f32_dpp v110, v110, v110 row_ror:4 row_mask:0xf bank_mask:0xf
    s_nop 1
    v_add_f32_dpp v110, v110, v110 row_ror:2 row_mask:0xf bank_mask:0xf
    s_nop 1
    v_add_f32_dpp v110, v110, v110 row_ror:1 row_mask:0xf bank_mask:0xf
    s_nop 1
    v_add_f32_dpp v110, v110, v110 row_bcast:15 row_mask:0xa bank_mask:0xf
    v_mul_f32 v110, s5, v110
    v_fma_f32 v110, -v118, v118, v110
    v_max_f32 v110, 0, v110
    s_branch f_var
f_sp:
    s_setprio 2
    ds_read_b128 v[56:59], v3 offset:18432
    ds_read_b128 v[60:63], v3 offset:19456
    s_waitcnt lgkmcnt(2)
    v_pk_mul_f16 v40, v24, v248 op_sel:[0,0] op_sel_hi:[1,0]
    v_pk_mul_f16 v41, v25, v248 op_sel:[0,1] op_sel_hi:[1,1]
    v_pk_mul_f16 v42, v26, v249 op_sel:[0,0] op_sel_hi:[1,0]
    v_pk_mul_f16 v43, v27, v249 op_sel:[0,1] op_sel_hi:[1,1]
    v_pk_mul_f16 v44, v28, v250 op_sel:[0,0] op_sel_hi:[1,0]
    v_pk_mul_f16 v45, v29, v250 op_sel:[0,1] op_sel_hi:[1,1]
    v_pk_mul_f16 v46, v30, v251 op_sel:[0,0] op_sel_hi:[1,0]
    v_pk_mul_f16 v47, v31, v251 op_sel:[0,1] op_sel_hi:[1,1]
    v_pk_mul_f16 v48, v32, v252 op_sel:[0,0] op_sel_hi:[1,0]
    v_pk_mul_f16 v49, v33, v252 op_sel:[0,1] op_sel_hi:[1,1]
    v_pk_mul_f16 v50, v34, v253 op_sel:[0,0] op_sel_hi:[1,0]
    v_pk_mul_f16 v51, v35, v253 op_sel:[0,1] op_sel_hi:[1,1]
    v_pk_mul_f16 v52, v36, v254 op_sel:[0,0] op_sel_hi:[1,0]
    v_pk_mul_f16 v53, v37, v254 op_sel:[0,1] op_sel_hi:[1,1]
    v_pk_mul_f16 v54, v38, v255 op_sel:[0,0] op_sel_hi:[1,0]
    v_pk_mul_f16 v55, v39, v255 op_sel:[0,1] op_sel_hi:[1,1]
    s_waitcnt lgkmcnt(0)
    v_and_b32 v24, 0xffff, v56
    v_lshrrev_b32 v32, 16, v56
    v_and_b32 v25, 0xffff, v57
    v_lshrrev_b32 v33, 16, v57
    v_and_b32 v26, 0xffff, v58
    v_lshrrev_b32 v34, 16, v58
    v_and_b32 v27, 0xffff, v59
    v_lshrrev_b32 v35, 16, v59
    v_and_b32 v28, 0xffff, v60
    v_lshrrev_b32 v36, 16, v60
    v_and_b32 v29, 0xffff, v61
    v_lshrrev_b32 v37, 16, v61
    v_and_b32 v30, 0xffff, v62
    v_lshrrev_b32 v38, 16, v62
    v_and_b32 v31, 0xffff, v63
    v_lshrrev_b32 v39, 16, v63
    v_pk_add_f16 v40, v40, v24
    v_pk_add_f16 v41, v41, v32
    v_pk_add_f16 v42, v42, v25
    v_pk_add_f16 v43, v43, v33
    v_pk_add_f16 v44, v44, v26
    v_pk_add_f16 v45, v45, v34
    v_pk_add_f16 v46, v46, v27
    v_pk_add_f16 v47, v47, v35
    v_pk_add_f16 v48, v48, v28
    v_pk_add_f16 v49, v49, v36
    v_pk_add_f16 v50, v50, v29
    v_pk_add_f16 v51, v51, v37
    v_pk_add_f16 v52, v52, v30
    v_pk_add_f16 v53, v53, v38
    v_pk_add_f16 v54, v54, v31
    v_pk_add_f16 v55, v55, v39
    v_mfma_f32_32x32x16_f16 v[56:71], v[40:43], v[88:91], 0
    v_mfma_f32_32x32x16_f16 v[72:87], v[40:43], v[104:107], 0
    v_mfma_f32_32x32x16_f16 v[56:71], v[44:47], v[92:95], v[56:71]
    v_mfma_f32_32x32x16_f16 v[72:87], v[44:47], v[108:111], v[72:87]
    s_branch f_st1
f_sp2:
    ds_read_b128 v[216:219], v3 offset:28672
    ds_read_b128 v[220:223], v3 offset:29696
    ds_read_b128 v[224:227], v3 offset:30720
    ds_read_b128 v[228:231], v3 offset:31744
    ds_read_b128 v[232:235], v3 offset:32768
    ds_read_b128 v[236:239], v3 offset:33792
    ds_read_b128 v[240:243], v3 offset:34816
    ds_read_b128 v[244:247], v3 offset:35840
    s_nop 1
    v_pk_mul_f32 v[24:25], v[56:57], v[120:121]
    v_pk_mul_f32 v[28:29], v[72:73], v[120:121]
    v_pk_mul_f32 v[26:27], v[58:59], v[122:123]
    v_pk_mul_f32 v[30:31], v[74:75], v[122:123]
    v_pk_fma_f32 v[24:25], v[72:73], v[136:137], v[24:25]
    v_pk_fma_f32 v[28:29], v[56:57], v[136:137], v[28:29] neg_lo:[1,0,0] neg_hi:[1,0,0]
    v_pk_fma_f32 v[26:27], v[74:75], v[138:139], v[26:27]
    v_pk_fma_f32 v[30:31], v[58:59], v[138:139], v[30:31] neg_lo:[1,0,0] neg_hi:[1,0,0]
    v_cvt_pk_f16_f32 v40, v24, v28
    v_cvt_pk_f16_f32 v41, v25, v29
    v_cvt_pk_f16_f32 v42, v26, v30
    v_cvt_pk_f16_f32 v43, v27, v31
    v_pk_mul_f32 v[32:33], v[60:61], v[124:125]
    v_pk_mul_f32 v[36:37], v[76:77], v[124:125]
    v_pk_mul_f32 v[34:35], v[62:63], v[126:127]
    v_pk_mul_f32 v[38:39], v[78:79], v[126:127]
    v_pk_fma_f32 v[32:33], v[76:77], v[140:141], v[32:33]
    v_pk_fma_f32 v[36:37], v[60:61], v[140:141], v[36:37] neg_lo:[1,0,0] neg_hi:[1,0,0]
    v_pk_fma_f32 v[34:35], v[78:79], v[142:143], v[34:35]
    v_pk_fma_f32 v[38:39], v[62:63], v[142:143], v[38:39] neg_lo:[1,0,0] neg_hi:[1,0,0]
    v_cvt_pk_f16_f32 v44, v32, v36
    v_cvt_pk_f16_f32 v45, v33, v37
    v_cvt_pk_f16_f32 v46, v34, v38
    v_cvt_pk_f16_f32 v47, v35, v39
    v_pk_mul_f32 v[24:25], v[64:65], v[128:129]
    v_pk_mul_f32 v[28:29], v[80:81], v[128:129]
    v_pk_mul_f32 v[26:27], v[66:67], v[130:131]
    v_pk_mul_f32 v[30:31], v[82:83], v[130:131]
    v_pk_fma_f32 v[24:25], v[80:81], v[144:145], v[24:25]
    v_pk_fma_f32 v[28:29], v[64:65], v[144:145], v[28:29] neg_lo:[1,0,0] neg_hi:[1,0,0]
    v_pk_fma_f32 v[26:27], v[82:83], v[146:147], v[26:27]
    v_pk_fma_f32 v[30:31], v[66:67], v[146:147], v[30:31] neg_lo:[1,0,0] neg_hi:[1,0,0]
    v_cvt_pk_f16_f32 v48, v24, v28
    v_cvt_pk_f16_f32 v49, v25, v29
    v_cvt_pk_f16_f32 v50, v26, v30
    v_cvt_pk_f16_f32 v51, v27, v31
    v_pk_mul_f32 v[32:33], v[68:69], v[132:133]
    v_pk_mul_f32 v[36:37], v[84:85], v[132:133]
    v_pk_mul_f32 v[34:35], v[70:71], v[134:135]
    v_pk_mul_f32 v[38:39], v[86:87], v[134:135]
    v_pk_fma_f32 v[32:33], v[84:85], v[148:149], v[32:33]
    v_pk_fma_f32 v[36:37], v[68:69], v[148:149], v[36:37] neg_lo:[1,0,0] neg_hi:[1,0,0]
    v_pk_fma_f32 v[34:35], v[86:87], v[150:151], v[34:35]
    v_pk_fma_f32 v[38:39], v[70:71], v[150:151], v[38:39] neg_lo:[1,0,0] neg_hi:[1,0,0]
    v_cvt_pk_f16_f32 v52, v32, v36
    v_cvt_pk_f16_f32 v53, v33, v37
    v_cvt_pk_f16_f32 v54, v34, v38
    v_cvt_pk_f16_f32 v55, v35, v39
    v_mfma_f32_32x32x16_f16 v[120:135], v[40:43], v[88:91], 0
    v_mfma_f32_32x32x16_f16 v[120:135], v[44:47], v[92:95], v[120:135]
    v_mfma_f32_32x32x16_f16 v[120:135], v[48:51], v[96:99], v[120:135]
    v_mfma_f32_32x32x16_f16 v[120:135], v[52:55], v[100:103], v[120:135]
    v_mfma_f32_32x32x16_f16 v[136:151], v[40:43], v[104:107], 0
    v_mfma_f32_32x32x16_f16 v[136:151], v[44:47], v[108:111], v[136:151]
    v_mfma_f32_32x32x16_f16 v[136:151], v[48:51], v[112:115], v[136:151]
    v_mfma_f32_32x32x16_f16 v[136:151], v[52:55], v[116:119], v[136:151]
    v_subrev_u32 v12, s68, v13
    v_subrev_u32 v17, s68, v14
    v_lshlrev_b32 v12, 1, v12
    v_lshlrev_b32 v17, 1, v17
    v_sub_u32 v7, 4096, v12
    v_and_b32 v7, 4095, v7
    s_nop 1
    ds_write_b128 v12, v[120:123] offset:0
    ds_write_b128 v12, v[124:127] offset:16
    ds_write_b128 v12, v[128:131] offset:32
    ds_write_b128 v12, v[132:135] offset:48
    ds_write_b128 v12, v[136:139] offset:4096
    ds_write_b128 v12, v[140:143] offset:4112
    ds_write_b128 v12, v[144:147] offset:4128
    ds_write_b128 v12, v[148:151] offset:4144
    s_waitcnt lgkmcnt(0)
    ds_read_b128 v[56:59], v17 offset:0
    ds_read_b128 v[60:63], v17 offset:16
    ds_read_b128 v[64:67], v17 offset:32
    ds_read_b128 v[68:71], v17 offset:48
    ds_read_b128 v[72:75], v17 offset:4096
    ds_read_b128 v[76:79], v17 offset:4112
    ds_read_b128 v[80:83], v17 offset:4128
    ds_read_b128 v[84:87], v17 offset:4144
    s_waitcnt lgkmcnt(0)
    ds_read_b32 v56, v7 offset:0
    ds_read_b32 v72, v7 offset:4096
    v_add_f32 v121, v121, v71
    v_add_f32 v122, v122, v70
    v_add_f32 v123, v123, v69
    v_add_f32 v124, v124, v68
    v_add_f32 v125, v125, v67
    v_add_f32 v126, v126, v66
    v_add_f32 v127, v127, v65
    v_add_f32 v128, v128, v64
    v_add_f32 v129, v129, v63
    v_add_f32 v130, v130, v62
    v_add_f32 v131, v131, v61
    v_add_f32 v132, v132, v60
    v_add_f32 v133, v133, v59
    v_add_f32 v134, v134, v58
    v_add_f32 v135, v135, v57
    v_add_f32 v137, v137, v87
    v_add_f32 v138, v138, v86
    v_add_f32 v139, v139, v85
    v_add_f32 v140, v140, v84
    v_add_f32 v141, v141, v83
    v_add_f32 v142, v142, v82
    v_add_f32 v143, v143, v81
    v_add_f32 v144, v144, v80
    v_add_f32 v145, v145, v79
    v_add_f32 v146, v146, v78
    v_add_f32 v147, v147, v77
    v_add_f32 v148, v148, v76
    v_add_f32 v149, v149, v75
    v_add_f32 v150, v150, v74
    v_add_f32 v151, v151, v73
    s_waitcnt lgkmcnt(0)
    v_add_f32 v120, v120, v56
    v_add_f32 v136, v136, v72
    ds_bpermute_b32 v12, v19, v136
    s_waitcnt lgkmcnt(1)
    v_pk_fma_f32 v[152:153], v[184:185], v[120:121], v[152:153]
    v_pk_fma_f32 v[154:155], v[186:187], v[122:123], v[154:155]
    v_pk_fma_f32 v[156:157], v[188:189], v[124:125], v[156:157]
    v_pk_fma_f32 v[158:159], v[190:191], v[126:127], v[158:159]
    v_pk_fma_f32 v[160:161], v[192:193], v[128:129], v[160:161]
    v_pk_fma_f32 v[162:163], v[194:195], v[130:131], v[162:163]
    v_pk_fma_f32 v[164:165], v[196:197], v[132:133], v[164:165]
    v_pk_fma_f32 v[166:167], v[198:199], v[134:135], v[166:167]
    v_pk_fma_f32 v[170:171], v[202:203], v[138:139], v[170:171]
    v_pk_fma_f32 v[172:173], v[204:205], v[140:141], v[172:173]
    v_pk_fma_f32 v[174:175], v[206:207], v[142:143], v[174:175]
    v_pk_fma_f32 v[176:177], v[208:209], v[144:145], v[176:177]
    v_pk_fma_f32 v[178:179], v[210:211], v[146:147], v[178:179]
    v_pk_fma_f32 v[180:181], v[212:213], v[148:149], v[180:181]
    v_pk_fma_f32 v[182:183], v[214:215], v[150:151], v[182:183]
    v_fmac_f32 v169, v201, v137
    s_waitcnt lgkmcnt(0)
    v_fmac_f32 v168, v200, v12
    s_setprio 0
    s_branch f_join
k_done:
    s_endpgm
code_end:
.p2align 8
.type tables,@object
tables:
.long 0x3c00,0x3c00,0x3c00,0x3c00,0x3c00,0x323e3bd9,0x361f3b64,0x38723aa7
.long 0x3c00,0x361f3b64,0x39a839a8,0x3b64361f,0x3c00,0x38723aa7,0x3b64361f,0x3bd9b23e
.long 0x3c00,0xbc00,0x3c00,0xbc00,0x3c00,0xb23ebbd9,0x361f3b64,0xb872baa7
.long 0x3c00,0xb61fbb64,0x39a839a8,0xbb64b61f,0x3c00,0xb872baa7,0x3b64361f,0xbbd9323e
.long 0x3c00,0x39a839a8,0x3c000000,0x39a8b9a8,0x3c00,0x3aa73872,0x3b64b61f,0x323ebbd9
.long 0x3c00,0x3b64361f,0x39a8b9a8,0xb61fbb64,0x3c00,0x3bd9323e,0x361fbb64,0xbaa7b872
.long 0x3c00,0xb9a8b9a8,0x3c000000,0xb9a839a8,0x3c00,0xbaa7b872,0x3b64b61f,0xb23e3bd9
.long 0x3c00,0xbb64b61f,0x39a8b9a8,0x361f3b64,0x3c00,0xbbd9b23e,0x361fbb64,0x3aa73872
.long 0x3c00,0x3c000000,0xbc00,0xbc008000,0x3c00,0x3bd9b23e,0xb61fbb64,0xbaa73872
.long 0x3c00,0x3b64b61f,0xb9a8b9a8,0xb61f3b64,0x3c00,0x3aa7b872,0xbb64b61f,0x323e3bd9
.long 0x3c00,0xbc008000,0xbc00,0x3c000000,0x3c00,0xbbd9323e,0xb61fbb64,0x3aa7b872
.long 0x3c00,0xbb64361f,0xb9a8b9a8,0x361fbb64,0x3c00,0xbaa73872,0xbb64b61f,0xb23ebbd9
.long 0x3c00,0x39a8b9a8,0xbc008000,0x39a839a8,0x3c00,0x3872baa7,0xbb64361f,0x3bd9323e
.long 0x3c00,0x361fbb64,0xb9a839a8,0x3b64b61f,0x3c00,0x323ebbd9,0xb61f3b64,0x3872baa7
.long 0x3c00,0xb9a839a8,0xbc008000,0xb9a8b9a8,0x3c00,0xb8723aa7,0xbb64361f,0xbbd9b23e
.long 0x3c00,0xb61f3b64,0xb9a839a8,0xbb64361f,0x3c00,0xb23e3bd9,0xb61f3b64,0xb8723aa7
.long 0x3c00,0x3c00,0x3c00,0x3c00,0x39a839a8,0x3aa73872,0x3b64361f,0x3bd9323e
.long 0x3c000000,0x3b64b61f,0x39a8b9a8,0x361fbb64,0x39a8b9a8,0x323ebbd9,0xb61fbb64,0xbaa7b872
.long 0x3c00,0xbc00,0x3c00,0xbc00,0x39a839a8,0xbaa7b872,0x3b64361f,0xbbd9b23e
.long 0x3c000000,0xbb64361f,0x39a8b9a8,0xb61f3b64,0x39a8b9a8,0xb23e3bd9,0xb61fbb64,0x3aa73872
.long 0xbc00,0xb9a8b9a8,0xbc008000,0xb9a839a8,0xb9a8b9a8,0xbbd9323e,0xb61f3b64,0x38723aa7
.long 0xbc008000,0xb61f3b64,0x39a839a8,0x3b64b61f,0xb9a839a8,0x38723aa7,0x3b64b61f,0xb23ebbd9
.long 0xbc00,0x39a839a8,0xbc008000,0x39a8b9a8,0xb9a8b9a8,0x3bd9b23e,0xb61f3b64,0xb872baa7
.long 0xbc008000,0x361fbb64,0x39a839a8,0xbb64361f,0xb9a839a8,0xb872baa7,0x3b64b61f,0x323e3bd9
.long 0x3c00,0x3c000000,0xbc00,0xbc008000,0x39a839a8,0x3872baa7,0xbb64b61f,0xb23e3bd9
.long 0x3c000000,0xb61fbb64,0xb9a839a8,0x3b64361f,0x39a8b9a8,0xbbd9b23e,0x361f3b64,0x3872baa7
.long 0x3c00,0xbc008000,0xbc00,0x3c000000,0x39a839a8,0xb8723aa7,0xbb64b61f,0x323ebbd9
.long 0x3c000000,0x361f3b64,0xb9a839a8,0xbb64b61f,0x39a8b9a8,0x3bd9323e,0x361f3b64,0xb8723aa7
.long 0xbc00,0xb9a839a8,0x3c000000,0xb9a8b9a8,0xb9a8b9a8,0x323e3bd9,0x361fbb64,0xbaa73872
.long 0xbc008000,0x3b64361f,0xb9a8b9a8,0x361f3b64,0xb9a839a8,0x3aa7b872,0xbb64361f,0x3bd9b23e
.long 0xbc00,0x39a8b9a8,0x3c000000,0x39a839a8,0xb9a8b9a8,0xb23ebbd9,0x361fbb64,0x3aa7b872
.long 0xbc008000,0xbb64b61f,0xb9a8b9a8,0xb61fbb64,0xb9a839a8,0xbaa73872,0xbb64361f,0xbbd9323e
.long 0x3c00,0x3c00,0x3c00,0x3c00,0x3c000000,0x3bd9b23e,0x3b64b61f,0x3aa7b872
.long 0xbc00,0xb61fbb64,0xb9a8b9a8,0xbb64b61f,0xbc008000,0xbaa73872,0xb61f3b64,0x323e3bd9
.long 0x3c00,0xbc00,0x3c00,0xbc00,0x3c000000,0xbbd9323e,0x3b64b61f,0xbaa73872
.long 0xbc00,0x361f3b64,0xb9a8b9a8,0x3b64361f,0xbc008000,0x3aa7b872,0xb61f3b64,0xb23ebbd9
.long 0x3c00,0x39a839a8,0x3c000000,0x39a8b9a8,0x3c000000,0x3872baa7,0xb61fbb64,0xbbd9b23e
.long 0xbc00,0xbb64b61f,0xb9a839a8,0x361f3b64,0xbc008000,0xb23e3bd9,0x3b64361f,0x3872baa7
.long 0x3c00,0xb9a8b9a8,0x3c000000,0xb9a839a8,0x3c000000,0xb8723aa7,0xb61fbb64,0x3bd9323e
.long 0xbc00,0x3b64361f,0xb9a839a8,0xb61fbb64,0xbc008000,0x323ebbd9,0x3b64361f,0xb8723aa7
.long 0x3c00,0x3c000000,0xbc00,0xbc008000,0x3c000000,0xb23ebbd9,0xbb64361f,0x38723aa7
.long 0xbc00,0xbb64361f,0x39a839a8,0x361fbb64,0xbc008000,0x38723aa7,0x361fbb64,0xbbd9323e
.long 0x3c00,0xbc008000,0xbc00,0x3c000000,0x3c000000,0x323e3bd9,0xbb64361f,0xb872baa7
.long 0xbc00,0x3b64b61f,0x39a839a8,0xb61f3b64,0xbc008000,0xb872baa7,0x361fbb64,0x3bd9b23e
.long 0x3c00,0x39a8b9a8,0xbc008000,0x39a839a8,0x3c000000,0xbaa7b872,0x361f3b64,0x323ebbd9
.long 0xbc00,0xb61f3b64,0x39a8b9a8,0xbb64361f,0xbc008000,0x3bd9323e,0xbb64b61f,0x3aa73872
.long 0x3c00,0xb9a839a8,0xbc008000,0xb9a8b9a8,0x3c000000,0x3aa73872,0x361f3b64,0xb23e3bd9
.long 0xbc00,0x361fbb64,0x39a8b9a8,0x3b64b61f,0xbc008000,0xbbd9b23e,0xbb64b61f,0xbaa7b872
.long 0x3c00,0x3c00,0x3c00,0x3c00,0x39a8b9a8,0x3872baa7,0x361fbb64,0x323ebbd9
.long 0xbc008000,0xbb64361f,0xb9a839a8,0xb61f3b64,0x39a839a8,0x3bd9323e,0x3b64b61f,0x3872baa7
.long 0x3c00,0xbc00,0x3c00,0xbc00,0x39a8b9a8,0xb8723aa7,0x361fbb64,0xb23e3bd9
.long 0xbc008000,0x3b64b61f,0xb9a839a8,0x361fbb64,0x39a839a8,0xbbd9b23e,0x3b64b61f,0xb8723aa7
.long 0xbc00,0xb9a8b9a8,0xbc008000,0xb9a839a8,0xb9a839a8,0x323e3bd9,0x3b64361f,0x3aa7b872
.long 0x3c000000,0x361fbb64,0xb9a8b9a8,0xbb64361f,0xb9a8b9a8,0xbaa73872,0x361f3b64,0x3bd9b23e
.long 0xbc00,0x39a839a8,0xbc008000,0x39a8b9a8,0xb9a839a8,0xb23ebbd9,0x3b64361f,0xbaa73872
.long 0x3c000000,0xb61f3b64,0xb9a8b9a8,0x3b64b61f,0xb9a8b9a8,0x3aa7b872,0x361f3b64,0xbbd9323e
.long 0x3c00,0x3c000000,0xbc00,0xbc008000,0x39a8b9a8,0xbaa7b872,0xb61f3b64,0x3bd9323e
.long 0xbc008000,0x361f3b64,0x39a8b9a8,0xbb64b61f,0x39a839a8,0x323ebbd9,0xbb64361f,0x3aa73872
.long 0x3c00,0xbc008000,0xbc00,0x3c000000,0x39a8b9a8,0x3aa73872,0xb61f3b64,0xbbd9b23e
.long 0xbc008000,0xb61fbb64,0x39a8b9a8,0x3b64361f,0x39a839a8,0xb23e3bd9,0xbb64361f,0xbaa7b872
.long 0xbc00,0xb9a839a8,0x3c000000,0xb9a8b9a8,0xb9a839a8,0x3bd9b23e,0xbb64b61f,0x38723aa7
.long 0x3c000000,0xbb64b61f,0x39a839a8,0xb61fbb64,0xb9a8b9a8,0x38723aa7,0xb61fbb64,0x323e3bd9
.long 0xbc00,0x39a8b9a8,0x3c000000,0x39a839a8,0xb9a839a8,0xbbd9323e,0xbb64b61f,0xb872baa7
.long 0x3c000000,0x3b64361f,0x39a839a8,0x361f3b64,0xb9a8b9a8,0xb872baa7,0xb61fbb64,0xb23ebbd9
.long 0x3c00,0x3c00,0x3c00,0x3c00,0xbc00,0xb23ebbd9,0xb61fbb64,0xb872baa7
.long 0x3c00,0x361f3b64,0x39a839a8,0x3b64361f,0xbc00,0xb872baa7,0xbb64b61f,0xbbd9323e
.long 0x3c00,0xbc00,0x3c00,0xbc00,0xbc00,0x323e3bd9,0xb61fbb64,0x38723aa7
.long 0x3c00,0xb61fbb64,0x39a839a8,0xbb64b61f,0xbc00,0x38723aa7,0xbb64b61f,0x3bd9b23e
.long 0x3c00,0x39a839a8,0x3c000000,0x39a8b9a8,0xbc00,0xbaa7b872,0xbb64361f,0xb23e3bd9
.long 0x3c00,0x3b64361f,0x39a8b9a8,0xb61fbb64,0xbc00,0xbbd9b23e,0xb61f3b64,0x3aa73872
.long 0x3c00,0xb9a8b9a8,0x3c000000,0xb9a839a8,0xbc00,0x3aa73872,0xbb64361f,0x323ebbd9
.long 0x3c00,0xbb64b61f,0x39a8b9a8,0x361f3b64,0xbc00,0x3bd9323e,0xb61f3b64,0xbaa7b872
.long 0x3c00,0x3c000000,0xbc00,0xbc008000,0xbc00,0xbbd9323e,0x361f3b64,0x3aa7b872
.long 0x3c00,0x3b64b61f,0xb9a8b9a8,0xb61f3b64,0xbc00,0xbaa73872,0x3b64361f,0xb23ebbd9
.long 0x3c00,0xbc008000,0xbc00,0x3c000000,0xbc00,0x3bd9b23e,0x361f3b64,0xbaa73872
.long 0x3c00,0xbb64361f,0xb9a8b9a8,0x361fbb64,0xbc00,0x3aa7b872,0x3b64361f,0x323e3bd9
.long 0x3c00,0x39a8b9a8,0xbc008000,0x39a839a8,0xbc00,0xb8723aa7,0x3b64b61f,0xbbd9b23e
.long 0x3c00,0x361fbb64,0xb9a839a8,0x3b64b61f,0xbc00,0xb23e3bd9,0x361fbb64,0xb8723aa7
.long 0x3c00,0xb9a839a8,0xbc008000,0xb9a8b9a8,0xbc00,0x3872baa7,0x3b64b61f,0x3bd9323e
.long 0x3c00,0xb61f3b64,0xb9a839a8,0xbb64361f,0xbc00,0x323ebbd9,0x361fbb64,0x3872baa7
.long 0x3c00,0x3c00,0x3c00,0x3c00,0xb9a8b9a8,0xbaa7b872,0xbb64b61f,0xbbd9b23e
.long 0x3c000000,0x3b64b61f,0x39a8b9a8,0x361fbb64,0xb9a839a8,0xb23e3bd9,0x361f3b64,0x3aa73872
.long 0x3c00,0xbc00,0x3c00,0xbc00,0xb9a8b9a8,0x3aa73872,0xbb64b61f,0x3bd9323e
.long 0x3c000000,0xbb64361f,0x39a8b9a8,0xb61f3b64,0xb9a839a8,0x323ebbd9,0x361f3b64,0xbaa7b872
.long 0xbc00,0xb9a8b9a8,0xbc008000,0xb9a839a8,0x39a839a8,0x3bd9b23e,0x361fbb64,0xb872baa7
.long 0xbc008000,0xb61f3b64,0x39a839a8,0x3b64b61f,0x39a8b9a8,0xb872baa7,0xbb64361f,0x323e3bd9
.long 0xbc00,0x39a839a8,0xbc008000,0x39a8b9a8,0x39a839a8,0xbbd9323e,0x361fbb64,0x38723aa7
.long 0xbc008000,0x361fbb64,0x39a839a8,0xbb64361f,0x39a8b9a8,0x38723aa7,0xbb64361f,0xb23ebbd9
.long 0x3c00,0x3c000000,0xbc00,0xbc008000,0xb9a8b9a8,0xb8723aa7,0x3b64361f,0x323ebbd9
.long 0x3c000000,0xb61fbb64,0xb9a839a8,0x3b64361f,0xb9a839a8,0x3bd9323e,0xb61fbb64,0xb8723aa7
.long 0x3c00,0xbc008000,0xbc00,0x3c000000,0xb9a8b9a8,0x3872baa7,0x3b64361f,0xb23e3bd9
.long 0x3c000000,0x361f3b64,0xb9a839a8,0xbb64b61f,0xb9a839a8,0xbbd9b23e,0xb61fbb64,0x3872baa7
.long 0xbc00,0xb9a839a8,0x3c000000,0xb9a8b9a8,0x39a839a8,0xb23ebbd9,0xb61f3b64,0x3aa7b872
.long 0xbc008000,0x3b64361f,0xb9a8b9a8,0x361f3b64,0x39a8b9a8,0xbaa73872,0x3b64b61f,0xbbd9323e
.long 0xbc00,0x39a8b9a8,0x3c000000,0x39a839a8,0x39a839a8,0x323e3bd9,0xb61f3b64,0xbaa73872
.long 0xbc008000,0xbb64b61f,0xb9a8b9a8,0xb61fbb64,0x39a8b9a8,0x3aa7b872,0x3b64b61f,0x3bd9b23e
.long 0x3c00,0x3c00,0x3c00,0x3c00,0xbc008000,0xbbd9323e,0xbb64361f,0xbaa73872
.long 0xbc00,0xb61fbb64,0xb9a8b9a8,0xbb64b61f,0x3c000000,0x3aa7b872,0x361fbb64,0xb23ebbd9
.long 0x3c00,0xbc00,0x3c00,0xbc00,0xbc008000,0x3bd9b23e,0xbb64361f,0x3aa7b872
.long 0xbc00,0x361f3b64,0xb9a8b9a8,0x3b64361f,0x3c000000,0xbaa73872,0x361fbb64,0x323e3bd9
.long 0x3c00,0x39a839a8,0x3c000000,0x39a8b9a8,0xbc008000,0xb8723aa7,0x361f3b64,0x3bd9323e
.long 0xbc00,0xbb64b61f,0xb9a839a8,0x361f3b64,0x3c000000,0x323ebbd9,0xbb64b61f,0xb8723aa7
.long 0x3c00,0xb9a8b9a8,0x3c000000,0xb9a839a8,0xbc008000,0x3872baa7,0x361f3b64,0xbbd9b23e
.long 0xbc00,0x3b64361f,0xb9a839a8,0xb61fbb64,0x3c000000,0xb23e3bd9,0xbb64b61f,0x3872baa7
.long 0x3c00,0x3c000000,0xbc00,0xbc008000,0xbc008000,0x323e3bd9,0x3b64b61f,0xb872baa7
.long 0xbc00,0xbb64361f,0x39a839a8,0x361fbb64,0x3c000000,0xb872baa7,0xb61f3b64,0x3bd9b23e
.long 0x3c00,0xbc008000,0xbc00,0x3c000000,0xbc008000,0xb23ebbd9,0x3b64b61f,0x38723aa7
.long 0xbc00,0x3b64b61f,0x39a839a8,0xb61f3b64,0x3c000000,0x38723aa7,0xb61f3b64,0xbbd9323e
.long 0x3c00,0x39a8b9a8,0xbc008000,0x39a839a8,0xbc008000,0x3aa73872,0xb61fbb64,0xb23e3bd9
.long 0xbc00,0xb61f3b64,0x39a8b9a8,0xbb64361f,0x3c000000,0xbbd9b23e,0x3b64361f,0xbaa7b872
.long 0x3c00,0xb9a839a8,0xbc008000,0xb9a8b9a8,0xbc008000,0xbaa7b872,0xb61fbb64,0x323ebbd9
.long 0xbc00,0x361fbb64,0x39a8b9a8,0x3b64b61f,0x3c000000,0x3bd9323e,0x3b64361f,0x3aa73872
.long 0x3c00,0x3c00,0x3c00,0x3c00,0xb9a839a8,0xb8723aa7,0xb61f3b64,0xb23e3bd9
.long 0xbc008000,0xbb64361f,0xb9a839a8,0xb61f3b64,0xb9a8b9a8,0xbbd9b23e,0xbb64361f,0xb8723aa7
.long 0x3c00,0xbc00,0x3c00,0xbc00,0xb9a839a8,0x3872baa7,0xb61f3b64,0x323ebbd9
.long 0xbc008000,0x3b64b61f,0xb9a839a8,0x361fbb64,0xb9a8b9a8,0x3bd9323e,0xbb64361f,0x3872baa7
.long 0xbc00,0xb9a8b9a8,0xbc008000,0xb9a839a8,0x39a8b9a8,0xb23ebbd9,0xbb64b61f,0xbaa73872
.long 0x3c000000,0x361fbb64,0xb9a8b9a8,0xbb64361f,0x39a839a8,0x3aa7b872,0xb61fbb64,0xbbd9323e
.long 0xbc00,0x39a839a8,0xbc008000,0x39a8b9a8,0x39a8b9a8,0x323e3bd9,0xbb64b61f,0x3aa7b872
.long 0x3c000000,0xb61f3b64,0xb9a8b9a8,0x3b64b61f,0x39a839a8,0xbaa73872,0xb61fbb64,0x3bd9b23e
.long 0x3c00,0x3c000000,0xbc00,0xbc008000,0xb9a839a8,0x3aa73872,0x361fbb64,0xbbd9b23e
.long 0xbc008000,0x361f3b64,0x39a8b9a8,0xbb64b61f,0xb9a8b9a8,0xb23e3bd9,0x3b64b61f,0xbaa7b872
.long 0x3c00,0xbc008000,0xbc00,0x3c000000,0xb9a839a8,0xbaa7b872,0x361fbb64,0x3bd9323e
.long 0xbc008000,0xb61fbb64,0x39a8b9a8,0x3b64361f,0xb9a8b9a8,0x323ebbd9,0x3b64b61f,0x3aa73872
.long 0xbc00,0xb9a839a8,0x3c000000,0xb9a8b9a8,0x39a8b9a8,0xbbd9323e,0x3b64361f,0xb872baa7
.long 0x3c000000,0xbb64b61f,0x39a839a8,0xb61fbb64,0x39a839a8,0xb872baa7,0x361f3b64,0xb23ebbd9
.long 0xbc00,0x39a8b9a8,0x3c000000,0x39a839a8,0x39a8b9a8,0x3bd9b23e,0x3b64361f,0x38723aa7
.long 0x3c000000,0x3b64361f,0x39a839a8,0x361f3b64,0x39a839a8,0x38723aa7,0x361f3b64,0x323e3bd9
.long 0x3c008000,0x3c008000,0x3c008000,0x3c008000,0x3c008000,0x3bd9b23e,0x3b64b61f,0x3aa7b872
.long 0x3c008000,0x3b64b61f,0x39a8b9a8,0x361fbb64,0x3c008000,0x3aa7b872,0x361fbb64,0xb23ebbd9
.long 0x3c008000,0xbc008000,0x3c008000,0xbc008000,0x3c008000,0xbbd9323e,0x3b64b61f,0xbaa73872
.long 0x3c008000,0xbb64361f,0x39a8b9a8,0xb61f3b64,0x3c008000,0xbaa73872,0x361fbb64,0x323e3bd9
.long 0x3c008000,0x39a8b9a8,0xbc00,0xb9a8b9a8,0x3c008000,0x3872baa7,0xb61fbb64,0xbbd9b23e
.long 0x3c008000,0x361fbb64,0xb9a8b9a8,0xbb64361f,0x3c008000,0x323ebbd9,0xbb64b61f,0xb8723aa7
.long 0x3c008000,0xb9a839a8,0xbc00,0x39a839a8,0x3c008000,0xb8723aa7,0xb61fbb64,0x3bd9323e
.long 0x3c008000,0xb61f3b64,0xb9a8b9a8,0x3b64b61f,0x3c008000,0xb23e3bd9,0xbb64b61f,0x3872baa7
.long 0x3c008000,0xbc00,0xbc008000,0x80003c00,0x3c008000,0xb23ebbd9,0xbb64361f,0x38723aa7
.long 0x3c008000,0xb61fbb64,0xb9a839a8,0x3b64361f,0x3c008000,0xb872baa7,0xb61f3b64,0x3bd9b23e
.long 0x3c008000,0x80003c00,0xbc008000,0xbc00,0x3c008000,0x323e3bd9,0xbb64361f,0xb872baa7
.long 0x3c008000,0x361f3b64,0xb9a839a8,0xbb64b61f,0x3c008000,0x38723aa7,0xb61f3b64,0xbbd9323e
.long 0x3c008000,0xb9a8b9a8,0x80003c00,0x39a8b9a8,0x3c008000,0xbaa7b872,0x361f3b64,0x323ebbd9
.long 0x3c008000,0xbb64b61f,0x39a839a8,0xb61fbb64,0x3c008000,0xbbd9b23e,0x3b64361f,0xbaa7b872
.long 0x3c008000,0x39a839a8,0x80003c00,0xb9a839a8,0x3c008000,0x3aa73872,0x361f3b64,0xb23e3bd9
.long 0x3c008000,0x3b64361f,0x39a839a8,0x361f3b64,0x3c008000,0x3bd9323e,0x3b64361f,0x3aa73872
.long 0x3c008000,0x3c008000,0x3c008000,0x3c008000,0x39a8b9a8,0x3872baa7,0x361fbb64,0x323ebbd9
.long 0xbc00,0xb61fbb64,0xb9a8b9a8,0xbb64b61f,0xb9a8b9a8,0xbbd9b23e,0xbb64361f,0xb8723aa7
.long 0x3c008000,0xbc008000,0x3c008000,0xbc008000,0x39a8b9a8,0xb8723aa7,0x361fbb64,0xb23e3bd9
.long 0xbc00,0x361f3b64,0xb9a8b9a8,0x3b64361f,0xb9a8b9a8,0x3bd9323e,0xbb64361f,0x3872baa7
.long 0xbc008000,0xb9a839a8,0x80003c00,0x39a839a8,0xb9a839a8,0x323e3bd9,0x3b64361f,0x3aa7b872
.long 0x80003c00,0x3b64361f,0x39a8b9a8,0xb61fbb64,0x39a839a8,0x3aa7b872,0xb61fbb64,0xbbd9323e
.long 0xbc008000,0x39a8b9a8,0x80003c00,0xb9a8b9a8,0xb9a839a8,0xb23ebbd9,0x3b64361f,0xbaa73872
.long 0x80003c00,0xbb64b61f,0x39a8b9a8,0x361f3b64,0x39a839a8,0xbaa73872,0xb61fbb64,0x3bd9b23e
.long 0x3c008000,0xbc00,0xbc008000,0x80003c00,0x39a8b9a8,0xbaa7b872,0xb61f3b64,0x3bd9323e
.long 0xbc00,0xbb64361f,0x39a839a8,0x361fbb64,0xb9a8b9a8,0xb23e3bd9,0x3b64b61f,0xbaa7b872
.long 0x3c008000,0x80003c00,0xbc008000,0xbc00,0x39a8b9a8,0x3aa73872,0xb61f3b64,0xbbd9b23e
.long 0xbc00,0x3b64b61f,0x39a839a8,0xb61f3b64,0xb9a8b9a8,0x323ebbd9,0x3b64b61f,0x3aa73872
.long 0xbc008000,0x39a839a8,0xbc00,0xb9a839a8,0xb9a839a8,0x3bd9b23e,0xbb64b61f,0x38723aa7
.long 0x80003c00,0x361fbb64,0xb9a839a8,0x3b64b61f,0x39a839a8,0xb872baa7,0x361f3b64,0xb23ebbd9
.long 0xbc008000,0xb9a8b9a8,0xbc00,0x39a8b9a8,0xb9a839a8,0xbbd9323e,0xbb64b61f,0xb872baa7
.long 0x80003c00,0xb61f3b64,0xb9a839a8,0xbb64361f,0x39a839a8,0x38723aa7,0x361f3b64,0x323e3bd9
.long 0x3c008000,0x3c008000,0x3c008000,0x3c008000,0xbc00,0xb23ebbd9,0xb61fbb64,0xb872baa7
.long 0xbc008000,0xbb64361f,0xb9a839a8,0xb61f3b64,0x80003c00,0x38723aa7,0x3b64361f,0x3bd9b23e
.long 0x3c008000,0xbc008000,0x3c008000,0xbc008000,0xbc00,0x323e3bd9,0xb61fbb64,0x38723aa7
.long 0xbc008000,0x3b64b61f,0xb9a839a8,0x361fbb64,0x80003c00,0xb872baa7,0x3b64361f,0xbbd9323e
.long 0x3c008000,0x39a8b9a8,0xbc00,0xb9a8b9a8,0xbc00,0xbaa7b872,0xbb64361f,0xb23e3bd9
.long 0xbc008000,0xb61f3b64,0x39a839a8,0x3b64b61f,0x80003c00,0x3bd9323e,0x361fbb64,0xbaa7b872
.long 0x3c008000,0xb9a839a8,0xbc00,0x39a839a8,0xbc00,0x3aa73872,0xbb64361f,0x323ebbd9
.long 0xbc008000,0x361fbb64,0x39a839a8,0xbb64361f,0x80003c00,0xbbd9b23e,0x361fbb64,0x3aa73872
.long 0x3c008000,0xbc00,0xbc008000,0x80003c00,0xbc00,0xbbd9323e,0x361f3b64,0x3aa7b872
.long 0xbc008000,0x361f3b64,0x39a8b9a8,0xbb64b61f,0x80003c00,0x3aa7b872,0xbb64b61f,0x323e3bd9
.long 0x3c008000,0x80003c00,0xbc008000,0xbc00,0xbc00,0x3bd9b23e,0x361f3b64,0xbaa73872
.long 0xbc008000,0xb61fbb64,0x39a8b9a8,0x3b64361f,0x80003c00,0xbaa73872,0xbb64b61f,0xb23ebbd9
.long 0x3c008000,0xb9a8b9a8,0x80003c00,0x39a8b9a8,0xbc00,0xb8723aa7,0x3b64b61f,0xbbd9b23e
.long 0xbc008000,0x3b64361f,0xb9a8b9a8,0x361f3b64,0x80003c00,0x323ebbd9,0xb61f3b64,0x3872baa7
.long 0x3c008000,0x39a839a8,0x80003c00,0xb9a839a8,0xbc00,0x3872baa7,0x3b64b61f,0x3bd9323e
.long 0xbc008000,0xbb64b61f,0xb9a8b9a8,0xb61fbb64,0x80003c00,0xb23e3bd9,0xb61f3b64,0xb8723aa7
.long 0x3c008000,0x3c008000,0x3c008000,0x3c008000,0xb9a8b9a8,0xbaa7b872,0xbb64b61f,0xbbd9b23e
.long 0x80003c00,0x361f3b64,0x39a839a8,0x3b64361f,0x39a8b9a8,0x323ebbd9,0xb61fbb64,0xbaa7b872
.long 0x3c008000,0xbc008000,0x3c008000,0xbc008000,0xb9a8b9a8,0x3aa73872,0xbb64b61f,0x3bd9323e
.long 0x80003c00,0xb61fbb64,0x39a839a8,0xbb64b61f,0x39a8b9a8,0xb23e3bd9,0xb61fbb64,0x3aa73872
.long 0xbc008000,0xb9a839a8,0x80003c00,0x39a839a8,0x39a839a8,0x3bd9b23e,0x361fbb64,0xb872baa7
.long 0xbc00,0xbb64b61f,0xb9a839a8,0x361f3b64,0xb9a839a8,0x38723aa7,0x3b64b61f,0xb23ebbd9
.long 0xbc008000,0x39a8b9a8,0x80003c00,0xb9a8b9a8,0x39a839a8,0xbbd9323e,0x361fbb64,0x38723aa7
.long 0xbc00,0x3b64361f,0xb9a839a8,0xb61fbb64,0xb9a839a8,0xb872baa7,0x3b64b61f,0x323e3bd9
.long 0x3c008000,0xbc00,0xbc008000,0x80003c00,0xb9a8b9a8,0xb8723aa7,0x3b64361f,0x323ebbd9
.long 0x80003c00,0x3b64b61f,0xb9a8b9a8,0xb61f3b64,0x39a8b9a8,0xbbd9b23e,0x361f3b64,0x3872baa7
.long 0x3c008000,0x80003c00,0xbc008000,0xbc00,0xb9a8b9a8,0x3872baa7,0x3b64361f,0xb23e3bd9
.long 0x80003c00,0xbb64361f,0xb9a8b9a8,0x361fbb64,0x39a8b9a8,0x3bd9323e,0x361f3b64,0xb8723aa7
.long 0xbc008000,0x39a839a8,0xbc00,0xb9a839a8,0x39a839a8,0xb23ebbd9,0xb61f3b64,0x3aa7b872
.long 0xbc00,0xb61f3b64,0x39a8b9a8,0xbb64361f,0xb9a839a8,0x3aa7b872,0xbb64361f,0x3bd9b23e
.long 0xbc008000,0xb9a8b9a8,0xbc00,0x39a8b9a8,0x39a839a8,0x323e3bd9,0xb61f3b64,0xbaa73872
.long 0xbc00,0x361fbb64,0x39a8b9a8,0x3b64b61f,0xb9a839a8,0xbaa73872,0xbb64361f,0xbbd9323e
.long 0x3c008000,0x3c008000,0x3c008000,0x3c008000,0xbc008000,0xbbd9323e,0xbb64361f,0xbaa73872
.long 0x3c008000,0x3b64b61f,0x39a8b9a8,0x361fbb64,0xbc008000,0xbaa73872,0xb61f3b64,0x323e3bd9
.long 0x3c008000,0xbc008000,0x3c008000,0xbc008000,0xbc008000,0x3bd9b23e,0xbb64361f,0x3aa7b872
.long 0x3c008000,0xbb64361f,0x39a8b9a8,0xb61f3b64,0xbc008000,0x3aa7b872,0xb61f3b64,0xb23ebbd9
.long 0x3c008000,0x39a8b9a8,0xbc00,0xb9a8b9a8,0xbc008000,0xb8723aa7,0x361f3b64,0x3bd9323e
.long 0x3c008000,0x361fbb64,0xb9a8b9a8,0xbb64361f,0xbc008000,0xb23e3bd9,0x3b64361f,0x3872baa7
.long 0x3c008000,0xb9a839a8,0xbc00,0x39a839a8,0xbc008000,0x3872baa7,0x361f3b64,0xbbd9b23e
.long 0x3c008000,0xb61f3b64,0xb9a8b9a8,0x3b64b61f,0xbc008000,0x323ebbd9,0x3b64361f,0xb8723aa7
.long 0x3c008000,0xbc00,0xbc008000,0x80003c00,0xbc008000,0x323e3bd9,0x3b64b61f,0xb872baa7
.long 0x3c008000,0xb61fbb64,0xb9a839a8,0x3b64361f,0xbc008000,0x38723aa7,0x361fbb64,0xbbd9323e
.long 0x3c008000,0x80003c00,0xbc008000,0xbc00,0xbc008000,0xb23ebbd9,0x3b64b61f,0x38723aa7
.long 0x3c008000,0x361f3b64,0xb9a839a8,0xbb64b61f,0xbc008000,0xb872baa7,0x361fbb64,0x3bd9b23e
.long 0x3c008000,0xb9a8b9a8,0x80003c00,0x39a8b9a8,0xbc008000,0x3aa73872,0xb61fbb64,0xb23e3bd9
.long 0x3c008000,0xbb64b61f,0x39a839a8,0xb61fbb64,0xbc008000,0x3bd9323e,0xbb64b61f,0x3aa73872
.long 0x3c008000,0x39a839a8,0x80003c00,0xb9a839a8,0xbc008000,0xbaa7b872,0xb61fbb64,0x323ebbd9
.long 0x3c008000,0x3b64361f,0x39a839a8,0x361f3b64,0xbc008000,0xbbd9b23e,0xbb64b61f,0xbaa7b872
.long 0x3c008000,0x3c008000,0x3c008000,0x3c008000,0xb9a839a8,0xb8723aa7,0xb61f3b64,0xb23e3bd9
.long 0xbc00,0xb61fbb64,0xb9a8b9a8,0xbb64b61f,0x39a839a8,0x3bd9323e,0x3b64b61f,0x3872baa7
.long 0x3c008000,0xbc008000,0x3c008000,0xbc008000,0xb9a839a8,0x3872baa7,0xb61f3b64,0x323ebbd9
.long 0xbc00,0x361f3b64,0xb9a8b9a8,0x3b64361f,0x39a839a8,0xbbd9b23e,0x3b64b61f,0xb8723aa7
.long 0xbc008000,0xb9a839a8,0x80003c00,0x39a839a8,0x39a8b9a8,0xb23ebbd9,0xbb64b61f,0xbaa73872
.long 0x80003c00,0x3b64361f,0x39a8b9a8,0xb61fbb64,0xb9a8b9a8,0xbaa73872,0x361f3b64,0x3bd9b23e
.long 0xbc008000,0x39a8b9a8,0x80003c00,0xb9a8b9a8,0x39a8b9a8,0x323e3bd9,0xbb64b61f,0x3aa7b872
.long 0x80003c00,0xbb64b61f,0x39a8b9a8,0x361f3b64,0xb9a8b9a8,0x3aa7b872,0x361f3b64,0xbbd9323e
.long 0x3c008000,0xbc00,0xbc008000,0x80003c00,0xb9a839a8,0x3aa73872,0x361fbb64,0xbbd9b23e
.long 0xbc00,0xbb64361f,0x39a839a8,0x361fbb64,0x39a839a8,0x323ebbd9,0xbb64361f,0x3aa73872
.long 0x3c008000,0x80003c00,0xbc008000,0xbc00,0xb9a839a8,0xbaa7b872,0x361fbb64,0x3bd9323e
.long 0xbc00,0x3b64b61f,0x39a839a8,0xb61f3b64,0x39a839a8,0xb23e3bd9,0xbb64361f,0xbaa7b872
.long 0xbc008000,0x39a839a8,0xbc00,0xb9a839a8,0x39a8b9a8,0xbbd9323e,0x3b64361f,0xb872baa7
.long 0x80003c00,0x361fbb64,0xb9a839a8,0x3b64b61f,0xb9a8b9a8,0x38723aa7,0xb61fbb64,0x323e3bd9
.long 0xbc008000,0xb9a8b9a8,0xbc00,0x39a8b9a8,0x39a8b9a8,0x3bd9b23e,0x3b64361f,0x38723aa7
.long 0x80003c00,0xb61f3b64,0xb9a839a8,0xbb64361f,0xb9a8b9a8,0xb872baa7,0xb61fbb64,0xb23ebbd9
.long 0x3c008000,0x3c008000,0x3c008000,0x3c008000,0x80003c00,0x323e3bd9,0x361f3b64,0x38723aa7
.long 0xbc008000,0xbb64361f,0xb9a839a8,0xb61f3b64,0xbc00,0xb872baa7,0xbb64b61f,0xbbd9323e
.long 0x3c008000,0xbc008000,0x3c008000,0xbc008000,0x80003c00,0xb23ebbd9,0x361f3b64,0xb872baa7
.long 0xbc008000,0x3b64b61f,0xb9a839a8,0x361fbb64,0xbc00,0x38723aa7,0xbb64b61f,0x3bd9b23e
.long 0x3c008000,0x39a8b9a8,0xbc00,0xb9a8b9a8,0x80003c00,0x3aa73872,0x3b64b61f,0x323ebbd9
.long 0xbc008000,0xb61f3b64,0x39a839a8,0x3b64b61f,0xbc00,0xbbd9b23e,0xb61f3b64,0x3aa73872
.long 0x3c008000,0xb9a839a8,0xbc00,0x39a839a8,0x80003c00,0xbaa7b872,0x3b64b61f,0xb23e3bd9
.long 0xbc008000,0x361fbb64,0x39a839a8,0xbb64361f,0xbc00,0x3bd9323e,0xb61f3b64,0xbaa7b872
.long 0x3c008000,0xbc00,0xbc008000,0x80003c00,0x80003c00,0x3bd9b23e,0xb61fbb64,0xbaa73872
.long 0xbc008000,0x361f3b64,0x39a8b9a8,0xbb64b61f,0xbc00,0xbaa73872,0x3b64361f,0xb23ebbd9
.long 0x3c008000,0x80003c00,0xbc008000,0xbc00,0x80003c00,0xbbd9323e,0xb61fbb64,0x3aa7b872
.long 0xbc008000,0xb61fbb64,0x39a8b9a8,0x3b64361f,0xbc00,0x3aa7b872,0x3b64361f,0x323e3bd9
.long 0x3c008000,0xb9a8b9a8,0x80003c00,0x39a8b9a8,0x80003c00,0x3872baa7,0xbb64361f,0x3bd9323e
.long 0xbc008000,0x3b64361f,0xb9a8b9a8,0x361f3b64,0xbc00,0xb23e3bd9,0x361fbb64,0xb8723aa7
.long 0x3c008000,0x39a839a8,0x80003c00,0xb9a839a8,0x80003c00,0xb8723aa7,0xbb64361f,0xbbd9b23e
.long 0xbc008000,0xbb64b61f,0xb9a8b9a8,0xb61fbb64,0xbc00,0x323ebbd9,0x361fbb64,0x3872baa7
.long 0x3c008000,0x3c008000,0x3c008000,0x3c008000,0x39a839a8,0x3aa73872,0x3b64361f,0x3bd9323e
.long 0x80003c00,0x361f3b64,0x39a839a8,0x3b64361f,0xb9a839a8,0xb23e3bd9,0x361f3b64,0x3aa73872
.long 0x3c008000,0xbc008000,0x3c008000,0xbc008000,0x39a839a8,0xbaa7b872,0x3b64361f,0xbbd9b23e
.long 0x80003c00,0xb61fbb64,0x39a839a8,0xbb64b61f,0xb9a839a8,0x323ebbd9,0x361f3b64,0xbaa7b872
.long 0xbc008000,0xb9a839a8,0x80003c00,0x39a839a8,0xb9a8b9a8,0xbbd9323e,0xb61f3b64,0x38723aa7
.long 0xbc00,0xbb64b61f,0xb9a839a8,0x361f3b64,0x39a8b9a8,0xb872baa7,0xbb64361f,0x323e3bd9
.long 0xbc008000,0x39a8b9a8,0x80003c00,0xb9a8b9a8,0xb9a8b9a8,0x3bd9b23e,0xb61f3b64,0xb872baa7
.long 0xbc00,0x3b64361f,0xb9a839a8,0xb61fbb64,0x39a8b9a8,0x38723aa7,0xbb64361f,0xb23ebbd9
.long 0x3c008000,0xbc00,0xbc008000,0x80003c00,0x39a839a8,0x3872baa7,0xbb64b61f,0xb23e3bd9
.long 0x80003c00,0x3b64b61f,0xb9a8b9a8,0xb61f3b64,0xb9a839a8,0x3bd9323e,0xb61fbb64,0xb8723aa7
.long 0x3c008000,0x80003c00,0xbc008000,0xbc00,0x39a839a8,0xb8723aa7,0xbb64b61f,0x323ebbd9
.long 0x80003c00,0xbb64361f,0xb9a8b9a8,0x361fbb64,0xb9a839a8,0xbbd9b23e,0xb61fbb64,0x3872baa7
.long 0xbc008000,0x39a839a8,0xbc00,0xb9a839a8,0xb9a8b9a8,0x323e3bd9,0x361fbb64,0xbaa73872
.long 0xbc00,0xb61f3b64,0x39a8b9a8,0xbb64361f,0x39a8b9a8,0xbaa73872,0x3b64b61f,0xbbd9323e
.long 0xbc008000,0xb9a8b9a8,0xbc00,0x39a8b9a8,0xb9a8b9a8,0xb23ebbd9,0x361fbb64,0x3aa7b872
.long 0xbc00,0x361fbb64,0x39a8b9a8,0x3b64b61f,0x39a8b9a8,0x3aa7b872,0x3b64b61f,0x3bd9b23e
.long 0x3f800000,0x3f800000,0x3f800000,0x3f800000,0x3f800000,0x3f7ffec4,0x3f7ffb11,0x3f7ff4e6
.long 0x3f800000,0x3f7ffb11,0x3f7fec43,0x3f7fd397,0x3f800000,0x3f7ff4e6,0x3f7fd397,0x3f7f9c18
.long 0x3f800000,0x3f7ec46d,0x3f7b14be,0x3f74fa0b,0x3f800000,0x3f7e9bc9,0x3f7a7302,0x3f73913f
.long 0x3f800000,0x3f7e70b0,0x3f79c79d,0x3f721352,0x3f800000,0x3f7e4323,0x3f791298,0x3f708066
.long 0x3f800000,0x3f7fec43,0x3f7fb10f,0x3f7f4e6d,0x3f800000,0x3f7fe129,0x3f7f84ab,0x3f7eea9d
.long 0x3f800000,0x3f7fd397,0x3f7f4e6d,0x3f7e70b0,0x3f800000,0x3f7fc38f,0x3f7f0e58,0x3f7de0b1
.long 0x3f800000,0x3f7e1324,0x3f7853f8,0x3f6ed89e,0x3f800000,0x3f7de0b1,0x3f778bc5,0x3f6d1c1d
.long 0x3f800000,0x3f7dabcc,0x3f76ba07,0x3f6b4b0c,0x3f800000,0x3f7d7474,0x3f75dec6,0x3f696591
.long 0x3f800000,0x3f7fb10f,0x3f7ec46d,0x3f7d3aac,0x3f800000,0x3f7f9c18,0x3f7e70b0,0x3f7c7eb0
.long 0x3f800000,0x3f7f84ab,0x3f7e1324,0x3f7baccd,0x3f800000,0x3f7f6ac7,0x3f7dabcc,0x3f7ac516
.long 0x3f800000,0x3f7d3aac,0x3f74fa0b,0x3f676bd8,0x3f800000,0x3f7cfe73,0x3f740bdd,0x3f655e0b
.long 0x3f800000,0x3f7cbfc9,0x3f731447,0x3f633c5a,0x3f800000,0x3f7c7eb0,0x3f721352,0x3f6106f2
.long 0x3f800000,0x3f7f4e6d,0x3f7d3aac,0x3f79c79d,0x3f800000,0x3f7f2f9d,0x3f7cbfc9,0x3f78b47b
.long 0x3f800000,0x3f7f0e58,0x3f7c3b28,0x3f778bc5,0x3f800000,0x3f7eea9d,0x3f7baccd,0x3f764d97
.long 0x3f800000,0x3f7c3b28,0x3f710908,0x3f5ebe05,0x3f800000,0x3f7bf531,0x3f6ff573,0x3f5c61c7
.long 0x3f800000,0x3f7baccd,0x3f6ed89e,0x3f59f26a,0x3f800000,0x3f7b61fc,0x3f6db293,0x3f577026
.long 0x3f800000,0x3f800000,0x3f800000,0x3f800000,0x3f7fec43,0x3f7fe129,0x3f7fd397,0x3f7fc38f
.long 0x3f7fb10f,0x3f7f84ab,0x3f7f4e6d,0x3f7f0e58,0x3f7f4e6d,0x3f7eea9d,0x3f7e70b0,0x3f7de0b1
.long 0x3f6c835e,0x3f61c598,0x3f54db31,0x3f45e403,0x3f6a09a7,0x3f5df6be,0x3f4f7a1f,0x3f3ebc1b
.long 0x3f676bd8,0x3f59f26a,0x3f49d112,0x3f373a23,0x3f64aa59,0x3f55b993,0x3f43e200,0x3f2f61a5
.long 0x3f7ec46d,0x3f7e1324,0x3f7d3aac,0x3f7c3b28,0x3f7e1324,0x3f7cfe73,0x3f7baccd,0x3f7a1e84
.long 0x3f7d3aac,0x3f7baccd,0x3f79c79d,0x3f778bc5,0x3f7c3b28,0x3f7a1e84,0x3f778bc5,0x3f748422
.long 0x3f61c598,0x3f514d3d,0x3f3daef9,0x3f273656,0x3f5ebe05,0x3f4cae79,0x3f373a23,0x3f1ebc12
.long 0x3f5b941a,0x3f47de65,0x3f3085bb,0x3f15f6d9,0x3f584853,0x3f42de29,0x3f299415,0x3f0cead0
.long 0x3f7b14be,0x3f7853f8,0x3f74fa0b,0x3f710908,0x3f79c79d,0x3f764d97,0x3f721352,0x3f6d1c1d
.long 0x3f7853f8,0x3f740bdd,0x3f6ed89e,0x3f68bf3c,0x3f76ba07,0x3f718f57,0x3f6b4b0c,0x3f63f473
.long 0x3f54db31,0x3f3daef9,0x3f226799,0x3f039c3d,0x3f514d3d,0x3f385216,0x3f1b02c6,0x3ef41f07
.long 0x3f4d9f02,0x3f32c8c9,0x3f13682a,0x3ee0924f,0x3f49d112,0x3f2d1469,0x3f0b9a6b,0x3ecc9b8b
.long 0x3f74fa0b,0x3f6ed89e,0x3f676bd8,0x3f5ebe05,0x3f731447,0x3f6be858,0x3f633c5a,0x3f591e6a
.long 0x3f710908,0x3f68bf3c,0x3f5ebe05,0x3f531849,0x3f6ed89e,0x3f655e0b,0x3f59f26a,0x3f4cae79
.long 0x3f45e403,0x3f273656,0x3f039c3d,0x3eb8442a,0x3f41d870,0x3f212ff9,0x3ef6e0cb,0x3ea395c5
.long 0x3f3daef9,0x3f1b02c6,0x3ee63375,0x3e8e9a22,0x3f396842,0x3f14b039,0x3ed53641,0x3e72b651
.long 0x3f800000,0x3f800000,0x3f800000,0x3f800000,0x3f7fb10f,0x3f7f9c18,0x3f7f84ab,0x3f7f6ac7
.long 0x3f7ec46d,0x3f7e70b0,0x3f7e1324,0x3f7dabcc,0x3f7d3aac,0x3f7c7eb0,0x3f7baccd,0x3f7ac516
.long 0x3f3504f3,0x3f226799,0x3f0e39da,0x3ef15aea,0x3f2beb4a,0x3f173c07,0x3f00e7e4,0x3ed25a09
.long 0x3f226799,0x3f0b9a6b,0x3ee63375,0x3eb263ef,0x3f187fc0,0x3eff17b2,0x3ec9b953,0x3e919ddd
.long 0x3f7b14be,0x3f79c79d,0x3f7853f8,0x3f76ba07,0x3f7853f8,0x3f764d97,0x3f740bdd,0x3f718f57
.long 0x3f74fa0b,0x3f721352,0x3f6ed89e,0x3f6b4b0c,0x3f710908,0x3f6d1c1d,0x3f68bf3c,0x3f63f473
.long 0x3f0e39da,0x3ee63375,0x3eac7cd4,0x3e605c13,0x3f039c3d,0x3ecc9b8b,0x3e8e9a22,0x3e1c76de
.long 0x3ef15aea,0x3eb263ef,0x3e605c13,0x3dafb680,0x3edae880,0x3e97a117,0x3e22abb6,0x3c96c9b6
.long 0x3f6c835e,0x3f676bd8,0x3f61c598,0x3f5b941a,0x3f676bd8,0x3f6106f2,0x3f59f26a,0x3f5233c6
.long 0x3f61c598,0x3f59f26a,0x3f514d3d,0x3f47de65,0x3f5b941a,0x3f5233c6,0x3f47de65,0x3f3ca003
.long 0x3ec3ef15,0x3e78cfcc,0x3dc8bd36,0xbd48fb30,0x3eac7cd4,0x3e419b37,0x3d16c32c,0xbdee3876
.long 0x3e94a031,0x3e09cf86,0xbcc90ab0,0xbe3b6ecf,0x3e78cfcc,0x3da3308c,0xbdafb680,0xbe7ee6e1
.long 0x3f54db31,0x3f49d112,0x3f3daef9,0x3f3085bb,0x3f4d9f02,0x3f40d0da,0x3f32c8c9,0x3f239da9
.long 0x3f45e403,0x3f373a23,0x3f273656,0x3f15f6d9,0x3f3daef9,0x3f2d1469,0x3f1b02c6,0x3f07a136
.long 0x3e47c5c2,0x3cc90ab0,0xbe164083,0xbea09ae5,0x3e164083,0xbcfb49ba,0xbe541501,0xbec1071e
.long 0x3dc8bd36,0xbdafb680,0xbe888e93,0xbee0924f,0x3d48fb30,0xbe1008b7,0xbea68f12,0xbeff17b2
.long 0x3f800000,0x3f800000,0x3f800000,0x3f800000,0x3f7f4e6d,0x3f7f2f9d,0x3f7f0e58,0x3f7eea9d
.long 0x3f7d3aac,0x3f7cbfc9,0x3f7c3b28,0x3f7baccd,0x3f79c79d,0x3f78b47b,0x3f778bc5,0x3f764d97
.long 0x3ec3ef15,0x3e94a031,0x3e47c5c2,0x3dc8bd36,0x3ea09ae5,0x3e5a3997,0x3de1bc2e,0x3bc90f88
.long 0x3e78cfcc,0x3e09cf86,0x3cc90ab0,0xbdafb680,0x3e2f10a2,0x3d621469,0xbd7b2b74,0xbe354098
.long 0x3f74fa0b,0x3f731447,0x3f710908,0x3f6ed89e,0x3f6ed89e,0x3f6be858,0x3f68bf3c,0x3f655e0b
.long 0x3f676bd8,0x3f633c5a,0x3f5ebe05,0x3f59f26a,0x3f5ebe05,0x3f591e6a,0x3f531849,0x3f4cae79
.long 0x3dc8bd36,0xbcc90ab0,0xbe164083,0xbe888e93,0x3cc90ab0,0xbdd53db9,0xbe6c9a7f,0xbeb554ec
.long 0xbd48fb30,0xbe3b6ecf,0xbea09ae5,0xbee0924f,0xbdfab273,0xbe8586ce,0xbec9b953,0xbf04f484
.long 0x3f54db31,0x3f4d9f02,0x3f45e403,0x3f3daef9,0x3f49d112,0x3f40d0da,0x3f373a23,0x3f2d1469
.long 0x3f3daef9,0x3f32c8c9,0x3f273656,0x3f1b02c6,0x3f3085bb,0x3f239da9,0x3f15f6d9,0x3f07a136
.long 0xbe47c5c2,0xbeac7cd4,0xbef15aea,0xbf187fc0,0xbe888e93,0xbed25a09,0xbf0b9a6b,0xbf2ac082
.long 0xbeac7cd4,0xbef6e0cb,0xbf1d7fd1,0xbf3b8f3b,0xbecf7bca,0xbf0cead0,0xbf2e3bde,0xbf4ac77f
.long 0x3f226799,0x3f13682a,0x3f039c3d,0x3ee63375,0x3f13682a,0x3f0242b1,0x3ee0924f,0x3ebb31a0
.long 0x3f039c3d,0x3ee0924f,0x3eb8442a,0x3e8e9a22,0x3ee63375,0x3ebb31a0,0x3e8e9a22,0x3e419b37
.long 0xbef15aea,0xbf1d7fd1,0xbf3daef9,0xbf584853,0xbf08f59b,0xbf2d1469,0xbf4bbbf8,0xbf63f473
.long 0xbf187fc0,0xbf3b8f3b,0xbf584853,0xbf6db293,0xbf273656,0xbf48d8b3,0xbf633c5a,0xbf756d97
.long 0x3f800000,0x3f800000,0x3f800000,0x3f800000,0x3f7ec46d,0x3f7e9bc9,0x3f7e70b0,0x3f7e4323
.long 0x3f7b14be,0x3f7a7302,0x3f79c79d,0x3f791298,0x3f74fa0b,0x3f73913f,0x3f721352,0x3f708066
.long 0x248d3132,0xbdc8bd36,0xbe47c5c2,0xbe94a031,0xbdc8bd36,0xbe4dee60,0xbe9aa086,0xbecc9b8b
.long 0xbe47c5c2,0xbe9aa086,0xbecf7bca,0xbf00e7e4,0xbe94a031,0xbecc9b8b,0xbf00e7e4,0xbf19c200
.long 0x3f6c835e,0x3f6a09a7,0x3f676bd8,0x3f64aa59,0x3f61c598,0x3f5df6be,0x3f59f26a,0x3f55b993
.long 0x3f54db31,0x3f4f7a1f,0x3f49d112,0x3f43e200,0x3f45e403,0x3f3ebc1b,0x3f373a23,0x3f2f61a5
.long 0xbec3ef15,0xbefc5d27,0xbf187fc0,0xbf3085bb,0xbef15aea,0xbf14b039,0xbf2e3bde,0xbf44e3f5
.long 0xbf0e39da,0xbf299415,0xbf41d870,0xbf5695e5,0xbf226799,0xbf3ca003,0xbf531849,0xbf655e0b
.long 0x3f3504f3,0x3f2beb4a,0x3f226799,0x3f187fc0,0x3f226799,0x3f173c07,0x3f0b9a6b,0x3eff17b2
.long 0x3f0e39da,0x3f00e7e4,0x3ee63375,0x3ec9b953,0x3ef15aea,0x3ed25a09,0x3eb263ef,0x3e919ddd
.long 0xbf3504f3,0xbf4d9f02,0xbf61c598,0xbf710908,0xbf45e403,0xbf5c61c7,0xbf6db293,0xbf796e4e
.long 0xbf54db31,0xbf68bf3c,0xbf76ba07,0xbf7e70b0,0xbf61c598,0xbf7294f8,0xbf7cbfc9,0xbf7ffec4
.long 0x3ec3ef15,0x3ea09ae5,0x3e78cfcc,0x3e2f10a2,0x3e94a031,0x3e5a3997,0x3e09cf86,0x3d621469
.long 0x3e47c5c2,0x3de1bc2e,0x3cc90ab0,0xbd7b2b74,0x3dc8bd36,0x3bc90f88,0xbdafb680,0xbe354098
.long 0xbf6c835e,0xbf79c79d,0xbf7fb10f,0xbf7e1324,0xbf74fa0b,0xbf7e4323,0xbf7f84ab,0xbf78b47b
.long 0xbf7b14be,0xbf7ffb11,0xbf7c3b28,0xbf6ff573,0xbf7ec46d,0xbf7eea9d,0xbf75dec6,0xbf63f473
.long 0x3f800000,0x3f800000,0x3f800000,0x3f800000,0x3f7e1324,0x3f7de0b1,0x3f7dabcc,0x3f7d7474
.long 0x3f7853f8,0x3f778bc5,0x3f76ba07,0x3f75dec6,0x3f6ed89e,0x3f6d1c1d,0x3f6b4b0c,0x3f696591
.long 0xbec3ef15,0xbef15aea,0xbf0e39da,0xbf226799,0xbefc5d27,0xbf14b039,0xbf299415,0xbf3ca003
.long 0xbf187fc0,0xbf2e3bde,0xbf41d870,0xbf531849,0xbf3085bb,0xbf44e3f5,0xbf5695e5,0xbf655e0b
.long 0x3f61c598,0x3f5ebe05,0x3f5b941a,0x3f584853,0x3f514d3d,0x3f4cae79,0x3f47de65,0x3f42de29
.long 0x3f3daef9,0x3f373a23,0x3f3085bb,0x3f299415,0x3f273656,0x3f1ebc12,0x3f15f6d9,0x3f0cead0
.long 0xbf45e403,0xbf584853,0xbf676bd8,0xbf731447,0xbf584853,0xbf6816a8,0xbf740bdd,0xbf7bf531
.long 0xbf676bd8,0xbf740bdd,0xbf7c3b28,0xbf7fd397,0xbf731447,0xbf7bf531,0xbf7fd397,0xbf7e9bc9
.long 0x3f0e39da,0x3f039c3d,0x3ef15aea,0x3edae880,0x3ee63375,0x3ecc9b8b,0x3eb263ef,0x3e97a117
.long 0x3eac7cd4,0x3e8e9a22,0x3e605c13,0x3e22abb6,0x3e605c13,0x3e1c76de,0x3dafb680,0x3c96c9b6
.long 0xbf7b14be,0xbf7fb10f,0xbf7ec46d,0xbf7853f8,0xbf7f4e6d,0xbf7f2f9d,0xbf791298,0xbf6d1c1d
.long 0xbf7fb10f,0xbf7a7302,0xbf6ed89e,0xbf5d2d53,0xbf7c3b28,0xbf718f57,0xbf604621,0xbf48d8b3
.long 0x3dc8bd36,0x3cc90ab0,0xbd48fb30,0xbdfab273,0xbcc90ab0,0xbdd53db9,0xbe3b6ecf,0xbe8586ce
.long 0xbe164083,0xbe6c9a7f,0xbea09ae5,0xbec9b953,0xbe888e93,0xbeb554ec,0xbee0924f,0xbf04f484
.long 0xbf74fa0b,0xbf64aa59,0xbf4d9f02,0xbf3085bb,0xbf6a09a7,0xbf53fac3,0xbf373a23,0xbf14b039
.long 0xbf5b941a,0xbf3fc767,0xbf1d7fd1,0xbeebcbbb,0xbf49d112,0xbf286605,0xbf00e7e4,0xbea986c4
.long 0x3f800000,0x3f800000,0x3f800000,0x3f800000,0x3f7d3aac,0x3f7cfe73,0x3f7cbfc9,0x3f7c7eb0
.long 0x3f74fa0b,0x3f740bdd,0x3f731447,0x3f721352,0x3f676bd8,0x3f655e0b,0x3f633c5a,0x3f6106f2
.long 0xbf3504f3,0xbf45e403,0xbf54db31,0xbf61c598,0xbf4d9f02,0xbf5c61c7,0xbf68bf3c,0xbf7294f8
.long 0xbf61c598,0xbf6db293,0xbf76ba07,0xbf7cbfc9,0xbf710908,0xbf796e4e,0xbf7e70b0,0xbf7ffec4
.long 0x3f54db31,0x3f514d3d,0x3f4d9f02,0x3f49d112,0x3f3daef9,0x3f385216,0x3f32c8c9,0x3f2d1469
.long 0x3f226799,0x3f1b02c6,0x3f13682a,0x3f0b9a6b,0x3f039c3d,0x3ef41f07,0x3ee0924f,0x3ecc9b8b
.long 0xbf7b14be,0xbf7f4e6d,0xbf7fb10f,0xbf7c3b28,0xbf7fb10f,0xbf7f2f9d,0xbf7a7302,0xbf718f57
.long 0xbf7ec46d,0xbf791298,0xbf6ed89e,0xbf604621,0xbf7853f8,0xbf6d1c1d,0xbf5d2d53,0xbf48d8b3
.long 0x3ec3ef15,0x3eac7cd4,0x3e94a031,0x3e78cfcc,0x3e78cfcc,0x3e419b37,0x3e09cf86,0x3da3308c
.long 0x3dc8bd36,0x3d16c32c,0xbcc90ab0,0xbdafb680,0xbd48fb30,0xbdee3876,0xbe3b6ecf,0xbe7ee6e1
.long 0xbf6c835e,0xbf5b941a,0xbf45e403,0xbf2beb4a,0xbf5b941a,0xbf44e3f5,0xbf299415,0xbf0a48ad
.long 0xbf45e403,0xbf299415,0xbf08f59b,0xbec9b953,0xbf2beb4a,0xbf0a48ad,0xbec9b953,0xbe72b651
.long 0xbe47c5c2,0xbe888e93,0xbeac7cd4,0xbecf7bca,0xbeac7cd4,0xbed25a09,0xbef6e0cb,0xbf0cead0
.long 0xbef15aea,0xbf0b9a6b,0xbf1d7fd1,0xbf2e3bde,0xbf187fc0,0xbf2ac082,0xbf3b8f3b,0xbf4ac77f
.long 0xbf0e39da,0xbecf7bca,0xbe78cfcc,0xbd96a905,0xbedae880,0xbe8586ce,0xbdafb680,0x3dbc3ac3
.long 0xbe94a031,0xbde1bc2e,0x3d96a905,0x3e827dc0,0xbe164083,0x3d2fe007,0x3e6c9a7f,0x3ed25a09
.long 0x3f800000,0x3f800000,0x3f800000,0x3f800000,0x3f7c3b28,0x3f7bf531,0x3f7baccd,0x3f7b61fc
.long 0x3f710908,0x3f6ff573,0x3f6ed89e,0x3f6db293,0x3f5ebe05,0x3f5c61c7,0x3f59f26a,0x3f577026
.long 0xbf6c835e,0xbf74fa0b,0xbf7b14be,0xbf7ec46d,0xbf79c79d,0xbf7e4323,0xbf7ffb11,0xbf7eea9d
.long 0xbf7fb10f,0xbf7f84ab,0xbf7c3b28,0xbf75dec6,0xbf7e1324,0xbf78b47b,0xbf6ff573,0xbf63f473
.long 0x3f45e403,0x3f41d870,0x3f3daef9,0x3f396842,0x3f273656,0x3f212ff9,0x3f1b02c6,0x3f14b039
.long 0x3f039c3d,0x3ef6e0cb,0x3ee63375,0x3ed53641,0x3eb8442a,0x3ea395c5,0x3e8e9a22,0x3e72b651
.long 0xbf74fa0b,0xbf6a09a7,0xbf5b941a,0xbf49d112,0xbf64aa59,0xbf53fac3,0xbf3fc767,0xbf286605
.long 0xbf4d9f02,0xbf373a23,0xbf1d7fd1,0xbf00e7e4,0xbf3085bb,0xbf14b039,0xbeebcbbb,0xbea986c4
.long 0x3e47c5c2,0x3e164083,0x3dc8bd36,0x3d48fb30,0x3cc90ab0,0xbcfb49ba,0xbdafb680,0xbe1008b7
.long 0xbe164083,0xbe541501,0xbe888e93,0xbea68f12,0xbea09ae5,0xbec1071e,0xbee0924f,0xbeff17b2
.long 0xbf0e39da,0xbedae880,0xbe94a031,0xbe164083,0xbecf7bca,0xbe8586ce,0xbde1bc2e,0x3d2fe007
.long 0xbe78cfcc,0xbdafb680,0x3d96a905,0x3e6c9a7f,0xbd96a905,0x3dbc3ac3,0x3e827dc0,0x3ed25a09
.long 0xbef15aea,0xbf08f59b,0xbf187fc0,0xbf273656,0xbf1d7fd1,0xbf2d1469,0xbf3b8f3b,0xbf48d8b3
.long 0xbf3daef9,0xbf4bbbf8,0xbf584853,0xbf633c5a,0xbf584853,0xbf63f473,0xbf6db293,0xbf756d97
.long 0x3dc8bd36,0x3e888e93,0x3edae880,0x3f13682a,0x3e888e93,0x3eddbe79,0x3f15f6d9,0x3f385216
.long 0x3edae880,0x3f15f6d9,0x3f396842,0x3f5695e5,0x3f13682a,0x3f385216,0x3f5695e5,0x3f6d1c1d
.long 0x0,0x0,0x0,0x0,0x0,0x3bc90f88,0x3c490e90,0x3c96c9b6
.long 0x0,0x3c490e90,0x3cc90ab0,0x3d16c32c,0x0,0x3c96c9b6,0x3d16c32c,0x3d621469
.long 0x0,0x3dc8bd36,0x3e47c5c2,0x3e94a031,0x0,0x3dd53db9,0x3e541501,0x3e9d9e78
.long 0x0,0x3de1bc2e,0x3e605c13,0x3ea68f12,0x0,0x3dee3876,0x3e6c9a7f,0x3eaf713a
.long 0x0,0x3cc90ab0,0x3d48fb30,0x3d96a905,0x0,0x3cfb49ba,0x3d7b2b74,0x3dbc3ac3
.long 0x0,0x3d16c32c,0x3d96a905,0x3de1bc2e,0x0,0x3d2fe007,0x3dafb680,0x3e039502
.long 0x0,0x3dfab273,0x3e78cfcc,0x3eb8442a,0x0,0x3e039502,0x3e827dc0,0x3ec1071e
.long 0x0,0x3e09cf86,0x3e888e93,0x3ec9b953,0x0,0x3e1008b7,0x3e8e9a22,0x3ed25a09
.long 0x0,0x3d48fb30,0x3dc8bd36,0x3e164083,0x0,0x3d621469,0x3de1bc2e,0x3e28defc
.long 0x0,0x3d7b2b74,0x3dfab273,0x3e3b6ecf,0x0,0x3d8a200a,0x3e09cf86,0x3e4dee60
.long 0x0,0x3e164083,0x3e94a031,0x3edae880,0x0,0x3e1c76de,0x3e9aa086,0x3ee363fa
.long 0x0,0x3e22abb6,0x3ea09ae5,0x3eebcbbb,0x0,0x3e28defc,0x3ea68f12,0x3ef41f07
.long 0x0,0x3d96a905,0x3e164083,0x3e605c13,0x0,0x3da3308c,0x3e22abb6,0x3e72b651
.long 0x0,0x3dafb680,0x3e2f10a2,0x3e827dc0,0x0,0x3dbc3ac3,0x3e3b6ecf,0x3e8b9507
.long 0x0,0x3e2f10a2,0x3eac7cd4,0x3efc5d27,0x0,0x3e354098,0x3eb263ef,0x3f0242b1
.long 0x0,0x3e3b6ecf,0x3eb8442a,0x3f064b82,0x0,0x3e419b37,0x3ebe1d4a,0x3f0a48ad
.long 0x0,0x0,0x0,0x0,0x3cc90ab0,0x3cfb49ba,0x3d16c32c,0x3d2fe007
.long 0x3d48fb30,0x3d7b2b74,0x3d96a905,0x3dafb680,0x3d96a905,0x3dbc3ac3,0x3de1bc2e,0x3e039502
.long 0x3ec3ef15,0x3ef15aea,0x3f0e39da,0x3f226799,0x3ecf7bca,0x3eff17b2,0x3f15f6d9,0x3f2ac082
.long 0x3edae880,0x3f064b82,0x3f1d7fd1,0x3f32c8c9,0x3ee63375,0x3f0cead0,0x3f24d225,0x3f3a7ca4
.long 0x3dc8bd36,0x3dfab273,0x3e164083,0x3e2f10a2,0x3dfab273,0x3e1c76de,0x3e3b6ecf,0x3e5a3997
.long 0x3e164083,0x3e3b6ecf,0x3e605c13,0x3e827dc0,0x3e2f10a2,0x3e5a3997,0x3e827dc0,0x3e97a117
.long 0x3ef15aea,0x3f13682a,0x3f2beb4a,0x3f41d870,0x3efc5d27,0x3f19c200,0x3f32c8c9,0x3f48d8b3
.long 0x3f039c3d,0x3f1ff6cb,0x3f396842,0x3f4f7a1f,0x3f08f59b,0x3f26050a,0x3f3fc767,0x3f55b993
.long 0x3e47c5c2,0x3e78cfcc,0x3e94a031,0x3eac7cd4,0x3e605c13,0x3e8b9507,0x3ea68f12,0x3ec1071e
.long 0x3e78cfcc,0x3e9aa086,0x3eb8442a,0x3ed53641,0x3e888e93,0x3ea986c4,0x3ec9b953,0x3ee900b7
.long 0x3f0e39da,0x3f2beb4a,0x3f45e403,0x3f5b941a,0x3f13682a,0x3f31a81d,0x3f4bbbf8,0x3f6106f2
.long 0x3f187fc0,0x3f373a23,0x3f514d3d,0x3f660f88,0x3f1d7fd1,0x3f3ca003,0x3f5695e5,0x3f6aab7b
.long 0x3e94a031,0x3eb8442a,0x3edae880,0x3efc5d27,0x3ea09ae5,0x3ec6d529,0x3eebcbbb,0x3f07a136
.long 0x3eac7cd4,0x3ed53641,0x3efc5d27,0x3f10d3cd,0x3eb8442a,0x3ee363fa,0x3f064b82,0x3f19c200
.long 0x3f226799,0x3f41d870,0x3f5b941a,0x3f6ed89e,0x3f273656,0x3f46e22a,0x3f604621,0x3f7294f8
.long 0x3f2beb4a,0x3f4bbbf8,0x3f64aa59,0x3f75dec6,0x3f3085bb,0x3f5064af,0x3f68bf3c,0x3f78b47b
.long 0x0,0x0,0x0,0x0,0x3d48fb30,0x3d621469,0x3d7b2b74,0x3d8a200a
.long 0x3dc8bd36,0x3de1bc2e,0x3dfab273,0x3e09cf86,0x3e164083,0x3e28defc,0x3e3b6ecf,0x3e4dee60
.long 0x3f3504f3,0x3f45e403,0x3f54db31,0x3f61c598,0x3f3daef9,0x3f4e8d90,0x3f5d2d53,0x3f696591
.long 0x3f45e403,0x3f5695e5,0x3f64aa59,0x3f6ff573,0x3f4d9f02,0x3f5df6be,0x3f6b4b0c,0x3f756d97
.long 0x3e47c5c2,0x3e605c13,0x3e78cfcc,0x3e888e93,0x3e78cfcc,0x3e8b9507,0x3e9aa086,0x3ea986c4
.long 0x3e94a031,0x3ea68f12,0x3eb8442a,0x3ec9b953,0x3eac7cd4,0x3ec1071e,0x3ed53641,0x3ee900b7
.long 0x3f54db31,0x3f64aa59,0x3f710908,0x3f79c79d,0x3f5b941a,0x3f6aab7b,0x3f75dec6,0x3f7cfe73
.long 0x3f61c598,0x3f6ff573,0x3f79c79d,0x3f7f0e58,0x3f676bd8,0x3f748422,0x3f7cbfc9,0x3f7ff4e6
.long 0x3ec3ef15,0x3edae880,0x3ef15aea,0x3f039c3d,0x3edae880,0x3ef41f07,0x3f064b82,0x3f121eb0
.long 0x3ef15aea,0x3f064b82,0x3f13682a,0x3f1ff6cb,0x3f039c3d,0x3f121eb0,0x3f1ff6cb,0x3f2d1469
.long 0x3f6c835e,0x3f7853f8,0x3f7ec46d,0x3f7fb10f,0x3f710908,0x3f7b61fc,0x3f7fd397,0x3f7e4323
.long 0x3f74fa0b,0x3f7dabcc,0x3f7fec43,0x3f7baccd,0x3f7853f8,0x3f7f2f9d,0x3f7f0e58,0x3f77f110
.long 0x3f0e39da,0x3f1d7fd1,0x3f2beb4a,0x3f396842,0x3f187fc0,0x3f286605,0x3f373a23,0x3f44e3f5
.long 0x3f226799,0x3f32c8c9,0x3f41d870,0x3f4f7a1f,0x3f2beb4a,0x3f3ca003,0x3f4bbbf8,0x3f591e6a
.long 0x3f7b14be,0x3f7fec43,0x3f7d3aac,0x3f731447,0x3f7d3aac,0x3f7fe129,0x3f7a7302,0x3f6d1c1d
.long 0x3f7ec46d,0x3f7f0e58,0x3f76ba07,0x3f660f88,0x3f7fb10f,0x3f7d7474,0x3f721352,0x3f5df6be
.long 0x0,0x0,0x0,0x0,0x3d96a905,0x3da3308c,0x3dafb680,0x3dbc3ac3
.long 0x3e164083,0x3e22abb6,0x3e2f10a2,0x3e3b6ecf,0x3e605c13,0x3e72b651,0x3e827dc0,0x3e8b9507
.long 0x3f6c835e,0x3f74fa0b,0x3f7b14be,0x3f7ec46d,0x3f731447,0x3f7a1e84,0x3f7e70b0,0x3f7ffec4
.long 0x3f7853f8,0x3f7dabcc,0x3f7fec43,0x3f7f0e58,0x3f7c3b28,0x3f7f9c18,0x3f7f84ab,0x3f7bf531
.long 0x3e94a031,0x3ea09ae5,0x3eac7cd4,0x3eb8442a,0x3eb8442a,0x3ec6d529,0x3ed53641,0x3ee363fa
.long 0x3edae880,0x3eebcbbb,0x3efc5d27,0x3f064b82,0x3efc5d27,0x3f07a136,0x3f10d3cd,0x3f19c200
.long 0x3f7ec46d,0x3f7fec43,0x3f7d3aac,0x3f76ba07,0x3f7fec43,0x3f7e9bc9,0x3f791298,0x3f6f6830
.long 0x3f7fb10f,0x3f7baccd,0x3f731447,0x3f660f88,0x3f7e1324,0x3f772417,0x3f6b4b0c,0x3f5ac450
.long 0x3f0e39da,0x3f187fc0,0x3f226799,0x3f2beb4a,0x3f1d7fd1,0x3f286605,0x3f32c8c9,0x3f3ca003
.long 0x3f2beb4a,0x3f373a23,0x3f41d870,0x3f4bbbf8,0x3f396842,0x3f44e3f5,0x3f4f7a1f,0x3f591e6a
.long 0x3f7b14be,0x3f710908,0x3f61c598,0x3f4d9f02,0x3f76ba07,0x3f696591,0x3f5695e5,0x3f3ebc1b
.long 0x3f710908,0x3f604621,0x3f49d112,0x3f2e3bde,0x3f6a09a7,0x3f55b993,0x3f3b8f3b,0x3f1c420c
.long 0x3f45e403,0x3f514d3d,0x3f5b941a,0x3f64aa59,0x3f514d3d,0x3f5c61c7,0x3f660f88,0x3f6e46be
.long 0x3f5b941a,0x3f660f88,0x3f6ed89e,0x3f75dec6,0x3f64aa59,0x3f6e46be,0x3f75dec6,0x3f7b61fc
.long 0x3f61c598,0x3f49d112,0x3f2beb4a,0x3f08f59b,0x3f584853,0x3f3ca003,0x3f1b02c6,0x3ee900b7
.long 0x3f4d9f02,0x3f2e3bde,0x3f08f59b,0x3ebe1d4a,0x3f41d870,0x3f1ebc12,0x3eebcbbb,0x3e919ddd
.long 0x0,0x0,0x0,0x0,0x3dc8bd36,0x3dd53db9,0x3de1bc2e,0x3dee3876
.long 0x3e47c5c2,0x3e541501,0x3e605c13,0x3e6c9a7f,0x3e94a031,0x3e9d9e78,0x3ea68f12,0x3eaf713a
.long 0x3f800000,0x3f7ec46d,0x3f7b14be,0x3f74fa0b,0x3f7ec46d,0x3f7ac516,0x3f740bdd,0x3f6aab7b
.long 0x3f7b14be,0x3f740bdd,0x3f6a09a7,0x3f5d2d53,0x3f74fa0b,0x3f6aab7b,0x3f5d2d53,0x3f4cae79
.long 0x3ec3ef15,0x3ecf7bca,0x3edae880,0x3ee63375,0x3ef15aea,0x3eff17b2,0x3f064b82,0x3f0cead0
.long 0x3f0e39da,0x3f15f6d9,0x3f1d7fd1,0x3f24d225,0x3f226799,0x3f2ac082,0x3f32c8c9,0x3f3a7ca4
.long 0x3f6c835e,0x3f5ebe05,0x3f4d9f02,0x3f396842,0x3f61c598,0x3f5064af,0x3f3b8f3b,0x3f239da9
.long 0x3f54db31,0x3f3fc767,0x3f273656,0x3f0b9a6b,0x3f45e403,0x3f2d1469,0x3f10d3cd,0x3ee363fa
.long 0x3f3504f3,0x3f3daef9,0x3f45e403,0x3f4d9f02,0x3f45e403,0x3f4e8d90,0x3f5695e5,0x3f5df6be
.long 0x3f54db31,0x3f5d2d53,0x3f64aa59,0x3f6b4b0c,0x3f61c598,0x3f696591,0x3f6ff573,0x3f756d97
.long 0x3f3504f3,0x3f187fc0,0x3ef15aea,0x3eac7cd4,0x3f226799,0x3f0242b1,0x3ebe1d4a,0x3e667c66
.long 0x3f0e39da,0x3ed53641,0x3e888e93,0x3de1bc2e,0x3ef15aea,0x3ea395c5,0x3e22abb6,0xbbc90f88
.long 0x3f6c835e,0x3f731447,0x3f7853f8,0x3f7c3b28,0x3f74fa0b,0x3f7a1e84,0x3f7dabcc,0x3f7f9c18
.long 0x3f7b14be,0x3f7e70b0,0x3f7fec43,0x3f7f84ab,0x3f7ec46d,0x3f7ffec4,0x3f7f0e58,0x3f7bf531
.long 0x3ec3ef15,0x3e605c13,0x3d48fb30,0xbdfab273,0x3e94a031,0x3dee3876,0xbd7b2b74,0xbe72b651
.long 0x3e47c5c2,0x3c490e90,0xbe2f10a2,0xbeb263ef,0x3dc8bd36,0xbdbc3ac3,0xbe8e9a22,0xbee900b7
.long 0x0,0x0,0x0,0x0,0x3dfab273,0x3e039502,0x3e09cf86,0x3e1008b7
.long 0x3e78cfcc,0x3e827dc0,0x3e888e93,0x3e8e9a22,0x3eb8442a,0x3ec1071e,0x3ec9b953,0x3ed25a09
.long 0x3f6c835e,0x3f61c598,0x3f54db31,0x3f45e403,0x3f5ebe05,0x3f5064af,0x3f3fc767,0x3f2d1469
.long 0x3f4d9f02,0x3f3b8f3b,0x3f273656,0x3f10d3cd,0x3f396842,0x3f239da9,0x3f0b9a6b,0x3ee363fa
.long 0x3ef15aea,0x3efc5d27,0x3f039c3d,0x3f08f59b,0x3f13682a,0x3f19c200,0x3f1ff6cb,0x3f26050a
.long 0x3f2beb4a,0x3f32c8c9,0x3f396842,0x3f3fc767,0x3f41d870,0x3f48d8b3,0x3f4f7a1f,0x3f55b993
.long 0x3f226799,0x3f08f59b,0x3edae880,0x3ea09ae5,0x3f08f59b,0x3ed8106b,0x3e9aa086,0x3e354098
.long 0x3edae880,0x3e9aa086,0x3e2f10a2,0x3d16c32c,0x3ea09ae5,0x3e354098,0x3d16c32c,0xbdd53db9
.long 0x3f54db31,0x3f5b941a,0x3f61c598,0x3f676bd8,0x3f64aa59,0x3f6aab7b,0x3f6ff573,0x3f748422
.long 0x3f710908,0x3f75dec6,0x3f79c79d,0x3f7cbfc9,0x3f79c79d,0x3f7cfe73,0x3f7f0e58,0x3f7ff4e6
.long 0x3e47c5c2,0x3d48fb30,0xbdc8bd36,0xbe78cfcc,0x3d96a905,0xbda3308c,0xbe6c9a7f,0xbec1071e
.long 0xbd48fb30,0xbe541501,0xbeb8442a,0xbf00e7e4,0xbe2f10a2,0xbea986c4,0xbef6e0cb,0xbf1ebc12
.long 0x3f7ec46d,0x3f7fec43,0x3f7fb10f,0x3f7e1324,0x3f7fec43,0x3f7e9bc9,0x3f7baccd,0x3f772417
.long 0x3f7d3aac,0x3f791298,0x3f731447,0x3f6b4b0c,0x3f76ba07,0x3f6f6830,0x3f660f88,0x3f5ac450
.long 0xbe94a031,0xbee63375,0xbf187fc0,0xbf396842,0xbecf7bca,0xbf0f8784,0xbf32c8c9,0xbf5064af
.long 0xbf039c3d,0xbf299415,0xbf49d112,0xbf633c5a,0xbf1d7fd1,0xbf40d0da,0xbf5d2d53,0xbf718f57
.long 0x0,0x0,0x0,0x0,0x3e164083,0x3e1c76de,0x3e22abb6,0x3e28defc
.long 0x3e94a031,0x3e9aa086,0x3ea09ae5,0x3ea68f12,0x3edae880,0x3ee363fa,0x3eebcbbb,0x3ef41f07
.long 0x3f3504f3,0x3f226799,0x3f0e39da,0x3ef15aea,0x3f187fc0,0x3f0242b1,0x3ed53641,0x3ea395c5
.long 0x3ef15aea,0x3ebe1d4a,0x3e888e93,0x3e22abb6,0x3eac7cd4,0x3e667c66,0x3de1bc2e,0xbbc90f88
.long 0x3f0e39da,0x3f13682a,0x3f187fc0,0x3f1d7fd1,0x3f2beb4a,0x3f31a81d,0x3f373a23,0x3f3ca003
.long 0x3f45e403,0x3f4bbbf8,0x3f514d3d,0x3f5695e5,0x3f5b941a,0x3f6106f2,0x3f660f88,0x3f6aab7b
.long 0x3e47c5c2,0x3d96a905,0xbd48fb30,0xbe2f10a2,0x3d48fb30,0xbda3308c,0xbe541501,0xbea986c4
.long 0xbdc8bd36,0xbe6c9a7f,0xbeb8442a,0xbef6e0cb,0xbe78cfcc,0xbec1071e,0xbf00e7e4,0xbf1ebc12
.long 0x3f6c835e,0x3f710908,0x3f74fa0b,0x3f7853f8,0x3f7853f8,0x3f7b61fc,0x3f7dabcc,0x3f7f2f9d
.long 0x3f7ec46d,0x3f7fd397,0x3f7fec43,0x3f7f0e58,0x3f7fb10f,0x3f7e4323,0x3f7baccd,0x3f77f110
.long 0xbec3ef15,0xbf039c3d,0xbf226799,0xbf3daef9,0xbf039c3d,0xbf239da9,0xbf3fc767,0xbf577026
.long 0xbf226799,0xbf3fc767,0xbf584853,0xbf6b4b0c,0xbf3daef9,0xbf577026,0xbf6b4b0c,0xbf78b47b
.long 0x3f7b14be,0x3f76ba07,0x3f710908,0x3f6a09a7,0x3f710908,0x3f696591,0x3f604621,0x3f55b993
.long 0x3f61c598,0x3f5695e5,0x3f49d112,0x3f3b8f3b,0x3f4d9f02,0x3f3ebc1b,0x3f2e3bde,0x3f1c420c
.long 0xbf54db31,0xbf6a09a7,0xbf7853f8,0xbf7f4e6d,0xbf676bd8,0xbf772417,0xbf7f0e58,0xbf7eea9d
.long 0xbf74fa0b,0xbf7e70b0,0xbf7f4e6d,0xbf778bc5,0xbf7d3aac,0xbf7fc38f,0xbf791298,0xbf696591
.long 0x0,0x0,0x0,0x0,0x3e2f10a2,0x3e354098,0x3e3b6ecf,0x3e419b37
.long 0x3eac7cd4,0x3eb263ef,0x3eb8442a,0x3ebe1d4a,0x3efc5d27,0x3f0242b1,0x3f064b82,0x3f0a48ad
.long 0x3ec3ef15,0x3e94a031,0x3e47c5c2,0x3dc8bd36,0x3e605c13,0x3dee3876,0x3c490e90,0xbdbc3ac3
.long 0x3d48fb30,0xbd7b2b74,0xbe2f10a2,0xbe8e9a22,0xbdfab273,0xbe72b651,0xbeb263ef,0xbee900b7
.long 0x3f226799,0x3f273656,0x3f2beb4a,0x3f3085bb,0x3f41d870,0x3f46e22a,0x3f4bbbf8,0x3f5064af
.long 0x3f5b941a,0x3f604621,0x3f64aa59,0x3f68bf3c,0x3f6ed89e,0x3f7294f8,0x3f75dec6,0x3f78b47b
.long 0xbe94a031,0xbecf7bca,0xbf039c3d,0xbf1d7fd1,0xbee63375,0xbf0f8784,0xbf299415,0xbf40d0da
.long 0xbf187fc0,0xbf32c8c9,0xbf49d112,0xbf5d2d53,0xbf396842,0xbf5064af,0xbf633c5a,0xbf718f57
.long 0x3f7b14be,0x3f7d3aac,0x3f7ec46d,0x3f7fb10f,0x3f7fec43,0x3f7fe129,0x3f7f0e58,0x3f7d7474
.long 0x3f7d3aac,0x3f7a7302,0x3f76ba07,0x3f721352,0x3f731447,0x3f6d1c1d,0x3f660f88,0x3f5df6be
.long 0xbf54db31,0xbf676bd8,0xbf74fa0b,0xbf7d3aac,0xbf6a09a7,0xbf772417,0xbf7e70b0,0xbf7fc38f
.long 0xbf7853f8,0xbf7f0e58,0xbf7f4e6d,0xbf791298,0xbf7f4e6d,0xbf7eea9d,0xbf778bc5,0xbf696591
.long 0x3f61c598,0x3f584853,0x3f4d9f02,0x3f41d870,0x3f49d112,0x3f3ca003,0x3f2e3bde,0x3f1ebc12
.long 0x3f2beb4a,0x3f1b02c6,0x3f08f59b,0x3eebcbbb,0x3f08f59b,0x3ee900b7,0x3ebe1d4a,0x3e919ddd
.long 0xbf7ec46d,0xbf76ba07,0xbf676bd8,0xbf514d3d,0xbf76ba07,0xbf66becc,0xbf4f7a1f,0xbf31a81d
.long 0xbf676bd8,0xbf4f7a1f,0xbf3085bb,0xbf0b9a6b,0xbf514d3d,0xbf31a81d,0xbf0b9a6b,0xbec1071e
.long 0x3c00,0x3c00,0x3c00,0x3c00,0x3c008000,0x3c008000,0x3c008000,0x3c008000
.long 0x3c00,0x361f3b64,0x39a839a8,0x3b64361f,0x3c008000,0x3b64b61f,0x39a8b9a8,0x361fbb64
.long 0x3c00,0x39a839a8,0x3c000000,0x39a8b9a8,0x3c008000,0x39a8b9a8,0xbc00,0xb9a8b9a8
.long 0x3c00,0x3b64361f,0x39a8b9a8,0xb61fbb64,0x3c008000,0x361fbb64,0xb9a8b9a8,0xbb64361f
.long 0x3c00,0x3c000000,0xbc00,0xbc008000,0x3c008000,0xbc00,0xbc008000,0x80003c00
.long 0x3c00,0x3b64b61f,0xb9a8b9a8,0xb61f3b64,0x3c008000,0xb61fbb64,0xb9a839a8,0x3b64361f
.long 0x3c00,0x39a8b9a8,0xbc008000,0x39a839a8,0x3c008000,0xb9a8b9a8,0x80003c00,0x39a8b9a8
.long 0x3c00,0x361fbb64,0xb9a839a8,0x3b64b61f,0x3c008000,0xbb64b61f,0x39a839a8,0xb61fbb64
.long 0x3c00,0x3c00,0x3c00,0x3c00,0x3c008000,0x3c008000,0x3c008000,0x3c008000
.long 0x3c000000,0x3b64b61f,0x39a8b9a8,0x361fbb64,0xbc00,0xb61fbb64,0xb9a8b9a8,0xbb64b61f
.long 0xbc00,0xb9a8b9a8,0xbc008000,0xb9a839a8,0xbc008000,0xb9a839a8,0x80003c00,0x39a839a8
.long 0xbc008000,0xb61f3b64,0x39a839a8,0x3b64b61f,0x80003c00,0x3b64361f,0x39a8b9a8,0xb61fbb64
.long 0x3c00,0x3c000000,0xbc00,0xbc008000,0x3c008000,0xbc00,0xbc008000,0x80003c00
.long 0x3c000000,0xb61fbb64,0xb9a839a8,0x3b64361f,0xbc00,0xbb64361f,0x39a839a8,0x361fbb64
.long 0xbc00,0xb9a839a8,0x3c000000,0xb9a8b9a8,0xbc008000,0x39a839a8,0xbc00,0xb9a839a8
.long 0xbc008000,0x3b64361f,0xb9a8b9a8,0x361f3b64,0x80003c00,0x361fbb64,0xb9a839a8,0x3b64b61f
.long 0x3c00,0x3c00,0x3c00,0x3c00,0x3c008000,0x3c008000,0x3c008000,0x3c008000
.long 0xbc00,0xb61fbb64,0xb9a8b9a8,0xbb64b61f,0xbc008000,0xbb64361f,0xb9a839a8,0xb61f3b64
.long 0x3c00,0x39a839a8,0x3c000000,0x39a8b9a8,0x3c008000,0x39a8b9a8,0xbc00,0xb9a8b9a8
.long 0xbc00,0xbb64b61f,0xb9a839a8,0x361f3b64,0xbc008000,0xb61f3b64,0x39a839a8,0x3b64b61f
.long 0x3c00,0x3c000000,0xbc00,0xbc008000,0x3c008000,0xbc00,0xbc008000,0x80003c00
.long 0xbc00,0xbb64361f,0x39a839a8,0x361fbb64,0xbc008000,0x361f3b64,0x39a8b9a8,0xbb64b61f
.long 0x3c00,0x39a8b9a8,0xbc008000,0x39a839a8,0x3c008000,0xb9a8b9a8,0x80003c00,0x39a8b9a8
.long 0xbc00,0xb61f3b64,0x39a8b9a8,0xbb64361f,0xbc008000,0x3b64361f,0xb9a8b9a8,0x361f3b64
.long 0x3c00,0x3c00,0x3c00,0x3c00,0x3c008000,0x3c008000,0x3c008000,0x3c008000
.long 0xbc008000,0xbb64361f,0xb9a839a8,0xb61f3b64,0x80003c00,0x361f3b64,0x39a839a8,0x3b64361f
.long 0xbc00,0xb9a8b9a8,0xbc008000,0xb9a839a8,0xbc008000,0xb9a839a8,0x80003c00,0x39a839a8
.long 0x3c000000,0x361fbb64,0xb9a8b9a8,0xbb64361f,0xbc00,0xbb64b61f,0xb9a839a8,0x361f3b64
.long 0x3c00,0x3c000000,0xbc00,0xbc008000,0x3c008000,0xbc00,0xbc008000,0x80003c00
.long 0xbc008000,0x361f3b64,0x39a8b9a8,0xbb64b61f,0x80003c00,0x3b64b61f,0xb9a8b9a8,0xb61f3b64
.long 0xbc00,0xb9a839a8,0x3c000000,0xb9a8b9a8,0xbc008000,0x39a839a8,0xbc00,0xb9a839a8
.long 0x3c000000,0xbb64b61f,0x39a839a8,0xb61fbb64,0xbc00,0xb61f3b64,0x39a8b9a8,0xbb64361f
.long 0x3c00,0xbc00,0x3c00,0xbc00,0x3c008000,0xbc008000,0x3c008000,0xbc008000
.long 0x3c00,0xb61fbb64,0x39a839a8,0xbb64b61f,0x3c008000,0xbb64361f,0x39a8b9a8,0xb61f3b64
.long 0x3c00,0xb9a8b9a8,0x3c000000,0xb9a839a8,0x3c008000,0xb9a839a8,0xbc00,0x39a839a8
.long 0x3c00,0xbb64b61f,0x39a8b9a8,0x361f3b64,0x3c008000,0xb61f3b64,0xb9a8b9a8,0x3b64b61f
.long 0x3c00,0xbc008000,0xbc00,0x3c000000,0x3c008000,0x80003c00,0xbc008000,0xbc00
.long 0x3c00,0xbb64361f,0xb9a8b9a8,0x361fbb64,0x3c008000,0x361f3b64,0xb9a839a8,0xbb64b61f
.long 0x3c00,0xb9a839a8,0xbc008000,0xb9a8b9a8,0x3c008000,0x39a839a8,0x80003c00,0xb9a839a8
.long 0x3c00,0xb61f3b64,0xb9a839a8,0xbb64361f,0x3c008000,0x3b64361f,0x39a839a8,0x361f3b64
.long 0x3c00,0xbc00,0x3c00,0xbc00,0x3c008000,0xbc008000,0x3c008000,0xbc008000
.long 0x3c000000,0xbb64361f,0x39a8b9a8,0xb61f3b64,0xbc00,0x361f3b64,0xb9a8b9a8,0x3b64361f
.long 0xbc00,0x39a839a8,0xbc008000,0x39a8b9a8,0xbc008000,0x39a8b9a8,0x80003c00,0xb9a8b9a8
.long 0xbc008000,0x361fbb64,0x39a839a8,0xbb64361f,0x80003c00,0xbb64b61f,0x39a8b9a8,0x361f3b64
.long 0x3c00,0xbc008000,0xbc00,0x3c000000,0x3c008000,0x80003c00,0xbc008000,0xbc00
.long 0x3c000000,0x361f3b64,0xb9a839a8,0xbb64b61f,0xbc00,0x3b64b61f,0x39a839a8,0xb61f3b64
.long 0xbc00,0x39a8b9a8,0x3c000000,0x39a839a8,0xbc008000,0xb9a8b9a8,0xbc00,0x39a8b9a8
.long 0xbc008000,0xbb64b61f,0xb9a8b9a8,0xb61fbb64,0x80003c00,0xb61f3b64,0xb9a839a8,0xbb64361f
.long 0x3c00,0xbc00,0x3c00,0xbc00,0x3c008000,0xbc008000,0x3c008000,0xbc008000
.long 0xbc00,0x361f3b64,0xb9a8b9a8,0x3b64361f,0xbc008000,0x3b64b61f,0xb9a839a8,0x361fbb64
.long 0x3c00,0xb9a8b9a8,0x3c000000,0xb9a839a8,0x3c008000,0xb9a839a8,0xbc00,0x39a839a8
.long 0xbc00,0x3b64361f,0xb9a839a8,0xb61fbb64,0xbc008000,0x361fbb64,0x39a839a8,0xbb64361f
.long 0x3c00,0xbc008000,0xbc00,0x3c000000,0x3c008000,0x80003c00,0xbc008000,0xbc00
.long 0xbc00,0x3b64b61f,0x39a839a8,0xb61f3b64,0xbc008000,0xb61fbb64,0x39a8b9a8,0x3b64361f
.long 0x3c00,0xb9a839a8,0xbc008000,0xb9a8b9a8,0x3c008000,0x39a839a8,0x80003c00,0xb9a839a8
.long 0xbc00,0x361fbb64,0x39a8b9a8,0x3b64b61f,0xbc008000,0xbb64b61f,0xb9a8b9a8,0xb61fbb64
.long 0x3c00,0xbc00,0x3c00,0xbc00,0x3c008000,0xbc008000,0x3c008000,0xbc008000
.long 0xbc008000,0x3b64b61f,0xb9a839a8,0x361fbb64,0x80003c00,0xb61fbb64,0x39a839a8,0xbb64b61f
.long 0xbc00,0x39a839a8,0xbc008000,0x39a8b9a8,0xbc008000,0x39a8b9a8,0x80003c00,0xb9a8b9a8
.long 0x3c000000,0xb61f3b64,0xb9a8b9a8,0x3b64b61f,0xbc00,0x3b64361f,0xb9a839a8,0xb61fbb64
.long 0x3c00,0xbc008000,0xbc00,0x3c000000,0x3c008000,0x80003c00,0xbc008000,0xbc00
.long 0xbc008000,0xb61fbb64,0x39a8b9a8,0x3b64361f,0x80003c00,0xbb64361f,0xb9a8b9a8,0x361fbb64
.long 0xbc00,0x39a8b9a8,0x3c000000,0x39a839a8,0xbc008000,0xb9a8b9a8,0xbc00,0x39a8b9a8
.long 0x3c000000,0x3b64361f,0x39a839a8,0x361f3b64,0xbc00,0x361fbb64,0x39a8b9a8,0x3b64b61f
.long 0x3c00,0x3c00,0x3c00,0x3c00,0x3c00,0xbc00,0x3c00,0xbc00
.long 0x3c00,0x3b64,0x39a8,0x361f,0x8000,0xb61f,0xb9a8,0xbb64
.long 0x3c00,0x39a8,0x0,0xb9a8,0x8000,0xb9a8,0xbc00,0xb9a8
.long 0x3c00,0x361f,0xb9a8,0xbb64,0x8000,0xbb64,0xb9a8,0x361f
.long 0x3c00,0x0,0xbc00,0x8000,0x8000,0xbc00,0x8000,0x3c00
.long 0x3c00,0xb61f,0xb9a8,0x3b64,0x8000,0xbb64,0x39a8,0x361f
.long 0x3c00,0xb9a8,0x8000,0x39a8,0x8000,0xb9a8,0x3c00,0xb9a8
.long 0x3c00,0xbb64,0x39a8,0xb61f,0x8000,0xb61f,0x39a8,0xbb64
.long 0x3c00,0x3c00,0x3c00,0x3c00,0x3c00,0xbc00,0x3c00,0xbc00
.long 0x0,0xb61f,0xb9a8,0xbb64,0xbc00,0xbb64,0xb9a8,0xb61f
.long 0xbc00,0xb9a8,0x8000,0x39a8,0x8000,0x39a8,0x3c00,0x39a8
.long 0x8000,0x3b64,0x39a8,0xb61f,0x3c00,0x361f,0xb9a8,0xbb64
.long 0x3c00,0x0,0xbc00,0x8000,0x8000,0xbc00,0x8000,0x3c00
.long 0x0,0xbb64,0x39a8,0x361f,0xbc00,0x361f,0x39a8,0xbb64
.long 0xbc00,0x39a8,0x0,0xb9a8,0x8000,0x39a8,0xbc00,0x39a8
.long 0x8000,0x361f,0xb9a8,0x3b64,0x3c00,0xbb64,0x39a8,0xb61f
.long 0x3c00,0x3c00,0x3c00,0x3c00,0x3c00,0xbc00,0x3c00,0xbc00
.long 0xbc00,0xbb64,0xb9a8,0xb61f,0x8000,0x361f,0x39a8,0x3b64
.long 0x3c00,0x39a8,0x0,0xb9a8,0x8000,0xb9a8,0xbc00,0xb9a8
.long 0xbc00,0xb61f,0x39a8,0x3b64,0x8000,0x3b64,0x39a8,0xb61f
.long 0x3c00,0x0,0xbc00,0x8000,0x8000,0xbc00,0x8000,0x3c00
.long 0xbc00,0x361f,0x39a8,0xbb64,0x8000,0x3b64,0xb9a8,0xb61f
.long 0x3c00,0xb9a8,0x8000,0x39a8,0x8000,0xb9a8,0x3c00,0xb9a8
.long 0xbc00,0x3b64,0xb9a8,0x361f,0x8000,0x361f,0xb9a8,0x3b64
.long 0x3c00,0x3c00,0x3c00,0x3c00,0x3c00,0xbc00,0x3c00,0xbc00
.long 0x8000,0x361f,0x39a8,0x3b64,0x3c00,0x3b64,0x39a8,0x361f
.long 0xbc00,0xb9a8,0x8000,0x39a8,0x8000,0x39a8,0x3c00,0x39a8
.long 0x0,0xbb64,0xb9a8,0x361f,0xbc00,0xb61f,0x39a8,0x3b64
.long 0x3c00,0x0,0xbc00,0x8000,0x8000,0xbc00,0x8000,0x3c00
.long 0x8000,0x3b64,0xb9a8,0xb61f,0x3c00,0xb61f,0xb9a8,0x3b64
.long 0xbc00,0x39a8,0x0,0xb9a8,0x8000,0x39a8,0xbc00,0x39a8
.long 0x0,0xb61f,0x39a8,0xbb64,0xbc00,0x3b64,0xb9a8,0x361f
.long 0x3c000000,0x3bd90000,0x3b640000,0x3aa70000,0x80000000,0xb23e0000,0xb61f0000,0xb8720000
.long 0x3c000000,0x3aa70000,0x361f0000,0xb23e0000,0x80000000,0xb8720000,0xbb640000,0xbbd90000
.long 0x3c000000,0x38720000,0xb61f0000,0xbbd90000,0x80000000,0xbaa70000,0xbb640000,0xb23e0000
.long 0x3c000000,0x323e0000,0xbb640000,0xb8720000,0x80000000,0xbbd90000,0xb61f0000,0x3aa70000
.long 0x3c000000,0xb23e0000,0xbb640000,0x38720000,0x80000000,0xbbd90000,0x361f0000,0x3aa70000
.long 0x3c000000,0xb8720000,0xb61f0000,0x3bd90000,0x80000000,0xbaa70000,0x3b640000,0xb23e0000
.long 0x3c000000,0xbaa70000,0x361f0000,0x323e0000,0x80000000,0xb8720000,0x3b640000,0xbbd90000
.long 0x3c000000,0xbbd90000,0x3b640000,0xbaa70000,0x80000000,0xb23e0000,0x361f0000,0xb8720000
.long 0x39a80000,0x38720000,0x361f0000,0x323e0000,0xb9a80000,0xbaa70000,0xbb640000,0xbbd90000
.long 0xb9a80000,0xbbd90000,0xbb640000,0xb8720000,0xb9a80000,0xb23e0000,0x361f0000,0x3aa70000
.long 0xb9a80000,0x323e0000,0x3b640000,0x3aa70000,0x39a80000,0x3bd90000,0x361f0000,0xb8720000
.long 0x39a80000,0x3aa70000,0xb61f0000,0xbbd90000,0x39a80000,0xb8720000,0xbb640000,0x323e0000
.long 0x39a80000,0xbaa70000,0xb61f0000,0x3bd90000,0xb9a80000,0xb8720000,0x3b640000,0x323e0000
.long 0xb9a80000,0xb23e0000,0x3b640000,0xbaa70000,0xb9a80000,0x3bd90000,0xb61f0000,0xb8720000
.long 0xb9a80000,0x3bd90000,0xbb640000,0x38720000,0x39a80000,0xb23e0000,0xb61f0000,0x3aa70000
.long 0x39a80000,0xb8720000,0x361f0000,0xb23e0000,0x39a80000,0xbaa70000,0x3b640000,0xbbd90000
.long 0x0,0xb23e0000,0xb61f0000,0xb8720000,0xbc000000,0xbbd90000,0xbb640000,0xbaa70000
.long 0x80000000,0x38720000,0x3b640000,0x3bd90000,0x3c000000,0x3aa70000,0x361f0000,0xb23e0000
.long 0x0,0xbaa70000,0xbb640000,0xb23e0000,0xbc000000,0xb8720000,0x361f0000,0x3bd90000
.long 0x80000000,0x3bd90000,0x361f0000,0xbaa70000,0x3c000000,0x323e0000,0xbb640000,0xb8720000
.long 0x0,0xbbd90000,0x361f0000,0x3aa70000,0xbc000000,0x323e0000,0x3b640000,0xb8720000
.long 0x80000000,0x3aa70000,0xbb640000,0x323e0000,0x3c000000,0xb8720000,0xb61f0000,0x3bd90000
.long 0x80000000,0xb8720000,0x3b640000,0xbbd90000,0xbc000000,0x3aa70000,0xb61f0000,0xb23e0000
.long 0x80000000,0x323e0000,0xb61f0000,0x38720000,0x3c000000,0xbbd90000,0x3b640000,0xbaa70000
.long 0xb9a80000,0xbaa70000,0xbb640000,0xbbd90000,0xb9a80000,0xb8720000,0xb61f0000,0xb23e0000
.long 0x39a80000,0x323e0000,0xb61f0000,0xbaa70000,0xb9a80000,0xbbd90000,0xbb640000,0xb8720000
.long 0x39a80000,0x3bd90000,0x361f0000,0xb8720000,0x39a80000,0xb23e0000,0xbb640000,0xbaa70000
.long 0xb9a80000,0x38720000,0x3b640000,0xb23e0000,0x39a80000,0x3aa70000,0xb61f0000,0xbbd90000
.long 0xb9a80000,0xb8720000,0x3b640000,0x323e0000,0xb9a80000,0x3aa70000,0x361f0000,0xbbd90000
.long 0x39a80000,0xbbd90000,0x361f0000,0x38720000,0xb9a80000,0xb23e0000,0x3b640000,0xbaa70000
.long 0x39a80000,0xb23e0000,0xb61f0000,0x3aa70000,0x39a80000,0xbbd90000,0x3b640000,0xb8720000
.long 0xb9a80000,0x3aa70000,0xbb640000,0x3bd90000,0x39a80000,0xb8720000,0x361f0000,0xb23e0000
.size tables, 20480
all_end:
.section .rodata,"a"
.p2align 6
.amdhsa_kernel adaLN_cond__spectral_fnet__moe_arch_mod__prompt_kernel
  .amdhsa_next_free_vgpr 256
  .amdhsa_next_free_sgpr 84
  .amdhsa_accum_offset 256
  .amdhsa_group_segment_fixed_size 0
  .amdhsa_kernarg_size 120
  .amdhsa_user_sgpr_count 2
  .amdhsa_user_sgpr_kernarg_segment_ptr 1
  .amdhsa_system_sgpr_workgroup_id_x 1
  .amdhsa_float_denorm_mode_32 3
  .amdhsa_float_denorm_mode_16_64 3
.end_amdhsa_kernel
```

```asm
; @launch grid=(256,1,1) block=(512,1,1) lds=163840
.amdgcn_target "amdgcn-amd-amdhsa--gfx950"
.text
.globl adaLN_cond__spectral_fnet__moe_arch_mod__prompt_kernel
.p2align 8
.type adaLN_cond__spectral_fnet__moe_arch_mod__prompt_kernel,@function
adaLN_cond__spectral_fnet__moe_arch_mod__prompt_kernel:
    s_cmp_ge_u32 s2, 256
    s_cbranch_scc1 k_done
    s_load_dwordx2 s[4:5], s[0:1], 0
    s_load_dwordx4 s[24:27], s[0:1], 96
    s_load_dwordx2 s[6:7], s[0:1], 112
    s_load_dwordx4 s[56:59], s[0:1], 80
    s_load_dwordx4 s[48:51], s[0:1], 48
    s_load_dwordx4 s[52:55], s[0:1], 64
    s_memrealtime s[32:33]
    v_lshrrev_b32 v1, 6, v0
    v_and_b32 v2, 63, v0
    v_readfirstlane_b32 s16, v1
    v_lshlrev_b32 v3, 4, v2
    v_mov_b32 v4, 0
    s_getpc_b64 s[36:37]
h_pc:
    s_and_b32 s34, s2, 7
    s_bfe_u32 s35, s2, 0x40003
    s_cmp_lg_u32 s16, 7
    s_cbranch_scc1 h_npf
    s_lshr_b32 s42, s2, 3
    s_lshl_b32 s42, s42, 11
    v_lshl_add_u32 v4, v2, 7, s42
    v_min_u32 v4, all_end-h_pc-4, v4
    s_mov_b64 exec, 0xffff
    global_load_dword v199, v4, s[36:37]
    s_mov_b64 exec, -1
h_npf:
    s_mov_b32 s11, 0x00020000
    s_mov_b32 s14, 268435456
    s_mov_b32 s15, 0x00020000
    s_bitcmp0_b32 s2, 7
    s_cbranch_scc1 g_start
    s_lshl_b32 s60, s16, 19
    s_lshl_b32 s61, s35, 15
    s_add_u32 s60, s60, s61
    s_lshl_b32 s61, s34, 11
    s_add_u32 s60, s60, s61
    s_add_u32 s61, s60, 16384
    s_lshl_b32 s62, s34, 11
    s_lshl_b32 s63, s35, 7
    s_add_u32 s62, s62, s63
    s_add_u32 s63, s62, 16809984
    s_lshl_b32 s42, s16, 4
    s_add_u32 s62, s62, s42
    s_add_u32 s62, s62, 16777216
    v_mov_b32 v116, 0
    s_mov_b32 s10, 4194304
    s_waitcnt lgkmcnt(0)
    s_mov_b32 s8, s4
    s_mov_b32 s9, s5
    s_mov_b32 s12, s6
    s_mov_b32 s13, s7
    buffer_load_dwordx4 v[64:67], v3, s[8:11], s60 offen offset:0
    buffer_load_dwordx4 v[72:75], v3, s[8:11], s61 offen offset:0
    buffer_load_dwordx4 v[68:71], v3, s[8:11], s60 offen offset:1024
    buffer_load_dwordx4 v[76:79], v3, s[8:11], s61 offen offset:1024
    s_mov_b64 exec, 1
    buffer_load_dword v215, v116, s[12:15], s62 offen sc1
    s_mov_b64 exec, -1
    s_branch f_start
h_non:
    s_mul_i32 s42, s32, 0x9e3779b1
    s_lshr_b32 s43, s42, 15
    s_xor_b32 s42, s42, s43
    s_mul_i32 s42, s42, 0x85ebca6b
    s_xor_b32 s33, s33, s42
    s_lshr_b32 s43, s42, 13
    s_xor_b32 s42, s42, s43
    s_mul_i32 s33, s33, 0xc2b2ae35
    s_add_u32 s33, s33, s32
    s_lshr_b32 s43, s33, 16
    s_xor_b32 s33, s33, s43
    s_mul_i32 s33, s33, 0x27d4eb2f
    s_or_b32 s32, s42, 1
    s_andn2_b32 s33, s33, 7
    v_mov_b32 v10, s32
    v_mov_b32 v11, s33
    v_lshlrev_b32 v12, 3, v2
    s_mov_b32 exec_hi, 0
    global_store_dwordx2 v12, v[10:11], s[26:27] sc1
    s_mov_b32 exec_hi, -1
    s_branch h_nonx
g_start:
    s_or_b32 s40, s2, s16
    s_xor_b32 s16, s16, 4
    v_xor_b32 v1, 4, v1
    v_xor_b32 v0, 0x100, v0
    v_lshlrev_b32 v13, 2, v2
    v_mov_b32 v220, 0
    v_mov_b32 v221, 0
    s_cmp_lt_u32 s16, 4
    s_cbranch_scc1 g_cons
g_load:
    s_and_b32 s69, s16, 3
    s_and_b32 s42, s16, 1
    s_lshl_b32 s42, s42, 7
    v_xor_b32 v6, s42, v3
    v_xor_b32 v7, 32, v6
    v_xor_b32 v8, 64, v6
    v_xor_b32 v9, 96, v6
    s_lshl_b32 s41, s35, 3
    s_add_u32 s41, s41, s69
    s_mul_i32 s18, s41, 98304
    s_lshl_b32 s41, s34, 10
    s_cmp_ge_u32 s34, 6
    s_cselect_b32 s42, 2048, 0
    s_add_u32 s18, s18, s41
    s_add_u32 s18, s18, s42
    s_lshl_b32 s68, s69, 13
    s_mov_b32 s10, 12582912
    s_waitcnt lgkmcnt(0)
    s_mov_b32 s8, s58
    s_mov_b32 s9, s59
    s_mov_b32 s12, s6
    s_mov_b32 s13, s7
    s_cmp_eq_u32 s40, 0
    s_cbranch_scc1 h_non
h_nonx:
    s_lshl_b32 s42, s69, 7
    s_add_u32 s42, s42, 139264
    s_mov_b32 m0, s42
    s_lshl_b32 s42, s35, 7
    v_add_u32 v10, s42, v13
    s_mov_b32 exec_hi, 0
    global_load_lds_dword v10, s[56:57]
    s_mov_b32 exec_hi, -1
    s_add_u32 s43, s68, 32768
    s_mov_b32 m0, s43
    s_add_u32 s42, s18, 0
    buffer_load_dwordx4 v6, s[8:11], s42 offen nt lds
    s_add_u32 s43, s68, 33792
    s_mov_b32 m0, s43
    s_add_u32 s42, s18, 12288
    buffer_load_dwordx4 v7, s[8:11], s42 offen nt lds
    s_add_u32 s43, s68, 34816
    s_mov_b32 m0, s43
    s_add_u32 s42, s18, 24576
    buffer_load_dwordx4 v8, s[8:11], s42 offen nt lds
    s_add_u32 s43, s68, 35840
    s_mov_b32 m0, s43
    s_add_u32 s42, s18, 36864
    buffer_load_dwordx4 v9, s[8:11], s42 offen nt lds
    s_add_u32 s43, s68, 36864
    s_mov_b32 m0, s43
    s_add_u32 s42, s18, 49152
    buffer_load_dwordx4 v6, s[8:11], s42 offen nt lds
    s_add_u32 s43, s68, 37888
    s_mov_b32 m0, s43
    s_add_u32 s42, s18, 61440
    buffer_load_dwordx4 v7, s[8:11], s42 offen nt lds
    s_add_u32 s43, s68, 38912
    s_mov_b32 m0, s43
    s_add_u32 s42, s18, 73728
    buffer_load_dwordx4 v8, s[8:11], s42 offen nt lds
    s_add_u32 s43, s68, 39936
    s_mov_b32 m0, s43
    s_add_u32 s42, s18, 86016
    buffer_load_dwordx4 v9, s[8:11], s42 offen nt lds
    s_lshl_b32 s19, s35, 2
    s_add_u32 s19, s19, s69
    s_mul_i32 s19, s19, 196608
    s_lshl_b32 s42, s34, 9
    s_add_u32 s19, s19, s42
    s_and_b32 s42, s34, 4
    s_lshl_b32 s42, s42, 9
    s_add_u32 s19, s19, s42
    s_add_u32 s19, s19, 6144
    v_lshrrev_b32 v5, 5, v2
    v_and_b32 v14, 0x1f0, v3
    v_lshlrev_b32 v12, 5, v5
    v_xor_b32 v14, v14, v12
    s_movk_i32 s42, 12288
    v_mad_u32_u24 v14, v5, s42, v14
    v_bfe_u32 v5, v0, 5, 1
    v_lshlrev_b32 v5, 3, v5
    v_bfe_u32 v12, v0, 3, 2
    v_add_u32 v5, v5, v12
    v_bfe_u32 v12, v0, 4, 2
    v_lshlrev_b32 v12, 1, v12
    v_xor_b32 v12, v12, v0
    v_and_b32 v12, 7, v12
    v_lshlrev_b32 v12, 4, v12
    s_movk_i32 s42, 7168
    v_mad_u32_u24 v5, v5, s42, v12
    s_mov_b32 s20, s26
    s_mov_b32 s21, s27
    s_mov_b32 s26, 4194304
    s_mov_b32 s27, 0x00020000
    s_and_b32 s65, s35, 1
    s_lshr_b32 s40, s35, 1
    s_mul_i32 s64, s34, 7
    s_add_u32 s64, s64, s40
    s_lshl_b32 s41, s34, 1
    s_add_u32 s41, s41, s65
    s_cmp_ge_u32 s35, 14
    s_cselect_b32 s66, 1, 0
    s_cselect_b32 s64, s41, s64
    v_lshrrev_b32 v10, 2, v2
    v_and_b32 v15, 3, v0
    v_bfe_u32 v11, v0, 3, 2
    v_xor_b32 v12, v11, v1
    v_and_b32 v12, 3, v12
    v_lshlrev_b32 v12, 5, v12
    v_lshl_add_u32 v12, v10, 7, v12
    v_lshl_add_u32 v12, v15, 3, v12
    v_lshrrev_b32 v16, 2, v1
    v_lshl_add_u32 v12, v16, 15, v12
    v_add_u32 v21, 65536, v12
    s_lshl_b32 s67, s65, 3
    s_add_u32 s67, s67, s69
    s_mul_i32 s67, s67, 458752
    s_lshl_b32 s42, s64, 7
    s_add_u32 s67, s67, s42
    s_mov_b32 s56, s50
    s_mov_b32 s57, s51
    s_mov_b32 s58, 7340032
    s_mov_b32 s59, 0x00020000
    s_mov_b32 s44, s52
    s_mov_b32 s45, s53
    s_mov_b32 s46, 7340032
    s_mov_b32 s47, 0x00020000
    s_waitcnt vmcnt(7)
    s_add_u32 s43, s68, 65536
    s_mov_b32 m0, s43
    s_add_u32 s42, s18, 393216
    buffer_load_dwordx4 v6, s[8:11], s42 offen nt lds
    s_waitcnt vmcnt(7)
    s_add_u32 s43, s68, 66560
    s_mov_b32 m0, s43
    s_add_u32 s42, s18, 405504
    buffer_load_dwordx4 v7, s[8:11], s42 offen nt lds
    s_load_dwordx2 s[32:33], s[20:21], 128
    s_waitcnt vmcnt(7)
    s_add_u32 s43, s68, 67584
    s_mov_b32 m0, s43
    s_add_u32 s42, s18, 417792
    buffer_load_dwordx4 v8, s[8:11], s42 offen nt lds
    s_waitcnt vmcnt(7)
    s_add_u32 s43, s68, 68608
    s_mov_b32 m0, s43
    s_add_u32 s42, s18, 430080
    buffer_load_dwordx4 v9, s[8:11], s42 offen nt lds
    s_waitcnt vmcnt(7)
    s_add_u32 s43, s68, 69632
    s_mov_b32 m0, s43
    s_add_u32 s42, s18, 442368
    buffer_load_dwordx4 v6, s[8:11], s42 offen nt lds
    s_waitcnt vmcnt(7)
    s_add_u32 s43, s68, 70656
    s_mov_b32 m0, s43
    s_add_u32 s42, s18, 454656
    buffer_load_dwordx4 v7, s[8:11], s42 offen nt lds
    s_waitcnt vmcnt(7)
    s_add_u32 s43, s68, 71680
    s_mov_b32 m0, s43
    s_add_u32 s42, s18, 466944
    buffer_load_dwordx4 v8, s[8:11], s42 offen nt lds
    s_waitcnt vmcnt(7)
    s_barrier
    s_add_u32 s43, s68, 72704
    s_mov_b32 m0, s43
    s_add_u32 s42, s18, 479232
    buffer_load_dwordx4 v9, s[8:11], s42 offen nt lds
    s_waitcnt lgkmcnt(0)
    s_cmp_lg_u32 s32, 0
    s_cbranch_scc1 g_n2x
    s_load_dwordx2 s[32:33], s[20:21], 192
    s_mov_b32 s83, 0
    v_mov_b32 v122, 0
    s_waitcnt lgkmcnt(0)
g_n2:
    s_cmp_lg_u32 s32, 0
    s_cbranch_scc1 g_n2x
    global_load_dwordx2 v[120:121], v122, s[20:21] sc1
    s_waitcnt vmcnt(0)
    v_readfirstlane_b32 s32, v120
    v_readfirstlane_b32 s33, v121
    s_add_u32 s83, s83, 1
    s_cmp_lt_u32 s83, 0x40000
    s_cbranch_scc1 g_n2
g_n2x:
    s_cmp_eq_u32 s66, 0
    s_cbranch_scc1 m_load
    s_waitcnt vmcnt(0)
    s_barrier
    s_barrier
    s_branch x_start
m_load:
    s_waitcnt vmcnt(0)
    s_barrier
    s_barrier
    s_waitcnt vmcnt(7)
    v_xor_b32 v4, 0, v14
    s_add_u32 s43, s68, 98304
    s_mov_b32 m0, s43
    s_add_u32 s42, s19, 0
    buffer_load_dwordx4 v4, s[8:11], s42 offen nt lds
    s_waitcnt vmcnt(7)
    v_xor_b32 v4, 64, v14
    s_add_u32 s43, s68, 99328
    s_mov_b32 m0, s43
    s_add_u32 s42, s19, 24576
    buffer_load_dwordx4 v4, s[8:11], s42 offen nt lds
    s_waitcnt vmcnt(7)
    v_xor_b32 v4, 0, v14
    s_add_u32 s43, s68, 100352
    s_mov_b32 m0, s43
    s_add_u32 s42, s19, 49152
    buffer_load_dwordx4 v4, s[8:11], s42 offen nt lds
    s_waitcnt vmcnt(7)
    v_xor_b32 v4, 64, v14
    s_add_u32 s43, s68, 101376
    s_mov_b32 m0, s43
    s_add_u32 s42, s19, 73728
    buffer_load_dwordx4 v4, s[8:11], s42 offen nt lds
    s_waitcnt vmcnt(7)
    v_xor_b32 v4, 128, v14
    s_add_u32 s43, s68, 102400
    s_mov_b32 m0, s43
    s_add_u32 s42, s19, 98304
    buffer_load_dwordx4 v4, s[8:11], s42 offen nt lds
    s_waitcnt vmcnt(7)
    v_xor_b32 v4, 192, v14
    s_add_u32 s43, s68, 103424
    s_mov_b32 m0, s43
    s_add_u32 s42, s19, 122880
    buffer_load_dwordx4 v4, s[8:11], s42 offen nt lds
    s_waitcnt vmcnt(7)
    v_xor_b32 v4, 128, v14
    s_add_u32 s43, s68, 104448
    s_mov_b32 m0, s43
    s_add_u32 s42, s19, 147456
    buffer_load_dwordx4 v4, s[8:11], s42 offen nt lds
    s_waitcnt vmcnt(7)
    v_xor_b32 v4, 192, v14
    s_add_u32 s43, s68, 105472
    s_mov_b32 m0, s43
    s_add_u32 s42, s19, 172032
    buffer_load_dwordx4 v4, s[8:11], s42 offen nt lds
    s_waitcnt vmcnt(7)
    s_add_u32 s43, s68, 0
    s_mov_b32 m0, s43
    s_add_u32 s42, s67, 0
    buffer_load_dwordx4 v5, s[56:59], s42 offen nt lds
    s_waitcnt vmcnt(7)
    s_add_u32 s43, s68, 1024
    s_mov_b32 m0, s43
    s_add_u32 s42, s67, 114688
    buffer_load_dwordx4 v5, s[56:59], s42 offen nt lds
    s_waitcnt vmcnt(7)
    s_add_u32 s43, s68, 2048
    s_mov_b32 m0, s43
    s_add_u32 s42, s67, 28672
    buffer_load_dwordx4 v5, s[56:59], s42 offen nt lds
    s_waitcnt vmcnt(7)
    s_add_u32 s43, s68, 3072
    s_mov_b32 m0, s43
    s_add_u32 s42, s67, 143360
    buffer_load_dwordx4 v5, s[56:59], s42 offen nt lds
    s_waitcnt vmcnt(4)
    s_barrier
    s_barrier
    s_waitcnt vmcnt(7)
    s_add_u32 s43, s68, 4096
    s_mov_b32 m0, s43
    s_add_u32 s42, s67, 229376
    buffer_load_dwordx4 v5, s[56:59], s42 offen nt lds
    s_waitcnt vmcnt(7)
    s_add_u32 s43, s68, 5120
    s_mov_b32 m0, s43
    s_add_u32 s42, s67, 344064
    buffer_load_dwordx4 v5, s[56:59], s42 offen nt lds
    s_waitcnt vmcnt(7)
    s_add_u32 s43, s68, 6144
    s_mov_b32 m0, s43
    s_add_u32 s42, s67, 258048
    buffer_load_dwordx4 v5, s[56:59], s42 offen nt lds
    s_waitcnt vmcnt(7)
    s_add_u32 s43, s68, 7168
    s_mov_b32 m0, s43
    s_add_u32 s42, s67, 372736
    buffer_load_dwordx4 v5, s[56:59], s42 offen nt lds
    s_waitcnt vmcnt(9)
    s_add_u32 s43, s68, 32768
    s_mov_b32 m0, s43
    s_add_u32 s42, s67, 1835008
    buffer_load_dwordx4 v5, s[56:59], s42 offen nt lds
    s_waitcnt vmcnt(9)
    s_add_u32 s43, s68, 33792
    s_mov_b32 m0, s43
    s_add_u32 s42, s67, 1949696
    buffer_load_dwordx4 v5, s[56:59], s42 offen nt lds
    s_waitcnt vmcnt(9)
    s_add_u32 s43, s68, 34816
    s_mov_b32 m0, s43
    s_add_u32 s42, s67, 1863680
    buffer_load_dwordx4 v5, s[56:59], s42 offen nt lds
    s_waitcnt vmcnt(9)
    s_add_u32 s43, s68, 35840
    s_mov_b32 m0, s43
    s_add_u32 s42, s67, 1978368
    buffer_load_dwordx4 v5, s[56:59], s42 offen nt lds
    s_waitcnt vmcnt(9)
    s_add_u32 s43, s68, 36864
    s_mov_b32 m0, s43
    s_add_u32 s42, s67, 2064384
    buffer_load_dwordx4 v5, s[56:59], s42 offen nt lds
    s_waitcnt vmcnt(9)
    s_add_u32 s43, s68, 37888
    s_mov_b32 m0, s43
    s_add_u32 s42, s67, 2179072
    buffer_load_dwordx4 v5, s[56:59], s42 offen nt lds
    s_waitcnt vmcnt(9)
    s_add_u32 s43, s68, 38912
    s_mov_b32 m0, s43
    s_add_u32 s42, s67, 2093056
    buffer_load_dwordx4 v5, s[56:59], s42 offen nt lds
    s_waitcnt vmcnt(9)
    s_add_u32 s43, s68, 39936
    s_mov_b32 m0, s43
    s_add_u32 s42, s67, 2207744
    buffer_load_dwordx4 v5, s[56:59], s42 offen nt lds
    s_waitcnt vmcnt(9)
    s_add_u32 s43, s68, 65536
    s_mov_b32 m0, s43
    s_add_u32 s42, s67, 0
    buffer_load_dwordx4 v5, s[44:47], s42 offen nt lds
    s_waitcnt vmcnt(9)
    s_barrier
    s_add_u32 s43, s68, 66560
    s_mov_b32 m0, s43
    s_add_u32 s42, s67, 114688
    buffer_load_dwordx4 v5, s[44:47], s42 offen nt lds
    s_waitcnt vmcnt(9)
    s_add_u32 s43, s68, 67584
    s_mov_b32 m0, s43
    s_add_u32 s42, s67, 28672
    buffer_load_dwordx4 v5, s[44:47], s42 offen nt lds
    s_waitcnt vmcnt(9)
    s_add_u32 s43, s68, 68608
    s_mov_b32 m0, s43
    s_add_u32 s42, s67, 143360
    buffer_load_dwordx4 v5, s[44:47], s42 offen nt lds
    s_waitcnt vmcnt(9)
    s_add_u32 s43, s68, 69632
    s_mov_b32 m0, s43
    s_add_u32 s42, s67, 229376
    buffer_load_dwordx4 v5, s[44:47], s42 offen nt lds
    s_waitcnt vmcnt(9)
    s_add_u32 s43, s68, 70656
    s_mov_b32 m0, s43
    s_add_u32 s42, s67, 344064
    buffer_load_dwordx4 v5, s[44:47], s42 offen nt lds
    s_waitcnt vmcnt(9)
    s_add_u32 s43, s68, 71680
    s_mov_b32 m0, s43
    s_add_u32 s42, s67, 258048
    buffer_load_dwordx4 v5, s[44:47], s42 offen nt lds
    s_waitcnt vmcnt(9)
    s_add_u32 s43, s68, 72704
    s_mov_b32 m0, s43
    s_add_u32 s42, s67, 372736
    buffer_load_dwordx4 v5, s[44:47], s42 offen nt lds
    s_waitcnt vmcnt(9)
    s_add_u32 s43, s68, 98304
    s_mov_b32 m0, s43
    s_add_u32 s42, s67, 1835008
    buffer_load_dwordx4 v5, s[44:47], s42 offen nt lds
    s_waitcnt vmcnt(9)
    s_barrier
    ds_read_b64_tr_b16 v[64:65], v12 offset:0
    ds_read_b64_tr_b16 v[66:67], v12 offset:2048
    ds_read_b64_tr_b16 v[68:69], v12 offset:4096
    ds_read_b64_tr_b16 v[70:71], v12 offset:6144
    ds_read_b64_tr_b16 v[72:73], v12 offset:8192
    ds_read_b64_tr_b16 v[74:75], v12 offset:10240
    ds_read_b64_tr_b16 v[76:77], v12 offset:12288
    ds_read_b64_tr_b16 v[78:79], v12 offset:14336
    ds_read_b64_tr_b16 v[80:81], v12 offset:16384
    ds_read_b64_tr_b16 v[82:83], v12 offset:18432
    ds_read_b64_tr_b16 v[84:85], v12 offset:20480
    ds_read_b64_tr_b16 v[86:87], v12 offset:22528
    ds_read_b64_tr_b16 v[88:89], v12 offset:24576
    ds_read_b64_tr_b16 v[90:91], v12 offset:26624
    ds_read_b64_tr_b16 v[92:93], v12 offset:28672
    ds_read_b64_tr_b16 v[94:95], v12 offset:30720
    s_add_u32 s43, s68, 99328
    s_mov_b32 m0, s43
    s_add_u32 s42, s67, 1949696
    buffer_load_dwordx4 v5, s[44:47], s42 offen nt lds
    s_waitcnt vmcnt(9)
    s_add_u32 s43, s68, 100352
    s_mov_b32 m0, s43
    s_add_u32 s42, s67, 1863680
    buffer_load_dwordx4 v5, s[44:47], s42 offen nt lds
    s_waitcnt vmcnt(9)
    s_add_u32 s43, s68, 101376
    s_mov_b32 m0, s43
    s_add_u32 s42, s67, 1978368
    buffer_load_dwordx4 v5, s[44:47], s42 offen nt lds
    s_waitcnt vmcnt(9)
    s_add_u32 s43, s68, 102400
    s_mov_b32 m0, s43
    s_add_u32 s42, s67, 2064384
    buffer_load_dwordx4 v5, s[44:47], s42 offen nt lds
    s_waitcnt vmcnt(9)
    s_add_u32 s43, s68, 103424
    s_mov_b32 m0, s43
    s_add_u32 s42, s67, 2179072
    buffer_load_dwordx4 v5, s[44:47], s42 offen nt lds
    s_waitcnt vmcnt(9)
    s_add_u32 s43, s68, 104448
    s_mov_b32 m0, s43
    s_add_u32 s42, s67, 2093056
    buffer_load_dwordx4 v5, s[44:47], s42 offen nt lds
    s_waitcnt vmcnt(9)
    s_add_u32 s43, s68, 105472
    s_mov_b32 m0, s43
    s_add_u32 s42, s67, 2207744
    buffer_load_dwordx4 v5, s[44:47], s42 offen nt lds
    s_branch m_join
g_cons:
    s_lshl_b32 s29, s34, 4
    s_add_u32 s29, s29, s35
    s_lshl_b32 s29, s29, 12
    s_add_u32 s29, s29, 19922944
    s_lshl_b32 s30, s16, 9
    s_add_u32 s30, s30, s29
    s_lshl_b32 s31, s16, 8
    s_add_u32 s31, s31, s29
    s_add_u32 s31, s31, 2048
    v_lshlrev_b32 v8, 1, v2
    v_lshlrev_b32 v9, 7, v2
    v_mov_b32 v104, -1
    v_mov_b32 v105, -1
    v_mov_b32 v106, -1
    v_mov_b32 v107, -1
    s_waitcnt lgkmcnt(0)
    s_mov_b32 s12, s6
    s_mov_b32 s13, s7
    s_cmp_eq_u32 s16, 1
    s_cselect_b64 exec, 0xffffff, 1
    buffer_load_dword v245, v9, s[12:15], s29 offen sc1
    s_mov_b64 exec, -1
    v_mov_b32 v14, 0
    s_mov_b32 s8, s58
    s_mov_b32 s9, s59
    s_mov_b32 s10, 12582912
    s_mov_b32 s11, 0x00020000
    s_mov_b32 s20, s26
    s_mov_b32 s21, s27
    s_mov_b32 s26, 4194304
    s_mov_b32 s27, 0x00020000
    s_and_b32 s65, s35, 1
    s_lshr_b32 s40, s35, 1
    s_mul_i32 s64, s34, 7
    s_add_u32 s64, s64, s40
    s_lshl_b32 s41, s34, 1
    s_add_u32 s41, s41, s65
    s_cmp_ge_u32 s35, 14
    s_cselect_b32 s66, 1, 0
    s_cselect_b32 s64, s41, s64
    v_lshrrev_b32 v10, 2, v2
    v_and_b32 v15, 3, v0
    v_bfe_u32 v11, v0, 3, 2
    v_xor_b32 v12, v11, v1
    v_and_b32 v12, 3, v12
    v_lshlrev_b32 v12, 5, v12
    v_lshl_add_u32 v12, v10, 7, v12
    v_lshl_add_u32 v12, v15, 3, v12
    v_lshrrev_b32 v16, 2, v1
    v_lshl_add_u32 v12, v16, 15, v12
    v_add_u32 v21, 65536, v12
    v_bfe_u32 v22, v0, 2, 3
    v_lshlrev_b32 v22, 5, v22
    v_lshl_add_u32 v22, v15, 3, v22
    v_bfe_u32 v23, v0, 2, 2
    v_bfe_u32 v24, v0, 4, 2
    v_lshl_add_u32 v23, v24, 3, v23
    v_lshl_add_u32 v200, v23, 10, v22
    v_lshl_add_u32 v200, v1, 8, v200
    v_add_u32 v200, 32768, v200
    v_lshlrev_b32 v25, 7, v1
    v_xor_b32 v22, v22, v25
    v_lshl_add_u32 v208, v23, 9, v22
    v_add_u32 v208, 98304, v208
    v_cmp_eq_u32 s[60:61], 1, v24
    v_cmp_eq_u32 s[62:63], 2, v24
    v_cmp_eq_u32 s[72:73], 3, v24
    v_add_u32 v8, v8, v25
    v_add_u32 v8, 139264, v8
    v_lshl_add_u32 v10, v24, 4, v25
    v_add_u32 v10, 139264, v10
    v_xor_b32 v201, 32, v200
    v_xor_b32 v202, 64, v200
    v_xor_b32 v203, 96, v200
    v_xor_b32 v204, 128, v200
    v_xor_b32 v205, 160, v200
    v_xor_b32 v206, 192, v200
    v_xor_b32 v207, 224, v200
    v_xor_b32 v209, 32, v208
    v_xor_b32 v210, 64, v208
    v_xor_b32 v211, 96, v208
    s_sleep 8
    s_load_dwordx2 s[32:33], s[20:21], 128
    s_waitcnt lgkmcnt(0)
    s_cmp_lg_u32 s32, 0
    s_cbranch_scc1 g_nnx
    s_load_dwordx2 s[32:33], s[20:21], 192
    s_mov_b32 s83, 0
    v_mov_b32 v114, 0
    s_waitcnt lgkmcnt(0)
g_nn:
    s_cmp_lg_u32 s32, 0
    s_cbranch_scc1 g_nnx
    global_load_dwordx2 v[112:113], v114, s[20:21] sc1
    s_waitcnt vmcnt(0)
    v_readfirstlane_b32 s32, v112
    v_readfirstlane_b32 s33, v113
    s_add_u32 s83, s83, 1
    s_cmp_lt_u32 s83, 0x40000
    s_cbranch_scc1 g_nn
g_nnx:
    v_mov_b32 v212, s32
    v_mov_b32 v213, s33
    v_and_b32 v214, 7, v0
    v_lshlrev_b32 v214, 3, v214
    v_lshrrev_b64 v[212:213], v214, v[212:213]
    v_and_b32 v212, 0xff, v212
    s_movk_i32 s74, 0xff00
    s_lshr_b32 s22, s64, 2
    s_lshl_b32 s22, s22, 12
    s_and_b32 s42, s64, 1
    s_lshl_b32 s42, s42, 8
    s_add_u32 s22, s22, s42
    s_and_b32 s42, s64, 2
    s_lshl_b32 s42, s42, 5
    s_add_u32 s22, s22, s42
    s_add_u32 s22, s22, 16875520
    s_lshr_b32 s23, s64, 3
    s_lshl_b32 s23, s23, 12
    s_and_b32 s42, s64, 3
    s_lshl_b32 s42, s42, 7
    s_add_u32 s23, s23, s42
    s_and_b32 s42, s64, 4
    s_lshl_b32 s42, s42, 4
    s_add_u32 s23, s23, s42
    s_add_u32 s23, s23, 16896000
    v_bfe_u32 v24, v0, 2, 1
    v_bfe_u32 v25, v0, 3, 2
    v_bfe_u32 v26, v0, 5, 1
    v_lshlrev_b32 v220, 4, v15
    v_lshl_add_u32 v220, v24, 9, v220
    v_lshl_add_u32 v220, v25, 10, v220
    v_lshl_add_u32 v220, v26, 7, v220
    v_lshlrev_b32 v221, 7, v15
    v_lshl_add_u32 v221, v24, 6, v221
    v_lshl_add_u32 v221, v25, 4, v221
    v_lshl_add_u32 v221, v26, 9, v221
    s_lshl_b32 s79, s64, 7
    s_add_u32 s79, s79, 16850944
    s_cmp_ge_u32 s16, s66
    s_cbranch_scc1 g_nw
    s_mov_b32 s44, s48
    s_mov_b32 s45, s49
    s_mov_b32 s46, 2048
    s_mov_b32 s47, 0x00020000
    v_lshrrev_b32 v11, 1, v221
    s_and_b32 s42, s64, 3
    s_lshl_b32 s42, s42, 9
    buffer_load_dwordx2 v[52:53], v11, s[44:47], s42 offen
    v_mov_b32 v216, s32
    v_mov_b32 v217, s33
    v_and_b32 v218, 1, v0
    v_cmp_eq_u32 vcc, 1, v218
    s_nop 1
    v_cndmask_b32 v216, v216, v217, vcc
    v_bfe_u32 v217, v216, 8, 8
    v_bfe_u32 v218, v216, 16, 8
    v_lshrrev_b32 v219, 24, v216
    v_and_b32 v216, 0xff, v216
    v_not_b32 v24, v216
    v_not_b32 v25, v217
    v_not_b32 v26, v218
    v_not_b32 v27, v219
    buffer_store_dwordx4 v[24:27], v220, s[12:15], s22 offen sc1
    s_add_u32 s42, s22, 4096
    s_cmp_ge_u32 s64, 12
    s_cselect_b32 s42, s42, s22
    buffer_store_dwordx4 v[24:27], v220, s[12:15], s42 offen sc1
    s_mov_b32 exec_hi, 0
    buffer_store_dwordx4 v[24:27], v220, s[12:15], s23 offen sc1
    s_mov_b64 exec, 0xff
    buffer_store_dwordx4 v[104:107], v3, s[12:15], s79 offen sc1
    s_mov_b64 exec, -1
g_nw:
    s_barrier
    ds_read_u16 v6, v8
    s_waitcnt lgkmcnt(0)
    v_lshlrev_b32 v6, 16, v6
    v_mul_f32 v24, 0xbfb8aa3b, v6
    v_exp_f32 v24, v24
    s_nop 0
    v_add_f32 v24, 1.0, v24
    v_rcp_f32 v24, v24
    s_nop 0
    v_mul_f32 v6, v6, v24
    v_cvt_pk_bf16_f32 v6, v6, v6
    ds_write_b16 v8, v6
    ds_read_b128 v[120:123], v10
    ds_read_b128 v[124:127], v10 offset:64
    ds_read_b64_tr_b16 v[128:129], v200 offset:0
    ds_read_b64_tr_b16 v[130:131], v200 offset:4096
    ds_read_b64_tr_b16 v[132:133], v201 offset:0
    ds_read_b64_tr_b16 v[134:135], v201 offset:4096
    ds_read_b64_tr_b16 v[136:137], v202 offset:0
    ds_read_b64_tr_b16 v[138:139], v202 offset:4096
    ds_read_b64_tr_b16 v[140:141], v203 offset:0
    ds_read_b64_tr_b16 v[142:143], v203 offset:4096
    ds_read_b64_tr_b16 v[144:145], v204 offset:0
    ds_read_b64_tr_b16 v[146:147], v204 offset:4096
    ds_read_b64_tr_b16 v[148:149], v205 offset:0
    ds_read_b64_tr_b16 v[150:151], v205 offset:4096
    ds_read_b64_tr_b16 v[152:153], v206 offset:0
    ds_read_b64_tr_b16 v[154:155], v206 offset:4096
    s_waitcnt lgkmcnt(12)
    v_mfma_f32_16x16x32_bf16 v[64:67], v[120:123], v[128:131], 0
    ds_read_b64_tr_b16 v[156:157], v207 offset:0
    ds_read_b64_tr_b16 v[158:159], v207 offset:4096
    s_waitcnt lgkmcnt(12)
    v_mfma_f32_16x16x32_bf16 v[68:71], v[120:123], v[132:135], 0
    s_waitcnt lgkmcnt(10)
    v_mfma_f32_16x16x32_bf16 v[72:75], v[120:123], v[136:139], 0
    s_waitcnt lgkmcnt(8)
    v_mfma_f32_16x16x32_bf16 v[76:79], v[120:123], v[140:143], 0
    s_waitcnt lgkmcnt(6)
    v_mfma_f32_16x16x32_bf16 v[80:83], v[120:123], v[144:147], 0
    s_waitcnt lgkmcnt(4)
    v_mfma_f32_16x16x32_bf16 v[84:87], v[120:123], v[148:151], 0
    s_waitcnt lgkmcnt(2)
    v_mfma_f32_16x16x32_bf16 v[88:91], v[120:123], v[152:155], 0
    s_waitcnt lgkmcnt(0)
    v_mfma_f32_16x16x32_bf16 v[92:95], v[120:123], v[156:159], 0
    s_barrier
    ds_read_b64_tr_b16 v[128:129], v200 offset:32768
    ds_read_b64_tr_b16 v[130:131], v200 offset:36864
    ds_read_b64_tr_b16 v[132:133], v201 offset:32768
    ds_read_b64_tr_b16 v[134:135], v201 offset:36864
    ds_read_b64_tr_b16 v[136:137], v202 offset:32768
    ds_read_b64_tr_b16 v[138:139], v202 offset:36864
    ds_read_b64_tr_b16 v[140:141], v203 offset:32768
    ds_read_b64_tr_b16 v[142:143], v203 offset:36864
    ds_read_b64_tr_b16 v[144:145], v204 offset:32768
    ds_read_b64_tr_b16 v[146:147], v204 offset:36864
    ds_read_b64_tr_b16 v[148:149], v205 offset:32768
    ds_read_b64_tr_b16 v[150:151], v205 offset:36864
    ds_read_b64_tr_b16 v[152:153], v206 offset:32768
    ds_read_b64_tr_b16 v[154:155], v206 offset:36864
    s_waitcnt lgkmcnt(12)
    v_mfma_f32_16x16x32_bf16 v[64:67], v[124:127], v[128:131], v[64:67]
    ds_read_b64_tr_b16 v[156:157], v207 offset:32768
    ds_read_b64_tr_b16 v[158:159], v207 offset:36864
    s_waitcnt lgkmcnt(12)
    v_mfma_f32_16x16x32_bf16 v[68:71], v[124:127], v[132:135], v[68:71]
    s_waitcnt lgkmcnt(10)
    v_mfma_f32_16x16x32_bf16 v[72:75], v[124:127], v[136:139], v[72:75]
    s_waitcnt lgkmcnt(8)
    v_mfma_f32_16x16x32_bf16 v[76:79], v[124:127], v[140:143], v[76:79]
    s_waitcnt lgkmcnt(6)
    v_mfma_f32_16x16x32_bf16 v[80:83], v[124:127], v[144:147], v[80:83]
    s_waitcnt lgkmcnt(4)
    v_mfma_f32_16x16x32_bf16 v[84:87], v[124:127], v[148:151], v[84:87]
    s_waitcnt lgkmcnt(2)
    v_mfma_f32_16x16x32_bf16 v[88:91], v[124:127], v[152:155], v[88:91]
    s_waitcnt lgkmcnt(0)
    v_mfma_f32_16x16x32_bf16 v[92:95], v[124:127], v[156:159], v[92:95]
    v_cndmask_b32 v64, v64, v68, s[60:61]
    v_cndmask_b32 v64, v64, v72, s[62:63]
    v_cndmask_b32 v64, v64, v76, s[72:73]
    v_and_or_b32 v224, v64, s74, v212
    v_cndmask_b32 v80, v80, v84, s[60:61]
    s_nop 0
    v_cndmask_b32 v80, v80, v88, s[62:63]
    s_nop 0
    v_cndmask_b32 v80, v80, v92, s[72:73]
    v_and_or_b32 v225, v80, s74, v212
    buffer_store_dword v224, v13, s[12:15], s30 offen offset:0
    buffer_store_dword v225, v13, s[12:15], s30 offen offset:256
    s_barrier
    s_cmp_eq_u32 s66, 1
    s_cbranch_scc1 x_start
    s_barrier
    ds_read_b64_tr_b16 v[128:129], v208 offset:0
    ds_read_b64_tr_b16 v[130:131], v208 offset:2048
    ds_read_b64_tr_b16 v[132:133], v209 offset:0
    ds_read_b64_tr_b16 v[134:135], v209 offset:2048
    ds_read_b64_tr_b16 v[136:137], v210 offset:0
    ds_read_b64_tr_b16 v[138:139], v210 offset:2048
    ds_read_b64_tr_b16 v[140:141], v211 offset:0
    ds_read_b64_tr_b16 v[142:143], v211 offset:2048
    ds_read_b64_tr_b16 v[144:145], v208 offset:16384
    ds_read_b64_tr_b16 v[146:147], v208 offset:18432
    ds_read_b64_tr_b16 v[148:149], v209 offset:16384
    ds_read_b64_tr_b16 v[150:151], v209 offset:18432
    ds_read_b64_tr_b16 v[152:153], v210 offset:16384
    ds_read_b64_tr_b16 v[154:155], v210 offset:18432
    s_waitcnt lgkmcnt(12)
    v_mfma_f32_16x16x32_bf16 v[64:67], v[120:123], v[128:131], 0
    ds_read_b64_tr_b16 v[156:157], v211 offset:16384
    ds_read_b64_tr_b16 v[158:159], v211 offset:18432
    s_waitcnt lgkmcnt(12)
    v_mfma_f32_16x16x32_bf16 v[68:71], v[120:123], v[132:135], 0
    s_waitcnt lgkmcnt(10)
    v_mfma_f32_16x16x32_bf16 v[72:75], v[120:123], v[136:139], 0
    s_waitcnt lgkmcnt(8)
    v_mfma_f32_16x16x32_bf16 v[76:79], v[120:123], v[140:143], 0
    s_waitcnt lgkmcnt(6)
    v_mfma_f32_16x16x32_bf16 v[64:67], v[124:127], v[144:147], v[64:67]
    s_waitcnt lgkmcnt(4)
    v_mfma_f32_16x16x32_bf16 v[68:71], v[124:127], v[148:151], v[68:71]
    s_waitcnt lgkmcnt(2)
    v_mfma_f32_16x16x32_bf16 v[72:75], v[124:127], v[152:155], v[72:75]
    s_waitcnt lgkmcnt(0)
    v_mfma_f32_16x16x32_bf16 v[76:79], v[124:127], v[156:159], v[76:79]
    s_nop 3
    v_cndmask_b32 v64, v64, v68, s[60:61]
    s_nop 0
    v_cndmask_b32 v64, v64, v72, s[62:63]
    s_nop 0
    v_cndmask_b32 v64, v64, v76, s[72:73]
    v_and_or_b32 v226, v64, s74, v212
    buffer_store_dword v226, v13, s[12:15], s31 offen offset:0
    s_barrier
    s_bitcmp1_b32 s16, 0
    s_cselect_b32 s8, s52, s50
    s_cselect_b32 s9, s53, s51
    s_mov_b32 s10, 7340032
    s_lshr_b32 s42, s8, 7
    s_sub_u32 s42, 3, s42
    s_add_u32 s42, s42, s34
    s_and_b32 s42, s42, 7
    s_cmp_eq_u32 s42, 7
    s_cbranch_scc1 m_nh2
    s_mul_i32 s43, s34, 7
    s_add_u32 s42, s42, s43
    s_lshl_b32 s42, s42, 7
    s_lshl_b32 s43, s35, 1
    s_lshr_b32 s40, s16, 1
    s_add_u32 s43, s43, s40
    s_mul_i32 s43, s43, 265216
    s_add_u32 s42, s42, s43
    v_mul_u32_u24 v24, 7168, v2
    s_mov_b32 exec_lo, 4294967295
    s_mov_b32 exec_hi, 31
    buffer_load_dword v245, v24, s[8:11], s42 offen
    s_mov_b64 exec, -1
m_nh2:
    s_barrier
    ds_read_b64_tr_b16 v[64:65], v12 offset:0
    ds_read_b64_tr_b16 v[66:67], v12 offset:2048
    ds_read_b64_tr_b16 v[68:69], v12 offset:4096
    ds_read_b64_tr_b16 v[70:71], v12 offset:6144
    ds_read_b64_tr_b16 v[72:73], v12 offset:8192
    ds_read_b64_tr_b16 v[74:75], v12 offset:10240
    ds_read_b64_tr_b16 v[76:77], v12 offset:12288
    ds_read_b64_tr_b16 v[78:79], v12 offset:14336
    ds_read_b64_tr_b16 v[80:81], v12 offset:16384
    ds_read_b64_tr_b16 v[82:83], v12 offset:18432
    ds_read_b64_tr_b16 v[84:85], v12 offset:20480
    ds_read_b64_tr_b16 v[86:87], v12 offset:22528
    ds_read_b64_tr_b16 v[88:89], v12 offset:24576
    ds_read_b64_tr_b16 v[90:91], v12 offset:26624
    ds_read_b64_tr_b16 v[92:93], v12 offset:28672
    ds_read_b64_tr_b16 v[94:95], v12 offset:30720
    s_waitcnt vmcnt(0)
    s_barrier
    s_sub_u32 s42, s16, 1
    s_cmp_ge_u32 s42, 3
    s_cbranch_scc1 m_nb
    s_lshl_b32 s42, s42, 10
    s_add_u32 s42, s42, s29
    s_add_u32 s43, s42, 524288
    buffer_load_dwordx4 v[44:47], v3, s[12:15], s42 offen sc1
    s_waitcnt vmcnt(0)
    buffer_store_dwordx4 v[44:47], v3, s[12:15], s43 offen sc1
m_nb:
m_join:
    v_bfe_u32 v7, v0, 4, 2
    v_and_b32 v6, 1, v0
    v_lshlrev_b32 v17, 10, v6
    v_lshl_add_u32 v17, v16, 9, v17
    v_lshl_add_u32 v17, v7, 4, v17
    v_add_u32 v17, 131072, v17
    v_and_b32 v6, 15, v0
    v_lshlrev_b32 v13, 6, v6
    v_bfe_u32 v22, v0, 4, 1
    v_lshl_add_u32 v13, v22, 5, v13
    v_bfe_u32 v22, v0, 5, 1
    v_lshl_add_u32 v13, v22, 4, v13
    v_add_u32 v13, 131072, v13
    v_lshl_add_u32 v13, v1, 10, v13
    s_lshl_b32 s70, s34, 1
    s_add_u32 s70, s70, s16
    s_lshl_b32 s70, s70, 13
    s_lshl_b32 s71, s65, 11
    s_add_u32 s70, s70, s71
    s_add_u32 s70, s70, 17301504
    s_mov_b32 s71, 0x07060302
    s_lshl_b32 s69, s64, 2
    s_and_b32 s42, s16, 3
    s_add_u32 s69, s69, s42
    s_lshl_b32 s69, s69, 10
    s_lshl_b32 s76, s65, 1
    s_lshr_b32 s42, s16, 2
    s_add_u32 s76, s76, s42
    s_lshl_b32 s76, s76, 8
    s_add_u32 s76, s76, s69
    s_add_u32 s77, s76, 18612224
    s_add_u32 s76, s76, 18350080
    s_add_u32 s69, s69, 18350080
    s_cmp_lg_u32 s16, 2
    s_cbranch_scc1 m_n0
    v_lshlrev_b32 v4, 7, v2
    s_sub_u32 s69, s69, 2048
    s_mov_b32 exec_hi, 0
    buffer_load_dword v5, v4, s[12:15], s69 offen sc1
    s_mov_b32 exec_hi, -1
m_n0:
    s_cmp_ge_u32 s16, 2
    s_cbranch_scc1 m_n1
    v_lshlrev_b32 v4, 7, v2
    s_mov_b64 exec, 0xffff
    buffer_load_dword v5, v4, s[12:15], s70 offen sc1
    s_mov_b64 exec, -1
m_n1:
    v_mov_b32 v216, s32
    v_mov_b32 v217, s33
    v_and_b32 v218, 1, v0
    v_cmp_eq_u32 vcc, 1, v218
    s_nop 1
    v_cndmask_b32 v216, v216, v217, vcc
    v_bfe_u32 v217, v216, 8, 8
    v_bfe_u32 v218, v216, 16, 8
    v_lshrrev_b32 v219, 24, v216
    v_and_b32 v216, 0xff, v216
    s_and_b32 s60, s32, 0xffff
    s_lshr_b32 s61, s32, 16
    s_and_b32 s62, s33, 0xffff
    s_lshr_b32 s63, s33, 16
    s_movk_i32 s74, 0xff00
    s_waitcnt vmcnt(0)
    s_barrier
    s_cmp_ge_u32 s16, 2
    s_cselect_b64 exec, 1, -1
    buffer_load_dwordx4 v[176:179], v3, s[12:15], s70 offen sc1
    buffer_load_dwordx4 v[180:183], v3, s[12:15], s70 offen offset:1024 sc1
    s_mov_b64 exec, -1
    ds_read_b64_tr_b16 v[96:97], v21 offset:0
    ds_read_b64_tr_b16 v[98:99], v21 offset:2048
    ds_read_b64_tr_b16 v[100:101], v21 offset:4096
    ds_read_b64_tr_b16 v[102:103], v21 offset:6144
    ds_read_b64_tr_b16 v[104:105], v21 offset:8192
    ds_read_b64_tr_b16 v[106:107], v21 offset:10240
    ds_read_b64_tr_b16 v[108:109], v21 offset:12288
    ds_read_b64_tr_b16 v[110:111], v21 offset:14336
    ds_read_b64_tr_b16 v[112:113], v21 offset:16384
    ds_read_b64_tr_b16 v[114:115], v21 offset:18432
    ds_read_b64_tr_b16 v[116:117], v21 offset:20480
    ds_read_b64_tr_b16 v[118:119], v21 offset:22528
    ds_read_b64_tr_b16 v[120:121], v21 offset:24576
    ds_read_b64_tr_b16 v[122:123], v21 offset:26624
    ds_read_b64_tr_b16 v[124:125], v21 offset:28672
    ds_read_b64_tr_b16 v[126:127], v21 offset:30720
    s_cbranch_scc1 m_nk
    s_mov_b32 s83, 0
m_ph:
    s_waitcnt vmcnt(0)
    v_perm_b32 v184, v177, v176, s71
    v_perm_b32 v185, v179, v178, s71
    v_perm_b32 v186, v181, v180, s71
    v_perm_b32 v187, v183, v182, s71
    ds_write_b128 v13, v[184:187]
    v_xor_b32 v176, s60, v176
    v_xor_b32 v177, s61, v177
    v_xor_b32 v178, s62, v178
    v_xor_b32 v179, s63, v179
    v_xor_b32 v180, s60, v180
    v_xor_b32 v181, s61, v181
    v_xor_b32 v182, s62, v182
    v_xor_b32 v183, s63, v183
    v_or3_b32 v4, v176, v177, 0
    v_or3_b32 v4, v178, v179, v4
    v_or3_b32 v4, v180, v181, v4
    v_or3_b32 v4, v182, v183, v4
    v_cmp_ne_u16 vcc, 0, v4
    s_cbranch_vccnz m_pr
m_phx:
m_nk:
    s_waitcnt lgkmcnt(0)
    s_barrier
    ds_read_b128 v[128:131], v17 offset:0
    ds_read_b128 v[132:135], v17 offset:64
    ds_read_b128 v[136:139], v17 offset:128
    ds_read_b128 v[140:143], v17 offset:192
    ds_read_b128 v[144:147], v17 offset:256
    ds_read_b128 v[148:151], v17 offset:320
    ds_read_b128 v[152:155], v17 offset:384
    ds_read_b128 v[156:159], v17 offset:448
    s_waitcnt lgkmcnt(7)
    v_mfma_f32_16x16x32_bf16 v[160:163], v[128:131], v[64:67], 0
    v_mfma_f32_16x16x32_bf16 v[164:167], v[128:131], v[96:99], 0
    s_waitcnt lgkmcnt(6)
    v_mfma_f32_16x16x32_bf16 v[160:163], v[132:135], v[68:71], v[160:163]
    v_mfma_f32_16x16x32_bf16 v[164:167], v[132:135], v[100:103], v[164:167]
    s_waitcnt lgkmcnt(5)
    v_mfma_f32_16x16x32_bf16 v[160:163], v[136:139], v[72:75], v[160:163]
    v_mfma_f32_16x16x32_bf16 v[164:167], v[136:139], v[104:107], v[164:167]
    s_waitcnt lgkmcnt(4)
    v_mfma_f32_16x16x32_bf16 v[160:163], v[140:143], v[76:79], v[160:163]
    v_mfma_f32_16x16x32_bf16 v[164:167], v[140:143], v[108:111], v[164:167]
    s_waitcnt lgkmcnt(3)
    v_mfma_f32_16x16x32_bf16 v[160:163], v[144:147], v[80:83], v[160:163]
    v_mfma_f32_16x16x32_bf16 v[164:167], v[144:147], v[112:115], v[164:167]
    s_waitcnt lgkmcnt(2)
    v_mfma_f32_16x16x32_bf16 v[160:163], v[148:151], v[84:87], v[160:163]
    v_mfma_f32_16x16x32_bf16 v[164:167], v[148:151], v[116:119], v[164:167]
    s_waitcnt lgkmcnt(1)
    v_mfma_f32_16x16x32_bf16 v[160:163], v[152:155], v[88:91], v[160:163]
    v_mfma_f32_16x16x32_bf16 v[164:167], v[152:155], v[120:123], v[164:167]
    s_waitcnt lgkmcnt(0)
    v_mfma_f32_16x16x32_bf16 v[160:163], v[156:159], v[92:95], v[160:163]
    v_mfma_f32_16x16x32_bf16 v[164:167], v[156:159], v[124:127], v[164:167]
    s_nop 6
    v_and_or_b32 v184, v160, s74, v216
    v_and_or_b32 v185, v161, s74, v217
    v_and_or_b32 v186, v164, s74, v218
    v_and_or_b32 v187, v165, s74, v219
    s_mov_b64 exec, 0xffff
    buffer_store_dwordx4 v[184:187], v3, s[12:15], s76 offen
    buffer_store_dwordx4 v[184:187], v3, s[12:15], s77 offen sc1
    s_mov_b64 exec, -1
    s_cmp_eq_u32 s16, 0
    s_cbranch_scc1 r_start
g_end:
    s_endpgm
m_pr:
    s_and_b32 s42, s83, 31
    s_cmp_eq_u32 s42, 31
    s_cselect_b32 s42, 131072, 0
    s_add_u32 s42, s42, s70
    buffer_load_dwordx4 v[176:179], v3, s[12:15], s42 offen sc1
    buffer_load_dwordx4 v[180:183], v3, s[12:15], s42 offen offset:1024 sc1
    s_add_u32 s83, s83, 1
    s_cmp_lt_u32 s83, 0x40000
    s_cbranch_scc1 m_ph
    s_branch m_phx
x_start:
    v_mov_b32 v216, s32
    v_mov_b32 v217, s33
    v_and_b32 v218, 1, v0
    v_cmp_eq_u32 vcc, 1, v218
    s_nop 1
    v_cndmask_b32 v216, v216, v217, vcc
    v_bfe_u32 v217, v216, 8, 8
    v_bfe_u32 v218, v216, 16, 8
    v_lshrrev_b32 v219, 24, v216
    v_and_b32 v216, 0xff, v216
    s_lshl_b32 s41, s34, 16
    s_lshl_b32 s42, s16, 13
    s_add_u32 s41, s41, s42
    s_add_u32 s41, s41, 19922944
    s_lshl_b32 s42, s65, 9
    s_add_u32 s40, s41, s42
    s_add_u32 s41, s40, s42
    v_lshlrev_b32 v10, 4, v0
    v_lshrrev_b32 v11, 5, v2
    v_and_b32 v12, 0x1f0, v3
    v_lshl_add_u32 v11, v11, 12, v12
    s_lshl_b32 s39, s34, 4
    s_add_u32 s39, s39, s35
    s_lshl_b32 s39, s39, 12
    s_add_u32 s39, s39, 19922944
    s_bitcmp1_b32 s64, 2
    s_cselect_b32 s28, 1.0, 0
    s_mov_b32 s83, 0
x_g0:
    s_and_b32 s42, s83, 31
    s_cmp_eq_u32 s42, 31
    s_cselect_b32 s42, 524288, 0
    s_add_u32 s42, s42, s41
    s_add_u32 s43, s42, 4096
    buffer_load_dwordx4 v[32:35], v3, s[12:15], s42 offen sc1
    buffer_load_dwordx4 v[36:39], v3, s[12:15], s43 offen sc1
    s_waitcnt vmcnt(0)
    v_xor_b32 v32, v216, v32
    v_xor_b32 v33, v217, v33
    v_xor_b32 v34, v218, v34
    v_xor_b32 v35, v219, v35
    v_xor_b32 v36, v216, v36
    v_xor_b32 v37, v217, v37
    v_xor_b32 v38, v218, v38
    v_xor_b32 v39, v219, v39
    v_or3_b32 v17, v32, v33, 0
    v_or3_b32 v17, v34, v35, v17
    v_or3_b32 v17, v36, v37, v17
    v_or3_b32 v17, v38, v39, v17
    v_and_b32 v17, 0xff, v17
    v_cmp_ne_u32 vcc, 0, v17
    s_cbranch_vccz x_g0x
    s_and_b32 s42, s83, 31
    s_cmp_lg_u32 s42, 24
    s_cbranch_scc1 x_g0n
    s_add_u32 s43, s39, 524288
    buffer_load_dwordx4 v[44:47], v3, s[12:15], s39 offen offset:0 sc1
    s_waitcnt vmcnt(0)
    buffer_store_dwordx4 v[44:47], v3, s[12:15], s43 offen offset:0 sc1
    s_waitcnt vmcnt(0)
    buffer_load_dwordx4 v[44:47], v3, s[12:15], s39 offen offset:1024 sc1
    s_waitcnt vmcnt(0)
    buffer_store_dwordx4 v[44:47], v3, s[12:15], s43 offen offset:1024 sc1
    s_waitcnt vmcnt(0)
x_g0n:
    s_add_u32 s83, s83, 1
    s_cmp_lt_u32 s83, 0x40000
    s_cbranch_scc1 x_g0
x_g0x:
    v_pk_add_f32 v[32:33], v[32:33], v[36:37]
    v_pk_add_f32 v[34:35], v[34:35], v[38:39]
    ds_write_b128 v10, v[32:35] offset:0
    s_waitcnt lgkmcnt(0)
    s_barrier
    s_cmp_lg_u32 s16, 0
    s_cbranch_scc1 x_g0e
    ds_read_b128 v[160:163], v221 offset:0
    ds_read_b128 v[164:167], v221 offset:1024
    ds_read_b128 v[168:171], v221 offset:2048
    ds_read_b128 v[172:175], v221 offset:3072
    ds_read_b128 v[176:179], v221 offset:4096
    ds_read_b128 v[180:183], v221 offset:5120
    ds_read_b128 v[184:187], v221 offset:6144
    ds_read_b128 v[188:191], v221 offset:7168
    s_waitcnt lgkmcnt(6)
    v_pk_add_f32 v[160:161], v[160:161], v[164:165]
    v_pk_add_f32 v[162:163], v[162:163], v[166:167]
    s_waitcnt lgkmcnt(4)
    v_pk_add_f32 v[168:169], v[168:169], v[172:173]
    v_pk_add_f32 v[170:171], v[170:171], v[174:175]
    s_waitcnt lgkmcnt(2)
    v_pk_add_f32 v[176:177], v[176:177], v[180:181]
    v_pk_add_f32 v[178:179], v[178:179], v[182:183]
    s_waitcnt lgkmcnt(0)
    v_pk_add_f32 v[184:185], v[184:185], v[188:189]
    v_pk_add_f32 v[186:187], v[186:187], v[190:191]
    v_pk_add_f32 v[160:161], v[160:161], v[168:169]
    v_pk_add_f32 v[176:177], v[176:177], v[184:185]
    v_pk_add_f32 v[162:163], v[162:163], v[170:171]
    v_pk_add_f32 v[178:179], v[178:179], v[186:187]
    v_pk_add_f32 v[160:161], v[160:161], v[176:177]
    v_pk_add_f32 v[162:163], v[162:163], v[178:179]
    v_cvt_pk_bf16_f32 v17, v160, v161
    v_lshlrev_b32 v160, 16, v17
    v_and_b32 v161, 0xffff0000, v17
    v_cvt_pk_bf16_f32 v18, v162, v163
    v_lshlrev_b32 v162, 16, v18
    v_and_b32 v163, 0xffff0000, v18
    v_add_f32 v160, s28, v160
    v_add_f32 v161, s28, v161
    v_add_f32 v162, s28, v162
    v_add_f32 v163, s28, v163
    v_cvt_pk_bf16_f32 v17, v160, v161
    v_lshlrev_b32 v160, 16, v17
    v_and_b32 v161, 0xffff0000, v17
    v_cvt_pk_bf16_f32 v18, v162, v163
    v_lshlrev_b32 v162, 16, v18
    v_and_b32 v163, 0xffff0000, v18
    v_and_or_b32 v40, v160, s74, v216
    v_and_or_b32 v41, v161, s74, v217
    v_and_or_b32 v42, v162, s74, v218
    v_and_or_b32 v43, v163, s74, v219
    buffer_store_dwordx4 v[40:43], v220, s[12:15], s22 offen sc1
    v_mov_b32 v48, s32
    v_mov_b32 v49, s33
    s_cmp_ge_u32 s64, 12
    s_cbranch_scc1 x_q
    v_max3_f32 v50, abs(v160), abs(v161), abs(v162)
    v_max_f32_e64 v50, v50, abs(v163)
    s_nop 1
    v_max_f32_dpp v50, v50, v50 row_ror:8 row_mask:0xf bank_mask:0xf
    s_nop 1
    v_max_f32_dpp v50, v50, v50 row_ror:4 row_mask:0xf bank_mask:0xf
    s_nop 1
    v_max_f32_dpp v50, v50, v50 row_ror:2 row_mask:0xf bank_mask:0xf
    s_nop 1
    v_max_f32_dpp v50, v50, v50 row_ror:1 row_mask:0xf bank_mask:0xf
    s_nop 1
    v_max_f32_dpp v50, v50, v50 row_bcast:15 row_mask:0xa bank_mask:0xf
    s_nop 1
    v_max_f32_dpp v50, v50, v50 row_bcast:31 row_mask:0xc bank_mask:0xf
    s_branch x_r
x_q:
    v_lshlrev_b32 v164, 16, v52
    v_and_b32 v165, 0xffff0000, v52
    v_lshlrev_b32 v166, 16, v53
    v_and_b32 v167, 0xffff0000, v53
    v_pk_mul_f32 v[164:165], v[164:165], v[160:161]
    v_pk_mul_f32 v[166:167], v[166:167], v[162:163]
    s_add_u32 s42, s22, 4096
    v_and_or_b32 v40, v164, s74, v216
    v_and_or_b32 v41, v165, s74, v217
    v_and_or_b32 v42, v166, s74, v218
    v_and_or_b32 v43, v167, s74, v219
    buffer_store_dwordx4 v[40:43], v220, s[12:15], s42 offen sc1
    v_and_b32 v164, s74, v164
    v_and_b32 v165, s74, v165
    v_and_b32 v166, s74, v166
    v_and_b32 v167, s74, v167
    v_pk_add_f32 v[164:165], v[164:165], v[166:167]
    v_add_f32 v50, v164, v165
    s_nop 1
    v_add_f32_dpp v50, v50, v50 row_ror:8 row_mask:0xf bank_mask:0xf
    s_nop 1
    v_add_f32_dpp v50, v50, v50 row_ror:4 row_mask:0xf bank_mask:0xf
    s_nop 1
    v_add_f32_dpp v50, v50, v50 row_ror:2 row_mask:0xf bank_mask:0xf
    s_nop 1
    v_add_f32_dpp v50, v50, v50 row_ror:1 row_mask:0xf bank_mask:0xf
    s_nop 1
    v_add_f32_dpp v50, v50, v50 row_bcast:15 row_mask:0xa bank_mask:0xf
    s_nop 1
    v_add_f32_dpp v50, v50, v50 row_bcast:31 row_mask:0xc bank_mask:0xf
x_r:
    s_nop 0
    v_readlane_b32 s42, v50, 63
    s_nop 1
    v_mov_b32 v50, s42
    s_mov_b64 exec, 0xff
    buffer_store_dwordx4 v[48:51], v3, s[12:15], s79 offen sc1
    s_mov_b64 exec, -1
x_g0e:
    s_barrier
    s_cmp_lt_u32 s16, 4
    s_cbranch_scc1 x_t1
    v_xor_b32 v4, 0, v14
    s_add_u32 s43, s68, 98304
    s_mov_b32 m0, s43
    s_add_u32 s42, s19, 0
    buffer_load_dwordx4 v4, s[8:11], s42 offen nt lds
    v_xor_b32 v4, 64, v14
    s_add_u32 s43, s68, 99328
    s_mov_b32 m0, s43
    s_add_u32 s42, s19, 24576
    buffer_load_dwordx4 v4, s[8:11], s42 offen nt lds
    v_xor_b32 v4, 0, v14
    s_add_u32 s43, s68, 100352
    s_mov_b32 m0, s43
    s_add_u32 s42, s19, 49152
    buffer_load_dwordx4 v4, s[8:11], s42 offen nt lds
    v_xor_b32 v4, 64, v14
    s_add_u32 s43, s68, 101376
    s_mov_b32 m0, s43
    s_add_u32 s42, s19, 73728
    buffer_load_dwordx4 v4, s[8:11], s42 offen nt lds
    v_xor_b32 v4, 128, v14
    s_add_u32 s43, s68, 102400
    s_mov_b32 m0, s43
    s_add_u32 s42, s19, 98304
    buffer_load_dwordx4 v4, s[8:11], s42 offen nt lds
    v_xor_b32 v4, 192, v14
    s_add_u32 s43, s68, 103424
    s_mov_b32 m0, s43
    s_add_u32 s42, s19, 122880
    buffer_load_dwordx4 v4, s[8:11], s42 offen nt lds
    v_xor_b32 v4, 128, v14
    s_add_u32 s43, s68, 104448
    s_mov_b32 m0, s43
    s_add_u32 s42, s19, 147456
    buffer_load_dwordx4 v4, s[8:11], s42 offen nt lds
    v_xor_b32 v4, 192, v14
    s_add_u32 s43, s68, 105472
    s_mov_b32 m0, s43
    s_add_u32 s42, s19, 172032
    buffer_load_dwordx4 v4, s[8:11], s42 offen nt lds
    s_waitcnt vmcnt(0)
    s_barrier
    s_branch x_t2
x_t1:
    s_barrier
    ds_read_b64_tr_b16 v[128:129], v208 offset:0
    ds_read_b64_tr_b16 v[130:131], v208 offset:2048
    ds_read_b64_tr_b16 v[132:133], v209 offset:0
    ds_read_b64_tr_b16 v[134:135], v209 offset:2048
    ds_read_b64_tr_b16 v[136:137], v210 offset:0
    ds_read_b64_tr_b16 v[138:139], v210 offset:2048
    ds_read_b64_tr_b16 v[140:141], v211 offset:0
    ds_read_b64_tr_b16 v[142:143], v211 offset:2048
    ds_read_b64_tr_b16 v[144:145], v208 offset:16384
    ds_read_b64_tr_b16 v[146:147], v208 offset:18432
    ds_read_b64_tr_b16 v[148:149], v209 offset:16384
    ds_read_b64_tr_b16 v[150:151], v209 offset:18432
    ds_read_b64_tr_b16 v[152:153], v210 offset:16384
    ds_read_b64_tr_b16 v[154:155], v210 offset:18432
    s_waitcnt lgkmcnt(12)
    v_mfma_f32_16x16x32_bf16 v[64:67], v[120:123], v[128:131], 0
    ds_read_b64_tr_b16 v[156:157], v211 offset:16384
    ds_read_b64_tr_b16 v[158:159], v211 offset:18432
    s_waitcnt lgkmcnt(12)
    v_mfma_f32_16x16x32_bf16 v[68:71], v[120:123], v[132:135], 0
    s_waitcnt lgkmcnt(10)
    v_mfma_f32_16x16x32_bf16 v[72:75], v[120:123], v[136:139], 0
    s_waitcnt lgkmcnt(8)
    v_mfma_f32_16x16x32_bf16 v[76:79], v[120:123], v[140:143], 0
    s_waitcnt lgkmcnt(6)
    v_mfma_f32_16x16x32_bf16 v[64:67], v[124:127], v[144:147], v[64:67]
    s_waitcnt lgkmcnt(4)
    v_mfma_f32_16x16x32_bf16 v[68:71], v[124:127], v[148:151], v[68:71]
    s_waitcnt lgkmcnt(2)
    v_mfma_f32_16x16x32_bf16 v[72:75], v[124:127], v[152:155], v[72:75]
    s_waitcnt lgkmcnt(0)
    v_mfma_f32_16x16x32_bf16 v[76:79], v[124:127], v[156:159], v[76:79]
    s_nop 3
    v_cndmask_b32 v64, v64, v68, s[60:61]
    s_nop 0
    v_cndmask_b32 v64, v64, v72, s[62:63]
    s_nop 0
    v_cndmask_b32 v64, v64, v76, s[72:73]
    v_and_or_b32 v226, v64, s74, v212
    buffer_store_dword v226, v13, s[12:15], s31 offen offset:0
x_t2:
    s_mov_b32 s83, 0
x_g1:
    s_and_b32 s42, s83, 31
    s_cmp_eq_u32 s42, 31
    s_cselect_b32 s42, 524288, 0
    s_add_u32 s42, s42, s40
    buffer_load_dwordx4 v[32:35], v11, s[12:15], s42 offen offset:2048 sc1
    s_waitcnt vmcnt(0)
    v_xor_b32 v32, v216, v32
    v_xor_b32 v33, v217, v33
    v_xor_b32 v34, v218, v34
    v_xor_b32 v35, v219, v35
    v_or3_b32 v17, v32, v33, 0
    v_or3_b32 v17, v34, v35, v17
    v_and_b32 v17, 0xff, v17
    v_cmp_ne_u32 vcc, 0, v17
    s_cbranch_vccz x_g1x
    s_and_b32 s42, s83, 31
    s_cmp_lg_u32 s42, 24
    s_cbranch_scc1 x_g1n
    s_add_u32 s43, s39, 524288
    buffer_load_dwordx4 v[44:47], v3, s[12:15], s39 offen offset:0 sc1
    s_waitcnt vmcnt(0)
    buffer_store_dwordx4 v[44:47], v3, s[12:15], s43 offen offset:0 sc1
    s_waitcnt vmcnt(0)
    buffer_load_dwordx4 v[44:47], v3, s[12:15], s39 offen offset:1024 sc1
    s_waitcnt vmcnt(0)
    buffer_store_dwordx4 v[44:47], v3, s[12:15], s43 offen offset:1024 sc1
    s_waitcnt vmcnt(0)
    buffer_load_dwordx4 v[44:47], v3, s[12:15], s39 offen offset:2048 sc1
    s_waitcnt vmcnt(0)
    buffer_store_dwordx4 v[44:47], v3, s[12:15], s43 offen offset:2048 sc1
    s_waitcnt vmcnt(0)
x_g1n:
    s_add_u32 s83, s83, 1
    s_cmp_lt_u32 s83, 0x40000
    s_cbranch_scc1 x_g1
x_g1x:
    ds_write_b128 v10, v[32:35] offset:8192
    s_waitcnt lgkmcnt(0)
    s_barrier
    s_cmp_lg_u32 s16, 0
    s_cbranch_scc1 x_g1e
    ds_read_b128 v[160:163], v221 offset:8192
    ds_read_b128 v[164:167], v221 offset:9216
    ds_read_b128 v[168:171], v221 offset:10240
    ds_read_b128 v[172:175], v221 offset:11264
    ds_read_b128 v[176:179], v221 offset:12288
    ds_read_b128 v[180:183], v221 offset:13312
    ds_read_b128 v[184:187], v221 offset:14336
    ds_read_b128 v[188:191], v221 offset:15360
    s_waitcnt lgkmcnt(6)
    v_pk_add_f32 v[160:161], v[160:161], v[164:165]
    v_pk_add_f32 v[162:163], v[162:163], v[166:167]
    s_waitcnt lgkmcnt(4)
    v_pk_add_f32 v[168:169], v[168:169], v[172:173]
    v_pk_add_f32 v[170:171], v[170:171], v[174:175]
    s_waitcnt lgkmcnt(2)
    v_pk_add_f32 v[176:177], v[176:177], v[180:181]
    v_pk_add_f32 v[178:179], v[178:179], v[182:183]
    s_waitcnt lgkmcnt(0)
    v_pk_add_f32 v[184:185], v[184:185], v[188:189]
    v_pk_add_f32 v[186:187], v[186:187], v[190:191]
    v_pk_add_f32 v[160:161], v[160:161], v[168:169]
    v_pk_add_f32 v[176:177], v[176:177], v[184:185]
    v_pk_add_f32 v[162:163], v[162:163], v[170:171]
    v_pk_add_f32 v[178:179], v[178:179], v[186:187]
    v_pk_add_f32 v[160:161], v[160:161], v[176:177]
    v_pk_add_f32 v[162:163], v[162:163], v[178:179]
    v_mov_b32 v164, v160
    v_mov_b32 v165, v161
    v_mov_b32 v166, v162
    v_mov_b32 v167, v163
    v_permlane32_swap_b32 v160, v164
    v_permlane32_swap_b32 v161, v165
    v_permlane32_swap_b32 v162, v166
    v_permlane32_swap_b32 v163, v167
    v_pk_add_f32 v[160:161], v[160:161], v[164:165]
    v_pk_add_f32 v[162:163], v[162:163], v[166:167]
    v_cvt_pk_bf16_f32 v17, v160, v161
    v_lshlrev_b32 v160, 16, v17
    v_and_b32 v161, 0xffff0000, v17
    v_cvt_pk_bf16_f32 v18, v162, v163
    v_lshlrev_b32 v162, 16, v18
    v_and_b32 v163, 0xffff0000, v18
    s_mov_b32 exec_hi, 0
    v_and_or_b32 v40, v160, s74, v216
    v_and_or_b32 v41, v161, s74, v217
    v_and_or_b32 v42, v162, s74, v218
    v_and_or_b32 v43, v163, s74, v219
    buffer_store_dwordx4 v[40:43], v220, s[12:15], s23 offen sc1
    s_mov_b32 exec_hi, -1
x_g1e:
    s_sub_u32 s42, s16, 0
    s_cmp_ge_u32 s42, 3
    s_cbranch_scc1 x_nb
    s_lshl_b32 s42, s42, 10
    s_add_u32 s42, s42, s29
    s_add_u32 s43, s42, 524288
    buffer_load_dwordx4 v[44:47], v3, s[12:15], s42 offen sc1
    s_waitcnt vmcnt(0)
    buffer_store_dwordx4 v[44:47], v3, s[12:15], s43 offen sc1
x_nb:
    s_cmp_lg_u32 s16, 0
    s_cbranch_scc1 g_end
    s_lshl_b32 s78, s34, 14
    s_add_u32 s78, s78, 17039360
    s_lshl_b32 s79, s34, 7
    s_add_u32 s79, s79, 16842752
    v_mov_b32 v22, 0
    s_mov_b32 s56, s48
    s_mov_b32 s57, s49
    s_mov_b32 s58, 2048
    s_mov_b32 s59, 0x00020000
    s_and_b32 s60, s32, 0xffff
    s_lshr_b32 s61, s32, 16
    s_and_b32 s62, s33, 0xffff
    s_lshr_b32 s63, s33, 16
    v_and_b32 v9, 15, v0
    v_lshlrev_b32 v9, 6, v9
    v_bfe_u32 v19, v0, 4, 1
    v_lshl_add_u32 v9, v19, 5, v9
    v_lshlrev_b32 v18, 9, v19
    v_bfe_u32 v19, v0, 5, 1
    v_lshl_add_u32 v9, v19, 4, v9
    v_lshl_add_u32 v18, v19, 11, v18
    v_bfe_u32 v19, v0, 2, 2
    v_lshl_add_u32 v18, v19, 7, v18
    v_lshl_add_u32 v18, v15, 4, v18
    s_mov_b32 s43, 16896000
    s_lshl_b32 s70, s64, 13
    s_add_u32 s70, s70, 17301504
    s_add_u32 s71, s70, 131072
    s_add_u32 s72, s70, 4096
    s_add_u32 s73, s71, 4096
    v_mov_b32 v21, 0xffff0000
    buffer_load_dwordx4 v[92:95], v9, s[56:59], 0 offen offset:0
    buffer_load_dwordx4 v[96:99], v9, s[56:59], 0 offen offset:1024
    s_mov_b32 s83, 0
    s_mov_b64 exec, 1
x_go:
    buffer_load_dwordx2 v[28:29], v22, s[12:15], s79 offen sc1
    s_waitcnt vmcnt(0)
    v_cmp_ne_u64 vcc, s[32:33], v[28:29]
    s_cbranch_vccz x_goy
    s_sleep 3
    s_add_u32 s83, s83, 1
    s_cmp_lt_u32 s83, 0x40000
    s_cbranch_scc1 x_go
x_goy:
    s_mov_b64 exec, -1
x_gox:
    s_mov_b32 s83, 0
x_sb:
    buffer_load_dwordx4 v[100:103], v18, s[12:15], s43 offen offset:0 sc1
    buffer_load_dwordx4 v[104:107], v18, s[12:15], s43 offen offset:1024 sc1
    buffer_load_dwordx4 v[108:111], v18, s[12:15], s43 offen offset:64 sc1
    buffer_load_dwordx4 v[112:115], v18, s[12:15], s43 offen offset:1088 sc1
    v_lshlrev_b32 v48, 16, v92
    v_and_b32 v49, 0xffff0000, v92
    v_lshlrev_b32 v50, 16, v93
    v_and_b32 v51, 0xffff0000, v93
    v_lshlrev_b32 v52, 16, v94
    v_and_b32 v53, 0xffff0000, v94
    v_lshlrev_b32 v54, 16, v95
    v_and_b32 v55, 0xffff0000, v95
    v_lshlrev_b32 v56, 16, v96
    v_and_b32 v57, 0xffff0000, v96
    v_lshlrev_b32 v58, 16, v97
    v_and_b32 v59, 0xffff0000, v97
    v_lshlrev_b32 v60, 16, v98
    v_and_b32 v61, 0xffff0000, v98
    v_lshlrev_b32 v62, 16, v99
    v_and_b32 v63, 0xffff0000, v99
    s_waitcnt vmcnt(0)
    v_xor_b32 v100, v216, v100
    v_xor_b32 v101, v217, v101
    v_xor_b32 v102, v218, v102
    v_xor_b32 v103, v219, v103
    v_xor_b32 v104, v216, v104
    v_xor_b32 v105, v217, v105
    v_xor_b32 v106, v218, v106
    v_xor_b32 v107, v219, v107
    v_xor_b32 v108, v216, v108
    v_xor_b32 v109, v217, v109
    v_xor_b32 v110, v218, v110
    v_xor_b32 v111, v219, v111
    v_xor_b32 v112, v216, v112
    v_xor_b32 v113, v217, v113
    v_xor_b32 v114, v218, v114
    v_xor_b32 v115, v219, v115
    v_or3_b32 v19, v100, v101, 0
    v_or3_b32 v19, v102, v103, v19
    v_or3_b32 v19, v104, v105, v19
    v_or3_b32 v19, v106, v107, v19
    v_or3_b32 v19, v108, v109, v19
    v_or3_b32 v19, v110, v111, v19
    v_or3_b32 v19, v112, v113, v19
    v_or3_b32 v19, v114, v115, v19
    v_and_b32 v19, 0xff, v19
    v_cmp_ne_u32 vcc, 0, v19
    s_cbranch_vccz x_sbx
    s_sleep 8
    s_add_u32 s83, s83, 1
    s_cmp_lt_u32 s83, 0x40000
    s_cbranch_scc1 x_sb
x_sbx:
    v_lshlrev_b32 v32, 7, v2
    s_add_u32 s42, s78, 8192
    s_mov_b32 s83, 0
    s_mov_b64 vcc, -1
    s_mov_b64 s[40:41], -1
x_pk:
    s_mov_b64 exec, vcc
    s_cbranch_execz x_pka
    buffer_load_dwordx4 v[24:27], v32, s[12:15], s78 offen sc1
x_pka:
    s_mov_b64 exec, s[40:41]
    s_cbranch_execz x_pkb
    buffer_load_dwordx4 v[28:31], v32, s[12:15], s42 offen sc1
x_pkb:
    s_mov_b64 exec, -1
    s_waitcnt vmcnt(0)
x_pkc:
    v_cmp_ne_u32 vcc, s32, v25
    v_cmp_ne_u32 s[20:21], s33, v27
    v_cmp_ne_u32 s[40:41], s32, v29
    v_cmp_ne_u32 s[22:23], s33, v31
    v_max_u32 v33, v24, v28
    v_min_u32 v34, v24, v28
    s_or_b64 vcc, vcc, s[20:21]
    s_or_b64 s[40:41], s[40:41], s[22:23]
    s_or_b64 s[20:21], vcc, s[40:41]
    s_cbranch_scc0 x_pkx
    s_add_u32 s83, s83, 1
    s_cmp_lt_u32 s83, 0x40000
    s_cbranch_scc1 x_pk
x_pkx:
    v_mov_b32 v35, v33
    v_max3_u32 v34, v34, v26, v30
    s_nop 0
    v_max_u32_dpp v35, v35, v35 row_ror:8 row_mask:0xf bank_mask:0xf
    s_nop 1
    v_max_u32_dpp v35, v35, v35 row_ror:4 row_mask:0xf bank_mask:0xf
    s_nop 1
    v_max_u32_dpp v35, v35, v35 row_ror:2 row_mask:0xf bank_mask:0xf
    s_nop 1
    v_max_u32_dpp v35, v35, v35 row_ror:1 row_mask:0xf bank_mask:0xf
    s_nop 1
    v_max_u32_dpp v35, v35, v35 row_bcast:15 row_mask:0xa bank_mask:0xf
    s_nop 1
    v_max_u32_dpp v35, v35, v35 row_bcast:31 row_mask:0xc bank_mask:0xf
    s_nop 0
    v_readlane_b32 s40, v35, 63
    s_cmp_eq_u32 s65, 0
    s_cbranch_scc1 x_t1st
    v_cmp_eq_u32 vcc, s40, v33
    s_nop 1
    v_cndmask_b32 v35, v33, v34, vcc
    s_nop 1
    v_max_u32_dpp v35, v35, v35 row_ror:8 row_mask:0xf bank_mask:0xf
    s_nop 1
    v_max_u32_dpp v35, v35, v35 row_ror:4 row_mask:0xf bank_mask:0xf
    s_nop 1
    v_max_u32_dpp v35, v35, v35 row_ror:2 row_mask:0xf bank_mask:0xf
    s_nop 1
    v_max_u32_dpp v35, v35, v35 row_ror:1 row_mask:0xf bank_mask:0xf
    s_nop 1
    v_max_u32_dpp v35, v35, v35 row_bcast:15 row_mask:0xa bank_mask:0xf
    s_nop 1
    v_max_u32_dpp v35, v35, v35 row_bcast:31 row_mask:0xc bank_mask:0xf
    s_nop 0
    v_readlane_b32 s41, v35, 63
    s_mov_b32 s40, s41
x_t1st:
    v_mov_b32 v46, s40
    s_bfe_u32 s42, s40, 0x70005
    s_lshl_b32 s42, s42, 13
    s_and_b32 s40, s40, 1
    s_lshl_b32 s40, s40, 12
    s_add_u32 s42, s42, s40
    s_add_u32 s42, s42, 18874368
    s_mov_b32 s83, 0
x_ph:
    buffer_load_dwordx4 v[32:35], v3, s[12:15], s42 offen sc1
    buffer_load_dwordx4 v[36:39], v3, s[12:15], s42 offen offset:1024 sc1
    s_waitcnt vmcnt(0)
    v_max3_u32 v19, v32, v33, v34
    v_max3_u32 v19, v19, v35, v36
    v_max3_u32 v19, v19, v37, v38
    v_max_u32 v19, v19, v39
    v_cmp_eq_u32 vcc, -1, v19
    s_cbranch_vccz x_phx
    s_add_u32 s83, s83, 1
    s_cmp_lt_u32 s83, 0x40000
    s_cbranch_scc1 x_ph
x_phx:
    v_lshlrev_b32 v64, 16, v32
    v_and_b32 v65, 0xffff0000, v32
    v_lshlrev_b32 v66, 16, v33
    v_and_b32 v67, 0xffff0000, v33
    v_pk_add_f32 v[64:65], v[64:65], v[100:101]
    v_pk_add_f32 v[66:67], v[66:67], v[102:103]
    v_cvt_pk_bf16_f32 v32, v64, v65
    v_cvt_pk_bf16_f32 v33, v66, v67
    v_lshl_or_b32 v64, v32, 16, s60
    v_and_or_b32 v65, v32, v21, s61
    v_lshl_or_b32 v66, v33, 16, s62
    v_and_or_b32 v67, v33, v21, s63
    buffer_store_dwordx4 v[64:67], v3, s[12:15], s70 offen offset:0
    v_lshlrev_b32 v68, 16, v34
    v_and_b32 v69, 0xffff0000, v34
    v_lshlrev_b32 v70, 16, v35
    v_and_b32 v71, 0xffff0000, v35
    v_pk_add_f32 v[68:69], v[68:69], v[104:105]
    v_pk_add_f32 v[70:71], v[70:71], v[106:107]
    v_cvt_pk_bf16_f32 v34, v68, v69
    v_cvt_pk_bf16_f32 v35, v70, v71
    v_lshl_or_b32 v68, v34, 16, s60
    v_and_or_b32 v69, v34, v21, s61
    v_lshl_or_b32 v70, v35, 16, s62
    v_and_or_b32 v71, v35, v21, s63
    buffer_store_dwordx4 v[68:71], v3, s[12:15], s70 offen offset:1024
    v_lshlrev_b32 v72, 16, v36
    v_and_b32 v73, 0xffff0000, v36
    v_lshlrev_b32 v74, 16, v37
    v_and_b32 v75, 0xffff0000, v37
    v_pk_add_f32 v[72:73], v[72:73], v[108:109]
    v_pk_add_f32 v[74:75], v[74:75], v[110:111]
    v_cvt_pk_bf16_f32 v36, v72, v73
    v_cvt_pk_bf16_f32 v37, v74, v75
    v_lshl_or_b32 v72, v36, 16, s60
    v_and_or_b32 v73, v36, v21, s61
    v_lshl_or_b32 v74, v37, 16, s62
    v_and_or_b32 v75, v37, v21, s63
    buffer_store_dwordx4 v[72:75], v3, s[12:15], s70 offen offset:2048
    v_lshlrev_b32 v76, 16, v38
    v_and_b32 v77, 0xffff0000, v38
    v_lshlrev_b32 v78, 16, v39
    v_and_b32 v79, 0xffff0000, v39
    v_pk_add_f32 v[76:77], v[76:77], v[112:113]
    v_pk_add_f32 v[78:79], v[78:79], v[114:115]
    v_cvt_pk_bf16_f32 v38, v76, v77
    v_cvt_pk_bf16_f32 v39, v78, v79
    v_lshl_or_b32 v76, v38, 16, s60
    v_and_or_b32 v77, v38, v21, s61
    v_lshl_or_b32 v78, v39, 16, s62
    v_and_or_b32 v79, v39, v21, s63
    buffer_store_dwordx4 v[76:79], v3, s[12:15], s70 offen offset:3072
    buffer_store_dwordx4 v[64:67], v3, s[12:15], s71 offen offset:0 sc1
    buffer_store_dwordx4 v[68:71], v3, s[12:15], s71 offen offset:1024 sc1
    buffer_store_dwordx4 v[72:75], v3, s[12:15], s71 offen offset:2048 sc1
    buffer_store_dwordx4 v[76:79], v3, s[12:15], s71 offen offset:3072 sc1
    v_lshlrev_b32 v100, 16, v32
    v_and_b32 v101, 0xffff0000, v32
    v_lshlrev_b32 v102, 16, v33
    v_and_b32 v103, 0xffff0000, v33
    v_lshlrev_b32 v104, 16, v34
    v_and_b32 v105, 0xffff0000, v34
    v_lshlrev_b32 v106, 16, v35
    v_and_b32 v107, 0xffff0000, v35
    v_lshlrev_b32 v108, 16, v36
    v_and_b32 v109, 0xffff0000, v36
    v_lshlrev_b32 v110, 16, v37
    v_and_b32 v111, 0xffff0000, v37
    v_lshlrev_b32 v112, 16, v38
    v_and_b32 v113, 0xffff0000, v38
    v_lshlrev_b32 v114, 16, v39
    v_and_b32 v115, 0xffff0000, v39
    v_pk_mul_f32 v[8:9], v[48:49], v[100:101]
    v_pk_fma_f32 v[8:9], v[50:51], v[102:103], v[8:9]
    v_pk_fma_f32 v[8:9], v[52:53], v[104:105], v[8:9]
    v_pk_fma_f32 v[8:9], v[54:55], v[106:107], v[8:9]
    v_pk_fma_f32 v[8:9], v[56:57], v[108:109], v[8:9]
    v_pk_fma_f32 v[8:9], v[58:59], v[110:111], v[8:9]
    v_pk_fma_f32 v[8:9], v[60:61], v[112:113], v[8:9]
    v_pk_fma_f32 v[8:9], v[62:63], v[114:115], v[8:9]
    v_add_f32 v8, v8, v9
    s_nop 1
    v_add_f32_dpp v8, v8, v8 row_ror:8 row_mask:0xf bank_mask:0xf
    s_nop 1
    v_add_f32_dpp v8, v8, v8 row_ror:4 row_mask:0xf bank_mask:0xf
    s_nop 1
    v_add_f32_dpp v8, v8, v8 row_ror:2 row_mask:0xf bank_mask:0xf
    s_nop 1
    v_add_f32_dpp v8, v8, v8 row_ror:1 row_mask:0xf bank_mask:0xf
    s_nop 1
    v_add_f32_dpp v8, v8, v8 row_bcast:15 row_mask:0xa bank_mask:0xf
    s_nop 1
    v_add_f32_dpp v8, v8, v8 row_bcast:31 row_mask:0xc bank_mask:0xf
    v_cvt_pk_bf16_f32 v8, v8, v8
    v_lshlrev_b32 v8, 16, v8
    v_mul_f32 v8, 0xbfb8aa3b, v8
    v_exp_f32 v8, v8
    s_nop 0
    v_add_f32 v8, 1.0, v8
    v_rcp_f32 v8, v8
    s_nop 0
    v_cvt_pk_bf16_f32 v8, v8, v8
    v_lshlrev_b32 v8, 16, v8
    s_nop 0
    v_readlane_b32 s46, v8, 63
    v_mov_b32 v44, s32
    v_mov_b32 v45, s33
    v_mov_b32 v47, s46
    s_mov_b64 exec, 0xff
    buffer_store_dwordx4 v[44:47], v3, s[12:15], s73 offen sc1
    s_mov_b64 exec, -1
    s_sleep 12
r_start:
    s_lshl_b32 s62, s34, 1
    s_lshr_b32 s42, s34, 2
    s_add_u32 s62, s62, s42
    s_lshl_b32 s62, s62, 13
    s_add_u32 s62, s62, 17432576
    s_add_u32 s61, s62, 4096
    s_and_b32 s18, s34, 3
    s_lshl_b32 s18, s18, 4
    s_add_u32 s18, s18, s35
    v_mov_b32 v11, 0
    v_and_b32 v4, 3, v0
    v_lshrrev_b32 v7, 4, v2
    v_lshlrev_b32 v5, 3, v4
    v_lshl_add_u32 v5, v7, 1, v5
    v_lshlrev_b32 v6, 10, v4
    v_lshl_add_u32 v6, v7, 2, v6
    v_lshrrev_b32 v86, 1, v4
    v_lshlrev_b32 v86, 9, v86
    v_and_b32 v87, 1, v4
    v_lshl_add_u32 v85, v87, 10, v86
    v_lshl_add_u32 v85, v7, 2, v85
    v_and_b32 v87, 12, v5
    v_add_u32 v86, v86, v87
    s_and_b32 s30, s18, 1
    s_bfe_u32 s31, s18, 0x20001
    s_bfe_u32 s40, s18, 0x20003
    s_lshr_b32 s41, s18, 5
    s_lshl_b32 s45, s41, 10
    s_add_u32 s62, s62, s45
    s_lshl_b32 s42, s30, 8
    s_add_u32 s45, s45, s42
    s_lshl_b32 s42, s40, 6
    s_add_u32 s45, s45, s42
    s_lshl_b32 s31, s31, 4
    s_add_u32 s45, s45, s31
    s_add_u32 s62, s62, s45
    s_lshl_b32 s30, s30, 9
    s_add_u32 s31, s31, s30
    s_lshl_b32 s40, s40, 7
    s_add_u32 s31, s31, s40
    s_lshl_b32 s41, s41, 6
    s_add_u32 s31, s31, s41
    s_add_u32 s31, s31, 16900096
    s_mov_b32 s83, 0
r_ld:
    s_mov_b64 exec, 1
    buffer_load_dwordx4 v[32:35], v11, s[12:15], s61 offen sc1
    s_mov_b64 exec, -1
    buffer_load_dword v41, v85, s[12:15], s62 offen sc1
    buffer_load_dword v91, v6, s[12:15], s31 offen sc1
    v_and_b32 v87, 2, v5
    v_lshlrev_b32 v87, 3, v87
    s_bitcmp1_b32 s18, 1
    s_cselect_b32 s42, s33, s32
    v_lshlrev_b32 v88, 3, v7
    v_lshrrev_b32_e64 v88, v88, s42
    v_and_b32 v88, 0xff, v88
    v_lshlrev_b32 v89, 4, v7
    v_lshrrev_b64 v[82:83], v89, s[32:33]
    v_and_b32 v82, 0xffff, v82
    s_waitcnt vmcnt(0)
    v_readfirstlane_b32 s50, v32
    v_readfirstlane_b32 s51, v33
    v_readfirstlane_b32 s40, v34
    v_readfirstlane_b32 s46, v35
    v_xor_b32 v91, v88, v91
    v_xor_b32 v41, v82, v41
    v_or_b32 v19, v91, v41
    v_cmp_ne_u16 vcc, 0, v19
    s_xor_b64 s[50:51], s[50:51], s[32:33]
    s_or_b64 vcc, vcc, s[50:51]
    s_cbranch_vccz r_ldx
    s_sleep 2
    s_add_u32 s83, s83, 1
    s_cmp_lt_u32 s83, 0x40000
    s_cbranch_scc1 r_ld
r_ldx:
    v_mul_f32 v80, s46, v91
    s_bfe_u32 s46, s40, 0x70005
    s_bfe_u32 s47, s40, 0x30002
    s_bfe_u32 s60, s40, 0x10001
    s_bfe_u32 s63, s40, 0x70005
    s_lshl_b32 s63, s63, 13
    s_and_b32 s40, s40, 1
    s_lshl_b32 s40, s40, 12
    s_add_u32 s63, s63, s40
    s_add_u32 s63, s63, s45
    s_add_u32 s63, s63, 18874368
    s_mov_b32 s83, 0
r_x1:
    buffer_load_dword v40, v86, s[12:15], s63 offen offset:2048 sc1
    v_lshrrev_b32 v10, 2, v2
    v_lshlrev_b32 v10, 7, v10
    v_lshl_add_u32 v10, v4, 4, v10
    s_lshl_b32 s44, s18, 13
    s_and_b32 s42, s34, 4
    s_lshl_b32 s42, s42, 4
    s_add_u32 s44, s44, s42
    s_add_u32 s44, s44, 17825792
    s_add_u32 s45, s44, 4096
    s_lshr_b32 s61, s46, 4
    s_and_b32 s41, s46, 15
    s_lshl_b32 s41, s41, 4
    s_add_u32 s41, s41, s61
    s_lshr_b32 s61, s46, 3
    s_cmp_eq_u32 s61, 1
    s_cselect_b32 s61, 120, 0
    s_sub_u32 s41, s41, s61
    s_lshl_b32 s61, s47, 8
    s_add_u32 s41, s41, s61
    s_cmp_ge_u32 s47, 4
    s_cselect_b32 s61, 896, 0
    s_cmp_eq_u32 s46, 0
    s_cselect_b32 s61, s61, 0
    s_sub_u32 s41, s41, s61
    s_sub_u32 s61, 2048, s41
    s_cmp_eq_u32 s41, 0
    s_cselect_b32 s61, 1024, s61
    s_cmp_eq_u32 s60, 1
    s_cselect_b32 s41, s61, s41
    s_lshl_b32 s41, s41, 11
    s_lshl_b32 s61, s18, 5
    s_add_u32 s41, s41, s61
    s_mov_b64 exec, 1
    buffer_load_dword v245, v5, s[24:27], s41 offen
    s_mov_b64 exec, -1
    s_waitcnt vmcnt(1)
    v_cmp_eq_u32 vcc, -1, v40
    s_cbranch_vccz r_x1x
    s_sleep 2
    s_add_u32 s83, s83, 1
    s_cmp_lt_u32 s83, 0x40000
    s_cbranch_scc1 r_x1
r_x1x:
    v_lshrrev_b32 v44, v87, v40
    v_lshlrev_b32 v44, 16, v44
    v_fmac_f32 v44, v91, v41
    v_mov_b32 v28, v216
    v_mov_b32 v29, v217
    v_mov_b32 v30, v218
    v_mov_b32 v31, v219
    s_sleep 32
    s_mov_b32 s83, 0
    s_mov_b64 s[64:65], -1
    s_mov_b64 s[66:67], -1
    s_mov_b64 s[68:69], -1
    s_mov_b32 s70, -1
    s_mov_b32 s71, 0
r_p:
    s_mov_b64 exec, s[64:65]
    s_cbranch_execz r_q0
    buffer_load_dwordx4 v[16:19], v10, s[12:15], s44 offen offset:0 sc1
r_q0:
    s_mov_b64 exec, s[66:67]
    s_cbranch_execz r_q1
    buffer_load_dwordx4 v[20:23], v10, s[12:15], s44 offen offset:2048 sc1
r_q1:
    s_mov_b64 exec, s[68:69]
    s_cbranch_execz r_q2
    buffer_load_dwordx4 v[24:27], v10, s[12:15], s45 offen offset:0 sc1
r_q2:
    s_mov_b64 exec, s[70:71]
    s_cbranch_execz r_q3
    buffer_load_dwordx4 v[28:31], v10, s[12:15], s45 offen offset:2048 sc1
r_q3:
    s_mov_b64 exec, -1
    s_waitcnt vmcnt(0)
    v_xor_b32 v48, v216, v16
    v_xor_b32 v49, v217, v17
    v_xor_b32 v50, v218, v18
    v_xor_b32 v51, v219, v19
    v_xor_b32 v52, v216, v20
    v_xor_b32 v53, v217, v21
    v_xor_b32 v54, v218, v22
    v_xor_b32 v55, v219, v23
    v_xor_b32 v56, v216, v24
    v_xor_b32 v57, v217, v25
    v_xor_b32 v58, v218, v26
    v_xor_b32 v59, v219, v27
    v_xor_b32 v60, v216, v28
    v_xor_b32 v61, v217, v29
    v_xor_b32 v62, v218, v30
    v_xor_b32 v63, v219, v31
    v_or3_b32 v12, v48, v49, v50
    v_or3_b32 v13, v52, v53, v54
    v_or3_b32 v14, v56, v57, v58
    v_or3_b32 v15, v60, v61, v62
    v_or_b32 v12, v12, v51
    v_or_b32 v13, v13, v55
    v_or_b32 v14, v14, v59
    v_or_b32 v15, v15, v63
    v_pk_add_f32 v[48:49], v[48:49], v[52:53]
    v_pk_add_f32 v[56:57], v[56:57], v[60:61]
    v_pk_add_f32 v[50:51], v[50:51], v[54:55]
    v_pk_add_f32 v[58:59], v[58:59], v[62:63]
    v_cmp_ne_u16_sdwa s[64:65], v12, v11 src0_sel:BYTE_0 src1_sel:DWORD
    v_cmp_ne_u16_sdwa s[66:67], v13, v11 src0_sel:BYTE_0 src1_sel:DWORD
    v_cmp_ne_u16_sdwa s[68:69], v14, v11 src0_sel:BYTE_0 src1_sel:DWORD
    v_cmp_ne_u16_sdwa s[70:71], v15, v11 src0_sel:BYTE_0 src1_sel:DWORD
    v_pk_add_f32 v[48:49], v[48:49], v[56:57]
    v_pk_add_f32 v[50:51], v[50:51], v[58:59]
    s_or_b64 s[50:51], s[64:65], s[66:67]
    s_or_b64 s[52:53], s[68:69], s[70:71]
    s_or_b64 s[50:51], s[50:51], s[52:53]
    s_cbranch_scc1 r_r
r_x:
    v_permlane32_swap_b32 v48, v50
    v_permlane32_swap_b32 v49, v51
    v_pk_add_f32 v[48:49], v[48:49], v[50:51]
    s_nop 1
    v_permlane16_swap_b32 v48, v49
    v_add_f32 v48, v48, v49
    s_nop 1
    v_add_f32_dpp v48, v48, v48 row_ror:4 row_mask:0xf bank_mask:0xf
    s_nop 1
    v_add_f32_dpp v48, v48, v48 row_ror:8 row_mask:0xf bank_mask:0xf
    v_fmac_f32 v44, v48, v80
    s_mov_b32 exec_lo, 0x000f000f
    s_mov_b32 exec_hi, 0x000f000f
    v_cvt_pk_bf16_f32 v44, v44, v44
    buffer_store_short v44, v5, s[24:27], s41 offen
    s_endpgm
r_r:
    s_add_u32 s83, s83, 1
    s_cmp_lt_u32 s83, 0x40000
    s_cbranch_scc1 r_p
    s_branch r_x
f_start:
    s_mov_b32 s20, s26
    s_mov_b32 s21, s27
    s_mov_b32 s26, 4194304
    s_mov_b32 s27, 0x00020000
    s_mov_b32 s22, s50
    s_mov_b32 s23, s51
    s_mov_b32 s28, s54
    s_mov_b32 s29, s55
    s_add_u32 s58, s36, tables-h_pc
    s_addc_u32 s59, s37, 0
    s_lshr_b32 s36, s35, 1
    s_and_b32 s36, s36, 4
    s_xor_b32 s36, s36, s16
    s_and_b32 s37, s34, 4
    s_xor_b32 s37, s37, s16
    s_lshl_b32 s3, s34, 4
    s_add_u32 s3, s3, s35
    v_and_b32 v4, 15, v0
    v_bfe_u32 v5, v0, 4, 2
    v_lshrrev_b32 v248, 3, v2
    v_lshlrev_b32 v248, 18, v248
    v_lshlrev_b32 v249, 1, v5
    v_xor_b32 v249, v249, v0
    v_and_b32 v249, 7, v249
    v_lshl_add_u32 v255, v249, 4, v248
    v_lshlrev_b32 v6, 16, v5
    v_lshl_add_u32 v6, v4, 4, v6
    s_lshl_b32 s60, s16, 15
    s_lshl_b32 s61, s34, 11
    s_add_u32 s60, s60, s61
    s_lshl_b32 s61, s35, 7
    s_add_u32 s60, s60, s61
    s_lshl_b32 s61, s16, 12
    s_add_u32 s61, s61, 61440
    s_lshl_b32 s64, s36, 19
    s_lshl_b32 s65, s35, 3
    s_and_b32 s66, s34, 1
    s_lshl_b32 s66, s66, 2
    s_add_u32 s65, s65, s66
    s_lshr_b32 s66, s34, 1
    s_add_u32 s65, s65, s66
    s_lshl_b32 s65, s65, 8
    s_add_u32 s64, s64, s65
    s_add_u32 s64, s64, 1048576
    s_add_u32 s65, s64, 32768
    s_add_u32 s66, s64, 262144
    s_add_u32 s67, s64, 294912
    s_barrier
    s_cmp_eq_u32 s36, 0
    s_cselect_b32 s42, 2048, 0
    s_add_u32 s42, s42, 16384
    v_add_u32 v248, s42, v3
    global_load_dwordx4 v[236:239], v248, s[58:59]
    global_load_dwordx4 v[240:243], v248, s[58:59] offset:1024
    s_lshr_b32 s42, s3, 4
    s_and_b32 s30, s3, 15
    s_lshl_b32 s30, s30, 4
    s_add_u32 s30, s30, s42
    s_lshr_b32 s42, s3, 3
    s_cmp_eq_u32 s42, 1
    s_cselect_b32 s42, 120, 0
    s_sub_u32 s30, s30, s42
    s_lshl_b32 s42, s16, 8
    s_add_u32 s30, s30, s42
    s_cmp_ge_u32 s16, 4
    s_cselect_b32 s42, 896, 0
    s_cmp_eq_u32 s3, 0
    s_cselect_b32 s42, s42, 0
    s_sub_u32 s30, s30, s42
    s_sub_u32 s31, 2048, s30
    s_cmp_eq_u32 s30, 0
    s_cselect_b32 s31, 1024, s31
    s_lshl_b32 s18, s30, 11
    s_lshl_b32 s19, s31, 11
    s_sub_u32 s75, s19, 2048
    s_lshl_b32 s68, s16, 12
    s_add_u32 s68, s68, 126976
    v_lshrrev_b32 v248, 1, v4
    v_and_b32 v249, 1, v0
    v_cmp_eq_u32 vcc, 1, v4
    s_nop 1
    v_cndmask_b32_e64 v250, v248, 0, vcc
    v_cndmask_b32_e64 v248, v248, 8, vcc
    v_cndmask_b32_e64 v249, v249, 0, vcc
    v_mad_u32_u24 v251, v248, v5, v249
    v_lshlrev_b32 v251, 5, v251
    v_mad_u32_u24 v251, v250, v1, v251
    v_cvt_f32_u32 v248, v248
    v_cvt_f32_u32 v250, v250
    v_cvt_f32_u32 v251, v251
    v_mul_f32 v248, 0x3d800000, v248
    v_mul_f32 v250, 0x3b800000, v250
    v_mul_f32 v216, 0x3c000000, v251
    v_add_f32 v217, v216, v248
    v_add_f32 v218, v217, v248
    v_add_f32 v219, v218, v248
    v_add_f32 v220, v216, v250
    v_add_f32 v221, v217, v250
    v_add_f32 v222, v218, v250
    v_add_f32 v223, v219, v250
    v_cos_f32 v216, v216
    v_cos_f32 v217, v217
    v_cos_f32 v218, v218
    v_cos_f32 v219, v219
    v_cos_f32 v220, v220
    v_cos_f32 v221, v221
    v_cos_f32 v222, v222
    v_cos_f32 v223, v223
    v_lshrrev_b32 v248, 2, v2
    v_lshlrev_b32 v8, 7, v248
    v_bfe_u32 v248, v0, 3, 2
    v_lshl_add_u32 v8, v248, 5, v8
    v_and_b32 v248, 3, v0
    v_lshl_add_u32 v8, v248, 3, v8
    v_lshl_add_u32 v8, v1, 12, v8
    v_xor_b32 v9, 32, v8
    v_xor_b32 v10, 64, v8
    v_xor_b32 v11, 96, v8
    v_lshlrev_b32 v12, 13, v5
    v_lshl_add_u32 v12, v4, 4, v12
    v_lshlrev_b32 v7, 5, v5
    v_and_b32 v248, 1, v0
    v_lshl_add_u32 v7, v248, 10, v7
    v_and_b32 v248, 2, v0
    v_lshl_add_u32 v7, v248, 3, v7
    s_lshl_b32 s70, s34, 11
    s_lshl_b32 s71, s16, 7
    s_add_u32 s71, s71, s70
    s_add_u32 s71, s71, 16777216
    s_lshr_b32 s42, s16, 1
    s_lshl_b32 s42, s42, 8
    s_and_b32 s43, s16, 1
    s_lshl_b32 s43, s43, 3
    s_add_u32 s42, s42, s43
    s_add_u32 s42, s42, 94208
    v_add_u32 v212, s42, v12
    s_lshl_b32 s42, s36, 12
    s_add_u32 s42, s42, 94208
    v_add_u32 v213, s42, v3
    s_mov_b32 s4, 0x3f803f80
    s_mov_b32 s5, 0x3a800000
    s_waitcnt vmcnt(6)
    s_load_dwordx2 s[32:33], s[20:21], 0
    v_dot2_f32_bf16 v108, v64, s4, 0
    v_dot2_f32_bf16 v110, v64, v64, 0
    v_dot2_f32_bf16 v108, v65, s4, v108
    v_dot2_f32_bf16 v110, v65, v65, v110
    v_dot2_f32_bf16 v108, v66, s4, v108
    v_dot2_f32_bf16 v110, v66, v66, v110
    v_dot2_f32_bf16 v108, v67, s4, v108
    v_dot2_f32_bf16 v110, v67, v67, v110
    s_waitcnt vmcnt(5)
    v_dot2_f32_bf16 v109, v72, s4, 0
    v_dot2_f32_bf16 v111, v72, v72, 0
    v_dot2_f32_bf16 v109, v73, s4, v109
    v_dot2_f32_bf16 v111, v73, v73, v111
    v_dot2_f32_bf16 v109, v74, s4, v109
    v_dot2_f32_bf16 v111, v74, v74, v111
    v_dot2_f32_bf16 v109, v75, s4, v109
    v_dot2_f32_bf16 v111, v75, v75, v111
    s_waitcnt vmcnt(4)
    v_dot2_f32_bf16 v108, v68, s4, v108
    v_dot2_f32_bf16 v110, v68, v68, v110
    v_dot2_f32_bf16 v108, v69, s4, v108
    v_dot2_f32_bf16 v110, v69, v69, v110
    v_dot2_f32_bf16 v108, v70, s4, v108
    v_dot2_f32_bf16 v110, v70, v70, v110
    v_dot2_f32_bf16 v108, v71, s4, v108
    v_dot2_f32_bf16 v110, v71, v71, v110
    s_waitcnt vmcnt(3)
    v_dot2_f32_bf16 v109, v76, s4, v109
    v_dot2_f32_bf16 v111, v76, v76, v111
    v_dot2_f32_bf16 v109, v77, s4, v109
    v_dot2_f32_bf16 v111, v77, v77, v111
    v_dot2_f32_bf16 v109, v78, s4, v109
    v_dot2_f32_bf16 v111, v78, v78, v111
    v_dot2_f32_bf16 v109, v79, s4, v109
    v_dot2_f32_bf16 v111, v79, v79, v111
    s_nop 1
    v_permlane32_swap_b32 v108, v109
    v_permlane32_swap_b32 v110, v111
    v_add_f32 v108, v108, v109
    v_add_f32 v110, v110, v111
    s_nop 0
    v_add_f32_dpp v108, v108, v108 row_ror:8 row_mask:0xf bank_mask:0xf
    v_add_f32_dpp v110, v110, v110 row_ror:8 row_mask:0xf bank_mask:0xf
    s_nop 0
    v_add_f32_dpp v108, v108, v108 row_ror:4 row_mask:0xf bank_mask:0xf
    v_add_f32_dpp v110, v110, v110 row_ror:4 row_mask:0xf bank_mask:0xf
    s_nop 0
    v_add_f32_dpp v108, v108, v108 row_ror:2 row_mask:0xf bank_mask:0xf
    v_add_f32_dpp v110, v110, v110 row_ror:2 row_mask:0xf bank_mask:0xf
    s_nop 0
    v_add_f32_dpp v108, v108, v108 row_ror:1 row_mask:0xf bank_mask:0xf
    v_add_f32_dpp v110, v110, v110 row_ror:1 row_mask:0xf bank_mask:0xf
    s_nop 0
    v_add_f32_dpp v108, v108, v108 row_bcast:15 row_mask:0xa bank_mask:0xf
    v_add_f32_dpp v110, v110, v110 row_bcast:15 row_mask:0xa bank_mask:0xf
    v_mul_f32 v108, s5, v108
    v_mul_f32 v110, s5, v110
    v_mul_f32 v116, v108, v108
    v_cvt_pk_bf16_f32 v117, -v108, -v108
    v_sub_f32 v110, v110, v116
    v_mul_f32 v118, 0x44000000, v110
    v_cmp_gt_f32 vcc, v116, v118
    v_readlane_b32 s40, v117, 31
    s_or_b32 s41, vcc_lo, vcc_hi
    s_bitcmp1_b32 s41, 31
    s_cbranch_scc1 f_slowvar
f_var:
    v_cvt_pk_bf16_f32 v110, v110, v110
    v_lshlrev_b32 v110, 16, v110
    v_add_f32 v110, 0x3727c5ac, v110
    v_cvt_pk_bf16_f32 v110, v110, v110
    v_lshlrev_b32 v110, 16, v110
    v_sqrt_f32 v110, v110
    s_and_b32 s40, s40, 0xffff
    v_mov_b32 v114, 0xffff0000
    v_cvt_pk_bf16_f32 v110, v110, v110
    v_lshlrev_b32 v110, 16, v110
    v_mul_f32 v110, 0x41800000, v110
    v_and_or_b32 v114, v117, v114, s40
    v_rcp_f32 v113, v110
    s_waitcnt lgkmcnt(0)
    s_cmp_lg_u32 s32, 0
    s_cbranch_scc1 f_nnx
    s_load_dwordx2 s[32:33], s[20:21], 64
    s_mov_b32 s83, 0
    v_mov_b32 v122, 0
    s_waitcnt lgkmcnt(0)
f_nn:
    s_cmp_lg_u32 s32, 0
    s_cbranch_scc1 f_nnx
    global_load_dwordx2 v[120:121], v122, s[20:21] sc1
    s_waitcnt vmcnt(0)
    v_readfirstlane_b32 s32, v120
    v_readfirstlane_b32 s33, v121
    s_add_u32 s83, s83, 1
    s_cmp_lt_u32 s83, 0x40000
    s_cbranch_scc1 f_nn
f_nnx:
    v_mov_b32 v115, s32
    v_mov_b32_dpp v112, v113 row_bcast:31 row_mask:0xc bank_mask:0xf
    v_mov_b32 v116, 0
    s_mov_b32 exec_lo, 0
    s_mov_b32 exec_hi, 0x80000000
    buffer_store_dwordx4 v[112:115], v116, s[12:15], s62 offen
    v_lshlrev_b32 v117, 4, v1
    v_add_u32 v117, 160768, v117
    ds_write_b128 v117, v[112:115]
    s_mov_b64 exec, -1
    s_mov_b32 m0, s61
    s_add_u32 s42, s60, 0
    s_add_u32 s61, s61, 1024
    buffer_load_dwordx4 v255, s[8:11], s42 offen lds
    s_mov_b32 m0, s61
    s_add_u32 s42, s60, 2097152
    s_add_u32 s61, s61, 1024
    buffer_load_dwordx4 v255, s[8:11], s42 offen lds
    s_mov_b32 m0, s61
    s_add_u32 s42, s60, 16384
    s_add_u32 s61, s61, 1024
    buffer_load_dwordx4 v255, s[8:11], s42 offen lds
    s_mov_b32 m0, s61
    s_add_u32 s42, s60, 2113536
    s_add_u32 s61, s61, 1024
    buffer_load_dwordx4 v255, s[8:11], s42 offen lds
    s_lshl_b32 s69, s16, 11
    v_add_u32 v254, s69, v3
    v_add_u32 v248, s68, v3
    ds_write_b128 v248, v[64:67] offset:0
    ds_write_b128 v248, v[68:71] offset:1024
    v_mov_b32 v244, s32
    v_mov_b32 v245, s33
    v_and_b32 v248, 4, v0
    v_cmp_eq_u32 vcc, 4, v248
    v_and_b32 v248, 3, v0
    v_lshlrev_b32 v248, 2, v248
    v_cndmask_b32 v244, v244, v245, vcc
    v_lshrrev_b32 v244, v248, v244
    s_mov_b32 s54, 0x00010001
    s_mov_b32 s55, 0xfffefffe
    s_mov_b32 s46, 0x05040100
    s_mov_b32 s47, 0x07060302
    v_lshrrev_b32 v245, 1, v244
    v_lshrrev_b32 v246, 2, v244
    v_lshrrev_b32 v247, 3, v244
    v_and_b32 v244, s54, v244
    v_and_b32 v245, s54, v245
    v_and_b32 v246, s54, v246
    v_and_b32 v247, s54, v247
    s_waitcnt vmcnt(2)
    s_mov_b32 exec_lo, 0x000f000f
    s_mov_b32 exec_hi, 0x000f000f
    buffer_load_dwordx4 v[24:27], v7, s[12:15], s71 offen sc1
    s_mov_b64 exec, -1
    s_mov_b32 s83, 0
    s_waitcnt vmcnt(1)
    ds_read_b64_tr_b16 v[40:41], v8 offset:61440
    ds_read_b64_tr_b16 v[42:43], v9 offset:61440
    ds_read_b64_tr_b16 v[44:45], v10 offset:61440
    ds_read_b64_tr_b16 v[46:47], v11 offset:61440
    ds_read_b64_tr_b16 v[48:49], v8 offset:63488
    ds_read_b64_tr_b16 v[50:51], v9 offset:63488
    ds_read_b64_tr_b16 v[52:53], v10 offset:63488
    ds_read_b64_tr_b16 v[54:55], v11 offset:63488
    s_mov_b32 exec_lo, 0x000f000f
    s_mov_b32 exec_hi, 0x000f000f
f_st:
    s_waitcnt vmcnt(0)
    v_cmp_ne_u32 vcc, s32, v27
    s_mov_b64 exec, -1
    s_cbranch_vccnz f_str
f_stx:
    s_setprio 3
    v_mov_b32_dpp v32, v26 row_newbcast:0 row_mask:0xf bank_mask:0xf
    v_mov_b32_dpp v33, v26 row_newbcast:1 row_mask:0xf bank_mask:0xf
    v_mov_b32_dpp v34, v26 row_newbcast:2 row_mask:0xf bank_mask:0xf
    v_mov_b32_dpp v35, v26 row_newbcast:3 row_mask:0xf bank_mask:0xf
    v_mul_f32_dpp v216, v24, v216 row_newbcast:0 row_mask:0xf bank_mask:0xf
    v_mul_f32_dpp v217, v24, v217 row_newbcast:1 row_mask:0xf bank_mask:0xf
    v_mul_f32_dpp v218, v24, v218 row_newbcast:2 row_mask:0xf bank_mask:0xf
    v_mul_f32_dpp v219, v24, v219 row_newbcast:3 row_mask:0xf bank_mask:0xf
    v_perm_b32 v28, v33, v32, s46
    v_perm_b32 v29, v35, v34, s46
    v_cvt_pk_bf16_f32 v224, v216, v217
    v_cvt_pk_bf16_f32 v225, v218, v219
    s_nop 1
    v_mfma_f32_16x16x16_bf16 v[228:231], v[224:225], v[28:29], 0
    v_mul_f32_dpp v220, v25, v220 row_newbcast:0 row_mask:0xf bank_mask:0xf
    v_mul_f32_dpp v221, v25, v221 row_newbcast:1 row_mask:0xf bank_mask:0xf
    v_mul_f32_dpp v222, v25, v222 row_newbcast:2 row_mask:0xf bank_mask:0xf
    v_mul_f32_dpp v223, v25, v223 row_newbcast:3 row_mask:0xf bank_mask:0xf
    v_perm_b32 v30, v33, v32, s47
    v_perm_b32 v31, v35, v34, s47
    v_cvt_pk_bf16_f32 v226, v220, v221
    v_cvt_pk_bf16_f32 v227, v222, v223
    s_nop 1
    v_mfma_f32_16x16x16_bf16 v[232:235], v[226:227], v[30:31], 0
    s_waitcnt lgkmcnt(0)
    v_mfma_f32_16x16x16_bf16 v[56:59], v[224:225], v[40:41], v[228:231]
    v_mfma_f32_16x16x16_bf16 v[60:63], v[226:227], v[48:49], v[232:235]
    v_mfma_f32_16x16x16_bf16 v[64:67], v[224:225], v[42:43], v[228:231]
    v_mfma_f32_16x16x16_bf16 v[68:71], v[226:227], v[50:51], v[232:235]
    s_mov_b32 m0, s68
    s_cmp_eq_u32 s34, 0
    s_cbranch_scc1 f_r0
f_nr:
    buffer_load_dwordx4 v3, s[8:11], s75 offen offset:2048 lds
    buffer_load_dwordx4 v3, s[8:11], s75 offen offset:3072 lds
    s_mov_b32 m0, s69
    s_nop 0
    global_load_lds_dwordx4 v254, s[58:59] offset:0
    global_load_lds_dwordx4 v254, s[58:59] offset:1024
    v_mfma_f32_16x16x16_bf16 v[72:75], v[224:225], v[44:45], v[228:231]
    v_mfma_f32_16x16x16_bf16 v[76:79], v[226:227], v[52:53], v[232:235]
    v_cvt_pk_f16_f32 v184, v56, v57
    v_cvt_pk_f16_f32 v185, v60, v61
    ds_write_b64 v212, v[184:185] offset:0
    v_cvt_pk_f16_f32 v186, v58, v59
    v_cvt_pk_f16_f32 v187, v62, v63
    ds_write_b64 v212, v[186:187] offset:4096
    v_mfma_f32_16x16x16_bf16 v[80:83], v[224:225], v[46:47], v[228:231]
    v_mfma_f32_16x16x16_bf16 v[84:87], v[226:227], v[54:55], v[232:235]
    v_cvt_pk_f16_f32 v188, v64, v65
    v_cvt_pk_f16_f32 v189, v68, v69
    ds_write_b64 v212, v[188:189] offset:1024
    v_cvt_pk_f16_f32 v190, v66, v67
    v_cvt_pk_f16_f32 v191, v70, v71
    ds_write_b64 v212, v[190:191] offset:5120
    v_cvt_pk_f16_f32 v192, v72, v73
    v_cvt_pk_f16_f32 v193, v76, v77
    ds_write_b64 v212, v[192:193] offset:2048
    v_cvt_pk_f16_f32 v194, v74, v75
    v_cvt_pk_f16_f32 v195, v78, v79
    ds_write_b64 v212, v[194:195] offset:6144
    v_cvt_pk_f16_f32 v196, v80, v81
    v_cvt_pk_f16_f32 v197, v84, v85
    ds_write_b64 v212, v[196:197] offset:3072
    v_cvt_pk_f16_f32 v198, v82, v83
    v_cvt_pk_f16_f32 v199, v86, v87
    ds_write_b64 v212, v[198:199] offset:7168
    s_waitcnt lgkmcnt(0)
    s_barrier
    ds_read_b128 v[152:155], v213 offset:0
    ds_read_b128 v[156:159], v213 offset:1024
    ds_read_b128 v[160:163], v213 offset:2048
    ds_read_b128 v[164:167], v213 offset:3072
    s_waitcnt lgkmcnt(3)
    v_mfma_f32_16x16x32_f16 v[56:59], v[236:239], v[152:155], 0
    s_waitcnt lgkmcnt(2)
    v_mfma_f32_16x16x32_f16 v[60:63], v[236:239], v[156:159], 0
    s_waitcnt lgkmcnt(1)
    v_mfma_f32_16x16x32_f16 v[64:67], v[236:239], v[160:163], 0
    s_waitcnt lgkmcnt(0)
    v_mfma_f32_16x16x32_f16 v[68:71], v[236:239], v[164:167], 0
    v_mfma_f32_16x16x32_f16 v[72:75], v[240:243], v[152:155], 0
    v_mfma_f32_16x16x32_f16 v[76:79], v[240:243], v[156:159], 0
    v_mfma_f32_16x16x32_f16 v[80:83], v[240:243], v[160:163], 0
    v_mfma_f32_16x16x32_f16 v[84:87], v[240:243], v[164:167], 0
    v_cvt_pk_f16_f32 v184, v56, v57
    v_cvt_pk_f16_f32 v185, v60, v61
    v_cvt_pk_f16_f32 v186, v64, v65
    s_nop 0
    v_cvt_pk_f16_f32 v187, v68, v69
    v_and_or_b32 v184, v184, s55, v244
    v_and_or_b32 v185, v185, s55, v245
    v_and_or_b32 v186, v186, s55, v246
    v_and_or_b32 v187, v187, s55, v247
    buffer_store_dwordx4 v[184:187], v6, s[12:15], s64 offen sc1
    v_cvt_pk_f16_f32 v188, v58, v59
    v_cvt_pk_f16_f32 v189, v62, v63
    v_cvt_pk_f16_f32 v190, v66, v67
    v_cvt_pk_f16_f32 v191, v70, v71
    v_and_or_b32 v188, v188, s55, v244
    v_and_or_b32 v189, v189, s55, v245
    v_and_or_b32 v190, v190, s55, v246
    v_and_or_b32 v191, v191, s55, v247
    buffer_store_dwordx4 v[188:191], v6, s[12:15], s65 offen sc1
    v_cvt_pk_f16_f32 v192, v72, v73
    v_cvt_pk_f16_f32 v193, v76, v77
    v_cvt_pk_f16_f32 v194, v80, v81
    v_cvt_pk_f16_f32 v195, v84, v85
    v_and_or_b32 v192, v192, s55, v244
    v_and_or_b32 v193, v193, s55, v245
    v_and_or_b32 v194, v194, s55, v246
    v_and_or_b32 v195, v195, s55, v247
    buffer_store_dwordx4 v[192:195], v6, s[12:15], s66 offen sc1
    v_cvt_pk_f16_f32 v196, v74, v75
    v_cvt_pk_f16_f32 v197, v78, v79
    v_cvt_pk_f16_f32 v198, v82, v83
    v_cvt_pk_f16_f32 v199, v86, v87
    v_and_or_b32 v196, v196, s55, v244
    v_and_or_b32 v197, v197, s55, v245
    v_and_or_b32 v198, v198, s55, v246
    v_and_or_b32 v199, v199, s55, v247
    buffer_store_dwordx4 v[196:199], v6, s[12:15], s67 offen sc1
    s_setprio 0
    s_mov_b32 s43, 0
    s_lshr_b32 s42, s3, 4
    s_and_b32 s40, s3, 15
    s_lshl_b32 s40, s40, 4
    s_add_u32 s40, s40, s42
    s_lshr_b32 s42, s3, 3
    s_cmp_eq_u32 s42, 1
    s_cselect_b32 s42, 120, 0
    s_sub_u32 s40, s40, s42
    s_lshl_b32 s42, s43, 8
    s_add_u32 s40, s40, s42
    s_cmp_ge_u32 s43, 4
    s_cselect_b32 s42, 896, 0
    s_cmp_eq_u32 s3, 0
    s_cselect_b32 s42, s42, 0
    s_sub_u32 s40, s40, s42
    v_lshrrev_b32 v248, 1, v4
    v_and_b32 v249, 1, v0
    v_lshlrev_b32 v250, 8, v248
    v_add_u32 v250, s40, v250
    s_cmp_lg_u32 s3, 0
    s_cbranch_scc1 f_a3n
    v_cmp_lt_u32 s[44:45], 3, v248
    v_subrev_u32 v251, 896, v250
    s_nop 0
    v_cndmask_b32 v250, v250, v251, s[44:45]
    v_cmp_eq_u32 vcc, 1, v4
    v_mov_b32 v251, 1024
    s_nop 0
    v_cndmask_b32 v250, v250, v251, vcc
    v_cndmask_b32_e64 v249, v249, 0, vcc
f_a3n:
    v_lshlrev_b32 v251, 1, v5
    v_mul_u32_u24 v251, v251, v250
    v_lshl_add_u32 v251, v249, 9, v251
    v_add_u32 v253, v251, v250
    v_add_u32 v252, 1536, v251
    v_add_u32 v254, 1536, v253
    v_and_b32 v251, 2047, v251
    v_and_b32 v252, 2047, v252
    v_and_b32 v253, 2047, v253
    v_and_b32 v254, 2047, v254
    v_cvt_f32_u32 v251, v251
    v_cvt_f32_u32 v252, v252
    v_cvt_f32_u32 v253, v253
    v_cvt_f32_u32 v254, v254
    v_mul_f32 v251, 0x3a000000, v251
    v_mul_f32 v252, 0x3a000000, v252
    v_mul_f32 v253, 0x3a000000, v253
    v_mul_f32 v254, 0x3a000000, v254
    v_cos_f32 v251, v251
    v_cos_f32 v252, v252
    v_cos_f32 v253, v253
    v_cos_f32 v254, v254
    s_cbranch_scc1 f_a3m
    v_cmp_gt_u32 vcc, 2, v4
    s_nop 1
    v_cndmask_b32_e64 v249, 1.0, 0.5, vcc
    v_mul_f32 v251, v251, v249
    v_mul_f32 v253, v253, v249
    v_cndmask_b32 v252, 0, v251, s[44:45]
    v_cndmask_b32 v254, 0, v253, s[44:45]
    v_cndmask_b32 v251, v251, 0, s[44:45]
    v_cndmask_b32 v253, v253, 0, s[44:45]
f_a3m:
    v_cvt_pk_f16_f32 v22, v251, v252
    v_cvt_pk_f16_f32 v23, v253, v254
    v_and_b32 v248, 3, v0
    v_bfe_u32 v249, v0, 2, 1
    v_bfe_u32 v250, v0, 3, 2
    v_bfe_u32 v251, v0, 5, 1
    v_lshlrev_b32 v13, 10, v249
    v_lshl_add_u32 v15, v251, 8, v13
    v_lshl_add_u32 v15, v250, 6, v15
    v_lshl_add_u32 v15, v248, 4, v15
    v_lshl_add_u32 v13, v250, 8, v13
    v_lshl_add_u32 v13, v248, 6, v13
    v_lshl_add_u32 v13, v251, 5, v13
    v_xor_b32 v14, 2016, v13
    v_add_u32 v13, s68, v13
    v_add_u32 v14, s68, v14
    s_waitcnt vmcnt(4)
    s_barrier
    ds_read_b128 v[200:203], v13 offset:0
    ds_read_b128 v[204:207], v13 offset:16
    ds_read_b128 v[208:211], v14 offset:2048
    ds_read_b128 v[212:215], v14 offset:2064
    s_cmp_lg_u32 s16, 0
    s_cbranch_scc1 f_sb2
    v_add_u32 v116, 160768, v3
    s_mov_b64 exec, 0xff
    ds_read_b128 v[112:115], v116
    s_waitcnt lgkmcnt(0)
    buffer_store_dwordx4 v[112:115], v3, s[12:15], s63 offen sc1
    s_mov_b64 exec, -1
f_sb2:
    s_lshl_b32 s42, s3, 13
    s_lshl_b32 s43, s16, 10
    s_add_u32 s42, s42, s43
    s_add_u32 s42, s42, 18874368
    v_mov_b32 v40, -1
    v_mov_b32 v41, -1
    v_mov_b32 v42, -1
    v_mov_b32 v43, -1
    buffer_store_dwordx4 v[40:43], v3, s[12:15], s42 offen sc1
    v_lshrrev_b32 v18, 3, v2
    v_lshlrev_b32 v18, 14, v18
    v_and_b32 v248, 0x70, v3
    v_add_u32 v18, v18, v248
    s_lshl_b32 s80, s3, 7
    s_add_u32 s80, s80, 17039360
    s_cmp_lg_u32 s16, 0
    s_cbranch_scc1 f_nkw
    v_mov_b32 v248, 0
    v_not_b32 v249, s32
    v_mov_b32 v250, 0
    v_not_b32 v251, s33
    buffer_store_dwordx4 v[248:251], v18, s[12:15], s80 offen sc1
f_nkw:
    v_lshlrev_b32 v18, 14, v2
    s_lshl_b32 s72, s3, 15
    s_lshl_b32 s73, s37, 12
    s_add_u32 s72, s72, s73
    s_add_u32 s72, s72, 1048576
    s_waitcnt lgkmcnt(0)
    ds_read_b128 v[88:91], v3 offset:0
    ds_read_b128 v[92:95], v3 offset:1024
    ds_read_b128 v[96:99], v3 offset:2048
    ds_read_b128 v[100:103], v3 offset:3072
    ds_read_b128 v[104:107], v3 offset:4096
    ds_read_b128 v[108:111], v3 offset:5120
    ds_read_b128 v[112:115], v3 offset:6144
    ds_read_b128 v[116:119], v3 offset:7168
    ds_read_b128 v[120:123], v3 offset:8192
    ds_read_b128 v[124:127], v3 offset:9216
    ds_read_b128 v[128:131], v3 offset:10240
    ds_read_b128 v[132:135], v3 offset:11264
    ds_read_b128 v[136:139], v3 offset:12288
    ds_read_b128 v[140:143], v3 offset:13312
    ds_read_b128 v[144:147], v3 offset:14336
    ds_read_b128 v[148:151], v3 offset:15360
    v_lshlrev_b32 v152, 16, v200
    v_and_b32 v153, 0xffff0000, v200
    v_lshlrev_b32 v154, 16, v201
    v_and_b32 v155, 0xffff0000, v201
    v_lshlrev_b32 v156, 16, v202
    v_and_b32 v157, 0xffff0000, v202
    v_lshlrev_b32 v158, 16, v203
    v_and_b32 v159, 0xffff0000, v203
    v_lshlrev_b32 v160, 16, v204
    v_and_b32 v161, 0xffff0000, v204
    v_lshlrev_b32 v162, 16, v205
    v_and_b32 v163, 0xffff0000, v205
    v_lshlrev_b32 v164, 16, v206
    v_and_b32 v165, 0xffff0000, v206
    v_lshlrev_b32 v166, 16, v207
    v_and_b32 v167, 0xffff0000, v207
    v_lshlrev_b32 v168, 16, v208
    v_and_b32 v183, 0xffff0000, v208
    v_lshlrev_b32 v182, 16, v209
    v_and_b32 v181, 0xffff0000, v209
    v_lshlrev_b32 v180, 16, v210
    v_and_b32 v179, 0xffff0000, v210
    v_lshlrev_b32 v178, 16, v211
    v_and_b32 v177, 0xffff0000, v211
    v_lshlrev_b32 v176, 16, v212
    v_and_b32 v175, 0xffff0000, v212
    v_lshlrev_b32 v174, 16, v213
    v_and_b32 v173, 0xffff0000, v213
    v_lshlrev_b32 v172, 16, v214
    v_and_b32 v171, 0xffff0000, v214
    v_lshlrev_b32 v170, 16, v215
    v_and_b32 v169, 0xffff0000, v215
    s_waitcnt vmcnt(1)
    s_barrier
    buffer_load_dwordx4 v[24:27], v3, s[12:15], s72 offen offset:0 sc1
    buffer_load_dwordx4 v[28:31], v3, s[12:15], s72 offen offset:1024 sc1
    buffer_load_dwordx4 v[32:35], v3, s[12:15], s72 offen offset:2048 sc1
    buffer_load_dwordx4 v[36:39], v3, s[12:15], s72 offen offset:3072 sc1
    v_xor_b32 v16, 1520, v15
    v_subrev_u32 v248, s68, v13
    v_add_u32 v248, 32, v248
    v_bfe_u32 v19, v248, 5, 1
    v_lshlrev_b32 v19, 5, v19
    v_bfe_u32 v249, v248, 8, 2
    v_lshl_add_u32 v19, v249, 3, v19
    v_bfe_u32 v249, v248, 10, 1
    v_lshl_add_u32 v19, v249, 2, v19
    v_bfe_u32 v249, v248, 6, 2
    v_add_lshl_u32 v19, v249, v19, 2
    s_lshl_b32 s74, s34, 14
    s_add_u32 s74, s74, 17039360
    s_lshl_b32 s42, s37, 9
    s_add_u32 s42, s42, 61440
    v_add_u32 v12, s42, v12
    s_mul_i32 s17, s34, 7
    s_lshr_b32 s42, s35, 1
    s_add_u32 s17, s17, s42
    s_lshl_b32 s42, s17, 6
    s_lshr_b32 s43, s16, 2
    s_lshl_b32 s43, s43, 5
    s_add_u32 s42, s42, s43
    s_and_b32 s43, s16, 1
    s_lshl_b32 s43, s43, 4
    s_add_u32 s42, s42, s43
    s_and_b32 s43, s16, 2
    s_lshl_b32 s43, s43, 1
    s_add_u32 s42, s42, s43
    s_lshl_b32 s38, s42, 11
    s_and_b32 s43, s35, 1
    s_lshl_b32 s43, s43, 10
    s_add_u32 s38, s38, s43
    s_lshl_b32 s39, s16, 13
    s_add_u32 s39, s39, 94208
    s_mov_b32 s48, s28
    s_mov_b32 s49, s29
    s_mov_b32 s50, 7340032
    s_mov_b32 s51, 0x00020000
    v_lshlrev_b32 v17, 7, v4
    s_and_b32 s40, s16, 3
    s_lshl_b32 s76, s40, 10
    v_add_u32 v4, s76, v3
    v_xor_b32 v6, 1008, v3
    s_sub_u32 s42, 4096, s76
    s_and_b32 s42, s42, 3072
    v_add_u32 v5, s42, v6
    s_sub_u32 s42, 3072, s76
    v_add_u32 v6, s42, v6
    v_subrev_u32 v248, s68, v13
    v_lshrrev_b32 v248, 1, v248
    s_lshl_b32 s42, s40, 2
    v_add_u32 v248, s42, v248
    v_bfe_u32 v235, v248, 7, 1
    v_lshlrev_b32 v235, 9, v235
    v_and_b32 v249, 31, v248
    v_lshl_add_u32 v235, v249, 4, v235
    v_bfe_u32 v249, v248, 8, 1
    v_lshl_add_u32 v235, v249, 3, v235
    v_lshrrev_b32 v249, 9, v248
    v_lshl_add_u32 v235, v249, 10, v235
    v_bfe_u32 v249, v248, 5, 2
    v_lshl_add_u32 v235, v249, 1, v235
    v_mov_b32 v8, s32
    v_mov_b32 v9, s33
    v_and_b32 v10, 1, v0
    v_cmp_eq_u32 vcc, 1, v10
    s_nop 1
    v_cndmask_b32 v8, v8, v9, vcc
    v_bfe_u32 v9, v8, 8, 8
    v_bfe_u32 v10, v8, 16, 8
    v_lshrrev_b32 v11, 24, v8
    v_and_b32 v8, 0xff, v8
    s_add_u32 s76, s76, 16875520
    s_mov_b32 s77, 16850944
    s_xor_b32 s79, s35, 1
    s_xor_b32 s43, s16, 5
    s_or_b32 s79, s79, s43
    s_cmp_ge_u32 s16, 4
    s_cselect_b32 s64, 4, 1
    s_cselect_b32 s65, 3, 2
    s_lshl_b32 s64, s64, 12
    s_lshl_b32 s65, s65, 12
    s_add_u32 s64, s64, s76
    s_add_u32 s65, s65, s76
    s_lshl_b32 s42, s16, 12
    s_add_u32 s42, s42, 61440
    v_add_u32 v7, s42, v3
    s_cmp_eq_u32 s3, 0
    s_cselect_b64 s[52:53], -1, 1
    v_mov_b32 v192, v8
    v_mov_b32 v193, v9
    v_mov_b32 v194, v10
    v_mov_b32 v195, v11
    s_waitcnt vmcnt(3)
    buffer_load_dwordx4 v[184:187], v3, s[12:15], s64 offen sc1
    buffer_load_dwordx4 v[188:191], v3, s[12:15], s65 offen sc1
    s_mov_b64 exec, 0xffff
    buffer_load_dwordx4 v[236:239], v17, s[12:15], s77 offen sc1
    s_mov_b64 exec, s[52:53]
    buffer_load_dwordx4 v[192:195], v3, s[12:15], s76 offen sc1
    s_mov_b64 exec, -1
    s_mov_b32 s83, 0
    s_waitcnt vmcnt(6)
f_zc:
    v_xor_b32 v40, v24, v244
    v_xor_b32 v41, v28, v244
    v_xor_b32 v42, v25, v245
    v_xor_b32 v43, v29, v245
    v_xor_b32 v44, v26, v246
    v_xor_b32 v45, v30, v246
    v_xor_b32 v46, v27, v247
    v_xor_b32 v47, v31, v247
    v_mfma_f32_16x16x16_f16 v[56:59], v[22:23], v[40:41], 0
    v_or3_b32 v248, v40, v41, 0
    v_mfma_f32_16x16x16_f16 v[64:67], v[22:23], v[44:45], 0
    v_or3_b32 v248, v44, v45, v248
    v_mfma_f32_16x16x16_f16 v[60:63], v[22:23], v[42:43], 0
    v_or3_b32 v248, v42, v43, v248
    v_mfma_f32_16x16x16_f16 v[68:71], v[22:23], v[46:47], 0
    v_or3_b32 v248, v46, v47, v248
    s_waitcnt vmcnt(4)
    v_xor_b32 v48, v32, v244
    v_xor_b32 v49, v36, v244
    v_xor_b32 v50, v33, v245
    v_xor_b32 v51, v37, v245
    v_xor_b32 v52, v34, v246
    v_xor_b32 v53, v38, v246
    v_xor_b32 v54, v35, v247
    v_xor_b32 v55, v39, v247
    v_mfma_f32_16x16x16_f16 v[72:75], v[22:23], v[48:49], 0
    v_or3_b32 v248, v48, v49, v248
    v_mfma_f32_16x16x16_f16 v[80:83], v[22:23], v[52:53], 0
    v_or3_b32 v248, v52, v53, v248
    v_mfma_f32_16x16x16_f16 v[76:79], v[22:23], v[50:51], 0
    v_or3_b32 v248, v50, v51, v248
    v_mfma_f32_16x16x16_f16 v[84:87], v[22:23], v[54:55], 0
    v_or3_b32 v248, v54, v55, v248
    v_and_b32 v248, s54, v248
    v_cmp_ne_u32 vcc, 0, v248
    s_cbranch_vccnz f_zr
f_zx:
    v_cvt_pk_f16_f32 v24, v56, v57
    v_cvt_pk_f16_f32 v25, v64, v65
    v_cvt_pk_f16_f32 v26, v72, v73
    v_cvt_pk_f16_f32 v27, v80, v81
    ds_write_b128 v12, v[24:27] offset:0
    v_cvt_pk_f16_f32 v28, v58, v59
    v_cvt_pk_f16_f32 v29, v66, v67
    v_cvt_pk_f16_f32 v30, v74, v75
    v_cvt_pk_f16_f32 v31, v82, v83
    ds_write_b128 v12, v[28:31] offset:4096
    v_cvt_pk_f16_f32 v32, v60, v61
    v_cvt_pk_f16_f32 v33, v68, v69
    v_cvt_pk_f16_f32 v34, v76, v77
    v_cvt_pk_f16_f32 v35, v84, v85
    ds_write_b128 v12, v[32:35] offset:256
    v_cvt_pk_f16_f32 v36, v62, v63
    v_cvt_pk_f16_f32 v37, v70, v71
    v_cvt_pk_f16_f32 v38, v78, v79
    v_cvt_pk_f16_f32 v39, v86, v87
    ds_write_b128 v12, v[36:39] offset:4352
    s_mov_b32 s83, 0
    s_waitcnt vmcnt(0)
f_pv:
    v_xor_b32 v184, v8, v184
    v_xor_b32 v185, v9, v185
    v_xor_b32 v186, v10, v186
    v_xor_b32 v187, v11, v187
    v_xor_b32 v188, v8, v188
    v_xor_b32 v189, v9, v189
    v_xor_b32 v190, v10, v190
    v_xor_b32 v191, v11, v191
    v_xor_b32 v192, v8, v192
    v_xor_b32 v193, v9, v193
    v_xor_b32 v194, v10, v194
    v_xor_b32 v195, v11, v195
    v_or3_b32 v248, v184, v185, 0
    v_or3_b32 v248, v186, v187, v248
    v_or3_b32 v248, v188, v189, v248
    v_or3_b32 v248, v190, v191, v248
    v_or3_b32 v248, v192, v193, v248
    v_or3_b32 v248, v194, v195, v248
    v_cmp_ne_u64 s[44:45], s[32:33], v[236:237]
    v_and_b32 v248, 0xff, v248
    v_cmp_ne_u32 vcc, 0, v248
    v_add_f32_dpp v239, v238, v238 quad_perm:[1,0,3,2] row_mask:0xf bank_mask:0xf
    s_and_b32 s44, s44, 0xffff
    s_or_b32 vcc_lo, vcc_lo, s44
    s_cbranch_vccnz f_pr
f_pw:
    v_add_f32_dpp v239, v239, v239 quad_perm:[2,3,0,1] row_mask:0xf bank_mask:0xf
    s_cmp_ge_u32 s16, 4
    s_cbranch_scc1 f_ph
    v_max_f32_dpp v238, v238, v238 quad_perm:[1,0,3,2] row_mask:0xf bank_mask:0xf
    s_nop 1
    v_max_f32_dpp v238, v238, v238 quad_perm:[2,3,0,1] row_mask:0xf bank_mask:0xf
    s_nop 1
    v_max_f32_dpp v238, v238, v238 row_half_mirror row_mask:0xf bank_mask:0xf
    v_frexp_exp_i32_f32 v238, v238
    s_nop 0
    v_readfirstlane_b32 s42, v238
    s_sub_u32 s43, -1, s42
    s_add_u32 s44, s42, 5
    s_sub_u32 s45, 5, s42
    v_ldexp_f32 v184, v184, s43
    v_ldexp_f32 v185, v185, s43
    v_ldexp_f32 v186, v186, s43
    v_ldexp_f32 v187, v187, s43
    v_cvt_pk_f16_f32 v184, v184, v185
    v_cvt_pk_f16_f32 v186, v186, v187
    ds_write_b16 v235, v184 offset:16384
    ds_write_b16_d16_hi v235, v184 offset:16400
    ds_write_b16 v235, v186 offset:16416
    ds_write_b16_d16_hi v235, v186 offset:16432
    v_ldexp_f32 v188, v188, s44
    v_ldexp_f32 v189, v189, s44
    v_ldexp_f32 v190, v190, s44
    v_ldexp_f32 v191, v191, s44
    ds_write_b128 v4, v[188:191] offset:20480
    ds_write_b32 v5, v188 offset:24576
    ds_write_b32 v6, v189 offset:24588
    ds_write_b32 v6, v190 offset:24584
    ds_write_b32 v6, v191 offset:24580
    s_cmp_lg_u32 s3, 0
    s_cbranch_scc1 f_pvx
    v_ldexp_f32 v192, v192, s45
    v_ldexp_f32 v193, v193, s45
    v_ldexp_f32 v194, v194, s45
    v_ldexp_f32 v195, v195, s45
    v_and_b32 v248, 0x3f0, v235
    v_bfe_u32 v249, v235, 10, 1
    v_lshl_add_u32 v248, v249, 11, v248
    v_bfe_u32 v249, v235, 3, 1
    v_lshl_add_u32 v248, v249, 10, v248
    v_and_b32 v249, 6, v235
    v_lshl_add_u32 v248, v249, 1, v248
    v_cvt_f16_f32 v192, v192
    ds_write_b32 v248, v192 offset:0
    v_cvt_f16_f32 v193, v193
    ds_write_b32 v248, v193 offset:16
    v_cvt_f16_f32 v194, v194
    ds_write_b32 v248, v194 offset:32
    v_cvt_f16_f32 v195, v195
    ds_write_b32 v248, v195 offset:48
    s_branch f_pvx
f_ph:
    ds_write_b128 v4, v[184:187] offset:28672
    ds_write_b32 v5, v184 offset:32768
    ds_write_b32 v6, v185 offset:32780
    ds_write_b32 v6, v186 offset:32776
    ds_write_b32 v6, v187 offset:32772
    ds_write_b128 v4, v[188:191] offset:36864
    ds_write_b32 v5, v188 offset:40960
    ds_write_b32 v6, v189 offset:40972
    ds_write_b32 v6, v190 offset:40968
    ds_write_b32 v6, v191 offset:40964
f_pvx:
    v_readlane_b32 s66, v239, 12
    s_waitcnt lgkmcnt(0)
    s_barrier
    ds_read_b128 v[248:251], v3 offset:16384
    ds_read_b128 v[24:27], v7 offset:0
    ds_read_b128 v[28:31], v7 offset:1024
    ds_read_b128 v[252:255], v3 offset:17408
    ds_read_b128 v[32:35], v7 offset:2048
    ds_read_b128 v[36:39], v7 offset:3072
    s_cmp_eq_u32 s30, 0
    s_cbranch_scc1 f_sp
    s_waitcnt lgkmcnt(4)
    v_pk_mul_f16 v40, v24, v248 op_sel:[0,0] op_sel_hi:[1,0]
    v_pk_mul_f16 v41, v25, v248 op_sel:[0,1] op_sel_hi:[1,1]
    v_pk_mul_f16 v42, v26, v249 op_sel:[0,0] op_sel_hi:[1,0]
    v_pk_mul_f16 v43, v27, v249 op_sel:[0,1] op_sel_hi:[1,1]
    s_nop 1
    v_mfma_f32_32x32x16_f16 v[56:71], v[40:43], v[88:91], 0
    s_waitcnt lgkmcnt(3)
    v_pk_mul_f16 v44, v28, v250 op_sel:[0,0] op_sel_hi:[1,0]
    v_pk_mul_f16 v45, v29, v250 op_sel:[0,1] op_sel_hi:[1,1]
    v_pk_mul_f16 v46, v30, v251 op_sel:[0,0] op_sel_hi:[1,0]
    v_pk_mul_f16 v47, v31, v251 op_sel:[0,1] op_sel_hi:[1,1]
    v_mfma_f32_32x32x16_f16 v[72:87], v[40:43], v[104:107], 0
    s_waitcnt lgkmcnt(1)
    v_pk_mul_f16 v48, v32, v252 op_sel:[0,0] op_sel_hi:[1,0]
    v_pk_mul_f16 v49, v33, v252 op_sel:[0,1] op_sel_hi:[1,1]
    v_pk_mul_f16 v50, v34, v253 op_sel:[0,0] op_sel_hi:[1,0]
    v_pk_mul_f16 v51, v35, v253 op_sel:[0,1] op_sel_hi:[1,1]
    v_mfma_f32_32x32x16_f16 v[56:71], v[44:47], v[92:95], v[56:71]
    s_waitcnt lgkmcnt(0)
    v_pk_mul_f16 v52, v36, v254 op_sel:[0,0] op_sel_hi:[1,0]
    v_pk_mul_f16 v53, v37, v254 op_sel:[0,1] op_sel_hi:[1,1]
    v_pk_mul_f16 v54, v38, v255 op_sel:[0,0] op_sel_hi:[1,0]
    v_pk_mul_f16 v55, v39, v255 op_sel:[0,1] op_sel_hi:[1,1]
    v_mfma_f32_32x32x16_f16 v[72:87], v[44:47], v[108:111], v[72:87]
f_st1:
    v_mfma_f32_32x32x16_f16 v[56:71], v[48:51], v[96:99], v[56:71]
    ds_read_b128 v[184:187], v3 offset:20480
    ds_read_b128 v[188:191], v3 offset:21504
    v_mfma_f32_32x32x16_f16 v[72:87], v[48:51], v[112:115], v[72:87]
    ds_read_b128 v[192:195], v3 offset:22528
    ds_read_b128 v[196:199], v3 offset:23552
    v_mfma_f32_32x32x16_f16 v[56:71], v[52:55], v[100:103], v[56:71]
    ds_read_b128 v[200:203], v3 offset:24576
    ds_read_b128 v[204:207], v3 offset:25600
    v_mfma_f32_32x32x16_f16 v[72:87], v[52:55], v[116:119], v[72:87]
    ds_read_b128 v[208:211], v3 offset:26624
    ds_read_b128 v[212:215], v3 offset:27648
    s_cmp_ge_u32 s35, 14
    s_cbranch_scc1 f_nd1
    s_add_u32 s43, s39, 0
    s_mov_b32 m0, s43
    s_add_u32 s42, s38, 0
    buffer_load_dwordx4 v3, s[48:51], s42 offen nt lds
    s_add_u32 s43, s39, 1024
    s_mov_b32 m0, s43
    s_add_u32 s42, s38, 2048
    v_xor_b32 v7, 32, v3
    buffer_load_dwordx4 v7, s[48:51], s42 offen nt lds
    s_add_u32 s43, s39, 2048
    s_mov_b32 m0, s43
    s_add_u32 s42, s38, 4096
    v_xor_b32 v7, 64, v3
    buffer_load_dwordx4 v7, s[48:51], s42 offen nt lds
f_nd1:
    s_cmp_eq_u32 s30, 0
    s_cbranch_scc1 f_sp2
    v_pk_mul_f32 v[24:25], v[56:57], v[120:121]
    v_pk_mul_f32 v[28:29], v[72:73], v[120:121]
    v_pk_mul_f32 v[26:27], v[58:59], v[122:123]
    v_pk_mul_f32 v[30:31], v[74:75], v[122:123]
    v_pk_fma_f32 v[24:25], v[72:73], v[136:137], v[24:25]
    v_pk_fma_f32 v[28:29], v[56:57], v[136:137], v[28:29] neg_lo:[1,0,0] neg_hi:[1,0,0]
    v_pk_fma_f32 v[26:27], v[74:75], v[138:139], v[26:27]
    v_pk_fma_f32 v[30:31], v[58:59], v[138:139], v[30:31] neg_lo:[1,0,0] neg_hi:[1,0,0]
    v_cvt_pk_f16_f32 v40, v24, v28
    v_cvt_pk_f16_f32 v41, v25, v29
    v_cvt_pk_f16_f32 v42, v26, v30
    v_cvt_pk_f16_f32 v43, v27, v31
    ds_read_b128 v[216:219], v3 offset:28672
    ds_read_b128 v[220:223], v3 offset:29696
    ds_read_b128 v[224:227], v3 offset:30720
    ds_read_b128 v[228:231], v3 offset:31744
    v_pk_mul_f32 v[32:33], v[60:61], v[124:125]
    v_pk_mul_f32 v[36:37], v[76:77], v[124:125]
    v_pk_mul_f32 v[34:35], v[62:63], v[126:127]
    v_pk_mul_f32 v[38:39], v[78:79], v[126:127]
    v_pk_fma_f32 v[32:33], v[76:77], v[140:141], v[32:33]
    v_pk_fma_f32 v[36:37], v[60:61], v[140:141], v[36:37] neg_lo:[1,0,0] neg_hi:[1,0,0]
    v_pk_fma_f32 v[34:35], v[78:79], v[142:143], v[34:35]
    v_pk_fma_f32 v[38:39], v[62:63], v[142:143], v[38:39] neg_lo:[1,0,0] neg_hi:[1,0,0]
    v_cvt_pk_f16_f32 v44, v32, v36
    v_cvt_pk_f16_f32 v45, v33, v37
    v_cvt_pk_f16_f32 v46, v34, v38
    v_cvt_pk_f16_f32 v47, v35, v39
    v_mfma_f32_32x32x16_f16 v[104:119], v[40:43], v[88:91], 0
    ds_read_b128 v[232:235], v3 offset:32768
    ds_read_b128 v[236:239], v3 offset:33792
    ds_read_b128 v[240:243], v3 offset:34816
    ds_read_b128 v[244:247], v3 offset:35840
    v_pk_mul_f32 v[24:25], v[64:65], v[128:129]
    v_pk_mul_f32 v[28:29], v[80:81], v[128:129]
    v_pk_mul_f32 v[26:27], v[66:67], v[130:131]
    v_pk_mul_f32 v[30:31], v[82:83], v[130:131]
    v_pk_fma_f32 v[24:25], v[80:81], v[144:145], v[24:25]
    v_pk_fma_f32 v[28:29], v[64:65], v[144:145], v[28:29] neg_lo:[1,0,0] neg_hi:[1,0,0]
    v_pk_fma_f32 v[26:27], v[82:83], v[146:147], v[26:27]
    v_pk_fma_f32 v[30:31], v[66:67], v[146:147], v[30:31] neg_lo:[1,0,0] neg_hi:[1,0,0]
    v_cvt_pk_f16_f32 v48, v24, v28
    v_cvt_pk_f16_f32 v49, v25, v29
    v_cvt_pk_f16_f32 v50, v26, v30
    v_cvt_pk_f16_f32 v51, v27, v31
    v_mfma_f32_32x32x16_f16 v[104:119], v[44:47], v[92:95], v[104:119]
    v_pk_mul_f32 v[32:33], v[68:69], v[132:133]
    v_pk_mul_f32 v[36:37], v[84:85], v[132:133]
    v_pk_mul_f32 v[34:35], v[70:71], v[134:135]
    v_pk_mul_f32 v[38:39], v[86:87], v[134:135]
    v_pk_fma_f32 v[32:33], v[84:85], v[148:149], v[32:33]
    v_pk_fma_f32 v[36:37], v[68:69], v[148:149], v[36:37] neg_lo:[1,0,0] neg_hi:[1,0,0]
    v_pk_fma_f32 v[34:35], v[86:87], v[150:151], v[34:35]
    v_pk_fma_f32 v[38:39], v[70:71], v[150:151], v[38:39] neg_lo:[1,0,0] neg_hi:[1,0,0]
    v_cvt_pk_f16_f32 v52, v32, v36
    v_cvt_pk_f16_f32 v53, v33, v37
    v_cvt_pk_f16_f32 v54, v34, v38
    v_cvt_pk_f16_f32 v55, v35, v39
    v_mfma_f32_32x32x16_f16 v[104:119], v[48:51], v[96:99], v[104:119]
    s_nop 0
    v_mfma_f32_32x32x16_f16 v[104:119], v[52:55], v[100:103], v[104:119]
    s_nop 11
    ds_bpermute_b32 v12, v19, v104
    s_waitcnt lgkmcnt(1)
    v_pk_fma_f32 v[152:153], v[184:185], v[104:105], v[152:153]
    v_pk_fma_f32 v[154:155], v[186:187], v[106:107], v[154:155]
    v_pk_fma_f32 v[156:157], v[188:189], v[108:109], v[156:157]
    v_pk_fma_f32 v[158:159], v[190:191], v[110:111], v[158:159]
    v_pk_fma_f32 v[160:161], v[192:193], v[112:113], v[160:161]
    v_pk_fma_f32 v[162:163], v[194:195], v[114:115], v[162:163]
    v_pk_fma_f32 v[164:165], v[196:197], v[116:117], v[164:165]
    v_pk_fma_f32 v[166:167], v[198:199], v[118:119], v[166:167]
    v_pk_fma_f32 v[170:171], v[202:203], v[106:107], v[170:171]
    v_pk_fma_f32 v[172:173], v[204:205], v[108:109], v[172:173]
    v_pk_fma_f32 v[174:175], v[206:207], v[110:111], v[174:175]
    v_pk_fma_f32 v[176:177], v[208:209], v[112:113], v[176:177]
    v_pk_fma_f32 v[178:179], v[210:211], v[114:115], v[178:179]
    v_pk_fma_f32 v[180:181], v[212:213], v[116:117], v[180:181]
    v_pk_fma_f32 v[182:183], v[214:215], v[118:119], v[182:183]
    v_fmac_f32 v169, v201, v105
    s_waitcnt lgkmcnt(0)
    v_fmac_f32 v168, v200, v12
f_join:
    ds_read_b128 v[88:91], v3 offset:36864
    ds_read_b128 v[92:95], v3 offset:37888
    ds_read_b128 v[96:99], v3 offset:38912
    ds_read_b128 v[100:103], v3 offset:39936
    ds_read_b128 v[120:123], v3 offset:40960
    ds_read_b128 v[124:127], v3 offset:41984
    ds_read_b128 v[128:131], v3 offset:43008
    ds_read_b128 v[132:135], v3 offset:44032
    v_lshrrev_b32 v17, 3, v0
    v_and_b32 v17, 60, v17
    v_add_u32 v17, 159744, v17
    v_and_b32 v7, 0xf0, v3
    v_lshrrev_b32 v7, 2, v7
    v_add_u32 v7, 159744, v7
    v_pk_add_f32 v[40:41], v[166:167], v[164:165]
    v_pk_add_f32 v[48:49], v[182:183], v[180:181]
    v_pk_add_f32 v[40:41], v[40:41], v[162:163]
    v_pk_add_f32 v[48:49], v[48:49], v[178:179]
    v_pk_add_f32 v[40:41], v[40:41], v[160:161]
    v_pk_add_f32 v[48:49], v[48:49], v[176:177]
    v_pk_add_f32 v[40:41], v[40:41], v[158:159]
    v_pk_add_f32 v[48:49], v[48:49], v[174:175]
    v_pk_add_f32 v[40:41], v[40:41], v[156:157]
    v_pk_add_f32 v[48:49], v[48:49], v[172:173]
    v_pk_add_f32 v[40:41], v[40:41], v[154:155]
    v_pk_add_f32 v[48:49], v[48:49], v[170:171]
    v_pk_add_f32 v[40:41], v[40:41], v[152:153]
    v_pk_add_f32 v[48:49], v[48:49], v[168:169]
    v_pk_mul_f32 v[42:43], v[166:167], v[166:167]
    v_pk_mul_f32 v[44:45], v[166:167], v[230:231]
    v_pk_mul_f32 v[50:51], v[182:183], v[182:183]
    v_pk_mul_f32 v[52:53], v[182:183], v[246:247]
    v_pk_fma_f32 v[42:43], v[164:165], v[164:165], v[42:43]
    v_pk_fma_f32 v[44:45], v[164:165], v[228:229], v[44:45]
    v_pk_fma_f32 v[50:51], v[180:181], v[180:181], v[50:51]
    v_pk_fma_f32 v[52:53], v[180:181], v[244:245], v[52:53]
    v_pk_fma_f32 v[42:43], v[162:163], v[162:163], v[42:43]
    v_pk_fma_f32 v[44:45], v[162:163], v[226:227], v[44:45]
    v_pk_fma_f32 v[50:51], v[178:179], v[178:179], v[50:51]
    v_pk_fma_f32 v[52:53], v[178:179], v[242:243], v[52:53]
    v_pk_fma_f32 v[42:43], v[160:161], v[160:161], v[42:43]
    v_pk_fma_f32 v[44:45], v[160:161], v[224:225], v[44:45]
    v_pk_fma_f32 v[50:51], v[176:177], v[176:177], v[50:51]
    v_pk_fma_f32 v[52:53], v[176:177], v[240:241], v[52:53]
    v_pk_fma_f32 v[42:43], v[158:159], v[158:159], v[42:43]
    v_pk_fma_f32 v[44:45], v[158:159], v[222:223], v[44:45]
    v_pk_fma_f32 v[50:51], v[174:175], v[174:175], v[50:51]
    v_pk_fma_f32 v[52:53], v[174:175], v[238:239], v[52:53]
    v_pk_fma_f32 v[42:43], v[156:157], v[156:157], v[42:43]
    v_pk_fma_f32 v[44:45], v[156:157], v[220:221], v[44:45]
    v_pk_fma_f32 v[50:51], v[172:173], v[172:173], v[50:51]
    v_pk_fma_f32 v[52:53], v[172:173], v[236:237], v[52:53]
    v_pk_fma_f32 v[42:43], v[154:155], v[154:155], v[42:43]
    v_pk_fma_f32 v[44:45], v[154:155], v[218:219], v[44:45]
    v_pk_fma_f32 v[50:51], v[170:171], v[170:171], v[50:51]
    v_pk_fma_f32 v[52:53], v[170:171], v[234:235], v[52:53]
    v_pk_fma_f32 v[42:43], v[152:153], v[152:153], v[42:43]
    v_pk_fma_f32 v[44:45], v[152:153], v[216:217], v[44:45]
    v_pk_fma_f32 v[50:51], v[168:169], v[168:169], v[50:51]
    v_pk_fma_f32 v[52:53], v[168:169], v[232:233], v[52:53]
    v_add_f32 v24, v40, v41
    v_add_f32 v25, v42, v43
    v_add_f32 v26, v44, v45
    v_add_f32 v28, v48, v49
    v_add_f32 v29, v50, v51
    v_add_f32 v30, v52, v53
    s_cmp_eq_u32 s79, 0
    s_cbranch_scc1 f_go
f_ngo:
    v_permlane32_swap_b32 v24, v28
    v_permlane32_swap_b32 v25, v29
    v_permlane32_swap_b32 v26, v30
    v_add_f32 v24, v24, v28
    v_add_f32 v25, v25, v29
    v_add_f32 v26, v26, v30
    v_add_f32_dpp v24, v24, v24 row_ror:8 row_mask:0xf bank_mask:0xf
    v_add_f32_dpp v25, v25, v25 row_ror:8 row_mask:0xf bank_mask:0xf
    v_add_f32_dpp v26, v26, v26 row_ror:8 row_mask:0xf bank_mask:0xf
    v_add_f32_dpp v24, v24, v24 row_ror:4 row_mask:0xf bank_mask:0xf
    v_add_f32_dpp v25, v25, v25 row_ror:4 row_mask:0xf bank_mask:0xf
    v_add_f32_dpp v26, v26, v26 row_ror:4 row_mask:0xf bank_mask:0xf
    v_add_f32_dpp v24, v24, v24 row_ror:2 row_mask:0xf bank_mask:0xf
    v_add_f32_dpp v25, v25, v25 row_ror:2 row_mask:0xf bank_mask:0xf
    v_add_f32_dpp v26, v26, v26 row_ror:2 row_mask:0xf bank_mask:0xf
    v_add_f32_dpp v24, v24, v24 row_ror:1 row_mask:0xf bank_mask:0xf
    v_add_f32_dpp v25, v25, v25 row_ror:1 row_mask:0xf bank_mask:0xf
    v_add_f32_dpp v26, v26, v26 row_ror:1 row_mask:0xf bank_mask:0xf
    v_add_f32_dpp v24, v24, v24 row_bcast:15 row_mask:0xa bank_mask:0xf
    v_add_f32_dpp v25, v25, v25 row_bcast:15 row_mask:0xa bank_mask:0xf
    v_add_f32_dpp v26, v26, v26 row_bcast:15 row_mask:0xa bank_mask:0xf
    v_mul_f32 v24, 0x3a800000, v24
    v_mul_f32 v25, 0x3a800000, v25
    v_mul_f32 v28, v24, v24
    v_fma_f32 v26, -v24, s66, v26
    v_sub_f32 v25, v25, v28
    v_mul_f32 v29, 4.0, v25
    v_cmp_gt_f32 vcc, v28, v29
    v_lshrrev_b32 v30, 4, v0
    s_lshl_b32 s43, s3, 5
    v_and_or_b32 v30, v30, 30, s43
    s_or_b32 s42, vcc_lo, vcc_hi
    s_bitcmp1_b32 s42, 31
    s_cbranch_scc1 f_slow2
f_var2:
    v_cvt_pk_bf16_f32 v25, v25, v25
    v_lshlrev_b32 v25, 16, v25
    v_add_f32 v25, 0x3727c5ac, v25
    v_cvt_pk_bf16_f32 v25, v25, v25
    v_lshlrev_b32 v25, 16, v25
    v_sqrt_f32 v25, v25
    s_nop 0
    v_cvt_pk_bf16_f32 v25, v25, v25
    v_lshlrev_b32 v25, 16, v25
    v_rcp_f32 v25, v25
    s_mov_b32 s42, 0x80000000
    s_movk_i32 s43, 0xf000
    s_mov_b32 exec_lo, s42
    s_mov_b32 exec_hi, s42
    v_mul_f32 v26, v26, v25
    v_ashrrev_i32 v28, 31, v26
    v_or_b32 v28, s42, v28
    v_xor_b32 v26, v26, v28
    v_and_or_b32 v26, v26, s43, v30
    ds_write_b32 v17, v26
    v_mul_f32 v24, -v24, v25
    s_mov_b64 exec, -1
    v_readlane_b32 s60, v26, 31
    v_readlane_b32 s56, v24, 31
    v_readlane_b32 s57, v25, 31
    v_readlane_b32 s61, v26, 63
    v_readlane_b32 s58, v24, 63
    v_readlane_b32 s59, v25, 63
    s_waitcnt lgkmcnt(0)
    s_barrier
    ds_read_b32 v32, v7
    s_waitcnt lgkmcnt(0)
    v_cmp_lt_u32 vcc, s60, v32
    v_cmp_lt_u32 s[44:45], s61, v32
    s_and_b32 s62, vcc_lo, 0xffff
    s_and_b32 s63, s44, 0xffff
    s_bcnt1_i32_b32 s62, s62
    s_bcnt1_i32_b32 s63, s63
    s_add_u32 s42, s62, s63
    s_cmp_eq_u32 s42, 1
    s_cbranch_scc1 f_both
    s_cmp_ge_u32 s62, 2
    s_cbranch_scc1 f_nc0
f_cand0:
    s_setprio 2
    s_or_b32 s42, s60, s62
    s_cmp_eq_u32 s62, 0
    s_cselect_b32 s43, s32, s33
    v_mov_b32 v34, s42
    v_mov_b32 v35, s43
    s_lshl_b32 s42, s62, 3
    s_add_u32 s42, s42, s80
    s_mov_b64 exec, 0xff
    buffer_store_dwordx2 v[34:35], v18, s[12:15], s42 offen sc1
    s_mov_b64 exec, -1
    s_lshl_b32 s43, s3, 1
    s_add_u32 s42, s62, s43
    s_lshl_b32 s42, s42, 12
    s_add_u32 s42, s42, 18874368
    v_pk_fma_f32 v[56:57], v[152:153], s[56:57], s[56:57] op_sel:[0,1,0] op_sel_hi:[1,1,0]
    v_pk_fma_f32 v[58:59], v[154:155], s[56:57], s[56:57] op_sel:[0,1,0] op_sel_hi:[1,1,0]
    v_pk_fma_f32 v[60:61], v[156:157], s[56:57], s[56:57] op_sel:[0,1,0] op_sel_hi:[1,1,0]
    v_pk_fma_f32 v[62:63], v[158:159], s[56:57], s[56:57] op_sel:[0,1,0] op_sel_hi:[1,1,0]
    v_pk_fma_f32 v[64:65], v[160:161], s[56:57], s[56:57] op_sel:[0,1,0] op_sel_hi:[1,1,0]
    v_pk_fma_f32 v[66:67], v[162:163], s[56:57], s[56:57] op_sel:[0,1,0] op_sel_hi:[1,1,0]
    v_pk_fma_f32 v[68:69], v[164:165], s[56:57], s[56:57] op_sel:[0,1,0] op_sel_hi:[1,1,0]
    v_pk_fma_f32 v[70:71], v[166:167], s[56:57], s[56:57] op_sel:[0,1,0] op_sel_hi:[1,1,0]
    v_pk_mul_f32 v[56:57], v[56:57], v[88:89]
    v_pk_mul_f32 v[58:59], v[58:59], v[90:91]
    v_pk_mul_f32 v[60:61], v[60:61], v[92:93]
    v_pk_mul_f32 v[62:63], v[62:63], v[94:95]
    v_pk_mul_f32 v[64:65], v[64:65], v[96:97]
    v_pk_mul_f32 v[66:67], v[66:67], v[98:99]
    v_pk_mul_f32 v[68:69], v[68:69], v[100:101]
    v_pk_mul_f32 v[70:71], v[70:71], v[102:103]
    v_cvt_pk_bf16_f32 v216, v56, v57
    v_cvt_pk_bf16_f32 v217, v58, v59
    v_cvt_pk_bf16_f32 v218, v60, v61
    v_cvt_pk_bf16_f32 v219, v62, v63
    v_cvt_pk_bf16_f32 v220, v64, v65
    v_cvt_pk_bf16_f32 v221, v66, v67
    v_cvt_pk_bf16_f32 v222, v68, v69
    v_cvt_pk_bf16_f32 v223, v70, v71
    v_min_u32 v216, -2, v216
    v_min_u32 v217, -2, v217
    v_min_u32 v218, -2, v218
    v_min_u32 v219, -2, v219
    buffer_store_dwordx4 v[216:219], v15, s[12:15], s42 offen offset:0 sc1
    v_min_u32 v220, -2, v220
    v_min_u32 v221, -2, v221
    v_min_u32 v222, -2, v222
    v_min_u32 v223, -2, v223
    buffer_store_dwordx4 v[220:223], v15, s[12:15], s42 offen offset:512 sc1
    v_cvt_pk_bf16_f32 v40, v152, v153
    v_cvt_pk_bf16_f32 v41, v154, v155
    v_cvt_pk_bf16_f32 v42, v156, v157
    v_cvt_pk_bf16_f32 v43, v158, v159
    v_cvt_pk_bf16_f32 v44, v160, v161
    v_cvt_pk_bf16_f32 v45, v162, v163
    v_cvt_pk_bf16_f32 v46, v164, v165
    v_cvt_pk_bf16_f32 v47, v166, v167
    v_min_u32 v40, -2, v40
    v_min_u32 v41, -2, v41
    v_min_u32 v42, -2, v42
    v_min_u32 v43, -2, v43
    v_min_u32 v44, -2, v44
    v_min_u32 v45, -2, v45
    v_min_u32 v46, -2, v46
    v_min_u32 v47, -2, v47
    buffer_store_dwordx4 v[40:43], v15, s[12:15], s42 offen offset:2048 sc1
    buffer_store_dwordx4 v[44:47], v15, s[12:15], s42 offen offset:2560 sc1
    s_setprio 0
f_nc0:
    s_cmp_ge_u32 s63, 2
    s_cbranch_scc1 f_nc1
f_cand1:
    s_setprio 2
    s_or_b32 s42, s61, s63
    s_cmp_eq_u32 s63, 0
    s_cselect_b32 s43, s32, s33
    v_mov_b32 v34, s42
    v_mov_b32 v35, s43
    s_lshl_b32 s42, s63, 3
    s_add_u32 s42, s42, s80
    s_mov_b64 exec, 0xff
    buffer_store_dwordx2 v[34:35], v18, s[12:15], s42 offen sc1
    s_mov_b64 exec, -1
    s_lshl_b32 s43, s3, 1
    s_add_u32 s42, s63, s43
    s_lshl_b32 s42, s42, 12
    s_add_u32 s42, s42, 18874368
    v_pk_fma_f32 v[72:73], v[168:169], s[58:59], s[58:59] op_sel:[0,1,0] op_sel_hi:[1,1,0]
    v_pk_fma_f32 v[74:75], v[170:171], s[58:59], s[58:59] op_sel:[0,1,0] op_sel_hi:[1,1,0]
    v_pk_fma_f32 v[76:77], v[172:173], s[58:59], s[58:59] op_sel:[0,1,0] op_sel_hi:[1,1,0]
    v_pk_fma_f32 v[78:79], v[174:175], s[58:59], s[58:59] op_sel:[0,1,0] op_sel_hi:[1,1,0]
    v_pk_fma_f32 v[80:81], v[176:177], s[58:59], s[58:59] op_sel:[0,1,0] op_sel_hi:[1,1,0]
    v_pk_fma_f32 v[82:83], v[178:179], s[58:59], s[58:59] op_sel:[0,1,0] op_sel_hi:[1,1,0]
    v_pk_fma_f32 v[84:85], v[180:181], s[58:59], s[58:59] op_sel:[0,1,0] op_sel_hi:[1,1,0]
    v_pk_fma_f32 v[86:87], v[182:183], s[58:59], s[58:59] op_sel:[0,1,0] op_sel_hi:[1,1,0]
    v_pk_mul_f32 v[72:73], v[72:73], v[120:121]
    v_pk_mul_f32 v[74:75], v[74:75], v[122:123]
    v_pk_mul_f32 v[76:77], v[76:77], v[124:125]
    v_pk_mul_f32 v[78:79], v[78:79], v[126:127]
    v_pk_mul_f32 v[80:81], v[80:81], v[128:129]
    v_pk_mul_f32 v[82:83], v[82:83], v[130:131]
    v_pk_mul_f32 v[84:85], v[84:85], v[132:133]
    v_pk_mul_f32 v[86:87], v[86:87], v[134:135]
    v_cvt_pk_bf16_f32 v224, v72, v87
    v_cvt_pk_bf16_f32 v225, v86, v85
    v_cvt_pk_bf16_f32 v226, v84, v83
    v_cvt_pk_bf16_f32 v227, v82, v81
    v_cvt_pk_bf16_f32 v228, v80, v79
    v_cvt_pk_bf16_f32 v229, v78, v77
    v_cvt_pk_bf16_f32 v230, v76, v75
    v_cvt_pk_bf16_f32 v231, v74, v73
    v_min_u32 v224, -2, v224
    v_min_u32 v225, -2, v225
    v_min_u32 v226, -2, v226
    v_min_u32 v227, -2, v227
    buffer_store_dwordx4 v[224:227], v16, s[12:15], s42 offen offset:0 sc1
    v_min_u32 v228, -2, v228
    v_min_u32 v229, -2, v229
    v_min_u32 v230, -2, v230
    v_min_u32 v231, -2, v231
    buffer_store_dwordx4 v[228:231], v16, s[12:15], s42 offen offset:512 sc1
    v_cvt_pk_bf16_f32 v48, v168, v183
    v_cvt_pk_bf16_f32 v49, v182, v181
    v_cvt_pk_bf16_f32 v50, v180, v179
    v_cvt_pk_bf16_f32 v51, v178, v177
    v_cvt_pk_bf16_f32 v52, v176, v175
    v_cvt_pk_bf16_f32 v53, v174, v173
    v_cvt_pk_bf16_f32 v54, v172, v171
    v_cvt_pk_bf16_f32 v55, v170, v169
    v_min_u32 v48, -2, v48
    v_min_u32 v49, -2, v49
    v_min_u32 v50, -2, v50
    v_min_u32 v51, -2, v51
    v_min_u32 v52, -2, v52
    v_min_u32 v53, -2, v53
    v_min_u32 v54, -2, v54
    v_min_u32 v55, -2, v55
    buffer_store_dwordx4 v[48:51], v16, s[12:15], s42 offen offset:2048 sc1
    buffer_store_dwordx4 v[52:55], v16, s[12:15], s42 offen offset:2560 sc1
    s_setprio 0
f_nc1:
    s_lshr_b32 s42, s16, 2
    s_lshl_b32 s43, s42, 13
    s_lshl_b32 s42, s42, 12
    s_add_u32 s64, s76, s42
    s_add_u32 s64, s64, 20480
    v_add_u32 v4, s43, v4
    v_add_u32 v5, s43, v5
    v_add_u32 v6, s43, v6
    buffer_load_dwordx4 v[248:251], v3, s[12:15], s64 offen sc1
    s_barrier
    s_cmp_ge_u32 s35, 14
    s_cbranch_scc1 f_nd2
    s_add_u32 s43, s39, 3072
    s_mov_b32 m0, s43
    s_add_u32 s42, s38, 6144
    v_xor_b32 v7, 96, v3
    buffer_load_dwordx4 v7, s[48:51], s42 offen nt lds
    s_add_u32 s43, s39, 4096
    s_mov_b32 m0, s43
    s_add_u32 s42, s38, 16384
    v_xor_b32 v7, 128, v3
    buffer_load_dwordx4 v7, s[48:51], s42 offen nt lds
    s_add_u32 s43, s39, 5120
    s_mov_b32 m0, s43
    s_add_u32 s42, s38, 18432
    v_xor_b32 v7, 160, v3
    buffer_load_dwordx4 v7, s[48:51], s42 offen nt lds
    s_add_u32 s43, s39, 6144
    s_mov_b32 m0, s43
    s_add_u32 s42, s38, 20480
    v_xor_b32 v7, 192, v3
    buffer_load_dwordx4 v7, s[48:51], s42 offen nt lds
    s_add_u32 s43, s39, 7168
    s_mov_b32 m0, s43
    s_add_u32 s42, s38, 22528
    v_xor_b32 v7, 224, v3
    buffer_load_dwordx4 v7, s[48:51], s42 offen nt lds
f_nd2:
    v_pk_fma_f32 v[56:57], v[152:153], s[56:57], s[56:57] op_sel:[0,1,0] op_sel_hi:[1,1,0]
    v_pk_fma_f32 v[58:59], v[154:155], s[56:57], s[56:57] op_sel:[0,1,0] op_sel_hi:[1,1,0]
    v_pk_fma_f32 v[60:61], v[156:157], s[56:57], s[56:57] op_sel:[0,1,0] op_sel_hi:[1,1,0]
    v_pk_fma_f32 v[62:63], v[158:159], s[56:57], s[56:57] op_sel:[0,1,0] op_sel_hi:[1,1,0]
    v_pk_fma_f32 v[64:65], v[160:161], s[56:57], s[56:57] op_sel:[0,1,0] op_sel_hi:[1,1,0]
    v_pk_fma_f32 v[66:67], v[162:163], s[56:57], s[56:57] op_sel:[0,1,0] op_sel_hi:[1,1,0]
    v_pk_fma_f32 v[68:69], v[164:165], s[56:57], s[56:57] op_sel:[0,1,0] op_sel_hi:[1,1,0]
    v_pk_fma_f32 v[70:71], v[166:167], s[56:57], s[56:57] op_sel:[0,1,0] op_sel_hi:[1,1,0]
    v_pk_fma_f32 v[72:73], v[168:169], s[58:59], s[58:59] op_sel:[0,1,0] op_sel_hi:[1,1,0]
    v_pk_fma_f32 v[74:75], v[170:171], s[58:59], s[58:59] op_sel:[0,1,0] op_sel_hi:[1,1,0]
    v_pk_fma_f32 v[76:77], v[172:173], s[58:59], s[58:59] op_sel:[0,1,0] op_sel_hi:[1,1,0]
    v_pk_fma_f32 v[78:79], v[174:175], s[58:59], s[58:59] op_sel:[0,1,0] op_sel_hi:[1,1,0]
    v_pk_fma_f32 v[80:81], v[176:177], s[58:59], s[58:59] op_sel:[0,1,0] op_sel_hi:[1,1,0]
    v_pk_fma_f32 v[82:83], v[178:179], s[58:59], s[58:59] op_sel:[0,1,0] op_sel_hi:[1,1,0]
    v_pk_fma_f32 v[84:85], v[180:181], s[58:59], s[58:59] op_sel:[0,1,0] op_sel_hi:[1,1,0]
    v_pk_fma_f32 v[86:87], v[182:183], s[58:59], s[58:59] op_sel:[0,1,0] op_sel_hi:[1,1,0]
    s_mov_b32 s83, 0
    s_cmp_ge_u32 s35, 14
    s_cbranch_scc1 f_p2c
    s_waitcnt vmcnt(5)
f_p2e:
    v_xor_b32 v248, v8, v248
    v_xor_b32 v249, v9, v249
    v_xor_b32 v250, v10, v250
    v_xor_b32 v251, v11, v251
    v_or3_b32 v12, v248, v249, 0
    v_or3_b32 v12, v250, v251, v12
    v_and_b32 v12, 0xff, v12
    v_cmp_ne_u32 vcc, 0, v12
    s_cbranch_vccnz f_p2r
f_p2w:
    ds_write_b128 v4, v[248:251] offset:45056
    ds_write_b32 v5, v248 offset:49152
    ds_write_b32 v6, v249 offset:49164
    ds_write_b32 v6, v250 offset:49160
    ds_write_b32 v6, v251 offset:49156
    s_waitcnt lgkmcnt(0)
    s_barrier
    ds_read_b128 v[136:139], v3 offset:45056
    ds_read_b128 v[140:143], v3 offset:46080
    ds_read_b128 v[144:147], v3 offset:47104
    ds_read_b128 v[148:151], v3 offset:48128
    ds_read_b128 v[184:187], v3 offset:53248
    ds_read_b128 v[188:191], v3 offset:54272
    ds_read_b128 v[192:195], v3 offset:55296
    ds_read_b128 v[196:199], v3 offset:56320
    ds_read_b128 v[104:107], v3 offset:49152
    ds_read_b128 v[108:111], v3 offset:50176
    ds_read_b128 v[112:115], v3 offset:51200
    ds_read_b128 v[116:119], v3 offset:52224
    ds_read_b128 v[200:203], v3 offset:57344
    ds_read_b128 v[204:207], v3 offset:58368
    ds_read_b128 v[208:211], v3 offset:59392
    ds_read_b128 v[212:215], v3 offset:60416
    s_waitcnt lgkmcnt(12)
    v_pk_fma_f32 v[56:57], v[56:57], v[88:89], v[136:137]
    v_pk_fma_f32 v[58:59], v[58:59], v[90:91], v[138:139]
    v_pk_fma_f32 v[60:61], v[60:61], v[92:93], v[140:141]
    v_pk_fma_f32 v[62:63], v[62:63], v[94:95], v[142:143]
    v_pk_fma_f32 v[64:65], v[64:65], v[96:97], v[144:145]
    v_pk_fma_f32 v[66:67], v[66:67], v[98:99], v[146:147]
    v_pk_fma_f32 v[68:69], v[68:69], v[100:101], v[148:149]
    v_pk_fma_f32 v[70:71], v[70:71], v[102:103], v[150:151]
    s_waitcnt lgkmcnt(8)
    v_pk_fma_f32 v[152:153], v[184:185], v[56:57], v[152:153]
    v_pk_fma_f32 v[154:155], v[186:187], v[58:59], v[154:155]
    v_pk_fma_f32 v[156:157], v[188:189], v[60:61], v[156:157]
    v_pk_fma_f32 v[158:159], v[190:191], v[62:63], v[158:159]
    v_pk_fma_f32 v[160:161], v[192:193], v[64:65], v[160:161]
    v_pk_fma_f32 v[162:163], v[194:195], v[66:67], v[162:163]
    v_pk_fma_f32 v[164:165], v[196:197], v[68:69], v[164:165]
    v_pk_fma_f32 v[166:167], v[198:199], v[70:71], v[166:167]
    v_cvt_pk_bf16_f32 v216, v152, v153
    v_cvt_pk_bf16_f32 v217, v154, v155
    v_cvt_pk_bf16_f32 v218, v156, v157
    v_cvt_pk_bf16_f32 v219, v158, v159
    v_cvt_pk_bf16_f32 v220, v160, v161
    v_cvt_pk_bf16_f32 v221, v162, v163
    v_cvt_pk_bf16_f32 v222, v164, v165
    v_cvt_pk_bf16_f32 v223, v166, v167
    s_waitcnt lgkmcnt(4)
    v_pk_fma_f32 v[72:73], v[72:73], v[120:121], v[104:105]
    v_pk_fma_f32 v[74:75], v[74:75], v[122:123], v[106:107]
    v_pk_fma_f32 v[76:77], v[76:77], v[124:125], v[108:109]
    v_pk_fma_f32 v[78:79], v[78:79], v[126:127], v[110:111]
    v_pk_fma_f32 v[80:81], v[80:81], v[128:129], v[112:113]
    v_pk_fma_f32 v[82:83], v[82:83], v[130:131], v[114:115]
    v_pk_fma_f32 v[84:85], v[84:85], v[132:133], v[116:117]
    v_pk_fma_f32 v[86:87], v[86:87], v[134:135], v[118:119]
    s_waitcnt lgkmcnt(0)
    v_pk_fma_f32 v[168:169], v[200:201], v[72:73], v[168:169]
    v_pk_fma_f32 v[170:171], v[202:203], v[74:75], v[170:171]
    v_pk_fma_f32 v[172:173], v[204:205], v[76:77], v[172:173]
    v_pk_fma_f32 v[174:175], v[206:207], v[78:79], v[174:175]
    v_pk_fma_f32 v[176:177], v[208:209], v[80:81], v[176:177]
    v_pk_fma_f32 v[178:179], v[210:211], v[82:83], v[178:179]
    v_pk_fma_f32 v[180:181], v[212:213], v[84:85], v[180:181]
    v_pk_fma_f32 v[182:183], v[214:215], v[86:87], v[182:183]
    v_cvt_pk_bf16_f32 v224, v168, v183
    v_cvt_pk_bf16_f32 v225, v182, v181
    v_cvt_pk_bf16_f32 v226, v180, v179
    v_cvt_pk_bf16_f32 v227, v178, v177
    v_cvt_pk_bf16_f32 v228, v176, v175
    v_cvt_pk_bf16_f32 v229, v174, v173
    v_cvt_pk_bf16_f32 v230, v172, v171
    v_cvt_pk_bf16_f32 v231, v170, v169
    v_subrev_u32 v13, 65536, v13
    v_subrev_u32 v14, 65536, v14
    s_sub_u32 s68, s68, 65536
    v_add_u32 v7, s68, v3
    ds_write_b128 v13, v[216:219] offset:0
    ds_write_b128 v13, v[220:223] offset:16
    ds_write_b128 v14, v[224:227] offset:2048
    ds_write_b128 v14, v[228:231] offset:2064
    s_waitcnt lgkmcnt(0)
    ds_read_b128 v[232:235], v7 offset:0
    ds_read_b128 v[236:239], v7 offset:1024
    ds_read_b128 v[240:243], v7 offset:2048
    ds_read_b128 v[244:247], v7 offset:3072
    v_lshrrev_b32 v144, 2, v2
    v_and_b32 v145, 7, v144
    v_and_b32 v146, 3, v0
    v_lshl_add_u32 v148, v1, 2, v146
    v_xor_b32 v148, v148, v145
    v_lshlrev_b32 v148, 5, v148
    v_lshl_add_u32 v148, v144, 10, v148
    v_add_u32 v148, 94208, v148
    v_cmp_eq_u32 s[44:45], 1, v146
    v_cmp_eq_u32 s[46:47], 2, v146
    v_cmp_eq_u32 s[72:73], 3, v146
    v_bfe_u32 v145, v0, 4, 2
    v_and_b32 v144, 1, v144
    v_lshlrev_b32 v153, 7, v144
    v_lshl_add_u32 v153, v145, 4, v153
    v_add_u32 v153, 159872, v153
    v_lshlrev_b32 v154, 4, v146
    v_lshl_add_u32 v154, v144, 6, v154
    v_lshl_add_u32 v154, v1, 15, v154
    v_lshl_add_u32 v154, v145, 13, v154
    v_and_b32 v144, 15, v0
    v_lshlrev_b32 v152, 1, v144
    v_lshl_add_u32 v152, v1, 5, v152
    v_lshl_add_u32 v152, v145, 7, v152
    v_add_u32 v152, 159872, v152
    s_and_b32 s76, s35, 1
    s_lshl_b32 s76, s76, 18
    s_lshl_b32 s77, s17, 7
    s_add_u32 s76, s76, s77
    s_add_u32 s76, s76, 17825792
    s_movk_i32 s77, 0xff00
    s_lshl_b32 s81, s17, 2
    s_and_b32 s42, s16, 3
    s_add_u32 s81, s81, s42
    s_lshl_b32 s81, s81, 10
    s_add_u32 s82, s81, 18612224
    s_add_u32 s81, s81, 18350080
    v_mov_b32 v5, 159848
    s_waitcnt vmcnt(0)
    s_barrier
    ds_read_b64_tr_b16 v[88:89], v148 offset:0
    ds_read_b64_tr_b16 v[90:91], v148 offset:16384
    ds_read_b64_tr_b16 v[92:93], v148 offset:8
    ds_read_b64_tr_b16 v[94:95], v148 offset:16392
    ds_read_b64_tr_b16 v[96:97], v148 offset:16
    ds_read_b64_tr_b16 v[98:99], v148 offset:16400
    ds_read_b64_tr_b16 v[100:101], v148 offset:24
    ds_read_b64_tr_b16 v[102:103], v148 offset:16408
    ds_read_b64_tr_b16 v[104:105], v148 offset:32768
    ds_read_b64_tr_b16 v[106:107], v148 offset:49152
    ds_read_b64_tr_b16 v[108:109], v148 offset:32776
    ds_read_b64_tr_b16 v[110:111], v148 offset:49160
    ds_read_b64_tr_b16 v[112:113], v148 offset:32784
    ds_read_b64_tr_b16 v[114:115], v148 offset:49168
    ds_read_b64_tr_b16 v[116:117], v148 offset:32792
    ds_read_b64_tr_b16 v[118:119], v148 offset:49176
    s_cmp_lg_u32 s16, 7
    s_cbranch_scc1 f_n7
    v_lshlrev_b32 v40, 7, v2
    s_add_u32 s42, s74, 8192
    buffer_load_dwordx4 v[32:35], v40, s[12:15], s74 offen sc1
    buffer_load_dwordx4 v[36:39], v40, s[12:15], s42 offen sc1
f_n7:
    s_cmp_ge_u32 s35, 14
    s_cbranch_scc1 f_na
    s_cmp_ge_u32 s16, 4
    s_cbranch_scc1 f_na
    s_mov_b32 s83, 0
f_px:
    s_and_b32 s42, s83, 31
    s_cmp_eq_u32 s42, 31
    s_cselect_b32 s42, s82, s81
    buffer_load_dwordx4 v[144:147], v3, s[12:15], s42 offen sc1
    s_waitcnt vmcnt(0)
    v_xor_b32 v144, v8, v144
    v_xor_b32 v145, v9, v145
    v_xor_b32 v146, v10, v146
    v_xor_b32 v147, v11, v147
    v_or3_b32 v4, v144, v145, 0
    v_or3_b32 v4, v146, v147, v4
    v_and_b32 v4, 0xff, v4
    v_cmp_ne_u32 vcc, 0, v4
    s_cbranch_vccz f_pxx
    s_add_u32 s83, s83, 1
    s_cmp_lt_u32 s83, 0x40000
    s_cbranch_scc1 f_px
f_pxx:
    v_permlane32_swap_b32 v144, v146
    v_permlane32_swap_b32 v145, v147
    v_pk_add_f32 v[144:145], v[144:145], v[146:147]
    s_nop 1
    v_permlane16_swap_b32 v144, v145
    v_add_f32 v144, v144, v145
    v_cvt_pk_bf16_f32 v144, v144, v144
    v_lshlrev_b32 v144, 16, v144
    v_mul_f32 v145, 0xbfb8aa3b, v144
    v_exp_f32 v145, v145
    v_mov_b32 v146, v144
    v_add_f32 v145, 1.0, v145
    v_rcp_f32 v145, v145
    v_mov_b32 v147, v144
    v_mul_f32 v145, v144, v145
    s_nop 0
    v_permlane32_swap_b32 v146, v147
    v_cvt_pk_bf16_f32 v145, v145, v145
    v_lshlrev_b32 v145, 16, v145
    v_mul_f32 v145, v145, v147
    v_cvt_pk_bf16_f32 v145, v145, v145
    ds_write_b16 v152, v145
f_na:
    s_waitcnt lgkmcnt(0)
    s_barrier
    s_cmp_ge_u32 s35, 14
    s_cbranch_scc1 f_fin
    ds_read_b128 v[120:123], v153 offset:0
    ds_read_b128 v[124:127], v153 offset:64
    s_waitcnt lgkmcnt(1)
    v_mfma_f32_16x16x32_bf16 v[128:131], v[88:91], v[120:123], 0
    v_mfma_f32_16x16x32_bf16 v[132:135], v[92:95], v[120:123], 0
    v_mfma_f32_16x16x32_bf16 v[136:139], v[96:99], v[120:123], 0
    v_mfma_f32_16x16x32_bf16 v[140:143], v[100:103], v[120:123], 0
    s_waitcnt lgkmcnt(0)
    v_mfma_f32_16x16x32_bf16 v[128:131], v[104:107], v[124:127], v[128:131]
    v_mfma_f32_16x16x32_bf16 v[132:135], v[108:111], v[124:127], v[132:135]
    v_mfma_f32_16x16x32_bf16 v[136:139], v[112:115], v[124:127], v[136:139]
    v_mfma_f32_16x16x32_bf16 v[140:143], v[116:119], v[124:127], v[140:143]
    s_nop 5
    v_cndmask_b32 v128, v128, v132, s[44:45]
    v_cndmask_b32 v129, v129, v133, s[44:45]
    v_cndmask_b32 v130, v130, v134, s[44:45]
    v_cndmask_b32 v131, v131, v135, s[44:45]
    v_cndmask_b32 v128, v128, v136, s[46:47]
    v_cndmask_b32 v129, v129, v137, s[46:47]
    v_cndmask_b32 v130, v130, v138, s[46:47]
    v_cndmask_b32 v131, v131, v139, s[46:47]
    v_cndmask_b32 v128, v128, v140, s[72:73]
    v_cndmask_b32 v129, v129, v141, s[72:73]
    v_cndmask_b32 v130, v130, v142, s[72:73]
    v_cndmask_b32 v131, v131, v143, s[72:73]
    v_and_or_b32 v128, v128, s77, v8
    v_and_or_b32 v129, v129, s77, v9
    v_and_or_b32 v130, v130, s77, v10
    v_and_or_b32 v131, v131, s77, v11
    s_mov_b32 exec_lo, 0x00ff00ff
    s_mov_b32 exec_hi, 0x00ff00ff
    buffer_store_dwordx4 v[128:131], v154, s[12:15], s76 offen sc1
    s_mov_b64 exec, -1
    s_waitcnt vmcnt(1)
f_fin:
    s_cmp_eq_u32 s16, 7
    s_cbranch_scc1 f_sel
f_selx:
    s_barrier
    ds_read_b64 v[28:29], v5
    s_waitcnt lgkmcnt(0)
    v_readfirstlane_b32 s40, v28
    v_readfirstlane_b32 s41, v29
    s_cmp_eq_u32 s60, s40
    s_cbranch_scc1 f_e0
    s_cmp_eq_u32 s60, s41
    s_cbranch_scc1 f_e0
    buffer_store_dwordx4 v[232:235], v3, s[24:27], s18 offen offset:0 sc1
    buffer_store_dwordx4 v[236:239], v3, s[24:27], s18 offen offset:1024 sc1
f_e0:
    s_cmp_eq_u32 s61, s40
    s_cbranch_scc1 f_e1
    s_cmp_eq_u32 s61, s41
    s_cbranch_scc1 f_e1
    buffer_store_dwordx4 v[240:243], v3, s[24:27], s19 offen offset:0 sc1
    buffer_store_dwordx4 v[244:247], v3, s[24:27], s19 offen offset:1024 sc1
f_e1:
    s_endpgm
f_sel:
    s_mov_b32 s83, 0
    s_cmp_lt_u32 s35, 14
    s_cbranch_scc1 f_kqc
    v_lshlrev_b32 v40, 7, v2
    s_add_u32 s42, s74, 8192
    s_mov_b32 s83, 0
    s_mov_b64 vcc, -1
    s_mov_b64 s[40:41], -1
f_kq:
    s_mov_b64 exec, vcc
    s_cbranch_execz f_kqa
    buffer_load_dwordx4 v[32:35], v40, s[12:15], s74 offen sc1
f_kqa:
    s_mov_b64 exec, s[40:41]
    s_cbranch_execz f_kqb
    buffer_load_dwordx4 v[36:39], v40, s[12:15], s42 offen sc1
f_kqb:
    s_mov_b64 exec, -1
    s_waitcnt vmcnt(0)
f_kqc:
    v_cmp_ne_u32 vcc, s32, v33
    v_cmp_ne_u32 s[20:21], s33, v35
    v_cmp_ne_u32 s[40:41], s32, v37
    v_cmp_ne_u32 s[22:23], s33, v39
    v_max_u32 v41, v32, v36
    v_min_u32 v42, v32, v36
    s_or_b64 vcc, vcc, s[20:21]
    s_or_b64 s[40:41], s[40:41], s[22:23]
    s_or_b64 s[20:21], vcc, s[40:41]
    s_cbranch_scc0 f_kqx
    s_sleep 4
    s_add_u32 s83, s83, 1
    s_cmp_lt_u32 s83, 0x40000
    s_cbranch_scc1 f_kq
f_kqx:
    v_mov_b32 v43, v41
    v_max3_u32 v42, v42, v34, v38
    s_nop 0
    v_max_u32_dpp v43, v43, v43 row_ror:8 row_mask:0xf bank_mask:0xf
    s_nop 1
    v_max_u32_dpp v43, v43, v43 row_ror:4 row_mask:0xf bank_mask:0xf
    s_nop 1
    v_max_u32_dpp v43, v43, v43 row_ror:2 row_mask:0xf bank_mask:0xf
    s_nop 1
    v_max_u32_dpp v43, v43, v43 row_ror:1 row_mask:0xf bank_mask:0xf
    s_nop 1
    v_max_u32_dpp v43, v43, v43 row_bcast:15 row_mask:0xa bank_mask:0xf
    s_nop 1
    v_max_u32_dpp v43, v43, v43 row_bcast:31 row_mask:0xc bank_mask:0xf
    s_nop 0
    v_readlane_b32 s40, v43, 63
    s_nop 1
    v_cmp_eq_u32 vcc, s40, v41
    s_nop 1
    v_cndmask_b32 v43, v41, v42, vcc
    s_nop 1
    v_max_u32_dpp v43, v43, v43 row_ror:8 row_mask:0xf bank_mask:0xf
    s_nop 1
    v_max_u32_dpp v43, v43, v43 row_ror:4 row_mask:0xf bank_mask:0xf
    s_nop 1
    v_max_u32_dpp v43, v43, v43 row_ror:2 row_mask:0xf bank_mask:0xf
    s_nop 1
    v_max_u32_dpp v43, v43, v43 row_ror:1 row_mask:0xf bank_mask:0xf
    s_nop 1
    v_max_u32_dpp v43, v43, v43 row_bcast:15 row_mask:0xa bank_mask:0xf
    s_nop 1
    v_max_u32_dpp v43, v43, v43 row_bcast:31 row_mask:0xc bank_mask:0xf
    s_nop 0
    v_readlane_b32 s41, v43, 63
    s_andn2_b32 s40, s40, 1
    s_andn2_b32 s41, s41, 1
    v_mov_b32 v28, s40
    v_mov_b32 v29, s41
    ds_write_b64 v5, v[28:29]
    s_waitcnt lgkmcnt(0)
    s_branch f_selx
f_p2r:
    s_add_u32 s83, s83, 1
    s_cmp_ge_u32 s83, 0x40000
    s_cbranch_scc1 f_p2w
    s_sleep 12
    buffer_load_dwordx4 v[248:251], v3, s[12:15], s64 offen sc1
f_p2c:
    s_waitcnt vmcnt(0)
    s_branch f_p2e
f_zr:
    v_or3_b32 v248, v40, v42, v44
    v_or_b32 v248, v248, v46
    v_and_b32 v248, s54, v248
    v_cmp_ne_u32 vcc, 0, v248
    s_cbranch_vccz f_zr0
    buffer_load_dwordx4 v[24:27], v3, s[12:15], s72 offen offset:0 sc1
f_zr0:
    v_or3_b32 v248, v41, v43, v45
    v_or_b32 v248, v248, v47
    v_and_b32 v248, s54, v248
    v_cmp_ne_u32 vcc, 0, v248
    s_cbranch_vccz f_zr1
    buffer_load_dwordx4 v[28:31], v3, s[12:15], s72 offen offset:1024 sc1
f_zr1:
    v_or3_b32 v248, v48, v50, v52
    v_or_b32 v248, v248, v54
    v_and_b32 v248, s54, v248
    v_cmp_ne_u32 vcc, 0, v248
    s_cbranch_vccz f_zr2
    buffer_load_dwordx4 v[32:35], v3, s[12:15], s72 offen offset:2048 sc1
f_zr2:
    v_or3_b32 v248, v49, v51, v53
    v_or_b32 v248, v248, v55
    v_and_b32 v248, s54, v248
    v_cmp_ne_u32 vcc, 0, v248
    s_cbranch_vccz f_zr3
    buffer_load_dwordx4 v[36:39], v3, s[12:15], s72 offen offset:3072 sc1
f_zr3:
    s_waitcnt vmcnt(0)
    s_add_u32 s83, s83, 1
    s_cmp_lt_u32 s83, 0x40000
    s_cbranch_scc1 f_zc
    s_branch f_zx
f_both:
    s_or_b32 s42, s61, s63
    s_cmp_eq_u32 s63, 0
    s_cselect_b32 s43, s32, s33
    v_mov_b32 v34, s42
    v_mov_b32 v35, s43
    s_lshl_b32 s42, s63, 3
    s_add_u32 s42, s42, s80
    s_mov_b64 exec, 0xff
    buffer_store_dwordx2 v[34:35], v18, s[12:15], s42 offen sc1
    s_mov_b64 exec, -1
    s_nop 1
    s_branch f_cand0
f_r0:
    buffer_load_dwordx4 v3, s[8:11], s18 offen offset:0 lds
    buffer_load_dwordx4 v3, s[8:11], s18 offen offset:1024 lds
    s_branch f_nr
f_str:
    s_and_b32 s42, s83, 31
    s_cmp_lg_u32 s42, 24
    s_cbranch_scc1 f_sb1
    v_add_u32 v116, 160768, v3
    s_mov_b64 exec, 0xff
    ds_read_b128 v[112:115], v116
    s_waitcnt lgkmcnt(0)
    buffer_store_dwordx4 v[112:115], v3, s[12:15], s63 offen sc1
    s_mov_b64 exec, -1
f_sb1:
    s_cmp_eq_u32 s42, 31
    s_cselect_b32 s42, 32768, 0
    s_add_u32 s42, s42, s71
    s_mov_b32 exec_lo, 0x000f000f
    s_mov_b32 exec_hi, 0x000f000f
    buffer_load_dwordx4 v[24:27], v7, s[12:15], s42 offen sc1
    s_add_u32 s83, s83, 1
    s_cmp_lt_u32 s83, 0x40000
    s_cbranch_scc1 f_st
    s_waitcnt vmcnt(0)
    s_mov_b64 exec, -1
    s_branch f_stx
f_pr:
    s_sleep 6
    v_mov_b32 v192, v8
    v_mov_b32 v193, v9
    v_mov_b32 v194, v10
    v_mov_b32 v195, v11
    buffer_load_dwordx4 v[184:187], v3, s[12:15], s64 offen sc1
    buffer_load_dwordx4 v[188:191], v3, s[12:15], s65 offen sc1
    s_mov_b64 exec, 0xffff
    buffer_load_dwordx4 v[236:239], v17, s[12:15], s77 offen sc1
    s_mov_b64 exec, s[52:53]
    buffer_load_dwordx4 v[192:195], v3, s[12:15], s76 offen sc1
    s_mov_b64 exec, -1
    s_waitcnt vmcnt(0)
    s_add_u32 s83, s83, 1
    s_cmp_lt_u32 s83, 0x40000
    s_cbranch_scc1 f_pv
    s_branch f_pw
f_go:
    s_lshl_b32 s41, s34, 7
    s_add_u32 s41, s41, 16842752
    v_mov_b32 v56, s32
    v_mov_b32 v57, s33
    s_mov_b64 exec, 0xff
    buffer_store_dwordx4 v[56:59], v3, s[12:15], s41 offen sc1
    s_mov_b64 exec, -1
    s_branch f_ngo
f_slow2:
    v_cvt_pk_bf16_f32 v40, v152, v153
    v_lshlrev_b32 v152, 16, v40
    v_and_b32 v153, 0xffff0000, v40
    v_cvt_pk_bf16_f32 v40, v154, v155
    v_lshlrev_b32 v154, 16, v40
    v_and_b32 v155, 0xffff0000, v40
    v_cvt_pk_bf16_f32 v40, v156, v157
    v_lshlrev_b32 v156, 16, v40
    v_and_b32 v157, 0xffff0000, v40
    v_cvt_pk_bf16_f32 v40, v158, v159
    v_lshlrev_b32 v158, 16, v40
    v_and_b32 v159, 0xffff0000, v40
    v_cvt_pk_bf16_f32 v40, v160, v161
    v_lshlrev_b32 v160, 16, v40
    v_and_b32 v161, 0xffff0000, v40
    v_cvt_pk_bf16_f32 v40, v162, v163
    v_lshlrev_b32 v162, 16, v40
    v_and_b32 v163, 0xffff0000, v40
    v_cvt_pk_bf16_f32 v40, v164, v165
    v_lshlrev_b32 v164, 16, v40
    v_and_b32 v165, 0xffff0000, v40
    v_cvt_pk_bf16_f32 v40, v166, v167
    v_lshlrev_b32 v166, 16, v40
    v_and_b32 v167, 0xffff0000, v40
    v_pk_add_f32 v[40:41], v[152:153], v[154:155]
    v_pk_add_f32 v[40:41], v[40:41], v[156:157]
    v_pk_add_f32 v[40:41], v[40:41], v[158:159]
    v_pk_add_f32 v[40:41], v[40:41], v[160:161]
    v_pk_add_f32 v[40:41], v[40:41], v[162:163]
    v_pk_add_f32 v[40:41], v[40:41], v[164:165]
    v_pk_add_f32 v[40:41], v[40:41], v[166:167]
    v_cvt_pk_bf16_f32 v48, v168, v169
    v_lshlrev_b32 v168, 16, v48
    v_and_b32 v169, 0xffff0000, v48
    v_cvt_pk_bf16_f32 v48, v170, v171
    v_lshlrev_b32 v170, 16, v48
    v_and_b32 v171, 0xffff0000, v48
    v_cvt_pk_bf16_f32 v48, v172, v173
    v_lshlrev_b32 v172, 16, v48
    v_and_b32 v173, 0xffff0000, v48
    v_cvt_pk_bf16_f32 v48, v174, v175
    v_lshlrev_b32 v174, 16, v48
    v_and_b32 v175, 0xffff0000, v48
    v_cvt_pk_bf16_f32 v48, v176, v177
    v_lshlrev_b32 v176, 16, v48
    v_and_b32 v177, 0xffff0000, v48
    v_cvt_pk_bf16_f32 v48, v178, v179
    v_lshlrev_b32 v178, 16, v48
    v_and_b32 v179, 0xffff0000, v48
    v_cvt_pk_bf16_f32 v48, v180, v181
    v_lshlrev_b32 v180, 16, v48
    v_and_b32 v181, 0xffff0000, v48
    v_cvt_pk_bf16_f32 v48, v182, v183
    v_lshlrev_b32 v182, 16, v48
    v_and_b32 v183, 0xffff0000, v48
    v_pk_add_f32 v[48:49], v[168:169], v[170:171]
    v_pk_add_f32 v[48:49], v[48:49], v[172:173]
    v_pk_add_f32 v[48:49], v[48:49], v[174:175]
    v_pk_add_f32 v[48:49], v[48:49], v[176:177]
    v_pk_add_f32 v[48:49], v[48:49], v[178:179]
    v_pk_add_f32 v[48:49], v[48:49], v[180:181]
    v_pk_add_f32 v[48:49], v[48:49], v[182:183]
    v_add_f32 v24, v40, v41
    v_add_f32 v28, v48, v49
    s_nop 1
    v_permlane32_swap_b32 v24, v28
    v_add_f32 v24, v24, v28
    s_nop 1
    v_add_f32_dpp v24, v24, v24 row_ror:8 row_mask:0xf bank_mask:0xf
    s_nop 1
    v_add_f32_dpp v24, v24, v24 row_ror:4 row_mask:0xf bank_mask:0xf
    s_nop 1
    v_add_f32_dpp v24, v24, v24 row_ror:2 row_mask:0xf bank_mask:0xf
    s_nop 1
    v_add_f32_dpp v24, v24, v24 row_ror:1 row_mask:0xf bank_mask:0xf
    s_nop 1
    v_add_f32_dpp v24, v24, v24 row_bcast:15 row_mask:0xa bank_mask:0xf
    v_mul_f32 v27, 0x3a800000, v24
    v_cvt_pk_bf16_f32 v24, v27, v27
    v_lshlrev_b32 v24, 16, v24
    v_sub_f32 v27, v27, v24
    v_readlane_b32 s56, v24, 31
    v_readlane_b32 s58, v24, 63
    s_nop 0
    v_pk_add_f32 v[56:57], v[152:153], s[56:57] op_sel:[0,0] op_sel_hi:[1,0] neg_lo:[0,1] neg_hi:[0,1]
    v_pk_add_f32 v[58:59], v[154:155], s[56:57] op_sel:[0,0] op_sel_hi:[1,0] neg_lo:[0,1] neg_hi:[0,1]
    v_pk_add_f32 v[60:61], v[156:157], s[56:57] op_sel:[0,0] op_sel_hi:[1,0] neg_lo:[0,1] neg_hi:[0,1]
    v_pk_add_f32 v[62:63], v[158:159], s[56:57] op_sel:[0,0] op_sel_hi:[1,0] neg_lo:[0,1] neg_hi:[0,1]
    v_pk_add_f32 v[64:65], v[160:161], s[56:57] op_sel:[0,0] op_sel_hi:[1,0] neg_lo:[0,1] neg_hi:[0,1]
    v_pk_add_f32 v[66:67], v[162:163], s[56:57] op_sel:[0,0] op_sel_hi:[1,0] neg_lo:[0,1] neg_hi:[0,1]
    v_pk_add_f32 v[68:69], v[164:165], s[56:57] op_sel:[0,0] op_sel_hi:[1,0] neg_lo:[0,1] neg_hi:[0,1]
    v_pk_add_f32 v[70:71], v[166:167], s[56:57] op_sel:[0,0] op_sel_hi:[1,0] neg_lo:[0,1] neg_hi:[0,1]
    v_pk_add_f32 v[72:73], v[168:169], s[58:59] op_sel:[0,0] op_sel_hi:[1,0] neg_lo:[0,1] neg_hi:[0,1]
    v_pk_add_f32 v[74:75], v[170:171], s[58:59] op_sel:[0,0] op_sel_hi:[1,0] neg_lo:[0,1] neg_hi:[0,1]
    v_pk_add_f32 v[76:77], v[172:173], s[58:59] op_sel:[0,0] op_sel_hi:[1,0] neg_lo:[0,1] neg_hi:[0,1]
    v_pk_add_f32 v[78:79], v[174:175], s[58:59] op_sel:[0,0] op_sel_hi:[1,0] neg_lo:[0,1] neg_hi:[0,1]
    v_pk_add_f32 v[80:81], v[176:177], s[58:59] op_sel:[0,0] op_sel_hi:[1,0] neg_lo:[0,1] neg_hi:[0,1]
    v_pk_add_f32 v[82:83], v[178:179], s[58:59] op_sel:[0,0] op_sel_hi:[1,0] neg_lo:[0,1] neg_hi:[0,1]
    v_pk_add_f32 v[84:85], v[180:181], s[58:59] op_sel:[0,0] op_sel_hi:[1,0] neg_lo:[0,1] neg_hi:[0,1]
    v_pk_add_f32 v[86:87], v[182:183], s[58:59] op_sel:[0,0] op_sel_hi:[1,0] neg_lo:[0,1] neg_hi:[0,1]
    v_mov_b32 v31, v30
    v_pk_mul_f32 v[42:43], v[70:71], v[70:71]
    v_pk_mul_f32 v[44:45], v[70:71], v[230:231]
    v_pk_mul_f32 v[50:51], v[86:87], v[86:87]
    v_pk_mul_f32 v[52:53], v[86:87], v[246:247]
    v_pk_fma_f32 v[42:43], v[68:69], v[68:69], v[42:43]
    v_pk_fma_f32 v[44:45], v[68:69], v[228:229], v[44:45]
    v_pk_fma_f32 v[50:51], v[84:85], v[84:85], v[50:51]
    v_pk_fma_f32 v[52:53], v[84:85], v[244:245], v[52:53]
    v_pk_fma_f32 v[42:43], v[66:67], v[66:67], v[42:43]
    v_pk_fma_f32 v[44:45], v[66:67], v[226:227], v[44:45]
    v_pk_fma_f32 v[50:51], v[82:83], v[82:83], v[50:51]
    v_pk_fma_f32 v[52:53], v[82:83], v[242:243], v[52:53]
    v_pk_fma_f32 v[42:43], v[64:65], v[64:65], v[42:43]
    v_pk_fma_f32 v[44:45], v[64:65], v[224:225], v[44:45]
    v_pk_fma_f32 v[50:51], v[80:81], v[80:81], v[50:51]
    v_pk_fma_f32 v[52:53], v[80:81], v[240:241], v[52:53]
    v_pk_fma_f32 v[42:43], v[62:63], v[62:63], v[42:43]
    v_pk_fma_f32 v[44:45], v[62:63], v[222:223], v[44:45]
    v_pk_fma_f32 v[50:51], v[78:79], v[78:79], v[50:51]
    v_pk_fma_f32 v[52:53], v[78:79], v[238:239], v[52:53]
    v_pk_fma_f32 v[42:43], v[60:61], v[60:61], v[42:43]
    v_pk_fma_f32 v[44:45], v[60:61], v[220:221], v[44:45]
    v_pk_fma_f32 v[50:51], v[76:77], v[76:77], v[50:51]
    v_pk_fma_f32 v[52:53], v[76:77], v[236:237], v[52:53]
    v_pk_fma_f32 v[42:43], v[58:59], v[58:59], v[42:43]
    v_pk_fma_f32 v[44:45], v[58:59], v[218:219], v[44:45]
    v_pk_fma_f32 v[50:51], v[74:75], v[74:75], v[50:51]
    v_pk_fma_f32 v[52:53], v[74:75], v[234:235], v[52:53]
    v_pk_fma_f32 v[42:43], v[56:57], v[56:57], v[42:43]
    v_pk_fma_f32 v[44:45], v[56:57], v[216:217], v[44:45]
    v_pk_fma_f32 v[50:51], v[72:73], v[72:73], v[50:51]
    v_pk_fma_f32 v[52:53], v[72:73], v[232:233], v[52:53]
    v_add_f32 v25, v42, v43
    v_add_f32 v26, v44, v45
    v_add_f32 v29, v50, v51
    v_add_f32 v30, v52, v53
    s_nop 0
    v_permlane32_swap_b32 v25, v29
    v_permlane32_swap_b32 v26, v30
    v_add_f32 v25, v25, v29
    v_add_f32 v26, v26, v30
    s_nop 0
    v_add_f32_dpp v25, v25, v25 row_ror:8 row_mask:0xf bank_mask:0xf
    v_add_f32_dpp v26, v26, v26 row_ror:8 row_mask:0xf bank_mask:0xf
    s_nop 0
    v_add_f32_dpp v25, v25, v25 row_ror:4 row_mask:0xf bank_mask:0xf
    v_add_f32_dpp v26, v26, v26 row_ror:4 row_mask:0xf bank_mask:0xf
    s_nop 0
    v_add_f32_dpp v25, v25, v25 row_ror:2 row_mask:0xf bank_mask:0xf
    v_add_f32_dpp v26, v26, v26 row_ror:2 row_mask:0xf bank_mask:0xf
    s_nop 0
    v_add_f32_dpp v25, v25, v25 row_ror:1 row_mask:0xf bank_mask:0xf
    v_add_f32_dpp v26, v26, v26 row_ror:1 row_mask:0xf bank_mask:0xf
    s_nop 0
    v_add_f32_dpp v25, v25, v25 row_bcast:15 row_mask:0xa bank_mask:0xf
    v_add_f32_dpp v26, v26, v26 row_bcast:15 row_mask:0xa bank_mask:0xf
    v_mul_f32 v25, 0x3a800000, v25
    v_fma_f32 v25, -v27, v27, v25
    v_max_f32 v25, 0, v25
    v_mov_b32 v30, v31
    s_branch f_var2
f_slowvar:
    v_lshlrev_b32 v118, 16, v117
    s_nop 0
    v_readlane_b32 s44, v118, 31
    v_readlane_b32 s46, v118, 63
    v_lshlrev_b32 v120, 16, v64
    v_and_b32 v121, 0xffff0000, v64
    v_pk_add_f32 v[120:121], v[120:121], s[44:45] op_sel_hi:[1,0]
    v_pk_mul_f32 v[122:123], v[120:121], v[120:121]
    v_lshlrev_b32 v120, 16, v65
    v_and_b32 v121, 0xffff0000, v65
    v_pk_add_f32 v[120:121], v[120:121], s[44:45] op_sel_hi:[1,0]
    v_pk_fma_f32 v[122:123], v[120:121], v[120:121], v[122:123]
    v_lshlrev_b32 v120, 16, v66
    v_and_b32 v121, 0xffff0000, v66
    v_pk_add_f32 v[120:121], v[120:121], s[44:45] op_sel_hi:[1,0]
    v_pk_fma_f32 v[122:123], v[120:121], v[120:121], v[122:123]
    v_lshlrev_b32 v120, 16, v67
    v_and_b32 v121, 0xffff0000, v67
    v_pk_add_f32 v[120:121], v[120:121], s[44:45] op_sel_hi:[1,0]
    v_pk_fma_f32 v[122:123], v[120:121], v[120:121], v[122:123]
    v_lshlrev_b32 v120, 16, v68
    v_and_b32 v121, 0xffff0000, v68
    v_pk_add_f32 v[120:121], v[120:121], s[44:45] op_sel_hi:[1,0]
    v_pk_fma_f32 v[122:123], v[120:121], v[120:121], v[122:123]
    v_lshlrev_b32 v120, 16, v69
    v_and_b32 v121, 0xffff0000, v69
    v_pk_add_f32 v[120:121], v[120:121], s[44:45] op_sel_hi:[1,0]
    v_pk_fma_f32 v[122:123], v[120:121], v[120:121], v[122:123]
    v_lshlrev_b32 v120, 16, v70
    v_and_b32 v121, 0xffff0000, v70
    v_pk_add_f32 v[120:121], v[120:121], s[44:45] op_sel_hi:[1,0]
    v_pk_fma_f32 v[122:123], v[120:121], v[120:121], v[122:123]
    v_lshlrev_b32 v120, 16, v71
    v_and_b32 v121, 0xffff0000, v71
    v_pk_add_f32 v[120:121], v[120:121], s[44:45] op_sel_hi:[1,0]
    v_pk_fma_f32 v[122:123], v[120:121], v[120:121], v[122:123]
    v_add_f32 v110, v122, v123
    v_lshlrev_b32 v120, 16, v72
    v_and_b32 v121, 0xffff0000, v72
    v_pk_add_f32 v[120:121], v[120:121], s[46:47] op_sel_hi:[1,0]
    v_pk_mul_f32 v[122:123], v[120:121], v[120:121]
    v_lshlrev_b32 v120, 16, v73
    v_and_b32 v121, 0xffff0000, v73
    v_pk_add_f32 v[120:121], v[120:121], s[46:47] op_sel_hi:[1,0]
    v_pk_fma_f32 v[122:123], v[120:121], v[120:121], v[122:123]
    v_lshlrev_b32 v120, 16, v74
    v_and_b32 v121, 0xffff0000, v74
    v_pk_add_f32 v[120:121], v[120:121], s[46:47] op_sel_hi:[1,0]
    v_pk_fma_f32 v[122:123], v[120:121], v[120:121], v[122:123]
    v_lshlrev_b32 v120, 16, v75
    v_and_b32 v121, 0xffff0000, v75
    v_pk_add_f32 v[120:121], v[120:121], s[46:47] op_sel_hi:[1,0]
    v_pk_fma_f32 v[122:123], v[120:121], v[120:121], v[122:123]
    v_lshlrev_b32 v120, 16, v76
    v_and_b32 v121, 0xffff0000, v76
    v_pk_add_f32 v[120:121], v[120:121], s[46:47] op_sel_hi:[1,0]
    v_pk_fma_f32 v[122:123], v[120:121], v[120:121], v[122:123]
    v_lshlrev_b32 v120, 16, v77
    v_and_b32 v121, 0xffff0000, v77
    v_pk_add_f32 v[120:121], v[120:121], s[46:47] op_sel_hi:[1,0]
    v_pk_fma_f32 v[122:123], v[120:121], v[120:121], v[122:123]
    v_lshlrev_b32 v120, 16, v78
    v_and_b32 v121, 0xffff0000, v78
    v_pk_add_f32 v[120:121], v[120:121], s[46:47] op_sel_hi:[1,0]
    v_pk_fma_f32 v[122:123], v[120:121], v[120:121], v[122:123]
    v_lshlrev_b32 v120, 16, v79
    v_and_b32 v121, 0xffff0000, v79
    v_pk_add_f32 v[120:121], v[120:121], s[46:47] op_sel_hi:[1,0]
    v_pk_fma_f32 v[122:123], v[120:121], v[120:121], v[122:123]
    v_add_f32 v111, v122, v123
    v_add_f32 v118, v118, v108
    s_nop 0
    v_permlane32_swap_b32 v110, v111
    v_add_f32 v110, v110, v111
    s_nop 1
    v_add_f32_dpp v110, v110, v110 row_ror:8 row_mask:0xf bank_mask:0xf
    s_nop 1
    v_add_f32_dpp v110, v110, v110 row_ror:4 row_mask:0xf bank_mask:0xf
    s_nop 1
    v_add_f32_dpp v110, v110, v110 row_ror:2 row_mask:0xf bank_mask:0xf
    s_nop 1
    v_add_f32_dpp v110, v110, v110 row_ror:1 row_mask:0xf bank_mask:0xf
    s_nop 1
    v_add_f32_dpp v110, v110, v110 row_bcast:15 row_mask:0xa bank_mask:0xf
    v_mul_f32 v110, s5, v110
    v_fma_f32 v110, -v118, v118, v110
    v_max_f32 v110, 0, v110
    s_branch f_var
f_sp:
    s_setprio 2
    ds_read_b128 v[56:59], v3 offset:0
    ds_read_b128 v[60:63], v3 offset:1024
    ds_read_b128 v[64:67], v3 offset:2048
    ds_read_b128 v[68:71], v3 offset:3072
    v_and_b32 v12, 31, v0
    v_lshlrev_b32 v12, 2, v12
    v_and_b32 v17, 32, v0
    v_lshl_add_u32 v12, v17, 4, v12
    v_sub_u32 v20, 4096, v12
    v_add_u32 v12, 4096, v12
    v_add_u32 v17, 128, v12
    v_add_u32 v21, 128, v20
    s_waitcnt lgkmcnt(3)
    v_pk_fma_f16 v40, v24, v248, v56 op_sel:[0,0,0] op_sel_hi:[1,0,1]
    v_pk_fma_f16 v41, v25, v248, v57 op_sel:[0,1,0] op_sel_hi:[1,1,1]
    v_pk_fma_f16 v42, v26, v249, v58 op_sel:[0,0,0] op_sel_hi:[1,0,1]
    v_pk_fma_f16 v43, v27, v249, v59 op_sel:[0,1,0] op_sel_hi:[1,1,1]
    ds_write2st64_b32 v12, v40, v42 offset0:0 offset1:1
    ds_write2st64_b32 v17, v41, v43 offset0:0 offset1:1
    s_waitcnt lgkmcnt(4)
    v_pk_fma_f16 v44, v28, v250, v60 op_sel:[0,0,0] op_sel_hi:[1,0,1]
    v_pk_fma_f16 v45, v29, v250, v61 op_sel:[0,1,0] op_sel_hi:[1,1,1]
    v_pk_fma_f16 v46, v30, v251, v62 op_sel:[0,0,0] op_sel_hi:[1,0,1]
    v_pk_fma_f16 v47, v31, v251, v63 op_sel:[0,1,0] op_sel_hi:[1,1,1]
    ds_write2st64_b32 v12, v44, v46 offset0:4 offset1:5
    ds_write2st64_b32 v17, v45, v47 offset0:4 offset1:5
    s_waitcnt lgkmcnt(5)
    v_pk_fma_f16 v48, v32, v252, v64 op_sel:[0,0,0] op_sel_hi:[1,0,1]
    v_pk_fma_f16 v49, v33, v252, v65 op_sel:[0,1,0] op_sel_hi:[1,1,1]
    v_pk_fma_f16 v50, v34, v253, v66 op_sel:[0,0,0] op_sel_hi:[1,0,1]
    v_pk_fma_f16 v51, v35, v253, v67 op_sel:[0,1,0] op_sel_hi:[1,1,1]
    ds_write2st64_b32 v12, v48, v50 offset0:8 offset1:9
    ds_write2st64_b32 v17, v49, v51 offset0:8 offset1:9
    s_waitcnt lgkmcnt(6)
    v_pk_fma_f16 v52, v36, v254, v68 op_sel:[0,0,0] op_sel_hi:[1,0,1]
    v_pk_fma_f16 v53, v37, v254, v69 op_sel:[0,1,0] op_sel_hi:[1,1,1]
    v_pk_fma_f16 v54, v38, v255, v70 op_sel:[0,0,0] op_sel_hi:[1,0,1]
    v_pk_fma_f16 v55, v39, v255, v71 op_sel:[0,1,0] op_sel_hi:[1,1,1]
    ds_write2st64_b32 v12, v52, v54 offset0:12 offset1:13
    ds_write2st64_b32 v17, v53, v55 offset0:12 offset1:13
    s_mov_b64 exec, 1
    ds_write_b32 v12, v40 offset:4096
    s_mov_b64 exec, -1
    ds_read2st64_b32 v[72:73], v20 offset0:16 offset1:15
    ds_read2st64_b32 v[74:75], v21 offset0:15 offset1:14
    ds_read2st64_b32 v[76:77], v20 offset0:12 offset1:11
    ds_read2st64_b32 v[78:79], v21 offset0:11 offset1:10
    ds_read2st64_b32 v[80:81], v20 offset0:8 offset1:7
    ds_read2st64_b32 v[82:83], v21 offset0:7 offset1:6
    ds_read2st64_b32 v[84:85], v20 offset0:4 offset1:3
    ds_read2st64_b32 v[86:87], v21 offset0:3 offset1:2
    s_waitcnt lgkmcnt(6)
    v_pk_add_f16 v40, v40, v72
    v_pk_add_f16 v41, v41, v74
    v_pk_add_f16 v42, v42, v73
    v_pk_add_f16 v43, v43, v75
    s_waitcnt lgkmcnt(4)
    v_pk_add_f16 v44, v44, v76
    v_pk_add_f16 v45, v45, v78
    v_pk_add_f16 v46, v46, v77
    v_pk_add_f16 v47, v47, v79
    s_waitcnt lgkmcnt(2)
    v_pk_add_f16 v48, v48, v80
    v_pk_add_f16 v49, v49, v82
    v_pk_add_f16 v50, v50, v81
    v_pk_add_f16 v51, v51, v83
    s_waitcnt lgkmcnt(0)
    v_pk_add_f16 v52, v52, v84
    v_pk_add_f16 v53, v53, v86
    v_pk_add_f16 v54, v54, v85
    v_pk_add_f16 v55, v55, v87
    v_mfma_f32_32x32x16_f16 v[56:71], v[40:43], v[88:91], 0
    v_mfma_f32_32x32x16_f16 v[72:87], v[40:43], v[104:107], 0
    v_mfma_f32_32x32x16_f16 v[56:71], v[44:47], v[92:95], v[56:71]
    v_mfma_f32_32x32x16_f16 v[72:87], v[44:47], v[108:111], v[72:87]
    s_branch f_st1
f_sp2:
    s_nop 9
    v_pk_mul_f32 v[24:25], v[56:57], v[120:121]
    v_pk_mul_f32 v[28:29], v[72:73], v[120:121]
    v_pk_mul_f32 v[26:27], v[58:59], v[122:123]
    v_pk_mul_f32 v[30:31], v[74:75], v[122:123]
    v_pk_fma_f32 v[24:25], v[72:73], v[136:137], v[24:25]
    v_pk_fma_f32 v[28:29], v[56:57], v[136:137], v[28:29] neg_lo:[1,0,0] neg_hi:[1,0,0]
    v_pk_fma_f32 v[26:27], v[74:75], v[138:139], v[26:27]
    v_pk_fma_f32 v[30:31], v[58:59], v[138:139], v[30:31] neg_lo:[1,0,0] neg_hi:[1,0,0]
    v_cvt_pk_f16_f32 v40, v24, v28
    v_cvt_pk_f16_f32 v41, v25, v29
    v_cvt_pk_f16_f32 v42, v26, v30
    v_cvt_pk_f16_f32 v43, v27, v31
    v_pk_mul_f32 v[32:33], v[60:61], v[124:125]
    v_pk_mul_f32 v[36:37], v[76:77], v[124:125]
    v_pk_mul_f32 v[34:35], v[62:63], v[126:127]
    v_pk_mul_f32 v[38:39], v[78:79], v[126:127]
    v_pk_fma_f32 v[32:33], v[76:77], v[140:141], v[32:33]
    v_pk_fma_f32 v[36:37], v[60:61], v[140:141], v[36:37] neg_lo:[1,0,0] neg_hi:[1,0,0]
    v_pk_fma_f32 v[34:35], v[78:79], v[142:143], v[34:35]
    v_pk_fma_f32 v[38:39], v[62:63], v[142:143], v[38:39] neg_lo:[1,0,0] neg_hi:[1,0,0]
    v_cvt_pk_f16_f32 v44, v32, v36
    v_cvt_pk_f16_f32 v45, v33, v37
    v_cvt_pk_f16_f32 v46, v34, v38
    v_cvt_pk_f16_f32 v47, v35, v39
    v_mfma_f32_32x32x16_f16 v[216:231], v[40:43], v[88:91], 0
    v_mfma_f32_32x32x16_f16 v[232:247], v[40:43], v[104:107], 0
    v_pk_mul_f32 v[24:25], v[64:65], v[128:129]
    v_pk_mul_f32 v[28:29], v[80:81], v[128:129]
    v_pk_mul_f32 v[26:27], v[66:67], v[130:131]
    v_pk_mul_f32 v[30:31], v[82:83], v[130:131]
    v_pk_fma_f32 v[24:25], v[80:81], v[144:145], v[24:25]
    v_pk_fma_f32 v[28:29], v[64:65], v[144:145], v[28:29] neg_lo:[1,0,0] neg_hi:[1,0,0]
    v_pk_fma_f32 v[26:27], v[82:83], v[146:147], v[26:27]
    v_pk_fma_f32 v[30:31], v[66:67], v[146:147], v[30:31] neg_lo:[1,0,0] neg_hi:[1,0,0]
    v_cvt_pk_f16_f32 v48, v24, v28
    v_cvt_pk_f16_f32 v49, v25, v29
    v_cvt_pk_f16_f32 v50, v26, v30
    v_cvt_pk_f16_f32 v51, v27, v31
    v_mfma_f32_32x32x16_f16 v[216:231], v[44:47], v[92:95], v[216:231]
    v_mfma_f32_32x32x16_f16 v[232:247], v[44:47], v[108:111], v[232:247]
    v_pk_mul_f32 v[32:33], v[68:69], v[132:133]
    v_pk_mul_f32 v[36:37], v[84:85], v[132:133]
    v_pk_mul_f32 v[34:35], v[70:71], v[134:135]
    v_pk_mul_f32 v[38:39], v[86:87], v[134:135]
    v_pk_fma_f32 v[32:33], v[84:85], v[148:149], v[32:33]
    v_pk_fma_f32 v[36:37], v[68:69], v[148:149], v[36:37] neg_lo:[1,0,0] neg_hi:[1,0,0]
    v_pk_fma_f32 v[34:35], v[86:87], v[150:151], v[34:35]
    v_pk_fma_f32 v[38:39], v[70:71], v[150:151], v[38:39] neg_lo:[1,0,0] neg_hi:[1,0,0]
    v_cvt_pk_f16_f32 v52, v32, v36
    v_cvt_pk_f16_f32 v53, v33, v37
    v_cvt_pk_f16_f32 v54, v34, v38
    v_cvt_pk_f16_f32 v55, v35, v39
    v_mfma_f32_32x32x16_f16 v[216:231], v[48:51], v[96:99], v[216:231]
    v_mfma_f32_32x32x16_f16 v[232:247], v[48:51], v[112:115], v[232:247]
    v_mfma_f32_32x32x16_f16 v[232:247], v[52:55], v[116:119], v[232:247]
    v_mfma_f32_32x32x16_f16 v[216:231], v[52:55], v[100:103], v[216:231]
    s_nop 10
    ds_bpermute_b32 v12, v19, v232
    s_waitcnt lgkmcnt(1)
    v_pk_fma_f32 v[152:153], v[184:185], v[216:217], v[152:153]
    v_pk_fma_f32 v[154:155], v[186:187], v[218:219], v[154:155]
    v_pk_fma_f32 v[156:157], v[188:189], v[220:221], v[156:157]
    v_pk_fma_f32 v[158:159], v[190:191], v[222:223], v[158:159]
    v_pk_fma_f32 v[160:161], v[192:193], v[224:225], v[160:161]
    v_pk_fma_f32 v[162:163], v[194:195], v[226:227], v[162:163]
    v_pk_fma_f32 v[164:165], v[196:197], v[228:229], v[164:165]
    v_pk_fma_f32 v[166:167], v[198:199], v[230:231], v[166:167]
    v_pk_fma_f32 v[170:171], v[202:203], v[234:235], v[170:171]
    v_pk_fma_f32 v[172:173], v[204:205], v[236:237], v[172:173]
    v_pk_fma_f32 v[174:175], v[206:207], v[238:239], v[174:175]
    v_pk_fma_f32 v[176:177], v[208:209], v[240:241], v[176:177]
    v_pk_fma_f32 v[178:179], v[210:211], v[242:243], v[178:179]
    v_pk_fma_f32 v[180:181], v[212:213], v[244:245], v[180:181]
    v_pk_fma_f32 v[182:183], v[214:215], v[246:247], v[182:183]
    v_fmac_f32 v169, v201, v233
    s_waitcnt lgkmcnt(0)
    v_fmac_f32 v168, v200, v12
    ds_read_b128 v[216:219], v3 offset:28672
    ds_read_b128 v[220:223], v3 offset:29696
    ds_read_b128 v[224:227], v3 offset:30720
    ds_read_b128 v[228:231], v3 offset:31744
    ds_read_b128 v[232:235], v3 offset:32768
    ds_read_b128 v[236:239], v3 offset:33792
    ds_read_b128 v[240:243], v3 offset:34816
    ds_read_b128 v[244:247], v3 offset:35840
    s_waitcnt lgkmcnt(0)
    s_setprio 0
    s_branch f_join
k_done:
    s_endpgm
code_end:
.p2align 8
.type tables,@object
tables:
.long 0x3c00,0x3c00,0x3c00,0x3c00,0x3c00,0x323e3bd9,0x361f3b64,0x38723aa7
.long 0x3c00,0x361f3b64,0x39a839a8,0x3b64361f,0x3c00,0x38723aa7,0x3b64361f,0x3bd9b23e
.long 0x3c00,0xbc00,0x3c00,0xbc00,0x3c00,0xb23ebbd9,0x361f3b64,0xb872baa7
.long 0x3c00,0xb61fbb64,0x39a839a8,0xbb64b61f,0x3c00,0xb872baa7,0x3b64361f,0xbbd9323e
.long 0x3c00,0x39a839a8,0x3c000000,0x39a8b9a8,0x3c00,0x3aa73872,0x3b64b61f,0x323ebbd9
.long 0x3c00,0x3b64361f,0x39a8b9a8,0xb61fbb64,0x3c00,0x3bd9323e,0x361fbb64,0xbaa7b872
.long 0x3c00,0xb9a8b9a8,0x3c000000,0xb9a839a8,0x3c00,0xbaa7b872,0x3b64b61f,0xb23e3bd9
.long 0x3c00,0xbb64b61f,0x39a8b9a8,0x361f3b64,0x3c00,0xbbd9b23e,0x361fbb64,0x3aa73872
.long 0x3c00,0x3c000000,0xbc00,0xbc008000,0x3c00,0x3bd9b23e,0xb61fbb64,0xbaa73872
.long 0x3c00,0x3b64b61f,0xb9a8b9a8,0xb61f3b64,0x3c00,0x3aa7b872,0xbb64b61f,0x323e3bd9
.long 0x3c00,0xbc008000,0xbc00,0x3c000000,0x3c00,0xbbd9323e,0xb61fbb64,0x3aa7b872
.long 0x3c00,0xbb64361f,0xb9a8b9a8,0x361fbb64,0x3c00,0xbaa73872,0xbb64b61f,0xb23ebbd9
.long 0x3c00,0x39a8b9a8,0xbc008000,0x39a839a8,0x3c00,0x3872baa7,0xbb64361f,0x3bd9323e
.long 0x3c00,0x361fbb64,0xb9a839a8,0x3b64b61f,0x3c00,0x323ebbd9,0xb61f3b64,0x3872baa7
.long 0x3c00,0xb9a839a8,0xbc008000,0xb9a8b9a8,0x3c00,0xb8723aa7,0xbb64361f,0xbbd9b23e
.long 0x3c00,0xb61f3b64,0xb9a839a8,0xbb64361f,0x3c00,0xb23e3bd9,0xb61f3b64,0xb8723aa7
.long 0x3c00,0x3c00,0x3c00,0x3c00,0x39a839a8,0x3aa73872,0x3b64361f,0x3bd9323e
.long 0x3c000000,0x3b64b61f,0x39a8b9a8,0x361fbb64,0x39a8b9a8,0x323ebbd9,0xb61fbb64,0xbaa7b872
.long 0x3c00,0xbc00,0x3c00,0xbc00,0x39a839a8,0xbaa7b872,0x3b64361f,0xbbd9b23e
.long 0x3c000000,0xbb64361f,0x39a8b9a8,0xb61f3b64,0x39a8b9a8,0xb23e3bd9,0xb61fbb64,0x3aa73872
.long 0xbc00,0xb9a8b9a8,0xbc008000,0xb9a839a8,0xb9a8b9a8,0xbbd9323e,0xb61f3b64,0x38723aa7
.long 0xbc008000,0xb61f3b64,0x39a839a8,0x3b64b61f,0xb9a839a8,0x38723aa7,0x3b64b61f,0xb23ebbd9
.long 0xbc00,0x39a839a8,0xbc008000,0x39a8b9a8,0xb9a8b9a8,0x3bd9b23e,0xb61f3b64,0xb872baa7
.long 0xbc008000,0x361fbb64,0x39a839a8,0xbb64361f,0xb9a839a8,0xb872baa7,0x3b64b61f,0x323e3bd9
.long 0x3c00,0x3c000000,0xbc00,0xbc008000,0x39a839a8,0x3872baa7,0xbb64b61f,0xb23e3bd9
.long 0x3c000000,0xb61fbb64,0xb9a839a8,0x3b64361f,0x39a8b9a8,0xbbd9b23e,0x361f3b64,0x3872baa7
.long 0x3c00,0xbc008000,0xbc00,0x3c000000,0x39a839a8,0xb8723aa7,0xbb64b61f,0x323ebbd9
.long 0x3c000000,0x361f3b64,0xb9a839a8,0xbb64b61f,0x39a8b9a8,0x3bd9323e,0x361f3b64,0xb8723aa7
.long 0xbc00,0xb9a839a8,0x3c000000,0xb9a8b9a8,0xb9a8b9a8,0x323e3bd9,0x361fbb64,0xbaa73872
.long 0xbc008000,0x3b64361f,0xb9a8b9a8,0x361f3b64,0xb9a839a8,0x3aa7b872,0xbb64361f,0x3bd9b23e
.long 0xbc00,0x39a8b9a8,0x3c000000,0x39a839a8,0xb9a8b9a8,0xb23ebbd9,0x361fbb64,0x3aa7b872
.long 0xbc008000,0xbb64b61f,0xb9a8b9a8,0xb61fbb64,0xb9a839a8,0xbaa73872,0xbb64361f,0xbbd9323e
.long 0x3c00,0x3c00,0x3c00,0x3c00,0x3c000000,0x3bd9b23e,0x3b64b61f,0x3aa7b872
.long 0xbc00,0xb61fbb64,0xb9a8b9a8,0xbb64b61f,0xbc008000,0xbaa73872,0xb61f3b64,0x323e3bd9
.long 0x3c00,0xbc00,0x3c00,0xbc00,0x3c000000,0xbbd9323e,0x3b64b61f,0xbaa73872
.long 0xbc00,0x361f3b64,0xb9a8b9a8,0x3b64361f,0xbc008000,0x3aa7b872,0xb61f3b64,0xb23ebbd9
.long 0x3c00,0x39a839a8,0x3c000000,0x39a8b9a8,0x3c000000,0x3872baa7,0xb61fbb64,0xbbd9b23e
.long 0xbc00,0xbb64b61f,0xb9a839a8,0x361f3b64,0xbc008000,0xb23e3bd9,0x3b64361f,0x3872baa7
.long 0x3c00,0xb9a8b9a8,0x3c000000,0xb9a839a8,0x3c000000,0xb8723aa7,0xb61fbb64,0x3bd9323e
.long 0xbc00,0x3b64361f,0xb9a839a8,0xb61fbb64,0xbc008000,0x323ebbd9,0x3b64361f,0xb8723aa7
.long 0x3c00,0x3c000000,0xbc00,0xbc008000,0x3c000000,0xb23ebbd9,0xbb64361f,0x38723aa7
.long 0xbc00,0xbb64361f,0x39a839a8,0x361fbb64,0xbc008000,0x38723aa7,0x361fbb64,0xbbd9323e
.long 0x3c00,0xbc008000,0xbc00,0x3c000000,0x3c000000,0x323e3bd9,0xbb64361f,0xb872baa7
.long 0xbc00,0x3b64b61f,0x39a839a8,0xb61f3b64,0xbc008000,0xb872baa7,0x361fbb64,0x3bd9b23e
.long 0x3c00,0x39a8b9a8,0xbc008000,0x39a839a8,0x3c000000,0xbaa7b872,0x361f3b64,0x323ebbd9
.long 0xbc00,0xb61f3b64,0x39a8b9a8,0xbb64361f,0xbc008000,0x3bd9323e,0xbb64b61f,0x3aa73872
.long 0x3c00,0xb9a839a8,0xbc008000,0xb9a8b9a8,0x3c000000,0x3aa73872,0x361f3b64,0xb23e3bd9
.long 0xbc00,0x361fbb64,0x39a8b9a8,0x3b64b61f,0xbc008000,0xbbd9b23e,0xbb64b61f,0xbaa7b872
.long 0x3c00,0x3c00,0x3c00,0x3c00,0x39a8b9a8,0x3872baa7,0x361fbb64,0x323ebbd9
.long 0xbc008000,0xbb64361f,0xb9a839a8,0xb61f3b64,0x39a839a8,0x3bd9323e,0x3b64b61f,0x3872baa7
.long 0x3c00,0xbc00,0x3c00,0xbc00,0x39a8b9a8,0xb8723aa7,0x361fbb64,0xb23e3bd9
.long 0xbc008000,0x3b64b61f,0xb9a839a8,0x361fbb64,0x39a839a8,0xbbd9b23e,0x3b64b61f,0xb8723aa7
.long 0xbc00,0xb9a8b9a8,0xbc008000,0xb9a839a8,0xb9a839a8,0x323e3bd9,0x3b64361f,0x3aa7b872
.long 0x3c000000,0x361fbb64,0xb9a8b9a8,0xbb64361f,0xb9a8b9a8,0xbaa73872,0x361f3b64,0x3bd9b23e
.long 0xbc00,0x39a839a8,0xbc008000,0x39a8b9a8,0xb9a839a8,0xb23ebbd9,0x3b64361f,0xbaa73872
.long 0x3c000000,0xb61f3b64,0xb9a8b9a8,0x3b64b61f,0xb9a8b9a8,0x3aa7b872,0x361f3b64,0xbbd9323e
.long 0x3c00,0x3c000000,0xbc00,0xbc008000,0x39a8b9a8,0xbaa7b872,0xb61f3b64,0x3bd9323e
.long 0xbc008000,0x361f3b64,0x39a8b9a8,0xbb64b61f,0x39a839a8,0x323ebbd9,0xbb64361f,0x3aa73872
.long 0x3c00,0xbc008000,0xbc00,0x3c000000,0x39a8b9a8,0x3aa73872,0xb61f3b64,0xbbd9b23e
.long 0xbc008000,0xb61fbb64,0x39a8b9a8,0x3b64361f,0x39a839a8,0xb23e3bd9,0xbb64361f,0xbaa7b872
.long 0xbc00,0xb9a839a8,0x3c000000,0xb9a8b9a8,0xb9a839a8,0x3bd9b23e,0xbb64b61f,0x38723aa7
.long 0x3c000000,0xbb64b61f,0x39a839a8,0xb61fbb64,0xb9a8b9a8,0x38723aa7,0xb61fbb64,0x323e3bd9
.long 0xbc00,0x39a8b9a8,0x3c000000,0x39a839a8,0xb9a839a8,0xbbd9323e,0xbb64b61f,0xb872baa7
.long 0x3c000000,0x3b64361f,0x39a839a8,0x361f3b64,0xb9a8b9a8,0xb872baa7,0xb61fbb64,0xb23ebbd9
.long 0x3c00,0x3c00,0x3c00,0x3c00,0xbc00,0xb23ebbd9,0xb61fbb64,0xb872baa7
.long 0x3c00,0x361f3b64,0x39a839a8,0x3b64361f,0xbc00,0xb872baa7,0xbb64b61f,0xbbd9323e
.long 0x3c00,0xbc00,0x3c00,0xbc00,0xbc00,0x323e3bd9,0xb61fbb64,0x38723aa7
.long 0x3c00,0xb61fbb64,0x39a839a8,0xbb64b61f,0xbc00,0x38723aa7,0xbb64b61f,0x3bd9b23e
.long 0x3c00,0x39a839a8,0x3c000000,0x39a8b9a8,0xbc00,0xbaa7b872,0xbb64361f,0xb23e3bd9
.long 0x3c00,0x3b64361f,0x39a8b9a8,0xb61fbb64,0xbc00,0xbbd9b23e,0xb61f3b64,0x3aa73872
.long 0x3c00,0xb9a8b9a8,0x3c000000,0xb9a839a8,0xbc00,0x3aa73872,0xbb64361f,0x323ebbd9
.long 0x3c00,0xbb64b61f,0x39a8b9a8,0x361f3b64,0xbc00,0x3bd9323e,0xb61f3b64,0xbaa7b872
.long 0x3c00,0x3c000000,0xbc00,0xbc008000,0xbc00,0xbbd9323e,0x361f3b64,0x3aa7b872
.long 0x3c00,0x3b64b61f,0xb9a8b9a8,0xb61f3b64,0xbc00,0xbaa73872,0x3b64361f,0xb23ebbd9
.long 0x3c00,0xbc008000,0xbc00,0x3c000000,0xbc00,0x3bd9b23e,0x361f3b64,0xbaa73872
.long 0x3c00,0xbb64361f,0xb9a8b9a8,0x361fbb64,0xbc00,0x3aa7b872,0x3b64361f,0x323e3bd9
.long 0x3c00,0x39a8b9a8,0xbc008000,0x39a839a8,0xbc00,0xb8723aa7,0x3b64b61f,0xbbd9b23e
.long 0x3c00,0x361fbb64,0xb9a839a8,0x3b64b61f,0xbc00,0xb23e3bd9,0x361fbb64,0xb8723aa7
.long 0x3c00,0xb9a839a8,0xbc008000,0xb9a8b9a8,0xbc00,0x3872baa7,0x3b64b61f,0x3bd9323e
.long 0x3c00,0xb61f3b64,0xb9a839a8,0xbb64361f,0xbc00,0x323ebbd9,0x361fbb64,0x3872baa7
.long 0x3c00,0x3c00,0x3c00,0x3c00,0xb9a8b9a8,0xbaa7b872,0xbb64b61f,0xbbd9b23e
.long 0x3c000000,0x3b64b61f,0x39a8b9a8,0x361fbb64,0xb9a839a8,0xb23e3bd9,0x361f3b64,0x3aa73872
.long 0x3c00,0xbc00,0x3c00,0xbc00,0xb9a8b9a8,0x3aa73872,0xbb64b61f,0x3bd9323e
.long 0x3c000000,0xbb64361f,0x39a8b9a8,0xb61f3b64,0xb9a839a8,0x323ebbd9,0x361f3b64,0xbaa7b872
.long 0xbc00,0xb9a8b9a8,0xbc008000,0xb9a839a8,0x39a839a8,0x3bd9b23e,0x361fbb64,0xb872baa7
.long 0xbc008000,0xb61f3b64,0x39a839a8,0x3b64b61f,0x39a8b9a8,0xb872baa7,0xbb64361f,0x323e3bd9
.long 0xbc00,0x39a839a8,0xbc008000,0x39a8b9a8,0x39a839a8,0xbbd9323e,0x361fbb64,0x38723aa7
.long 0xbc008000,0x361fbb64,0x39a839a8,0xbb64361f,0x39a8b9a8,0x38723aa7,0xbb64361f,0xb23ebbd9
.long 0x3c00,0x3c000000,0xbc00,0xbc008000,0xb9a8b9a8,0xb8723aa7,0x3b64361f,0x323ebbd9
.long 0x3c000000,0xb61fbb64,0xb9a839a8,0x3b64361f,0xb9a839a8,0x3bd9323e,0xb61fbb64,0xb8723aa7
.long 0x3c00,0xbc008000,0xbc00,0x3c000000,0xb9a8b9a8,0x3872baa7,0x3b64361f,0xb23e3bd9
.long 0x3c000000,0x361f3b64,0xb9a839a8,0xbb64b61f,0xb9a839a8,0xbbd9b23e,0xb61fbb64,0x3872baa7
.long 0xbc00,0xb9a839a8,0x3c000000,0xb9a8b9a8,0x39a839a8,0xb23ebbd9,0xb61f3b64,0x3aa7b872
.long 0xbc008000,0x3b64361f,0xb9a8b9a8,0x361f3b64,0x39a8b9a8,0xbaa73872,0x3b64b61f,0xbbd9323e
.long 0xbc00,0x39a8b9a8,0x3c000000,0x39a839a8,0x39a839a8,0x323e3bd9,0xb61f3b64,0xbaa73872
.long 0xbc008000,0xbb64b61f,0xb9a8b9a8,0xb61fbb64,0x39a8b9a8,0x3aa7b872,0x3b64b61f,0x3bd9b23e
.long 0x3c00,0x3c00,0x3c00,0x3c00,0xbc008000,0xbbd9323e,0xbb64361f,0xbaa73872
.long 0xbc00,0xb61fbb64,0xb9a8b9a8,0xbb64b61f,0x3c000000,0x3aa7b872,0x361fbb64,0xb23ebbd9
.long 0x3c00,0xbc00,0x3c00,0xbc00,0xbc008000,0x3bd9b23e,0xbb64361f,0x3aa7b872
.long 0xbc00,0x361f3b64,0xb9a8b9a8,0x3b64361f,0x3c000000,0xbaa73872,0x361fbb64,0x323e3bd9
.long 0x3c00,0x39a839a8,0x3c000000,0x39a8b9a8,0xbc008000,0xb8723aa7,0x361f3b64,0x3bd9323e
.long 0xbc00,0xbb64b61f,0xb9a839a8,0x361f3b64,0x3c000000,0x323ebbd9,0xbb64b61f,0xb8723aa7
.long 0x3c00,0xb9a8b9a8,0x3c000000,0xb9a839a8,0xbc008000,0x3872baa7,0x361f3b64,0xbbd9b23e
.long 0xbc00,0x3b64361f,0xb9a839a8,0xb61fbb64,0x3c000000,0xb23e3bd9,0xbb64b61f,0x3872baa7
.long 0x3c00,0x3c000000,0xbc00,0xbc008000,0xbc008000,0x323e3bd9,0x3b64b61f,0xb872baa7
.long 0xbc00,0xbb64361f,0x39a839a8,0x361fbb64,0x3c000000,0xb872baa7,0xb61f3b64,0x3bd9b23e
.long 0x3c00,0xbc008000,0xbc00,0x3c000000,0xbc008000,0xb23ebbd9,0x3b64b61f,0x38723aa7
.long 0xbc00,0x3b64b61f,0x39a839a8,0xb61f3b64,0x3c000000,0x38723aa7,0xb61f3b64,0xbbd9323e
.long 0x3c00,0x39a8b9a8,0xbc008000,0x39a839a8,0xbc008000,0x3aa73872,0xb61fbb64,0xb23e3bd9
.long 0xbc00,0xb61f3b64,0x39a8b9a8,0xbb64361f,0x3c000000,0xbbd9b23e,0x3b64361f,0xbaa7b872
.long 0x3c00,0xb9a839a8,0xbc008000,0xb9a8b9a8,0xbc008000,0xbaa7b872,0xb61fbb64,0x323ebbd9
.long 0xbc00,0x361fbb64,0x39a8b9a8,0x3b64b61f,0x3c000000,0x3bd9323e,0x3b64361f,0x3aa73872
.long 0x3c00,0x3c00,0x3c00,0x3c00,0xb9a839a8,0xb8723aa7,0xb61f3b64,0xb23e3bd9
.long 0xbc008000,0xbb64361f,0xb9a839a8,0xb61f3b64,0xb9a8b9a8,0xbbd9b23e,0xbb64361f,0xb8723aa7
.long 0x3c00,0xbc00,0x3c00,0xbc00,0xb9a839a8,0x3872baa7,0xb61f3b64,0x323ebbd9
.long 0xbc008000,0x3b64b61f,0xb9a839a8,0x361fbb64,0xb9a8b9a8,0x3bd9323e,0xbb64361f,0x3872baa7
.long 0xbc00,0xb9a8b9a8,0xbc008000,0xb9a839a8,0x39a8b9a8,0xb23ebbd9,0xbb64b61f,0xbaa73872
.long 0x3c000000,0x361fbb64,0xb9a8b9a8,0xbb64361f,0x39a839a8,0x3aa7b872,0xb61fbb64,0xbbd9323e
.long 0xbc00,0x39a839a8,0xbc008000,0x39a8b9a8,0x39a8b9a8,0x323e3bd9,0xbb64b61f,0x3aa7b872
.long 0x3c000000,0xb61f3b64,0xb9a8b9a8,0x3b64b61f,0x39a839a8,0xbaa73872,0xb61fbb64,0x3bd9b23e
.long 0x3c00,0x3c000000,0xbc00,0xbc008000,0xb9a839a8,0x3aa73872,0x361fbb64,0xbbd9b23e
.long 0xbc008000,0x361f3b64,0x39a8b9a8,0xbb64b61f,0xb9a8b9a8,0xb23e3bd9,0x3b64b61f,0xbaa7b872
.long 0x3c00,0xbc008000,0xbc00,0x3c000000,0xb9a839a8,0xbaa7b872,0x361fbb64,0x3bd9323e
.long 0xbc008000,0xb61fbb64,0x39a8b9a8,0x3b64361f,0xb9a8b9a8,0x323ebbd9,0x3b64b61f,0x3aa73872
.long 0xbc00,0xb9a839a8,0x3c000000,0xb9a8b9a8,0x39a8b9a8,0xbbd9323e,0x3b64361f,0xb872baa7
.long 0x3c000000,0xbb64b61f,0x39a839a8,0xb61fbb64,0x39a839a8,0xb872baa7,0x361f3b64,0xb23ebbd9
.long 0xbc00,0x39a8b9a8,0x3c000000,0x39a839a8,0x39a8b9a8,0x3bd9b23e,0x3b64361f,0x38723aa7
.long 0x3c000000,0x3b64361f,0x39a839a8,0x361f3b64,0x39a839a8,0x38723aa7,0x361f3b64,0x323e3bd9
.long 0x3c008000,0x3c008000,0x3c008000,0x3c008000,0x3c008000,0x3bd9b23e,0x3b64b61f,0x3aa7b872
.long 0x3c008000,0x3b64b61f,0x39a8b9a8,0x361fbb64,0x3c008000,0x3aa7b872,0x361fbb64,0xb23ebbd9
.long 0x3c008000,0xbc008000,0x3c008000,0xbc008000,0x3c008000,0xbbd9323e,0x3b64b61f,0xbaa73872
.long 0x3c008000,0xbb64361f,0x39a8b9a8,0xb61f3b64,0x3c008000,0xbaa73872,0x361fbb64,0x323e3bd9
.long 0x3c008000,0x39a8b9a8,0xbc00,0xb9a8b9a8,0x3c008000,0x3872baa7,0xb61fbb64,0xbbd9b23e
.long 0x3c008000,0x361fbb64,0xb9a8b9a8,0xbb64361f,0x3c008000,0x323ebbd9,0xbb64b61f,0xb8723aa7
.long 0x3c008000,0xb9a839a8,0xbc00,0x39a839a8,0x3c008000,0xb8723aa7,0xb61fbb64,0x3bd9323e
.long 0x3c008000,0xb61f3b64,0xb9a8b9a8,0x3b64b61f,0x3c008000,0xb23e3bd9,0xbb64b61f,0x3872baa7
.long 0x3c008000,0xbc00,0xbc008000,0x80003c00,0x3c008000,0xb23ebbd9,0xbb64361f,0x38723aa7
.long 0x3c008000,0xb61fbb64,0xb9a839a8,0x3b64361f,0x3c008000,0xb872baa7,0xb61f3b64,0x3bd9b23e
.long 0x3c008000,0x80003c00,0xbc008000,0xbc00,0x3c008000,0x323e3bd9,0xbb64361f,0xb872baa7
.long 0x3c008000,0x361f3b64,0xb9a839a8,0xbb64b61f,0x3c008000,0x38723aa7,0xb61f3b64,0xbbd9323e
.long 0x3c008000,0xb9a8b9a8,0x80003c00,0x39a8b9a8,0x3c008000,0xbaa7b872,0x361f3b64,0x323ebbd9
.long 0x3c008000,0xbb64b61f,0x39a839a8,0xb61fbb64,0x3c008000,0xbbd9b23e,0x3b64361f,0xbaa7b872
.long 0x3c008000,0x39a839a8,0x80003c00,0xb9a839a8,0x3c008000,0x3aa73872,0x361f3b64,0xb23e3bd9
.long 0x3c008000,0x3b64361f,0x39a839a8,0x361f3b64,0x3c008000,0x3bd9323e,0x3b64361f,0x3aa73872
.long 0x3c008000,0x3c008000,0x3c008000,0x3c008000,0x39a8b9a8,0x3872baa7,0x361fbb64,0x323ebbd9
.long 0xbc00,0xb61fbb64,0xb9a8b9a8,0xbb64b61f,0xb9a8b9a8,0xbbd9b23e,0xbb64361f,0xb8723aa7
.long 0x3c008000,0xbc008000,0x3c008000,0xbc008000,0x39a8b9a8,0xb8723aa7,0x361fbb64,0xb23e3bd9
.long 0xbc00,0x361f3b64,0xb9a8b9a8,0x3b64361f,0xb9a8b9a8,0x3bd9323e,0xbb64361f,0x3872baa7
.long 0xbc008000,0xb9a839a8,0x80003c00,0x39a839a8,0xb9a839a8,0x323e3bd9,0x3b64361f,0x3aa7b872
.long 0x80003c00,0x3b64361f,0x39a8b9a8,0xb61fbb64,0x39a839a8,0x3aa7b872,0xb61fbb64,0xbbd9323e
.long 0xbc008000,0x39a8b9a8,0x80003c00,0xb9a8b9a8,0xb9a839a8,0xb23ebbd9,0x3b64361f,0xbaa73872
.long 0x80003c00,0xbb64b61f,0x39a8b9a8,0x361f3b64,0x39a839a8,0xbaa73872,0xb61fbb64,0x3bd9b23e
.long 0x3c008000,0xbc00,0xbc008000,0x80003c00,0x39a8b9a8,0xbaa7b872,0xb61f3b64,0x3bd9323e
.long 0xbc00,0xbb64361f,0x39a839a8,0x361fbb64,0xb9a8b9a8,0xb23e3bd9,0x3b64b61f,0xbaa7b872
.long 0x3c008000,0x80003c00,0xbc008000,0xbc00,0x39a8b9a8,0x3aa73872,0xb61f3b64,0xbbd9b23e
.long 0xbc00,0x3b64b61f,0x39a839a8,0xb61f3b64,0xb9a8b9a8,0x323ebbd9,0x3b64b61f,0x3aa73872
.long 0xbc008000,0x39a839a8,0xbc00,0xb9a839a8,0xb9a839a8,0x3bd9b23e,0xbb64b61f,0x38723aa7
.long 0x80003c00,0x361fbb64,0xb9a839a8,0x3b64b61f,0x39a839a8,0xb872baa7,0x361f3b64,0xb23ebbd9
.long 0xbc008000,0xb9a8b9a8,0xbc00,0x39a8b9a8,0xb9a839a8,0xbbd9323e,0xbb64b61f,0xb872baa7
.long 0x80003c00,0xb61f3b64,0xb9a839a8,0xbb64361f,0x39a839a8,0x38723aa7,0x361f3b64,0x323e3bd9
.long 0x3c008000,0x3c008000,0x3c008000,0x3c008000,0xbc00,0xb23ebbd9,0xb61fbb64,0xb872baa7
.long 0xbc008000,0xbb64361f,0xb9a839a8,0xb61f3b64,0x80003c00,0x38723aa7,0x3b64361f,0x3bd9b23e
.long 0x3c008000,0xbc008000,0x3c008000,0xbc008000,0xbc00,0x323e3bd9,0xb61fbb64,0x38723aa7
.long 0xbc008000,0x3b64b61f,0xb9a839a8,0x361fbb64,0x80003c00,0xb872baa7,0x3b64361f,0xbbd9323e
.long 0x3c008000,0x39a8b9a8,0xbc00,0xb9a8b9a8,0xbc00,0xbaa7b872,0xbb64361f,0xb23e3bd9
.long 0xbc008000,0xb61f3b64,0x39a839a8,0x3b64b61f,0x80003c00,0x3bd9323e,0x361fbb64,0xbaa7b872
.long 0x3c008000,0xb9a839a8,0xbc00,0x39a839a8,0xbc00,0x3aa73872,0xbb64361f,0x323ebbd9
.long 0xbc008000,0x361fbb64,0x39a839a8,0xbb64361f,0x80003c00,0xbbd9b23e,0x361fbb64,0x3aa73872
.long 0x3c008000,0xbc00,0xbc008000,0x80003c00,0xbc00,0xbbd9323e,0x361f3b64,0x3aa7b872
.long 0xbc008000,0x361f3b64,0x39a8b9a8,0xbb64b61f,0x80003c00,0x3aa7b872,0xbb64b61f,0x323e3bd9
.long 0x3c008000,0x80003c00,0xbc008000,0xbc00,0xbc00,0x3bd9b23e,0x361f3b64,0xbaa73872
.long 0xbc008000,0xb61fbb64,0x39a8b9a8,0x3b64361f,0x80003c00,0xbaa73872,0xbb64b61f,0xb23ebbd9
.long 0x3c008000,0xb9a8b9a8,0x80003c00,0x39a8b9a8,0xbc00,0xb8723aa7,0x3b64b61f,0xbbd9b23e
.long 0xbc008000,0x3b64361f,0xb9a8b9a8,0x361f3b64,0x80003c00,0x323ebbd9,0xb61f3b64,0x3872baa7
.long 0x3c008000,0x39a839a8,0x80003c00,0xb9a839a8,0xbc00,0x3872baa7,0x3b64b61f,0x3bd9323e
.long 0xbc008000,0xbb64b61f,0xb9a8b9a8,0xb61fbb64,0x80003c00,0xb23e3bd9,0xb61f3b64,0xb8723aa7
.long 0x3c008000,0x3c008000,0x3c008000,0x3c008000,0xb9a8b9a8,0xbaa7b872,0xbb64b61f,0xbbd9b23e
.long 0x80003c00,0x361f3b64,0x39a839a8,0x3b64361f,0x39a8b9a8,0x323ebbd9,0xb61fbb64,0xbaa7b872
.long 0x3c008000,0xbc008000,0x3c008000,0xbc008000,0xb9a8b9a8,0x3aa73872,0xbb64b61f,0x3bd9323e
.long 0x80003c00,0xb61fbb64,0x39a839a8,0xbb64b61f,0x39a8b9a8,0xb23e3bd9,0xb61fbb64,0x3aa73872
.long 0xbc008000,0xb9a839a8,0x80003c00,0x39a839a8,0x39a839a8,0x3bd9b23e,0x361fbb64,0xb872baa7
.long 0xbc00,0xbb64b61f,0xb9a839a8,0x361f3b64,0xb9a839a8,0x38723aa7,0x3b64b61f,0xb23ebbd9
.long 0xbc008000,0x39a8b9a8,0x80003c00,0xb9a8b9a8,0x39a839a8,0xbbd9323e,0x361fbb64,0x38723aa7
.long 0xbc00,0x3b64361f,0xb9a839a8,0xb61fbb64,0xb9a839a8,0xb872baa7,0x3b64b61f,0x323e3bd9
.long 0x3c008000,0xbc00,0xbc008000,0x80003c00,0xb9a8b9a8,0xb8723aa7,0x3b64361f,0x323ebbd9
.long 0x80003c00,0x3b64b61f,0xb9a8b9a8,0xb61f3b64,0x39a8b9a8,0xbbd9b23e,0x361f3b64,0x3872baa7
.long 0x3c008000,0x80003c00,0xbc008000,0xbc00,0xb9a8b9a8,0x3872baa7,0x3b64361f,0xb23e3bd9
.long 0x80003c00,0xbb64361f,0xb9a8b9a8,0x361fbb64,0x39a8b9a8,0x3bd9323e,0x361f3b64,0xb8723aa7
.long 0xbc008000,0x39a839a8,0xbc00,0xb9a839a8,0x39a839a8,0xb23ebbd9,0xb61f3b64,0x3aa7b872
.long 0xbc00,0xb61f3b64,0x39a8b9a8,0xbb64361f,0xb9a839a8,0x3aa7b872,0xbb64361f,0x3bd9b23e
.long 0xbc008000,0xb9a8b9a8,0xbc00,0x39a8b9a8,0x39a839a8,0x323e3bd9,0xb61f3b64,0xbaa73872
.long 0xbc00,0x361fbb64,0x39a8b9a8,0x3b64b61f,0xb9a839a8,0xbaa73872,0xbb64361f,0xbbd9323e
.long 0x3c008000,0x3c008000,0x3c008000,0x3c008000,0xbc008000,0xbbd9323e,0xbb64361f,0xbaa73872
.long 0x3c008000,0x3b64b61f,0x39a8b9a8,0x361fbb64,0xbc008000,0xbaa73872,0xb61f3b64,0x323e3bd9
.long 0x3c008000,0xbc008000,0x3c008000,0xbc008000,0xbc008000,0x3bd9b23e,0xbb64361f,0x3aa7b872
.long 0x3c008000,0xbb64361f,0x39a8b9a8,0xb61f3b64,0xbc008000,0x3aa7b872,0xb61f3b64,0xb23ebbd9
.long 0x3c008000,0x39a8b9a8,0xbc00,0xb9a8b9a8,0xbc008000,0xb8723aa7,0x361f3b64,0x3bd9323e
.long 0x3c008000,0x361fbb64,0xb9a8b9a8,0xbb64361f,0xbc008000,0xb23e3bd9,0x3b64361f,0x3872baa7
.long 0x3c008000,0xb9a839a8,0xbc00,0x39a839a8,0xbc008000,0x3872baa7,0x361f3b64,0xbbd9b23e
.long 0x3c008000,0xb61f3b64,0xb9a8b9a8,0x3b64b61f,0xbc008000,0x323ebbd9,0x3b64361f,0xb8723aa7
.long 0x3c008000,0xbc00,0xbc008000,0x80003c00,0xbc008000,0x323e3bd9,0x3b64b61f,0xb872baa7
.long 0x3c008000,0xb61fbb64,0xb9a839a8,0x3b64361f,0xbc008000,0x38723aa7,0x361fbb64,0xbbd9323e
.long 0x3c008000,0x80003c00,0xbc008000,0xbc00,0xbc008000,0xb23ebbd9,0x3b64b61f,0x38723aa7
.long 0x3c008000,0x361f3b64,0xb9a839a8,0xbb64b61f,0xbc008000,0xb872baa7,0x361fbb64,0x3bd9b23e
.long 0x3c008000,0xb9a8b9a8,0x80003c00,0x39a8b9a8,0xbc008000,0x3aa73872,0xb61fbb64,0xb23e3bd9
.long 0x3c008000,0xbb64b61f,0x39a839a8,0xb61fbb64,0xbc008000,0x3bd9323e,0xbb64b61f,0x3aa73872
.long 0x3c008000,0x39a839a8,0x80003c00,0xb9a839a8,0xbc008000,0xbaa7b872,0xb61fbb64,0x323ebbd9
.long 0x3c008000,0x3b64361f,0x39a839a8,0x361f3b64,0xbc008000,0xbbd9b23e,0xbb64b61f,0xbaa7b872
.long 0x3c008000,0x3c008000,0x3c008000,0x3c008000,0xb9a839a8,0xb8723aa7,0xb61f3b64,0xb23e3bd9
.long 0xbc00,0xb61fbb64,0xb9a8b9a8,0xbb64b61f,0x39a839a8,0x3bd9323e,0x3b64b61f,0x3872baa7
.long 0x3c008000,0xbc008000,0x3c008000,0xbc008000,0xb9a839a8,0x3872baa7,0xb61f3b64,0x323ebbd9
.long 0xbc00,0x361f3b64,0xb9a8b9a8,0x3b64361f,0x39a839a8,0xbbd9b23e,0x3b64b61f,0xb8723aa7
.long 0xbc008000,0xb9a839a8,0x80003c00,0x39a839a8,0x39a8b9a8,0xb23ebbd9,0xbb64b61f,0xbaa73872
.long 0x80003c00,0x3b64361f,0x39a8b9a8,0xb61fbb64,0xb9a8b9a8,0xbaa73872,0x361f3b64,0x3bd9b23e
.long 0xbc008000,0x39a8b9a8,0x80003c00,0xb9a8b9a8,0x39a8b9a8,0x323e3bd9,0xbb64b61f,0x3aa7b872
.long 0x80003c00,0xbb64b61f,0x39a8b9a8,0x361f3b64,0xb9a8b9a8,0x3aa7b872,0x361f3b64,0xbbd9323e
.long 0x3c008000,0xbc00,0xbc008000,0x80003c00,0xb9a839a8,0x3aa73872,0x361fbb64,0xbbd9b23e
.long 0xbc00,0xbb64361f,0x39a839a8,0x361fbb64,0x39a839a8,0x323ebbd9,0xbb64361f,0x3aa73872
.long 0x3c008000,0x80003c00,0xbc008000,0xbc00,0xb9a839a8,0xbaa7b872,0x361fbb64,0x3bd9323e
.long 0xbc00,0x3b64b61f,0x39a839a8,0xb61f3b64,0x39a839a8,0xb23e3bd9,0xbb64361f,0xbaa7b872
.long 0xbc008000,0x39a839a8,0xbc00,0xb9a839a8,0x39a8b9a8,0xbbd9323e,0x3b64361f,0xb872baa7
.long 0x80003c00,0x361fbb64,0xb9a839a8,0x3b64b61f,0xb9a8b9a8,0x38723aa7,0xb61fbb64,0x323e3bd9
.long 0xbc008000,0xb9a8b9a8,0xbc00,0x39a8b9a8,0x39a8b9a8,0x3bd9b23e,0x3b64361f,0x38723aa7
.long 0x80003c00,0xb61f3b64,0xb9a839a8,0xbb64361f,0xb9a8b9a8,0xb872baa7,0xb61fbb64,0xb23ebbd9
.long 0x3c008000,0x3c008000,0x3c008000,0x3c008000,0x80003c00,0x323e3bd9,0x361f3b64,0x38723aa7
.long 0xbc008000,0xbb64361f,0xb9a839a8,0xb61f3b64,0xbc00,0xb872baa7,0xbb64b61f,0xbbd9323e
.long 0x3c008000,0xbc008000,0x3c008000,0xbc008000,0x80003c00,0xb23ebbd9,0x361f3b64,0xb872baa7
.long 0xbc008000,0x3b64b61f,0xb9a839a8,0x361fbb64,0xbc00,0x38723aa7,0xbb64b61f,0x3bd9b23e
.long 0x3c008000,0x39a8b9a8,0xbc00,0xb9a8b9a8,0x80003c00,0x3aa73872,0x3b64b61f,0x323ebbd9
.long 0xbc008000,0xb61f3b64,0x39a839a8,0x3b64b61f,0xbc00,0xbbd9b23e,0xb61f3b64,0x3aa73872
.long 0x3c008000,0xb9a839a8,0xbc00,0x39a839a8,0x80003c00,0xbaa7b872,0x3b64b61f,0xb23e3bd9
.long 0xbc008000,0x361fbb64,0x39a839a8,0xbb64361f,0xbc00,0x3bd9323e,0xb61f3b64,0xbaa7b872
.long 0x3c008000,0xbc00,0xbc008000,0x80003c00,0x80003c00,0x3bd9b23e,0xb61fbb64,0xbaa73872
.long 0xbc008000,0x361f3b64,0x39a8b9a8,0xbb64b61f,0xbc00,0xbaa73872,0x3b64361f,0xb23ebbd9
.long 0x3c008000,0x80003c00,0xbc008000,0xbc00,0x80003c00,0xbbd9323e,0xb61fbb64,0x3aa7b872
.long 0xbc008000,0xb61fbb64,0x39a8b9a8,0x3b64361f,0xbc00,0x3aa7b872,0x3b64361f,0x323e3bd9
.long 0x3c008000,0xb9a8b9a8,0x80003c00,0x39a8b9a8,0x80003c00,0x3872baa7,0xbb64361f,0x3bd9323e
.long 0xbc008000,0x3b64361f,0xb9a8b9a8,0x361f3b64,0xbc00,0xb23e3bd9,0x361fbb64,0xb8723aa7
.long 0x3c008000,0x39a839a8,0x80003c00,0xb9a839a8,0x80003c00,0xb8723aa7,0xbb64361f,0xbbd9b23e
.long 0xbc008000,0xbb64b61f,0xb9a8b9a8,0xb61fbb64,0xbc00,0x323ebbd9,0x361fbb64,0x3872baa7
.long 0x3c008000,0x3c008000,0x3c008000,0x3c008000,0x39a839a8,0x3aa73872,0x3b64361f,0x3bd9323e
.long 0x80003c00,0x361f3b64,0x39a839a8,0x3b64361f,0xb9a839a8,0xb23e3bd9,0x361f3b64,0x3aa73872
.long 0x3c008000,0xbc008000,0x3c008000,0xbc008000,0x39a839a8,0xbaa7b872,0x3b64361f,0xbbd9b23e
.long 0x80003c00,0xb61fbb64,0x39a839a8,0xbb64b61f,0xb9a839a8,0x323ebbd9,0x361f3b64,0xbaa7b872
.long 0xbc008000,0xb9a839a8,0x80003c00,0x39a839a8,0xb9a8b9a8,0xbbd9323e,0xb61f3b64,0x38723aa7
.long 0xbc00,0xbb64b61f,0xb9a839a8,0x361f3b64,0x39a8b9a8,0xb872baa7,0xbb64361f,0x323e3bd9
.long 0xbc008000,0x39a8b9a8,0x80003c00,0xb9a8b9a8,0xb9a8b9a8,0x3bd9b23e,0xb61f3b64,0xb872baa7
.long 0xbc00,0x3b64361f,0xb9a839a8,0xb61fbb64,0x39a8b9a8,0x38723aa7,0xbb64361f,0xb23ebbd9
.long 0x3c008000,0xbc00,0xbc008000,0x80003c00,0x39a839a8,0x3872baa7,0xbb64b61f,0xb23e3bd9
.long 0x80003c00,0x3b64b61f,0xb9a8b9a8,0xb61f3b64,0xb9a839a8,0x3bd9323e,0xb61fbb64,0xb8723aa7
.long 0x3c008000,0x80003c00,0xbc008000,0xbc00,0x39a839a8,0xb8723aa7,0xbb64b61f,0x323ebbd9
.long 0x80003c00,0xbb64361f,0xb9a8b9a8,0x361fbb64,0xb9a839a8,0xbbd9b23e,0xb61fbb64,0x3872baa7
.long 0xbc008000,0x39a839a8,0xbc00,0xb9a839a8,0xb9a8b9a8,0x323e3bd9,0x361fbb64,0xbaa73872
.long 0xbc00,0xb61f3b64,0x39a8b9a8,0xbb64361f,0x39a8b9a8,0xbaa73872,0x3b64b61f,0xbbd9323e
.long 0xbc008000,0xb9a8b9a8,0xbc00,0x39a8b9a8,0xb9a8b9a8,0xb23ebbd9,0x361fbb64,0x3aa7b872
.long 0xbc00,0x361fbb64,0x39a8b9a8,0x3b64b61f,0x39a8b9a8,0x3aa7b872,0x3b64b61f,0x3bd9b23e
.long 0x3f800000,0x3f800000,0x3f800000,0x3f800000,0x3f800000,0x3f7ffec4,0x3f7ffb11,0x3f7ff4e6
.long 0x3f800000,0x3f7ffb11,0x3f7fec43,0x3f7fd397,0x3f800000,0x3f7ff4e6,0x3f7fd397,0x3f7f9c18
.long 0x3f800000,0x3f7ec46d,0x3f7b14be,0x3f74fa0b,0x3f800000,0x3f7e9bc9,0x3f7a7302,0x3f73913f
.long 0x3f800000,0x3f7e70b0,0x3f79c79d,0x3f721352,0x3f800000,0x3f7e4323,0x3f791298,0x3f708066
.long 0x3f800000,0x3f7fec43,0x3f7fb10f,0x3f7f4e6d,0x3f800000,0x3f7fe129,0x3f7f84ab,0x3f7eea9d
.long 0x3f800000,0x3f7fd397,0x3f7f4e6d,0x3f7e70b0,0x3f800000,0x3f7fc38f,0x3f7f0e58,0x3f7de0b1
.long 0x3f800000,0x3f7e1324,0x3f7853f8,0x3f6ed89e,0x3f800000,0x3f7de0b1,0x3f778bc5,0x3f6d1c1d
.long 0x3f800000,0x3f7dabcc,0x3f76ba07,0x3f6b4b0c,0x3f800000,0x3f7d7474,0x3f75dec6,0x3f696591
.long 0x3f800000,0x3f7fb10f,0x3f7ec46d,0x3f7d3aac,0x3f800000,0x3f7f9c18,0x3f7e70b0,0x3f7c7eb0
.long 0x3f800000,0x3f7f84ab,0x3f7e1324,0x3f7baccd,0x3f800000,0x3f7f6ac7,0x3f7dabcc,0x3f7ac516
.long 0x3f800000,0x3f7d3aac,0x3f74fa0b,0x3f676bd8,0x3f800000,0x3f7cfe73,0x3f740bdd,0x3f655e0b
.long 0x3f800000,0x3f7cbfc9,0x3f731447,0x3f633c5a,0x3f800000,0x3f7c7eb0,0x3f721352,0x3f6106f2
.long 0x3f800000,0x3f7f4e6d,0x3f7d3aac,0x3f79c79d,0x3f800000,0x3f7f2f9d,0x3f7cbfc9,0x3f78b47b
.long 0x3f800000,0x3f7f0e58,0x3f7c3b28,0x3f778bc5,0x3f800000,0x3f7eea9d,0x3f7baccd,0x3f764d97
.long 0x3f800000,0x3f7c3b28,0x3f710908,0x3f5ebe05,0x3f800000,0x3f7bf531,0x3f6ff573,0x3f5c61c7
.long 0x3f800000,0x3f7baccd,0x3f6ed89e,0x3f59f26a,0x3f800000,0x3f7b61fc,0x3f6db293,0x3f577026
.long 0x3f800000,0x3f800000,0x3f800000,0x3f800000,0x3f7fec43,0x3f7fe129,0x3f7fd397,0x3f7fc38f
.long 0x3f7fb10f,0x3f7f84ab,0x3f7f4e6d,0x3f7f0e58,0x3f7f4e6d,0x3f7eea9d,0x3f7e70b0,0x3f7de0b1
.long 0x3f6c835e,0x3f61c598,0x3f54db31,0x3f45e403,0x3f6a09a7,0x3f5df6be,0x3f4f7a1f,0x3f3ebc1b
.long 0x3f676bd8,0x3f59f26a,0x3f49d112,0x3f373a23,0x3f64aa59,0x3f55b993,0x3f43e200,0x3f2f61a5
.long 0x3f7ec46d,0x3f7e1324,0x3f7d3aac,0x3f7c3b28,0x3f7e1324,0x3f7cfe73,0x3f7baccd,0x3f7a1e84
.long 0x3f7d3aac,0x3f7baccd,0x3f79c79d,0x3f778bc5,0x3f7c3b28,0x3f7a1e84,0x3f778bc5,0x3f748422
.long 0x3f61c598,0x3f514d3d,0x3f3daef9,0x3f273656,0x3f5ebe05,0x3f4cae79,0x3f373a23,0x3f1ebc12
.long 0x3f5b941a,0x3f47de65,0x3f3085bb,0x3f15f6d9,0x3f584853,0x3f42de29,0x3f299415,0x3f0cead0
.long 0x3f7b14be,0x3f7853f8,0x3f74fa0b,0x3f710908,0x3f79c79d,0x3f764d97,0x3f721352,0x3f6d1c1d
.long 0x3f7853f8,0x3f740bdd,0x3f6ed89e,0x3f68bf3c,0x3f76ba07,0x3f718f57,0x3f6b4b0c,0x3f63f473
.long 0x3f54db31,0x3f3daef9,0x3f226799,0x3f039c3d,0x3f514d3d,0x3f385216,0x3f1b02c6,0x3ef41f07
.long 0x3f4d9f02,0x3f32c8c9,0x3f13682a,0x3ee0924f,0x3f49d112,0x3f2d1469,0x3f0b9a6b,0x3ecc9b8b
.long 0x3f74fa0b,0x3f6ed89e,0x3f676bd8,0x3f5ebe05,0x3f731447,0x3f6be858,0x3f633c5a,0x3f591e6a
.long 0x3f710908,0x3f68bf3c,0x3f5ebe05,0x3f531849,0x3f6ed89e,0x3f655e0b,0x3f59f26a,0x3f4cae79
.long 0x3f45e403,0x3f273656,0x3f039c3d,0x3eb8442a,0x3f41d870,0x3f212ff9,0x3ef6e0cb,0x3ea395c5
.long 0x3f3daef9,0x3f1b02c6,0x3ee63375,0x3e8e9a22,0x3f396842,0x3f14b039,0x3ed53641,0x3e72b651
.long 0x3f800000,0x3f800000,0x3f800000,0x3f800000,0x3f7fb10f,0x3f7f9c18,0x3f7f84ab,0x3f7f6ac7
.long 0x3f7ec46d,0x3f7e70b0,0x3f7e1324,0x3f7dabcc,0x3f7d3aac,0x3f7c7eb0,0x3f7baccd,0x3f7ac516
.long 0x3f3504f3,0x3f226799,0x3f0e39da,0x3ef15aea,0x3f2beb4a,0x3f173c07,0x3f00e7e4,0x3ed25a09
.long 0x3f226799,0x3f0b9a6b,0x3ee63375,0x3eb263ef,0x3f187fc0,0x3eff17b2,0x3ec9b953,0x3e919ddd
.long 0x3f7b14be,0x3f79c79d,0x3f7853f8,0x3f76ba07,0x3f7853f8,0x3f764d97,0x3f740bdd,0x3f718f57
.long 0x3f74fa0b,0x3f721352,0x3f6ed89e,0x3f6b4b0c,0x3f710908,0x3f6d1c1d,0x3f68bf3c,0x3f63f473
.long 0x3f0e39da,0x3ee63375,0x3eac7cd4,0x3e605c13,0x3f039c3d,0x3ecc9b8b,0x3e8e9a22,0x3e1c76de
.long 0x3ef15aea,0x3eb263ef,0x3e605c13,0x3dafb680,0x3edae880,0x3e97a117,0x3e22abb6,0x3c96c9b6
.long 0x3f6c835e,0x3f676bd8,0x3f61c598,0x3f5b941a,0x3f676bd8,0x3f6106f2,0x3f59f26a,0x3f5233c6
.long 0x3f61c598,0x3f59f26a,0x3f514d3d,0x3f47de65,0x3f5b941a,0x3f5233c6,0x3f47de65,0x3f3ca003
.long 0x3ec3ef15,0x3e78cfcc,0x3dc8bd36,0xbd48fb30,0x3eac7cd4,0x3e419b37,0x3d16c32c,0xbdee3876
.long 0x3e94a031,0x3e09cf86,0xbcc90ab0,0xbe3b6ecf,0x3e78cfcc,0x3da3308c,0xbdafb680,0xbe7ee6e1
.long 0x3f54db31,0x3f49d112,0x3f3daef9,0x3f3085bb,0x3f4d9f02,0x3f40d0da,0x3f32c8c9,0x3f239da9
.long 0x3f45e403,0x3f373a23,0x3f273656,0x3f15f6d9,0x3f3daef9,0x3f2d1469,0x3f1b02c6,0x3f07a136
.long 0x3e47c5c2,0x3cc90ab0,0xbe164083,0xbea09ae5,0x3e164083,0xbcfb49ba,0xbe541501,0xbec1071e
.long 0x3dc8bd36,0xbdafb680,0xbe888e93,0xbee0924f,0x3d48fb30,0xbe1008b7,0xbea68f12,0xbeff17b2
.long 0x3f800000,0x3f800000,0x3f800000,0x3f800000,0x3f7f4e6d,0x3f7f2f9d,0x3f7f0e58,0x3f7eea9d
.long 0x3f7d3aac,0x3f7cbfc9,0x3f7c3b28,0x3f7baccd,0x3f79c79d,0x3f78b47b,0x3f778bc5,0x3f764d97
.long 0x3ec3ef15,0x3e94a031,0x3e47c5c2,0x3dc8bd36,0x3ea09ae5,0x3e5a3997,0x3de1bc2e,0x3bc90f88
.long 0x3e78cfcc,0x3e09cf86,0x3cc90ab0,0xbdafb680,0x3e2f10a2,0x3d621469,0xbd7b2b74,0xbe354098
.long 0x3f74fa0b,0x3f731447,0x3f710908,0x3f6ed89e,0x3f6ed89e,0x3f6be858,0x3f68bf3c,0x3f655e0b
.long 0x3f676bd8,0x3f633c5a,0x3f5ebe05,0x3f59f26a,0x3f5ebe05,0x3f591e6a,0x3f531849,0x3f4cae79
.long 0x3dc8bd36,0xbcc90ab0,0xbe164083,0xbe888e93,0x3cc90ab0,0xbdd53db9,0xbe6c9a7f,0xbeb554ec
.long 0xbd48fb30,0xbe3b6ecf,0xbea09ae5,0xbee0924f,0xbdfab273,0xbe8586ce,0xbec9b953,0xbf04f484
.long 0x3f54db31,0x3f4d9f02,0x3f45e403,0x3f3daef9,0x3f49d112,0x3f40d0da,0x3f373a23,0x3f2d1469
.long 0x3f3daef9,0x3f32c8c9,0x3f273656,0x3f1b02c6,0x3f3085bb,0x3f239da9,0x3f15f6d9,0x3f07a136
.long 0xbe47c5c2,0xbeac7cd4,0xbef15aea,0xbf187fc0,0xbe888e93,0xbed25a09,0xbf0b9a6b,0xbf2ac082
.long 0xbeac7cd4,0xbef6e0cb,0xbf1d7fd1,0xbf3b8f3b,0xbecf7bca,0xbf0cead0,0xbf2e3bde,0xbf4ac77f
.long 0x3f226799,0x3f13682a,0x3f039c3d,0x3ee63375,0x3f13682a,0x3f0242b1,0x3ee0924f,0x3ebb31a0
.long 0x3f039c3d,0x3ee0924f,0x3eb8442a,0x3e8e9a22,0x3ee63375,0x3ebb31a0,0x3e8e9a22,0x3e419b37
.long 0xbef15aea,0xbf1d7fd1,0xbf3daef9,0xbf584853,0xbf08f59b,0xbf2d1469,0xbf4bbbf8,0xbf63f473
.long 0xbf187fc0,0xbf3b8f3b,0xbf584853,0xbf6db293,0xbf273656,0xbf48d8b3,0xbf633c5a,0xbf756d97
.long 0x3f800000,0x3f800000,0x3f800000,0x3f800000,0x3f7ec46d,0x3f7e9bc9,0x3f7e70b0,0x3f7e4323
.long 0x3f7b14be,0x3f7a7302,0x3f79c79d,0x3f791298,0x3f74fa0b,0x3f73913f,0x3f721352,0x3f708066
.long 0x248d3132,0xbdc8bd36,0xbe47c5c2,0xbe94a031,0xbdc8bd36,0xbe4dee60,0xbe9aa086,0xbecc9b8b
.long 0xbe47c5c2,0xbe9aa086,0xbecf7bca,0xbf00e7e4,0xbe94a031,0xbecc9b8b,0xbf00e7e4,0xbf19c200
.long 0x3f6c835e,0x3f6a09a7,0x3f676bd8,0x3f64aa59,0x3f61c598,0x3f5df6be,0x3f59f26a,0x3f55b993
.long 0x3f54db31,0x3f4f7a1f,0x3f49d112,0x3f43e200,0x3f45e403,0x3f3ebc1b,0x3f373a23,0x3f2f61a5
.long 0xbec3ef15,0xbefc5d27,0xbf187fc0,0xbf3085bb,0xbef15aea,0xbf14b039,0xbf2e3bde,0xbf44e3f5
.long 0xbf0e39da,0xbf299415,0xbf41d870,0xbf5695e5,0xbf226799,0xbf3ca003,0xbf531849,0xbf655e0b
.long 0x3f3504f3,0x3f2beb4a,0x3f226799,0x3f187fc0,0x3f226799,0x3f173c07,0x3f0b9a6b,0x3eff17b2
.long 0x3f0e39da,0x3f00e7e4,0x3ee63375,0x3ec9b953,0x3ef15aea,0x3ed25a09,0x3eb263ef,0x3e919ddd
.long 0xbf3504f3,0xbf4d9f02,0xbf61c598,0xbf710908,0xbf45e403,0xbf5c61c7,0xbf6db293,0xbf796e4e
.long 0xbf54db31,0xbf68bf3c,0xbf76ba07,0xbf7e70b0,0xbf61c598,0xbf7294f8,0xbf7cbfc9,0xbf7ffec4
.long 0x3ec3ef15,0x3ea09ae5,0x3e78cfcc,0x3e2f10a2,0x3e94a031,0x3e5a3997,0x3e09cf86,0x3d621469
.long 0x3e47c5c2,0x3de1bc2e,0x3cc90ab0,0xbd7b2b74,0x3dc8bd36,0x3bc90f88,0xbdafb680,0xbe354098
.long 0xbf6c835e,0xbf79c79d,0xbf7fb10f,0xbf7e1324,0xbf74fa0b,0xbf7e4323,0xbf7f84ab,0xbf78b47b
.long 0xbf7b14be,0xbf7ffb11,0xbf7c3b28,0xbf6ff573,0xbf7ec46d,0xbf7eea9d,0xbf75dec6,0xbf63f473
.long 0x3f800000,0x3f800000,0x3f800000,0x3f800000,0x3f7e1324,0x3f7de0b1,0x3f7dabcc,0x3f7d7474
.long 0x3f7853f8,0x3f778bc5,0x3f76ba07,0x3f75dec6,0x3f6ed89e,0x3f6d1c1d,0x3f6b4b0c,0x3f696591
.long 0xbec3ef15,0xbef15aea,0xbf0e39da,0xbf226799,0xbefc5d27,0xbf14b039,0xbf299415,0xbf3ca003
.long 0xbf187fc0,0xbf2e3bde,0xbf41d870,0xbf531849,0xbf3085bb,0xbf44e3f5,0xbf5695e5,0xbf655e0b
.long 0x3f61c598,0x3f5ebe05,0x3f5b941a,0x3f584853,0x3f514d3d,0x3f4cae79,0x3f47de65,0x3f42de29
.long 0x3f3daef9,0x3f373a23,0x3f3085bb,0x3f299415,0x3f273656,0x3f1ebc12,0x3f15f6d9,0x3f0cead0
.long 0xbf45e403,0xbf584853,0xbf676bd8,0xbf731447,0xbf584853,0xbf6816a8,0xbf740bdd,0xbf7bf531
.long 0xbf676bd8,0xbf740bdd,0xbf7c3b28,0xbf7fd397,0xbf731447,0xbf7bf531,0xbf7fd397,0xbf7e9bc9
.long 0x3f0e39da,0x3f039c3d,0x3ef15aea,0x3edae880,0x3ee63375,0x3ecc9b8b,0x3eb263ef,0x3e97a117
.long 0x3eac7cd4,0x3e8e9a22,0x3e605c13,0x3e22abb6,0x3e605c13,0x3e1c76de,0x3dafb680,0x3c96c9b6
.long 0xbf7b14be,0xbf7fb10f,0xbf7ec46d,0xbf7853f8,0xbf7f4e6d,0xbf7f2f9d,0xbf791298,0xbf6d1c1d
.long 0xbf7fb10f,0xbf7a7302,0xbf6ed89e,0xbf5d2d53,0xbf7c3b28,0xbf718f57,0xbf604621,0xbf48d8b3
.long 0x3dc8bd36,0x3cc90ab0,0xbd48fb30,0xbdfab273,0xbcc90ab0,0xbdd53db9,0xbe3b6ecf,0xbe8586ce
.long 0xbe164083,0xbe6c9a7f,0xbea09ae5,0xbec9b953,0xbe888e93,0xbeb554ec,0xbee0924f,0xbf04f484
.long 0xbf74fa0b,0xbf64aa59,0xbf4d9f02,0xbf3085bb,0xbf6a09a7,0xbf53fac3,0xbf373a23,0xbf14b039
.long 0xbf5b941a,0xbf3fc767,0xbf1d7fd1,0xbeebcbbb,0xbf49d112,0xbf286605,0xbf00e7e4,0xbea986c4
.long 0x3f800000,0x3f800000,0x3f800000,0x3f800000,0x3f7d3aac,0x3f7cfe73,0x3f7cbfc9,0x3f7c7eb0
.long 0x3f74fa0b,0x3f740bdd,0x3f731447,0x3f721352,0x3f676bd8,0x3f655e0b,0x3f633c5a,0x3f6106f2
.long 0xbf3504f3,0xbf45e403,0xbf54db31,0xbf61c598,0xbf4d9f02,0xbf5c61c7,0xbf68bf3c,0xbf7294f8
.long 0xbf61c598,0xbf6db293,0xbf76ba07,0xbf7cbfc9,0xbf710908,0xbf796e4e,0xbf7e70b0,0xbf7ffec4
.long 0x3f54db31,0x3f514d3d,0x3f4d9f02,0x3f49d112,0x3f3daef9,0x3f385216,0x3f32c8c9,0x3f2d1469
.long 0x3f226799,0x3f1b02c6,0x3f13682a,0x3f0b9a6b,0x3f039c3d,0x3ef41f07,0x3ee0924f,0x3ecc9b8b
.long 0xbf7b14be,0xbf7f4e6d,0xbf7fb10f,0xbf7c3b28,0xbf7fb10f,0xbf7f2f9d,0xbf7a7302,0xbf718f57
.long 0xbf7ec46d,0xbf791298,0xbf6ed89e,0xbf604621,0xbf7853f8,0xbf6d1c1d,0xbf5d2d53,0xbf48d8b3
.long 0x3ec3ef15,0x3eac7cd4,0x3e94a031,0x3e78cfcc,0x3e78cfcc,0x3e419b37,0x3e09cf86,0x3da3308c
.long 0x3dc8bd36,0x3d16c32c,0xbcc90ab0,0xbdafb680,0xbd48fb30,0xbdee3876,0xbe3b6ecf,0xbe7ee6e1
.long 0xbf6c835e,0xbf5b941a,0xbf45e403,0xbf2beb4a,0xbf5b941a,0xbf44e3f5,0xbf299415,0xbf0a48ad
.long 0xbf45e403,0xbf299415,0xbf08f59b,0xbec9b953,0xbf2beb4a,0xbf0a48ad,0xbec9b953,0xbe72b651
.long 0xbe47c5c2,0xbe888e93,0xbeac7cd4,0xbecf7bca,0xbeac7cd4,0xbed25a09,0xbef6e0cb,0xbf0cead0
.long 0xbef15aea,0xbf0b9a6b,0xbf1d7fd1,0xbf2e3bde,0xbf187fc0,0xbf2ac082,0xbf3b8f3b,0xbf4ac77f
.long 0xbf0e39da,0xbecf7bca,0xbe78cfcc,0xbd96a905,0xbedae880,0xbe8586ce,0xbdafb680,0x3dbc3ac3
.long 0xbe94a031,0xbde1bc2e,0x3d96a905,0x3e827dc0,0xbe164083,0x3d2fe007,0x3e6c9a7f,0x3ed25a09
.long 0x3f800000,0x3f800000,0x3f800000,0x3f800000,0x3f7c3b28,0x3f7bf531,0x3f7baccd,0x3f7b61fc
.long 0x3f710908,0x3f6ff573,0x3f6ed89e,0x3f6db293,0x3f5ebe05,0x3f5c61c7,0x3f59f26a,0x3f577026
.long 0xbf6c835e,0xbf74fa0b,0xbf7b14be,0xbf7ec46d,0xbf79c79d,0xbf7e4323,0xbf7ffb11,0xbf7eea9d
.long 0xbf7fb10f,0xbf7f84ab,0xbf7c3b28,0xbf75dec6,0xbf7e1324,0xbf78b47b,0xbf6ff573,0xbf63f473
.long 0x3f45e403,0x3f41d870,0x3f3daef9,0x3f396842,0x3f273656,0x3f212ff9,0x3f1b02c6,0x3f14b039
.long 0x3f039c3d,0x3ef6e0cb,0x3ee63375,0x3ed53641,0x3eb8442a,0x3ea395c5,0x3e8e9a22,0x3e72b651
.long 0xbf74fa0b,0xbf6a09a7,0xbf5b941a,0xbf49d112,0xbf64aa59,0xbf53fac3,0xbf3fc767,0xbf286605
.long 0xbf4d9f02,0xbf373a23,0xbf1d7fd1,0xbf00e7e4,0xbf3085bb,0xbf14b039,0xbeebcbbb,0xbea986c4
.long 0x3e47c5c2,0x3e164083,0x3dc8bd36,0x3d48fb30,0x3cc90ab0,0xbcfb49ba,0xbdafb680,0xbe1008b7
.long 0xbe164083,0xbe541501,0xbe888e93,0xbea68f12,0xbea09ae5,0xbec1071e,0xbee0924f,0xbeff17b2
.long 0xbf0e39da,0xbedae880,0xbe94a031,0xbe164083,0xbecf7bca,0xbe8586ce,0xbde1bc2e,0x3d2fe007
.long 0xbe78cfcc,0xbdafb680,0x3d96a905,0x3e6c9a7f,0xbd96a905,0x3dbc3ac3,0x3e827dc0,0x3ed25a09
.long 0xbef15aea,0xbf08f59b,0xbf187fc0,0xbf273656,0xbf1d7fd1,0xbf2d1469,0xbf3b8f3b,0xbf48d8b3
.long 0xbf3daef9,0xbf4bbbf8,0xbf584853,0xbf633c5a,0xbf584853,0xbf63f473,0xbf6db293,0xbf756d97
.long 0x3dc8bd36,0x3e888e93,0x3edae880,0x3f13682a,0x3e888e93,0x3eddbe79,0x3f15f6d9,0x3f385216
.long 0x3edae880,0x3f15f6d9,0x3f396842,0x3f5695e5,0x3f13682a,0x3f385216,0x3f5695e5,0x3f6d1c1d
.long 0x0,0x0,0x0,0x0,0x0,0x3bc90f88,0x3c490e90,0x3c96c9b6
.long 0x0,0x3c490e90,0x3cc90ab0,0x3d16c32c,0x0,0x3c96c9b6,0x3d16c32c,0x3d621469
.long 0x0,0x3dc8bd36,0x3e47c5c2,0x3e94a031,0x0,0x3dd53db9,0x3e541501,0x3e9d9e78
.long 0x0,0x3de1bc2e,0x3e605c13,0x3ea68f12,0x0,0x3dee3876,0x3e6c9a7f,0x3eaf713a
.long 0x0,0x3cc90ab0,0x3d48fb30,0x3d96a905,0x0,0x3cfb49ba,0x3d7b2b74,0x3dbc3ac3
.long 0x0,0x3d16c32c,0x3d96a905,0x3de1bc2e,0x0,0x3d2fe007,0x3dafb680,0x3e039502
.long 0x0,0x3dfab273,0x3e78cfcc,0x3eb8442a,0x0,0x3e039502,0x3e827dc0,0x3ec1071e
.long 0x0,0x3e09cf86,0x3e888e93,0x3ec9b953,0x0,0x3e1008b7,0x3e8e9a22,0x3ed25a09
.long 0x0,0x3d48fb30,0x3dc8bd36,0x3e164083,0x0,0x3d621469,0x3de1bc2e,0x3e28defc
.long 0x0,0x3d7b2b74,0x3dfab273,0x3e3b6ecf,0x0,0x3d8a200a,0x3e09cf86,0x3e4dee60
.long 0x0,0x3e164083,0x3e94a031,0x3edae880,0x0,0x3e1c76de,0x3e9aa086,0x3ee363fa
.long 0x0,0x3e22abb6,0x3ea09ae5,0x3eebcbbb,0x0,0x3e28defc,0x3ea68f12,0x3ef41f07
.long 0x0,0x3d96a905,0x3e164083,0x3e605c13,0x0,0x3da3308c,0x3e22abb6,0x3e72b651
.long 0x0,0x3dafb680,0x3e2f10a2,0x3e827dc0,0x0,0x3dbc3ac3,0x3e3b6ecf,0x3e8b9507
.long 0x0,0x3e2f10a2,0x3eac7cd4,0x3efc5d27,0x0,0x3e354098,0x3eb263ef,0x3f0242b1
.long 0x0,0x3e3b6ecf,0x3eb8442a,0x3f064b82,0x0,0x3e419b37,0x3ebe1d4a,0x3f0a48ad
.long 0x0,0x0,0x0,0x0,0x3cc90ab0,0x3cfb49ba,0x3d16c32c,0x3d2fe007
.long 0x3d48fb30,0x3d7b2b74,0x3d96a905,0x3dafb680,0x3d96a905,0x3dbc3ac3,0x3de1bc2e,0x3e039502
.long 0x3ec3ef15,0x3ef15aea,0x3f0e39da,0x3f226799,0x3ecf7bca,0x3eff17b2,0x3f15f6d9,0x3f2ac082
.long 0x3edae880,0x3f064b82,0x3f1d7fd1,0x3f32c8c9,0x3ee63375,0x3f0cead0,0x3f24d225,0x3f3a7ca4
.long 0x3dc8bd36,0x3dfab273,0x3e164083,0x3e2f10a2,0x3dfab273,0x3e1c76de,0x3e3b6ecf,0x3e5a3997
.long 0x3e164083,0x3e3b6ecf,0x3e605c13,0x3e827dc0,0x3e2f10a2,0x3e5a3997,0x3e827dc0,0x3e97a117
.long 0x3ef15aea,0x3f13682a,0x3f2beb4a,0x3f41d870,0x3efc5d27,0x3f19c200,0x3f32c8c9,0x3f48d8b3
.long 0x3f039c3d,0x3f1ff6cb,0x3f396842,0x3f4f7a1f,0x3f08f59b,0x3f26050a,0x3f3fc767,0x3f55b993
.long 0x3e47c5c2,0x3e78cfcc,0x3e94a031,0x3eac7cd4,0x3e605c13,0x3e8b9507,0x3ea68f12,0x3ec1071e
.long 0x3e78cfcc,0x3e9aa086,0x3eb8442a,0x3ed53641,0x3e888e93,0x3ea986c4,0x3ec9b953,0x3ee900b7
.long 0x3f0e39da,0x3f2beb4a,0x3f45e403,0x3f5b941a,0x3f13682a,0x3f31a81d,0x3f4bbbf8,0x3f6106f2
.long 0x3f187fc0,0x3f373a23,0x3f514d3d,0x3f660f88,0x3f1d7fd1,0x3f3ca003,0x3f5695e5,0x3f6aab7b
.long 0x3e94a031,0x3eb8442a,0x3edae880,0x3efc5d27,0x3ea09ae5,0x3ec6d529,0x3eebcbbb,0x3f07a136
.long 0x3eac7cd4,0x3ed53641,0x3efc5d27,0x3f10d3cd,0x3eb8442a,0x3ee363fa,0x3f064b82,0x3f19c200
.long 0x3f226799,0x3f41d870,0x3f5b941a,0x3f6ed89e,0x3f273656,0x3f46e22a,0x3f604621,0x3f7294f8
.long 0x3f2beb4a,0x3f4bbbf8,0x3f64aa59,0x3f75dec6,0x3f3085bb,0x3f5064af,0x3f68bf3c,0x3f78b47b
.long 0x0,0x0,0x0,0x0,0x3d48fb30,0x3d621469,0x3d7b2b74,0x3d8a200a
.long 0x3dc8bd36,0x3de1bc2e,0x3dfab273,0x3e09cf86,0x3e164083,0x3e28defc,0x3e3b6ecf,0x3e4dee60
.long 0x3f3504f3,0x3f45e403,0x3f54db31,0x3f61c598,0x3f3daef9,0x3f4e8d90,0x3f5d2d53,0x3f696591
.long 0x3f45e403,0x3f5695e5,0x3f64aa59,0x3f6ff573,0x3f4d9f02,0x3f5df6be,0x3f6b4b0c,0x3f756d97
.long 0x3e47c5c2,0x3e605c13,0x3e78cfcc,0x3e888e93,0x3e78cfcc,0x3e8b9507,0x3e9aa086,0x3ea986c4
.long 0x3e94a031,0x3ea68f12,0x3eb8442a,0x3ec9b953,0x3eac7cd4,0x3ec1071e,0x3ed53641,0x3ee900b7
.long 0x3f54db31,0x3f64aa59,0x3f710908,0x3f79c79d,0x3f5b941a,0x3f6aab7b,0x3f75dec6,0x3f7cfe73
.long 0x3f61c598,0x3f6ff573,0x3f79c79d,0x3f7f0e58,0x3f676bd8,0x3f748422,0x3f7cbfc9,0x3f7ff4e6
.long 0x3ec3ef15,0x3edae880,0x3ef15aea,0x3f039c3d,0x3edae880,0x3ef41f07,0x3f064b82,0x3f121eb0
.long 0x3ef15aea,0x3f064b82,0x3f13682a,0x3f1ff6cb,0x3f039c3d,0x3f121eb0,0x3f1ff6cb,0x3f2d1469
.long 0x3f6c835e,0x3f7853f8,0x3f7ec46d,0x3f7fb10f,0x3f710908,0x3f7b61fc,0x3f7fd397,0x3f7e4323
.long 0x3f74fa0b,0x3f7dabcc,0x3f7fec43,0x3f7baccd,0x3f7853f8,0x3f7f2f9d,0x3f7f0e58,0x3f77f110
.long 0x3f0e39da,0x3f1d7fd1,0x3f2beb4a,0x3f396842,0x3f187fc0,0x3f286605,0x3f373a23,0x3f44e3f5
.long 0x3f226799,0x3f32c8c9,0x3f41d870,0x3f4f7a1f,0x3f2beb4a,0x3f3ca003,0x3f4bbbf8,0x3f591e6a
.long 0x3f7b14be,0x3f7fec43,0x3f7d3aac,0x3f731447,0x3f7d3aac,0x3f7fe129,0x3f7a7302,0x3f6d1c1d
.long 0x3f7ec46d,0x3f7f0e58,0x3f76ba07,0x3f660f88,0x3f7fb10f,0x3f7d7474,0x3f721352,0x3f5df6be
.long 0x0,0x0,0x0,0x0,0x3d96a905,0x3da3308c,0x3dafb680,0x3dbc3ac3
.long 0x3e164083,0x3e22abb6,0x3e2f10a2,0x3e3b6ecf,0x3e605c13,0x3e72b651,0x3e827dc0,0x3e8b9507
.long 0x3f6c835e,0x3f74fa0b,0x3f7b14be,0x3f7ec46d,0x3f731447,0x3f7a1e84,0x3f7e70b0,0x3f7ffec4
.long 0x3f7853f8,0x3f7dabcc,0x3f7fec43,0x3f7f0e58,0x3f7c3b28,0x3f7f9c18,0x3f7f84ab,0x3f7bf531
.long 0x3e94a031,0x3ea09ae5,0x3eac7cd4,0x3eb8442a,0x3eb8442a,0x3ec6d529,0x3ed53641,0x3ee363fa
.long 0x3edae880,0x3eebcbbb,0x3efc5d27,0x3f064b82,0x3efc5d27,0x3f07a136,0x3f10d3cd,0x3f19c200
.long 0x3f7ec46d,0x3f7fec43,0x3f7d3aac,0x3f76ba07,0x3f7fec43,0x3f7e9bc9,0x3f791298,0x3f6f6830
.long 0x3f7fb10f,0x3f7baccd,0x3f731447,0x3f660f88,0x3f7e1324,0x3f772417,0x3f6b4b0c,0x3f5ac450
.long 0x3f0e39da,0x3f187fc0,0x3f226799,0x3f2beb4a,0x3f1d7fd1,0x3f286605,0x3f32c8c9,0x3f3ca003
.long 0x3f2beb4a,0x3f373a23,0x3f41d870,0x3f4bbbf8,0x3f396842,0x3f44e3f5,0x3f4f7a1f,0x3f591e6a
.long 0x3f7b14be,0x3f710908,0x3f61c598,0x3f4d9f02,0x3f76ba07,0x3f696591,0x3f5695e5,0x3f3ebc1b
.long 0x3f710908,0x3f604621,0x3f49d112,0x3f2e3bde,0x3f6a09a7,0x3f55b993,0x3f3b8f3b,0x3f1c420c
.long 0x3f45e403,0x3f514d3d,0x3f5b941a,0x3f64aa59,0x3f514d3d,0x3f5c61c7,0x3f660f88,0x3f6e46be
.long 0x3f5b941a,0x3f660f88,0x3f6ed89e,0x3f75dec6,0x3f64aa59,0x3f6e46be,0x3f75dec6,0x3f7b61fc
.long 0x3f61c598,0x3f49d112,0x3f2beb4a,0x3f08f59b,0x3f584853,0x3f3ca003,0x3f1b02c6,0x3ee900b7
.long 0x3f4d9f02,0x3f2e3bde,0x3f08f59b,0x3ebe1d4a,0x3f41d870,0x3f1ebc12,0x3eebcbbb,0x3e919ddd
.long 0x0,0x0,0x0,0x0,0x3dc8bd36,0x3dd53db9,0x3de1bc2e,0x3dee3876
.long 0x3e47c5c2,0x3e541501,0x3e605c13,0x3e6c9a7f,0x3e94a031,0x3e9d9e78,0x3ea68f12,0x3eaf713a
.long 0x3f800000,0x3f7ec46d,0x3f7b14be,0x3f74fa0b,0x3f7ec46d,0x3f7ac516,0x3f740bdd,0x3f6aab7b
.long 0x3f7b14be,0x3f740bdd,0x3f6a09a7,0x3f5d2d53,0x3f74fa0b,0x3f6aab7b,0x3f5d2d53,0x3f4cae79
.long 0x3ec3ef15,0x3ecf7bca,0x3edae880,0x3ee63375,0x3ef15aea,0x3eff17b2,0x3f064b82,0x3f0cead0
.long 0x3f0e39da,0x3f15f6d9,0x3f1d7fd1,0x3f24d225,0x3f226799,0x3f2ac082,0x3f32c8c9,0x3f3a7ca4
.long 0x3f6c835e,0x3f5ebe05,0x3f4d9f02,0x3f396842,0x3f61c598,0x3f5064af,0x3f3b8f3b,0x3f239da9
.long 0x3f54db31,0x3f3fc767,0x3f273656,0x3f0b9a6b,0x3f45e403,0x3f2d1469,0x3f10d3cd,0x3ee363fa
.long 0x3f3504f3,0x3f3daef9,0x3f45e403,0x3f4d9f02,0x3f45e403,0x3f4e8d90,0x3f5695e5,0x3f5df6be
.long 0x3f54db31,0x3f5d2d53,0x3f64aa59,0x3f6b4b0c,0x3f61c598,0x3f696591,0x3f6ff573,0x3f756d97
.long 0x3f3504f3,0x3f187fc0,0x3ef15aea,0x3eac7cd4,0x3f226799,0x3f0242b1,0x3ebe1d4a,0x3e667c66
.long 0x3f0e39da,0x3ed53641,0x3e888e93,0x3de1bc2e,0x3ef15aea,0x3ea395c5,0x3e22abb6,0xbbc90f88
.long 0x3f6c835e,0x3f731447,0x3f7853f8,0x3f7c3b28,0x3f74fa0b,0x3f7a1e84,0x3f7dabcc,0x3f7f9c18
.long 0x3f7b14be,0x3f7e70b0,0x3f7fec43,0x3f7f84ab,0x3f7ec46d,0x3f7ffec4,0x3f7f0e58,0x3f7bf531
.long 0x3ec3ef15,0x3e605c13,0x3d48fb30,0xbdfab273,0x3e94a031,0x3dee3876,0xbd7b2b74,0xbe72b651
.long 0x3e47c5c2,0x3c490e90,0xbe2f10a2,0xbeb263ef,0x3dc8bd36,0xbdbc3ac3,0xbe8e9a22,0xbee900b7
.long 0x0,0x0,0x0,0x0,0x3dfab273,0x3e039502,0x3e09cf86,0x3e1008b7
.long 0x3e78cfcc,0x3e827dc0,0x3e888e93,0x3e8e9a22,0x3eb8442a,0x3ec1071e,0x3ec9b953,0x3ed25a09
.long 0x3f6c835e,0x3f61c598,0x3f54db31,0x3f45e403,0x3f5ebe05,0x3f5064af,0x3f3fc767,0x3f2d1469
.long 0x3f4d9f02,0x3f3b8f3b,0x3f273656,0x3f10d3cd,0x3f396842,0x3f239da9,0x3f0b9a6b,0x3ee363fa
.long 0x3ef15aea,0x3efc5d27,0x3f039c3d,0x3f08f59b,0x3f13682a,0x3f19c200,0x3f1ff6cb,0x3f26050a
.long 0x3f2beb4a,0x3f32c8c9,0x3f396842,0x3f3fc767,0x3f41d870,0x3f48d8b3,0x3f4f7a1f,0x3f55b993
.long 0x3f226799,0x3f08f59b,0x3edae880,0x3ea09ae5,0x3f08f59b,0x3ed8106b,0x3e9aa086,0x3e354098
.long 0x3edae880,0x3e9aa086,0x3e2f10a2,0x3d16c32c,0x3ea09ae5,0x3e354098,0x3d16c32c,0xbdd53db9
.long 0x3f54db31,0x3f5b941a,0x3f61c598,0x3f676bd8,0x3f64aa59,0x3f6aab7b,0x3f6ff573,0x3f748422
.long 0x3f710908,0x3f75dec6,0x3f79c79d,0x3f7cbfc9,0x3f79c79d,0x3f7cfe73,0x3f7f0e58,0x3f7ff4e6
.long 0x3e47c5c2,0x3d48fb30,0xbdc8bd36,0xbe78cfcc,0x3d96a905,0xbda3308c,0xbe6c9a7f,0xbec1071e
.long 0xbd48fb30,0xbe541501,0xbeb8442a,0xbf00e7e4,0xbe2f10a2,0xbea986c4,0xbef6e0cb,0xbf1ebc12
.long 0x3f7ec46d,0x3f7fec43,0x3f7fb10f,0x3f7e1324,0x3f7fec43,0x3f7e9bc9,0x3f7baccd,0x3f772417
.long 0x3f7d3aac,0x3f791298,0x3f731447,0x3f6b4b0c,0x3f76ba07,0x3f6f6830,0x3f660f88,0x3f5ac450
.long 0xbe94a031,0xbee63375,0xbf187fc0,0xbf396842,0xbecf7bca,0xbf0f8784,0xbf32c8c9,0xbf5064af
.long 0xbf039c3d,0xbf299415,0xbf49d112,0xbf633c5a,0xbf1d7fd1,0xbf40d0da,0xbf5d2d53,0xbf718f57
.long 0x0,0x0,0x0,0x0,0x3e164083,0x3e1c76de,0x3e22abb6,0x3e28defc
.long 0x3e94a031,0x3e9aa086,0x3ea09ae5,0x3ea68f12,0x3edae880,0x3ee363fa,0x3eebcbbb,0x3ef41f07
.long 0x3f3504f3,0x3f226799,0x3f0e39da,0x3ef15aea,0x3f187fc0,0x3f0242b1,0x3ed53641,0x3ea395c5
.long 0x3ef15aea,0x3ebe1d4a,0x3e888e93,0x3e22abb6,0x3eac7cd4,0x3e667c66,0x3de1bc2e,0xbbc90f88
.long 0x3f0e39da,0x3f13682a,0x3f187fc0,0x3f1d7fd1,0x3f2beb4a,0x3f31a81d,0x3f373a23,0x3f3ca003
.long 0x3f45e403,0x3f4bbbf8,0x3f514d3d,0x3f5695e5,0x3f5b941a,0x3f6106f2,0x3f660f88,0x3f6aab7b
.long 0x3e47c5c2,0x3d96a905,0xbd48fb30,0xbe2f10a2,0x3d48fb30,0xbda3308c,0xbe541501,0xbea986c4
.long 0xbdc8bd36,0xbe6c9a7f,0xbeb8442a,0xbef6e0cb,0xbe78cfcc,0xbec1071e,0xbf00e7e4,0xbf1ebc12
.long 0x3f6c835e,0x3f710908,0x3f74fa0b,0x3f7853f8,0x3f7853f8,0x3f7b61fc,0x3f7dabcc,0x3f7f2f9d
.long 0x3f7ec46d,0x3f7fd397,0x3f7fec43,0x3f7f0e58,0x3f7fb10f,0x3f7e4323,0x3f7baccd,0x3f77f110
.long 0xbec3ef15,0xbf039c3d,0xbf226799,0xbf3daef9,0xbf039c3d,0xbf239da9,0xbf3fc767,0xbf577026
.long 0xbf226799,0xbf3fc767,0xbf584853,0xbf6b4b0c,0xbf3daef9,0xbf577026,0xbf6b4b0c,0xbf78b47b
.long 0x3f7b14be,0x3f76ba07,0x3f710908,0x3f6a09a7,0x3f710908,0x3f696591,0x3f604621,0x3f55b993
.long 0x3f61c598,0x3f5695e5,0x3f49d112,0x3f3b8f3b,0x3f4d9f02,0x3f3ebc1b,0x3f2e3bde,0x3f1c420c
.long 0xbf54db31,0xbf6a09a7,0xbf7853f8,0xbf7f4e6d,0xbf676bd8,0xbf772417,0xbf7f0e58,0xbf7eea9d
.long 0xbf74fa0b,0xbf7e70b0,0xbf7f4e6d,0xbf778bc5,0xbf7d3aac,0xbf7fc38f,0xbf791298,0xbf696591
.long 0x0,0x0,0x0,0x0,0x3e2f10a2,0x3e354098,0x3e3b6ecf,0x3e419b37
.long 0x3eac7cd4,0x3eb263ef,0x3eb8442a,0x3ebe1d4a,0x3efc5d27,0x3f0242b1,0x3f064b82,0x3f0a48ad
.long 0x3ec3ef15,0x3e94a031,0x3e47c5c2,0x3dc8bd36,0x3e605c13,0x3dee3876,0x3c490e90,0xbdbc3ac3
.long 0x3d48fb30,0xbd7b2b74,0xbe2f10a2,0xbe8e9a22,0xbdfab273,0xbe72b651,0xbeb263ef,0xbee900b7
.long 0x3f226799,0x3f273656,0x3f2beb4a,0x3f3085bb,0x3f41d870,0x3f46e22a,0x3f4bbbf8,0x3f5064af
.long 0x3f5b941a,0x3f604621,0x3f64aa59,0x3f68bf3c,0x3f6ed89e,0x3f7294f8,0x3f75dec6,0x3f78b47b
.long 0xbe94a031,0xbecf7bca,0xbf039c3d,0xbf1d7fd1,0xbee63375,0xbf0f8784,0xbf299415,0xbf40d0da
.long 0xbf187fc0,0xbf32c8c9,0xbf49d112,0xbf5d2d53,0xbf396842,0xbf5064af,0xbf633c5a,0xbf718f57
.long 0x3f7b14be,0x3f7d3aac,0x3f7ec46d,0x3f7fb10f,0x3f7fec43,0x3f7fe129,0x3f7f0e58,0x3f7d7474
.long 0x3f7d3aac,0x3f7a7302,0x3f76ba07,0x3f721352,0x3f731447,0x3f6d1c1d,0x3f660f88,0x3f5df6be
.long 0xbf54db31,0xbf676bd8,0xbf74fa0b,0xbf7d3aac,0xbf6a09a7,0xbf772417,0xbf7e70b0,0xbf7fc38f
.long 0xbf7853f8,0xbf7f0e58,0xbf7f4e6d,0xbf791298,0xbf7f4e6d,0xbf7eea9d,0xbf778bc5,0xbf696591
.long 0x3f61c598,0x3f584853,0x3f4d9f02,0x3f41d870,0x3f49d112,0x3f3ca003,0x3f2e3bde,0x3f1ebc12
.long 0x3f2beb4a,0x3f1b02c6,0x3f08f59b,0x3eebcbbb,0x3f08f59b,0x3ee900b7,0x3ebe1d4a,0x3e919ddd
.long 0xbf7ec46d,0xbf76ba07,0xbf676bd8,0xbf514d3d,0xbf76ba07,0xbf66becc,0xbf4f7a1f,0xbf31a81d
.long 0xbf676bd8,0xbf4f7a1f,0xbf3085bb,0xbf0b9a6b,0xbf514d3d,0xbf31a81d,0xbf0b9a6b,0xbec1071e
.long 0x3c00,0x3c00,0x3c00,0x3c00,0x3c008000,0x3c008000,0x3c008000,0x3c008000
.long 0x3c00,0x361f3b64,0x39a839a8,0x3b64361f,0x3c008000,0x3b64b61f,0x39a8b9a8,0x361fbb64
.long 0x3c00,0x39a839a8,0x3c000000,0x39a8b9a8,0x3c008000,0x39a8b9a8,0xbc00,0xb9a8b9a8
.long 0x3c00,0x3b64361f,0x39a8b9a8,0xb61fbb64,0x3c008000,0x361fbb64,0xb9a8b9a8,0xbb64361f
.long 0x3c00,0x3c000000,0xbc00,0xbc008000,0x3c008000,0xbc00,0xbc008000,0x80003c00
.long 0x3c00,0x3b64b61f,0xb9a8b9a8,0xb61f3b64,0x3c008000,0xb61fbb64,0xb9a839a8,0x3b64361f
.long 0x3c00,0x39a8b9a8,0xbc008000,0x39a839a8,0x3c008000,0xb9a8b9a8,0x80003c00,0x39a8b9a8
.long 0x3c00,0x361fbb64,0xb9a839a8,0x3b64b61f,0x3c008000,0xbb64b61f,0x39a839a8,0xb61fbb64
.long 0x3c00,0x3c00,0x3c00,0x3c00,0x3c008000,0x3c008000,0x3c008000,0x3c008000
.long 0x3c000000,0x3b64b61f,0x39a8b9a8,0x361fbb64,0xbc00,0xb61fbb64,0xb9a8b9a8,0xbb64b61f
.long 0xbc00,0xb9a8b9a8,0xbc008000,0xb9a839a8,0xbc008000,0xb9a839a8,0x80003c00,0x39a839a8
.long 0xbc008000,0xb61f3b64,0x39a839a8,0x3b64b61f,0x80003c00,0x3b64361f,0x39a8b9a8,0xb61fbb64
.long 0x3c00,0x3c000000,0xbc00,0xbc008000,0x3c008000,0xbc00,0xbc008000,0x80003c00
.long 0x3c000000,0xb61fbb64,0xb9a839a8,0x3b64361f,0xbc00,0xbb64361f,0x39a839a8,0x361fbb64
.long 0xbc00,0xb9a839a8,0x3c000000,0xb9a8b9a8,0xbc008000,0x39a839a8,0xbc00,0xb9a839a8
.long 0xbc008000,0x3b64361f,0xb9a8b9a8,0x361f3b64,0x80003c00,0x361fbb64,0xb9a839a8,0x3b64b61f
.long 0x3c00,0x3c00,0x3c00,0x3c00,0x3c008000,0x3c008000,0x3c008000,0x3c008000
.long 0xbc00,0xb61fbb64,0xb9a8b9a8,0xbb64b61f,0xbc008000,0xbb64361f,0xb9a839a8,0xb61f3b64
.long 0x3c00,0x39a839a8,0x3c000000,0x39a8b9a8,0x3c008000,0x39a8b9a8,0xbc00,0xb9a8b9a8
.long 0xbc00,0xbb64b61f,0xb9a839a8,0x361f3b64,0xbc008000,0xb61f3b64,0x39a839a8,0x3b64b61f
.long 0x3c00,0x3c000000,0xbc00,0xbc008000,0x3c008000,0xbc00,0xbc008000,0x80003c00
.long 0xbc00,0xbb64361f,0x39a839a8,0x361fbb64,0xbc008000,0x361f3b64,0x39a8b9a8,0xbb64b61f
.long 0x3c00,0x39a8b9a8,0xbc008000,0x39a839a8,0x3c008000,0xb9a8b9a8,0x80003c00,0x39a8b9a8
.long 0xbc00,0xb61f3b64,0x39a8b9a8,0xbb64361f,0xbc008000,0x3b64361f,0xb9a8b9a8,0x361f3b64
.long 0x3c00,0x3c00,0x3c00,0x3c00,0x3c008000,0x3c008000,0x3c008000,0x3c008000
.long 0xbc008000,0xbb64361f,0xb9a839a8,0xb61f3b64,0x80003c00,0x361f3b64,0x39a839a8,0x3b64361f
.long 0xbc00,0xb9a8b9a8,0xbc008000,0xb9a839a8,0xbc008000,0xb9a839a8,0x80003c00,0x39a839a8
.long 0x3c000000,0x361fbb64,0xb9a8b9a8,0xbb64361f,0xbc00,0xbb64b61f,0xb9a839a8,0x361f3b64
.long 0x3c00,0x3c000000,0xbc00,0xbc008000,0x3c008000,0xbc00,0xbc008000,0x80003c00
.long 0xbc008000,0x361f3b64,0x39a8b9a8,0xbb64b61f,0x80003c00,0x3b64b61f,0xb9a8b9a8,0xb61f3b64
.long 0xbc00,0xb9a839a8,0x3c000000,0xb9a8b9a8,0xbc008000,0x39a839a8,0xbc00,0xb9a839a8
.long 0x3c000000,0xbb64b61f,0x39a839a8,0xb61fbb64,0xbc00,0xb61f3b64,0x39a8b9a8,0xbb64361f
.long 0x3c00,0xbc00,0x3c00,0xbc00,0x3c008000,0xbc008000,0x3c008000,0xbc008000
.long 0x3c00,0xb61fbb64,0x39a839a8,0xbb64b61f,0x3c008000,0xbb64361f,0x39a8b9a8,0xb61f3b64
.long 0x3c00,0xb9a8b9a8,0x3c000000,0xb9a839a8,0x3c008000,0xb9a839a8,0xbc00,0x39a839a8
.long 0x3c00,0xbb64b61f,0x39a8b9a8,0x361f3b64,0x3c008000,0xb61f3b64,0xb9a8b9a8,0x3b64b61f
.long 0x3c00,0xbc008000,0xbc00,0x3c000000,0x3c008000,0x80003c00,0xbc008000,0xbc00
.long 0x3c00,0xbb64361f,0xb9a8b9a8,0x361fbb64,0x3c008000,0x361f3b64,0xb9a839a8,0xbb64b61f
.long 0x3c00,0xb9a839a8,0xbc008000,0xb9a8b9a8,0x3c008000,0x39a839a8,0x80003c00,0xb9a839a8
.long 0x3c00,0xb61f3b64,0xb9a839a8,0xbb64361f,0x3c008000,0x3b64361f,0x39a839a8,0x361f3b64
.long 0x3c00,0xbc00,0x3c00,0xbc00,0x3c008000,0xbc008000,0x3c008000,0xbc008000
.long 0x3c000000,0xbb64361f,0x39a8b9a8,0xb61f3b64,0xbc00,0x361f3b64,0xb9a8b9a8,0x3b64361f
.long 0xbc00,0x39a839a8,0xbc008000,0x39a8b9a8,0xbc008000,0x39a8b9a8,0x80003c00,0xb9a8b9a8
.long 0xbc008000,0x361fbb64,0x39a839a8,0xbb64361f,0x80003c00,0xbb64b61f,0x39a8b9a8,0x361f3b64
.long 0x3c00,0xbc008000,0xbc00,0x3c000000,0x3c008000,0x80003c00,0xbc008000,0xbc00
.long 0x3c000000,0x361f3b64,0xb9a839a8,0xbb64b61f,0xbc00,0x3b64b61f,0x39a839a8,0xb61f3b64
.long 0xbc00,0x39a8b9a8,0x3c000000,0x39a839a8,0xbc008000,0xb9a8b9a8,0xbc00,0x39a8b9a8
.long 0xbc008000,0xbb64b61f,0xb9a8b9a8,0xb61fbb64,0x80003c00,0xb61f3b64,0xb9a839a8,0xbb64361f
.long 0x3c00,0xbc00,0x3c00,0xbc00,0x3c008000,0xbc008000,0x3c008000,0xbc008000
.long 0xbc00,0x361f3b64,0xb9a8b9a8,0x3b64361f,0xbc008000,0x3b64b61f,0xb9a839a8,0x361fbb64
.long 0x3c00,0xb9a8b9a8,0x3c000000,0xb9a839a8,0x3c008000,0xb9a839a8,0xbc00,0x39a839a8
.long 0xbc00,0x3b64361f,0xb9a839a8,0xb61fbb64,0xbc008000,0x361fbb64,0x39a839a8,0xbb64361f
.long 0x3c00,0xbc008000,0xbc00,0x3c000000,0x3c008000,0x80003c00,0xbc008000,0xbc00
.long 0xbc00,0x3b64b61f,0x39a839a8,0xb61f3b64,0xbc008000,0xb61fbb64,0x39a8b9a8,0x3b64361f
.long 0x3c00,0xb9a839a8,0xbc008000,0xb9a8b9a8,0x3c008000,0x39a839a8,0x80003c00,0xb9a839a8
.long 0xbc00,0x361fbb64,0x39a8b9a8,0x3b64b61f,0xbc008000,0xbb64b61f,0xb9a8b9a8,0xb61fbb64
.long 0x3c00,0xbc00,0x3c00,0xbc00,0x3c008000,0xbc008000,0x3c008000,0xbc008000
.long 0xbc008000,0x3b64b61f,0xb9a839a8,0x361fbb64,0x80003c00,0xb61fbb64,0x39a839a8,0xbb64b61f
.long 0xbc00,0x39a839a8,0xbc008000,0x39a8b9a8,0xbc008000,0x39a8b9a8,0x80003c00,0xb9a8b9a8
.long 0x3c000000,0xb61f3b64,0xb9a8b9a8,0x3b64b61f,0xbc00,0x3b64361f,0xb9a839a8,0xb61fbb64
.long 0x3c00,0xbc008000,0xbc00,0x3c000000,0x3c008000,0x80003c00,0xbc008000,0xbc00
.long 0xbc008000,0xb61fbb64,0x39a8b9a8,0x3b64361f,0x80003c00,0xbb64361f,0xb9a8b9a8,0x361fbb64
.long 0xbc00,0x39a8b9a8,0x3c000000,0x39a839a8,0xbc008000,0xb9a8b9a8,0xbc00,0x39a8b9a8
.long 0x3c000000,0x3b64361f,0x39a839a8,0x361f3b64,0xbc00,0x361fbb64,0x39a8b9a8,0x3b64b61f
.long 0x3c00,0x3c00,0x3c00,0x3c00,0x3c00,0xbc00,0x3c00,0xbc00
.long 0x3c00,0x3b64,0x39a8,0x361f,0x8000,0xb61f,0xb9a8,0xbb64
.long 0x3c00,0x39a8,0x0,0xb9a8,0x8000,0xb9a8,0xbc00,0xb9a8
.long 0x3c00,0x361f,0xb9a8,0xbb64,0x8000,0xbb64,0xb9a8,0x361f
.long 0x3c00,0x0,0xbc00,0x8000,0x8000,0xbc00,0x8000,0x3c00
.long 0x3c00,0xb61f,0xb9a8,0x3b64,0x8000,0xbb64,0x39a8,0x361f
.long 0x3c00,0xb9a8,0x8000,0x39a8,0x8000,0xb9a8,0x3c00,0xb9a8
.long 0x3c00,0xbb64,0x39a8,0xb61f,0x8000,0xb61f,0x39a8,0xbb64
.long 0x3c00,0x3c00,0x3c00,0x3c00,0x3c00,0xbc00,0x3c00,0xbc00
.long 0x0,0xb61f,0xb9a8,0xbb64,0xbc00,0xbb64,0xb9a8,0xb61f
.long 0xbc00,0xb9a8,0x8000,0x39a8,0x8000,0x39a8,0x3c00,0x39a8
.long 0x8000,0x3b64,0x39a8,0xb61f,0x3c00,0x361f,0xb9a8,0xbb64
.long 0x3c00,0x0,0xbc00,0x8000,0x8000,0xbc00,0x8000,0x3c00
.long 0x0,0xbb64,0x39a8,0x361f,0xbc00,0x361f,0x39a8,0xbb64
.long 0xbc00,0x39a8,0x0,0xb9a8,0x8000,0x39a8,0xbc00,0x39a8
.long 0x8000,0x361f,0xb9a8,0x3b64,0x3c00,0xbb64,0x39a8,0xb61f
.long 0x3c00,0x3c00,0x3c00,0x3c00,0x3c00,0xbc00,0x3c00,0xbc00
.long 0xbc00,0xbb64,0xb9a8,0xb61f,0x8000,0x361f,0x39a8,0x3b64
.long 0x3c00,0x39a8,0x0,0xb9a8,0x8000,0xb9a8,0xbc00,0xb9a8
.long 0xbc00,0xb61f,0x39a8,0x3b64,0x8000,0x3b64,0x39a8,0xb61f
.long 0x3c00,0x0,0xbc00,0x8000,0x8000,0xbc00,0x8000,0x3c00
.long 0xbc00,0x361f,0x39a8,0xbb64,0x8000,0x3b64,0xb9a8,0xb61f
.long 0x3c00,0xb9a8,0x8000,0x39a8,0x8000,0xb9a8,0x3c00,0xb9a8
.long 0xbc00,0x3b64,0xb9a8,0x361f,0x8000,0x361f,0xb9a8,0x3b64
.long 0x3c00,0x3c00,0x3c00,0x3c00,0x3c00,0xbc00,0x3c00,0xbc00
.long 0x8000,0x361f,0x39a8,0x3b64,0x3c00,0x3b64,0x39a8,0x361f
.long 0xbc00,0xb9a8,0x8000,0x39a8,0x8000,0x39a8,0x3c00,0x39a8
.long 0x0,0xbb64,0xb9a8,0x361f,0xbc00,0xb61f,0x39a8,0x3b64
.long 0x3c00,0x0,0xbc00,0x8000,0x8000,0xbc00,0x8000,0x3c00
.long 0x8000,0x3b64,0xb9a8,0xb61f,0x3c00,0xb61f,0xb9a8,0x3b64
.long 0xbc00,0x39a8,0x0,0xb9a8,0x8000,0x39a8,0xbc00,0x39a8
.long 0x0,0xb61f,0x39a8,0xbb64,0xbc00,0x3b64,0xb9a8,0x361f
.long 0x3c000000,0x3bd90000,0x3b640000,0x3aa70000,0x80000000,0xb23e0000,0xb61f0000,0xb8720000
.long 0x3c000000,0x3aa70000,0x361f0000,0xb23e0000,0x80000000,0xb8720000,0xbb640000,0xbbd90000
.long 0x3c000000,0x38720000,0xb61f0000,0xbbd90000,0x80000000,0xbaa70000,0xbb640000,0xb23e0000
.long 0x3c000000,0x323e0000,0xbb640000,0xb8720000,0x80000000,0xbbd90000,0xb61f0000,0x3aa70000
.long 0x3c000000,0xb23e0000,0xbb640000,0x38720000,0x80000000,0xbbd90000,0x361f0000,0x3aa70000
.long 0x3c000000,0xb8720000,0xb61f0000,0x3bd90000,0x80000000,0xbaa70000,0x3b640000,0xb23e0000
.long 0x3c000000,0xbaa70000,0x361f0000,0x323e0000,0x80000000,0xb8720000,0x3b640000,0xbbd90000
.long 0x3c000000,0xbbd90000,0x3b640000,0xbaa70000,0x80000000,0xb23e0000,0x361f0000,0xb8720000
.long 0x39a80000,0x38720000,0x361f0000,0x323e0000,0xb9a80000,0xbaa70000,0xbb640000,0xbbd90000
.long 0xb9a80000,0xbbd90000,0xbb640000,0xb8720000,0xb9a80000,0xb23e0000,0x361f0000,0x3aa70000
.long 0xb9a80000,0x323e0000,0x3b640000,0x3aa70000,0x39a80000,0x3bd90000,0x361f0000,0xb8720000
.long 0x39a80000,0x3aa70000,0xb61f0000,0xbbd90000,0x39a80000,0xb8720000,0xbb640000,0x323e0000
.long 0x39a80000,0xbaa70000,0xb61f0000,0x3bd90000,0xb9a80000,0xb8720000,0x3b640000,0x323e0000
.long 0xb9a80000,0xb23e0000,0x3b640000,0xbaa70000,0xb9a80000,0x3bd90000,0xb61f0000,0xb8720000
.long 0xb9a80000,0x3bd90000,0xbb640000,0x38720000,0x39a80000,0xb23e0000,0xb61f0000,0x3aa70000
.long 0x39a80000,0xb8720000,0x361f0000,0xb23e0000,0x39a80000,0xbaa70000,0x3b640000,0xbbd90000
.long 0x0,0xb23e0000,0xb61f0000,0xb8720000,0xbc000000,0xbbd90000,0xbb640000,0xbaa70000
.long 0x80000000,0x38720000,0x3b640000,0x3bd90000,0x3c000000,0x3aa70000,0x361f0000,0xb23e0000
.long 0x0,0xbaa70000,0xbb640000,0xb23e0000,0xbc000000,0xb8720000,0x361f0000,0x3bd90000
.long 0x80000000,0x3bd90000,0x361f0000,0xbaa70000,0x3c000000,0x323e0000,0xbb640000,0xb8720000
.long 0x0,0xbbd90000,0x361f0000,0x3aa70000,0xbc000000,0x323e0000,0x3b640000,0xb8720000
.long 0x80000000,0x3aa70000,0xbb640000,0x323e0000,0x3c000000,0xb8720000,0xb61f0000,0x3bd90000
.long 0x80000000,0xb8720000,0x3b640000,0xbbd90000,0xbc000000,0x3aa70000,0xb61f0000,0xb23e0000
.long 0x80000000,0x323e0000,0xb61f0000,0x38720000,0x3c000000,0xbbd90000,0x3b640000,0xbaa70000
.long 0xb9a80000,0xbaa70000,0xbb640000,0xbbd90000,0xb9a80000,0xb8720000,0xb61f0000,0xb23e0000
.long 0x39a80000,0x323e0000,0xb61f0000,0xbaa70000,0xb9a80000,0xbbd90000,0xbb640000,0xb8720000
.long 0x39a80000,0x3bd90000,0x361f0000,0xb8720000,0x39a80000,0xb23e0000,0xbb640000,0xbaa70000
.long 0xb9a80000,0x38720000,0x3b640000,0xb23e0000,0x39a80000,0x3aa70000,0xb61f0000,0xbbd90000
.long 0xb9a80000,0xb8720000,0x3b640000,0x323e0000,0xb9a80000,0x3aa70000,0x361f0000,0xbbd90000
.long 0x39a80000,0xbbd90000,0x361f0000,0x38720000,0xb9a80000,0xb23e0000,0x3b640000,0xbaa70000
.long 0x39a80000,0xb23e0000,0xb61f0000,0x3aa70000,0x39a80000,0xbbd90000,0x3b640000,0xb8720000
.long 0xb9a80000,0x3aa70000,0xbb640000,0x3bd90000,0x39a80000,0xb8720000,0x361f0000,0xb23e0000
.size tables, 20480
all_end:
.section .rodata,"a"
.p2align 6
.amdhsa_kernel adaLN_cond__spectral_fnet__moe_arch_mod__prompt_kernel
  .amdhsa_next_free_vgpr 256
  .amdhsa_next_free_sgpr 84
  .amdhsa_accum_offset 256
  .amdhsa_group_segment_fixed_size 0
  .amdhsa_kernarg_size 120
  .amdhsa_user_sgpr_count 2
  .amdhsa_user_sgpr_kernarg_segment_ptr 1
  .amdhsa_system_sgpr_workgroup_id_x 1
  .amdhsa_float_denorm_mode_32 3
  .amdhsa_float_denorm_mode_16_64 3
.end_amdhsa_kernel
```

```asm
; @launch grid=(256,1,1) block=(512,1,1) lds=163840
.amdgcn_target "amdgcn-amd-amdhsa--gfx950"
.text
.globl adaLN_cond__spectral_fnet__moe_arch_mod__prompt_kernel
.p2align 8
.type adaLN_cond__spectral_fnet__moe_arch_mod__prompt_kernel,@function
adaLN_cond__spectral_fnet__moe_arch_mod__prompt_kernel:
    s_cmp_ge_u32 s2, 256
    s_cbranch_scc1 k_done
    s_load_dwordx2 s[4:5], s[0:1], 0
    s_load_dwordx4 s[24:27], s[0:1], 96
    s_load_dwordx2 s[6:7], s[0:1], 112
    s_load_dwordx4 s[56:59], s[0:1], 80
    s_load_dwordx4 s[48:51], s[0:1], 48
    s_load_dwordx4 s[52:55], s[0:1], 64
    s_memrealtime s[32:33]
    v_lshrrev_b32 v1, 6, v0
    v_and_b32 v2, 63, v0
    v_readfirstlane_b32 s16, v1
    v_lshlrev_b32 v3, 4, v2
    v_mov_b32 v4, 0
    s_getpc_b64 s[36:37]
h_pc:
    s_and_b32 s34, s2, 7
    s_bfe_u32 s35, s2, 0x40003
    s_cmp_lg_u32 s16, 7
    s_cbranch_scc1 h_npf
    s_lshr_b32 s42, s2, 3
    s_lshl_b32 s42, s42, 11
    v_lshl_add_u32 v4, v2, 7, s42
    v_min_u32 v4, all_end-h_pc-4, v4
    s_mov_b64 exec, 0xffff
    global_load_dword v199, v4, s[36:37]
    s_mov_b64 exec, -1
h_npf:
    s_mov_b32 s11, 0x00020000
    s_mov_b32 s14, 268435456
    s_mov_b32 s15, 0x00020000
    s_bitcmp0_b32 s2, 7
    s_cbranch_scc1 g_start
    s_lshl_b32 s60, s16, 19
    s_lshl_b32 s61, s35, 15
    s_add_u32 s60, s60, s61
    s_lshl_b32 s61, s34, 11
    s_add_u32 s60, s60, s61
    s_add_u32 s61, s60, 16384
    s_lshl_b32 s62, s34, 11
    s_lshl_b32 s63, s35, 7
    s_add_u32 s62, s62, s63
    s_add_u32 s63, s62, 16809984
    s_lshl_b32 s42, s16, 4
    s_add_u32 s62, s62, s42
    s_add_u32 s62, s62, 16777216
    v_mov_b32 v116, 0
    s_mov_b32 s10, 4194304
    s_waitcnt lgkmcnt(0)
    s_mov_b32 s8, s4
    s_mov_b32 s9, s5
    s_mov_b32 s12, s6
    s_mov_b32 s13, s7
    buffer_load_dwordx4 v[64:67], v3, s[8:11], s60 offen offset:0
    buffer_load_dwordx4 v[72:75], v3, s[8:11], s61 offen offset:0
    buffer_load_dwordx4 v[68:71], v3, s[8:11], s60 offen offset:1024
    buffer_load_dwordx4 v[76:79], v3, s[8:11], s61 offen offset:1024
    s_mov_b64 exec, 1
    buffer_load_dword v215, v116, s[12:15], s62 offen sc1
    s_mov_b64 exec, -1
    s_branch f_start
h_non:
    s_mul_i32 s42, s32, 0x9e3779b1
    s_lshr_b32 s43, s42, 15
    s_xor_b32 s42, s42, s43
    s_mul_i32 s42, s42, 0x85ebca6b
    s_xor_b32 s33, s33, s42
    s_lshr_b32 s43, s42, 13
    s_xor_b32 s42, s42, s43
    s_mul_i32 s33, s33, 0xc2b2ae35
    s_add_u32 s33, s33, s32
    s_lshr_b32 s43, s33, 16
    s_xor_b32 s33, s33, s43
    s_mul_i32 s33, s33, 0x27d4eb2f
    s_or_b32 s32, s42, 1
    s_andn2_b32 s33, s33, 7
    v_mov_b32 v10, s32
    v_mov_b32 v11, s33
    v_lshlrev_b32 v12, 3, v2
    s_mov_b32 exec_hi, 0
    global_store_dwordx2 v12, v[10:11], s[26:27] sc1
    s_mov_b32 exec_hi, -1
    s_branch h_nonx
g_start:
    s_or_b32 s40, s2, s16
    s_xor_b32 s16, s16, 4
    v_xor_b32 v1, 4, v1
    v_xor_b32 v0, 0x100, v0
    v_lshlrev_b32 v13, 2, v2
    v_mov_b32 v220, 0
    v_mov_b32 v221, 0
    s_cmp_lt_u32 s16, 4
    s_cbranch_scc1 g_cons
g_load:
    s_and_b32 s69, s16, 3
    s_and_b32 s42, s16, 1
    s_lshl_b32 s42, s42, 7
    v_xor_b32 v6, s42, v3
    v_xor_b32 v7, 32, v6
    v_xor_b32 v8, 64, v6
    v_xor_b32 v9, 96, v6
    s_lshl_b32 s41, s35, 3
    s_add_u32 s41, s41, s69
    s_mul_i32 s18, s41, 98304
    s_lshl_b32 s41, s34, 10
    s_cmp_ge_u32 s34, 6
    s_cselect_b32 s42, 2048, 0
    s_add_u32 s18, s18, s41
    s_add_u32 s18, s18, s42
    s_lshl_b32 s68, s69, 13
    s_mov_b32 s10, 12582912
    s_waitcnt lgkmcnt(0)
    s_mov_b32 s8, s58
    s_mov_b32 s9, s59
    s_mov_b32 s12, s6
    s_mov_b32 s13, s7
    s_cmp_eq_u32 s40, 0
    s_cbranch_scc1 h_non
h_nonx:
    s_lshl_b32 s42, s69, 7
    s_add_u32 s42, s42, 139264
    s_mov_b32 m0, s42
    s_lshl_b32 s42, s35, 7
    v_add_u32 v10, s42, v13
    s_mov_b32 exec_hi, 0
    global_load_lds_dword v10, s[56:57]
    s_mov_b32 exec_hi, -1
    s_add_u32 s43, s68, 32768
    s_mov_b32 m0, s43
    s_add_u32 s42, s18, 0
    buffer_load_dwordx4 v6, s[8:11], s42 offen nt lds
    s_add_u32 s43, s68, 33792
    s_mov_b32 m0, s43
    s_add_u32 s42, s18, 12288
    buffer_load_dwordx4 v7, s[8:11], s42 offen nt lds
    s_add_u32 s43, s68, 34816
    s_mov_b32 m0, s43
    s_add_u32 s42, s18, 24576
    buffer_load_dwordx4 v8, s[8:11], s42 offen nt lds
    s_add_u32 s43, s68, 35840
    s_mov_b32 m0, s43
    s_add_u32 s42, s18, 36864
    buffer_load_dwordx4 v9, s[8:11], s42 offen nt lds
    s_add_u32 s43, s68, 36864
    s_mov_b32 m0, s43
    s_add_u32 s42, s18, 49152
    buffer_load_dwordx4 v6, s[8:11], s42 offen nt lds
    s_add_u32 s43, s68, 37888
    s_mov_b32 m0, s43
    s_add_u32 s42, s18, 61440
    buffer_load_dwordx4 v7, s[8:11], s42 offen nt lds
    s_add_u32 s43, s68, 38912
    s_mov_b32 m0, s43
    s_add_u32 s42, s18, 73728
    buffer_load_dwordx4 v8, s[8:11], s42 offen nt lds
    s_add_u32 s43, s68, 39936
    s_mov_b32 m0, s43
    s_add_u32 s42, s18, 86016
    buffer_load_dwordx4 v9, s[8:11], s42 offen nt lds
    s_lshl_b32 s19, s35, 2
    s_add_u32 s19, s19, s69
    s_mul_i32 s19, s19, 196608
    s_lshl_b32 s42, s34, 9
    s_add_u32 s19, s19, s42
    s_and_b32 s42, s34, 4
    s_lshl_b32 s42, s42, 9
    s_add_u32 s19, s19, s42
    s_add_u32 s19, s19, 6144
    v_lshrrev_b32 v5, 5, v2
    v_and_b32 v14, 0x1f0, v3
    v_lshlrev_b32 v12, 5, v5
    v_xor_b32 v14, v14, v12
    s_movk_i32 s42, 12288
    v_mad_u32_u24 v14, v5, s42, v14
    v_bfe_u32 v5, v0, 5, 1
    v_lshlrev_b32 v5, 3, v5
    v_bfe_u32 v12, v0, 3, 2
    v_add_u32 v5, v5, v12
    v_bfe_u32 v12, v0, 4, 2
    v_lshlrev_b32 v12, 1, v12
    v_xor_b32 v12, v12, v0
    v_and_b32 v12, 7, v12
    v_lshlrev_b32 v12, 4, v12
    s_movk_i32 s42, 7168
    v_mad_u32_u24 v5, v5, s42, v12
    s_mov_b32 s20, s26
    s_mov_b32 s21, s27
    s_mov_b32 s26, 4194304
    s_mov_b32 s27, 0x00020000
    s_and_b32 s65, s35, 1
    s_lshr_b32 s40, s35, 1
    s_mul_i32 s64, s34, 7
    s_add_u32 s64, s64, s40
    s_lshl_b32 s41, s34, 1
    s_add_u32 s41, s41, s65
    s_cmp_ge_u32 s35, 14
    s_cselect_b32 s66, 1, 0
    s_cselect_b32 s64, s41, s64
    v_lshrrev_b32 v10, 2, v2
    v_and_b32 v15, 3, v0
    v_bfe_u32 v11, v0, 3, 2
    v_xor_b32 v12, v11, v1
    v_and_b32 v12, 3, v12
    v_lshlrev_b32 v12, 5, v12
    v_lshl_add_u32 v12, v10, 7, v12
    v_lshl_add_u32 v12, v15, 3, v12
    v_lshrrev_b32 v16, 2, v1
    v_lshl_add_u32 v12, v16, 15, v12
    v_add_u32 v21, 65536, v12
    s_lshl_b32 s67, s65, 3
    s_add_u32 s67, s67, s69
    s_mul_i32 s67, s67, 458752
    s_lshl_b32 s42, s64, 7
    s_add_u32 s67, s67, s42
    s_mov_b32 s56, s50
    s_mov_b32 s57, s51
    s_mov_b32 s58, 7340032
    s_mov_b32 s59, 0x00020000
    s_mov_b32 s44, s52
    s_mov_b32 s45, s53
    s_mov_b32 s46, 7340032
    s_mov_b32 s47, 0x00020000
    s_waitcnt vmcnt(7)
    s_add_u32 s43, s68, 65536
    s_mov_b32 m0, s43
    s_add_u32 s42, s18, 393216
    buffer_load_dwordx4 v6, s[8:11], s42 offen nt lds
    s_waitcnt vmcnt(7)
    s_add_u32 s43, s68, 66560
    s_mov_b32 m0, s43
    s_add_u32 s42, s18, 405504
    buffer_load_dwordx4 v7, s[8:11], s42 offen nt lds
    s_load_dwordx2 s[32:33], s[20:21], 128
    s_waitcnt vmcnt(7)
    s_add_u32 s43, s68, 67584
    s_mov_b32 m0, s43
    s_add_u32 s42, s18, 417792
    buffer_load_dwordx4 v8, s[8:11], s42 offen nt lds
    s_waitcnt vmcnt(7)
    s_add_u32 s43, s68, 68608
    s_mov_b32 m0, s43
    s_add_u32 s42, s18, 430080
    buffer_load_dwordx4 v9, s[8:11], s42 offen nt lds
    s_waitcnt vmcnt(7)
    s_add_u32 s43, s68, 69632
    s_mov_b32 m0, s43
    s_add_u32 s42, s18, 442368
    buffer_load_dwordx4 v6, s[8:11], s42 offen nt lds
    s_waitcnt vmcnt(7)
    s_add_u32 s43, s68, 70656
    s_mov_b32 m0, s43
    s_add_u32 s42, s18, 454656
    buffer_load_dwordx4 v7, s[8:11], s42 offen nt lds
    s_waitcnt vmcnt(7)
    s_add_u32 s43, s68, 71680
    s_mov_b32 m0, s43
    s_add_u32 s42, s18, 466944
    buffer_load_dwordx4 v8, s[8:11], s42 offen nt lds
    s_waitcnt vmcnt(7)
    s_barrier
    s_add_u32 s43, s68, 72704
    s_mov_b32 m0, s43
    s_add_u32 s42, s18, 479232
    buffer_load_dwordx4 v9, s[8:11], s42 offen nt lds
    s_waitcnt lgkmcnt(0)
    s_cmp_lg_u32 s32, 0
    s_cbranch_scc1 g_n2x
    s_load_dwordx2 s[32:33], s[20:21], 192
    s_mov_b32 s83, 0
    v_mov_b32 v122, 0
    s_waitcnt lgkmcnt(0)
g_n2:
    s_cmp_lg_u32 s32, 0
    s_cbranch_scc1 g_n2x
    global_load_dwordx2 v[120:121], v122, s[20:21] sc1
    s_waitcnt vmcnt(0)
    v_readfirstlane_b32 s32, v120
    v_readfirstlane_b32 s33, v121
    s_add_u32 s83, s83, 1
    s_cmp_lt_u32 s83, 0x40000
    s_cbranch_scc1 g_n2
g_n2x:
    s_cmp_eq_u32 s66, 0
    s_cbranch_scc1 m_load
    s_waitcnt vmcnt(0)
    s_barrier
    s_barrier
    s_branch x_start
m_load:
    s_waitcnt vmcnt(7)
    v_xor_b32 v4, 0, v14
    s_add_u32 s43, s68, 98304
    s_mov_b32 m0, s43
    s_add_u32 s42, s19, 0
    buffer_load_dwordx4 v4, s[8:11], s42 offen nt lds
    s_waitcnt vmcnt(7)
    v_xor_b32 v4, 64, v14
    s_add_u32 s43, s68, 99328
    s_mov_b32 m0, s43
    s_add_u32 s42, s19, 24576
    buffer_load_dwordx4 v4, s[8:11], s42 offen nt lds
    s_waitcnt vmcnt(7)
    v_xor_b32 v4, 0, v14
    s_add_u32 s43, s68, 100352
    s_mov_b32 m0, s43
    s_add_u32 s42, s19, 49152
    buffer_load_dwordx4 v4, s[8:11], s42 offen nt lds
    s_waitcnt vmcnt(7)
    v_xor_b32 v4, 64, v14
    s_add_u32 s43, s68, 101376
    s_mov_b32 m0, s43
    s_add_u32 s42, s19, 73728
    buffer_load_dwordx4 v4, s[8:11], s42 offen nt lds
    s_waitcnt vmcnt(4)
    s_barrier
    s_barrier
    s_waitcnt vmcnt(7)
    v_xor_b32 v4, 128, v14
    s_add_u32 s43, s68, 102400
    s_mov_b32 m0, s43
    s_add_u32 s42, s19, 98304
    buffer_load_dwordx4 v4, s[8:11], s42 offen nt lds
    s_waitcnt vmcnt(7)
    v_xor_b32 v4, 192, v14
    s_add_u32 s43, s68, 103424
    s_mov_b32 m0, s43
    s_add_u32 s42, s19, 122880
    buffer_load_dwordx4 v4, s[8:11], s42 offen nt lds
    s_waitcnt vmcnt(7)
    v_xor_b32 v4, 128, v14
    s_add_u32 s43, s68, 104448
    s_mov_b32 m0, s43
    s_add_u32 s42, s19, 147456
    buffer_load_dwordx4 v4, s[8:11], s42 offen nt lds
    s_waitcnt vmcnt(7)
    v_xor_b32 v4, 192, v14
    s_add_u32 s43, s68, 105472
    s_mov_b32 m0, s43
    s_add_u32 s42, s19, 172032
    buffer_load_dwordx4 v4, s[8:11], s42 offen nt lds
    s_waitcnt vmcnt(7)
    s_add_u32 s43, s68, 0
    s_mov_b32 m0, s43
    s_add_u32 s42, s67, 0
    buffer_load_dwordx4 v5, s[56:59], s42 offen nt lds
    s_waitcnt vmcnt(7)
    s_add_u32 s43, s68, 1024
    s_mov_b32 m0, s43
    s_add_u32 s42, s67, 114688
    buffer_load_dwordx4 v5, s[56:59], s42 offen nt lds
    s_waitcnt vmcnt(7)
    s_add_u32 s43, s68, 2048
    s_mov_b32 m0, s43
    s_add_u32 s42, s67, 28672
    buffer_load_dwordx4 v5, s[56:59], s42 offen nt lds
    s_waitcnt vmcnt(7)
    s_add_u32 s43, s68, 3072
    s_mov_b32 m0, s43
    s_add_u32 s42, s67, 143360
    buffer_load_dwordx4 v5, s[56:59], s42 offen nt lds
    s_waitcnt vmcnt(7)
    s_add_u32 s43, s68, 4096
    s_mov_b32 m0, s43
    s_add_u32 s42, s67, 229376
    buffer_load_dwordx4 v5, s[56:59], s42 offen nt lds
    s_waitcnt vmcnt(7)
    s_add_u32 s43, s68, 5120
    s_mov_b32 m0, s43
    s_add_u32 s42, s67, 344064
    buffer_load_dwordx4 v5, s[56:59], s42 offen nt lds
    s_waitcnt vmcnt(6)
    s_barrier
    s_barrier
    s_waitcnt vmcnt(7)
    s_add_u32 s43, s68, 6144
    s_mov_b32 m0, s43
    s_add_u32 s42, s67, 258048
    buffer_load_dwordx4 v5, s[56:59], s42 offen nt lds
    s_waitcnt vmcnt(7)
    s_add_u32 s43, s68, 7168
    s_mov_b32 m0, s43
    s_add_u32 s42, s67, 372736
    buffer_load_dwordx4 v5, s[56:59], s42 offen nt lds
    s_waitcnt vmcnt(9)
    s_add_u32 s43, s68, 32768
    s_mov_b32 m0, s43
    s_add_u32 s42, s67, 1835008
    buffer_load_dwordx4 v5, s[56:59], s42 offen nt lds
    s_waitcnt vmcnt(9)
    s_add_u32 s43, s68, 33792
    s_mov_b32 m0, s43
    s_add_u32 s42, s67, 1949696
    buffer_load_dwordx4 v5, s[56:59], s42 offen nt lds
    s_waitcnt vmcnt(9)
    s_add_u32 s43, s68, 34816
    s_mov_b32 m0, s43
    s_add_u32 s42, s67, 1863680
    buffer_load_dwordx4 v5, s[56:59], s42 offen nt lds
    s_waitcnt vmcnt(9)
    s_add_u32 s43, s68, 35840
    s_mov_b32 m0, s43
    s_add_u32 s42, s67, 1978368
    buffer_load_dwordx4 v5, s[56:59], s42 offen nt lds
    s_waitcnt vmcnt(9)
    s_add_u32 s43, s68, 36864
    s_mov_b32 m0, s43
    s_add_u32 s42, s67, 2064384
    buffer_load_dwordx4 v5, s[56:59], s42 offen nt lds
    s_waitcnt vmcnt(9)
    s_add_u32 s43, s68, 37888
    s_mov_b32 m0, s43
    s_add_u32 s42, s67, 2179072
    buffer_load_dwordx4 v5, s[56:59], s42 offen nt lds
    s_waitcnt vmcnt(9)
    s_add_u32 s43, s68, 38912
    s_mov_b32 m0, s43
    s_add_u32 s42, s67, 2093056
    buffer_load_dwordx4 v5, s[56:59], s42 offen nt lds
    s_waitcnt vmcnt(9)
    s_add_u32 s43, s68, 39936
    s_mov_b32 m0, s43
    s_add_u32 s42, s67, 2207744
    buffer_load_dwordx4 v5, s[56:59], s42 offen nt lds
    s_waitcnt vmcnt(9)
    s_add_u32 s43, s68, 65536
    s_mov_b32 m0, s43
    s_add_u32 s42, s67, 0
    buffer_load_dwordx4 v5, s[44:47], s42 offen nt lds
    s_waitcnt vmcnt(9)
    s_barrier
    s_add_u32 s43, s68, 66560
    s_mov_b32 m0, s43
    s_add_u32 s42, s67, 114688
    buffer_load_dwordx4 v5, s[44:47], s42 offen nt lds
    s_waitcnt vmcnt(9)
    s_add_u32 s43, s68, 67584
    s_mov_b32 m0, s43
    s_add_u32 s42, s67, 28672
    buffer_load_dwordx4 v5, s[44:47], s42 offen nt lds
    s_waitcnt vmcnt(9)
    s_add_u32 s43, s68, 68608
    s_mov_b32 m0, s43
    s_add_u32 s42, s67, 143360
    buffer_load_dwordx4 v5, s[44:47], s42 offen nt lds
    s_waitcnt vmcnt(9)
    s_add_u32 s43, s68, 69632
    s_mov_b32 m0, s43
    s_add_u32 s42, s67, 229376
    buffer_load_dwordx4 v5, s[44:47], s42 offen nt lds
    s_waitcnt vmcnt(9)
    s_add_u32 s43, s68, 70656
    s_mov_b32 m0, s43
    s_add_u32 s42, s67, 344064
    buffer_load_dwordx4 v5, s[44:47], s42 offen nt lds
    s_waitcnt vmcnt(9)
    s_add_u32 s43, s68, 71680
    s_mov_b32 m0, s43
    s_add_u32 s42, s67, 258048
    buffer_load_dwordx4 v5, s[44:47], s42 offen nt lds
    s_waitcnt vmcnt(9)
    s_add_u32 s43, s68, 72704
    s_mov_b32 m0, s43
    s_add_u32 s42, s67, 372736
    buffer_load_dwordx4 v5, s[44:47], s42 offen nt lds
    s_waitcnt vmcnt(9)
    s_add_u32 s43, s68, 98304
    s_mov_b32 m0, s43
    s_add_u32 s42, s67, 1835008
    buffer_load_dwordx4 v5, s[44:47], s42 offen nt lds
    s_waitcnt vmcnt(9)
    s_barrier
    ds_read_b64_tr_b16 v[64:65], v12 offset:0
    ds_read_b64_tr_b16 v[66:67], v12 offset:2048
    ds_read_b64_tr_b16 v[68:69], v12 offset:4096
    ds_read_b64_tr_b16 v[70:71], v12 offset:6144
    ds_read_b64_tr_b16 v[72:73], v12 offset:8192
    ds_read_b64_tr_b16 v[74:75], v12 offset:10240
    ds_read_b64_tr_b16 v[76:77], v12 offset:12288
    ds_read_b64_tr_b16 v[78:79], v12 offset:14336
    ds_read_b64_tr_b16 v[80:81], v12 offset:16384
    ds_read_b64_tr_b16 v[82:83], v12 offset:18432
    ds_read_b64_tr_b16 v[84:85], v12 offset:20480
    ds_read_b64_tr_b16 v[86:87], v12 offset:22528
    ds_read_b64_tr_b16 v[88:89], v12 offset:24576
    ds_read_b64_tr_b16 v[90:91], v12 offset:26624
    ds_read_b64_tr_b16 v[92:93], v12 offset:28672
    ds_read_b64_tr_b16 v[94:95], v12 offset:30720
    s_add_u32 s43, s68, 99328
    s_mov_b32 m0, s43
    s_add_u32 s42, s67, 1949696
    buffer_load_dwordx4 v5, s[44:47], s42 offen nt lds
    s_waitcnt vmcnt(9)
    s_add_u32 s43, s68, 100352
    s_mov_b32 m0, s43
    s_add_u32 s42, s67, 1863680
    buffer_load_dwordx4 v5, s[44:47], s42 offen nt lds
    s_waitcnt vmcnt(9)
    s_add_u32 s43, s68, 101376
    s_mov_b32 m0, s43
    s_add_u32 s42, s67, 1978368
    buffer_load_dwordx4 v5, s[44:47], s42 offen nt lds
    s_waitcnt vmcnt(9)
    s_add_u32 s43, s68, 102400
    s_mov_b32 m0, s43
    s_add_u32 s42, s67, 2064384
    buffer_load_dwordx4 v5, s[44:47], s42 offen nt lds
    s_waitcnt vmcnt(9)
    s_add_u32 s43, s68, 103424
    s_mov_b32 m0, s43
    s_add_u32 s42, s67, 2179072
    buffer_load_dwordx4 v5, s[44:47], s42 offen nt lds
    s_waitcnt vmcnt(9)
    s_add_u32 s43, s68, 104448
    s_mov_b32 m0, s43
    s_add_u32 s42, s67, 2093056
    buffer_load_dwordx4 v5, s[44:47], s42 offen nt lds
    s_waitcnt vmcnt(9)
    s_add_u32 s43, s68, 105472
    s_mov_b32 m0, s43
    s_add_u32 s42, s67, 2207744
    buffer_load_dwordx4 v5, s[44:47], s42 offen nt lds
    s_branch m_join
g_cons:
    s_lshl_b32 s29, s34, 4
    s_add_u32 s29, s29, s35
    s_lshl_b32 s29, s29, 12
    s_add_u32 s29, s29, 19922944
    s_lshl_b32 s30, s16, 9
    s_add_u32 s30, s30, s29
    s_lshl_b32 s31, s16, 8
    s_add_u32 s31, s31, s29
    s_add_u32 s31, s31, 2048
    v_lshlrev_b32 v8, 1, v2
    v_lshlrev_b32 v9, 7, v2
    v_mov_b32 v104, -1
    v_mov_b32 v105, -1
    v_mov_b32 v106, -1
    v_mov_b32 v107, -1
    s_waitcnt lgkmcnt(0)
    s_mov_b32 s12, s6
    s_mov_b32 s13, s7
    s_cmp_eq_u32 s16, 1
    s_cselect_b64 exec, 0xffffff, 1
    buffer_load_dword v245, v9, s[12:15], s29 offen sc1
    s_mov_b64 exec, -1
    v_mov_b32 v14, 0
    s_mov_b32 s8, s58
    s_mov_b32 s9, s59
    s_mov_b32 s10, 12582912
    s_mov_b32 s11, 0x00020000
    s_mov_b32 s20, s26
    s_mov_b32 s21, s27
    s_mov_b32 s26, 4194304
    s_mov_b32 s27, 0x00020000
    s_and_b32 s65, s35, 1
    s_lshr_b32 s40, s35, 1
    s_mul_i32 s64, s34, 7
    s_add_u32 s64, s64, s40
    s_lshl_b32 s41, s34, 1
    s_add_u32 s41, s41, s65
    s_cmp_ge_u32 s35, 14
    s_cselect_b32 s66, 1, 0
    s_cselect_b32 s64, s41, s64
    v_lshrrev_b32 v10, 2, v2
    v_and_b32 v15, 3, v0
    v_bfe_u32 v11, v0, 3, 2
    v_xor_b32 v12, v11, v1
    v_and_b32 v12, 3, v12
    v_lshlrev_b32 v12, 5, v12
    v_lshl_add_u32 v12, v10, 7, v12
    v_lshl_add_u32 v12, v15, 3, v12
    v_lshrrev_b32 v16, 2, v1
    v_lshl_add_u32 v12, v16, 15, v12
    v_add_u32 v21, 65536, v12
    v_bfe_u32 v22, v0, 2, 3
    v_lshlrev_b32 v22, 5, v22
    v_lshl_add_u32 v22, v15, 3, v22
    v_bfe_u32 v23, v0, 2, 2
    v_bfe_u32 v24, v0, 4, 2
    v_lshl_add_u32 v23, v24, 3, v23
    v_lshl_add_u32 v200, v23, 10, v22
    v_lshl_add_u32 v200, v1, 8, v200
    v_add_u32 v200, 32768, v200
    v_lshlrev_b32 v25, 7, v1
    v_xor_b32 v22, v22, v25
    v_lshl_add_u32 v208, v23, 9, v22
    v_add_u32 v208, 98304, v208
    v_cmp_eq_u32 s[60:61], 1, v24
    v_cmp_eq_u32 s[62:63], 2, v24
    v_cmp_eq_u32 s[72:73], 3, v24
    v_add_u32 v8, v8, v25
    v_add_u32 v8, 139264, v8
    v_lshl_add_u32 v10, v24, 4, v25
    v_add_u32 v10, 139264, v10
    v_xor_b32 v201, 32, v200
    v_xor_b32 v202, 64, v200
    v_xor_b32 v203, 96, v200
    v_xor_b32 v204, 128, v200
    v_xor_b32 v205, 160, v200
    v_xor_b32 v206, 192, v200
    v_xor_b32 v207, 224, v200
    v_xor_b32 v209, 32, v208
    v_xor_b32 v210, 64, v208
    v_xor_b32 v211, 96, v208
    s_sleep 8
    s_load_dwordx2 s[32:33], s[20:21], 128
    s_waitcnt lgkmcnt(0)
    s_cmp_lg_u32 s32, 0
    s_cbranch_scc1 g_nnx
    s_load_dwordx2 s[32:33], s[20:21], 192
    s_mov_b32 s83, 0
    v_mov_b32 v114, 0
    s_waitcnt lgkmcnt(0)
g_nn:
    s_cmp_lg_u32 s32, 0
    s_cbranch_scc1 g_nnx
    global_load_dwordx2 v[112:113], v114, s[20:21] sc1
    s_waitcnt vmcnt(0)
    v_readfirstlane_b32 s32, v112
    v_readfirstlane_b32 s33, v113
    s_add_u32 s83, s83, 1
    s_cmp_lt_u32 s83, 0x40000
    s_cbranch_scc1 g_nn
g_nnx:
    v_mov_b32 v212, s32
    v_mov_b32 v213, s33
    v_and_b32 v214, 7, v0
    v_lshlrev_b32 v214, 3, v214
    v_lshrrev_b64 v[212:213], v214, v[212:213]
    v_and_b32 v212, 0xff, v212
    s_movk_i32 s74, 0xff00
    s_lshr_b32 s22, s64, 2
    s_lshl_b32 s22, s22, 12
    s_and_b32 s42, s64, 1
    s_lshl_b32 s42, s42, 8
    s_add_u32 s22, s22, s42
    s_and_b32 s42, s64, 2
    s_lshl_b32 s42, s42, 5
    s_add_u32 s22, s22, s42
    s_add_u32 s22, s22, 16875520
    s_lshr_b32 s23, s64, 3
    s_lshl_b32 s23, s23, 12
    s_and_b32 s42, s64, 3
    s_lshl_b32 s42, s42, 7
    s_add_u32 s23, s23, s42
    s_and_b32 s42, s64, 4
    s_lshl_b32 s42, s42, 4
    s_add_u32 s23, s23, s42
    s_add_u32 s23, s23, 16896000
    v_bfe_u32 v24, v0, 2, 1
    v_bfe_u32 v25, v0, 3, 2
    v_bfe_u32 v26, v0, 5, 1
    v_lshlrev_b32 v220, 4, v15
    v_lshl_add_u32 v220, v24, 9, v220
    v_lshl_add_u32 v220, v25, 10, v220
    v_lshl_add_u32 v220, v26, 7, v220
    v_lshlrev_b32 v221, 7, v15
    v_lshl_add_u32 v221, v24, 6, v221
    v_lshl_add_u32 v221, v25, 4, v221
    v_lshl_add_u32 v221, v26, 9, v221
    s_lshl_b32 s79, s64, 7
    s_add_u32 s79, s79, 16850944
    s_cmp_ge_u32 s16, s66
    s_cbranch_scc1 g_nw
    s_mov_b32 s44, s48
    s_mov_b32 s45, s49
    s_mov_b32 s46, 2048
    s_mov_b32 s47, 0x00020000
    v_lshrrev_b32 v11, 1, v221
    s_and_b32 s42, s64, 3
    s_lshl_b32 s42, s42, 9
    buffer_load_dwordx2 v[52:53], v11, s[44:47], s42 offen
    v_mov_b32 v216, s32
    v_mov_b32 v217, s33
    v_and_b32 v218, 1, v0
    v_cmp_eq_u32 vcc, 1, v218
    s_nop 1
    v_cndmask_b32 v216, v216, v217, vcc
    v_bfe_u32 v217, v216, 8, 8
    v_bfe_u32 v218, v216, 16, 8
    v_lshrrev_b32 v219, 24, v216
    v_and_b32 v216, 0xff, v216
    v_not_b32 v24, v216
    v_not_b32 v25, v217
    v_not_b32 v26, v218
    v_not_b32 v27, v219
    buffer_store_dwordx4 v[24:27], v220, s[12:15], s22 offen sc1
    s_add_u32 s42, s22, 4096
    s_cmp_ge_u32 s64, 12
    s_cselect_b32 s42, s42, s22
    buffer_store_dwordx4 v[24:27], v220, s[12:15], s42 offen sc1
    s_mov_b32 exec_hi, 0
    buffer_store_dwordx4 v[24:27], v220, s[12:15], s23 offen sc1
    s_mov_b64 exec, 0xff
    buffer_store_dwordx4 v[104:107], v3, s[12:15], s79 offen sc1
    s_mov_b64 exec, -1
g_nw:
    s_barrier
    ds_read_u16 v6, v8
    s_waitcnt lgkmcnt(0)
    v_lshlrev_b32 v6, 16, v6
    v_mul_f32 v24, 0xbfb8aa3b, v6
    v_exp_f32 v24, v24
    s_nop 0
    v_add_f32 v24, 1.0, v24
    v_rcp_f32 v24, v24
    s_nop 0
    v_mul_f32 v6, v6, v24
    v_cvt_pk_bf16_f32 v6, v6, v6
    ds_write_b16 v8, v6
    ds_read_b128 v[120:123], v10
    ds_read_b128 v[124:127], v10 offset:64
    ds_read_b64_tr_b16 v[128:129], v200 offset:0
    ds_read_b64_tr_b16 v[130:131], v200 offset:4096
    ds_read_b64_tr_b16 v[132:133], v201 offset:0
    ds_read_b64_tr_b16 v[134:135], v201 offset:4096
    ds_read_b64_tr_b16 v[136:137], v202 offset:0
    ds_read_b64_tr_b16 v[138:139], v202 offset:4096
    ds_read_b64_tr_b16 v[140:141], v203 offset:0
    ds_read_b64_tr_b16 v[142:143], v203 offset:4096
    ds_read_b64_tr_b16 v[144:145], v204 offset:0
    ds_read_b64_tr_b16 v[146:147], v204 offset:4096
    ds_read_b64_tr_b16 v[148:149], v205 offset:0
    ds_read_b64_tr_b16 v[150:151], v205 offset:4096
    ds_read_b64_tr_b16 v[152:153], v206 offset:0
    ds_read_b64_tr_b16 v[154:155], v206 offset:4096
    s_waitcnt lgkmcnt(12)
    v_mfma_f32_16x16x32_bf16 v[64:67], v[120:123], v[128:131], 0
    ds_read_b64_tr_b16 v[156:157], v207 offset:0
    ds_read_b64_tr_b16 v[158:159], v207 offset:4096
    s_waitcnt lgkmcnt(12)
    v_mfma_f32_16x16x32_bf16 v[68:71], v[120:123], v[132:135], 0
    s_waitcnt lgkmcnt(10)
    v_mfma_f32_16x16x32_bf16 v[72:75], v[120:123], v[136:139], 0
    s_waitcnt lgkmcnt(8)
    v_mfma_f32_16x16x32_bf16 v[76:79], v[120:123], v[140:143], 0
    s_waitcnt lgkmcnt(6)
    v_mfma_f32_16x16x32_bf16 v[80:83], v[120:123], v[144:147], 0
    s_waitcnt lgkmcnt(4)
    v_mfma_f32_16x16x32_bf16 v[84:87], v[120:123], v[148:151], 0
    s_waitcnt lgkmcnt(2)
    v_mfma_f32_16x16x32_bf16 v[88:91], v[120:123], v[152:155], 0
    s_waitcnt lgkmcnt(0)
    v_mfma_f32_16x16x32_bf16 v[92:95], v[120:123], v[156:159], 0
    s_barrier
    ds_read_b64_tr_b16 v[128:129], v200 offset:32768
    ds_read_b64_tr_b16 v[130:131], v200 offset:36864
    ds_read_b64_tr_b16 v[132:133], v201 offset:32768
    ds_read_b64_tr_b16 v[134:135], v201 offset:36864
    ds_read_b64_tr_b16 v[136:137], v202 offset:32768
    ds_read_b64_tr_b16 v[138:139], v202 offset:36864
    ds_read_b64_tr_b16 v[140:141], v203 offset:32768
    ds_read_b64_tr_b16 v[142:143], v203 offset:36864
    ds_read_b64_tr_b16 v[144:145], v204 offset:32768
    ds_read_b64_tr_b16 v[146:147], v204 offset:36864
    ds_read_b64_tr_b16 v[148:149], v205 offset:32768
    ds_read_b64_tr_b16 v[150:151], v205 offset:36864
    ds_read_b64_tr_b16 v[152:153], v206 offset:32768
    ds_read_b64_tr_b16 v[154:155], v206 offset:36864
    s_waitcnt lgkmcnt(12)
    v_mfma_f32_16x16x32_bf16 v[64:67], v[124:127], v[128:131], v[64:67]
    ds_read_b64_tr_b16 v[156:157], v207 offset:32768
    ds_read_b64_tr_b16 v[158:159], v207 offset:36864
    s_waitcnt lgkmcnt(12)
    v_mfma_f32_16x16x32_bf16 v[68:71], v[124:127], v[132:135], v[68:71]
    s_waitcnt lgkmcnt(10)
    v_mfma_f32_16x16x32_bf16 v[72:75], v[124:127], v[136:139], v[72:75]
    s_waitcnt lgkmcnt(8)
    v_mfma_f32_16x16x32_bf16 v[76:79], v[124:127], v[140:143], v[76:79]
    s_waitcnt lgkmcnt(6)
    v_mfma_f32_16x16x32_bf16 v[80:83], v[124:127], v[144:147], v[80:83]
    s_waitcnt lgkmcnt(4)
    v_mfma_f32_16x16x32_bf16 v[84:87], v[124:127], v[148:151], v[84:87]
    s_waitcnt lgkmcnt(2)
    v_mfma_f32_16x16x32_bf16 v[88:91], v[124:127], v[152:155], v[88:91]
    s_waitcnt lgkmcnt(0)
    v_mfma_f32_16x16x32_bf16 v[92:95], v[124:127], v[156:159], v[92:95]
    v_cndmask_b32 v64, v64, v68, s[60:61]
    v_cndmask_b32 v64, v64, v72, s[62:63]
    v_cndmask_b32 v64, v64, v76, s[72:73]
    v_and_or_b32 v224, v64, s74, v212
    v_cndmask_b32 v80, v80, v84, s[60:61]
    s_nop 0
    v_cndmask_b32 v80, v80, v88, s[62:63]
    s_nop 0
    v_cndmask_b32 v80, v80, v92, s[72:73]
    v_and_or_b32 v225, v80, s74, v212
    buffer_store_dword v224, v13, s[12:15], s30 offen offset:0
    buffer_store_dword v225, v13, s[12:15], s30 offen offset:256
    s_barrier
    s_cmp_eq_u32 s66, 1
    s_cbranch_scc1 x_start
    s_barrier
    ds_read_b64_tr_b16 v[128:129], v208 offset:0
    ds_read_b64_tr_b16 v[130:131], v208 offset:2048
    ds_read_b64_tr_b16 v[132:133], v209 offset:0
    ds_read_b64_tr_b16 v[134:135], v209 offset:2048
    ds_read_b64_tr_b16 v[136:137], v210 offset:0
    ds_read_b64_tr_b16 v[138:139], v210 offset:2048
    ds_read_b64_tr_b16 v[140:141], v211 offset:0
    ds_read_b64_tr_b16 v[142:143], v211 offset:2048
    ds_read_b64_tr_b16 v[144:145], v208 offset:16384
    ds_read_b64_tr_b16 v[146:147], v208 offset:18432
    ds_read_b64_tr_b16 v[148:149], v209 offset:16384
    ds_read_b64_tr_b16 v[150:151], v209 offset:18432
    ds_read_b64_tr_b16 v[152:153], v210 offset:16384
    ds_read_b64_tr_b16 v[154:155], v210 offset:18432
    s_waitcnt lgkmcnt(12)
    v_mfma_f32_16x16x32_bf16 v[64:67], v[120:123], v[128:131], 0
    ds_read_b64_tr_b16 v[156:157], v211 offset:16384
    ds_read_b64_tr_b16 v[158:159], v211 offset:18432
    s_waitcnt lgkmcnt(12)
    v_mfma_f32_16x16x32_bf16 v[68:71], v[120:123], v[132:135], 0
    s_waitcnt lgkmcnt(10)
    v_mfma_f32_16x16x32_bf16 v[72:75], v[120:123], v[136:139], 0
    s_waitcnt lgkmcnt(8)
    v_mfma_f32_16x16x32_bf16 v[76:79], v[120:123], v[140:143], 0
    s_waitcnt lgkmcnt(6)
    v_mfma_f32_16x16x32_bf16 v[64:67], v[124:127], v[144:147], v[64:67]
    s_waitcnt lgkmcnt(4)
    v_mfma_f32_16x16x32_bf16 v[68:71], v[124:127], v[148:151], v[68:71]
    s_waitcnt lgkmcnt(2)
    v_mfma_f32_16x16x32_bf16 v[72:75], v[124:127], v[152:155], v[72:75]
    s_waitcnt lgkmcnt(0)
    v_mfma_f32_16x16x32_bf16 v[76:79], v[124:127], v[156:159], v[76:79]
    s_nop 3
    v_cndmask_b32 v64, v64, v68, s[60:61]
    s_nop 0
    v_cndmask_b32 v64, v64, v72, s[62:63]
    s_nop 0
    v_cndmask_b32 v64, v64, v76, s[72:73]
    v_and_or_b32 v226, v64, s74, v212
    buffer_store_dword v226, v13, s[12:15], s31 offen offset:0
    s_barrier
    s_bitcmp1_b32 s16, 0
    s_cselect_b32 s8, s52, s50
    s_cselect_b32 s9, s53, s51
    s_mov_b32 s10, 7340032
    s_lshr_b32 s42, s8, 7
    s_sub_u32 s42, 3, s42
    s_add_u32 s42, s42, s34
    s_and_b32 s42, s42, 7
    s_cmp_eq_u32 s42, 7
    s_cbranch_scc1 m_nh2
    s_mul_i32 s43, s34, 7
    s_add_u32 s42, s42, s43
    s_lshl_b32 s42, s42, 7
    s_lshl_b32 s43, s35, 1
    s_lshr_b32 s40, s16, 1
    s_add_u32 s43, s43, s40
    s_mul_i32 s43, s43, 265216
    s_add_u32 s42, s42, s43
    v_mul_u32_u24 v24, 7168, v2
    s_mov_b32 exec_lo, 4294967295
    s_mov_b32 exec_hi, 31
    buffer_load_dword v245, v24, s[8:11], s42 offen
    s_mov_b64 exec, -1
m_nh2:
    s_barrier
    ds_read_b64_tr_b16 v[64:65], v12 offset:0
    ds_read_b64_tr_b16 v[66:67], v12 offset:2048
    ds_read_b64_tr_b16 v[68:69], v12 offset:4096
    ds_read_b64_tr_b16 v[70:71], v12 offset:6144
    ds_read_b64_tr_b16 v[72:73], v12 offset:8192
    ds_read_b64_tr_b16 v[74:75], v12 offset:10240
    ds_read_b64_tr_b16 v[76:77], v12 offset:12288
    ds_read_b64_tr_b16 v[78:79], v12 offset:14336
    ds_read_b64_tr_b16 v[80:81], v12 offset:16384
    ds_read_b64_tr_b16 v[82:83], v12 offset:18432
    ds_read_b64_tr_b16 v[84:85], v12 offset:20480
    ds_read_b64_tr_b16 v[86:87], v12 offset:22528
    ds_read_b64_tr_b16 v[88:89], v12 offset:24576
    ds_read_b64_tr_b16 v[90:91], v12 offset:26624
    ds_read_b64_tr_b16 v[92:93], v12 offset:28672
    ds_read_b64_tr_b16 v[94:95], v12 offset:30720
    s_waitcnt vmcnt(0)
    s_barrier
    s_sub_u32 s42, s16, 1
    s_cmp_ge_u32 s42, 3
    s_cbranch_scc1 m_nb
    s_lshl_b32 s42, s42, 10
    s_add_u32 s42, s42, s29
    s_add_u32 s43, s42, 524288
    buffer_load_dwordx4 v[44:47], v3, s[12:15], s42 offen sc1
    s_waitcnt vmcnt(0)
    buffer_store_dwordx4 v[44:47], v3, s[12:15], s43 offen sc1
m_nb:
m_join:
    v_bfe_u32 v7, v0, 4, 2
    v_and_b32 v6, 1, v0
    v_lshlrev_b32 v17, 10, v6
    v_lshl_add_u32 v17, v16, 9, v17
    v_lshl_add_u32 v17, v7, 4, v17
    v_add_u32 v17, 131072, v17
    v_and_b32 v6, 15, v0
    v_lshlrev_b32 v13, 6, v6
    v_bfe_u32 v22, v0, 4, 1
    v_lshl_add_u32 v13, v22, 5, v13
    v_bfe_u32 v22, v0, 5, 1
    v_lshl_add_u32 v13, v22, 4, v13
    v_add_u32 v13, 131072, v13
    v_lshl_add_u32 v13, v1, 10, v13
    s_lshl_b32 s70, s34, 1
    s_add_u32 s70, s70, s16
    s_lshl_b32 s70, s70, 13
    s_lshl_b32 s71, s65, 11
    s_add_u32 s70, s70, s71
    s_add_u32 s70, s70, 17301504
    s_mov_b32 s71, 0x07060302
    s_lshl_b32 s69, s64, 2
    s_and_b32 s42, s16, 3
    s_add_u32 s69, s69, s42
    s_lshl_b32 s69, s69, 10
    s_lshl_b32 s76, s65, 1
    s_lshr_b32 s42, s16, 2
    s_add_u32 s76, s76, s42
    s_lshl_b32 s76, s76, 8
    s_add_u32 s76, s76, s69
    s_add_u32 s77, s76, 18612224
    s_add_u32 s76, s76, 18350080
    s_add_u32 s69, s69, 18350080
    s_cmp_lg_u32 s16, 2
    s_cbranch_scc1 m_n0
    v_lshlrev_b32 v4, 7, v2
    s_sub_u32 s69, s69, 2048
    s_mov_b32 exec_hi, 0
    buffer_load_dword v5, v4, s[12:15], s69 offen sc1
    s_mov_b32 exec_hi, -1
m_n0:
    s_cmp_ge_u32 s16, 2
    s_cbranch_scc1 m_n1
    v_lshlrev_b32 v4, 7, v2
    s_mov_b64 exec, 0xffff
    buffer_load_dword v5, v4, s[12:15], s70 offen sc1
    s_mov_b64 exec, -1
m_n1:
    v_mov_b32 v216, s32
    v_mov_b32 v217, s33
    v_and_b32 v218, 1, v0
    v_cmp_eq_u32 vcc, 1, v218
    s_nop 1
    v_cndmask_b32 v216, v216, v217, vcc
    v_bfe_u32 v217, v216, 8, 8
    v_bfe_u32 v218, v216, 16, 8
    v_lshrrev_b32 v219, 24, v216
    v_and_b32 v216, 0xff, v216
    s_and_b32 s60, s32, 0xffff
    s_lshr_b32 s61, s32, 16
    s_and_b32 s62, s33, 0xffff
    s_lshr_b32 s63, s33, 16
    s_movk_i32 s74, 0xff00
    s_waitcnt vmcnt(0)
    s_barrier
    s_cmp_ge_u32 s16, 2
    s_cselect_b64 exec, 1, -1
    buffer_load_dwordx4 v[176:179], v3, s[12:15], s70 offen sc1
    buffer_load_dwordx4 v[180:183], v3, s[12:15], s70 offen offset:1024 sc1
    s_mov_b64 exec, -1
    ds_read_b64_tr_b16 v[96:97], v21 offset:0
    ds_read_b64_tr_b16 v[98:99], v21 offset:2048
    ds_read_b64_tr_b16 v[100:101], v21 offset:4096
    ds_read_b64_tr_b16 v[102:103], v21 offset:6144
    ds_read_b64_tr_b16 v[104:105], v21 offset:8192
    ds_read_b64_tr_b16 v[106:107], v21 offset:10240
    ds_read_b64_tr_b16 v[108:109], v21 offset:12288
    ds_read_b64_tr_b16 v[110:111], v21 offset:14336
    ds_read_b64_tr_b16 v[112:113], v21 offset:16384
    ds_read_b64_tr_b16 v[114:115], v21 offset:18432
    ds_read_b64_tr_b16 v[116:117], v21 offset:20480
    ds_read_b64_tr_b16 v[118:119], v21 offset:22528
    ds_read_b64_tr_b16 v[120:121], v21 offset:24576
    ds_read_b64_tr_b16 v[122:123], v21 offset:26624
    ds_read_b64_tr_b16 v[124:125], v21 offset:28672
    ds_read_b64_tr_b16 v[126:127], v21 offset:30720
    s_cbranch_scc1 m_nk
    s_mov_b32 s83, 0
    s_branch m_ph
m_pr:
    s_and_b32 s42, s83, 63
    s_cmp_eq_u32 s42, 63
    s_cselect_b32 s42, 131072, 0
    s_add_u32 s42, s42, s70
    buffer_load_dwordx4 v[176:179], v3, s[12:15], s42 offen sc1
    buffer_load_dwordx4 v[180:183], v3, s[12:15], s42 offen offset:1024 sc1
    s_add_u32 s83, s83, 1
    s_cmp_ge_u32 s83, 0x40000
    s_cbranch_scc1 m_phx
m_ph:
    s_waitcnt vmcnt(0)
    v_cmp_ne_u16 vcc, s63, v183
    s_cbranch_vccnz m_pr
    v_perm_b32 v184, v177, v176, s71
    v_perm_b32 v185, v179, v178, s71
    v_perm_b32 v186, v181, v180, s71
    v_perm_b32 v187, v183, v182, s71
    ds_write_b128 v13, v[184:187]
    v_xor_b32 v176, s60, v176
    v_xor_b32 v177, s61, v177
    v_xor_b32 v178, s62, v178
    v_xor_b32 v179, s63, v179
    v_xor_b32 v180, s60, v180
    v_xor_b32 v181, s61, v181
    v_xor_b32 v182, s62, v182
    v_xor_b32 v183, s63, v183
    v_or3_b32 v4, v176, v177, 0
    v_or3_b32 v4, v178, v179, v4
    v_or3_b32 v4, v180, v181, v4
    v_or3_b32 v4, v182, v183, v4
    v_cmp_ne_u16 vcc, 0, v4
    s_cbranch_vccnz m_pr
m_phx:
m_nk:
    s_waitcnt lgkmcnt(0)
    s_barrier
    ds_read_b128 v[128:131], v17 offset:0
    ds_read_b128 v[132:135], v17 offset:64
    ds_read_b128 v[136:139], v17 offset:128
    ds_read_b128 v[140:143], v17 offset:192
    ds_read_b128 v[144:147], v17 offset:256
    ds_read_b128 v[148:151], v17 offset:320
    ds_read_b128 v[152:155], v17 offset:384
    ds_read_b128 v[156:159], v17 offset:448
    s_waitcnt lgkmcnt(7)
    v_mfma_f32_16x16x32_bf16 v[160:163], v[128:131], v[64:67], 0
    v_mfma_f32_16x16x32_bf16 v[164:167], v[128:131], v[96:99], 0
    s_waitcnt lgkmcnt(6)
    v_mfma_f32_16x16x32_bf16 v[160:163], v[132:135], v[68:71], v[160:163]
    v_mfma_f32_16x16x32_bf16 v[164:167], v[132:135], v[100:103], v[164:167]
    s_waitcnt lgkmcnt(5)
    v_mfma_f32_16x16x32_bf16 v[160:163], v[136:139], v[72:75], v[160:163]
    v_mfma_f32_16x16x32_bf16 v[164:167], v[136:139], v[104:107], v[164:167]
    s_waitcnt lgkmcnt(4)
    v_mfma_f32_16x16x32_bf16 v[160:163], v[140:143], v[76:79], v[160:163]
    v_mfma_f32_16x16x32_bf16 v[164:167], v[140:143], v[108:111], v[164:167]
    s_waitcnt lgkmcnt(3)
    v_mfma_f32_16x16x32_bf16 v[160:163], v[144:147], v[80:83], v[160:163]
    v_mfma_f32_16x16x32_bf16 v[164:167], v[144:147], v[112:115], v[164:167]
    s_waitcnt lgkmcnt(2)
    v_mfma_f32_16x16x32_bf16 v[160:163], v[148:151], v[84:87], v[160:163]
    v_mfma_f32_16x16x32_bf16 v[164:167], v[148:151], v[116:119], v[164:167]
    s_waitcnt lgkmcnt(1)
    v_mfma_f32_16x16x32_bf16 v[160:163], v[152:155], v[88:91], v[160:163]
    v_mfma_f32_16x16x32_bf16 v[164:167], v[152:155], v[120:123], v[164:167]
    s_waitcnt lgkmcnt(0)
    v_mfma_f32_16x16x32_bf16 v[160:163], v[156:159], v[92:95], v[160:163]
    v_mfma_f32_16x16x32_bf16 v[164:167], v[156:159], v[124:127], v[164:167]
    s_nop 6
    v_and_or_b32 v184, v160, s74, v216
    v_and_or_b32 v185, v161, s74, v217
    v_and_or_b32 v186, v164, s74, v218
    v_and_or_b32 v187, v165, s74, v219
    s_mov_b64 exec, 0xffff
    buffer_store_dwordx4 v[184:187], v3, s[12:15], s76 offen
    buffer_store_dwordx4 v[184:187], v3, s[12:15], s77 offen sc1
    s_mov_b64 exec, -1
    s_cmp_eq_u32 s16, 0
    s_cbranch_scc1 r_start
g_end:
    s_endpgm
x_start:
    v_mov_b32 v216, s32
    v_mov_b32 v217, s33
    v_and_b32 v218, 1, v0
    v_cmp_eq_u32 vcc, 1, v218
    s_nop 1
    v_cndmask_b32 v216, v216, v217, vcc
    v_bfe_u32 v217, v216, 8, 8
    v_bfe_u32 v218, v216, 16, 8
    v_lshrrev_b32 v219, 24, v216
    v_and_b32 v216, 0xff, v216
    s_lshl_b32 s41, s34, 16
    s_lshl_b32 s42, s16, 13
    s_add_u32 s41, s41, s42
    s_add_u32 s41, s41, 19922944
    s_lshl_b32 s42, s65, 9
    s_add_u32 s40, s41, s42
    s_add_u32 s41, s40, s42
    v_lshlrev_b32 v10, 4, v0
    v_lshrrev_b32 v11, 5, v2
    v_and_b32 v12, 0x1f0, v3
    v_lshl_add_u32 v11, v11, 12, v12
    s_lshl_b32 s39, s34, 4
    s_add_u32 s39, s39, s35
    s_lshl_b32 s39, s39, 12
    s_add_u32 s39, s39, 19922944
    s_bitcmp1_b32 s64, 2
    s_cselect_b32 s28, 1.0, 0
    s_mov_b32 s83, 0
x_g0:
    s_and_b32 s42, s83, 31
    s_cmp_eq_u32 s42, 31
    s_cselect_b32 s42, 524288, 0
    s_add_u32 s42, s42, s41
    s_add_u32 s43, s42, 4096
    buffer_load_dwordx4 v[32:35], v3, s[12:15], s42 offen sc1
    buffer_load_dwordx4 v[36:39], v3, s[12:15], s43 offen sc1
    s_waitcnt vmcnt(0)
    v_xor_b32 v32, v216, v32
    v_xor_b32 v33, v217, v33
    v_xor_b32 v34, v218, v34
    v_xor_b32 v35, v219, v35
    v_xor_b32 v36, v216, v36
    v_xor_b32 v37, v217, v37
    v_xor_b32 v38, v218, v38
    v_xor_b32 v39, v219, v39
    v_or3_b32 v17, v32, v33, 0
    v_or3_b32 v17, v34, v35, v17
    v_or3_b32 v17, v36, v37, v17
    v_or3_b32 v17, v38, v39, v17
    v_and_b32 v17, 0xff, v17
    v_cmp_ne_u32 vcc, 0, v17
    s_cbranch_vccz x_g0x
    s_and_b32 s42, s83, 31
    s_cmp_lg_u32 s42, 24
    s_cbranch_scc1 x_g0n
    s_add_u32 s43, s39, 524288
    buffer_load_dwordx4 v[44:47], v3, s[12:15], s39 offen offset:0 sc1
    s_waitcnt vmcnt(0)
    buffer_store_dwordx4 v[44:47], v3, s[12:15], s43 offen offset:0 sc1
    s_waitcnt vmcnt(0)
    buffer_load_dwordx4 v[44:47], v3, s[12:15], s39 offen offset:1024 sc1
    s_waitcnt vmcnt(0)
    buffer_store_dwordx4 v[44:47], v3, s[12:15], s43 offen offset:1024 sc1
    s_waitcnt vmcnt(0)
x_g0n:
    s_add_u32 s83, s83, 1
    s_cmp_lt_u32 s83, 0x40000
    s_cbranch_scc1 x_g0
x_g0x:
    v_pk_add_f32 v[32:33], v[32:33], v[36:37]
    v_pk_add_f32 v[34:35], v[34:35], v[38:39]
    ds_write_b128 v10, v[32:35] offset:0
    s_waitcnt lgkmcnt(0)
    s_barrier
    s_cmp_lg_u32 s16, 0
    s_cbranch_scc1 x_g0e
    ds_read_b128 v[160:163], v221 offset:0
    ds_read_b128 v[164:167], v221 offset:1024
    ds_read_b128 v[168:171], v221 offset:2048
    ds_read_b128 v[172:175], v221 offset:3072
    ds_read_b128 v[176:179], v221 offset:4096
    ds_read_b128 v[180:183], v221 offset:5120
    ds_read_b128 v[184:187], v221 offset:6144
    ds_read_b128 v[188:191], v221 offset:7168
    s_waitcnt lgkmcnt(6)
    v_pk_add_f32 v[160:161], v[160:161], v[164:165]
    v_pk_add_f32 v[162:163], v[162:163], v[166:167]
    s_waitcnt lgkmcnt(4)
    v_pk_add_f32 v[168:169], v[168:169], v[172:173]
    v_pk_add_f32 v[170:171], v[170:171], v[174:175]
    s_waitcnt lgkmcnt(2)
    v_pk_add_f32 v[176:177], v[176:177], v[180:181]
    v_pk_add_f32 v[178:179], v[178:179], v[182:183]
    s_waitcnt lgkmcnt(0)
    v_pk_add_f32 v[184:185], v[184:185], v[188:189]
    v_pk_add_f32 v[186:187], v[186:187], v[190:191]
    v_pk_add_f32 v[160:161], v[160:161], v[168:169]
    v_pk_add_f32 v[176:177], v[176:177], v[184:185]
    v_pk_add_f32 v[162:163], v[162:163], v[170:171]
    v_pk_add_f32 v[178:179], v[178:179], v[186:187]
    v_pk_add_f32 v[160:161], v[160:161], v[176:177]
    v_pk_add_f32 v[162:163], v[162:163], v[178:179]
    v_cvt_pk_bf16_f32 v17, v160, v161
    v_lshlrev_b32 v160, 16, v17
    v_and_b32 v161, 0xffff0000, v17
    v_cvt_pk_bf16_f32 v18, v162, v163
    v_lshlrev_b32 v162, 16, v18
    v_and_b32 v163, 0xffff0000, v18
    v_add_f32 v160, s28, v160
    v_add_f32 v161, s28, v161
    v_add_f32 v162, s28, v162
    v_add_f32 v163, s28, v163
    v_cvt_pk_bf16_f32 v17, v160, v161
    v_lshlrev_b32 v160, 16, v17
    v_and_b32 v161, 0xffff0000, v17
    v_cvt_pk_bf16_f32 v18, v162, v163
    v_lshlrev_b32 v162, 16, v18
    v_and_b32 v163, 0xffff0000, v18
    v_and_or_b32 v40, v160, s74, v216
    v_and_or_b32 v41, v161, s74, v217
    v_and_or_b32 v42, v162, s74, v218
    v_and_or_b32 v43, v163, s74, v219
    buffer_store_dwordx4 v[40:43], v220, s[12:15], s22 offen sc1
    v_mov_b32 v48, s32
    v_mov_b32 v49, s33
    s_cmp_ge_u32 s64, 12
    s_cbranch_scc1 x_q
    v_max3_f32 v50, abs(v160), abs(v161), abs(v162)
    v_max_f32_e64 v50, v50, abs(v163)
    s_nop 1
    v_max_f32_dpp v50, v50, v50 row_ror:8 row_mask:0xf bank_mask:0xf
    s_nop 1
    v_max_f32_dpp v50, v50, v50 row_ror:4 row_mask:0xf bank_mask:0xf
    s_nop 1
    v_max_f32_dpp v50, v50, v50 row_ror:2 row_mask:0xf bank_mask:0xf
    s_nop 1
    v_max_f32_dpp v50, v50, v50 row_ror:1 row_mask:0xf bank_mask:0xf
    s_nop 1
    v_max_f32_dpp v50, v50, v50 row_bcast:15 row_mask:0xa bank_mask:0xf
    s_nop 1
    v_max_f32_dpp v50, v50, v50 row_bcast:31 row_mask:0xc bank_mask:0xf
    s_branch x_r
x_q:
    v_lshlrev_b32 v164, 16, v52
    v_and_b32 v165, 0xffff0000, v52
    v_lshlrev_b32 v166, 16, v53
    v_and_b32 v167, 0xffff0000, v53
    v_pk_mul_f32 v[164:165], v[164:165], v[160:161]
    v_pk_mul_f32 v[166:167], v[166:167], v[162:163]
    s_add_u32 s42, s22, 4096
    v_and_or_b32 v40, v164, s74, v216
    v_and_or_b32 v41, v165, s74, v217
    v_and_or_b32 v42, v166, s74, v218
    v_and_or_b32 v43, v167, s74, v219
    buffer_store_dwordx4 v[40:43], v220, s[12:15], s42 offen sc1
    v_and_b32 v164, s74, v164
    v_and_b32 v165, s74, v165
    v_and_b32 v166, s74, v166
    v_and_b32 v167, s74, v167
    v_pk_add_f32 v[164:165], v[164:165], v[166:167]
    v_add_f32 v50, v164, v165
    s_nop 1
    v_add_f32_dpp v50, v50, v50 row_ror:8 row_mask:0xf bank_mask:0xf
    s_nop 1
    v_add_f32_dpp v50, v50, v50 row_ror:4 row_mask:0xf bank_mask:0xf
    s_nop 1
    v_add_f32_dpp v50, v50, v50 row_ror:2 row_mask:0xf bank_mask:0xf
    s_nop 1
    v_add_f32_dpp v50, v50, v50 row_ror:1 row_mask:0xf bank_mask:0xf
    s_nop 1
    v_add_f32_dpp v50, v50, v50 row_bcast:15 row_mask:0xa bank_mask:0xf
    s_nop 1
    v_add_f32_dpp v50, v50, v50 row_bcast:31 row_mask:0xc bank_mask:0xf
x_r:
    s_nop 0
    v_readlane_b32 s42, v50, 63
    s_nop 1
    v_mov_b32 v50, s42
    s_mov_b64 exec, 0xff
    buffer_store_dwordx4 v[48:51], v3, s[12:15], s79 offen sc1
    s_mov_b64 exec, -1
x_g0e:
    s_barrier
    s_cmp_lt_u32 s16, 4
    s_cbranch_scc1 x_t1
    v_xor_b32 v4, 0, v14
    s_add_u32 s43, s68, 98304
    s_mov_b32 m0, s43
    s_add_u32 s42, s19, 0
    buffer_load_dwordx4 v4, s[8:11], s42 offen nt lds
    v_xor_b32 v4, 64, v14
    s_add_u32 s43, s68, 99328
    s_mov_b32 m0, s43
    s_add_u32 s42, s19, 24576
    buffer_load_dwordx4 v4, s[8:11], s42 offen nt lds
    v_xor_b32 v4, 0, v14
    s_add_u32 s43, s68, 100352
    s_mov_b32 m0, s43
    s_add_u32 s42, s19, 49152
    buffer_load_dwordx4 v4, s[8:11], s42 offen nt lds
    v_xor_b32 v4, 64, v14
    s_add_u32 s43, s68, 101376
    s_mov_b32 m0, s43
    s_add_u32 s42, s19, 73728
    buffer_load_dwordx4 v4, s[8:11], s42 offen nt lds
    v_xor_b32 v4, 128, v14
    s_add_u32 s43, s68, 102400
    s_mov_b32 m0, s43
    s_add_u32 s42, s19, 98304
    buffer_load_dwordx4 v4, s[8:11], s42 offen nt lds
    v_xor_b32 v4, 192, v14
    s_add_u32 s43, s68, 103424
    s_mov_b32 m0, s43
    s_add_u32 s42, s19, 122880
    buffer_load_dwordx4 v4, s[8:11], s42 offen nt lds
    v_xor_b32 v4, 128, v14
    s_add_u32 s43, s68, 104448
    s_mov_b32 m0, s43
    s_add_u32 s42, s19, 147456
    buffer_load_dwordx4 v4, s[8:11], s42 offen nt lds
    v_xor_b32 v4, 192, v14
    s_add_u32 s43, s68, 105472
    s_mov_b32 m0, s43
    s_add_u32 s42, s19, 172032
    buffer_load_dwordx4 v4, s[8:11], s42 offen nt lds
    s_waitcnt vmcnt(0)
    s_barrier
    s_branch x_t2
x_t1:
    s_barrier
    ds_read_b64_tr_b16 v[128:129], v208 offset:0
    ds_read_b64_tr_b16 v[130:131], v208 offset:2048
    ds_read_b64_tr_b16 v[132:133], v209 offset:0
    ds_read_b64_tr_b16 v[134:135], v209 offset:2048
    ds_read_b64_tr_b16 v[136:137], v210 offset:0
    ds_read_b64_tr_b16 v[138:139], v210 offset:2048
    ds_read_b64_tr_b16 v[140:141], v211 offset:0
    ds_read_b64_tr_b16 v[142:143], v211 offset:2048
    ds_read_b64_tr_b16 v[144:145], v208 offset:16384
    ds_read_b64_tr_b16 v[146:147], v208 offset:18432
    ds_read_b64_tr_b16 v[148:149], v209 offset:16384
    ds_read_b64_tr_b16 v[150:151], v209 offset:18432
    ds_read_b64_tr_b16 v[152:153], v210 offset:16384
    ds_read_b64_tr_b16 v[154:155], v210 offset:18432
    s_waitcnt lgkmcnt(12)
    v_mfma_f32_16x16x32_bf16 v[64:67], v[120:123], v[128:131], 0
    ds_read_b64_tr_b16 v[156:157], v211 offset:16384
    ds_read_b64_tr_b16 v[158:159], v211 offset:18432
    s_waitcnt lgkmcnt(12)
    v_mfma_f32_16x16x32_bf16 v[68:71], v[120:123], v[132:135], 0
    s_waitcnt lgkmcnt(10)
    v_mfma_f32_16x16x32_bf16 v[72:75], v[120:123], v[136:139], 0
    s_waitcnt lgkmcnt(8)
    v_mfma_f32_16x16x32_bf16 v[76:79], v[120:123], v[140:143], 0
    s_waitcnt lgkmcnt(6)
    v_mfma_f32_16x16x32_bf16 v[64:67], v[124:127], v[144:147], v[64:67]
    s_waitcnt lgkmcnt(4)
    v_mfma_f32_16x16x32_bf16 v[68:71], v[124:127], v[148:151], v[68:71]
    s_waitcnt lgkmcnt(2)
    v_mfma_f32_16x16x32_bf16 v[72:75], v[124:127], v[152:155], v[72:75]
    s_waitcnt lgkmcnt(0)
    v_mfma_f32_16x16x32_bf16 v[76:79], v[124:127], v[156:159], v[76:79]
    s_nop 3
    v_cndmask_b32 v64, v64, v68, s[60:61]
    s_nop 0
    v_cndmask_b32 v64, v64, v72, s[62:63]
    s_nop 0
    v_cndmask_b32 v64, v64, v76, s[72:73]
    v_and_or_b32 v226, v64, s74, v212
    buffer_store_dword v226, v13, s[12:15], s31 offen offset:0
x_t2:
    s_mov_b32 s83, 0
x_g1:
    s_and_b32 s42, s83, 31
    s_cmp_eq_u32 s42, 31
    s_cselect_b32 s42, 524288, 0
    s_add_u32 s42, s42, s40
    buffer_load_dwordx4 v[32:35], v11, s[12:15], s42 offen offset:2048 sc1
    s_waitcnt vmcnt(0)
    v_xor_b32 v32, v216, v32
    v_xor_b32 v33, v217, v33
    v_xor_b32 v34, v218, v34
    v_xor_b32 v35, v219, v35
    v_or3_b32 v17, v32, v33, 0
    v_or3_b32 v17, v34, v35, v17
    v_and_b32 v17, 0xff, v17
    v_cmp_ne_u32 vcc, 0, v17
    s_cbranch_vccz x_g1x
    s_and_b32 s42, s83, 31
    s_cmp_lg_u32 s42, 24
    s_cbranch_scc1 x_g1n
    s_add_u32 s43, s39, 524288
    buffer_load_dwordx4 v[44:47], v3, s[12:15], s39 offen offset:0 sc1
    s_waitcnt vmcnt(0)
    buffer_store_dwordx4 v[44:47], v3, s[12:15], s43 offen offset:0 sc1
    s_waitcnt vmcnt(0)
    buffer_load_dwordx4 v[44:47], v3, s[12:15], s39 offen offset:1024 sc1
    s_waitcnt vmcnt(0)
    buffer_store_dwordx4 v[44:47], v3, s[12:15], s43 offen offset:1024 sc1
    s_waitcnt vmcnt(0)
    buffer_load_dwordx4 v[44:47], v3, s[12:15], s39 offen offset:2048 sc1
    s_waitcnt vmcnt(0)
    buffer_store_dwordx4 v[44:47], v3, s[12:15], s43 offen offset:2048 sc1
    s_waitcnt vmcnt(0)
x_g1n:
    s_add_u32 s83, s83, 1
    s_cmp_lt_u32 s83, 0x40000
    s_cbranch_scc1 x_g1
x_g1x:
    ds_write_b128 v10, v[32:35] offset:8192
    s_waitcnt lgkmcnt(0)
    s_barrier
    s_cmp_lg_u32 s16, 0
    s_cbranch_scc1 x_g1e
    ds_read_b128 v[160:163], v221 offset:8192
    ds_read_b128 v[164:167], v221 offset:9216
    ds_read_b128 v[168:171], v221 offset:10240
    ds_read_b128 v[172:175], v221 offset:11264
    ds_read_b128 v[176:179], v221 offset:12288
    ds_read_b128 v[180:183], v221 offset:13312
    ds_read_b128 v[184:187], v221 offset:14336
    ds_read_b128 v[188:191], v221 offset:15360
    s_waitcnt lgkmcnt(6)
    v_pk_add_f32 v[160:161], v[160:161], v[164:165]
    v_pk_add_f32 v[162:163], v[162:163], v[166:167]
    s_waitcnt lgkmcnt(4)
    v_pk_add_f32 v[168:169], v[168:169], v[172:173]
    v_pk_add_f32 v[170:171], v[170:171], v[174:175]
    s_waitcnt lgkmcnt(2)
    v_pk_add_f32 v[176:177], v[176:177], v[180:181]
    v_pk_add_f32 v[178:179], v[178:179], v[182:183]
    s_waitcnt lgkmcnt(0)
    v_pk_add_f32 v[184:185], v[184:185], v[188:189]
    v_pk_add_f32 v[186:187], v[186:187], v[190:191]
    v_pk_add_f32 v[160:161], v[160:161], v[168:169]
    v_pk_add_f32 v[176:177], v[176:177], v[184:185]
    v_pk_add_f32 v[162:163], v[162:163], v[170:171]
    v_pk_add_f32 v[178:179], v[178:179], v[186:187]
    v_pk_add_f32 v[160:161], v[160:161], v[176:177]
    v_pk_add_f32 v[162:163], v[162:163], v[178:179]
    v_mov_b32 v164, v160
    v_mov_b32 v165, v161
    v_mov_b32 v166, v162
    v_mov_b32 v167, v163
    v_permlane32_swap_b32 v160, v164
    v_permlane32_swap_b32 v161, v165
    v_permlane32_swap_b32 v162, v166
    v_permlane32_swap_b32 v163, v167
    v_pk_add_f32 v[160:161], v[160:161], v[164:165]
    v_pk_add_f32 v[162:163], v[162:163], v[166:167]
    v_cvt_pk_bf16_f32 v17, v160, v161
    v_lshlrev_b32 v160, 16, v17
    v_and_b32 v161, 0xffff0000, v17
    v_cvt_pk_bf16_f32 v18, v162, v163
    v_lshlrev_b32 v162, 16, v18
    v_and_b32 v163, 0xffff0000, v18
    s_mov_b32 exec_hi, 0
    v_and_or_b32 v40, v160, s74, v216
    v_and_or_b32 v41, v161, s74, v217
    v_and_or_b32 v42, v162, s74, v218
    v_and_or_b32 v43, v163, s74, v219
    buffer_store_dwordx4 v[40:43], v220, s[12:15], s23 offen sc1
    s_mov_b32 exec_hi, -1
x_g1e:
    s_sub_u32 s42, s16, 0
    s_cmp_ge_u32 s42, 3
    s_cbranch_scc1 x_nb
    s_lshl_b32 s42, s42, 10
    s_add_u32 s42, s42, s29
    s_add_u32 s43, s42, 524288
    buffer_load_dwordx4 v[44:47], v3, s[12:15], s42 offen sc1
    s_waitcnt vmcnt(0)
    buffer_store_dwordx4 v[44:47], v3, s[12:15], s43 offen sc1
x_nb:
    s_cmp_lg_u32 s16, 0
    s_cbranch_scc1 g_end
    s_lshl_b32 s78, s34, 14
    s_add_u32 s78, s78, 17039360
    s_lshl_b32 s79, s34, 7
    s_add_u32 s79, s79, 16842752
    v_mov_b32 v22, 0
    s_mov_b32 s56, s48
    s_mov_b32 s57, s49
    s_mov_b32 s58, 2048
    s_mov_b32 s59, 0x00020000
    s_and_b32 s60, s32, 0xffff
    s_lshr_b32 s61, s32, 16
    s_and_b32 s62, s33, 0xffff
    s_lshr_b32 s63, s33, 16
    s_bfe_u32 s44, s32, 524288
    s_bfe_u32 s45, s32, 524296
    s_bfe_u32 s46, s32, 524304
    s_bfe_u32 s47, s32, 524312
    s_bfe_u32 s48, s33, 524288
    s_bfe_u32 s49, s33, 524296
    s_bfe_u32 s50, s33, 524304
    s_bfe_u32 s51, s33, 524312
    v_and_b32 v9, 15, v0
    v_lshlrev_b32 v9, 6, v9
    v_bfe_u32 v19, v0, 4, 1
    v_lshl_add_u32 v9, v19, 5, v9
    v_lshlrev_b32 v18, 9, v19
    v_bfe_u32 v19, v0, 5, 1
    v_lshl_add_u32 v9, v19, 4, v9
    v_lshl_add_u32 v18, v19, 11, v18
    v_bfe_u32 v19, v0, 2, 2
    v_lshl_add_u32 v18, v19, 7, v18
    v_lshl_add_u32 v18, v15, 4, v18
    s_mov_b32 s43, 16896000
    s_lshl_b32 s70, s64, 13
    s_add_u32 s70, s70, 17301504
    s_add_u32 s71, s70, 131072
    s_add_u32 s72, s70, 4096
    s_add_u32 s73, s71, 4096
    v_mov_b32 v21, 0xffff0000
    buffer_load_dwordx4 v[92:95], v9, s[56:59], 0 offen offset:0
    buffer_load_dwordx4 v[96:99], v9, s[56:59], 0 offen offset:1024
    s_mov_b32 s83, 0
    s_mov_b64 exec, 1
x_go:
    buffer_load_dwordx2 v[28:29], v22, s[12:15], s79 offen sc1
    s_waitcnt vmcnt(0)
    v_cmp_ne_u64 vcc, s[32:33], v[28:29]
    s_cbranch_vccz x_goy
    s_sleep 3
    s_add_u32 s83, s83, 1
    s_cmp_lt_u32 s83, 0x40000
    s_cbranch_scc1 x_go
x_goy:
    s_mov_b64 exec, -1
x_gox:
    s_mov_b32 s83, 0
x_sb:
    buffer_load_dwordx4 v[100:103], v18, s[12:15], s43 offen offset:0 sc1
    buffer_load_dwordx4 v[104:107], v18, s[12:15], s43 offen offset:1024 sc1
    buffer_load_dwordx4 v[108:111], v18, s[12:15], s43 offen offset:64 sc1
    buffer_load_dwordx4 v[112:115], v18, s[12:15], s43 offen offset:1088 sc1
    s_sub_u32 s42, s43, 8192
    buffer_load_dwordx4 v[116:119], v18, s[12:15], s42 offen offset:0 sc1
    buffer_load_dwordx4 v[120:123], v18, s[12:15], s42 offen offset:1024 sc1
    buffer_load_dwordx4 v[124:127], v18, s[12:15], s42 offen offset:64 sc1
    buffer_load_dwordx4 v[128:131], v18, s[12:15], s42 offen offset:1088 sc1
    v_lshlrev_b32 v48, 16, v92
    v_and_b32 v49, 0xffff0000, v92
    v_lshlrev_b32 v50, 16, v93
    v_and_b32 v51, 0xffff0000, v93
    v_lshlrev_b32 v52, 16, v94
    v_and_b32 v53, 0xffff0000, v94
    v_lshlrev_b32 v54, 16, v95
    v_and_b32 v55, 0xffff0000, v95
    v_lshlrev_b32 v56, 16, v96
    v_and_b32 v57, 0xffff0000, v96
    v_lshlrev_b32 v58, 16, v97
    v_and_b32 v59, 0xffff0000, v97
    v_lshlrev_b32 v60, 16, v98
    v_and_b32 v61, 0xffff0000, v98
    v_lshlrev_b32 v62, 16, v99
    v_and_b32 v63, 0xffff0000, v99
    s_waitcnt vmcnt(0)
    v_xor_b32 v100, v216, v100
    v_xor_b32 v101, v217, v101
    v_xor_b32 v102, v218, v102
    v_xor_b32 v103, v219, v103
    v_xor_b32 v104, v216, v104
    v_xor_b32 v105, v217, v105
    v_xor_b32 v106, v218, v106
    v_xor_b32 v107, v219, v107
    v_xor_b32 v108, v216, v108
    v_xor_b32 v109, v217, v109
    v_xor_b32 v110, v218, v110
    v_xor_b32 v111, v219, v111
    v_xor_b32 v112, v216, v112
    v_xor_b32 v113, v217, v113
    v_xor_b32 v114, v218, v114
    v_xor_b32 v115, v219, v115
    v_xor_b32 v116, v216, v116
    v_xor_b32 v117, v217, v117
    v_xor_b32 v118, v218, v118
    v_xor_b32 v119, v219, v119
    v_xor_b32 v120, v216, v120
    v_xor_b32 v121, v217, v121
    v_xor_b32 v122, v218, v122
    v_xor_b32 v123, v219, v123
    v_xor_b32 v124, v216, v124
    v_xor_b32 v125, v217, v125
    v_xor_b32 v126, v218, v126
    v_xor_b32 v127, v219, v127
    v_xor_b32 v128, v216, v128
    v_xor_b32 v129, v217, v129
    v_xor_b32 v130, v218, v130
    v_xor_b32 v131, v219, v131
    v_or3_b32 v19, v100, v101, 0
    v_or3_b32 v19, v102, v103, v19
    v_or3_b32 v19, v104, v105, v19
    v_or3_b32 v19, v106, v107, v19
    v_or3_b32 v19, v108, v109, v19
    v_or3_b32 v19, v110, v111, v19
    v_or3_b32 v19, v112, v113, v19
    v_or3_b32 v19, v114, v115, v19
    v_or3_b32 v19, v116, v117, v19
    v_or3_b32 v19, v118, v119, v19
    v_or3_b32 v19, v120, v121, v19
    v_or3_b32 v19, v122, v123, v19
    v_or3_b32 v19, v124, v125, v19
    v_or3_b32 v19, v126, v127, v19
    v_or3_b32 v19, v128, v129, v19
    v_or3_b32 v19, v130, v131, v19
    v_and_b32 v19, 0xff, v19
    v_cmp_ne_u32 vcc, 0, v19
    s_cbranch_vccz x_sbx
    s_sleep 8
    s_add_u32 s83, s83, 1
    s_cmp_lt_u32 s83, 0x40000
    s_cbranch_scc1 x_sb
x_sbx:
    v_lshlrev_b32 v32, 7, v2
    s_add_u32 s42, s78, 8192
    s_mov_b32 s83, 0
    s_mov_b64 vcc, -1
    s_mov_b64 s[40:41], -1
x_pk:
    s_mov_b64 exec, vcc
    s_cbranch_execz x_pka
    buffer_load_dwordx4 v[24:27], v32, s[12:15], s78 offen sc1
x_pka:
    s_mov_b64 exec, s[40:41]
    s_cbranch_execz x_pkb
    buffer_load_dwordx4 v[28:31], v32, s[12:15], s42 offen sc1
x_pkb:
    s_mov_b64 exec, -1
    s_waitcnt vmcnt(0)
x_pkc:
    v_cmp_ne_u32 vcc, s32, v25
    v_cmp_ne_u32 s[20:21], s33, v27
    v_cmp_ne_u32 s[40:41], s32, v29
    v_cmp_ne_u32 s[22:23], s33, v31
    v_max_u32 v33, v24, v28
    v_min_u32 v34, v24, v28
    s_or_b64 vcc, vcc, s[20:21]
    s_or_b64 s[40:41], s[40:41], s[22:23]
    s_or_b64 s[20:21], vcc, s[40:41]
    s_cbranch_scc0 x_pkx
    s_add_u32 s83, s83, 1
    s_cmp_lt_u32 s83, 0x40000
    s_cbranch_scc1 x_pk
x_pkx:
    v_mov_b32 v35, v33
    v_max3_u32 v34, v34, v26, v30
    s_nop 0
    v_max_u32_dpp v35, v35, v35 row_ror:8 row_mask:0xf bank_mask:0xf
    s_nop 1
    v_max_u32_dpp v35, v35, v35 row_ror:4 row_mask:0xf bank_mask:0xf
    s_nop 1
    v_max_u32_dpp v35, v35, v35 row_ror:2 row_mask:0xf bank_mask:0xf
    s_nop 1
    v_max_u32_dpp v35, v35, v35 row_ror:1 row_mask:0xf bank_mask:0xf
    s_nop 1
    v_max_u32_dpp v35, v35, v35 row_bcast:15 row_mask:0xa bank_mask:0xf
    s_nop 1
    v_max_u32_dpp v35, v35, v35 row_bcast:31 row_mask:0xc bank_mask:0xf
    s_nop 0
    v_readlane_b32 s40, v35, 63
    s_cmp_eq_u32 s65, 0
    s_cbranch_scc1 x_t1st
    v_cmp_eq_u32 vcc, s40, v33
    s_nop 1
    v_cndmask_b32 v35, v33, v34, vcc
    s_nop 1
    v_max_u32_dpp v35, v35, v35 row_ror:8 row_mask:0xf bank_mask:0xf
    s_nop 1
    v_max_u32_dpp v35, v35, v35 row_ror:4 row_mask:0xf bank_mask:0xf
    s_nop 1
    v_max_u32_dpp v35, v35, v35 row_ror:2 row_mask:0xf bank_mask:0xf
    s_nop 1
    v_max_u32_dpp v35, v35, v35 row_ror:1 row_mask:0xf bank_mask:0xf
    s_nop 1
    v_max_u32_dpp v35, v35, v35 row_bcast:15 row_mask:0xa bank_mask:0xf
    s_nop 1
    v_max_u32_dpp v35, v35, v35 row_bcast:31 row_mask:0xc bank_mask:0xf
    s_nop 0
    v_readlane_b32 s41, v35, 63
    s_mov_b32 s40, s41
x_t1st:
    v_mov_b32 v46, s40
    s_bfe_u32 s42, s40, 0x70005
    s_lshl_b32 s42, s42, 13
    s_and_b32 s40, s40, 1
    s_lshl_b32 s40, s40, 12
    s_add_u32 s42, s42, s40
    s_lshr_b32 s43, s42, 5
    s_add_u32 s42, s42, 18874368
    s_add_u32 s43, s43, 17170432
    s_mov_b32 s83, 0
x_ph:
    s_mov_b64 exec, 1
    buffer_load_dwordx4 v[28:31], v22, s[12:15], s43 offen sc1
    s_mov_b64 exec, -1
    buffer_load_dwordx4 v[64:67], v3, s[12:15], s42 offen offset:0 sc1
    buffer_load_dwordx4 v[68:71], v3, s[12:15], s42 offen offset:1024 sc1
    buffer_load_dwordx4 v[72:75], v3, s[12:15], s42 offen offset:2048 sc1
    buffer_load_dwordx4 v[76:79], v3, s[12:15], s42 offen offset:3072 sc1
    s_waitcnt vmcnt(4)
    v_readfirstlane_b32 s22, v28
    v_readfirstlane_b32 s23, v29
    v_readfirstlane_b32 s20, v30
    v_readfirstlane_b32 s21, v31
    s_xor_b64 s[22:23], s[22:23], s[32:33]
    s_cbranch_scc1 x_pr
    s_waitcnt vmcnt(3)
    v_xor_b32 v64, s44, v64
    v_xor_b32 v65, s45, v65
    v_xor_b32 v66, s46, v66
    v_xor_b32 v67, s47, v67
    v_or3_b32 v19, v64, v65, v66
    v_or_b32 v19, v19, v67
    v_pk_fma_f32 v[64:65], v[64:65], s[20:21], s[20:21] op_sel:[0,1,0] op_sel_hi:[1,1,0]
    v_pk_fma_f32 v[66:67], v[66:67], s[20:21], s[20:21] op_sel:[0,1,0] op_sel_hi:[1,1,0]
    v_cmp_ne_u16_sdwa vcc, v19, v22 src0_sel:BYTE_0 src1_sel:DWORD
    v_pk_fma_f32 v[64:65], v[64:65], v[116:117], v[100:101]
    v_pk_fma_f32 v[66:67], v[66:67], v[118:119], v[102:103]
    v_cvt_pk_bf16_f32 v32, v64, v65
    v_cvt_pk_bf16_f32 v33, v66, v67
    s_cbranch_vccnz x_pr
    v_lshl_or_b32 v64, v32, 16, s60
    v_and_or_b32 v65, v32, v21, s61
    v_lshl_or_b32 v66, v33, 16, s62
    v_and_or_b32 v67, v33, v21, s63
    buffer_store_dwordx4 v[64:67], v3, s[12:15], s70 offen offset:0
    s_waitcnt vmcnt(3)
    v_xor_b32 v68, s48, v68
    v_xor_b32 v69, s49, v69
    v_xor_b32 v70, s50, v70
    v_xor_b32 v71, s51, v71
    v_or3_b32 v19, v68, v69, v70
    v_or_b32 v19, v19, v71
    v_pk_fma_f32 v[68:69], v[68:69], s[20:21], s[20:21] op_sel:[0,1,0] op_sel_hi:[1,1,0]
    v_pk_fma_f32 v[70:71], v[70:71], s[20:21], s[20:21] op_sel:[0,1,0] op_sel_hi:[1,1,0]
    v_cmp_ne_u16_sdwa vcc, v19, v22 src0_sel:BYTE_0 src1_sel:DWORD
    v_pk_fma_f32 v[68:69], v[68:69], v[120:121], v[104:105]
    v_pk_fma_f32 v[70:71], v[70:71], v[122:123], v[106:107]
    v_cvt_pk_bf16_f32 v34, v68, v69
    v_cvt_pk_bf16_f32 v35, v70, v71
    s_cbranch_vccnz x_pr
    v_lshl_or_b32 v68, v34, 16, s60
    v_and_or_b32 v69, v34, v21, s61
    v_lshl_or_b32 v70, v35, 16, s62
    v_and_or_b32 v71, v35, v21, s63
    buffer_store_dwordx4 v[68:71], v3, s[12:15], s70 offen offset:1024
    s_waitcnt vmcnt(3)
    v_xor_b32 v72, s44, v72
    v_xor_b32 v73, s45, v73
    v_xor_b32 v74, s46, v74
    v_xor_b32 v75, s47, v75
    v_or3_b32 v19, v72, v73, v74
    v_or_b32 v19, v19, v75
    v_pk_fma_f32 v[72:73], v[72:73], s[20:21], s[20:21] op_sel:[0,1,0] op_sel_hi:[1,1,0]
    v_pk_fma_f32 v[74:75], v[74:75], s[20:21], s[20:21] op_sel:[0,1,0] op_sel_hi:[1,1,0]
    v_cmp_ne_u16_sdwa vcc, v19, v22 src0_sel:BYTE_0 src1_sel:DWORD
    v_pk_fma_f32 v[72:73], v[72:73], v[124:125], v[108:109]
    v_pk_fma_f32 v[74:75], v[74:75], v[126:127], v[110:111]
    v_cvt_pk_bf16_f32 v36, v72, v73
    v_cvt_pk_bf16_f32 v37, v74, v75
    s_cbranch_vccnz x_pr
    v_lshl_or_b32 v72, v36, 16, s60
    v_and_or_b32 v73, v36, v21, s61
    v_lshl_or_b32 v74, v37, 16, s62
    v_and_or_b32 v75, v37, v21, s63
    buffer_store_dwordx4 v[72:75], v3, s[12:15], s70 offen offset:2048
    s_waitcnt vmcnt(3)
    v_xor_b32 v76, s48, v76
    v_xor_b32 v77, s49, v77
    v_xor_b32 v78, s50, v78
    v_xor_b32 v79, s51, v79
    v_or3_b32 v19, v76, v77, v78
    v_or_b32 v19, v19, v79
    v_pk_fma_f32 v[76:77], v[76:77], s[20:21], s[20:21] op_sel:[0,1,0] op_sel_hi:[1,1,0]
    v_pk_fma_f32 v[78:79], v[78:79], s[20:21], s[20:21] op_sel:[0,1,0] op_sel_hi:[1,1,0]
    v_cmp_ne_u16_sdwa vcc, v19, v22 src0_sel:BYTE_0 src1_sel:DWORD
    v_pk_fma_f32 v[76:77], v[76:77], v[128:129], v[112:113]
    v_pk_fma_f32 v[78:79], v[78:79], v[130:131], v[114:115]
    v_cvt_pk_bf16_f32 v38, v76, v77
    v_cvt_pk_bf16_f32 v39, v78, v79
    s_cbranch_vccnz x_pr
    v_lshl_or_b32 v76, v38, 16, s60
    v_and_or_b32 v77, v38, v21, s61
    v_lshl_or_b32 v78, v39, 16, s62
    v_and_or_b32 v79, v39, v21, s63
    buffer_store_dwordx4 v[76:79], v3, s[12:15], s70 offen offset:3072
x_phx:
    buffer_store_dwordx4 v[64:67], v3, s[12:15], s71 offen offset:0 sc1
    buffer_store_dwordx4 v[68:71], v3, s[12:15], s71 offen offset:1024 sc1
    buffer_store_dwordx4 v[72:75], v3, s[12:15], s71 offen offset:2048 sc1
    buffer_store_dwordx4 v[76:79], v3, s[12:15], s71 offen offset:3072 sc1
    v_lshlrev_b32 v100, 16, v32
    v_and_b32 v101, 0xffff0000, v32
    v_lshlrev_b32 v102, 16, v33
    v_and_b32 v103, 0xffff0000, v33
    v_lshlrev_b32 v104, 16, v34
    v_and_b32 v105, 0xffff0000, v34
    v_lshlrev_b32 v106, 16, v35
    v_and_b32 v107, 0xffff0000, v35
    v_lshlrev_b32 v108, 16, v36
    v_and_b32 v109, 0xffff0000, v36
    v_lshlrev_b32 v110, 16, v37
    v_and_b32 v111, 0xffff0000, v37
    v_lshlrev_b32 v112, 16, v38
    v_and_b32 v113, 0xffff0000, v38
    v_lshlrev_b32 v114, 16, v39
    v_and_b32 v115, 0xffff0000, v39
    v_pk_mul_f32 v[8:9], v[48:49], v[100:101]
    v_pk_fma_f32 v[8:9], v[50:51], v[102:103], v[8:9]
    v_pk_fma_f32 v[8:9], v[52:53], v[104:105], v[8:9]
    v_pk_fma_f32 v[8:9], v[54:55], v[106:107], v[8:9]
    v_pk_fma_f32 v[8:9], v[56:57], v[108:109], v[8:9]
    v_pk_fma_f32 v[8:9], v[58:59], v[110:111], v[8:9]
    v_pk_fma_f32 v[8:9], v[60:61], v[112:113], v[8:9]
    v_pk_fma_f32 v[8:9], v[62:63], v[114:115], v[8:9]
    v_add_f32 v8, v8, v9
    s_nop 1
    v_add_f32_dpp v8, v8, v8 row_ror:8 row_mask:0xf bank_mask:0xf
    s_nop 1
    v_add_f32_dpp v8, v8, v8 row_ror:4 row_mask:0xf bank_mask:0xf
    s_nop 1
    v_add_f32_dpp v8, v8, v8 row_ror:2 row_mask:0xf bank_mask:0xf
    s_nop 1
    v_add_f32_dpp v8, v8, v8 row_ror:1 row_mask:0xf bank_mask:0xf
    s_nop 1
    v_add_f32_dpp v8, v8, v8 row_bcast:15 row_mask:0xa bank_mask:0xf
    s_nop 1
    v_add_f32_dpp v8, v8, v8 row_bcast:31 row_mask:0xc bank_mask:0xf
    v_cvt_pk_bf16_f32 v8, v8, v8
    v_lshlrev_b32 v8, 16, v8
    v_mul_f32 v8, 0xbfb8aa3b, v8
    v_exp_f32 v8, v8
    s_nop 0
    v_add_f32 v8, 1.0, v8
    v_rcp_f32 v8, v8
    s_nop 0
    v_cvt_pk_bf16_f32 v8, v8, v8
    v_lshlrev_b32 v8, 16, v8
    s_nop 0
    v_readlane_b32 s46, v8, 63
    v_mov_b32 v44, s32
    v_mov_b32 v45, s33
    v_mov_b32 v47, s46
    s_mov_b64 exec, 0xff
    buffer_store_dwordx4 v[44:47], v3, s[12:15], s73 offen sc1
    s_mov_b64 exec, -1
    s_sleep 20
r_start:
    s_lshl_b32 s62, s34, 1
    s_lshr_b32 s42, s34, 2
    s_add_u32 s62, s62, s42
    s_lshl_b32 s62, s62, 13
    s_add_u32 s62, s62, 17432576
    s_add_u32 s61, s62, 4096
    s_and_b32 s18, s34, 3
    s_lshl_b32 s18, s18, 4
    s_add_u32 s18, s18, s35
    v_mov_b32 v11, 0
    v_and_b32 v4, 3, v0
    v_lshrrev_b32 v7, 4, v2
    v_lshlrev_b32 v5, 3, v4
    v_lshl_add_u32 v5, v7, 1, v5
    v_lshlrev_b32 v6, 10, v4
    v_lshl_add_u32 v6, v7, 2, v6
    v_lshrrev_b32 v86, 1, v4
    v_lshlrev_b32 v86, 9, v86
    v_and_b32 v87, 1, v4
    v_lshl_add_u32 v85, v87, 10, v86
    v_lshl_add_u32 v85, v7, 2, v85
    s_and_b32 s30, s18, 1
    s_bfe_u32 s31, s18, 0x20001
    s_bfe_u32 s40, s18, 0x20003
    s_lshr_b32 s41, s18, 5
    s_lshl_b32 s45, s41, 11
    s_lshl_b32 s42, s30, 8
    s_add_u32 s45, s45, s42
    s_lshl_b32 s42, s40, 6
    s_add_u32 s45, s45, s42
    s_lshl_b32 s31, s31, 4
    s_add_u32 s45, s45, s31
    s_add_u32 s62, s62, s45
    s_lshl_b32 s30, s30, 9
    s_add_u32 s31, s31, s30
    s_lshl_b32 s40, s40, 7
    s_add_u32 s31, s31, s40
    s_lshl_b32 s41, s41, 6
    s_add_u32 s31, s31, s41
    s_add_u32 s31, s31, 16900096
    s_mov_b32 s83, 0
r_ld:
    s_mov_b64 exec, 1
    buffer_load_dwordx4 v[32:35], v11, s[12:15], s61 offen sc1
    s_mov_b64 exec, -1
    buffer_load_dword v41, v85, s[12:15], s62 offen sc1
    buffer_load_dword v91, v6, s[12:15], s31 offen sc1
    s_bitcmp1_b32 s18, 1
    s_cselect_b32 s42, s33, s32
    v_lshlrev_b32 v88, 3, v7
    v_lshrrev_b32_e64 v88, v88, s42
    v_and_b32 v88, 0xff, v88
    v_lshlrev_b32 v89, 4, v7
    v_lshrrev_b64 v[82:83], v89, s[32:33]
    v_and_b32 v82, 0xffff, v82
    s_waitcnt vmcnt(0)
    v_readfirstlane_b32 s50, v32
    v_readfirstlane_b32 s51, v33
    v_readfirstlane_b32 s40, v34
    v_readfirstlane_b32 s46, v35
    v_xor_b32 v91, v88, v91
    v_xor_b32 v41, v82, v41
    v_or_b32 v19, v91, v41
    v_cmp_ne_u16 vcc, 0, v19
    s_xor_b64 s[50:51], s[50:51], s[32:33]
    s_or_b64 vcc, vcc, s[50:51]
    s_cbranch_vccz r_ldx
    s_sleep 2
    s_add_u32 s83, s83, 1
    s_cmp_lt_u32 s83, 0x40000
    s_cbranch_scc1 r_ld
r_ldx:
    v_mul_f32 v80, s46, v91
    s_bfe_u32 s46, s40, 0x70005
    s_bfe_u32 s47, s40, 0x30002
    s_bfe_u32 s60, s40, 0x10001
    s_bfe_u32 s63, s40, 0x70005
    s_lshl_b32 s63, s63, 13
    s_and_b32 s40, s40, 1
    s_lshl_b32 s40, s40, 12
    s_add_u32 s63, s63, s40
    s_add_u32 s63, s63, s45
    s_add_u32 s63, s63, 18874368
    buffer_load_dword v44, v85, s[12:15], s63 offen sc1
    v_lshrrev_b32 v10, 2, v2
    v_lshlrev_b32 v10, 7, v10
    v_lshl_add_u32 v10, v4, 4, v10
    s_lshl_b32 s44, s18, 13
    s_and_b32 s42, s34, 4
    s_lshl_b32 s42, s42, 4
    s_add_u32 s44, s44, s42
    s_add_u32 s44, s44, 17825792
    s_add_u32 s45, s44, 4096
    s_lshr_b32 s61, s46, 4
    s_and_b32 s41, s46, 15
    s_lshl_b32 s41, s41, 4
    s_add_u32 s41, s41, s61
    s_lshr_b32 s61, s46, 3
    s_cmp_eq_u32 s61, 1
    s_cselect_b32 s61, 120, 0
    s_sub_u32 s41, s41, s61
    s_lshl_b32 s61, s47, 8
    s_add_u32 s41, s41, s61
    s_cmp_ge_u32 s47, 4
    s_cselect_b32 s61, 896, 0
    s_cmp_eq_u32 s46, 0
    s_cselect_b32 s61, s61, 0
    s_sub_u32 s41, s41, s61
    s_sub_u32 s61, 2048, s41
    s_cmp_eq_u32 s41, 0
    s_cselect_b32 s61, 1024, s61
    s_cmp_eq_u32 s60, 1
    s_cselect_b32 s41, s61, s41
    s_lshl_b32 s41, s41, 11
    s_lshl_b32 s61, s18, 5
    s_add_u32 s41, s41, s61
    s_mov_b64 exec, 1
    buffer_load_dword v245, v5, s[24:27], s41 offen
    s_mov_b64 exec, -1
    s_waitcnt vmcnt(1)
    v_and_b32 v44, 0xffffff00, v44
    v_fmac_f32 v44, v91, v41
    v_mov_b32 v28, v216
    v_mov_b32 v29, v217
    v_mov_b32 v30, v218
    v_mov_b32 v31, v219
    s_sleep 28
    s_mov_b32 s83, 0
    s_mov_b64 s[64:65], -1
    s_mov_b64 s[66:67], -1
    s_mov_b64 s[68:69], -1
    s_mov_b32 s70, -1
    s_mov_b32 s71, 0
r_p:
    s_mov_b64 exec, s[64:65]
    s_cbranch_execz r_q0
    buffer_load_dwordx4 v[16:19], v10, s[12:15], s44 offen offset:0 sc1
r_q0:
    s_mov_b64 exec, s[66:67]
    s_cbranch_execz r_q1
    buffer_load_dwordx4 v[20:23], v10, s[12:15], s44 offen offset:2048 sc1
r_q1:
    s_mov_b64 exec, s[68:69]
    s_cbranch_execz r_q2
    buffer_load_dwordx4 v[24:27], v10, s[12:15], s45 offen offset:0 sc1
r_q2:
    s_mov_b64 exec, s[70:71]
    s_cbranch_execz r_q3
    buffer_load_dwordx4 v[28:31], v10, s[12:15], s45 offen offset:2048 sc1
r_q3:
    s_mov_b64 exec, -1
    s_waitcnt vmcnt(0)
    v_xor_b32 v48, v216, v16
    v_xor_b32 v49, v217, v17
    v_xor_b32 v50, v218, v18
    v_xor_b32 v51, v219, v19
    v_xor_b32 v52, v216, v20
    v_xor_b32 v53, v217, v21
    v_xor_b32 v54, v218, v22
    v_xor_b32 v55, v219, v23
    v_xor_b32 v56, v216, v24
    v_xor_b32 v57, v217, v25
    v_xor_b32 v58, v218, v26
    v_xor_b32 v59, v219, v27
    v_xor_b32 v60, v216, v28
    v_xor_b32 v61, v217, v29
    v_xor_b32 v62, v218, v30
    v_xor_b32 v63, v219, v31
    v_or3_b32 v12, v48, v49, v50
    v_or3_b32 v13, v52, v53, v54
    v_or3_b32 v14, v56, v57, v58
    v_or3_b32 v15, v60, v61, v62
    v_or_b32 v12, v12, v51
    v_or_b32 v13, v13, v55
    v_or_b32 v14, v14, v59
    v_or_b32 v15, v15, v63
    v_pk_add_f32 v[48:49], v[48:49], v[52:53]
    v_pk_add_f32 v[56:57], v[56:57], v[60:61]
    v_pk_add_f32 v[50:51], v[50:51], v[54:55]
    v_pk_add_f32 v[58:59], v[58:59], v[62:63]
    v_cmp_ne_u16_sdwa s[64:65], v12, v11 src0_sel:BYTE_0 src1_sel:DWORD
    v_cmp_ne_u16_sdwa s[66:67], v13, v11 src0_sel:BYTE_0 src1_sel:DWORD
    v_cmp_ne_u16_sdwa s[68:69], v14, v11 src0_sel:BYTE_0 src1_sel:DWORD
    v_cmp_ne_u16_sdwa s[70:71], v15, v11 src0_sel:BYTE_0 src1_sel:DWORD
    v_pk_add_f32 v[48:49], v[48:49], v[56:57]
    v_pk_add_f32 v[50:51], v[50:51], v[58:59]
    s_or_b64 s[50:51], s[64:65], s[66:67]
    s_or_b64 s[52:53], s[68:69], s[70:71]
    s_or_b64 s[50:51], s[50:51], s[52:53]
    s_cbranch_scc1 r_r
r_x:
    v_permlane32_swap_b32 v48, v50
    v_permlane32_swap_b32 v49, v51
    v_pk_add_f32 v[48:49], v[48:49], v[50:51]
    s_nop 1
    v_permlane16_swap_b32 v48, v49
    v_add_f32 v48, v48, v49
    s_nop 1
    v_add_f32_dpp v48, v48, v48 row_ror:4 row_mask:0xf bank_mask:0xf
    s_nop 1
    v_add_f32_dpp v48, v48, v48 row_ror:8 row_mask:0xf bank_mask:0xf
    v_fmac_f32 v44, v48, v80
    s_mov_b32 exec_lo, 0x000f000f
    s_mov_b32 exec_hi, 0x000f000f
    v_cvt_pk_bf16_f32 v44, v44, v44
    buffer_store_short v44, v5, s[24:27], s41 offen
    s_endpgm
x_pr:
    s_waitcnt vmcnt(0)
    s_add_u32 s83, s83, 1
    s_cmp_lt_u32 s83, 0x40000
    s_cbranch_scc1 x_ph
    s_branch x_phx
r_r:
    s_add_u32 s83, s83, 1
    s_cmp_lt_u32 s83, 0x40000
    s_cbranch_scc1 r_p
    s_branch r_x
f_start:
    s_mov_b32 s20, s26
    s_mov_b32 s21, s27
    s_mov_b32 s26, 4194304
    s_mov_b32 s27, 0x00020000
    s_mov_b32 s22, s50
    s_mov_b32 s23, s51
    s_mov_b32 s28, s54
    s_mov_b32 s29, s55
    s_add_u32 s58, s36, tables-h_pc
    s_addc_u32 s59, s37, 0
    s_lshr_b32 s36, s35, 1
    s_and_b32 s36, s36, 4
    s_xor_b32 s36, s36, s16
    s_and_b32 s37, s34, 4
    s_xor_b32 s37, s37, s16
    s_lshl_b32 s3, s34, 4
    s_add_u32 s3, s3, s35
    v_and_b32 v4, 15, v0
    v_bfe_u32 v5, v0, 4, 2
    v_lshrrev_b32 v248, 3, v2
    v_lshlrev_b32 v248, 18, v248
    v_lshlrev_b32 v249, 1, v5
    v_xor_b32 v249, v249, v0
    v_and_b32 v249, 7, v249
    v_lshl_add_u32 v255, v249, 4, v248
    v_lshlrev_b32 v6, 16, v5
    v_lshl_add_u32 v6, v4, 4, v6
    s_lshl_b32 s60, s16, 15
    s_lshl_b32 s61, s34, 11
    s_add_u32 s60, s60, s61
    s_lshl_b32 s61, s35, 7
    s_add_u32 s60, s60, s61
    s_lshl_b32 s61, s16, 12
    s_add_u32 s61, s61, 61440
    s_lshl_b32 s64, s36, 19
    s_lshl_b32 s65, s35, 3
    s_and_b32 s66, s34, 1
    s_lshl_b32 s66, s66, 2
    s_add_u32 s65, s65, s66
    s_lshr_b32 s66, s34, 1
    s_add_u32 s65, s65, s66
    s_lshl_b32 s65, s65, 8
    s_add_u32 s64, s64, s65
    s_add_u32 s64, s64, 1048576
    s_add_u32 s65, s64, 32768
    s_add_u32 s66, s64, 262144
    s_add_u32 s67, s64, 294912
    s_barrier
    s_cmp_eq_u32 s36, 0
    s_cselect_b32 s42, 2048, 0
    v_add_u32 v248, s42, v3
    global_load_dwordx4 v[236:239], v248, s[58:59]
    global_load_dwordx4 v[240:243], v248, s[58:59] offset:1024
    s_lshr_b32 s42, s3, 4
    s_and_b32 s30, s3, 15
    s_lshl_b32 s30, s30, 4
    s_add_u32 s30, s30, s42
    s_lshr_b32 s42, s3, 3
    s_cmp_eq_u32 s42, 1
    s_cselect_b32 s42, 120, 0
    s_sub_u32 s30, s30, s42
    s_lshl_b32 s42, s16, 8
    s_add_u32 s30, s30, s42
    s_cmp_ge_u32 s16, 4
    s_cselect_b32 s42, 896, 0
    s_cmp_eq_u32 s3, 0
    s_cselect_b32 s42, s42, 0
    s_sub_u32 s30, s30, s42
    s_sub_u32 s31, 2048, s30
    s_cmp_eq_u32 s30, 0
    s_cselect_b32 s31, 1024, s31
    s_lshl_b32 s18, s30, 11
    s_lshl_b32 s19, s31, 11
    s_sub_u32 s75, s19, 2048
    s_lshl_b32 s68, s16, 12
    s_add_u32 s68, s68, 126976
    v_bfe_u32 v248, v0, 2, 1
    v_bfe_u32 v249, v0, 3, 2
    v_lshlrev_b32 v249, 2, v249
    v_lshl_add_u32 v248, v248, 4, v249
    v_and_or_b32 v248, v0, 3, v248
    v_bfe_u32 v249, v0, 5, 3
    v_cvt_f32_u32 v248, v248
    v_cvt_f32_u32 v249, v249
    s_cmp_lt_u32 s16, 4
    s_mov_b32 s42, 0x3d000000
    s_cselect_b32 s42, s42, 0x3a800000
    v_mul_f32 v248, s42, v248
    v_mul_f32 v249, 4.0, v249
    v_mul_f32 v152, v248, v249
    v_add_f32 v153, v152, v248
    v_add_f32 v154, v153, v248
    v_add_f32 v155, v154, v248
    v_sin_f32 v156, v152
    v_sin_f32 v157, v153
    v_sin_f32 v158, v154
    v_sin_f32 v159, v155
    v_cos_f32 v152, v152
    v_cos_f32 v153, v153
    v_cos_f32 v154, v154
    v_cos_f32 v155, v155
    s_cbranch_scc0 f_tw
    v_cvt_pk_f16_f32 v160, v152, v156
    v_cvt_pk_f16_f32 v156, -v156, v152
    v_mov_b32 v152, v160
    v_cvt_pk_f16_f32 v160, v153, v157
    v_cvt_pk_f16_f32 v157, -v157, v153
    v_mov_b32 v153, v160
    v_cvt_pk_f16_f32 v160, v154, v158
    v_cvt_pk_f16_f32 v158, -v158, v154
    v_mov_b32 v154, v160
    v_cvt_pk_f16_f32 v160, v155, v159
    v_cvt_pk_f16_f32 v159, -v159, v155
    v_mov_b32 v155, v160
f_tw:
    s_and_b32 s42, s16, 4
    s_add_u32 s42, s42, s16
    s_lshl_b32 s42, s42, 10
    v_add_u32 v248, s42, v3
    ds_write_b128 v248, v[152:155] offset:0
    ds_write_b128 v248, v[156:159] offset:4096
    v_lshrrev_b32 v248, 1, v4
    v_and_b32 v249, 1, v0
    v_cmp_eq_u32 vcc, 1, v4
    s_nop 1
    v_cndmask_b32_e64 v250, v248, 0, vcc
    v_cndmask_b32_e64 v248, v248, 8, vcc
    v_cndmask_b32_e64 v249, v249, 0, vcc
    v_mad_u32_u24 v251, v248, v5, v249
    v_lshlrev_b32 v251, 5, v251
    v_mad_u32_u24 v251, v250, v1, v251
    v_cvt_f32_u32 v248, v248
    v_cvt_f32_u32 v250, v250
    v_cvt_f32_u32 v251, v251
    v_mul_f32 v248, 0x3d800000, v248
    v_mul_f32 v250, 0x3b800000, v250
    v_mul_f32 v216, 0x3c000000, v251
    v_add_f32 v217, v216, v248
    v_add_f32 v218, v217, v248
    v_add_f32 v219, v218, v248
    v_add_f32 v220, v216, v250
    v_add_f32 v221, v217, v250
    v_add_f32 v222, v218, v250
    v_add_f32 v223, v219, v250
    v_cos_f32 v216, v216
    v_cos_f32 v217, v217
    v_cos_f32 v218, v218
    v_cos_f32 v219, v219
    v_cos_f32 v220, v220
    v_cos_f32 v221, v221
    v_cos_f32 v222, v222
    v_cos_f32 v223, v223
    v_lshrrev_b32 v248, 2, v2
    v_lshlrev_b32 v8, 7, v248
    v_bfe_u32 v248, v0, 3, 2
    v_lshl_add_u32 v8, v248, 5, v8
    v_and_b32 v248, 3, v0
    v_lshl_add_u32 v8, v248, 3, v8
    v_lshl_add_u32 v8, v1, 12, v8
    v_xor_b32 v9, 32, v8
    v_xor_b32 v10, 64, v8
    v_xor_b32 v11, 96, v8
    v_lshlrev_b32 v12, 13, v5
    v_lshl_add_u32 v12, v4, 4, v12
    v_lshlrev_b32 v7, 5, v5
    v_and_b32 v248, 1, v0
    v_lshl_add_u32 v7, v248, 10, v7
    v_and_b32 v248, 2, v0
    v_lshl_add_u32 v7, v248, 3, v7
    s_lshl_b32 s70, s34, 11
    s_lshl_b32 s71, s16, 7
    s_add_u32 s71, s71, s70
    s_add_u32 s71, s71, 16777216
    s_lshl_b32 s42, s16, 7
    s_add_u32 s42, s42, 94208
    v_lshlrev_b32 v213, 3, v4
    v_lshl_add_u32 v212, v5, 13, v213
    v_add_u32 v212, s42, v212
    s_lshl_b32 s42, s36, 12
    s_add_u32 s42, s42, 94208
    v_lshl_add_u32 v213, v5, 8, v213
    v_and_b32 v214, 16, v0
    v_lshl_add_u32 v213, v214, 3, v213
    v_add_u32 v213, s42, v213
    v_xor_b32 v214, 128, v213
    s_mov_b32 s4, 0x3f803f80
    s_mov_b32 s5, 0x3a800000
    s_waitcnt vmcnt(6)
    s_load_dwordx2 s[32:33], s[20:21], 0
    v_dot2_f32_bf16 v108, v64, s4, 0
    v_dot2_f32_bf16 v110, v64, v64, 0
    v_dot2_f32_bf16 v108, v65, s4, v108
    v_dot2_f32_bf16 v110, v65, v65, v110
    v_dot2_f32_bf16 v108, v66, s4, v108
    v_dot2_f32_bf16 v110, v66, v66, v110
    v_dot2_f32_bf16 v108, v67, s4, v108
    v_dot2_f32_bf16 v110, v67, v67, v110
    s_waitcnt vmcnt(5)
    v_dot2_f32_bf16 v109, v72, s4, 0
    v_dot2_f32_bf16 v111, v72, v72, 0
    v_dot2_f32_bf16 v109, v73, s4, v109
    v_dot2_f32_bf16 v111, v73, v73, v111
    v_dot2_f32_bf16 v109, v74, s4, v109
    v_dot2_f32_bf16 v111, v74, v74, v111
    v_dot2_f32_bf16 v109, v75, s4, v109
    v_dot2_f32_bf16 v111, v75, v75, v111
    s_waitcnt vmcnt(4)
    v_dot2_f32_bf16 v108, v68, s4, v108
    v_dot2_f32_bf16 v110, v68, v68, v110
    v_dot2_f32_bf16 v108, v69, s4, v108
    v_dot2_f32_bf16 v110, v69, v69, v110
    v_dot2_f32_bf16 v108, v70, s4, v108
    v_dot2_f32_bf16 v110, v70, v70, v110
    v_dot2_f32_bf16 v108, v71, s4, v108
    v_dot2_f32_bf16 v110, v71, v71, v110
    s_waitcnt vmcnt(3)
    v_dot2_f32_bf16 v109, v76, s4, v109
    v_dot2_f32_bf16 v111, v76, v76, v111
    v_dot2_f32_bf16 v109, v77, s4, v109
    v_dot2_f32_bf16 v111, v77, v77, v111
    v_dot2_f32_bf16 v109, v78, s4, v109
    v_dot2_f32_bf16 v111, v78, v78, v111
    v_dot2_f32_bf16 v109, v79, s4, v109
    v_dot2_f32_bf16 v111, v79, v79, v111
    s_nop 1
    v_permlane32_swap_b32 v108, v109
    v_permlane32_swap_b32 v110, v111
    v_add_f32 v108, v108, v109
    v_add_f32 v110, v110, v111
    s_nop 0
    v_add_f32_dpp v108, v108, v108 row_ror:8 row_mask:0xf bank_mask:0xf
    v_add_f32_dpp v110, v110, v110 row_ror:8 row_mask:0xf bank_mask:0xf
    s_nop 0
    v_add_f32_dpp v108, v108, v108 row_ror:4 row_mask:0xf bank_mask:0xf
    v_add_f32_dpp v110, v110, v110 row_ror:4 row_mask:0xf bank_mask:0xf
    s_nop 0
    v_add_f32_dpp v108, v108, v108 row_ror:2 row_mask:0xf bank_mask:0xf
    v_add_f32_dpp v110, v110, v110 row_ror:2 row_mask:0xf bank_mask:0xf
    s_nop 0
    v_add_f32_dpp v108, v108, v108 row_ror:1 row_mask:0xf bank_mask:0xf
    v_add_f32_dpp v110, v110, v110 row_ror:1 row_mask:0xf bank_mask:0xf
    s_nop 0
    v_add_f32_dpp v108, v108, v108 row_bcast:15 row_mask:0xa bank_mask:0xf
    v_add_f32_dpp v110, v110, v110 row_bcast:15 row_mask:0xa bank_mask:0xf
    v_mul_f32 v108, s5, v108
    v_mul_f32 v110, s5, v110
    v_mul_f32 v116, v108, v108
    v_cvt_pk_bf16_f32 v117, -v108, -v108
    v_sub_f32 v110, v110, v116
    v_mul_f32 v118, 0x44000000, v110
    v_cmp_gt_f32 vcc, v116, v118
    v_readlane_b32 s40, v117, 31
    s_or_b32 s41, vcc_lo, vcc_hi
    s_bitcmp1_b32 s41, 31
    s_cbranch_scc1 f_slowvar
f_var:
    v_cvt_pk_bf16_f32 v110, v110, v110
    v_lshlrev_b32 v110, 16, v110
    v_add_f32 v110, 0x3727c5ac, v110
    v_cvt_pk_bf16_f32 v110, v110, v110
    v_lshlrev_b32 v110, 16, v110
    v_sqrt_f32 v110, v110
    s_and_b32 s40, s40, 0xffff
    v_mov_b32 v114, 0xffff0000
    v_cvt_pk_bf16_f32 v110, v110, v110
    v_lshlrev_b32 v110, 16, v110
    v_mul_f32 v110, 0x41800000, v110
    v_and_or_b32 v114, v117, v114, s40
    v_rcp_f32 v113, v110
    s_waitcnt lgkmcnt(0)
    s_cmp_lg_u32 s32, 0
    s_cbranch_scc1 f_nnx
    s_load_dwordx2 s[32:33], s[20:21], 64
    s_mov_b32 s83, 0
    v_mov_b32 v122, 0
    s_waitcnt lgkmcnt(0)
f_nn:
    s_cmp_lg_u32 s32, 0
    s_cbranch_scc1 f_nnx
    global_load_dwordx2 v[120:121], v122, s[20:21] sc1
    s_waitcnt vmcnt(0)
    v_readfirstlane_b32 s32, v120
    v_readfirstlane_b32 s33, v121
    s_add_u32 s83, s83, 1
    s_cmp_lt_u32 s83, 0x40000
    s_cbranch_scc1 f_nn
f_nnx:
    v_mov_b32 v115, s32
    v_mov_b32_dpp v112, v113 row_bcast:31 row_mask:0xc bank_mask:0xf
    v_mov_b32 v116, 0
    s_mov_b32 exec_lo, 0
    s_mov_b32 exec_hi, 0x80000000
    buffer_store_dwordx4 v[112:115], v116, s[12:15], s62 offen
    v_lshlrev_b32 v117, 4, v1
    v_add_u32 v117, 160768, v117
    ds_write_b128 v117, v[112:115]
    s_mov_b64 exec, -1
    s_mov_b32 m0, s61
    s_add_u32 s42, s60, 0
    s_add_u32 s61, s61, 1024
    buffer_load_dwordx4 v255, s[8:11], s42 offen lds
    s_mov_b32 m0, s61
    s_add_u32 s42, s60, 2097152
    s_add_u32 s61, s61, 1024
    buffer_load_dwordx4 v255, s[8:11], s42 offen lds
    s_mov_b32 m0, s61
    s_add_u32 s42, s60, 16384
    s_add_u32 s61, s61, 1024
    buffer_load_dwordx4 v255, s[8:11], s42 offen lds
    s_mov_b32 m0, s61
    s_add_u32 s42, s60, 2113536
    s_add_u32 s61, s61, 1024
    buffer_load_dwordx4 v255, s[8:11], s42 offen lds
    v_add_u32 v248, s68, v3
    ds_write_b128 v248, v[64:67] offset:0
    ds_write_b128 v248, v[68:71] offset:1024
    v_mov_b32 v244, s32
    v_mov_b32 v245, s33
    v_and_b32 v248, 4, v0
    v_cmp_eq_u32 vcc, 4, v248
    v_and_b32 v248, 3, v0
    v_lshlrev_b32 v248, 2, v248
    v_cndmask_b32 v244, v244, v245, vcc
    v_lshrrev_b32 v244, v248, v244
    s_mov_b32 s54, 0x00010001
    s_mov_b32 s55, 0xfffefffe
    s_mov_b32 s46, 0x05040100
    s_mov_b32 s47, 0x07060302
    v_lshrrev_b32 v245, 1, v244
    v_lshrrev_b32 v246, 2, v244
    v_lshrrev_b32 v247, 3, v244
    v_and_b32 v244, s54, v244
    v_and_b32 v245, s54, v245
    v_and_b32 v246, s54, v246
    v_and_b32 v247, s54, v247
    s_waitcnt vmcnt(2)
    s_mov_b32 exec_lo, 0x000f000f
    s_mov_b32 exec_hi, 0x000f000f
    buffer_load_dwordx4 v[24:27], v7, s[12:15], s71 offen sc1
    s_mov_b64 exec, -1
    s_mov_b32 s83, 0
    s_waitcnt vmcnt(1)
    ds_read_b64_tr_b16 v[40:41], v8 offset:61440
    ds_read_b64_tr_b16 v[42:43], v9 offset:61440
    ds_read_b64_tr_b16 v[44:45], v10 offset:61440
    ds_read_b64_tr_b16 v[46:47], v11 offset:61440
    ds_read_b64_tr_b16 v[48:49], v8 offset:63488
    ds_read_b64_tr_b16 v[50:51], v9 offset:63488
    ds_read_b64_tr_b16 v[52:53], v10 offset:63488
    ds_read_b64_tr_b16 v[54:55], v11 offset:63488
    s_mov_b32 exec_lo, 0x000f000f
    s_mov_b32 exec_hi, 0x000f000f
f_st:
    s_waitcnt vmcnt(0)
    v_cmp_ne_u32 vcc, s32, v27
    s_mov_b64 exec, -1
    s_cbranch_vccnz f_str
f_stx:
    s_setprio 3
    v_mov_b32_dpp v32, v26 row_newbcast:0 row_mask:0xf bank_mask:0xf
    v_mov_b32_dpp v33, v26 row_newbcast:1 row_mask:0xf bank_mask:0xf
    v_mov_b32_dpp v34, v26 row_newbcast:2 row_mask:0xf bank_mask:0xf
    v_mov_b32_dpp v35, v26 row_newbcast:3 row_mask:0xf bank_mask:0xf
    v_mul_f32_dpp v216, v24, v216 row_newbcast:0 row_mask:0xf bank_mask:0xf
    v_mul_f32_dpp v217, v24, v217 row_newbcast:1 row_mask:0xf bank_mask:0xf
    v_mul_f32_dpp v218, v24, v218 row_newbcast:2 row_mask:0xf bank_mask:0xf
    v_mul_f32_dpp v219, v24, v219 row_newbcast:3 row_mask:0xf bank_mask:0xf
    v_perm_b32 v28, v33, v32, s46
    v_perm_b32 v29, v35, v34, s46
    v_cvt_pk_bf16_f32 v224, v216, v217
    v_cvt_pk_bf16_f32 v225, v218, v219
    s_nop 1
    v_mfma_f32_16x16x16_bf16 v[228:231], v[224:225], v[28:29], 0
    v_mul_f32_dpp v220, v25, v220 row_newbcast:0 row_mask:0xf bank_mask:0xf
    v_mul_f32_dpp v221, v25, v221 row_newbcast:1 row_mask:0xf bank_mask:0xf
    v_mul_f32_dpp v222, v25, v222 row_newbcast:2 row_mask:0xf bank_mask:0xf
    v_mul_f32_dpp v223, v25, v223 row_newbcast:3 row_mask:0xf bank_mask:0xf
    v_perm_b32 v30, v33, v32, s47
    v_perm_b32 v31, v35, v34, s47
    v_cvt_pk_bf16_f32 v226, v220, v221
    v_cvt_pk_bf16_f32 v227, v222, v223
    s_nop 1
    v_mfma_f32_16x16x16_bf16 v[232:235], v[226:227], v[30:31], 0
    s_waitcnt lgkmcnt(0)
    v_mfma_f32_16x16x16_bf16 v[56:59], v[224:225], v[40:41], v[228:231]
    v_mfma_f32_16x16x16_bf16 v[60:63], v[226:227], v[48:49], v[232:235]
    v_mfma_f32_16x16x16_bf16 v[64:67], v[224:225], v[42:43], v[228:231]
    v_mfma_f32_16x16x16_bf16 v[68:71], v[226:227], v[50:51], v[232:235]
    s_mov_b32 m0, s68
    s_cmp_eq_u32 s34, 0
    s_cbranch_scc1 f_r0
f_nr:
    buffer_load_dwordx4 v3, s[8:11], s75 offen offset:2048 lds
    buffer_load_dwordx4 v3, s[8:11], s75 offen offset:3072 lds
    v_mfma_f32_16x16x16_bf16 v[72:75], v[224:225], v[44:45], v[228:231]
    v_mfma_f32_16x16x16_bf16 v[76:79], v[226:227], v[52:53], v[232:235]
    v_cvt_pk_f16_f32 v184, v56, v57
    v_cvt_pk_f16_f32 v185, v60, v61
    ds_write_b64 v212, v[184:185] offset:0
    v_cvt_pk_f16_f32 v186, v58, v59
    v_cvt_pk_f16_f32 v187, v62, v63
    ds_write_b64 v212, v[186:187] offset:4096
    v_mfma_f32_16x16x16_bf16 v[80:83], v[224:225], v[46:47], v[228:231]
    v_mfma_f32_16x16x16_bf16 v[84:87], v[226:227], v[54:55], v[232:235]
    v_cvt_pk_f16_f32 v188, v64, v65
    v_cvt_pk_f16_f32 v189, v68, v69
    ds_write_b64 v212, v[188:189] offset:1024
    v_cvt_pk_f16_f32 v190, v66, v67
    v_cvt_pk_f16_f32 v191, v70, v71
    ds_write_b64 v212, v[190:191] offset:5120
    v_cvt_pk_f16_f32 v192, v72, v73
    v_cvt_pk_f16_f32 v193, v76, v77
    ds_write_b64 v212, v[192:193] offset:2048
    v_cvt_pk_f16_f32 v194, v74, v75
    v_cvt_pk_f16_f32 v195, v78, v79
    ds_write_b64 v212, v[194:195] offset:6144
    v_cvt_pk_f16_f32 v196, v80, v81
    v_cvt_pk_f16_f32 v197, v84, v85
    ds_write_b64 v212, v[196:197] offset:3072
    v_cvt_pk_f16_f32 v198, v82, v83
    v_cvt_pk_f16_f32 v199, v86, v87
    ds_write_b64 v212, v[198:199] offset:7168
    s_waitcnt lgkmcnt(0)
    s_barrier
    ds_read_b64 v[152:153], v213 offset:0
    ds_read_b64 v[154:155], v214 offset:0
    ds_read_b64 v[156:157], v213 offset:1024
    ds_read_b64 v[158:159], v214 offset:1024
    ds_read_b64 v[160:161], v213 offset:2048
    ds_read_b64 v[162:163], v214 offset:2048
    ds_read_b64 v[164:165], v213 offset:3072
    ds_read_b64 v[166:167], v214 offset:3072
    s_waitcnt lgkmcnt(6)
    v_mfma_f32_16x16x32_f16 v[56:59], v[236:239], v[152:155], 0
    s_waitcnt lgkmcnt(4)
    v_mfma_f32_16x16x32_f16 v[60:63], v[236:239], v[156:159], 0
    s_waitcnt lgkmcnt(2)
    v_mfma_f32_16x16x32_f16 v[64:67], v[236:239], v[160:163], 0
    s_waitcnt lgkmcnt(0)
    v_mfma_f32_16x16x32_f16 v[68:71], v[236:239], v[164:167], 0
    v_mfma_f32_16x16x32_f16 v[72:75], v[240:243], v[152:155], 0
    v_mfma_f32_16x16x32_f16 v[76:79], v[240:243], v[156:159], 0
    v_mfma_f32_16x16x32_f16 v[80:83], v[240:243], v[160:163], 0
    v_mfma_f32_16x16x32_f16 v[84:87], v[240:243], v[164:167], 0
    v_cvt_pk_f16_f32 v184, v56, v57
    v_cvt_pk_f16_f32 v185, v60, v61
    v_cvt_pk_f16_f32 v186, v64, v65
    s_nop 0
    v_cvt_pk_f16_f32 v187, v68, v69
    v_and_or_b32 v184, v184, s55, v244
    v_and_or_b32 v185, v185, s55, v245
    v_and_or_b32 v186, v186, s55, v246
    v_and_or_b32 v187, v187, s55, v247
    buffer_store_dwordx4 v[184:187], v6, s[12:15], s64 offen sc1
    v_cvt_pk_f16_f32 v188, v58, v59
    v_cvt_pk_f16_f32 v189, v62, v63
    v_cvt_pk_f16_f32 v190, v66, v67
    v_cvt_pk_f16_f32 v191, v70, v71
    v_and_or_b32 v188, v188, s55, v244
    v_and_or_b32 v189, v189, s55, v245
    v_and_or_b32 v190, v190, s55, v246
    v_and_or_b32 v191, v191, s55, v247
    buffer_store_dwordx4 v[188:191], v6, s[12:15], s65 offen sc1
    v_cvt_pk_f16_f32 v192, v72, v73
    v_cvt_pk_f16_f32 v193, v76, v77
    v_cvt_pk_f16_f32 v194, v80, v81
    v_cvt_pk_f16_f32 v195, v84, v85
    v_and_or_b32 v192, v192, s55, v244
    v_and_or_b32 v193, v193, s55, v245
    v_and_or_b32 v194, v194, s55, v246
    v_and_or_b32 v195, v195, s55, v247
    buffer_store_dwordx4 v[192:195], v6, s[12:15], s66 offen sc1
    v_cvt_pk_f16_f32 v196, v74, v75
    v_cvt_pk_f16_f32 v197, v78, v79
    v_cvt_pk_f16_f32 v198, v82, v83
    v_cvt_pk_f16_f32 v199, v86, v87
    v_and_or_b32 v196, v196, s55, v244
    v_and_or_b32 v197, v197, s55, v245
    v_and_or_b32 v198, v198, s55, v246
    v_and_or_b32 v199, v199, s55, v247
    buffer_store_dwordx4 v[196:199], v6, s[12:15], s67 offen sc1
    s_setprio 0
    s_mov_b32 s43, 0
    s_lshr_b32 s42, s3, 4
    s_and_b32 s40, s3, 15
    s_lshl_b32 s40, s40, 4
    s_add_u32 s40, s40, s42
    s_lshr_b32 s42, s3, 3
    s_cmp_eq_u32 s42, 1
    s_cselect_b32 s42, 120, 0
    s_sub_u32 s40, s40, s42
    s_lshl_b32 s42, s43, 8
    s_add_u32 s40, s40, s42
    s_cmp_ge_u32 s43, 4
    s_cselect_b32 s42, 896, 0
    s_cmp_eq_u32 s3, 0
    s_cselect_b32 s42, s42, 0
    s_sub_u32 s40, s40, s42
    v_lshrrev_b32 v248, 1, v4
    v_and_b32 v249, 1, v0
    v_lshlrev_b32 v250, 8, v248
    v_add_u32 v250, s40, v250
    s_cmp_lg_u32 s3, 0
    s_cbranch_scc1 f_a3n
    v_cmp_lt_u32 s[44:45], 3, v248
    v_subrev_u32 v251, 896, v250
    s_nop 0
    v_cndmask_b32 v250, v250, v251, s[44:45]
    v_cmp_eq_u32 vcc, 1, v4
    v_mov_b32 v251, 1024
    s_nop 0
    v_cndmask_b32 v250, v250, v251, vcc
    v_cndmask_b32_e64 v249, v249, 0, vcc
f_a3n:
    v_lshlrev_b32 v251, 1, v5
    v_mul_u32_u24 v251, v251, v250
    v_lshl_add_u32 v251, v249, 9, v251
    v_add_u32 v253, v251, v250
    v_add_u32 v252, 1536, v251
    v_add_u32 v254, 1536, v253
    v_and_b32 v251, 2047, v251
    v_and_b32 v252, 2047, v252
    v_and_b32 v253, 2047, v253
    v_and_b32 v254, 2047, v254
    v_cvt_f32_u32 v251, v251
    v_cvt_f32_u32 v252, v252
    v_cvt_f32_u32 v253, v253
    v_cvt_f32_u32 v254, v254
    v_mul_f32 v251, 0x3a000000, v251
    v_mul_f32 v252, 0x3a000000, v252
    v_mul_f32 v253, 0x3a000000, v253
    v_mul_f32 v254, 0x3a000000, v254
    v_cos_f32 v251, v251
    v_cos_f32 v252, v252
    v_cos_f32 v253, v253
    v_cos_f32 v254, v254
    s_cbranch_scc1 f_a3m
    v_cmp_gt_u32 vcc, 2, v4
    s_nop 1
    v_cndmask_b32_e64 v249, 1.0, 0.5, vcc
    v_mul_f32 v251, v251, v249
    v_mul_f32 v253, v253, v249
    v_cndmask_b32 v252, 0, v251, s[44:45]
    v_cndmask_b32 v254, 0, v253, s[44:45]
    v_cndmask_b32 v251, v251, 0, s[44:45]
    v_cndmask_b32 v253, v253, 0, s[44:45]
f_a3m:
    v_cvt_pk_f16_f32 v22, v251, v252
    v_cvt_pk_f16_f32 v23, v253, v254
    v_and_b32 v248, 3, v0
    v_bfe_u32 v249, v0, 2, 1
    v_bfe_u32 v250, v0, 3, 2
    v_bfe_u32 v251, v0, 5, 1
    v_lshlrev_b32 v13, 10, v249
    v_lshlrev_b32 v15, 11, v249
    v_lshl_add_u32 v15, v251, 8, v15
    v_lshl_add_u32 v15, v250, 6, v15
    v_lshl_add_u32 v15, v248, 4, v15
    v_lshl_add_u32 v13, v250, 8, v13
    v_lshl_add_u32 v13, v248, 6, v13
    v_lshl_add_u32 v13, v251, 5, v13
    v_xor_b32 v14, 2016, v13
    v_add_u32 v13, s68, v13
    v_add_u32 v14, s68, v14
    s_waitcnt vmcnt(4)
    ds_read_b128 v[200:203], v13 offset:0
    ds_read_b128 v[204:207], v13 offset:16
    ds_read_b128 v[208:211], v14 offset:2048
    ds_read_b128 v[212:215], v14 offset:2064
    s_lshl_b32 s72, s3, 15
    s_lshl_b32 s73, s37, 12
    s_add_u32 s72, s72, s73
    s_add_u32 s72, s72, 1048576
    s_waitcnt lgkmcnt(0)
    ds_read_b128 v[88:91], v3 offset:0
    ds_read_b128 v[92:95], v3 offset:1024
    ds_read_b128 v[96:99], v3 offset:2048
    ds_read_b128 v[100:103], v3 offset:3072
    ds_read_b128 v[104:107], v3 offset:4096
    ds_read_b128 v[108:111], v3 offset:5120
    ds_read_b128 v[112:115], v3 offset:6144
    ds_read_b128 v[116:119], v3 offset:7168
    ds_read_b128 v[120:123], v3 offset:8192
    ds_read_b128 v[124:127], v3 offset:9216
    ds_read_b128 v[128:131], v3 offset:10240
    ds_read_b128 v[132:135], v3 offset:11264
    ds_read_b128 v[136:139], v3 offset:12288
    ds_read_b128 v[140:143], v3 offset:13312
    ds_read_b128 v[144:147], v3 offset:14336
    ds_read_b128 v[148:151], v3 offset:15360
    v_lshlrev_b32 v152, 16, v200
    v_and_b32 v153, 0xffff0000, v200
    v_lshlrev_b32 v154, 16, v201
    v_and_b32 v155, 0xffff0000, v201
    v_lshlrev_b32 v156, 16, v202
    v_and_b32 v157, 0xffff0000, v202
    v_lshlrev_b32 v158, 16, v203
    v_and_b32 v159, 0xffff0000, v203
    v_lshlrev_b32 v160, 16, v204
    v_and_b32 v161, 0xffff0000, v204
    v_lshlrev_b32 v162, 16, v205
    v_and_b32 v163, 0xffff0000, v205
    v_lshlrev_b32 v164, 16, v206
    v_and_b32 v165, 0xffff0000, v206
    v_lshlrev_b32 v166, 16, v207
    v_and_b32 v167, 0xffff0000, v207
    v_lshlrev_b32 v168, 16, v208
    v_and_b32 v183, 0xffff0000, v208
    v_lshlrev_b32 v182, 16, v209
    v_and_b32 v181, 0xffff0000, v209
    v_lshlrev_b32 v180, 16, v210
    v_and_b32 v179, 0xffff0000, v210
    v_lshlrev_b32 v178, 16, v211
    v_and_b32 v177, 0xffff0000, v211
    v_lshlrev_b32 v176, 16, v212
    v_and_b32 v175, 0xffff0000, v212
    v_lshlrev_b32 v174, 16, v213
    v_and_b32 v173, 0xffff0000, v213
    v_lshlrev_b32 v172, 16, v214
    v_and_b32 v171, 0xffff0000, v214
    v_lshlrev_b32 v170, 16, v215
    v_and_b32 v169, 0xffff0000, v215
    s_waitcnt vmcnt(0)
    s_barrier
    buffer_load_dwordx4 v[24:27], v3, s[12:15], s72 offen offset:0 sc1
    buffer_load_dwordx4 v[28:31], v3, s[12:15], s72 offen offset:1024 sc1
    buffer_load_dwordx4 v[32:35], v3, s[12:15], s72 offen offset:2048 sc1
    buffer_load_dwordx4 v[36:39], v3, s[12:15], s72 offen offset:3072 sc1
    s_lshl_b32 s80, s3, 7
    s_add_u32 s80, s80, 17039360
    s_cmp_lg_u32 s16, 0
    s_cbranch_scc1 f_sb2
    v_add_u32 v84, 160768, v3
    s_mov_b64 exec, 0xff
    ds_read_b128 v[80:83], v84
    s_waitcnt lgkmcnt(0)
    buffer_store_dwordx4 v[80:83], v3, s[12:15], s63 offen sc1
    s_mov_b64 exec, -1
    v_lshrrev_b32 v18, 3, v2
    v_lshlrev_b32 v18, 14, v18
    v_and_b32 v248, 0x70, v3
    v_add_u32 v18, v18, v248
    v_not_b32 v249, s32
    v_not_b32 v251, s33
    buffer_store_dwordx4 v[248:251], v18, s[12:15], s80 offen sc1
f_sb2:
    v_lshlrev_b32 v18, 14, v2
    v_xor_b32 v16, 2544, v15
    v_subrev_u32 v248, s68, v13
    v_add_u32 v248, 32, v248
    v_bfe_u32 v19, v248, 5, 1
    v_lshlrev_b32 v19, 5, v19
    v_bfe_u32 v249, v248, 8, 2
    v_lshl_add_u32 v19, v249, 3, v19
    v_bfe_u32 v249, v248, 10, 1
    v_lshl_add_u32 v19, v249, 2, v19
    v_bfe_u32 v249, v248, 6, 2
    v_add_lshl_u32 v19, v249, v19, 2
    s_lshl_b32 s74, s34, 14
    s_add_u32 s74, s74, 17039360
    s_lshl_b32 s42, s37, 9
    s_add_u32 s42, s42, 61440
    v_add_u32 v12, s42, v12
    s_mul_i32 s17, s34, 7
    s_lshr_b32 s42, s35, 1
    s_add_u32 s17, s17, s42
    s_lshl_b32 s42, s17, 6
    s_lshr_b32 s43, s16, 2
    s_lshl_b32 s43, s43, 5
    s_add_u32 s42, s42, s43
    s_and_b32 s43, s16, 1
    s_lshl_b32 s43, s43, 4
    s_add_u32 s42, s42, s43
    s_and_b32 s43, s16, 2
    s_lshl_b32 s43, s43, 1
    s_add_u32 s42, s42, s43
    s_lshl_b32 s38, s42, 11
    s_and_b32 s43, s35, 1
    s_lshl_b32 s43, s43, 10
    s_add_u32 s38, s38, s43
    s_lshl_b32 s39, s16, 13
    s_add_u32 s39, s39, 94208
    s_mov_b32 s48, s28
    s_mov_b32 s49, s29
    s_mov_b32 s50, 7340032
    s_mov_b32 s51, 0x00020000
    s_bfe_u32 s4, s32, 524288
    s_bfe_u32 s5, s32, 524296
    s_bfe_u32 s6, s32, 524304
    s_bfe_u32 s7, s32, 524312
    s_bfe_u32 s8, s33, 524288
    s_bfe_u32 s9, s33, 524296
    s_bfe_u32 s10, s33, 524304
    s_bfe_u32 s11, s33, 524312
    v_lshlrev_b32 v17, 7, v4
    s_and_b32 s40, s16, 3
    s_lshl_b32 s76, s40, 10
    v_add_u32 v4, s76, v3
    v_xor_b32 v6, 1008, v3
    s_sub_u32 s42, 4096, s76
    s_and_b32 s42, s42, 3072
    v_add_u32 v5, s42, v6
    s_sub_u32 s42, 3072, s76
    v_add_u32 v6, s42, v6
    v_subrev_u32 v248, s68, v13
    v_lshrrev_b32 v248, 1, v248
    s_lshl_b32 s42, s40, 2
    v_add_u32 v248, s42, v248
    v_bfe_u32 v235, v248, 7, 1
    v_lshlrev_b32 v235, 9, v235
    v_and_b32 v249, 31, v248
    v_lshl_add_u32 v235, v249, 4, v235
    v_bfe_u32 v249, v248, 8, 1
    v_lshl_add_u32 v235, v249, 3, v235
    v_lshrrev_b32 v249, 9, v248
    v_lshl_add_u32 v235, v249, 10, v235
    v_bfe_u32 v249, v248, 5, 2
    v_lshl_add_u32 v235, v249, 1, v235
    v_mov_b32 v8, s32
    v_mov_b32 v9, s33
    v_and_b32 v10, 1, v0
    v_cmp_eq_u32 vcc, 1, v10
    s_nop 1
    v_cndmask_b32 v8, v8, v9, vcc
    v_bfe_u32 v9, v8, 8, 8
    v_bfe_u32 v10, v8, 16, 8
    v_lshrrev_b32 v11, 24, v8
    v_and_b32 v8, 0xff, v8
    s_add_u32 s76, s76, 16875520
    s_mov_b32 s77, 16850944
    s_xor_b32 s79, s35, 1
    s_xor_b32 s43, s16, 5
    s_or_b32 s79, s79, s43
    s_cmp_ge_u32 s16, 4
    s_cselect_b32 s64, 4, 1
    s_cselect_b32 s65, 3, 2
    s_lshl_b32 s64, s64, 12
    s_lshl_b32 s65, s65, 12
    s_add_u32 s64, s64, s76
    s_add_u32 s65, s65, s76
    s_lshl_b32 s42, s16, 12
    s_add_u32 s42, s42, 61440
    v_add_u32 v7, s42, v3
    s_cmp_eq_u32 s3, 0
    s_cselect_b64 s[52:53], -1, 1
    v_mov_b32 v192, v8
    v_mov_b32 v193, v9
    v_mov_b32 v194, v10
    v_mov_b32 v195, v11
    s_waitcnt vmcnt(3)
    buffer_load_dwordx4 v[184:187], v3, s[12:15], s64 offen sc1
    buffer_load_dwordx4 v[188:191], v3, s[12:15], s65 offen sc1
    s_mov_b64 exec, 0xffff
    buffer_load_dwordx4 v[236:239], v17, s[12:15], s77 offen sc1
    s_mov_b64 exec, s[52:53]
    buffer_load_dwordx4 v[192:195], v3, s[12:15], s76 offen sc1
    s_mov_b64 exec, -1
    s_mov_b32 s83, 0
    s_waitcnt vmcnt(6)
f_zc:
    v_xor_b32 v40, v24, v244
    v_xor_b32 v41, v28, v244
    v_xor_b32 v42, v25, v245
    v_xor_b32 v43, v29, v245
    v_xor_b32 v44, v26, v246
    v_xor_b32 v45, v30, v246
    v_xor_b32 v46, v27, v247
    v_xor_b32 v47, v31, v247
    v_mfma_f32_16x16x16_f16 v[56:59], v[22:23], v[40:41], 0
    v_or3_b32 v248, v40, v41, 0
    v_mfma_f32_16x16x16_f16 v[64:67], v[22:23], v[44:45], 0
    v_or3_b32 v248, v44, v45, v248
    v_mfma_f32_16x16x16_f16 v[60:63], v[22:23], v[42:43], 0
    v_or3_b32 v248, v42, v43, v248
    v_mfma_f32_16x16x16_f16 v[68:71], v[22:23], v[46:47], 0
    v_or3_b32 v248, v46, v47, v248
    s_waitcnt vmcnt(4)
    v_xor_b32 v48, v32, v244
    v_xor_b32 v49, v36, v244
    v_xor_b32 v50, v33, v245
    v_xor_b32 v51, v37, v245
    v_xor_b32 v52, v34, v246
    v_xor_b32 v53, v38, v246
    v_xor_b32 v54, v35, v247
    v_xor_b32 v55, v39, v247
    v_mfma_f32_16x16x16_f16 v[72:75], v[22:23], v[48:49], 0
    v_or3_b32 v248, v48, v49, v248
    v_mfma_f32_16x16x16_f16 v[80:83], v[22:23], v[52:53], 0
    v_or3_b32 v248, v52, v53, v248
    v_mfma_f32_16x16x16_f16 v[76:79], v[22:23], v[50:51], 0
    v_or3_b32 v248, v50, v51, v248
    v_mfma_f32_16x16x16_f16 v[84:87], v[22:23], v[54:55], 0
    v_or3_b32 v248, v54, v55, v248
    v_and_b32 v248, s54, v248
    v_cmp_ne_u32 vcc, 0, v248
    s_cbranch_vccnz f_zr
f_zx:
    v_cvt_pk_f16_f32 v24, v56, v57
    v_cvt_pk_f16_f32 v25, v64, v65
    v_cvt_pk_f16_f32 v26, v72, v73
    v_cvt_pk_f16_f32 v27, v80, v81
    ds_write_b128 v12, v[24:27] offset:0
    v_cvt_pk_f16_f32 v28, v58, v59
    v_cvt_pk_f16_f32 v29, v66, v67
    v_cvt_pk_f16_f32 v30, v74, v75
    v_cvt_pk_f16_f32 v31, v82, v83
    ds_write_b128 v12, v[28:31] offset:4096
    v_cvt_pk_f16_f32 v32, v60, v61
    v_cvt_pk_f16_f32 v33, v68, v69
    v_cvt_pk_f16_f32 v34, v76, v77
    v_cvt_pk_f16_f32 v35, v84, v85
    ds_write_b128 v12, v[32:35] offset:256
    v_cvt_pk_f16_f32 v36, v62, v63
    v_cvt_pk_f16_f32 v37, v70, v71
    v_cvt_pk_f16_f32 v38, v78, v79
    v_cvt_pk_f16_f32 v39, v86, v87
    ds_write_b128 v12, v[36:39] offset:4352
    s_mov_b32 s83, 0
    s_waitcnt vmcnt(0)
f_pv:
    v_xor_b32 v184, v8, v184
    v_xor_b32 v185, v9, v185
    v_xor_b32 v186, v10, v186
    v_xor_b32 v187, v11, v187
    v_xor_b32 v188, v8, v188
    v_xor_b32 v189, v9, v189
    v_xor_b32 v190, v10, v190
    v_xor_b32 v191, v11, v191
    v_xor_b32 v192, v8, v192
    v_xor_b32 v193, v9, v193
    v_xor_b32 v194, v10, v194
    v_xor_b32 v195, v11, v195
    v_or3_b32 v248, v184, v185, 0
    v_or3_b32 v248, v186, v187, v248
    v_or3_b32 v248, v188, v189, v248
    v_or3_b32 v248, v190, v191, v248
    v_or3_b32 v248, v192, v193, v248
    v_or3_b32 v248, v194, v195, v248
    v_cmp_ne_u64 s[44:45], s[32:33], v[236:237]
    v_and_b32 v248, 0xff, v248
    v_cmp_ne_u32 vcc, 0, v248
    v_add_f32_dpp v239, v238, v238 quad_perm:[1,0,3,2] row_mask:0xf bank_mask:0xf
    s_and_b32 s44, s44, 0xffff
    s_or_b32 vcc_lo, vcc_lo, s44
    s_cbranch_vccnz f_pr
f_pw:
    v_add_f32_dpp v239, v239, v239 quad_perm:[2,3,0,1] row_mask:0xf bank_mask:0xf
    s_cmp_ge_u32 s16, 4
    s_cbranch_scc1 f_ph
    v_max_f32_dpp v238, v238, v238 quad_perm:[1,0,3,2] row_mask:0xf bank_mask:0xf
    s_nop 1
    v_max_f32_dpp v238, v238, v238 quad_perm:[2,3,0,1] row_mask:0xf bank_mask:0xf
    s_nop 1
    v_max_f32_dpp v238, v238, v238 row_half_mirror row_mask:0xf bank_mask:0xf
    v_frexp_exp_i32_f32 v238, v238
    s_nop 0
    v_readfirstlane_b32 s42, v238
    s_sub_u32 s43, -1, s42
    s_add_u32 s44, s42, 5
    s_sub_u32 s45, 5, s42
    v_ldexp_f32 v184, v184, s43
    v_ldexp_f32 v185, v185, s43
    v_ldexp_f32 v186, v186, s43
    v_ldexp_f32 v187, v187, s43
    v_cvt_pk_f16_f32 v184, v184, v185
    v_cvt_pk_f16_f32 v186, v186, v187
    ds_write_b16 v235, v184 offset:16384
    ds_write_b16_d16_hi v235, v184 offset:16400
    ds_write_b16 v235, v186 offset:16416
    ds_write_b16_d16_hi v235, v186 offset:16432
    v_ldexp_f32 v188, v188, s44
    v_ldexp_f32 v189, v189, s44
    v_ldexp_f32 v190, v190, s44
    v_ldexp_f32 v191, v191, s44
    ds_write_b128 v4, v[188:191] offset:20480
    ds_write_b32 v5, v188 offset:24576
    ds_write_b32 v6, v189 offset:24588
    ds_write_b32 v6, v190 offset:24584
    ds_write_b32 v6, v191 offset:24580
    s_cmp_lg_u32 s3, 0
    s_cbranch_scc1 f_pvx
    v_ldexp_f32 v192, v192, s45
    v_ldexp_f32 v193, v193, s45
    v_ldexp_f32 v194, v194, s45
    v_ldexp_f32 v195, v195, s45
    v_and_b32 v248, 0x3f0, v235
    v_bfe_u32 v249, v235, 10, 1
    v_lshl_add_u32 v248, v249, 11, v248
    v_bfe_u32 v249, v235, 3, 1
    v_lshl_add_u32 v248, v249, 10, v248
    v_and_b32 v249, 6, v235
    v_lshl_add_u32 v248, v249, 1, v248
    v_cvt_f16_f32 v192, v192
    ds_write_b32 v248, v192 offset:0
    v_cvt_f16_f32 v193, v193
    ds_write_b32 v248, v193 offset:16
    v_cvt_f16_f32 v194, v194
    ds_write_b32 v248, v194 offset:32
    v_cvt_f16_f32 v195, v195
    ds_write_b32 v248, v195 offset:48
    s_branch f_pvx
f_ph:
    ds_write_b128 v4, v[184:187] offset:28672
    ds_write_b32 v5, v184 offset:32768
    ds_write_b32 v6, v185 offset:32780
    ds_write_b32 v6, v186 offset:32776
    ds_write_b32 v6, v187 offset:32772
    ds_write_b128 v4, v[188:191] offset:36864
    ds_write_b32 v5, v188 offset:40960
    ds_write_b32 v6, v189 offset:40972
    ds_write_b32 v6, v190 offset:40968
    ds_write_b32 v6, v191 offset:40964
f_pvx:
    v_readlane_b32 s66, v239, 12
    s_waitcnt lgkmcnt(0)
    s_barrier
    ds_read_b128 v[248:251], v3 offset:16384
    ds_read_b128 v[24:27], v7 offset:0
    ds_read_b128 v[28:31], v7 offset:1024
    ds_read_b128 v[252:255], v3 offset:17408
    ds_read_b128 v[32:35], v7 offset:2048
    ds_read_b128 v[36:39], v7 offset:3072
    s_cmp_eq_u32 s30, 0
    s_cbranch_scc1 f_sp
    s_waitcnt lgkmcnt(4)
    v_pk_mul_f16 v40, v24, v248 op_sel:[0,0] op_sel_hi:[1,0]
    v_pk_mul_f16 v41, v25, v248 op_sel:[0,1] op_sel_hi:[1,1]
    v_pk_mul_f16 v42, v26, v249 op_sel:[0,0] op_sel_hi:[1,0]
    v_pk_mul_f16 v43, v27, v249 op_sel:[0,1] op_sel_hi:[1,1]
    s_nop 1
    v_mfma_f32_32x32x16_f16 v[56:71], v[40:43], v[88:91], 0
    s_waitcnt lgkmcnt(3)
    v_pk_mul_f16 v44, v28, v250 op_sel:[0,0] op_sel_hi:[1,0]
    v_pk_mul_f16 v45, v29, v250 op_sel:[0,1] op_sel_hi:[1,1]
    v_pk_mul_f16 v46, v30, v251 op_sel:[0,0] op_sel_hi:[1,0]
    v_pk_mul_f16 v47, v31, v251 op_sel:[0,1] op_sel_hi:[1,1]
    v_mfma_f32_32x32x16_f16 v[72:87], v[40:43], v[104:107], 0
    s_waitcnt lgkmcnt(1)
    v_pk_mul_f16 v48, v32, v252 op_sel:[0,0] op_sel_hi:[1,0]
    v_pk_mul_f16 v49, v33, v252 op_sel:[0,1] op_sel_hi:[1,1]
    v_pk_mul_f16 v50, v34, v253 op_sel:[0,0] op_sel_hi:[1,0]
    v_pk_mul_f16 v51, v35, v253 op_sel:[0,1] op_sel_hi:[1,1]
    v_mfma_f32_32x32x16_f16 v[56:71], v[44:47], v[92:95], v[56:71]
    s_waitcnt lgkmcnt(0)
    v_pk_mul_f16 v52, v36, v254 op_sel:[0,0] op_sel_hi:[1,0]
    v_pk_mul_f16 v53, v37, v254 op_sel:[0,1] op_sel_hi:[1,1]
    v_pk_mul_f16 v54, v38, v255 op_sel:[0,0] op_sel_hi:[1,0]
    v_pk_mul_f16 v55, v39, v255 op_sel:[0,1] op_sel_hi:[1,1]
    v_mfma_f32_32x32x16_f16 v[72:87], v[44:47], v[108:111], v[72:87]
f_st1:
    v_mfma_f32_32x32x16_f16 v[56:71], v[48:51], v[96:99], v[56:71]
    ds_read_b128 v[184:187], v3 offset:20480
    ds_read_b128 v[188:191], v3 offset:21504
    v_mfma_f32_32x32x16_f16 v[72:87], v[48:51], v[112:115], v[72:87]
    ds_read_b128 v[192:195], v3 offset:22528
    ds_read_b128 v[196:199], v3 offset:23552
    v_mfma_f32_32x32x16_f16 v[56:71], v[52:55], v[100:103], v[56:71]
    ds_read_b128 v[200:203], v3 offset:24576
    ds_read_b128 v[204:207], v3 offset:25600
    v_mfma_f32_32x32x16_f16 v[72:87], v[52:55], v[116:119], v[72:87]
    ds_read_b128 v[208:211], v3 offset:26624
    ds_read_b128 v[212:215], v3 offset:27648
    s_cmp_ge_u32 s35, 14
    s_cbranch_scc1 f_nd0
    s_add_u32 s43, s39, 0
    s_mov_b32 m0, s43
    s_add_u32 s42, s38, 0
    buffer_load_dwordx4 v3, s[48:51], s42 offen nt lds
    s_add_u32 s43, s39, 1024
    s_mov_b32 m0, s43
    s_add_u32 s42, s38, 2048
    v_xor_b32 v7, 32, v3
    buffer_load_dwordx4 v7, s[48:51], s42 offen nt lds
    s_add_u32 s43, s39, 2048
    s_mov_b32 m0, s43
    s_add_u32 s42, s38, 4096
    v_xor_b32 v7, 64, v3
    buffer_load_dwordx4 v7, s[48:51], s42 offen nt lds
f_nd0:
    s_cmp_eq_u32 s30, 0
    s_cbranch_scc1 f_sp2
    v_pk_mul_f32 v[24:25], v[56:57], v[120:121]
    v_pk_mul_f32 v[28:29], v[72:73], v[120:121]
    v_pk_mul_f32 v[26:27], v[58:59], v[122:123]
    v_pk_mul_f32 v[30:31], v[74:75], v[122:123]
    v_pk_fma_f32 v[24:25], v[72:73], v[136:137], v[24:25]
    v_pk_fma_f32 v[28:29], v[56:57], v[136:137], v[28:29] neg_lo:[1,0,0] neg_hi:[1,0,0]
    v_pk_fma_f32 v[26:27], v[74:75], v[138:139], v[26:27]
    v_pk_fma_f32 v[30:31], v[58:59], v[138:139], v[30:31] neg_lo:[1,0,0] neg_hi:[1,0,0]
    v_cvt_pk_f16_f32 v40, v24, v28
    v_cvt_pk_f16_f32 v41, v25, v29
    v_cvt_pk_f16_f32 v42, v26, v30
    v_cvt_pk_f16_f32 v43, v27, v31
    ds_read_b128 v[216:219], v3 offset:28672
    ds_read_b128 v[220:223], v3 offset:29696
    ds_read_b128 v[224:227], v3 offset:30720
    ds_read_b128 v[228:231], v3 offset:31744
    v_pk_mul_f32 v[32:33], v[60:61], v[124:125]
    v_pk_mul_f32 v[36:37], v[76:77], v[124:125]
    v_pk_mul_f32 v[34:35], v[62:63], v[126:127]
    v_pk_mul_f32 v[38:39], v[78:79], v[126:127]
    v_pk_fma_f32 v[32:33], v[76:77], v[140:141], v[32:33]
    v_pk_fma_f32 v[36:37], v[60:61], v[140:141], v[36:37] neg_lo:[1,0,0] neg_hi:[1,0,0]
    v_pk_fma_f32 v[34:35], v[78:79], v[142:143], v[34:35]
    v_pk_fma_f32 v[38:39], v[62:63], v[142:143], v[38:39] neg_lo:[1,0,0] neg_hi:[1,0,0]
    v_cvt_pk_f16_f32 v44, v32, v36
    v_cvt_pk_f16_f32 v45, v33, v37
    v_cvt_pk_f16_f32 v46, v34, v38
    v_cvt_pk_f16_f32 v47, v35, v39
    v_mfma_f32_32x32x16_f16 v[104:119], v[40:43], v[88:91], 0
    ds_read_b128 v[232:235], v3 offset:32768
    ds_read_b128 v[236:239], v3 offset:33792
    ds_read_b128 v[240:243], v3 offset:34816
    ds_read_b128 v[244:247], v3 offset:35840
    v_pk_mul_f32 v[24:25], v[64:65], v[128:129]
    v_pk_mul_f32 v[28:29], v[80:81], v[128:129]
    v_pk_mul_f32 v[26:27], v[66:67], v[130:131]
    v_pk_mul_f32 v[30:31], v[82:83], v[130:131]
    v_pk_fma_f32 v[24:25], v[80:81], v[144:145], v[24:25]
    v_pk_fma_f32 v[28:29], v[64:65], v[144:145], v[28:29] neg_lo:[1,0,0] neg_hi:[1,0,0]
    v_pk_fma_f32 v[26:27], v[82:83], v[146:147], v[26:27]
    v_pk_fma_f32 v[30:31], v[66:67], v[146:147], v[30:31] neg_lo:[1,0,0] neg_hi:[1,0,0]
    v_cvt_pk_f16_f32 v48, v24, v28
    v_cvt_pk_f16_f32 v49, v25, v29
    v_cvt_pk_f16_f32 v50, v26, v30
    v_cvt_pk_f16_f32 v51, v27, v31
    v_mfma_f32_32x32x16_f16 v[104:119], v[44:47], v[92:95], v[104:119]
    v_pk_mul_f32 v[32:33], v[68:69], v[132:133]
    v_pk_mul_f32 v[36:37], v[84:85], v[132:133]
    v_pk_mul_f32 v[34:35], v[70:71], v[134:135]
    v_pk_mul_f32 v[38:39], v[86:87], v[134:135]
    v_pk_fma_f32 v[32:33], v[84:85], v[148:149], v[32:33]
    v_pk_fma_f32 v[36:37], v[68:69], v[148:149], v[36:37] neg_lo:[1,0,0] neg_hi:[1,0,0]
    v_pk_fma_f32 v[34:35], v[86:87], v[150:151], v[34:35]
    v_pk_fma_f32 v[38:39], v[70:71], v[150:151], v[38:39] neg_lo:[1,0,0] neg_hi:[1,0,0]
    v_cvt_pk_f16_f32 v52, v32, v36
    v_cvt_pk_f16_f32 v53, v33, v37
    v_cvt_pk_f16_f32 v54, v34, v38
    v_cvt_pk_f16_f32 v55, v35, v39
    v_mfma_f32_32x32x16_f16 v[104:119], v[48:51], v[96:99], v[104:119]
    s_nop 0
    v_mfma_f32_32x32x16_f16 v[104:119], v[52:55], v[100:103], v[104:119]
    s_nop 11
    ds_bpermute_b32 v12, v19, v104
    s_waitcnt lgkmcnt(1)
    v_pk_fma_f32 v[152:153], v[184:185], v[104:105], v[152:153]
    v_pk_fma_f32 v[154:155], v[186:187], v[106:107], v[154:155]
    v_pk_fma_f32 v[156:157], v[188:189], v[108:109], v[156:157]
    v_pk_fma_f32 v[158:159], v[190:191], v[110:111], v[158:159]
    v_pk_fma_f32 v[160:161], v[192:193], v[112:113], v[160:161]
    v_pk_fma_f32 v[162:163], v[194:195], v[114:115], v[162:163]
    v_pk_fma_f32 v[164:165], v[196:197], v[116:117], v[164:165]
    v_pk_fma_f32 v[166:167], v[198:199], v[118:119], v[166:167]
    v_pk_fma_f32 v[170:171], v[202:203], v[106:107], v[170:171]
    v_pk_fma_f32 v[172:173], v[204:205], v[108:109], v[172:173]
    v_pk_fma_f32 v[174:175], v[206:207], v[110:111], v[174:175]
    v_pk_fma_f32 v[176:177], v[208:209], v[112:113], v[176:177]
    v_pk_fma_f32 v[178:179], v[210:211], v[114:115], v[178:179]
    v_pk_fma_f32 v[180:181], v[212:213], v[116:117], v[180:181]
    v_pk_fma_f32 v[182:183], v[214:215], v[118:119], v[182:183]
    v_fmac_f32 v169, v201, v105
    s_waitcnt lgkmcnt(0)
    v_fmac_f32 v168, v200, v12
f_join:
    v_lshrrev_b32 v17, 3, v0
    v_and_b32 v17, 60, v17
    v_add_u32 v17, 159744, v17
    v_and_b32 v7, 0xf0, v3
    v_lshrrev_b32 v7, 2, v7
    v_add_u32 v7, 159744, v7
    v_pk_add_f32 v[40:41], v[166:167], v[164:165]
    v_pk_add_f32 v[48:49], v[182:183], v[180:181]
    v_pk_add_f32 v[40:41], v[40:41], v[162:163]
    v_pk_add_f32 v[48:49], v[48:49], v[178:179]
    v_pk_add_f32 v[40:41], v[40:41], v[160:161]
    v_pk_add_f32 v[48:49], v[48:49], v[176:177]
    v_pk_add_f32 v[40:41], v[40:41], v[158:159]
    v_pk_add_f32 v[48:49], v[48:49], v[174:175]
    v_pk_add_f32 v[40:41], v[40:41], v[156:157]
    v_pk_add_f32 v[48:49], v[48:49], v[172:173]
    v_pk_add_f32 v[40:41], v[40:41], v[154:155]
    v_pk_add_f32 v[48:49], v[48:49], v[170:171]
    v_pk_add_f32 v[40:41], v[40:41], v[152:153]
    v_pk_add_f32 v[48:49], v[48:49], v[168:169]
    v_pk_mul_f32 v[42:43], v[166:167], v[166:167]
    v_pk_mul_f32 v[44:45], v[166:167], v[230:231]
    v_pk_mul_f32 v[50:51], v[182:183], v[182:183]
    v_pk_mul_f32 v[52:53], v[182:183], v[246:247]
    v_pk_fma_f32 v[42:43], v[164:165], v[164:165], v[42:43]
    v_pk_fma_f32 v[44:45], v[164:165], v[228:229], v[44:45]
    v_pk_fma_f32 v[50:51], v[180:181], v[180:181], v[50:51]
    v_pk_fma_f32 v[52:53], v[180:181], v[244:245], v[52:53]
    v_pk_fma_f32 v[42:43], v[162:163], v[162:163], v[42:43]
    v_pk_fma_f32 v[44:45], v[162:163], v[226:227], v[44:45]
    v_pk_fma_f32 v[50:51], v[178:179], v[178:179], v[50:51]
    v_pk_fma_f32 v[52:53], v[178:179], v[242:243], v[52:53]
    v_pk_fma_f32 v[42:43], v[160:161], v[160:161], v[42:43]
    v_pk_fma_f32 v[44:45], v[160:161], v[224:225], v[44:45]
    v_pk_fma_f32 v[50:51], v[176:177], v[176:177], v[50:51]
    v_pk_fma_f32 v[52:53], v[176:177], v[240:241], v[52:53]
    v_pk_fma_f32 v[42:43], v[158:159], v[158:159], v[42:43]
    v_pk_fma_f32 v[44:45], v[158:159], v[222:223], v[44:45]
    v_pk_fma_f32 v[50:51], v[174:175], v[174:175], v[50:51]
    v_pk_fma_f32 v[52:53], v[174:175], v[238:239], v[52:53]
    v_pk_fma_f32 v[42:43], v[156:157], v[156:157], v[42:43]
    v_pk_fma_f32 v[44:45], v[156:157], v[220:221], v[44:45]
    v_pk_fma_f32 v[50:51], v[172:173], v[172:173], v[50:51]
    v_pk_fma_f32 v[52:53], v[172:173], v[236:237], v[52:53]
    v_pk_fma_f32 v[42:43], v[154:155], v[154:155], v[42:43]
    v_pk_fma_f32 v[44:45], v[154:155], v[218:219], v[44:45]
    v_pk_fma_f32 v[50:51], v[170:171], v[170:171], v[50:51]
    v_pk_fma_f32 v[52:53], v[170:171], v[234:235], v[52:53]
    v_pk_fma_f32 v[42:43], v[152:153], v[152:153], v[42:43]
    v_pk_fma_f32 v[44:45], v[152:153], v[216:217], v[44:45]
    v_pk_fma_f32 v[50:51], v[168:169], v[168:169], v[50:51]
    v_pk_fma_f32 v[52:53], v[168:169], v[232:233], v[52:53]
    v_add_f32 v24, v40, v41
    v_add_f32 v25, v42, v43
    v_add_f32 v26, v44, v45
    v_add_f32 v28, v48, v49
    v_add_f32 v29, v50, v51
    v_add_f32 v30, v52, v53
    s_cmp_eq_u32 s79, 0
    s_cbranch_scc1 f_go
f_ngo:
    v_permlane32_swap_b32 v24, v28
    v_permlane32_swap_b32 v25, v29
    v_permlane32_swap_b32 v26, v30
    v_add_f32 v24, v24, v28
    v_add_f32 v25, v25, v29
    v_add_f32 v26, v26, v30
    v_add_f32_dpp v24, v24, v24 row_ror:8 row_mask:0xf bank_mask:0xf
    v_add_f32_dpp v25, v25, v25 row_ror:8 row_mask:0xf bank_mask:0xf
    v_add_f32_dpp v26, v26, v26 row_ror:8 row_mask:0xf bank_mask:0xf
    v_add_f32_dpp v24, v24, v24 row_ror:4 row_mask:0xf bank_mask:0xf
    v_add_f32_dpp v25, v25, v25 row_ror:4 row_mask:0xf bank_mask:0xf
    v_add_f32_dpp v26, v26, v26 row_ror:4 row_mask:0xf bank_mask:0xf
    v_add_f32_dpp v24, v24, v24 row_ror:2 row_mask:0xf bank_mask:0xf
    v_add_f32_dpp v25, v25, v25 row_ror:2 row_mask:0xf bank_mask:0xf
    v_add_f32_dpp v26, v26, v26 row_ror:2 row_mask:0xf bank_mask:0xf
    v_add_f32_dpp v24, v24, v24 row_ror:1 row_mask:0xf bank_mask:0xf
    v_add_f32_dpp v25, v25, v25 row_ror:1 row_mask:0xf bank_mask:0xf
    v_add_f32_dpp v26, v26, v26 row_ror:1 row_mask:0xf bank_mask:0xf
    v_add_f32_dpp v24, v24, v24 row_bcast:15 row_mask:0xa bank_mask:0xf
    v_add_f32_dpp v25, v25, v25 row_bcast:15 row_mask:0xa bank_mask:0xf
    v_add_f32_dpp v26, v26, v26 row_bcast:15 row_mask:0xa bank_mask:0xf
    v_mul_f32 v24, 0x3a800000, v24
    v_mul_f32 v25, 0x3a800000, v25
    v_mul_f32 v28, v24, v24
    v_fma_f32 v26, -v24, s66, v26
    v_sub_f32 v25, v25, v28
    v_mul_f32 v29, 4.0, v25
    v_cmp_gt_f32 vcc, v28, v29
    v_lshrrev_b32 v30, 4, v0
    s_lshl_b32 s43, s3, 5
    v_and_or_b32 v30, v30, 30, s43
    s_or_b32 s42, vcc_lo, vcc_hi
    s_bitcmp1_b32 s42, 31
    s_cbranch_scc1 f_slow2
f_var2:
    v_cvt_pk_bf16_f32 v25, v25, v25
    v_lshlrev_b32 v25, 16, v25
    v_add_f32 v25, 0x3727c5ac, v25
    v_cvt_pk_bf16_f32 v25, v25, v25
    v_lshlrev_b32 v25, 16, v25
    v_sqrt_f32 v25, v25
    s_nop 0
    v_cvt_pk_bf16_f32 v25, v25, v25
    v_lshlrev_b32 v25, 16, v25
    v_rcp_f32 v25, v25
    s_mov_b32 s42, 0x80000000
    s_movk_i32 s43, 0xf000
    s_mov_b32 exec_lo, s42
    s_mov_b32 exec_hi, s42
    v_mul_f32 v26, v26, v25
    v_ashrrev_i32 v28, 31, v26
    v_or_b32 v28, s42, v28
    v_xor_b32 v26, v26, v28
    v_and_or_b32 v26, v26, s43, v30
    ds_write_b32 v17, v26
    v_mul_f32 v24, -v24, v25
    s_mov_b64 exec, -1
    v_readlane_b32 s60, v26, 31
    v_readlane_b32 s56, v24, 31
    v_readlane_b32 s57, v25, 31
    v_readlane_b32 s61, v26, 63
    v_readlane_b32 s58, v24, 63
    v_readlane_b32 s59, v25, 63
    s_waitcnt lgkmcnt(0)
    s_barrier
    ds_read_b32 v32, v7
    s_lshr_b32 s42, s16, 2
    s_lshl_b32 s43, s42, 13
    s_lshl_b32 s42, s42, 12
    s_add_u32 s64, s76, s42
    s_add_u32 s64, s64, 20480
    v_add_u32 v4, s43, v4
    v_add_u32 v5, s43, v5
    v_add_u32 v6, s43, v6
    buffer_load_dwordx4 v[248:251], v3, s[12:15], s64 offen sc1
    s_waitcnt lgkmcnt(0)
    v_cmp_lt_u32 vcc, s60, v32
    v_cmp_lt_u32 s[44:45], s61, v32
    s_and_b32 s62, vcc_lo, 0xffff
    s_and_b32 s63, s44, 0xffff
    s_bcnt1_i32_b32 s62, s62
    s_bcnt1_i32_b32 s63, s63
    s_add_u32 s42, s62, s63
    s_cmp_eq_u32 s42, 1
    s_cbranch_scc1 f_both
    s_cmp_ge_u32 s62, 2
    s_cbranch_scc1 f_nc0
f_cand0:
    s_setprio 2
    s_or_b32 s42, s60, s62
    s_cmp_eq_u32 s62, 0
    s_cselect_b32 s43, s32, s33
    v_mov_b32 v34, s42
    v_mov_b32 v35, s43
    s_lshl_b32 s42, s62, 3
    s_add_u32 s42, s42, s80
    s_mov_b64 exec, 0xff
    buffer_store_dwordx2 v[34:35], v18, s[12:15], s42 offen sc1
    s_mov_b64 exec, -1
    s_lshl_b32 s43, s3, 1
    s_add_u32 s42, s62, s43
    s_lshl_b32 s43, s42, 7
    s_lshl_b32 s42, s42, 12
    s_add_u32 s42, s42, 18874368
    s_add_u32 s43, s43, 17170432
    v_mov_b32 v12, 0xffffff00
    v_and_or_b32 v56, v152, v12, s4
    v_and_or_b32 v57, v153, v12, s5
    v_and_or_b32 v58, v154, v12, s6
    v_and_or_b32 v59, v155, v12, s7
    buffer_store_dwordx4 v[56:59], v15, s[12:15], s42 offen offset:0 sc1
    v_and_or_b32 v60, v156, v12, s8
    v_and_or_b32 v61, v157, v12, s9
    v_and_or_b32 v62, v158, v12, s10
    v_and_or_b32 v63, v159, v12, s11
    buffer_store_dwordx4 v[60:63], v15, s[12:15], s42 offen offset:1024 sc1
    v_and_or_b32 v64, v160, v12, s4
    v_and_or_b32 v65, v161, v12, s5
    v_and_or_b32 v66, v162, v12, s6
    v_and_or_b32 v67, v163, v12, s7
    buffer_store_dwordx4 v[64:67], v15, s[12:15], s42 offen offset:512 sc1
    v_and_or_b32 v68, v164, v12, s8
    v_and_or_b32 v69, v165, v12, s9
    v_and_or_b32 v70, v166, v12, s10
    v_and_or_b32 v71, v167, v12, s11
    buffer_store_dwordx4 v[68:71], v15, s[12:15], s42 offen offset:1536 sc1
    v_mov_b32 v40, s32
    v_mov_b32 v41, s33
    v_mov_b32 v42, s56
    v_mov_b32 v43, s57
    s_mov_b64 exec, 0xff
    buffer_store_dwordx4 v[40:43], v3, s[12:15], s43 offen sc1
    s_mov_b64 exec, -1
    s_setprio 0
f_nc0:
    s_cmp_ge_u32 s63, 2
    s_cbranch_scc1 f_nc1
f_cand1:
    s_setprio 2
    s_or_b32 s42, s61, s63
    s_cmp_eq_u32 s63, 0
    s_cselect_b32 s43, s32, s33
    v_mov_b32 v34, s42
    v_mov_b32 v35, s43
    s_lshl_b32 s42, s63, 3
    s_add_u32 s42, s42, s80
    s_mov_b64 exec, 0xff
    buffer_store_dwordx2 v[34:35], v18, s[12:15], s42 offen sc1
    s_mov_b64 exec, -1
    s_lshl_b32 s43, s3, 1
    s_add_u32 s42, s63, s43
    s_lshl_b32 s43, s42, 7
    s_lshl_b32 s42, s42, 12
    s_add_u32 s42, s42, 18874368
    s_add_u32 s43, s43, 17170432
    v_mov_b32 v12, 0xffffff00
    v_and_or_b32 v72, v168, v12, s4
    v_and_or_b32 v73, v183, v12, s5
    v_and_or_b32 v74, v182, v12, s6
    v_and_or_b32 v75, v181, v12, s7
    buffer_store_dwordx4 v[72:75], v16, s[12:15], s42 offen offset:0 sc1
    v_and_or_b32 v76, v180, v12, s8
    v_and_or_b32 v77, v179, v12, s9
    v_and_or_b32 v78, v178, v12, s10
    v_and_or_b32 v79, v177, v12, s11
    buffer_store_dwordx4 v[76:79], v16, s[12:15], s42 offen offset:1024 sc1
    v_and_or_b32 v80, v176, v12, s4
    v_and_or_b32 v81, v175, v12, s5
    v_and_or_b32 v82, v174, v12, s6
    v_and_or_b32 v83, v173, v12, s7
    buffer_store_dwordx4 v[80:83], v16, s[12:15], s42 offen offset:512 sc1
    v_and_or_b32 v84, v172, v12, s8
    v_and_or_b32 v85, v171, v12, s9
    v_and_or_b32 v86, v170, v12, s10
    v_and_or_b32 v87, v169, v12, s11
    buffer_store_dwordx4 v[84:87], v16, s[12:15], s42 offen offset:1536 sc1
    v_mov_b32 v44, s32
    v_mov_b32 v45, s33
    v_mov_b32 v46, s58
    v_mov_b32 v47, s59
    s_mov_b64 exec, 0xff
    buffer_store_dwordx4 v[44:47], v3, s[12:15], s43 offen sc1
    s_mov_b64 exec, -1
    s_setprio 0
f_nc1:
    ds_read_b128 v[88:91], v3 offset:36864
    ds_read_b128 v[92:95], v3 offset:37888
    ds_read_b128 v[96:99], v3 offset:38912
    ds_read_b128 v[100:103], v3 offset:39936
    ds_read_b128 v[120:123], v3 offset:40960
    ds_read_b128 v[124:127], v3 offset:41984
    ds_read_b128 v[128:131], v3 offset:43008
    ds_read_b128 v[132:135], v3 offset:44032
    v_pk_fma_f32 v[56:57], v[152:153], s[56:57], s[56:57] op_sel:[0,1,0] op_sel_hi:[1,1,0]
    v_pk_fma_f32 v[58:59], v[154:155], s[56:57], s[56:57] op_sel:[0,1,0] op_sel_hi:[1,1,0]
    v_pk_fma_f32 v[60:61], v[156:157], s[56:57], s[56:57] op_sel:[0,1,0] op_sel_hi:[1,1,0]
    v_pk_fma_f32 v[62:63], v[158:159], s[56:57], s[56:57] op_sel:[0,1,0] op_sel_hi:[1,1,0]
    v_pk_fma_f32 v[64:65], v[160:161], s[56:57], s[56:57] op_sel:[0,1,0] op_sel_hi:[1,1,0]
    v_pk_fma_f32 v[66:67], v[162:163], s[56:57], s[56:57] op_sel:[0,1,0] op_sel_hi:[1,1,0]
    v_pk_fma_f32 v[68:69], v[164:165], s[56:57], s[56:57] op_sel:[0,1,0] op_sel_hi:[1,1,0]
    v_pk_fma_f32 v[70:71], v[166:167], s[56:57], s[56:57] op_sel:[0,1,0] op_sel_hi:[1,1,0]
    v_pk_fma_f32 v[72:73], v[168:169], s[58:59], s[58:59] op_sel:[0,1,0] op_sel_hi:[1,1,0]
    v_pk_fma_f32 v[74:75], v[170:171], s[58:59], s[58:59] op_sel:[0,1,0] op_sel_hi:[1,1,0]
    v_pk_fma_f32 v[76:77], v[172:173], s[58:59], s[58:59] op_sel:[0,1,0] op_sel_hi:[1,1,0]
    v_pk_fma_f32 v[78:79], v[174:175], s[58:59], s[58:59] op_sel:[0,1,0] op_sel_hi:[1,1,0]
    v_pk_fma_f32 v[80:81], v[176:177], s[58:59], s[58:59] op_sel:[0,1,0] op_sel_hi:[1,1,0]
    v_pk_fma_f32 v[82:83], v[178:179], s[58:59], s[58:59] op_sel:[0,1,0] op_sel_hi:[1,1,0]
    v_pk_fma_f32 v[84:85], v[180:181], s[58:59], s[58:59] op_sel:[0,1,0] op_sel_hi:[1,1,0]
    v_pk_fma_f32 v[86:87], v[182:183], s[58:59], s[58:59] op_sel:[0,1,0] op_sel_hi:[1,1,0]
    v_subrev_u32 v13, s68, v13
    s_sub_u32 s68, s68, 65536
    v_bfe_u32 v12, v0, 1, 2
    v_lshlrev_b32 v12, 4, v12
    v_xor_b32 v13, v13, v12
    v_xor_b32 v14, 2000, v13
    v_add_u32 v13, s68, v13
    v_add_u32 v14, s68, v14
    v_xor_b32 v20, 16, v13
    v_xor_b32 v21, 16, v14
    v_and_b32 v22, 8, v0
    v_lshlrev_b32 v22, 1, v22
    v_xor_b32 v22, v22, v3
    v_add_u32 v22, s68, v22
    v_xor_b32 v23, 32, v22
    s_mov_b32 s83, 0
    s_min_u32 s42, s62, s63
    s_cmp_lt_u32 s42, 2
    s_cbranch_scc1 f_p2k
    s_waitcnt vmcnt(0)
f_p2e:
    v_xor_b32 v248, v8, v248
    v_xor_b32 v249, v9, v249
    v_xor_b32 v250, v10, v250
    v_xor_b32 v251, v11, v251
    v_or3_b32 v12, v248, v249, 0
    v_or3_b32 v12, v250, v251, v12
    v_and_b32 v12, 0xff, v12
    v_cmp_ne_u32 vcc, 0, v12
    s_cbranch_vccnz f_p2r
f_p2w:
    ds_write_b128 v4, v[248:251] offset:45056
    ds_write_b32 v5, v248 offset:49152
    ds_write_b32 v6, v249 offset:49164
    ds_write_b32 v6, v250 offset:49160
    ds_write_b32 v6, v251 offset:49156
    s_waitcnt lgkmcnt(0)
    s_barrier
    s_cmp_ge_u32 s35, 14
    s_cbranch_scc1 f_nd2
    s_add_u32 s43, s39, 3072
    s_mov_b32 m0, s43
    s_add_u32 s42, s38, 6144
    v_xor_b32 v7, 96, v3
    buffer_load_dwordx4 v7, s[48:51], s42 offen nt lds
    s_add_u32 s43, s39, 4096
    s_mov_b32 m0, s43
    s_add_u32 s42, s38, 16384
    v_xor_b32 v7, 128, v3
    buffer_load_dwordx4 v7, s[48:51], s42 offen nt lds
    s_add_u32 s43, s39, 5120
    s_mov_b32 m0, s43
    s_add_u32 s42, s38, 18432
    v_xor_b32 v7, 160, v3
    buffer_load_dwordx4 v7, s[48:51], s42 offen nt lds
    s_add_u32 s43, s39, 6144
    s_mov_b32 m0, s43
    s_add_u32 s42, s38, 20480
    v_xor_b32 v7, 192, v3
    buffer_load_dwordx4 v7, s[48:51], s42 offen nt lds
    s_add_u32 s43, s39, 7168
    s_mov_b32 m0, s43
    s_add_u32 s42, s38, 22528
    v_xor_b32 v7, 224, v3
    buffer_load_dwordx4 v7, s[48:51], s42 offen nt lds
f_nd2:
    ds_read_b128 v[136:139], v3 offset:45056
    ds_read_b128 v[140:143], v3 offset:46080
    ds_read_b128 v[144:147], v3 offset:47104
    ds_read_b128 v[148:151], v3 offset:48128
    ds_read_b128 v[184:187], v3 offset:53248
    ds_read_b128 v[188:191], v3 offset:54272
    ds_read_b128 v[192:195], v3 offset:55296
    ds_read_b128 v[196:199], v3 offset:56320
    ds_read_b128 v[104:107], v3 offset:49152
    ds_read_b128 v[108:111], v3 offset:50176
    ds_read_b128 v[112:115], v3 offset:51200
    ds_read_b128 v[116:119], v3 offset:52224
    ds_read_b128 v[200:203], v3 offset:57344
    ds_read_b128 v[204:207], v3 offset:58368
    ds_read_b128 v[208:211], v3 offset:59392
    ds_read_b128 v[212:215], v3 offset:60416
    s_waitcnt lgkmcnt(12)
    v_pk_fma_f32 v[56:57], v[56:57], v[88:89], v[136:137]
    v_pk_fma_f32 v[58:59], v[58:59], v[90:91], v[138:139]
    v_pk_fma_f32 v[60:61], v[60:61], v[92:93], v[140:141]
    v_pk_fma_f32 v[62:63], v[62:63], v[94:95], v[142:143]
    v_pk_fma_f32 v[64:65], v[64:65], v[96:97], v[144:145]
    v_pk_fma_f32 v[66:67], v[66:67], v[98:99], v[146:147]
    v_pk_fma_f32 v[68:69], v[68:69], v[100:101], v[148:149]
    v_pk_fma_f32 v[70:71], v[70:71], v[102:103], v[150:151]
    s_waitcnt lgkmcnt(8)
    v_pk_fma_f32 v[152:153], v[184:185], v[56:57], v[152:153]
    v_pk_fma_f32 v[154:155], v[186:187], v[58:59], v[154:155]
    v_pk_fma_f32 v[156:157], v[188:189], v[60:61], v[156:157]
    v_pk_fma_f32 v[158:159], v[190:191], v[62:63], v[158:159]
    v_pk_fma_f32 v[160:161], v[192:193], v[64:65], v[160:161]
    v_pk_fma_f32 v[162:163], v[194:195], v[66:67], v[162:163]
    v_pk_fma_f32 v[164:165], v[196:197], v[68:69], v[164:165]
    v_pk_fma_f32 v[166:167], v[198:199], v[70:71], v[166:167]
    v_cvt_pk_bf16_f32 v216, v152, v153
    v_cvt_pk_bf16_f32 v217, v154, v155
    v_cvt_pk_bf16_f32 v218, v156, v157
    v_cvt_pk_bf16_f32 v219, v158, v159
    v_cvt_pk_bf16_f32 v220, v160, v161
    v_cvt_pk_bf16_f32 v221, v162, v163
    v_cvt_pk_bf16_f32 v222, v164, v165
    v_cvt_pk_bf16_f32 v223, v166, v167
    ds_write_b128 v13, v[216:219] offset:0
    ds_write_b128 v20, v[220:223] offset:0
    s_waitcnt lgkmcnt(6)
    v_pk_fma_f32 v[72:73], v[72:73], v[120:121], v[104:105]
    v_pk_fma_f32 v[74:75], v[74:75], v[122:123], v[106:107]
    v_pk_fma_f32 v[76:77], v[76:77], v[124:125], v[108:109]
    v_pk_fma_f32 v[78:79], v[78:79], v[126:127], v[110:111]
    v_pk_fma_f32 v[80:81], v[80:81], v[128:129], v[112:113]
    v_pk_fma_f32 v[82:83], v[82:83], v[130:131], v[114:115]
    v_pk_fma_f32 v[84:85], v[84:85], v[132:133], v[116:117]
    v_pk_fma_f32 v[86:87], v[86:87], v[134:135], v[118:119]
    s_waitcnt lgkmcnt(2)
    v_pk_fma_f32 v[168:169], v[200:201], v[72:73], v[168:169]
    v_pk_fma_f32 v[170:171], v[202:203], v[74:75], v[170:171]
    v_pk_fma_f32 v[172:173], v[204:205], v[76:77], v[172:173]
    v_pk_fma_f32 v[174:175], v[206:207], v[78:79], v[174:175]
    v_pk_fma_f32 v[176:177], v[208:209], v[80:81], v[176:177]
    v_pk_fma_f32 v[178:179], v[210:211], v[82:83], v[178:179]
    v_pk_fma_f32 v[180:181], v[212:213], v[84:85], v[180:181]
    v_pk_fma_f32 v[182:183], v[214:215], v[86:87], v[182:183]
    v_cvt_pk_bf16_f32 v224, v168, v183
    v_cvt_pk_bf16_f32 v225, v182, v181
    v_cvt_pk_bf16_f32 v226, v180, v179
    v_cvt_pk_bf16_f32 v227, v178, v177
    v_cvt_pk_bf16_f32 v228, v176, v175
    v_cvt_pk_bf16_f32 v229, v174, v173
    v_cvt_pk_bf16_f32 v230, v172, v171
    v_cvt_pk_bf16_f32 v231, v170, v169
    ds_write_b128 v14, v[224:227] offset:2048
    ds_write_b128 v21, v[228:231] offset:2048
    s_waitcnt lgkmcnt(0)
    ds_read_b128 v[232:235], v22 offset:0
    ds_read_b128 v[236:239], v23 offset:1024
    ds_read_b128 v[240:243], v22 offset:2048
    ds_read_b128 v[244:247], v23 offset:3072
    v_lshrrev_b32 v144, 2, v2
    v_and_b32 v145, 7, v144
    v_and_b32 v146, 3, v0
    v_lshl_add_u32 v148, v1, 2, v146
    v_xor_b32 v148, v148, v145
    v_lshlrev_b32 v148, 5, v148
    v_lshl_add_u32 v148, v144, 10, v148
    v_add_u32 v148, 94208, v148
    v_cmp_eq_u32 s[44:45], 1, v146
    v_cmp_eq_u32 s[46:47], 2, v146
    v_cmp_eq_u32 s[72:73], 3, v146
    v_bfe_u32 v145, v0, 4, 2
    v_and_b32 v144, 1, v144
    v_lshlrev_b32 v153, 7, v144
    v_lshl_add_u32 v153, v145, 4, v153
    v_add_u32 v153, 159872, v153
    v_lshlrev_b32 v154, 4, v146
    v_lshl_add_u32 v154, v144, 6, v154
    v_lshl_add_u32 v154, v1, 15, v154
    v_lshl_add_u32 v154, v145, 13, v154
    v_and_b32 v144, 15, v0
    v_lshlrev_b32 v152, 1, v144
    v_lshl_add_u32 v152, v1, 5, v152
    v_lshl_add_u32 v152, v145, 7, v152
    v_add_u32 v152, 159872, v152
    s_and_b32 s76, s35, 1
    s_lshl_b32 s76, s76, 18
    s_lshl_b32 s77, s17, 7
    s_add_u32 s76, s76, s77
    s_add_u32 s76, s76, 17825792
    s_movk_i32 s77, 0xff00
    s_lshl_b32 s81, s17, 2
    s_and_b32 s42, s16, 3
    s_add_u32 s81, s81, s42
    s_lshl_b32 s81, s81, 10
    s_add_u32 s82, s81, 18612224
    s_add_u32 s81, s81, 18350080
    v_mov_b32 v5, 159848
    s_waitcnt vmcnt(0)
    s_barrier
    ds_read_b64_tr_b16 v[88:89], v148 offset:0
    ds_read_b64_tr_b16 v[90:91], v148 offset:16384
    ds_read_b64_tr_b16 v[92:93], v148 offset:8
    ds_read_b64_tr_b16 v[94:95], v148 offset:16392
    ds_read_b64_tr_b16 v[96:97], v148 offset:16
    ds_read_b64_tr_b16 v[98:99], v148 offset:16400
    ds_read_b64_tr_b16 v[100:101], v148 offset:24
    ds_read_b64_tr_b16 v[102:103], v148 offset:16408
    ds_read_b64_tr_b16 v[104:105], v148 offset:32768
    ds_read_b64_tr_b16 v[106:107], v148 offset:49152
    ds_read_b64_tr_b16 v[108:109], v148 offset:32776
    ds_read_b64_tr_b16 v[110:111], v148 offset:49160
    ds_read_b64_tr_b16 v[112:113], v148 offset:32784
    ds_read_b64_tr_b16 v[114:115], v148 offset:49168
    ds_read_b64_tr_b16 v[116:117], v148 offset:32792
    ds_read_b64_tr_b16 v[118:119], v148 offset:49176
    s_cmp_lg_u32 s16, 7
    s_cbranch_scc1 f_n7
    v_lshlrev_b32 v40, 7, v2
    s_add_u32 s42, s74, 8192
    buffer_load_dwordx4 v[32:35], v40, s[12:15], s74 offen sc1
    buffer_load_dwordx4 v[36:39], v40, s[12:15], s42 offen sc1
f_n7:
    s_cmp_ge_u32 s35, 14
    s_cbranch_scc1 f_na
    s_cmp_ge_u32 s16, 4
    s_cbranch_scc1 f_na
    s_mov_b32 s83, 0
f_px:
    s_and_b32 s42, s83, 63
    s_cmp_eq_u32 s42, 63
    s_cselect_b32 s42, s82, s81
    buffer_load_dwordx4 v[144:147], v3, s[12:15], s42 offen sc1
    s_add_u32 s83, s83, 1
    s_cmp_ge_u32 s83, 0x40000
    s_cbranch_scc1 f_pxx
    s_waitcnt vmcnt(0)
    v_cmp_ne_u16_sdwa vcc, v147, v11 src0_sel:BYTE_0 src1_sel:DWORD
    s_cbranch_vccnz f_px
    v_xor_b32 v144, v8, v144
    v_xor_b32 v145, v9, v145
    v_xor_b32 v146, v10, v146
    v_xor_b32 v147, v11, v147
    v_or3_b32 v4, v144, v145, 0
    v_or3_b32 v4, v146, v147, v4
    v_and_b32 v4, 0xff, v4
    v_cmp_ne_u32 vcc, 0, v4
    s_cbranch_vccnz f_px
f_pxx:
    s_waitcnt vmcnt(0)
    v_permlane32_swap_b32 v144, v146
    v_permlane32_swap_b32 v145, v147
    v_pk_add_f32 v[144:145], v[144:145], v[146:147]
    s_nop 1
    v_permlane16_swap_b32 v144, v145
    v_add_f32 v144, v144, v145
    v_cvt_pk_bf16_f32 v144, v144, v144
    v_lshlrev_b32 v144, 16, v144
    v_mul_f32 v145, 0xbfb8aa3b, v144
    v_exp_f32 v145, v145
    v_mov_b32 v146, v144
    v_add_f32 v145, 1.0, v145
    v_rcp_f32 v145, v145
    v_mov_b32 v147, v144
    v_mul_f32 v145, v144, v145
    s_nop 0
    v_permlane32_swap_b32 v146, v147
    v_cvt_pk_bf16_f32 v145, v145, v145
    v_lshlrev_b32 v145, 16, v145
    v_mul_f32 v145, v145, v147
    v_cvt_pk_bf16_f32 v145, v145, v145
    ds_write_b16 v152, v145
f_na:
    s_waitcnt lgkmcnt(0)
    s_barrier
    s_cmp_ge_u32 s35, 14
    s_cbranch_scc1 f_fin
    ds_read_b128 v[120:123], v153 offset:0
    ds_read_b128 v[124:127], v153 offset:64
    s_waitcnt lgkmcnt(1)
    v_mfma_f32_16x16x32_bf16 v[128:131], v[88:91], v[120:123], 0
    v_mfma_f32_16x16x32_bf16 v[132:135], v[92:95], v[120:123], 0
    v_mfma_f32_16x16x32_bf16 v[136:139], v[96:99], v[120:123], 0
    v_mfma_f32_16x16x32_bf16 v[140:143], v[100:103], v[120:123], 0
    s_waitcnt lgkmcnt(0)
    v_mfma_f32_16x16x32_bf16 v[128:131], v[104:107], v[124:127], v[128:131]
    v_mfma_f32_16x16x32_bf16 v[132:135], v[108:111], v[124:127], v[132:135]
    v_mfma_f32_16x16x32_bf16 v[136:139], v[112:115], v[124:127], v[136:139]
    v_mfma_f32_16x16x32_bf16 v[140:143], v[116:119], v[124:127], v[140:143]
    s_nop 5
    v_cndmask_b32 v128, v128, v132, s[44:45]
    v_cndmask_b32 v129, v129, v133, s[44:45]
    v_cndmask_b32 v130, v130, v134, s[44:45]
    v_cndmask_b32 v131, v131, v135, s[44:45]
    v_cndmask_b32 v128, v128, v136, s[46:47]
    v_cndmask_b32 v129, v129, v137, s[46:47]
    v_cndmask_b32 v130, v130, v138, s[46:47]
    v_cndmask_b32 v131, v131, v139, s[46:47]
    v_cndmask_b32 v128, v128, v140, s[72:73]
    v_cndmask_b32 v129, v129, v141, s[72:73]
    v_cndmask_b32 v130, v130, v142, s[72:73]
    v_cndmask_b32 v131, v131, v143, s[72:73]
    v_and_or_b32 v128, v128, s77, v8
    v_and_or_b32 v129, v129, s77, v9
    v_and_or_b32 v130, v130, s77, v10
    v_and_or_b32 v131, v131, s77, v11
    s_mov_b32 exec_lo, 0x00ff00ff
    s_mov_b32 exec_hi, 0x00ff00ff
    buffer_store_dwordx4 v[128:131], v154, s[12:15], s76 offen sc1
    s_mov_b64 exec, -1
    s_waitcnt vmcnt(1)
f_fin:
    s_cmp_eq_u32 s16, 7
    s_cbranch_scc1 f_sel
f_selx:
    s_barrier
    ds_read_b64 v[28:29], v5
    s_waitcnt lgkmcnt(0)
    v_readfirstlane_b32 s40, v28
    v_readfirstlane_b32 s41, v29
    s_cmp_eq_u32 s60, s40
    s_cbranch_scc1 f_e0
    s_cmp_eq_u32 s60, s41
    s_cbranch_scc1 f_e0
    buffer_store_dwordx4 v[232:235], v3, s[24:27], s18 offen offset:0 sc1
    buffer_store_dwordx4 v[236:239], v3, s[24:27], s18 offen offset:1024 sc1
f_e0:
    s_cmp_eq_u32 s61, s40
    s_cbranch_scc1 f_e1
    s_cmp_eq_u32 s61, s41
    s_cbranch_scc1 f_e1
    buffer_store_dwordx4 v[240:243], v3, s[24:27], s19 offen offset:0 sc1
    buffer_store_dwordx4 v[244:247], v3, s[24:27], s19 offen offset:1024 sc1
f_e1:
    s_endpgm
f_sel:
    s_mov_b32 s83, 0
    s_cmp_lt_u32 s35, 14
    s_cbranch_scc1 f_kqc
    v_lshlrev_b32 v40, 7, v2
    s_add_u32 s42, s74, 8192
    s_mov_b32 s83, 0
    s_mov_b64 vcc, -1
    s_mov_b64 s[40:41], -1
f_kq:
    s_mov_b64 exec, vcc
    s_cbranch_execz f_kqa
    buffer_load_dwordx4 v[32:35], v40, s[12:15], s74 offen sc1
f_kqa:
    s_mov_b64 exec, s[40:41]
    s_cbranch_execz f_kqb
    buffer_load_dwordx4 v[36:39], v40, s[12:15], s42 offen sc1
f_kqb:
    s_mov_b64 exec, -1
    s_waitcnt vmcnt(0)
f_kqc:
    v_cmp_ne_u32 vcc, s32, v33
    v_cmp_ne_u32 s[20:21], s33, v35
    v_cmp_ne_u32 s[40:41], s32, v37
    v_cmp_ne_u32 s[22:23], s33, v39
    v_max_u32 v41, v32, v36
    v_min_u32 v42, v32, v36
    s_or_b64 vcc, vcc, s[20:21]
    s_or_b64 s[40:41], s[40:41], s[22:23]
    s_or_b64 s[20:21], vcc, s[40:41]
    s_cbranch_scc0 f_kqx
    s_sleep 4
    s_add_u32 s83, s83, 1
    s_cmp_lt_u32 s83, 0x40000
    s_cbranch_scc1 f_kq
f_kqx:
    v_mov_b32 v43, v41
    v_max3_u32 v42, v42, v34, v38
    s_nop 0
    v_max_u32_dpp v43, v43, v43 row_ror:8 row_mask:0xf bank_mask:0xf
    s_nop 1
    v_max_u32_dpp v43, v43, v43 row_ror:4 row_mask:0xf bank_mask:0xf
    s_nop 1
    v_max_u32_dpp v43, v43, v43 row_ror:2 row_mask:0xf bank_mask:0xf
    s_nop 1
    v_max_u32_dpp v43, v43, v43 row_ror:1 row_mask:0xf bank_mask:0xf
    s_nop 1
    v_max_u32_dpp v43, v43, v43 row_bcast:15 row_mask:0xa bank_mask:0xf
    s_nop 1
    v_max_u32_dpp v43, v43, v43 row_bcast:31 row_mask:0xc bank_mask:0xf
    s_nop 0
    v_readlane_b32 s40, v43, 63
    s_nop 1
    v_cmp_eq_u32 vcc, s40, v41
    s_nop 1
    v_cndmask_b32 v43, v41, v42, vcc
    s_nop 1
    v_max_u32_dpp v43, v43, v43 row_ror:8 row_mask:0xf bank_mask:0xf
    s_nop 1
    v_max_u32_dpp v43, v43, v43 row_ror:4 row_mask:0xf bank_mask:0xf
    s_nop 1
    v_max_u32_dpp v43, v43, v43 row_ror:2 row_mask:0xf bank_mask:0xf
    s_nop 1
    v_max_u32_dpp v43, v43, v43 row_ror:1 row_mask:0xf bank_mask:0xf
    s_nop 1
    v_max_u32_dpp v43, v43, v43 row_bcast:15 row_mask:0xa bank_mask:0xf
    s_nop 1
    v_max_u32_dpp v43, v43, v43 row_bcast:31 row_mask:0xc bank_mask:0xf
    s_nop 0
    v_readlane_b32 s41, v43, 63
    s_andn2_b32 s40, s40, 1
    s_andn2_b32 s41, s41, 1
    v_mov_b32 v28, s40
    v_mov_b32 v29, s41
    ds_write_b64 v5, v[28:29]
    s_waitcnt lgkmcnt(0)
    s_branch f_selx
f_p2r:
    s_add_u32 s83, s83, 1
    s_cmp_ge_u32 s83, 0x40000
    s_cbranch_scc1 f_p2w
    s_sleep 12
    buffer_load_dwordx4 v[248:251], v3, s[12:15], s64 offen sc1
    s_waitcnt vmcnt(0)
    s_branch f_p2e
f_p2k:
    s_waitcnt vmcnt(6)
    s_branch f_p2e
f_zr:
    v_or3_b32 v248, v40, v42, v44
    v_or_b32 v248, v248, v46
    v_and_b32 v248, s54, v248
    v_cmp_ne_u32 vcc, 0, v248
    s_cbranch_vccz f_zr0
    buffer_load_dwordx4 v[24:27], v3, s[12:15], s72 offen offset:0 sc1
f_zr0:
    v_or3_b32 v248, v41, v43, v45
    v_or_b32 v248, v248, v47
    v_and_b32 v248, s54, v248
    v_cmp_ne_u32 vcc, 0, v248
    s_cbranch_vccz f_zr1
    buffer_load_dwordx4 v[28:31], v3, s[12:15], s72 offen offset:1024 sc1
f_zr1:
    v_or3_b32 v248, v48, v50, v52
    v_or_b32 v248, v248, v54
    v_and_b32 v248, s54, v248
    v_cmp_ne_u32 vcc, 0, v248
    s_cbranch_vccz f_zr2
    buffer_load_dwordx4 v[32:35], v3, s[12:15], s72 offen offset:2048 sc1
f_zr2:
    v_or3_b32 v248, v49, v51, v53
    v_or_b32 v248, v248, v55
    v_and_b32 v248, s54, v248
    v_cmp_ne_u32 vcc, 0, v248
    s_cbranch_vccz f_zr3
    buffer_load_dwordx4 v[36:39], v3, s[12:15], s72 offen offset:3072 sc1
f_zr3:
    s_waitcnt vmcnt(0)
    s_add_u32 s83, s83, 1
    s_cmp_lt_u32 s83, 0x40000
    s_cbranch_scc1 f_zc
    s_branch f_zx
f_both:
    s_or_b32 s42, s61, s63
    s_cmp_eq_u32 s63, 0
    s_cselect_b32 s43, s32, s33
    v_mov_b32 v34, s42
    v_mov_b32 v35, s43
    s_lshl_b32 s42, s63, 3
    s_add_u32 s42, s42, s80
    s_mov_b64 exec, 0xff
    buffer_store_dwordx2 v[34:35], v18, s[12:15], s42 offen sc1
    s_mov_b64 exec, -1
    s_nop 1
    s_branch f_cand0
f_r0:
    buffer_load_dwordx4 v3, s[8:11], s18 offen offset:0 lds
    buffer_load_dwordx4 v3, s[8:11], s18 offen offset:1024 lds
    s_branch f_nr
f_str:
    s_and_b32 s42, s83, 31
    s_cmp_lg_u32 s42, 24
    s_cbranch_scc1 f_sb1
    v_add_u32 v84, 160768, v3
    s_mov_b64 exec, 0xff
    ds_read_b128 v[80:83], v84
    s_waitcnt lgkmcnt(0)
    buffer_store_dwordx4 v[80:83], v3, s[12:15], s63 offen sc1
    s_mov_b64 exec, -1
f_sb1:
    s_cmp_eq_u32 s42, 31
    s_cselect_b32 s42, 32768, 0
    s_add_u32 s42, s42, s71
    s_mov_b32 exec_lo, 0x000f000f
    s_mov_b32 exec_hi, 0x000f000f
    buffer_load_dwordx4 v[24:27], v7, s[12:15], s42 offen sc1
    s_add_u32 s83, s83, 1
    s_cmp_lt_u32 s83, 0x40000
    s_cbranch_scc1 f_st
    s_waitcnt vmcnt(0)
    s_mov_b64 exec, -1
    s_branch f_stx
f_pr:
    s_sleep 6
    v_mov_b32 v192, v8
    v_mov_b32 v193, v9
    v_mov_b32 v194, v10
    v_mov_b32 v195, v11
    buffer_load_dwordx4 v[184:187], v3, s[12:15], s64 offen sc1
    buffer_load_dwordx4 v[188:191], v3, s[12:15], s65 offen sc1
    s_mov_b64 exec, 0xffff
    buffer_load_dwordx4 v[236:239], v17, s[12:15], s77 offen sc1
    s_mov_b64 exec, s[52:53]
    buffer_load_dwordx4 v[192:195], v3, s[12:15], s76 offen sc1
    s_mov_b64 exec, -1
    s_waitcnt vmcnt(0)
    s_add_u32 s83, s83, 1
    s_cmp_lt_u32 s83, 0x40000
    s_cbranch_scc1 f_pv
    s_branch f_pw
f_go:
    s_lshl_b32 s41, s34, 7
    s_add_u32 s41, s41, 16842752
    v_mov_b32 v56, s32
    v_mov_b32 v57, s33
    s_mov_b64 exec, 0xff
    buffer_store_dwordx4 v[56:59], v3, s[12:15], s41 offen sc1
    s_mov_b64 exec, -1
    s_branch f_ngo
f_slow2:
    v_cvt_pk_bf16_f32 v40, v152, v153
    v_lshlrev_b32 v152, 16, v40
    v_and_b32 v153, 0xffff0000, v40
    v_cvt_pk_bf16_f32 v40, v154, v155
    v_lshlrev_b32 v154, 16, v40
    v_and_b32 v155, 0xffff0000, v40
    v_cvt_pk_bf16_f32 v40, v156, v157
    v_lshlrev_b32 v156, 16, v40
    v_and_b32 v157, 0xffff0000, v40
    v_cvt_pk_bf16_f32 v40, v158, v159
    v_lshlrev_b32 v158, 16, v40
    v_and_b32 v159, 0xffff0000, v40
    v_cvt_pk_bf16_f32 v40, v160, v161
    v_lshlrev_b32 v160, 16, v40
    v_and_b32 v161, 0xffff0000, v40
    v_cvt_pk_bf16_f32 v40, v162, v163
    v_lshlrev_b32 v162, 16, v40
    v_and_b32 v163, 0xffff0000, v40
    v_cvt_pk_bf16_f32 v40, v164, v165
    v_lshlrev_b32 v164, 16, v40
    v_and_b32 v165, 0xffff0000, v40
    v_cvt_pk_bf16_f32 v40, v166, v167
    v_lshlrev_b32 v166, 16, v40
    v_and_b32 v167, 0xffff0000, v40
    v_pk_add_f32 v[40:41], v[152:153], v[154:155]
    v_pk_add_f32 v[40:41], v[40:41], v[156:157]
    v_pk_add_f32 v[40:41], v[40:41], v[158:159]
    v_pk_add_f32 v[40:41], v[40:41], v[160:161]
    v_pk_add_f32 v[40:41], v[40:41], v[162:163]
    v_pk_add_f32 v[40:41], v[40:41], v[164:165]
    v_pk_add_f32 v[40:41], v[40:41], v[166:167]
    v_cvt_pk_bf16_f32 v48, v168, v169
    v_lshlrev_b32 v168, 16, v48
    v_and_b32 v169, 0xffff0000, v48
    v_cvt_pk_bf16_f32 v48, v170, v171
    v_lshlrev_b32 v170, 16, v48
    v_and_b32 v171, 0xffff0000, v48
    v_cvt_pk_bf16_f32 v48, v172, v173
    v_lshlrev_b32 v172, 16, v48
    v_and_b32 v173, 0xffff0000, v48
    v_cvt_pk_bf16_f32 v48, v174, v175
    v_lshlrev_b32 v174, 16, v48
    v_and_b32 v175, 0xffff0000, v48
    v_cvt_pk_bf16_f32 v48, v176, v177
    v_lshlrev_b32 v176, 16, v48
    v_and_b32 v177, 0xffff0000, v48
    v_cvt_pk_bf16_f32 v48, v178, v179
    v_lshlrev_b32 v178, 16, v48
    v_and_b32 v179, 0xffff0000, v48
    v_cvt_pk_bf16_f32 v48, v180, v181
    v_lshlrev_b32 v180, 16, v48
    v_and_b32 v181, 0xffff0000, v48
    v_cvt_pk_bf16_f32 v48, v182, v183
    v_lshlrev_b32 v182, 16, v48
    v_and_b32 v183, 0xffff0000, v48
    v_pk_add_f32 v[48:49], v[168:169], v[170:171]
    v_pk_add_f32 v[48:49], v[48:49], v[172:173]
    v_pk_add_f32 v[48:49], v[48:49], v[174:175]
    v_pk_add_f32 v[48:49], v[48:49], v[176:177]
    v_pk_add_f32 v[48:49], v[48:49], v[178:179]
    v_pk_add_f32 v[48:49], v[48:49], v[180:181]
    v_pk_add_f32 v[48:49], v[48:49], v[182:183]
    v_add_f32 v24, v40, v41
    v_add_f32 v28, v48, v49
    s_nop 1
    v_permlane32_swap_b32 v24, v28
    v_add_f32 v24, v24, v28
    s_nop 1
    v_add_f32_dpp v24, v24, v24 row_ror:8 row_mask:0xf bank_mask:0xf
    s_nop 1
    v_add_f32_dpp v24, v24, v24 row_ror:4 row_mask:0xf bank_mask:0xf
    s_nop 1
    v_add_f32_dpp v24, v24, v24 row_ror:2 row_mask:0xf bank_mask:0xf
    s_nop 1
    v_add_f32_dpp v24, v24, v24 row_ror:1 row_mask:0xf bank_mask:0xf
    s_nop 1
    v_add_f32_dpp v24, v24, v24 row_bcast:15 row_mask:0xa bank_mask:0xf
    v_mul_f32 v27, 0x3a800000, v24
    v_cvt_pk_bf16_f32 v24, v27, v27
    v_lshlrev_b32 v24, 16, v24
    v_sub_f32 v27, v27, v24
    v_readlane_b32 s56, v24, 31
    v_readlane_b32 s58, v24, 63
    s_nop 0
    v_pk_add_f32 v[56:57], v[152:153], s[56:57] op_sel:[0,0] op_sel_hi:[1,0] neg_lo:[0,1] neg_hi:[0,1]
    v_pk_add_f32 v[58:59], v[154:155], s[56:57] op_sel:[0,0] op_sel_hi:[1,0] neg_lo:[0,1] neg_hi:[0,1]
    v_pk_add_f32 v[60:61], v[156:157], s[56:57] op_sel:[0,0] op_sel_hi:[1,0] neg_lo:[0,1] neg_hi:[0,1]
    v_pk_add_f32 v[62:63], v[158:159], s[56:57] op_sel:[0,0] op_sel_hi:[1,0] neg_lo:[0,1] neg_hi:[0,1]
    v_pk_add_f32 v[64:65], v[160:161], s[56:57] op_sel:[0,0] op_sel_hi:[1,0] neg_lo:[0,1] neg_hi:[0,1]
    v_pk_add_f32 v[66:67], v[162:163], s[56:57] op_sel:[0,0] op_sel_hi:[1,0] neg_lo:[0,1] neg_hi:[0,1]
    v_pk_add_f32 v[68:69], v[164:165], s[56:57] op_sel:[0,0] op_sel_hi:[1,0] neg_lo:[0,1] neg_hi:[0,1]
    v_pk_add_f32 v[70:71], v[166:167], s[56:57] op_sel:[0,0] op_sel_hi:[1,0] neg_lo:[0,1] neg_hi:[0,1]
    v_pk_add_f32 v[72:73], v[168:169], s[58:59] op_sel:[0,0] op_sel_hi:[1,0] neg_lo:[0,1] neg_hi:[0,1]
    v_pk_add_f32 v[74:75], v[170:171], s[58:59] op_sel:[0,0] op_sel_hi:[1,0] neg_lo:[0,1] neg_hi:[0,1]
    v_pk_add_f32 v[76:77], v[172:173], s[58:59] op_sel:[0,0] op_sel_hi:[1,0] neg_lo:[0,1] neg_hi:[0,1]
    v_pk_add_f32 v[78:79], v[174:175], s[58:59] op_sel:[0,0] op_sel_hi:[1,0] neg_lo:[0,1] neg_hi:[0,1]
    v_pk_add_f32 v[80:81], v[176:177], s[58:59] op_sel:[0,0] op_sel_hi:[1,0] neg_lo:[0,1] neg_hi:[0,1]
    v_pk_add_f32 v[82:83], v[178:179], s[58:59] op_sel:[0,0] op_sel_hi:[1,0] neg_lo:[0,1] neg_hi:[0,1]
    v_pk_add_f32 v[84:85], v[180:181], s[58:59] op_sel:[0,0] op_sel_hi:[1,0] neg_lo:[0,1] neg_hi:[0,1]
    v_pk_add_f32 v[86:87], v[182:183], s[58:59] op_sel:[0,0] op_sel_hi:[1,0] neg_lo:[0,1] neg_hi:[0,1]
    v_mov_b32 v31, v30
    v_pk_mul_f32 v[42:43], v[70:71], v[70:71]
    v_pk_mul_f32 v[44:45], v[70:71], v[230:231]
    v_pk_mul_f32 v[50:51], v[86:87], v[86:87]
    v_pk_mul_f32 v[52:53], v[86:87], v[246:247]
    v_pk_fma_f32 v[42:43], v[68:69], v[68:69], v[42:43]
    v_pk_fma_f32 v[44:45], v[68:69], v[228:229], v[44:45]
    v_pk_fma_f32 v[50:51], v[84:85], v[84:85], v[50:51]
    v_pk_fma_f32 v[52:53], v[84:85], v[244:245], v[52:53]
    v_pk_fma_f32 v[42:43], v[66:67], v[66:67], v[42:43]
    v_pk_fma_f32 v[44:45], v[66:67], v[226:227], v[44:45]
    v_pk_fma_f32 v[50:51], v[82:83], v[82:83], v[50:51]
    v_pk_fma_f32 v[52:53], v[82:83], v[242:243], v[52:53]
    v_pk_fma_f32 v[42:43], v[64:65], v[64:65], v[42:43]
    v_pk_fma_f32 v[44:45], v[64:65], v[224:225], v[44:45]
    v_pk_fma_f32 v[50:51], v[80:81], v[80:81], v[50:51]
    v_pk_fma_f32 v[52:53], v[80:81], v[240:241], v[52:53]
    v_pk_fma_f32 v[42:43], v[62:63], v[62:63], v[42:43]
    v_pk_fma_f32 v[44:45], v[62:63], v[222:223], v[44:45]
    v_pk_fma_f32 v[50:51], v[78:79], v[78:79], v[50:51]
    v_pk_fma_f32 v[52:53], v[78:79], v[238:239], v[52:53]
    v_pk_fma_f32 v[42:43], v[60:61], v[60:61], v[42:43]
    v_pk_fma_f32 v[44:45], v[60:61], v[220:221], v[44:45]
    v_pk_fma_f32 v[50:51], v[76:77], v[76:77], v[50:51]
    v_pk_fma_f32 v[52:53], v[76:77], v[236:237], v[52:53]
    v_pk_fma_f32 v[42:43], v[58:59], v[58:59], v[42:43]
    v_pk_fma_f32 v[44:45], v[58:59], v[218:219], v[44:45]
    v_pk_fma_f32 v[50:51], v[74:75], v[74:75], v[50:51]
    v_pk_fma_f32 v[52:53], v[74:75], v[234:235], v[52:53]
    v_pk_fma_f32 v[42:43], v[56:57], v[56:57], v[42:43]
    v_pk_fma_f32 v[44:45], v[56:57], v[216:217], v[44:45]
    v_pk_fma_f32 v[50:51], v[72:73], v[72:73], v[50:51]
    v_pk_fma_f32 v[52:53], v[72:73], v[232:233], v[52:53]
    v_add_f32 v25, v42, v43
    v_add_f32 v26, v44, v45
    v_add_f32 v29, v50, v51
    v_add_f32 v30, v52, v53
    s_nop 0
    v_permlane32_swap_b32 v25, v29
    v_permlane32_swap_b32 v26, v30
    v_add_f32 v25, v25, v29
    v_add_f32 v26, v26, v30
    s_nop 0
    v_add_f32_dpp v25, v25, v25 row_ror:8 row_mask:0xf bank_mask:0xf
    v_add_f32_dpp v26, v26, v26 row_ror:8 row_mask:0xf bank_mask:0xf
    s_nop 0
    v_add_f32_dpp v25, v25, v25 row_ror:4 row_mask:0xf bank_mask:0xf
    v_add_f32_dpp v26, v26, v26 row_ror:4 row_mask:0xf bank_mask:0xf
    s_nop 0
    v_add_f32_dpp v25, v25, v25 row_ror:2 row_mask:0xf bank_mask:0xf
    v_add_f32_dpp v26, v26, v26 row_ror:2 row_mask:0xf bank_mask:0xf
    s_nop 0
    v_add_f32_dpp v25, v25, v25 row_ror:1 row_mask:0xf bank_mask:0xf
    v_add_f32_dpp v26, v26, v26 row_ror:1 row_mask:0xf bank_mask:0xf
    s_nop 0
    v_add_f32_dpp v25, v25, v25 row_bcast:15 row_mask:0xa bank_mask:0xf
    v_add_f32_dpp v26, v26, v26 row_bcast:15 row_mask:0xa bank_mask:0xf
    v_mul_f32 v25, 0x3a800000, v25
    v_fma_f32 v25, -v27, v27, v25
    v_max_f32 v25, 0, v25
    v_mov_b32 v30, v31
    s_branch f_var2
f_slowvar:
    v_lshlrev_b32 v118, 16, v117
    s_nop 0
    v_readlane_b32 s44, v118, 31
    v_readlane_b32 s46, v118, 63
    v_lshlrev_b32 v120, 16, v64
    v_and_b32 v121, 0xffff0000, v64
    v_pk_add_f32 v[120:121], v[120:121], s[44:45] op_sel_hi:[1,0]
    v_pk_mul_f32 v[122:123], v[120:121], v[120:121]
    v_lshlrev_b32 v120, 16, v65
    v_and_b32 v121, 0xffff0000, v65
    v_pk_add_f32 v[120:121], v[120:121], s[44:45] op_sel_hi:[1,0]
    v_pk_fma_f32 v[122:123], v[120:121], v[120:121], v[122:123]
    v_lshlrev_b32 v120, 16, v66
    v_and_b32 v121, 0xffff0000, v66
    v_pk_add_f32 v[120:121], v[120:121], s[44:45] op_sel_hi:[1,0]
    v_pk_fma_f32 v[122:123], v[120:121], v[120:121], v[122:123]
    v_lshlrev_b32 v120, 16, v67
    v_and_b32 v121, 0xffff0000, v67
    v_pk_add_f32 v[120:121], v[120:121], s[44:45] op_sel_hi:[1,0]
    v_pk_fma_f32 v[122:123], v[120:121], v[120:121], v[122:123]
    v_lshlrev_b32 v120, 16, v68
    v_and_b32 v121, 0xffff0000, v68
    v_pk_add_f32 v[120:121], v[120:121], s[44:45] op_sel_hi:[1,0]
    v_pk_fma_f32 v[122:123], v[120:121], v[120:121], v[122:123]
    v_lshlrev_b32 v120, 16, v69
    v_and_b32 v121, 0xffff0000, v69
    v_pk_add_f32 v[120:121], v[120:121], s[44:45] op_sel_hi:[1,0]
    v_pk_fma_f32 v[122:123], v[120:121], v[120:121], v[122:123]
    v_lshlrev_b32 v120, 16, v70
    v_and_b32 v121, 0xffff0000, v70
    v_pk_add_f32 v[120:121], v[120:121], s[44:45] op_sel_hi:[1,0]
    v_pk_fma_f32 v[122:123], v[120:121], v[120:121], v[122:123]
    v_lshlrev_b32 v120, 16, v71
    v_and_b32 v121, 0xffff0000, v71
    v_pk_add_f32 v[120:121], v[120:121], s[44:45] op_sel_hi:[1,0]
    v_pk_fma_f32 v[122:123], v[120:121], v[120:121], v[122:123]
    v_add_f32 v110, v122, v123
    v_lshlrev_b32 v120, 16, v72
    v_and_b32 v121, 0xffff0000, v72
    v_pk_add_f32 v[120:121], v[120:121], s[46:47] op_sel_hi:[1,0]
    v_pk_mul_f32 v[122:123], v[120:121], v[120:121]
    v_lshlrev_b32 v120, 16, v73
    v_and_b32 v121, 0xffff0000, v73
    v_pk_add_f32 v[120:121], v[120:121], s[46:47] op_sel_hi:[1,0]
    v_pk_fma_f32 v[122:123], v[120:121], v[120:121], v[122:123]
    v_lshlrev_b32 v120, 16, v74
    v_and_b32 v121, 0xffff0000, v74
    v_pk_add_f32 v[120:121], v[120:121], s[46:47] op_sel_hi:[1,0]
    v_pk_fma_f32 v[122:123], v[120:121], v[120:121], v[122:123]
    v_lshlrev_b32 v120, 16, v75
    v_and_b32 v121, 0xffff0000, v75
    v_pk_add_f32 v[120:121], v[120:121], s[46:47] op_sel_hi:[1,0]
    v_pk_fma_f32 v[122:123], v[120:121], v[120:121], v[122:123]
    v_lshlrev_b32 v120, 16, v76
    v_and_b32 v121, 0xffff0000, v76
    v_pk_add_f32 v[120:121], v[120:121], s[46:47] op_sel_hi:[1,0]
    v_pk_fma_f32 v[122:123], v[120:121], v[120:121], v[122:123]
    v_lshlrev_b32 v120, 16, v77
    v_and_b32 v121, 0xffff0000, v77
    v_pk_add_f32 v[120:121], v[120:121], s[46:47] op_sel_hi:[1,0]
    v_pk_fma_f32 v[122:123], v[120:121], v[120:121], v[122:123]
    v_lshlrev_b32 v120, 16, v78
    v_and_b32 v121, 0xffff0000, v78
    v_pk_add_f32 v[120:121], v[120:121], s[46:47] op_sel_hi:[1,0]
    v_pk_fma_f32 v[122:123], v[120:121], v[120:121], v[122:123]
    v_lshlrev_b32 v120, 16, v79
    v_and_b32 v121, 0xffff0000, v79
    v_pk_add_f32 v[120:121], v[120:121], s[46:47] op_sel_hi:[1,0]
    v_pk_fma_f32 v[122:123], v[120:121], v[120:121], v[122:123]
    v_add_f32 v111, v122, v123
    v_add_f32 v118, v118, v108
    s_nop 0
    v_permlane32_swap_b32 v110, v111
    v_add_f32 v110, v110, v111
    s_nop 1
    v_add_f32_dpp v110, v110, v110 row_ror:8 row_mask:0xf bank_mask:0xf
    s_nop 1
    v_add_f32_dpp v110, v110, v110 row_ror:4 row_mask:0xf bank_mask:0xf
    s_nop 1
    v_add_f32_dpp v110, v110, v110 row_ror:2 row_mask:0xf bank_mask:0xf
    s_nop 1
    v_add_f32_dpp v110, v110, v110 row_ror:1 row_mask:0xf bank_mask:0xf
    s_nop 1
    v_add_f32_dpp v110, v110, v110 row_bcast:15 row_mask:0xa bank_mask:0xf
    v_mul_f32 v110, s5, v110
    v_fma_f32 v110, -v118, v118, v110
    v_max_f32 v110, 0, v110
    s_branch f_var
f_sp:
    s_setprio 2
    ds_read_b128 v[56:59], v3 offset:0
    ds_read_b128 v[60:63], v3 offset:1024
    ds_read_b128 v[64:67], v3 offset:2048
    ds_read_b128 v[68:71], v3 offset:3072
    v_and_b32 v12, 31, v0
    v_lshlrev_b32 v12, 2, v12
    v_and_b32 v17, 32, v0
    v_lshl_add_u32 v12, v17, 4, v12
    v_sub_u32 v20, 4096, v12
    v_add_u32 v12, 4096, v12
    v_add_u32 v17, 128, v12
    v_add_u32 v21, 128, v20
    s_waitcnt lgkmcnt(3)
    v_pk_fma_f16 v40, v24, v248, v56 op_sel:[0,0,0] op_sel_hi:[1,0,1]
    v_pk_fma_f16 v41, v25, v248, v57 op_sel:[0,1,0] op_sel_hi:[1,1,1]
    v_pk_fma_f16 v42, v26, v249, v58 op_sel:[0,0,0] op_sel_hi:[1,0,1]
    v_pk_fma_f16 v43, v27, v249, v59 op_sel:[0,1,0] op_sel_hi:[1,1,1]
    ds_write2st64_b32 v12, v40, v42 offset0:0 offset1:1
    ds_write2st64_b32 v17, v41, v43 offset0:0 offset1:1
    s_waitcnt lgkmcnt(4)
    v_pk_fma_f16 v44, v28, v250, v60 op_sel:[0,0,0] op_sel_hi:[1,0,1]
    v_pk_fma_f16 v45, v29, v250, v61 op_sel:[0,1,0] op_sel_hi:[1,1,1]
    v_pk_fma_f16 v46, v30, v251, v62 op_sel:[0,0,0] op_sel_hi:[1,0,1]
    v_pk_fma_f16 v47, v31, v251, v63 op_sel:[0,1,0] op_sel_hi:[1,1,1]
    ds_write2st64_b32 v12, v44, v46 offset0:4 offset1:5
    ds_write2st64_b32 v17, v45, v47 offset0:4 offset1:5
    s_waitcnt lgkmcnt(5)
    v_pk_fma_f16 v48, v32, v252, v64 op_sel:[0,0,0] op_sel_hi:[1,0,1]
    v_pk_fma_f16 v49, v33, v252, v65 op_sel:[0,1,0] op_sel_hi:[1,1,1]
    v_pk_fma_f16 v50, v34, v253, v66 op_sel:[0,0,0] op_sel_hi:[1,0,1]
    v_pk_fma_f16 v51, v35, v253, v67 op_sel:[0,1,0] op_sel_hi:[1,1,1]
    ds_write2st64_b32 v12, v48, v50 offset0:8 offset1:9
    ds_write2st64_b32 v17, v49, v51 offset0:8 offset1:9
    s_waitcnt lgkmcnt(6)
    v_pk_fma_f16 v52, v36, v254, v68 op_sel:[0,0,0] op_sel_hi:[1,0,1]
    v_pk_fma_f16 v53, v37, v254, v69 op_sel:[0,1,0] op_sel_hi:[1,1,1]
    v_pk_fma_f16 v54, v38, v255, v70 op_sel:[0,0,0] op_sel_hi:[1,0,1]
    v_pk_fma_f16 v55, v39, v255, v71 op_sel:[0,1,0] op_sel_hi:[1,1,1]
    ds_write2st64_b32 v12, v52, v54 offset0:12 offset1:13
    ds_write2st64_b32 v17, v53, v55 offset0:12 offset1:13
    s_mov_b64 exec, 1
    ds_write_b32 v12, v40 offset:4096
    s_mov_b64 exec, -1
    ds_read2st64_b32 v[72:73], v20 offset0:16 offset1:15
    ds_read2st64_b32 v[74:75], v21 offset0:15 offset1:14
    ds_read2st64_b32 v[76:77], v20 offset0:12 offset1:11
    ds_read2st64_b32 v[78:79], v21 offset0:11 offset1:10
    ds_read2st64_b32 v[80:81], v20 offset0:8 offset1:7
    ds_read2st64_b32 v[82:83], v21 offset0:7 offset1:6
    ds_read2st64_b32 v[84:85], v20 offset0:4 offset1:3
    ds_read2st64_b32 v[86:87], v21 offset0:3 offset1:2
    s_waitcnt lgkmcnt(6)
    v_pk_add_f16 v40, v40, v72
    v_pk_add_f16 v41, v41, v74
    v_pk_add_f16 v42, v42, v73
    v_pk_add_f16 v43, v43, v75
    s_waitcnt lgkmcnt(4)
    v_pk_add_f16 v44, v44, v76
    v_pk_add_f16 v45, v45, v78
    v_pk_add_f16 v46, v46, v77
    v_pk_add_f16 v47, v47, v79
    s_waitcnt lgkmcnt(2)
    v_pk_add_f16 v48, v48, v80
    v_pk_add_f16 v49, v49, v82
    v_pk_add_f16 v50, v50, v81
    v_pk_add_f16 v51, v51, v83
    s_waitcnt lgkmcnt(0)
    v_pk_add_f16 v52, v52, v84
    v_pk_add_f16 v53, v53, v86
    v_pk_add_f16 v54, v54, v85
    v_pk_add_f16 v55, v55, v87
    v_mfma_f32_32x32x16_f16 v[56:71], v[40:43], v[88:91], 0
    v_mfma_f32_32x32x16_f16 v[72:87], v[40:43], v[104:107], 0
    v_mfma_f32_32x32x16_f16 v[56:71], v[44:47], v[92:95], v[56:71]
    v_mfma_f32_32x32x16_f16 v[72:87], v[44:47], v[108:111], v[72:87]
    s_branch f_st1
f_sp2:
    s_nop 9
    v_pk_mul_f32 v[24:25], v[56:57], v[120:121]
    v_pk_mul_f32 v[28:29], v[72:73], v[120:121]
    v_pk_mul_f32 v[26:27], v[58:59], v[122:123]
    v_pk_mul_f32 v[30:31], v[74:75], v[122:123]
    v_pk_fma_f32 v[24:25], v[72:73], v[136:137], v[24:25]
    v_pk_fma_f32 v[28:29], v[56:57], v[136:137], v[28:29] neg_lo:[1,0,0] neg_hi:[1,0,0]
    v_pk_fma_f32 v[26:27], v[74:75], v[138:139], v[26:27]
    v_pk_fma_f32 v[30:31], v[58:59], v[138:139], v[30:31] neg_lo:[1,0,0] neg_hi:[1,0,0]
    v_cvt_pk_f16_f32 v40, v24, v28
    v_cvt_pk_f16_f32 v41, v25, v29
    v_cvt_pk_f16_f32 v42, v26, v30
    v_cvt_pk_f16_f32 v43, v27, v31
    v_pk_mul_f32 v[32:33], v[60:61], v[124:125]
    v_pk_mul_f32 v[36:37], v[76:77], v[124:125]
    v_pk_mul_f32 v[34:35], v[62:63], v[126:127]
    v_pk_mul_f32 v[38:39], v[78:79], v[126:127]
    v_pk_fma_f32 v[32:33], v[76:77], v[140:141], v[32:33]
    v_pk_fma_f32 v[36:37], v[60:61], v[140:141], v[36:37] neg_lo:[1,0,0] neg_hi:[1,0,0]
    v_pk_fma_f32 v[34:35], v[78:79], v[142:143], v[34:35]
    v_pk_fma_f32 v[38:39], v[62:63], v[142:143], v[38:39] neg_lo:[1,0,0] neg_hi:[1,0,0]
    v_cvt_pk_f16_f32 v44, v32, v36
    v_cvt_pk_f16_f32 v45, v33, v37
    v_cvt_pk_f16_f32 v46, v34, v38
    v_cvt_pk_f16_f32 v47, v35, v39
    v_mfma_f32_32x32x16_f16 v[216:231], v[40:43], v[88:91], 0
    v_mfma_f32_32x32x16_f16 v[232:247], v[40:43], v[104:107], 0
    v_pk_mul_f32 v[24:25], v[64:65], v[128:129]
    v_pk_mul_f32 v[28:29], v[80:81], v[128:129]
    v_pk_mul_f32 v[26:27], v[66:67], v[130:131]
    v_pk_mul_f32 v[30:31], v[82:83], v[130:131]
    v_pk_fma_f32 v[24:25], v[80:81], v[144:145], v[24:25]
    v_pk_fma_f32 v[28:29], v[64:65], v[144:145], v[28:29] neg_lo:[1,0,0] neg_hi:[1,0,0]
    v_pk_fma_f32 v[26:27], v[82:83], v[146:147], v[26:27]
    v_pk_fma_f32 v[30:31], v[66:67], v[146:147], v[30:31] neg_lo:[1,0,0] neg_hi:[1,0,0]
    v_cvt_pk_f16_f32 v48, v24, v28
    v_cvt_pk_f16_f32 v49, v25, v29
    v_cvt_pk_f16_f32 v50, v26, v30
    v_cvt_pk_f16_f32 v51, v27, v31
    v_mfma_f32_32x32x16_f16 v[216:231], v[44:47], v[92:95], v[216:231]
    v_mfma_f32_32x32x16_f16 v[232:247], v[44:47], v[108:111], v[232:247]
    v_pk_mul_f32 v[32:33], v[68:69], v[132:133]
    v_pk_mul_f32 v[36:37], v[84:85], v[132:133]
    v_pk_mul_f32 v[34:35], v[70:71], v[134:135]
    v_pk_mul_f32 v[38:39], v[86:87], v[134:135]
    v_pk_fma_f32 v[32:33], v[84:85], v[148:149], v[32:33]
    v_pk_fma_f32 v[36:37], v[68:69], v[148:149], v[36:37] neg_lo:[1,0,0] neg_hi:[1,0,0]
    v_pk_fma_f32 v[34:35], v[86:87], v[150:151], v[34:35]
    v_pk_fma_f32 v[38:39], v[70:71], v[150:151], v[38:39] neg_lo:[1,0,0] neg_hi:[1,0,0]
    v_cvt_pk_f16_f32 v52, v32, v36
    v_cvt_pk_f16_f32 v53, v33, v37
    v_cvt_pk_f16_f32 v54, v34, v38
    v_cvt_pk_f16_f32 v55, v35, v39
    v_mfma_f32_32x32x16_f16 v[216:231], v[48:51], v[96:99], v[216:231]
    v_mfma_f32_32x32x16_f16 v[232:247], v[48:51], v[112:115], v[232:247]
    v_mfma_f32_32x32x16_f16 v[232:247], v[52:55], v[116:119], v[232:247]
    v_mfma_f32_32x32x16_f16 v[216:231], v[52:55], v[100:103], v[216:231]
    s_nop 10
    ds_bpermute_b32 v12, v19, v232
    s_waitcnt lgkmcnt(1)
    v_pk_fma_f32 v[152:153], v[184:185], v[216:217], v[152:153]
    v_pk_fma_f32 v[154:155], v[186:187], v[218:219], v[154:155]
    v_pk_fma_f32 v[156:157], v[188:189], v[220:221], v[156:157]
    v_pk_fma_f32 v[158:159], v[190:191], v[222:223], v[158:159]
    v_pk_fma_f32 v[160:161], v[192:193], v[224:225], v[160:161]
    v_pk_fma_f32 v[162:163], v[194:195], v[226:227], v[162:163]
    v_pk_fma_f32 v[164:165], v[196:197], v[228:229], v[164:165]
    v_pk_fma_f32 v[166:167], v[198:199], v[230:231], v[166:167]
    v_pk_fma_f32 v[170:171], v[202:203], v[234:235], v[170:171]
    v_pk_fma_f32 v[172:173], v[204:205], v[236:237], v[172:173]
    v_pk_fma_f32 v[174:175], v[206:207], v[238:239], v[174:175]
    v_pk_fma_f32 v[176:177], v[208:209], v[240:241], v[176:177]
    v_pk_fma_f32 v[178:179], v[210:211], v[242:243], v[178:179]
    v_pk_fma_f32 v[180:181], v[212:213], v[244:245], v[180:181]
    v_pk_fma_f32 v[182:183], v[214:215], v[246:247], v[182:183]
    v_fmac_f32 v169, v201, v233
    s_waitcnt lgkmcnt(0)
    v_fmac_f32 v168, v200, v12
    ds_read_b128 v[216:219], v3 offset:28672
    ds_read_b128 v[220:223], v3 offset:29696
    ds_read_b128 v[224:227], v3 offset:30720
    ds_read_b128 v[228:231], v3 offset:31744
    ds_read_b128 v[232:235], v3 offset:32768
    ds_read_b128 v[236:239], v3 offset:33792
    ds_read_b128 v[240:243], v3 offset:34816
    ds_read_b128 v[244:247], v3 offset:35840
    s_waitcnt lgkmcnt(0)
    s_setprio 0
    s_branch f_join
k_done:
    s_endpgm
code_end:
.p2align 8
.type tables,@object
tables:
.long 0x3c00,0x3c00,0x3c00,0x3c00,0x3c008000,0x3c008000,0x3c008000,0x3c008000
.long 0x3c00,0x361f3b64,0x39a839a8,0x3b64361f,0x3c008000,0x3b64b61f,0x39a8b9a8,0x361fbb64
.long 0x3c00,0x39a839a8,0x3c000000,0x39a8b9a8,0x3c008000,0x39a8b9a8,0xbc00,0xb9a8b9a8
.long 0x3c00,0x3b64361f,0x39a8b9a8,0xb61fbb64,0x3c008000,0x361fbb64,0xb9a8b9a8,0xbb64361f
.long 0x3c00,0x3c000000,0xbc00,0xbc008000,0x3c008000,0xbc00,0xbc008000,0x80003c00
.long 0x3c00,0x3b64b61f,0xb9a8b9a8,0xb61f3b64,0x3c008000,0xb61fbb64,0xb9a839a8,0x3b64361f
.long 0x3c00,0x39a8b9a8,0xbc008000,0x39a839a8,0x3c008000,0xb9a8b9a8,0x80003c00,0x39a8b9a8
.long 0x3c00,0x361fbb64,0xb9a839a8,0x3b64b61f,0x3c008000,0xbb64b61f,0x39a839a8,0xb61fbb64
.long 0x3c00,0x3c00,0x3c00,0x3c00,0x3c008000,0x3c008000,0x3c008000,0x3c008000
.long 0x39a8b9a8,0x361fbb64,0x3c000000,0x3b64b61f,0xb9a8b9a8,0xbb64b61f,0xbc00,0xb61fbb64
.long 0xbc008000,0xb9a839a8,0xbc00,0xb9a8b9a8,0x80003c00,0x39a839a8,0xbc008000,0xb9a839a8
.long 0x39a839a8,0x3b64b61f,0xbc008000,0xb61f3b64,0x39a8b9a8,0xb61fbb64,0x80003c00,0x3b64361f
.long 0xbc00,0xbc008000,0x3c00,0x3c000000,0xbc008000,0x80003c00,0x3c008000,0xbc00
.long 0xb9a839a8,0x3b64361f,0x3c000000,0xb61fbb64,0x39a839a8,0x361fbb64,0xbc00,0xbb64361f
.long 0x3c000000,0xb9a8b9a8,0xbc00,0xb9a839a8,0xbc00,0xb9a839a8,0xbc008000,0x39a839a8
.long 0xb9a8b9a8,0x361f3b64,0xbc008000,0x3b64361f,0xb9a839a8,0x3b64b61f,0x80003c00,0x361fbb64
.long 0x3c00,0x3c00,0x3c00,0x3c00,0x3c008000,0x3c008000,0x3c008000,0x3c008000
.long 0xbc00,0xb61fbb64,0xb9a8b9a8,0xbb64b61f,0xbc008000,0xbb64361f,0xb9a839a8,0xb61f3b64
.long 0x3c00,0x39a839a8,0x3c000000,0x39a8b9a8,0x3c008000,0x39a8b9a8,0xbc00,0xb9a8b9a8
.long 0xbc00,0xbb64b61f,0xb9a839a8,0x361f3b64,0xbc008000,0xb61f3b64,0x39a839a8,0x3b64b61f
.long 0x3c00,0x3c000000,0xbc00,0xbc008000,0x3c008000,0xbc00,0xbc008000,0x80003c00
.long 0xbc00,0xbb64361f,0x39a839a8,0x361fbb64,0xbc008000,0x361f3b64,0x39a8b9a8,0xbb64b61f
.long 0x3c00,0x39a8b9a8,0xbc008000,0x39a839a8,0x3c008000,0xb9a8b9a8,0x80003c00,0x39a8b9a8
.long 0xbc00,0xb61f3b64,0x39a8b9a8,0xbb64361f,0xbc008000,0x3b64361f,0xb9a8b9a8,0x361f3b64
.long 0x3c00,0x3c00,0x3c00,0x3c00,0x3c008000,0x3c008000,0x3c008000,0x3c008000
.long 0xb9a839a8,0xb61f3b64,0xbc008000,0xbb64361f,0x39a839a8,0x3b64361f,0x80003c00,0x361f3b64
.long 0xbc008000,0xb9a839a8,0xbc00,0xb9a8b9a8,0x80003c00,0x39a839a8,0xbc008000,0xb9a839a8
.long 0xb9a8b9a8,0xbb64361f,0x3c000000,0x361fbb64,0xb9a839a8,0x361f3b64,0xbc00,0xbb64b61f
.long 0xbc00,0xbc008000,0x3c00,0x3c000000,0xbc008000,0x80003c00,0x3c008000,0xbc00
.long 0x39a8b9a8,0xbb64b61f,0xbc008000,0x361f3b64,0xb9a8b9a8,0xb61f3b64,0x80003c00,0x3b64b61f
.long 0x3c000000,0xb9a8b9a8,0xbc00,0xb9a839a8,0xbc00,0xb9a839a8,0xbc008000,0x39a839a8
.long 0x39a839a8,0xb61fbb64,0x3c000000,0xbb64b61f,0x39a8b9a8,0xbb64361f,0xbc00,0xb61f3b64
.long 0x3c00,0xbc00,0x3c00,0xbc00,0x3c008000,0xbc008000,0x3c008000,0xbc008000
.long 0x3c00,0xb61fbb64,0x39a839a8,0xbb64b61f,0x3c008000,0xbb64361f,0x39a8b9a8,0xb61f3b64
.long 0x3c00,0xb9a8b9a8,0x3c000000,0xb9a839a8,0x3c008000,0xb9a839a8,0xbc00,0x39a839a8
.long 0x3c00,0xbb64b61f,0x39a8b9a8,0x361f3b64,0x3c008000,0xb61f3b64,0xb9a8b9a8,0x3b64b61f
.long 0x3c00,0xbc008000,0xbc00,0x3c000000,0x3c008000,0x80003c00,0xbc008000,0xbc00
.long 0x3c00,0xbb64361f,0xb9a8b9a8,0x361fbb64,0x3c008000,0x361f3b64,0xb9a839a8,0xbb64b61f
.long 0x3c00,0xb9a839a8,0xbc008000,0xb9a8b9a8,0x3c008000,0x39a839a8,0x80003c00,0xb9a839a8
.long 0x3c00,0xb61f3b64,0xb9a839a8,0xbb64361f,0x3c008000,0x3b64361f,0x39a839a8,0x361f3b64
.long 0x3c00,0xbc00,0x3c00,0xbc00,0x3c008000,0xbc008000,0x3c008000,0xbc008000
.long 0x39a8b9a8,0xb61f3b64,0x3c000000,0xbb64361f,0xb9a8b9a8,0x3b64361f,0xbc00,0x361f3b64
.long 0xbc008000,0x39a8b9a8,0xbc00,0x39a839a8,0x80003c00,0xb9a8b9a8,0xbc008000,0x39a8b9a8
.long 0x39a839a8,0xbb64361f,0xbc008000,0x361fbb64,0x39a8b9a8,0x361f3b64,0x80003c00,0xbb64b61f
.long 0xbc00,0x3c000000,0x3c00,0xbc008000,0xbc008000,0xbc00,0x3c008000,0x80003c00
.long 0xb9a839a8,0xbb64b61f,0x3c000000,0x361f3b64,0x39a839a8,0xb61f3b64,0xbc00,0x3b64b61f
.long 0x3c000000,0x39a839a8,0xbc00,0x39a8b9a8,0xbc00,0x39a8b9a8,0xbc008000,0xb9a8b9a8
.long 0xb9a8b9a8,0xb61fbb64,0xbc008000,0xbb64b61f,0xb9a839a8,0xbb64361f,0x80003c00,0xb61f3b64
.long 0x3c00,0xbc00,0x3c00,0xbc00,0x3c008000,0xbc008000,0x3c008000,0xbc008000
.long 0xbc00,0x361f3b64,0xb9a8b9a8,0x3b64361f,0xbc008000,0x3b64b61f,0xb9a839a8,0x361fbb64
.long 0x3c00,0xb9a8b9a8,0x3c000000,0xb9a839a8,0x3c008000,0xb9a839a8,0xbc00,0x39a839a8
.long 0xbc00,0x3b64361f,0xb9a839a8,0xb61fbb64,0xbc008000,0x361fbb64,0x39a839a8,0xbb64361f
.long 0x3c00,0xbc008000,0xbc00,0x3c000000,0x3c008000,0x80003c00,0xbc008000,0xbc00
.long 0xbc00,0x3b64b61f,0x39a839a8,0xb61f3b64,0xbc008000,0xb61fbb64,0x39a8b9a8,0x3b64361f
.long 0x3c00,0xb9a839a8,0xbc008000,0xb9a8b9a8,0x3c008000,0x39a839a8,0x80003c00,0xb9a839a8
.long 0xbc00,0x361fbb64,0x39a8b9a8,0x3b64b61f,0xbc008000,0xbb64b61f,0xb9a8b9a8,0xb61fbb64
.long 0x3c00,0xbc00,0x3c00,0xbc00,0x3c008000,0xbc008000,0x3c008000,0xbc008000
.long 0xb9a839a8,0x361fbb64,0xbc008000,0x3b64b61f,0x39a839a8,0xbb64b61f,0x80003c00,0xb61fbb64
.long 0xbc008000,0x39a8b9a8,0xbc00,0x39a839a8,0x80003c00,0xb9a8b9a8,0xbc008000,0x39a8b9a8
.long 0xb9a8b9a8,0x3b64b61f,0x3c000000,0xb61f3b64,0xb9a839a8,0xb61fbb64,0xbc00,0x3b64361f
.long 0xbc00,0x3c000000,0x3c00,0xbc008000,0xbc008000,0xbc00,0x3c008000,0x80003c00
.long 0x39a8b9a8,0x3b64361f,0xbc008000,0xb61fbb64,0xb9a8b9a8,0x361fbb64,0x80003c00,0xbb64361f
.long 0x3c000000,0x39a839a8,0xbc00,0x39a8b9a8,0xbc00,0x39a8b9a8,0xbc008000,0xb9a8b9a8
.long 0x39a839a8,0x361f3b64,0x3c000000,0x3b64361f,0x39a8b9a8,0x3b64b61f,0xbc00,0x361fbb64
.long 0x3c00,0x3c00,0x3c00,0x3c00,0x3c00,0xbc00,0x3c00,0xbc00
.long 0x3c00,0x3b64,0x39a8,0x361f,0x8000,0xb61f,0xb9a8,0xbb64
.long 0x3c00,0x39a8,0x0,0xb9a8,0x8000,0xb9a8,0xbc00,0xb9a8
.long 0x3c00,0x361f,0xb9a8,0xbb64,0x8000,0xbb64,0xb9a8,0x361f
.long 0x3c00,0x0,0xbc00,0x8000,0x8000,0xbc00,0x8000,0x3c00
.long 0x3c00,0xb61f,0xb9a8,0x3b64,0x8000,0xbb64,0x39a8,0x361f
.long 0x3c00,0xb9a8,0x8000,0x39a8,0x8000,0xb9a8,0x3c00,0xb9a8
.long 0x3c00,0xbb64,0x39a8,0xb61f,0x8000,0xb61f,0x39a8,0xbb64
.long 0x3c00,0x3c00,0x3c00,0x3c00,0x3c00,0xbc00,0x3c00,0xbc00
.long 0xb9a8,0xbb64,0x0,0xb61f,0xb9a8,0xb61f,0xbc00,0xbb64
.long 0x8000,0x39a8,0xbc00,0xb9a8,0x3c00,0x39a8,0x8000,0x39a8
.long 0x39a8,0xb61f,0x8000,0x3b64,0xb9a8,0xbb64,0x3c00,0x361f
.long 0xbc00,0x8000,0x3c00,0x0,0x8000,0x3c00,0x8000,0xbc00
.long 0x39a8,0x361f,0x0,0xbb64,0x39a8,0xbb64,0xbc00,0x361f
.long 0x0,0xb9a8,0xbc00,0x39a8,0xbc00,0x39a8,0x8000,0x39a8
.long 0xb9a8,0x3b64,0x8000,0x361f,0x39a8,0xb61f,0x3c00,0xbb64
.long 0x3c00,0x3c00,0x3c00,0x3c00,0x3c00,0xbc00,0x3c00,0xbc00
.long 0xbc00,0xbb64,0xb9a8,0xb61f,0x8000,0x361f,0x39a8,0x3b64
.long 0x3c00,0x39a8,0x0,0xb9a8,0x8000,0xb9a8,0xbc00,0xb9a8
.long 0xbc00,0xb61f,0x39a8,0x3b64,0x8000,0x3b64,0x39a8,0xb61f
.long 0x3c00,0x0,0xbc00,0x8000,0x8000,0xbc00,0x8000,0x3c00
.long 0xbc00,0x361f,0x39a8,0xbb64,0x8000,0x3b64,0xb9a8,0xb61f
.long 0x3c00,0xb9a8,0x8000,0x39a8,0x8000,0xb9a8,0x3c00,0xb9a8
.long 0xbc00,0x3b64,0xb9a8,0x361f,0x8000,0x361f,0xb9a8,0x3b64
.long 0x3c00,0x3c00,0x3c00,0x3c00,0x3c00,0xbc00,0x3c00,0xbc00
.long 0x39a8,0x3b64,0x8000,0x361f,0x39a8,0x361f,0x3c00,0x3b64
.long 0x8000,0x39a8,0xbc00,0xb9a8,0x3c00,0x39a8,0x8000,0x39a8
.long 0xb9a8,0x361f,0x0,0xbb64,0x39a8,0x3b64,0xbc00,0xb61f
.long 0xbc00,0x8000,0x3c00,0x0,0x8000,0x3c00,0x8000,0xbc00
.long 0xb9a8,0xb61f,0x8000,0x3b64,0xb9a8,0x3b64,0x3c00,0xb61f
.long 0x0,0xb9a8,0xbc00,0x39a8,0xbc00,0x39a8,0x8000,0x39a8
.long 0x39a8,0xbb64,0x0,0xb61f,0xb9a8,0x361f,0xbc00,0x3b64
.long 0x3c000000,0x3bd90000,0x3b640000,0x3aa70000,0x80000000,0xb23e0000,0xb61f0000,0xb8720000
.long 0x3c000000,0x3aa70000,0x361f0000,0xb23e0000,0x80000000,0xb8720000,0xbb640000,0xbbd90000
.long 0x3c000000,0x38720000,0xb61f0000,0xbbd90000,0x80000000,0xbaa70000,0xbb640000,0xb23e0000
.long 0x3c000000,0x323e0000,0xbb640000,0xb8720000,0x80000000,0xbbd90000,0xb61f0000,0x3aa70000
.long 0x3c000000,0xb23e0000,0xbb640000,0x38720000,0x80000000,0xbbd90000,0x361f0000,0x3aa70000
.long 0x3c000000,0xb8720000,0xb61f0000,0x3bd90000,0x80000000,0xbaa70000,0x3b640000,0xb23e0000
.long 0x3c000000,0xbaa70000,0x361f0000,0x323e0000,0x80000000,0xb8720000,0x3b640000,0xbbd90000
.long 0x3c000000,0xbbd90000,0x3b640000,0xbaa70000,0x80000000,0xb23e0000,0x361f0000,0xb8720000
.long 0x361f0000,0x323e0000,0x39a80000,0x38720000,0xbb640000,0xbbd90000,0xb9a80000,0xbaa70000
.long 0xbb640000,0xb8720000,0xb9a80000,0xbbd90000,0x361f0000,0x3aa70000,0xb9a80000,0xb23e0000
.long 0x3b640000,0x3aa70000,0xb9a80000,0x323e0000,0x361f0000,0xb8720000,0x39a80000,0x3bd90000
.long 0xb61f0000,0xbbd90000,0x39a80000,0x3aa70000,0xbb640000,0x323e0000,0x39a80000,0xb8720000
.long 0xb61f0000,0x3bd90000,0x39a80000,0xbaa70000,0x3b640000,0x323e0000,0xb9a80000,0xb8720000
.long 0x3b640000,0xbaa70000,0xb9a80000,0xb23e0000,0xb61f0000,0xb8720000,0xb9a80000,0x3bd90000
.long 0xbb640000,0x38720000,0xb9a80000,0x3bd90000,0xb61f0000,0x3aa70000,0x39a80000,0xb23e0000
.long 0x361f0000,0xb23e0000,0x39a80000,0xb8720000,0x3b640000,0xbbd90000,0x39a80000,0xbaa70000
.long 0x0,0xb23e0000,0xb61f0000,0xb8720000,0xbc000000,0xbbd90000,0xbb640000,0xbaa70000
.long 0x80000000,0x38720000,0x3b640000,0x3bd90000,0x3c000000,0x3aa70000,0x361f0000,0xb23e0000
.long 0x0,0xbaa70000,0xbb640000,0xb23e0000,0xbc000000,0xb8720000,0x361f0000,0x3bd90000
.long 0x80000000,0x3bd90000,0x361f0000,0xbaa70000,0x3c000000,0x323e0000,0xbb640000,0xb8720000
.long 0x0,0xbbd90000,0x361f0000,0x3aa70000,0xbc000000,0x323e0000,0x3b640000,0xb8720000
.long 0x80000000,0x3aa70000,0xbb640000,0x323e0000,0x3c000000,0xb8720000,0xb61f0000,0x3bd90000
.long 0x80000000,0xb8720000,0x3b640000,0xbbd90000,0xbc000000,0x3aa70000,0xb61f0000,0xb23e0000
.long 0x80000000,0x323e0000,0xb61f0000,0x38720000,0x3c000000,0xbbd90000,0x3b640000,0xbaa70000
.long 0xbb640000,0xbbd90000,0xb9a80000,0xbaa70000,0xb61f0000,0xb23e0000,0xb9a80000,0xb8720000
.long 0xb61f0000,0xbaa70000,0x39a80000,0x323e0000,0xbb640000,0xb8720000,0xb9a80000,0xbbd90000
.long 0x361f0000,0xb8720000,0x39a80000,0x3bd90000,0xbb640000,0xbaa70000,0x39a80000,0xb23e0000
.long 0x3b640000,0xb23e0000,0xb9a80000,0x38720000,0xb61f0000,0xbbd90000,0x39a80000,0x3aa70000
.long 0x3b640000,0x323e0000,0xb9a80000,0xb8720000,0x361f0000,0xbbd90000,0xb9a80000,0x3aa70000
.long 0x361f0000,0x38720000,0x39a80000,0xbbd90000,0x3b640000,0xbaa70000,0xb9a80000,0xb23e0000
.long 0xb61f0000,0x3aa70000,0x39a80000,0xb23e0000,0x3b640000,0xb8720000,0x39a80000,0xbbd90000
.long 0xbb640000,0x3bd90000,0xb9a80000,0x3aa70000,0x361f0000,0xb23e0000,0x39a80000,0xb8720000
.size tables, 4096
all_end:
.section .rodata,"a"
.p2align 6
.amdhsa_kernel adaLN_cond__spectral_fnet__moe_arch_mod__prompt_kernel
  .amdhsa_next_free_vgpr 256
  .amdhsa_next_free_sgpr 84
  .amdhsa_accum_offset 256
  .amdhsa_group_segment_fixed_size 0
  .amdhsa_kernarg_size 120
  .amdhsa_user_sgpr_count 2
  .amdhsa_user_sgpr_kernarg_segment_ptr 1
  .amdhsa_system_sgpr_workgroup_id_x 1
  .amdhsa_float_denorm_mode_32 3
  .amdhsa_float_denorm_mode_16_64 3
.end_amdhsa_kernel
```

```asm
; @launch grid=(256,1,1) block=(512,1,1) lds=163840
.amdgcn_target "amdgcn-amd-amdhsa--gfx950"
.text
.globl adaLN_cond__spectral_fnet__moe_arch_mod__prompt_kernel
.p2align 8
.type adaLN_cond__spectral_fnet__moe_arch_mod__prompt_kernel,@function
adaLN_cond__spectral_fnet__moe_arch_mod__prompt_kernel:
    s_cmp_ge_u32 s2, 256
    s_cbranch_scc1 k_done
    s_load_dwordx2 s[4:5], s[0:1], 0
    s_load_dwordx4 s[24:27], s[0:1], 96
    s_load_dwordx2 s[6:7], s[0:1], 112
    s_load_dwordx4 s[56:59], s[0:1], 80
    s_load_dwordx4 s[48:51], s[0:1], 48
    s_load_dwordx4 s[52:55], s[0:1], 64
    s_memrealtime s[32:33]
    v_lshrrev_b32 v1, 6, v0
    v_and_b32 v2, 63, v0
    v_readfirstlane_b32 s16, v1
    v_lshlrev_b32 v3, 4, v2
    v_mov_b32 v4, 0
    s_getpc_b64 s[36:37]
h_pc:
    s_and_b32 s34, s2, 7
    s_bfe_u32 s35, s2, 0x40003
    s_cmp_lg_u32 s16, 7
    s_cbranch_scc1 h_npf
    s_lshr_b32 s42, s2, 3
    s_lshl_b32 s42, s42, 11
    v_lshl_add_u32 v4, v2, 7, s42
    v_min_u32 v4, all_end-h_pc-4, v4
    s_mov_b64 exec, 0xffff
    global_load_dword v199, v4, s[36:37]
    s_mov_b64 exec, -1
h_npf:
    s_mov_b32 s11, 0x00020000
    s_mov_b32 s14, 268435456
    s_mov_b32 s15, 0x00020000
    s_bitcmp0_b32 s2, 7
    s_cbranch_scc1 g_start
    s_lshl_b32 s60, s16, 19
    s_lshl_b32 s61, s35, 15
    s_add_u32 s60, s60, s61
    s_lshl_b32 s61, s34, 11
    s_add_u32 s60, s60, s61
    s_add_u32 s61, s60, 16384
    s_lshl_b32 s62, s34, 11
    s_lshl_b32 s63, s35, 7
    s_add_u32 s62, s62, s63
    s_add_u32 s63, s62, 16809984
    s_lshl_b32 s42, s16, 4
    s_add_u32 s62, s62, s42
    s_add_u32 s62, s62, 16777216
    v_mov_b32 v116, 0
    s_mov_b32 s10, 4194304
    s_waitcnt lgkmcnt(0)
    s_mov_b32 s8, s4
    s_mov_b32 s9, s5
    s_mov_b32 s12, s6
    s_mov_b32 s13, s7
    buffer_load_dwordx4 v[64:67], v3, s[8:11], s60 offen offset:0
    buffer_load_dwordx4 v[72:75], v3, s[8:11], s61 offen offset:0
    buffer_load_dwordx4 v[68:71], v3, s[8:11], s60 offen offset:1024
    buffer_load_dwordx4 v[76:79], v3, s[8:11], s61 offen offset:1024
    s_mov_b64 exec, 1
    buffer_load_dword v215, v116, s[12:15], s62 offen sc1
    s_mov_b64 exec, -1
    s_branch f_start
h_non:
    s_mul_i32 s42, s32, 0x9e3779b1
    s_lshr_b32 s43, s42, 15
    s_xor_b32 s42, s42, s43
    s_mul_i32 s42, s42, 0x85ebca6b
    s_xor_b32 s33, s33, s42
    s_lshr_b32 s43, s42, 13
    s_xor_b32 s42, s42, s43
    s_mul_i32 s33, s33, 0xc2b2ae35
    s_add_u32 s33, s33, s32
    s_lshr_b32 s43, s33, 16
    s_xor_b32 s33, s33, s43
    s_mul_i32 s33, s33, 0x27d4eb2f
    s_or_b32 s32, s42, 1
    s_andn2_b32 s33, s33, 7
    v_mov_b32 v10, s32
    v_mov_b32 v11, s33
    v_lshlrev_b32 v12, 3, v2
    s_mov_b32 exec_hi, 0
    global_store_dwordx2 v12, v[10:11], s[26:27] sc1
    s_mov_b32 exec_hi, -1
    s_branch h_nonx
g_start:
    s_or_b32 s40, s2, s16
    s_xor_b32 s16, s16, 4
    v_xor_b32 v1, 4, v1
    v_xor_b32 v0, 0x100, v0
    v_lshlrev_b32 v13, 2, v2
    v_mov_b32 v220, 0
    v_mov_b32 v221, 0
    v_mov_b32 v233, 0
    v_mov_b32 v234, 0
    v_mov_b32 v235, 0
    s_cmp_lt_u32 s16, 4
    s_cbranch_scc1 g_cons
g_load:
    s_and_b32 s69, s16, 3
    s_and_b32 s42, s16, 1
    s_lshl_b32 s42, s42, 7
    v_xor_b32 v6, s42, v3
    v_xor_b32 v7, 32, v6
    v_xor_b32 v8, 64, v6
    v_xor_b32 v9, 96, v6
    s_lshl_b32 s41, s35, 3
    s_add_u32 s41, s41, s69
    s_mul_i32 s18, s41, 98304
    s_lshl_b32 s41, s34, 10
    s_cmp_ge_u32 s34, 6
    s_cselect_b32 s42, 2048, 0
    s_add_u32 s18, s18, s41
    s_add_u32 s18, s18, s42
    s_lshl_b32 s68, s69, 13
    s_mov_b32 s10, 12582912
    s_waitcnt lgkmcnt(0)
    s_mov_b32 s8, s58
    s_mov_b32 s9, s59
    s_mov_b32 s12, s6
    s_mov_b32 s13, s7
    s_cmp_eq_u32 s40, 0
    s_cbranch_scc1 h_non
h_nonx:
    s_lshl_b32 s42, s69, 7
    s_add_u32 s42, s42, 139264
    s_mov_b32 m0, s42
    s_lshl_b32 s42, s35, 7
    v_add_u32 v10, s42, v13
    s_mov_b32 exec_hi, 0
    global_load_lds_dword v10, s[56:57]
    s_mov_b32 exec_hi, -1
    s_add_u32 s43, s68, 32768
    s_mov_b32 m0, s43
    s_add_u32 s42, s18, 0
    buffer_load_dwordx4 v6, s[8:11], s42 offen nt lds
    s_add_u32 s43, s68, 33792
    s_mov_b32 m0, s43
    s_add_u32 s42, s18, 12288
    buffer_load_dwordx4 v7, s[8:11], s42 offen nt lds
    s_add_u32 s43, s68, 34816
    s_mov_b32 m0, s43
    s_add_u32 s42, s18, 24576
    buffer_load_dwordx4 v8, s[8:11], s42 offen nt lds
    s_add_u32 s43, s68, 35840
    s_mov_b32 m0, s43
    s_add_u32 s42, s18, 36864
    buffer_load_dwordx4 v9, s[8:11], s42 offen nt lds
    s_add_u32 s43, s68, 36864
    s_mov_b32 m0, s43
    s_add_u32 s42, s18, 49152
    buffer_load_dwordx4 v6, s[8:11], s42 offen nt lds
    s_add_u32 s43, s68, 37888
    s_mov_b32 m0, s43
    s_add_u32 s42, s18, 61440
    buffer_load_dwordx4 v7, s[8:11], s42 offen nt lds
    s_add_u32 s43, s68, 38912
    s_mov_b32 m0, s43
    s_add_u32 s42, s18, 73728
    buffer_load_dwordx4 v8, s[8:11], s42 offen nt lds
    s_add_u32 s43, s68, 39936
    s_mov_b32 m0, s43
    s_add_u32 s42, s18, 86016
    buffer_load_dwordx4 v9, s[8:11], s42 offen nt lds
    s_lshl_b32 s19, s35, 2
    s_add_u32 s19, s19, s69
    s_mul_i32 s19, s19, 196608
    s_lshl_b32 s42, s34, 9
    s_add_u32 s19, s19, s42
    s_and_b32 s42, s34, 4
    s_lshl_b32 s42, s42, 9
    s_add_u32 s19, s19, s42
    s_add_u32 s19, s19, 6144
    v_lshrrev_b32 v5, 5, v2
    v_and_b32 v14, 0x1f0, v3
    v_lshlrev_b32 v12, 5, v5
    v_xor_b32 v14, v14, v12
    s_movk_i32 s42, 12288
    v_mad_u32_u24 v14, v5, s42, v14
    v_bfe_u32 v5, v0, 5, 1
    v_lshlrev_b32 v5, 3, v5
    v_bfe_u32 v12, v0, 3, 2
    v_add_u32 v5, v5, v12
    v_bfe_u32 v12, v0, 4, 2
    v_lshlrev_b32 v12, 1, v12
    v_xor_b32 v12, v12, v0
    v_and_b32 v12, 7, v12
    v_lshlrev_b32 v12, 4, v12
    s_movk_i32 s42, 7168
    v_mad_u32_u24 v5, v5, s42, v12
    s_mov_b32 s20, s26
    s_mov_b32 s21, s27
    s_mov_b32 s26, 4194304
    s_mov_b32 s27, 0x00020000
    s_and_b32 s65, s35, 1
    s_lshr_b32 s40, s35, 1
    s_mul_i32 s64, s34, 7
    s_add_u32 s64, s64, s40
    s_lshl_b32 s41, s34, 1
    s_add_u32 s41, s41, s65
    s_cmp_ge_u32 s35, 14
    s_cselect_b32 s66, 1, 0
    s_cselect_b32 s64, s41, s64
    v_lshrrev_b32 v10, 2, v2
    v_and_b32 v15, 3, v0
    v_bfe_u32 v11, v0, 3, 2
    v_xor_b32 v12, v11, v1
    v_and_b32 v12, 3, v12
    v_lshlrev_b32 v12, 5, v12
    v_lshl_add_u32 v12, v10, 7, v12
    v_lshl_add_u32 v12, v15, 3, v12
    v_lshrrev_b32 v16, 2, v1
    v_lshl_add_u32 v12, v16, 15, v12
    v_add_u32 v21, 65536, v12
    s_lshl_b32 s67, s65, 3
    s_add_u32 s67, s67, s69
    s_mul_i32 s67, s67, 458752
    s_lshl_b32 s42, s64, 7
    s_add_u32 s67, s67, s42
    s_mov_b32 s56, s50
    s_mov_b32 s57, s51
    s_mov_b32 s58, 7340032
    s_mov_b32 s59, 0x00020000
    s_mov_b32 s44, s52
    s_mov_b32 s45, s53
    s_mov_b32 s46, 7340032
    s_mov_b32 s47, 0x00020000
    s_waitcnt vmcnt(7)
    s_add_u32 s43, s68, 65536
    s_mov_b32 m0, s43
    s_add_u32 s42, s18, 393216
    buffer_load_dwordx4 v6, s[8:11], s42 offen nt lds
    s_waitcnt vmcnt(7)
    s_add_u32 s43, s68, 66560
    s_mov_b32 m0, s43
    s_add_u32 s42, s18, 405504
    buffer_load_dwordx4 v7, s[8:11], s42 offen nt lds
    s_load_dwordx2 s[32:33], s[20:21], 128
    s_waitcnt vmcnt(7)
    s_add_u32 s43, s68, 67584
    s_mov_b32 m0, s43
    s_add_u32 s42, s18, 417792
    buffer_load_dwordx4 v8, s[8:11], s42 offen nt lds
    s_waitcnt vmcnt(7)
    s_add_u32 s43, s68, 68608
    s_mov_b32 m0, s43
    s_add_u32 s42, s18, 430080
    buffer_load_dwordx4 v9, s[8:11], s42 offen nt lds
    s_waitcnt vmcnt(7)
    s_add_u32 s43, s68, 69632
    s_mov_b32 m0, s43
    s_add_u32 s42, s18, 442368
    buffer_load_dwordx4 v6, s[8:11], s42 offen nt lds
    s_waitcnt vmcnt(7)
    s_add_u32 s43, s68, 70656
    s_mov_b32 m0, s43
    s_add_u32 s42, s18, 454656
    buffer_load_dwordx4 v7, s[8:11], s42 offen nt lds
    s_waitcnt vmcnt(7)
    s_add_u32 s43, s68, 71680
    s_mov_b32 m0, s43
    s_add_u32 s42, s18, 466944
    buffer_load_dwordx4 v8, s[8:11], s42 offen nt lds
    s_waitcnt vmcnt(7)
    s_barrier
    s_add_u32 s43, s68, 72704
    s_mov_b32 m0, s43
    s_add_u32 s42, s18, 479232
    buffer_load_dwordx4 v9, s[8:11], s42 offen nt lds
    s_waitcnt lgkmcnt(0)
    s_cmp_lg_u32 s32, 0
    s_cbranch_scc1 g_n2x
    s_load_dwordx2 s[32:33], s[20:21], 192
    s_mov_b32 s83, 0
    v_mov_b32 v122, 0
    s_waitcnt lgkmcnt(0)
g_n2:
    s_cmp_lg_u32 s32, 0
    s_cbranch_scc1 g_n2x
    global_load_dwordx2 v[120:121], v122, s[20:21] sc1
    s_waitcnt vmcnt(0)
    v_readfirstlane_b32 s32, v120
    v_readfirstlane_b32 s33, v121
    s_add_u32 s83, s83, 1
    s_cmp_lt_u32 s83, 0x40000
    s_cbranch_scc1 g_n2
g_n2x:
    s_cmp_eq_u32 s66, 0
    s_cbranch_scc1 m_load
    v_mov_b32 v216, s32
    v_mov_b32 v217, s33
    v_and_b32 v218, 1, v0
    v_cmp_eq_u32 vcc, 1, v218
    s_nop 1
    v_cndmask_b32 v216, v216, v217, vcc
    v_bfe_u32 v217, v216, 8, 8
    v_bfe_u32 v218, v216, 16, 8
    v_lshrrev_b32 v219, 24, v216
    v_and_b32 v216, 0xff, v216
    s_lshl_b32 s81, s34, 16
    s_lshl_b32 s42, s16, 13
    s_add_u32 s81, s81, s42
    s_add_u32 s81, s81, 19922944
    s_lshl_b32 s42, s65, 9
    s_add_u32 s80, s81, s42
    s_add_u32 s81, s80, s42
    v_lshlrev_b32 v222, 4, v0
    v_lshrrev_b32 v223, 5, v2
    v_and_b32 v24, 0x1f0, v3
    v_lshl_add_u32 v223, v223, 12, v24
    s_lshl_b32 s39, s34, 4
    s_add_u32 s39, s39, s35
    s_lshl_b32 s39, s39, 12
    s_add_u32 s39, s39, 19922944
    s_bitcmp1_b32 s64, 2
    s_cselect_b32 s28, 1.0, 0
    s_waitcnt vmcnt(0)
    s_barrier
    s_branch x_start
m_load:
    s_waitcnt vmcnt(7)
    v_xor_b32 v4, 0, v14
    s_add_u32 s43, s68, 98304
    s_mov_b32 m0, s43
    s_add_u32 s42, s19, 0
    buffer_load_dwordx4 v4, s[8:11], s42 offen nt lds
    s_waitcnt vmcnt(7)
    v_xor_b32 v4, 64, v14
    s_add_u32 s43, s68, 99328
    s_mov_b32 m0, s43
    s_add_u32 s42, s19, 24576
    buffer_load_dwordx4 v4, s[8:11], s42 offen nt lds
    s_waitcnt vmcnt(7)
    v_xor_b32 v4, 0, v14
    s_add_u32 s43, s68, 100352
    s_mov_b32 m0, s43
    s_add_u32 s42, s19, 49152
    buffer_load_dwordx4 v4, s[8:11], s42 offen nt lds
    s_waitcnt vmcnt(7)
    v_xor_b32 v4, 64, v14
    s_add_u32 s43, s68, 101376
    s_mov_b32 m0, s43
    s_add_u32 s42, s19, 73728
    buffer_load_dwordx4 v4, s[8:11], s42 offen nt lds
    s_waitcnt vmcnt(4)
    s_barrier
    s_barrier
    s_waitcnt vmcnt(7)
    v_xor_b32 v4, 128, v14
    s_add_u32 s43, s68, 102400
    s_mov_b32 m0, s43
    s_add_u32 s42, s19, 98304
    buffer_load_dwordx4 v4, s[8:11], s42 offen nt lds
    s_waitcnt vmcnt(7)
    v_xor_b32 v4, 192, v14
    s_add_u32 s43, s68, 103424
    s_mov_b32 m0, s43
    s_add_u32 s42, s19, 122880
    buffer_load_dwordx4 v4, s[8:11], s42 offen nt lds
    s_waitcnt vmcnt(7)
    v_xor_b32 v4, 128, v14
    s_add_u32 s43, s68, 104448
    s_mov_b32 m0, s43
    s_add_u32 s42, s19, 147456
    buffer_load_dwordx4 v4, s[8:11], s42 offen nt lds
    s_waitcnt vmcnt(7)
    v_xor_b32 v4, 192, v14
    s_add_u32 s43, s68, 105472
    s_mov_b32 m0, s43
    s_add_u32 s42, s19, 172032
    buffer_load_dwordx4 v4, s[8:11], s42 offen nt lds
    s_waitcnt vmcnt(7)
    s_add_u32 s43, s68, 0
    s_mov_b32 m0, s43
    s_add_u32 s42, s67, 0
    buffer_load_dwordx4 v5, s[56:59], s42 offen nt lds
    s_waitcnt vmcnt(7)
    s_add_u32 s43, s68, 1024
    s_mov_b32 m0, s43
    s_add_u32 s42, s67, 114688
    buffer_load_dwordx4 v5, s[56:59], s42 offen nt lds
    s_waitcnt vmcnt(7)
    s_add_u32 s43, s68, 2048
    s_mov_b32 m0, s43
    s_add_u32 s42, s67, 28672
    buffer_load_dwordx4 v5, s[56:59], s42 offen nt lds
    s_waitcnt vmcnt(7)
    s_add_u32 s43, s68, 3072
    s_mov_b32 m0, s43
    s_add_u32 s42, s67, 143360
    buffer_load_dwordx4 v5, s[56:59], s42 offen nt lds
    s_waitcnt vmcnt(7)
    s_add_u32 s43, s68, 4096
    s_mov_b32 m0, s43
    s_add_u32 s42, s67, 229376
    buffer_load_dwordx4 v5, s[56:59], s42 offen nt lds
    s_waitcnt vmcnt(7)
    s_add_u32 s43, s68, 5120
    s_mov_b32 m0, s43
    s_add_u32 s42, s67, 344064
    buffer_load_dwordx4 v5, s[56:59], s42 offen nt lds
    s_waitcnt vmcnt(6)
    s_barrier
    s_barrier
    s_waitcnt vmcnt(7)
    s_add_u32 s43, s68, 6144
    s_mov_b32 m0, s43
    s_add_u32 s42, s67, 258048
    buffer_load_dwordx4 v5, s[56:59], s42 offen nt lds
    s_waitcnt vmcnt(7)
    s_add_u32 s43, s68, 7168
    s_mov_b32 m0, s43
    s_add_u32 s42, s67, 372736
    buffer_load_dwordx4 v5, s[56:59], s42 offen nt lds
    s_waitcnt vmcnt(9)
    s_add_u32 s43, s68, 32768
    s_mov_b32 m0, s43
    s_add_u32 s42, s67, 1835008
    buffer_load_dwordx4 v5, s[56:59], s42 offen nt lds
    s_waitcnt vmcnt(9)
    s_add_u32 s43, s68, 33792
    s_mov_b32 m0, s43
    s_add_u32 s42, s67, 1949696
    buffer_load_dwordx4 v5, s[56:59], s42 offen nt lds
    s_waitcnt vmcnt(9)
    s_add_u32 s43, s68, 34816
    s_mov_b32 m0, s43
    s_add_u32 s42, s67, 1863680
    buffer_load_dwordx4 v5, s[56:59], s42 offen nt lds
    s_waitcnt vmcnt(9)
    s_add_u32 s43, s68, 35840
    s_mov_b32 m0, s43
    s_add_u32 s42, s67, 1978368
    buffer_load_dwordx4 v5, s[56:59], s42 offen nt lds
    s_waitcnt vmcnt(9)
    s_add_u32 s43, s68, 36864
    s_mov_b32 m0, s43
    s_add_u32 s42, s67, 2064384
    buffer_load_dwordx4 v5, s[56:59], s42 offen nt lds
    s_waitcnt vmcnt(9)
    s_add_u32 s43, s68, 37888
    s_mov_b32 m0, s43
    s_add_u32 s42, s67, 2179072
    buffer_load_dwordx4 v5, s[56:59], s42 offen nt lds
    s_waitcnt vmcnt(9)
    s_add_u32 s43, s68, 38912
    s_mov_b32 m0, s43
    s_add_u32 s42, s67, 2093056
    buffer_load_dwordx4 v5, s[56:59], s42 offen nt lds
    s_waitcnt vmcnt(9)
    s_add_u32 s43, s68, 39936
    s_mov_b32 m0, s43
    s_add_u32 s42, s67, 2207744
    buffer_load_dwordx4 v5, s[56:59], s42 offen nt lds
    s_waitcnt vmcnt(9)
    s_add_u32 s43, s68, 65536
    s_mov_b32 m0, s43
    s_add_u32 s42, s67, 0
    buffer_load_dwordx4 v5, s[44:47], s42 offen nt lds
    s_waitcnt vmcnt(9)
    s_barrier
    s_add_u32 s43, s68, 66560
    s_mov_b32 m0, s43
    s_add_u32 s42, s67, 114688
    buffer_load_dwordx4 v5, s[44:47], s42 offen nt lds
    s_waitcnt vmcnt(9)
    s_add_u32 s43, s68, 67584
    s_mov_b32 m0, s43
    s_add_u32 s42, s67, 28672
    buffer_load_dwordx4 v5, s[44:47], s42 offen nt lds
    s_waitcnt vmcnt(9)
    s_add_u32 s43, s68, 68608
    s_mov_b32 m0, s43
    s_add_u32 s42, s67, 143360
    buffer_load_dwordx4 v5, s[44:47], s42 offen nt lds
    s_waitcnt vmcnt(9)
    s_add_u32 s43, s68, 69632
    s_mov_b32 m0, s43
    s_add_u32 s42, s67, 229376
    buffer_load_dwordx4 v5, s[44:47], s42 offen nt lds
    s_waitcnt vmcnt(9)
    s_add_u32 s43, s68, 70656
    s_mov_b32 m0, s43
    s_add_u32 s42, s67, 344064
    buffer_load_dwordx4 v5, s[44:47], s42 offen nt lds
    s_waitcnt vmcnt(9)
    s_add_u32 s43, s68, 71680
    s_mov_b32 m0, s43
    s_add_u32 s42, s67, 258048
    buffer_load_dwordx4 v5, s[44:47], s42 offen nt lds
    s_waitcnt vmcnt(9)
    s_add_u32 s43, s68, 72704
    s_mov_b32 m0, s43
    s_add_u32 s42, s67, 372736
    buffer_load_dwordx4 v5, s[44:47], s42 offen nt lds
    s_waitcnt vmcnt(9)
    s_add_u32 s43, s68, 98304
    s_mov_b32 m0, s43
    s_add_u32 s42, s67, 1835008
    buffer_load_dwordx4 v5, s[44:47], s42 offen nt lds
    s_waitcnt vmcnt(9)
    s_barrier
    ds_read_b64_tr_b16 v[64:65], v12 offset:0
    ds_read_b64_tr_b16 v[66:67], v12 offset:2048
    ds_read_b64_tr_b16 v[68:69], v12 offset:4096
    ds_read_b64_tr_b16 v[70:71], v12 offset:6144
    ds_read_b64_tr_b16 v[72:73], v12 offset:8192
    ds_read_b64_tr_b16 v[74:75], v12 offset:10240
    ds_read_b64_tr_b16 v[76:77], v12 offset:12288
    ds_read_b64_tr_b16 v[78:79], v12 offset:14336
    ds_read_b64_tr_b16 v[80:81], v12 offset:16384
    ds_read_b64_tr_b16 v[82:83], v12 offset:18432
    ds_read_b64_tr_b16 v[84:85], v12 offset:20480
    ds_read_b64_tr_b16 v[86:87], v12 offset:22528
    ds_read_b64_tr_b16 v[88:89], v12 offset:24576
    ds_read_b64_tr_b16 v[90:91], v12 offset:26624
    ds_read_b64_tr_b16 v[92:93], v12 offset:28672
    ds_read_b64_tr_b16 v[94:95], v12 offset:30720
    s_add_u32 s43, s68, 99328
    s_mov_b32 m0, s43
    s_add_u32 s42, s67, 1949696
    buffer_load_dwordx4 v5, s[44:47], s42 offen nt lds
    s_waitcnt vmcnt(9)
    s_add_u32 s43, s68, 100352
    s_mov_b32 m0, s43
    s_add_u32 s42, s67, 1863680
    buffer_load_dwordx4 v5, s[44:47], s42 offen nt lds
    s_waitcnt vmcnt(9)
    s_add_u32 s43, s68, 101376
    s_mov_b32 m0, s43
    s_add_u32 s42, s67, 1978368
    buffer_load_dwordx4 v5, s[44:47], s42 offen nt lds
    s_waitcnt vmcnt(9)
    s_add_u32 s43, s68, 102400
    s_mov_b32 m0, s43
    s_add_u32 s42, s67, 2064384
    buffer_load_dwordx4 v5, s[44:47], s42 offen nt lds
    s_waitcnt vmcnt(9)
    s_add_u32 s43, s68, 103424
    s_mov_b32 m0, s43
    s_add_u32 s42, s67, 2179072
    buffer_load_dwordx4 v5, s[44:47], s42 offen nt lds
    s_waitcnt vmcnt(9)
    s_add_u32 s43, s68, 104448
    s_mov_b32 m0, s43
    s_add_u32 s42, s67, 2093056
    buffer_load_dwordx4 v5, s[44:47], s42 offen nt lds
    s_waitcnt vmcnt(9)
    s_add_u32 s43, s68, 105472
    s_mov_b32 m0, s43
    s_add_u32 s42, s67, 2207744
    buffer_load_dwordx4 v5, s[44:47], s42 offen nt lds
    s_branch m_join
g_cons:
    s_lshl_b32 s29, s34, 4
    s_add_u32 s29, s29, s35
    s_lshl_b32 s29, s29, 12
    s_add_u32 s29, s29, 19922944
    s_lshl_b32 s30, s16, 9
    s_add_u32 s30, s30, s29
    s_lshl_b32 s31, s16, 8
    s_add_u32 s31, s31, s29
    s_add_u32 s31, s31, 2048
    v_lshlrev_b32 v8, 1, v2
    v_lshlrev_b32 v9, 7, v2
    v_mov_b32 v104, -1
    v_mov_b32 v105, -1
    v_mov_b32 v106, -1
    v_mov_b32 v107, -1
    s_waitcnt lgkmcnt(0)
    s_mov_b32 s12, s6
    s_mov_b32 s13, s7
    s_cmp_eq_u32 s16, 1
    s_cselect_b64 exec, 0xffffff, 1
    buffer_load_dword v245, v9, s[12:15], s29 offen sc1
    s_mov_b64 exec, -1
    v_mov_b32 v14, 0
    s_mov_b32 s8, s58
    s_mov_b32 s9, s59
    s_mov_b32 s10, 12582912
    s_mov_b32 s11, 0x00020000
    s_mov_b32 s20, s26
    s_mov_b32 s21, s27
    s_mov_b32 s26, 4194304
    s_mov_b32 s27, 0x00020000
    s_and_b32 s65, s35, 1
    s_lshr_b32 s40, s35, 1
    s_mul_i32 s64, s34, 7
    s_add_u32 s64, s64, s40
    s_lshl_b32 s41, s34, 1
    s_add_u32 s41, s41, s65
    s_cmp_ge_u32 s35, 14
    s_cselect_b32 s66, 1, 0
    s_cselect_b32 s64, s41, s64
    v_lshrrev_b32 v10, 2, v2
    v_and_b32 v15, 3, v0
    v_bfe_u32 v11, v0, 3, 2
    v_xor_b32 v12, v11, v1
    v_and_b32 v12, 3, v12
    v_lshlrev_b32 v12, 5, v12
    v_lshl_add_u32 v12, v10, 7, v12
    v_lshl_add_u32 v12, v15, 3, v12
    v_lshrrev_b32 v16, 2, v1
    v_lshl_add_u32 v12, v16, 15, v12
    v_add_u32 v21, 65536, v12
    v_bfe_u32 v22, v0, 2, 3
    v_lshlrev_b32 v22, 5, v22
    v_lshl_add_u32 v22, v15, 3, v22
    v_bfe_u32 v23, v0, 2, 2
    v_bfe_u32 v24, v0, 4, 2
    v_lshl_add_u32 v23, v24, 3, v23
    v_lshl_add_u32 v200, v23, 10, v22
    v_lshl_add_u32 v200, v1, 8, v200
    v_add_u32 v200, 32768, v200
    v_lshlrev_b32 v25, 7, v1
    v_xor_b32 v22, v22, v25
    v_lshl_add_u32 v208, v23, 9, v22
    v_add_u32 v208, 98304, v208
    v_cmp_eq_u32 s[60:61], 1, v24
    v_cmp_eq_u32 s[62:63], 2, v24
    v_cmp_eq_u32 s[72:73], 3, v24
    v_add_u32 v8, v8, v25
    v_add_u32 v8, 139264, v8
    v_lshl_add_u32 v10, v24, 4, v25
    v_add_u32 v10, 139264, v10
    v_xor_b32 v201, 32, v200
    v_xor_b32 v202, 64, v200
    v_xor_b32 v203, 96, v200
    v_xor_b32 v204, 128, v200
    v_xor_b32 v205, 160, v200
    v_xor_b32 v206, 192, v200
    v_xor_b32 v207, 224, v200
    v_xor_b32 v209, 32, v208
    v_xor_b32 v210, 64, v208
    v_xor_b32 v211, 96, v208
    s_sleep 8
    s_load_dwordx2 s[32:33], s[20:21], 128
    s_waitcnt lgkmcnt(0)
    s_cmp_lg_u32 s32, 0
    s_cbranch_scc1 g_nnx
    s_load_dwordx2 s[32:33], s[20:21], 192
    s_mov_b32 s83, 0
    v_mov_b32 v114, 0
    s_waitcnt lgkmcnt(0)
g_nn:
    s_cmp_lg_u32 s32, 0
    s_cbranch_scc1 g_nnx
    global_load_dwordx2 v[112:113], v114, s[20:21] sc1
    s_waitcnt vmcnt(0)
    v_readfirstlane_b32 s32, v112
    v_readfirstlane_b32 s33, v113
    s_add_u32 s83, s83, 1
    s_cmp_lt_u32 s83, 0x40000
    s_cbranch_scc1 g_nn
g_nnx:
    v_mov_b32 v212, s32
    v_mov_b32 v213, s33
    v_and_b32 v214, 7, v0
    v_lshlrev_b32 v214, 3, v214
    v_lshrrev_b64 v[212:213], v214, v[212:213]
    v_and_b32 v212, 0xff, v212
    s_movk_i32 s74, 0xff00
    s_cmp_ge_u32 s16, s66
    s_cbranch_scc1 g_nw
    s_lshr_b32 s22, s64, 2
    s_cmp_eq_u32 s22, 3
    s_cselect_b32 s22, 6, s22
    s_lshl_b32 s22, s22, 12
    s_add_u32 s22, s22, 16875520
    s_lshr_b32 s23, s64, 3
    s_lshl_b32 s23, s23, 13
    s_add_u32 s23, s23, 16908288
    s_mov_b32 s75, 16891904
    v_bfe_u32 v24, v0, 2, 1
    v_bfe_u32 v25, v0, 3, 2
    v_bfe_u32 v26, v0, 5, 1
    v_lshlrev_b32 v220, 4, v15
    v_lshl_add_u32 v220, v24, 9, v220
    v_lshl_add_u32 v220, v25, 10, v220
    s_and_b32 s42, s64, 3
    s_lshl_b32 s42, s42, 7
    s_and_b32 s43, s64, 4
    s_lshl_b32 s43, s43, 4
    s_add_u32 s42, s42, s43
    v_add_u32 v233, s42, v220
    v_lshl_add_u32 v220, v26, 7, v220
    s_and_b32 s42, s64, 1
    s_lshl_b32 s42, s42, 8
    s_and_b32 s43, s64, 2
    s_lshl_b32 s43, s43, 5
    s_add_u32 s42, s42, s43
    v_add_u32 v220, s42, v220
    v_xor_b32 v234, 8176, v220
    v_xor_b32 v235, 8176, v233
    v_lshlrev_b32 v221, 7, v15
    v_lshl_add_u32 v221, v24, 6, v221
    v_lshl_add_u32 v221, v25, 4, v221
    v_lshl_add_u32 v221, v26, 9, v221
    v_add_u32 v232, 8, v2
    v_and_b32 v232, 31, v232
    v_lshl_add_u32 v232, v26, 5, v232
    v_lshlrev_b32 v232, 2, v232
    s_lshl_b32 s79, s64, 7
    s_add_u32 s79, s79, 16850944
    v_xor_b32 v0, 1, v0
    v_mov_b32 v228, s32
    v_mov_b32 v229, s33
    v_and_b32 v230, 1, v0
    v_cmp_eq_u32 vcc, 1, v230
    s_nop 1
    v_cndmask_b32 v228, v228, v229, vcc
    v_bfe_u32 v229, v228, 8, 8
    v_bfe_u32 v230, v228, 16, 8
    v_lshrrev_b32 v231, 24, v228
    v_and_b32 v228, 0xff, v228
    v_xor_b32 v0, 1, v0
    s_mov_b32 s44, s48
    s_mov_b32 s45, s49
    s_mov_b32 s46, 2048
    s_mov_b32 s47, 0x00020000
    v_lshrrev_b32 v11, 1, v221
    s_and_b32 s42, s64, 3
    s_lshl_b32 s42, s42, 9
    buffer_load_dwordx2 v[52:53], v11, s[44:47], s42 offen
    v_mov_b32 v216, s32
    v_mov_b32 v217, s33
    v_and_b32 v218, 1, v0
    v_cmp_eq_u32 vcc, 1, v218
    s_nop 1
    v_cndmask_b32 v216, v216, v217, vcc
    v_bfe_u32 v217, v216, 8, 8
    v_bfe_u32 v218, v216, 16, 8
    v_lshrrev_b32 v219, 24, v216
    v_and_b32 v216, 0xff, v216
    v_not_b32 v24, v216
    v_not_b32 v25, v229
    buffer_store_dwordx4 v[24:27], v220, s[12:15], s22 offen sc1
    s_mov_b32 exec_hi, 0
    buffer_store_dwordx4 v[24:27], v233, s[12:15], s23 offen sc1
    buffer_store_dwordx4 v[24:27], v235, s[12:15], s23 offen sc1
    s_mov_b64 exec, 0xff
    buffer_store_dwordx4 v[104:107], v3, s[12:15], s79 offen sc1
    s_mov_b64 exec, -1
    s_cmp_lt_u32 s64, 8
    s_cbranch_scc1 g_nw
    buffer_store_dwordx4 v[24:27], v234, s[12:15], s22 offen sc1
    s_cmp_lt_u32 s64, 12
    s_cbranch_scc1 g_nw
    buffer_store_dwordx4 v[24:27], v220, s[12:15], s75 offen sc1
    buffer_store_dwordx4 v[24:27], v234, s[12:15], s75 offen sc1
g_nw:
    s_barrier
    ds_read_u16 v6, v8
    s_waitcnt lgkmcnt(0)
    v_lshlrev_b32 v6, 16, v6
    v_mul_f32 v24, 0xbfb8aa3b, v6
    v_exp_f32 v24, v24
    s_nop 0
    v_add_f32 v24, 1.0, v24
    v_rcp_f32 v24, v24
    s_nop 0
    v_mul_f32 v6, v6, v24
    v_cvt_pk_bf16_f32 v6, v6, v6
    ds_write_b16 v8, v6
    ds_read_b128 v[120:123], v10
    ds_read_b128 v[124:127], v10 offset:64
    ds_read_b64_tr_b16 v[128:129], v200 offset:0
    ds_read_b64_tr_b16 v[130:131], v200 offset:4096
    ds_read_b64_tr_b16 v[132:133], v201 offset:0
    ds_read_b64_tr_b16 v[134:135], v201 offset:4096
    ds_read_b64_tr_b16 v[136:137], v202 offset:0
    ds_read_b64_tr_b16 v[138:139], v202 offset:4096
    ds_read_b64_tr_b16 v[140:141], v203 offset:0
    ds_read_b64_tr_b16 v[142:143], v203 offset:4096
    ds_read_b64_tr_b16 v[144:145], v204 offset:0
    ds_read_b64_tr_b16 v[146:147], v204 offset:4096
    ds_read_b64_tr_b16 v[148:149], v205 offset:0
    ds_read_b64_tr_b16 v[150:151], v205 offset:4096
    ds_read_b64_tr_b16 v[152:153], v206 offset:0
    ds_read_b64_tr_b16 v[154:155], v206 offset:4096
    s_waitcnt lgkmcnt(12)
    v_mfma_f32_16x16x32_bf16 v[64:67], v[120:123], v[128:131], 0
    ds_read_b64_tr_b16 v[156:157], v207 offset:0
    ds_read_b64_tr_b16 v[158:159], v207 offset:4096
    s_waitcnt lgkmcnt(12)
    v_mfma_f32_16x16x32_bf16 v[68:71], v[120:123], v[132:135], 0
    s_waitcnt lgkmcnt(10)
    v_mfma_f32_16x16x32_bf16 v[72:75], v[120:123], v[136:139], 0
    s_waitcnt lgkmcnt(8)
    v_mfma_f32_16x16x32_bf16 v[76:79], v[120:123], v[140:143], 0
    s_waitcnt lgkmcnt(6)
    v_mfma_f32_16x16x32_bf16 v[80:83], v[120:123], v[144:147], 0
    s_waitcnt lgkmcnt(4)
    v_mfma_f32_16x16x32_bf16 v[84:87], v[120:123], v[148:151], 0
    s_waitcnt lgkmcnt(2)
    v_mfma_f32_16x16x32_bf16 v[88:91], v[120:123], v[152:155], 0
    s_waitcnt lgkmcnt(0)
    v_mfma_f32_16x16x32_bf16 v[92:95], v[120:123], v[156:159], 0
    v_mov_b32 v216, s32
    v_mov_b32 v217, s33
    v_and_b32 v218, 1, v0
    v_cmp_eq_u32 vcc, 1, v218
    s_nop 1
    v_cndmask_b32 v216, v216, v217, vcc
    v_bfe_u32 v217, v216, 8, 8
    v_bfe_u32 v218, v216, 16, 8
    v_lshrrev_b32 v219, 24, v216
    v_and_b32 v216, 0xff, v216
    s_lshl_b32 s81, s34, 16
    s_lshl_b32 s42, s16, 13
    s_add_u32 s81, s81, s42
    s_add_u32 s81, s81, 19922944
    s_lshl_b32 s42, s65, 9
    s_add_u32 s80, s81, s42
    s_add_u32 s81, s80, s42
    v_lshlrev_b32 v222, 4, v0
    v_lshrrev_b32 v223, 5, v2
    v_and_b32 v24, 0x1f0, v3
    v_lshl_add_u32 v223, v223, 12, v24
    s_lshl_b32 s39, s34, 4
    s_add_u32 s39, s39, s35
    s_lshl_b32 s39, s39, 12
    s_add_u32 s39, s39, 19922944
    s_bitcmp1_b32 s64, 2
    s_cselect_b32 s28, 1.0, 0
    s_barrier
    ds_read_b64_tr_b16 v[128:129], v200 offset:32768
    ds_read_b64_tr_b16 v[130:131], v200 offset:36864
    ds_read_b64_tr_b16 v[132:133], v201 offset:32768
    ds_read_b64_tr_b16 v[134:135], v201 offset:36864
    ds_read_b64_tr_b16 v[136:137], v202 offset:32768
    ds_read_b64_tr_b16 v[138:139], v202 offset:36864
    ds_read_b64_tr_b16 v[140:141], v203 offset:32768
    ds_read_b64_tr_b16 v[142:143], v203 offset:36864
    ds_read_b64_tr_b16 v[144:145], v204 offset:32768
    ds_read_b64_tr_b16 v[146:147], v204 offset:36864
    ds_read_b64_tr_b16 v[148:149], v205 offset:32768
    ds_read_b64_tr_b16 v[150:151], v205 offset:36864
    ds_read_b64_tr_b16 v[152:153], v206 offset:32768
    ds_read_b64_tr_b16 v[154:155], v206 offset:36864
    s_waitcnt lgkmcnt(12)
    v_mfma_f32_16x16x32_bf16 v[64:67], v[124:127], v[128:131], v[64:67]
    ds_read_b64_tr_b16 v[156:157], v207 offset:32768
    ds_read_b64_tr_b16 v[158:159], v207 offset:36864
    s_waitcnt lgkmcnt(12)
    v_mfma_f32_16x16x32_bf16 v[68:71], v[124:127], v[132:135], v[68:71]
    s_waitcnt lgkmcnt(10)
    v_mfma_f32_16x16x32_bf16 v[72:75], v[124:127], v[136:139], v[72:75]
    s_waitcnt lgkmcnt(8)
    v_mfma_f32_16x16x32_bf16 v[76:79], v[124:127], v[140:143], v[76:79]
    s_waitcnt lgkmcnt(6)
    v_mfma_f32_16x16x32_bf16 v[80:83], v[124:127], v[144:147], v[80:83]
    s_waitcnt lgkmcnt(4)
    v_mfma_f32_16x16x32_bf16 v[84:87], v[124:127], v[148:151], v[84:87]
    s_waitcnt lgkmcnt(2)
    v_mfma_f32_16x16x32_bf16 v[88:91], v[124:127], v[152:155], v[88:91]
    s_waitcnt lgkmcnt(0)
    v_mfma_f32_16x16x32_bf16 v[92:95], v[124:127], v[156:159], v[92:95]
    v_cndmask_b32 v64, v64, v68, s[60:61]
    v_cndmask_b32 v64, v64, v72, s[62:63]
    v_cndmask_b32 v64, v64, v76, s[72:73]
    v_and_or_b32 v224, v64, s74, v212
    v_cndmask_b32 v80, v80, v84, s[60:61]
    s_nop 0
    v_cndmask_b32 v80, v80, v88, s[62:63]
    s_nop 0
    v_cndmask_b32 v80, v80, v92, s[72:73]
    v_and_or_b32 v225, v80, s74, v212
    buffer_store_dword v224, v13, s[12:15], s30 offen offset:0
    buffer_store_dword v225, v13, s[12:15], s30 offen offset:256
    s_cmp_eq_u32 s66, 1
    s_cbranch_scc1 x_start
    s_barrier
    s_barrier
    ds_read_b64_tr_b16 v[128:129], v208 offset:0
    ds_read_b64_tr_b16 v[130:131], v208 offset:2048
    ds_read_b64_tr_b16 v[132:133], v209 offset:0
    ds_read_b64_tr_b16 v[134:135], v209 offset:2048
    ds_read_b64_tr_b16 v[136:137], v210 offset:0
    ds_read_b64_tr_b16 v[138:139], v210 offset:2048
    ds_read_b64_tr_b16 v[140:141], v211 offset:0
    ds_read_b64_tr_b16 v[142:143], v211 offset:2048
    ds_read_b64_tr_b16 v[144:145], v208 offset:16384
    ds_read_b64_tr_b16 v[146:147], v208 offset:18432
    ds_read_b64_tr_b16 v[148:149], v209 offset:16384
    ds_read_b64_tr_b16 v[150:151], v209 offset:18432
    ds_read_b64_tr_b16 v[152:153], v210 offset:16384
    ds_read_b64_tr_b16 v[154:155], v210 offset:18432
    s_waitcnt lgkmcnt(12)
    v_mfma_f32_16x16x32_bf16 v[64:67], v[120:123], v[128:131], 0
    ds_read_b64_tr_b16 v[156:157], v211 offset:16384
    ds_read_b64_tr_b16 v[158:159], v211 offset:18432
    s_waitcnt lgkmcnt(12)
    v_mfma_f32_16x16x32_bf16 v[68:71], v[120:123], v[132:135], 0
    s_waitcnt lgkmcnt(10)
    v_mfma_f32_16x16x32_bf16 v[72:75], v[120:123], v[136:139], 0
    s_waitcnt lgkmcnt(8)
    v_mfma_f32_16x16x32_bf16 v[76:79], v[120:123], v[140:143], 0
    s_waitcnt lgkmcnt(6)
    v_mfma_f32_16x16x32_bf16 v[64:67], v[124:127], v[144:147], v[64:67]
    s_waitcnt lgkmcnt(4)
    v_mfma_f32_16x16x32_bf16 v[68:71], v[124:127], v[148:151], v[68:71]
    s_waitcnt lgkmcnt(2)
    v_mfma_f32_16x16x32_bf16 v[72:75], v[124:127], v[152:155], v[72:75]
    s_waitcnt lgkmcnt(0)
    v_mfma_f32_16x16x32_bf16 v[76:79], v[124:127], v[156:159], v[76:79]
    s_nop 3
    v_cndmask_b32 v64, v64, v68, s[60:61]
    s_nop 0
    v_cndmask_b32 v64, v64, v72, s[62:63]
    s_nop 0
    v_cndmask_b32 v64, v64, v76, s[72:73]
    v_and_or_b32 v226, v64, s74, v212
    buffer_store_dword v226, v13, s[12:15], s31 offen offset:0
    s_barrier
    s_bitcmp1_b32 s16, 0
    s_cselect_b32 s8, s52, s50
    s_cselect_b32 s9, s53, s51
    s_mov_b32 s10, 7340032
    s_lshr_b32 s42, s8, 7
    s_sub_u32 s42, 3, s42
    s_add_u32 s42, s42, s34
    s_and_b32 s42, s42, 7
    s_cmp_eq_u32 s42, 7
    s_cbranch_scc1 m_nh2
    s_mul_i32 s43, s34, 7
    s_add_u32 s42, s42, s43
    s_lshl_b32 s42, s42, 7
    s_lshl_b32 s43, s35, 1
    s_lshr_b32 s40, s16, 1
    s_add_u32 s43, s43, s40
    s_mul_i32 s43, s43, 265216
    s_add_u32 s42, s42, s43
    v_mul_u32_u24 v24, 7168, v2
    s_mov_b32 exec_lo, 4294967295
    s_mov_b32 exec_hi, 31
    buffer_load_dword v245, v24, s[8:11], s42 offen
    s_mov_b64 exec, -1
m_nh2:
    s_barrier
    ds_read_b64_tr_b16 v[64:65], v12 offset:0
    ds_read_b64_tr_b16 v[66:67], v12 offset:2048
    ds_read_b64_tr_b16 v[68:69], v12 offset:4096
    ds_read_b64_tr_b16 v[70:71], v12 offset:6144
    ds_read_b64_tr_b16 v[72:73], v12 offset:8192
    ds_read_b64_tr_b16 v[74:75], v12 offset:10240
    ds_read_b64_tr_b16 v[76:77], v12 offset:12288
    ds_read_b64_tr_b16 v[78:79], v12 offset:14336
    ds_read_b64_tr_b16 v[80:81], v12 offset:16384
    ds_read_b64_tr_b16 v[82:83], v12 offset:18432
    ds_read_b64_tr_b16 v[84:85], v12 offset:20480
    ds_read_b64_tr_b16 v[86:87], v12 offset:22528
    ds_read_b64_tr_b16 v[88:89], v12 offset:24576
    ds_read_b64_tr_b16 v[90:91], v12 offset:26624
    ds_read_b64_tr_b16 v[92:93], v12 offset:28672
    ds_read_b64_tr_b16 v[94:95], v12 offset:30720
    s_waitcnt vmcnt(0)
    s_barrier
    s_sub_u32 s42, s16, 1
    s_cmp_ge_u32 s42, 3
    s_cbranch_scc1 m_nb
    s_lshl_b32 s42, s42, 10
    s_add_u32 s42, s42, s29
    s_add_u32 s43, s42, 524288
    buffer_load_dwordx4 v[44:47], v3, s[12:15], s42 offen sc1
    s_waitcnt vmcnt(0)
    buffer_store_dwordx4 v[44:47], v3, s[12:15], s43 offen sc1
m_nb:
m_join:
    v_bfe_u32 v7, v0, 4, 2
    v_and_b32 v6, 1, v0
    v_lshlrev_b32 v17, 10, v6
    v_lshl_add_u32 v17, v16, 9, v17
    v_lshl_add_u32 v17, v7, 4, v17
    v_add_u32 v17, 131072, v17
    v_and_b32 v6, 15, v0
    v_lshlrev_b32 v13, 6, v6
    v_bfe_u32 v22, v0, 4, 1
    v_lshl_add_u32 v13, v22, 5, v13
    v_bfe_u32 v22, v0, 5, 1
    v_lshl_add_u32 v13, v22, 4, v13
    v_add_u32 v13, 131072, v13
    v_lshl_add_u32 v13, v1, 10, v13
    s_lshl_b32 s70, s34, 1
    s_add_u32 s70, s70, s16
    s_lshl_b32 s70, s70, 13
    s_lshl_b32 s71, s65, 11
    s_add_u32 s70, s70, s71
    s_add_u32 s70, s70, 17301504
    s_mov_b32 s71, 0x07060302
    s_lshl_b32 s69, s64, 2
    s_and_b32 s42, s16, 3
    s_add_u32 s69, s69, s42
    s_lshl_b32 s69, s69, 10
    s_lshl_b32 s76, s65, 1
    s_lshr_b32 s42, s16, 2
    s_add_u32 s76, s76, s42
    s_lshl_b32 s76, s76, 8
    s_add_u32 s76, s76, s69
    s_add_u32 s77, s76, 18612224
    s_add_u32 s76, s76, 18350080
    s_add_u32 s69, s69, 18350080
    s_cmp_lg_u32 s16, 2
    s_cbranch_scc1 m_n0
    v_lshlrev_b32 v4, 7, v2
    s_sub_u32 s69, s69, 2048
    s_mov_b32 exec_hi, 0
    buffer_load_dword v5, v4, s[12:15], s69 offen sc1
    s_mov_b32 exec_hi, -1
m_n0:
    s_cmp_ge_u32 s16, 2
    s_cbranch_scc1 m_n1
    v_lshlrev_b32 v4, 7, v2
    s_mov_b64 exec, 0xffff
    buffer_load_dword v5, v4, s[12:15], s70 offen sc1
    s_mov_b64 exec, -1
m_n1:
    v_mov_b32 v216, s32
    v_mov_b32 v217, s33
    v_and_b32 v218, 1, v0
    v_cmp_eq_u32 vcc, 1, v218
    s_nop 1
    v_cndmask_b32 v216, v216, v217, vcc
    v_bfe_u32 v217, v216, 8, 8
    v_bfe_u32 v218, v216, 16, 8
    v_lshrrev_b32 v219, 24, v216
    v_and_b32 v216, 0xff, v216
    s_and_b32 s60, s32, 0xffff
    s_lshr_b32 s61, s32, 16
    s_and_b32 s62, s33, 0xffff
    s_lshr_b32 s63, s33, 16
    s_movk_i32 s74, 0xff00
    s_waitcnt vmcnt(0)
    s_barrier
    s_cmp_ge_u32 s16, 2
    s_cselect_b64 exec, 1, -1
    buffer_load_dwordx4 v[176:179], v3, s[12:15], s70 offen sc1
    buffer_load_dwordx4 v[180:183], v3, s[12:15], s70 offen offset:1024 sc1
    s_mov_b64 exec, -1
    ds_read_b64_tr_b16 v[96:97], v21 offset:0
    ds_read_b64_tr_b16 v[98:99], v21 offset:2048
    ds_read_b64_tr_b16 v[100:101], v21 offset:4096
    ds_read_b64_tr_b16 v[102:103], v21 offset:6144
    ds_read_b64_tr_b16 v[104:105], v21 offset:8192
    ds_read_b64_tr_b16 v[106:107], v21 offset:10240
    ds_read_b64_tr_b16 v[108:109], v21 offset:12288
    ds_read_b64_tr_b16 v[110:111], v21 offset:14336
    ds_read_b64_tr_b16 v[112:113], v21 offset:16384
    ds_read_b64_tr_b16 v[114:115], v21 offset:18432
    ds_read_b64_tr_b16 v[116:117], v21 offset:20480
    ds_read_b64_tr_b16 v[118:119], v21 offset:22528
    ds_read_b64_tr_b16 v[120:121], v21 offset:24576
    ds_read_b64_tr_b16 v[122:123], v21 offset:26624
    ds_read_b64_tr_b16 v[124:125], v21 offset:28672
    ds_read_b64_tr_b16 v[126:127], v21 offset:30720
    s_cbranch_scc1 m_nk
    s_mov_b32 s83, 0
    s_branch m_ph
m_pr:
    s_and_b32 s42, s83, 63
    s_cmp_eq_u32 s42, 63
    s_cselect_b32 s42, 131072, 0
    s_add_u32 s42, s42, s70
    buffer_load_dwordx4 v[176:179], v3, s[12:15], s42 offen sc1
    buffer_load_dwordx4 v[180:183], v3, s[12:15], s42 offen offset:1024 sc1
    s_add_u32 s83, s83, 1
    s_cmp_ge_u32 s83, 0x40000
    s_cbranch_scc1 m_phx
m_ph:
    s_waitcnt vmcnt(0)
    v_cmp_ne_u16 vcc, s63, v183
    s_cbranch_vccnz m_pr
    v_perm_b32 v184, v177, v176, s71
    v_perm_b32 v185, v179, v178, s71
    v_perm_b32 v186, v181, v180, s71
    v_perm_b32 v187, v183, v182, s71
    ds_write_b128 v13, v[184:187]
    v_xor_b32 v176, s60, v176
    v_xor_b32 v177, s61, v177
    v_xor_b32 v178, s62, v178
    v_xor_b32 v179, s63, v179
    v_xor_b32 v180, s60, v180
    v_xor_b32 v181, s61, v181
    v_xor_b32 v182, s62, v182
    v_xor_b32 v183, s63, v183
    v_or3_b32 v4, v176, v177, 0
    v_or3_b32 v4, v178, v179, v4
    v_or3_b32 v4, v180, v181, v4
    v_or3_b32 v4, v182, v183, v4
    v_cmp_ne_u16 vcc, 0, v4
    s_cbranch_vccnz m_pr
m_phx:
m_nk:
    s_waitcnt lgkmcnt(0)
    s_barrier
    ds_read_b128 v[128:131], v17 offset:0
    ds_read_b128 v[132:135], v17 offset:64
    ds_read_b128 v[136:139], v17 offset:128
    ds_read_b128 v[140:143], v17 offset:192
    ds_read_b128 v[144:147], v17 offset:256
    ds_read_b128 v[148:151], v17 offset:320
    ds_read_b128 v[152:155], v17 offset:384
    ds_read_b128 v[156:159], v17 offset:448
    s_waitcnt lgkmcnt(7)
    v_mfma_f32_16x16x32_bf16 v[160:163], v[128:131], v[64:67], 0
    v_mfma_f32_16x16x32_bf16 v[164:167], v[128:131], v[96:99], 0
    s_waitcnt lgkmcnt(6)
    v_mfma_f32_16x16x32_bf16 v[160:163], v[132:135], v[68:71], v[160:163]
    v_mfma_f32_16x16x32_bf16 v[164:167], v[132:135], v[100:103], v[164:167]
    s_waitcnt lgkmcnt(5)
    v_mfma_f32_16x16x32_bf16 v[160:163], v[136:139], v[72:75], v[160:163]
    v_mfma_f32_16x16x32_bf16 v[164:167], v[136:139], v[104:107], v[164:167]
    s_waitcnt lgkmcnt(4)
    v_mfma_f32_16x16x32_bf16 v[160:163], v[140:143], v[76:79], v[160:163]
    v_mfma_f32_16x16x32_bf16 v[164:167], v[140:143], v[108:111], v[164:167]
    s_waitcnt lgkmcnt(3)
    v_mfma_f32_16x16x32_bf16 v[160:163], v[144:147], v[80:83], v[160:163]
    v_mfma_f32_16x16x32_bf16 v[164:167], v[144:147], v[112:115], v[164:167]
    s_waitcnt lgkmcnt(2)
    v_mfma_f32_16x16x32_bf16 v[160:163], v[148:151], v[84:87], v[160:163]
    v_mfma_f32_16x16x32_bf16 v[164:167], v[148:151], v[116:119], v[164:167]
    s_waitcnt lgkmcnt(1)
    v_mfma_f32_16x16x32_bf16 v[160:163], v[152:155], v[88:91], v[160:163]
    v_mfma_f32_16x16x32_bf16 v[164:167], v[152:155], v[120:123], v[164:167]
    s_waitcnt lgkmcnt(0)
    v_mfma_f32_16x16x32_bf16 v[160:163], v[156:159], v[92:95], v[160:163]
    v_mfma_f32_16x16x32_bf16 v[164:167], v[156:159], v[124:127], v[164:167]
    s_nop 6
    v_and_or_b32 v184, v160, s74, v216
    v_and_or_b32 v185, v161, s74, v217
    v_and_or_b32 v186, v164, s74, v218
    v_and_or_b32 v187, v165, s74, v219
    s_mov_b64 exec, 0xffff
    buffer_store_dwordx4 v[184:187], v3, s[12:15], s76 offen
    buffer_store_dwordx4 v[184:187], v3, s[12:15], s77 offen sc1
    s_mov_b64 exec, -1
    s_cmp_eq_u32 s16, 0
    s_cbranch_scc1 r_start
g_end:
    s_endpgm
x_start:
    s_mov_b32 s83, 0
x_g0:
    s_and_b32 s42, s83, 63
    s_cmp_eq_u32 s42, 63
    s_cselect_b32 s42, 524288, 0
    s_add_u32 s42, s42, s81
    s_add_u32 s43, s42, 4096
    buffer_load_dwordx4 v[32:35], v3, s[12:15], s42 offen sc1
    buffer_load_dwordx4 v[36:39], v3, s[12:15], s43 offen sc1
    s_waitcnt vmcnt(0)
    v_xor_b32 v32, v216, v32
    v_xor_b32 v33, v217, v33
    v_xor_b32 v34, v218, v34
    v_xor_b32 v35, v219, v35
    v_xor_b32 v36, v216, v36
    v_xor_b32 v37, v217, v37
    v_xor_b32 v38, v218, v38
    v_xor_b32 v39, v219, v39
    v_or3_b32 v17, v32, v33, 0
    v_or3_b32 v17, v34, v35, v17
    v_or3_b32 v17, v36, v37, v17
    v_or3_b32 v17, v38, v39, v17
    v_and_b32 v17, 0xff, v17
    v_cmp_ne_u32 vcc, 0, v17
    s_cbranch_vccz x_g0x
    s_and_b32 s42, s83, 63
    s_cmp_lg_u32 s42, 48
    s_cbranch_scc1 x_g0n
    s_add_u32 s43, s39, 524288
    buffer_load_dwordx4 v[44:47], v3, s[12:15], s39 offen offset:0 sc1
    s_waitcnt vmcnt(0)
    buffer_store_dwordx4 v[44:47], v3, s[12:15], s43 offen offset:0 sc1
    s_waitcnt vmcnt(0)
    buffer_load_dwordx4 v[44:47], v3, s[12:15], s39 offen offset:1024 sc1
    s_waitcnt vmcnt(0)
    buffer_store_dwordx4 v[44:47], v3, s[12:15], s43 offen offset:1024 sc1
    s_waitcnt vmcnt(0)
x_g0n:
    s_add_u32 s83, s83, 1
    s_cmp_lt_u32 s83, 0x40000
    s_cbranch_scc1 x_g0
x_g0x:
    v_pk_add_f32 v[32:33], v[32:33], v[36:37]
    v_pk_add_f32 v[34:35], v[34:35], v[38:39]
    ds_write_b128 v222, v[32:35] offset:0
    s_waitcnt lgkmcnt(0)
    s_barrier
    s_cmp_lg_u32 s16, 0
    s_cbranch_scc1 x_g0e
    ds_read_b128 v[160:163], v221 offset:0
    ds_read_b128 v[164:167], v221 offset:1024
    ds_read_b128 v[168:171], v221 offset:2048
    ds_read_b128 v[172:175], v221 offset:3072
    ds_read_b128 v[176:179], v221 offset:4096
    ds_read_b128 v[180:183], v221 offset:5120
    ds_read_b128 v[184:187], v221 offset:6144
    ds_read_b128 v[188:191], v221 offset:7168
    s_waitcnt lgkmcnt(6)
    v_pk_add_f32 v[160:161], v[160:161], v[164:165]
    v_pk_add_f32 v[162:163], v[162:163], v[166:167]
    s_waitcnt lgkmcnt(4)
    v_pk_add_f32 v[168:169], v[168:169], v[172:173]
    v_pk_add_f32 v[170:171], v[170:171], v[174:175]
    s_waitcnt lgkmcnt(2)
    v_pk_add_f32 v[176:177], v[176:177], v[180:181]
    v_pk_add_f32 v[178:179], v[178:179], v[182:183]
    s_waitcnt lgkmcnt(0)
    v_pk_add_f32 v[184:185], v[184:185], v[188:189]
    v_pk_add_f32 v[186:187], v[186:187], v[190:191]
    v_pk_add_f32 v[160:161], v[160:161], v[168:169]
    v_pk_add_f32 v[176:177], v[176:177], v[184:185]
    v_pk_add_f32 v[162:163], v[162:163], v[170:171]
    v_pk_add_f32 v[178:179], v[178:179], v[186:187]
    v_pk_add_f32 v[160:161], v[160:161], v[176:177]
    v_pk_add_f32 v[162:163], v[162:163], v[178:179]
    v_cvt_pk_bf16_f32 v17, v160, v161
    v_lshlrev_b32 v160, 16, v17
    v_and_b32 v161, 0xffff0000, v17
    v_cvt_pk_bf16_f32 v18, v162, v163
    v_lshlrev_b32 v162, 16, v18
    v_and_b32 v163, 0xffff0000, v18
    v_add_f32 v160, s28, v160
    v_add_f32 v161, s28, v161
    v_add_f32 v162, s28, v162
    v_add_f32 v163, s28, v163
    v_cvt_pk_bf16_f32 v17, v160, v161
    v_lshlrev_b32 v160, 16, v17
    v_and_b32 v161, 0xffff0000, v17
    v_cvt_pk_bf16_f32 v18, v162, v163
    v_lshlrev_b32 v162, 16, v18
    v_and_b32 v163, 0xffff0000, v18
    v_mov_b32 v48, s32
    v_mov_b32 v49, s33
    s_cmp_ge_u32 s64, 8
    s_cbranch_scc1 x_q
    v_and_or_b32 v168, v160, s74, v216
    v_and_or_b32 v169, v161, s74, v217
    v_and_or_b32 v170, v162, s74, v218
    v_and_or_b32 v171, v163, s74, v219
    buffer_store_dwordx4 v[168:171], v220, s[12:15], s22 offen sc1
    v_max3_f32 v50, abs(v160), abs(v161), abs(v162)
    v_max_f32_e64 v50, v50, abs(v163)
    s_nop 1
    v_max_f32_dpp v50, v50, v50 row_ror:8 row_mask:0xf bank_mask:0xf
    s_nop 1
    v_max_f32_dpp v50, v50, v50 row_ror:4 row_mask:0xf bank_mask:0xf
    s_nop 1
    v_max_f32_dpp v50, v50, v50 row_ror:2 row_mask:0xf bank_mask:0xf
    s_nop 1
    v_max_f32_dpp v50, v50, v50 row_ror:1 row_mask:0xf bank_mask:0xf
    s_nop 1
    v_max_f32_dpp v50, v50, v50 row_bcast:15 row_mask:0xa bank_mask:0xf
    s_nop 1
    v_max_f32_dpp v50, v50, v50 row_bcast:31 row_mask:0xc bank_mask:0xf
    s_nop 0
    v_readlane_b32 s42, v50, 63
    s_nop 1
    v_mov_b32 v50, s42
    s_mov_b64 exec, 0xff
    buffer_store_dwordx4 v[48:51], v3, s[12:15], s79 offen sc1
    s_mov_b64 exec, -1
    s_branch x_g0e
x_q:
    s_cmp_lt_u32 s64, 12
    s_cbranch_scc1 x_nq
    v_lshlrev_b32 v164, 16, v52
    v_and_b32 v165, 0xffff0000, v52
    v_lshlrev_b32 v166, 16, v53
    v_and_b32 v167, 0xffff0000, v53
    v_pk_mul_f32 v[164:165], v[164:165], v[160:161]
    v_pk_mul_f32 v[166:167], v[166:167], v[162:163]
    ds_bpermute_b32 v180, v232, v164
    v_and_or_b32 v176, v164, s74, v216
    v_and_or_b32 v177, v165, s74, v217
    v_and_or_b32 v178, v166, s74, v218
    v_and_or_b32 v179, v167, s74, v219
    buffer_store_dwordx4 v[176:179], v220, s[12:15], s75 offen sc1
    v_and_or_b32 v181, v167, s74, v229
    v_and_or_b32 v182, v166, s74, v230
    v_and_or_b32 v183, v165, s74, v231
    s_waitcnt lgkmcnt(0)
    v_and_or_b32 v180, v180, s74, v228
    buffer_store_dwordx4 v[180:183], v234, s[12:15], s75 offen sc1
    v_and_b32 v164, s74, v164
    v_and_b32 v165, s74, v165
    v_and_b32 v166, s74, v166
    v_and_b32 v167, s74, v167
    v_pk_add_f32 v[164:165], v[164:165], v[166:167]
    v_add_f32 v50, v164, v165
    s_nop 1
    v_add_f32_dpp v50, v50, v50 row_ror:8 row_mask:0xf bank_mask:0xf
    s_nop 1
    v_add_f32_dpp v50, v50, v50 row_ror:4 row_mask:0xf bank_mask:0xf
    s_nop 1
    v_add_f32_dpp v50, v50, v50 row_ror:2 row_mask:0xf bank_mask:0xf
    s_nop 1
    v_add_f32_dpp v50, v50, v50 row_ror:1 row_mask:0xf bank_mask:0xf
    s_nop 1
    v_add_f32_dpp v50, v50, v50 row_bcast:15 row_mask:0xa bank_mask:0xf
    s_nop 1
    v_add_f32_dpp v50, v50, v50 row_bcast:31 row_mask:0xc bank_mask:0xf
    s_nop 0
    v_readlane_b32 s42, v50, 63
    s_nop 1
    v_mov_b32 v50, s42
    s_mov_b64 exec, 0xff
    buffer_store_dwordx4 v[48:51], v3, s[12:15], s79 offen sc1
    s_mov_b64 exec, -1
x_nq:
    ds_bpermute_b32 v172, v232, v160
    v_and_or_b32 v168, v160, s74, v216
    v_and_or_b32 v169, v161, s74, v217
    v_and_or_b32 v170, v162, s74, v218
    v_and_or_b32 v171, v163, s74, v219
    buffer_store_dwordx4 v[168:171], v220, s[12:15], s22 offen sc1
    v_and_or_b32 v173, v163, s74, v229
    v_and_or_b32 v174, v162, s74, v230
    v_and_or_b32 v175, v161, s74, v231
    s_waitcnt lgkmcnt(0)
    v_and_or_b32 v172, v172, s74, v228
    buffer_store_dwordx4 v[172:175], v234, s[12:15], s22 offen sc1
x_g0e:
    s_barrier
    s_cmp_lt_u32 s16, 4
    s_cbranch_scc1 x_t1
    v_xor_b32 v4, 0, v14
    s_add_u32 s43, s68, 98304
    s_mov_b32 m0, s43
    s_add_u32 s42, s19, 0
    buffer_load_dwordx4 v4, s[8:11], s42 offen nt lds
    v_xor_b32 v4, 64, v14
    s_add_u32 s43, s68, 99328
    s_mov_b32 m0, s43
    s_add_u32 s42, s19, 24576
    buffer_load_dwordx4 v4, s[8:11], s42 offen nt lds
    v_xor_b32 v4, 0, v14
    s_add_u32 s43, s68, 100352
    s_mov_b32 m0, s43
    s_add_u32 s42, s19, 49152
    buffer_load_dwordx4 v4, s[8:11], s42 offen nt lds
    v_xor_b32 v4, 64, v14
    s_add_u32 s43, s68, 101376
    s_mov_b32 m0, s43
    s_add_u32 s42, s19, 73728
    buffer_load_dwordx4 v4, s[8:11], s42 offen nt lds
    v_xor_b32 v4, 128, v14
    s_add_u32 s43, s68, 102400
    s_mov_b32 m0, s43
    s_add_u32 s42, s19, 98304
    buffer_load_dwordx4 v4, s[8:11], s42 offen nt lds
    v_xor_b32 v4, 192, v14
    s_add_u32 s43, s68, 103424
    s_mov_b32 m0, s43
    s_add_u32 s42, s19, 122880
    buffer_load_dwordx4 v4, s[8:11], s42 offen nt lds
    v_xor_b32 v4, 128, v14
    s_add_u32 s43, s68, 104448
    s_mov_b32 m0, s43
    s_add_u32 s42, s19, 147456
    buffer_load_dwordx4 v4, s[8:11], s42 offen nt lds
    v_xor_b32 v4, 192, v14
    s_add_u32 s43, s68, 105472
    s_mov_b32 m0, s43
    s_add_u32 s42, s19, 172032
    buffer_load_dwordx4 v4, s[8:11], s42 offen nt lds
    s_waitcnt vmcnt(0)
    s_barrier
    s_branch x_t2
x_t1:
    s_barrier
    ds_read_b64_tr_b16 v[128:129], v208 offset:0
    ds_read_b64_tr_b16 v[130:131], v208 offset:2048
    ds_read_b64_tr_b16 v[132:133], v209 offset:0
    ds_read_b64_tr_b16 v[134:135], v209 offset:2048
    ds_read_b64_tr_b16 v[136:137], v210 offset:0
    ds_read_b64_tr_b16 v[138:139], v210 offset:2048
    ds_read_b64_tr_b16 v[140:141], v211 offset:0
    ds_read_b64_tr_b16 v[142:143], v211 offset:2048
    ds_read_b64_tr_b16 v[144:145], v208 offset:16384
    ds_read_b64_tr_b16 v[146:147], v208 offset:18432
    ds_read_b64_tr_b16 v[148:149], v209 offset:16384
    ds_read_b64_tr_b16 v[150:151], v209 offset:18432
    ds_read_b64_tr_b16 v[152:153], v210 offset:16384
    ds_read_b64_tr_b16 v[154:155], v210 offset:18432
    s_waitcnt lgkmcnt(12)
    v_mfma_f32_16x16x32_bf16 v[64:67], v[120:123], v[128:131], 0
    ds_read_b64_tr_b16 v[156:157], v211 offset:16384
    ds_read_b64_tr_b16 v[158:159], v211 offset:18432
    s_waitcnt lgkmcnt(12)
    v_mfma_f32_16x16x32_bf16 v[68:71], v[120:123], v[132:135], 0
    s_waitcnt lgkmcnt(10)
    v_mfma_f32_16x16x32_bf16 v[72:75], v[120:123], v[136:139], 0
    s_waitcnt lgkmcnt(8)
    v_mfma_f32_16x16x32_bf16 v[76:79], v[120:123], v[140:143], 0
    s_waitcnt lgkmcnt(6)
    v_mfma_f32_16x16x32_bf16 v[64:67], v[124:127], v[144:147], v[64:67]
    s_waitcnt lgkmcnt(4)
    v_mfma_f32_16x16x32_bf16 v[68:71], v[124:127], v[148:151], v[68:71]
    s_waitcnt lgkmcnt(2)
    v_mfma_f32_16x16x32_bf16 v[72:75], v[124:127], v[152:155], v[72:75]
    s_waitcnt lgkmcnt(0)
    v_mfma_f32_16x16x32_bf16 v[76:79], v[124:127], v[156:159], v[76:79]
    s_nop 3
    v_cndmask_b32 v64, v64, v68, s[60:61]
    s_nop 0
    v_cndmask_b32 v64, v64, v72, s[62:63]
    s_nop 0
    v_cndmask_b32 v64, v64, v76, s[72:73]
    v_and_or_b32 v226, v64, s74, v212
    buffer_store_dword v226, v13, s[12:15], s31 offen offset:0
x_t2:
    s_mov_b32 s83, 0
x_g1:
    s_and_b32 s42, s83, 63
    s_cmp_eq_u32 s42, 63
    s_cselect_b32 s42, 524288, 0
    s_add_u32 s42, s42, s80
    buffer_load_dwordx4 v[32:35], v223, s[12:15], s42 offen offset:2048 sc1
    s_waitcnt vmcnt(0)
    v_xor_b32 v32, v216, v32
    v_xor_b32 v33, v217, v33
    v_xor_b32 v34, v218, v34
    v_xor_b32 v35, v219, v35
    v_or3_b32 v17, v32, v33, 0
    v_or3_b32 v17, v34, v35, v17
    v_and_b32 v17, 0xff, v17
    v_cmp_ne_u32 vcc, 0, v17
    s_cbranch_vccz x_g1x
    s_and_b32 s42, s83, 63
    s_cmp_lg_u32 s42, 48
    s_cbranch_scc1 x_g1n
    s_add_u32 s43, s39, 524288
    buffer_load_dwordx4 v[44:47], v3, s[12:15], s39 offen offset:0 sc1
    s_waitcnt vmcnt(0)
    buffer_store_dwordx4 v[44:47], v3, s[12:15], s43 offen offset:0 sc1
    s_waitcnt vmcnt(0)
    buffer_load_dwordx4 v[44:47], v3, s[12:15], s39 offen offset:1024 sc1
    s_waitcnt vmcnt(0)
    buffer_store_dwordx4 v[44:47], v3, s[12:15], s43 offen offset:1024 sc1
    s_waitcnt vmcnt(0)
    buffer_load_dwordx4 v[44:47], v3, s[12:15], s39 offen offset:2048 sc1
    s_waitcnt vmcnt(0)
    buffer_store_dwordx4 v[44:47], v3, s[12:15], s43 offen offset:2048 sc1
    s_waitcnt vmcnt(0)
x_g1n:
    s_add_u32 s83, s83, 1
    s_cmp_lt_u32 s83, 0x40000
    s_cbranch_scc1 x_g1
x_g1x:
    ds_write_b128 v222, v[32:35] offset:8192
    s_waitcnt lgkmcnt(0)
    s_barrier
    s_cmp_lg_u32 s16, 0
    s_cbranch_scc1 x_g1e
    ds_read_b128 v[160:163], v221 offset:8192
    ds_read_b128 v[164:167], v221 offset:9216
    ds_read_b128 v[168:171], v221 offset:10240
    ds_read_b128 v[172:175], v221 offset:11264
    ds_read_b128 v[176:179], v221 offset:12288
    ds_read_b128 v[180:183], v221 offset:13312
    ds_read_b128 v[184:187], v221 offset:14336
    ds_read_b128 v[188:191], v221 offset:15360
    s_waitcnt lgkmcnt(6)
    v_pk_add_f32 v[160:161], v[160:161], v[164:165]
    v_pk_add_f32 v[162:163], v[162:163], v[166:167]
    s_waitcnt lgkmcnt(4)
    v_pk_add_f32 v[168:169], v[168:169], v[172:173]
    v_pk_add_f32 v[170:171], v[170:171], v[174:175]
    s_waitcnt lgkmcnt(2)
    v_pk_add_f32 v[176:177], v[176:177], v[180:181]
    v_pk_add_f32 v[178:179], v[178:179], v[182:183]
    s_waitcnt lgkmcnt(0)
    v_pk_add_f32 v[184:185], v[184:185], v[188:189]
    v_pk_add_f32 v[186:187], v[186:187], v[190:191]
    v_pk_add_f32 v[160:161], v[160:161], v[168:169]
    v_pk_add_f32 v[176:177], v[176:177], v[184:185]
    v_pk_add_f32 v[162:163], v[162:163], v[170:171]
    v_pk_add_f32 v[178:179], v[178:179], v[186:187]
    v_pk_add_f32 v[160:161], v[160:161], v[176:177]
    v_pk_add_f32 v[162:163], v[162:163], v[178:179]
    v_mov_b32 v164, v160
    v_mov_b32 v165, v161
    v_mov_b32 v166, v162
    v_mov_b32 v167, v163
    v_permlane32_swap_b32 v160, v164
    v_permlane32_swap_b32 v161, v165
    v_permlane32_swap_b32 v162, v166
    v_permlane32_swap_b32 v163, v167
    v_pk_add_f32 v[160:161], v[160:161], v[164:165]
    v_pk_add_f32 v[162:163], v[162:163], v[166:167]
    v_cvt_pk_bf16_f32 v17, v160, v161
    v_lshlrev_b32 v160, 16, v17
    v_and_b32 v161, 0xffff0000, v17
    v_cvt_pk_bf16_f32 v18, v162, v163
    v_lshlrev_b32 v162, 16, v18
    v_and_b32 v163, 0xffff0000, v18
    s_mov_b32 exec_hi, 0
    ds_bpermute_b32 v172, v232, v160
    v_and_or_b32 v168, v160, s74, v216
    v_and_or_b32 v169, v161, s74, v217
    v_and_or_b32 v170, v162, s74, v218
    v_and_or_b32 v171, v163, s74, v219
    buffer_store_dwordx4 v[168:171], v233, s[12:15], s23 offen sc1
    v_and_or_b32 v173, v163, s74, v229
    v_and_or_b32 v174, v162, s74, v230
    v_and_or_b32 v175, v161, s74, v231
    s_waitcnt lgkmcnt(0)
    v_and_or_b32 v172, v172, s74, v228
    buffer_store_dwordx4 v[172:175], v235, s[12:15], s23 offen sc1
    s_mov_b32 exec_hi, -1
x_g1e:
    s_sub_u32 s42, s16, 0
    s_cmp_ge_u32 s42, 3
    s_cbranch_scc1 x_nb
    s_lshl_b32 s42, s42, 10
    s_add_u32 s42, s42, s29
    s_add_u32 s43, s42, 524288
    buffer_load_dwordx4 v[44:47], v3, s[12:15], s42 offen sc1
    s_waitcnt vmcnt(0)
    buffer_store_dwordx4 v[44:47], v3, s[12:15], s43 offen sc1
x_nb:
    s_cmp_lg_u32 s16, 0
    s_cbranch_scc1 g_end
    s_lshl_b32 s78, s34, 14
    s_add_u32 s78, s78, 17039360
    s_lshl_b32 s79, s34, 7
    s_add_u32 s79, s79, 16842752
    v_mov_b32 v22, 0
    s_mov_b32 s56, s48
    s_mov_b32 s57, s49
    s_mov_b32 s58, 2048
    s_mov_b32 s59, 0x00020000
    s_and_b32 s60, s32, 0xffff
    s_lshr_b32 s61, s32, 16
    s_and_b32 s62, s33, 0xffff
    s_lshr_b32 s63, s33, 16
    s_bfe_u32 s44, s32, 524288
    s_bfe_u32 s45, s32, 524296
    s_bfe_u32 s46, s32, 524304
    s_bfe_u32 s47, s32, 524312
    s_bfe_u32 s48, s33, 524288
    s_bfe_u32 s49, s33, 524296
    s_bfe_u32 s50, s33, 524304
    s_bfe_u32 s51, s33, 524312
    v_and_b32 v9, 15, v0
    v_lshlrev_b32 v9, 6, v9
    v_bfe_u32 v19, v0, 4, 1
    v_lshl_add_u32 v9, v19, 5, v9
    v_lshlrev_b32 v18, 9, v19
    v_bfe_u32 v19, v0, 5, 1
    v_lshl_add_u32 v9, v19, 4, v9
    v_lshl_add_u32 v18, v19, 11, v18
    v_bfe_u32 v19, v0, 2, 2
    v_lshl_add_u32 v18, v19, 7, v18
    v_lshl_add_u32 v18, v15, 4, v18
    s_mov_b32 s43, 16908288
    s_lshl_b32 s70, s64, 13
    s_add_u32 s70, s70, 17301504
    s_add_u32 s71, s70, 131072
    s_add_u32 s72, s70, 4096
    s_add_u32 s73, s71, 4096
    v_mov_b32 v21, 0xffff0000
    buffer_load_dwordx4 v[92:95], v9, s[56:59], 0 offen offset:0
    buffer_load_dwordx4 v[96:99], v9, s[56:59], 0 offen offset:1024
    s_mov_b32 s83, 0
x_sb:
    s_sleep 12
    buffer_load_dwordx4 v[100:103], v18, s[12:15], s43 offen offset:0 sc1
    buffer_load_dwordx4 v[104:107], v18, s[12:15], s43 offen offset:1024 sc1
    buffer_load_dwordx4 v[108:111], v18, s[12:15], s43 offen offset:64 sc1
    buffer_load_dwordx4 v[112:115], v18, s[12:15], s43 offen offset:1088 sc1
    s_sub_u32 s42, s43, 8192
    buffer_load_dwordx4 v[116:119], v18, s[12:15], s42 offen offset:0 sc1
    buffer_load_dwordx4 v[120:123], v18, s[12:15], s42 offen offset:1024 sc1
    buffer_load_dwordx4 v[124:127], v18, s[12:15], s42 offen offset:64 sc1
    buffer_load_dwordx4 v[128:131], v18, s[12:15], s42 offen offset:1088 sc1
    s_waitcnt vmcnt(0)
    v_xor_b32 v100, v216, v100
    v_xor_b32 v101, v217, v101
    v_xor_b32 v102, v218, v102
    v_xor_b32 v103, v219, v103
    v_xor_b32 v104, v216, v104
    v_xor_b32 v105, v217, v105
    v_xor_b32 v106, v218, v106
    v_xor_b32 v107, v219, v107
    v_xor_b32 v108, v216, v108
    v_xor_b32 v109, v217, v109
    v_xor_b32 v110, v218, v110
    v_xor_b32 v111, v219, v111
    v_xor_b32 v112, v216, v112
    v_xor_b32 v113, v217, v113
    v_xor_b32 v114, v218, v114
    v_xor_b32 v115, v219, v115
    v_xor_b32 v116, v216, v116
    v_xor_b32 v117, v217, v117
    v_xor_b32 v118, v218, v118
    v_xor_b32 v119, v219, v119
    v_xor_b32 v120, v216, v120
    v_xor_b32 v121, v217, v121
    v_xor_b32 v122, v218, v122
    v_xor_b32 v123, v219, v123
    v_xor_b32 v124, v216, v124
    v_xor_b32 v125, v217, v125
    v_xor_b32 v126, v218, v126
    v_xor_b32 v127, v219, v127
    v_xor_b32 v128, v216, v128
    v_xor_b32 v129, v217, v129
    v_xor_b32 v130, v218, v130
    v_xor_b32 v131, v219, v131
    v_or3_b32 v19, v100, v101, 0
    v_or3_b32 v19, v102, v103, v19
    v_or3_b32 v19, v104, v105, v19
    v_or3_b32 v19, v106, v107, v19
    v_or3_b32 v19, v108, v109, v19
    v_or3_b32 v19, v110, v111, v19
    v_or3_b32 v19, v112, v113, v19
    v_or3_b32 v19, v114, v115, v19
    v_or3_b32 v19, v116, v117, v19
    v_or3_b32 v19, v118, v119, v19
    v_or3_b32 v19, v120, v121, v19
    v_or3_b32 v19, v122, v123, v19
    v_or3_b32 v19, v124, v125, v19
    v_or3_b32 v19, v126, v127, v19
    v_or3_b32 v19, v128, v129, v19
    v_or3_b32 v19, v130, v131, v19
    v_and_b32 v19, 0xff, v19
    v_cmp_ne_u32 vcc, 0, v19
    s_cbranch_vccz x_sbx
    s_add_u32 s83, s83, 1
    s_cmp_lt_u32 s83, 0x40000
    s_cbranch_scc1 x_sb
x_sbx:
    v_lshlrev_b32 v48, 16, v92
    v_and_b32 v49, 0xffff0000, v92
    v_lshlrev_b32 v50, 16, v93
    v_and_b32 v51, 0xffff0000, v93
    v_lshlrev_b32 v52, 16, v94
    v_and_b32 v53, 0xffff0000, v94
    v_lshlrev_b32 v54, 16, v95
    v_and_b32 v55, 0xffff0000, v95
    v_lshlrev_b32 v56, 16, v96
    v_and_b32 v57, 0xffff0000, v96
    v_lshlrev_b32 v58, 16, v97
    v_and_b32 v59, 0xffff0000, v97
    v_lshlrev_b32 v60, 16, v98
    v_and_b32 v61, 0xffff0000, v98
    v_lshlrev_b32 v62, 16, v99
    v_and_b32 v63, 0xffff0000, v99
    s_mov_b32 s83, 0
    s_mov_b64 exec, 1
x_go:
    buffer_load_dwordx2 v[28:29], v22, s[12:15], s79 offen sc1
    s_waitcnt vmcnt(0)
    v_cmp_ne_u64 vcc, s[32:33], v[28:29]
    s_cbranch_vccz x_goy
    s_sleep 1
    s_add_u32 s83, s83, 1
    s_cmp_lt_u32 s83, 0x40000
    s_cbranch_scc1 x_go
x_goy:
    s_mov_b64 exec, -1
x_gox:
    s_lshl_b32 s42, s65, 13
    s_add_u32 s78, s78, s42
    v_lshlrev_b32 v32, 7, v2
    s_xor_b32 s42, s78, 8192
    s_mov_b32 s83, 0
    s_mov_b64 vcc, -1
    s_mov_b64 s[40:41], -1
x_pk:
    s_mov_b64 exec, vcc
    s_cbranch_execz x_pka
    buffer_load_dwordx4 v[24:27], v32, s[12:15], s78 offen sc1
x_pka:
    s_mov_b64 exec, s[40:41]
    s_cbranch_execz x_pkb
    buffer_load_dwordx4 v[28:31], v32, s[12:15], s42 offen sc1
x_pkb:
    s_mov_b64 exec, -1
    s_waitcnt vmcnt(0)
x_pkc:
    v_cmp_ne_u32 vcc, s32, v25
    v_cmp_ne_u32 s[20:21], s33, v27
    v_cmp_ne_u32 s[40:41], s32, v29
    v_cmp_ne_u32 s[22:23], s33, v31
    v_max_u32 v33, v24, v28
    v_min_u32 v34, v24, v28
    s_or_b64 vcc, vcc, s[20:21]
    s_or_b64 s[40:41], s[40:41], s[22:23]
    s_or_b64 s[20:21], vcc, s[40:41]
    s_cbranch_scc0 x_pkx
    s_add_u32 s83, s83, 1
    s_cmp_lt_u32 s83, 0x40000
    s_cbranch_scc1 x_pk
x_pkx:
    v_mov_b32 v35, v33
    v_max3_u32 v34, v34, v26, v30
    s_nop 0
    v_max_u32_dpp v35, v35, v35 row_ror:8 row_mask:0xf bank_mask:0xf
    s_nop 1
    v_max_u32_dpp v35, v35, v35 row_ror:4 row_mask:0xf bank_mask:0xf
    s_nop 1
    v_max_u32_dpp v35, v35, v35 row_ror:2 row_mask:0xf bank_mask:0xf
    s_nop 1
    v_max_u32_dpp v35, v35, v35 row_ror:1 row_mask:0xf bank_mask:0xf
    s_nop 1
    v_max_u32_dpp v35, v35, v35 row_bcast:15 row_mask:0xa bank_mask:0xf
    s_nop 1
    v_max_u32_dpp v35, v35, v35 row_bcast:31 row_mask:0xc bank_mask:0xf
    s_nop 0
    v_readlane_b32 s40, v35, 63
    s_cmp_eq_u32 s65, 0
    s_cbranch_scc1 x_t1st
    v_cmp_eq_u32 vcc, s40, v33
    s_nop 1
    v_cndmask_b32 v35, v33, v34, vcc
    s_nop 1
    v_max_u32_dpp v35, v35, v35 row_ror:8 row_mask:0xf bank_mask:0xf
    s_nop 1
    v_max_u32_dpp v35, v35, v35 row_ror:4 row_mask:0xf bank_mask:0xf
    s_nop 1
    v_max_u32_dpp v35, v35, v35 row_ror:2 row_mask:0xf bank_mask:0xf
    s_nop 1
    v_max_u32_dpp v35, v35, v35 row_ror:1 row_mask:0xf bank_mask:0xf
    s_nop 1
    v_max_u32_dpp v35, v35, v35 row_bcast:15 row_mask:0xa bank_mask:0xf
    s_nop 1
    v_max_u32_dpp v35, v35, v35 row_bcast:31 row_mask:0xc bank_mask:0xf
    s_nop 0
    v_readlane_b32 s41, v35, 63
    s_mov_b32 s40, s41
x_t1st:
    v_mov_b32 v46, s40
    s_bfe_u32 s42, s40, 0x70005
    s_lshl_b32 s42, s42, 13
    s_and_b32 s40, s40, 1
    s_lshl_b32 s40, s40, 12
    s_add_u32 s42, s42, s40
    s_lshr_b32 s43, s42, 5
    s_add_u32 s42, s42, 18874368
    s_add_u32 s43, s43, 17170432
    s_mov_b32 s83, 0
x_ph:
    s_mov_b64 exec, 1
    buffer_load_dwordx4 v[28:31], v22, s[12:15], s43 offen sc1
    s_mov_b64 exec, -1
    buffer_load_dwordx4 v[64:67], v3, s[12:15], s42 offen offset:0 sc1
    buffer_load_dwordx4 v[68:71], v3, s[12:15], s42 offen offset:1024 sc1
    buffer_load_dwordx4 v[72:75], v3, s[12:15], s42 offen offset:2048 sc1
    buffer_load_dwordx4 v[76:79], v3, s[12:15], s42 offen offset:3072 sc1
    s_waitcnt vmcnt(4)
    v_readfirstlane_b32 s22, v28
    v_readfirstlane_b32 s23, v29
    v_readfirstlane_b32 s20, v30
    v_readfirstlane_b32 s21, v31
    s_xor_b64 s[22:23], s[22:23], s[32:33]
    s_cbranch_scc1 x_pr
    s_waitcnt vmcnt(3)
    v_xor_b32 v64, s44, v64
    v_xor_b32 v65, s45, v65
    v_xor_b32 v66, s46, v66
    v_xor_b32 v67, s47, v67
    v_or3_b32 v19, v64, v65, v66
    v_or_b32 v19, v19, v67
    v_pk_fma_f32 v[64:65], v[64:65], s[20:21], s[20:21] op_sel:[0,1,0] op_sel_hi:[1,1,0]
    v_pk_fma_f32 v[66:67], v[66:67], s[20:21], s[20:21] op_sel:[0,1,0] op_sel_hi:[1,1,0]
    v_cmp_ne_u16_sdwa vcc, v19, v22 src0_sel:BYTE_0 src1_sel:DWORD
    v_pk_fma_f32 v[64:65], v[64:65], v[116:117], v[100:101]
    v_pk_fma_f32 v[66:67], v[66:67], v[118:119], v[102:103]
    v_cvt_pk_bf16_f32 v32, v64, v65
    v_cvt_pk_bf16_f32 v33, v66, v67
    s_cbranch_vccnz x_pr
    v_lshl_or_b32 v64, v32, 16, s60
    v_and_or_b32 v65, v32, v21, s61
    v_lshl_or_b32 v66, v33, 16, s62
    v_and_or_b32 v67, v33, v21, s63
    buffer_store_dwordx4 v[64:67], v3, s[12:15], s70 offen offset:0
    s_waitcnt vmcnt(3)
    v_xor_b32 v68, s48, v68
    v_xor_b32 v69, s49, v69
    v_xor_b32 v70, s50, v70
    v_xor_b32 v71, s51, v71
    v_or3_b32 v19, v68, v69, v70
    v_or_b32 v19, v19, v71
    v_pk_fma_f32 v[68:69], v[68:69], s[20:21], s[20:21] op_sel:[0,1,0] op_sel_hi:[1,1,0]
    v_pk_fma_f32 v[70:71], v[70:71], s[20:21], s[20:21] op_sel:[0,1,0] op_sel_hi:[1,1,0]
    v_cmp_ne_u16_sdwa vcc, v19, v22 src0_sel:BYTE_0 src1_sel:DWORD
    v_pk_fma_f32 v[68:69], v[68:69], v[120:121], v[104:105]
    v_pk_fma_f32 v[70:71], v[70:71], v[122:123], v[106:107]
    v_cvt_pk_bf16_f32 v34, v68, v69
    v_cvt_pk_bf16_f32 v35, v70, v71
    s_cbranch_vccnz x_pr
    v_lshl_or_b32 v68, v34, 16, s60
    v_and_or_b32 v69, v34, v21, s61
    v_lshl_or_b32 v70, v35, 16, s62
    v_and_or_b32 v71, v35, v21, s63
    buffer_store_dwordx4 v[68:71], v3, s[12:15], s70 offen offset:1024
    s_waitcnt vmcnt(3)
    v_xor_b32 v72, s44, v72
    v_xor_b32 v73, s45, v73
    v_xor_b32 v74, s46, v74
    v_xor_b32 v75, s47, v75
    v_or3_b32 v19, v72, v73, v74
    v_or_b32 v19, v19, v75
    v_pk_fma_f32 v[72:73], v[72:73], s[20:21], s[20:21] op_sel:[0,1,0] op_sel_hi:[1,1,0]
    v_pk_fma_f32 v[74:75], v[74:75], s[20:21], s[20:21] op_sel:[0,1,0] op_sel_hi:[1,1,0]
    v_cmp_ne_u16_sdwa vcc, v19, v22 src0_sel:BYTE_0 src1_sel:DWORD
    v_pk_fma_f32 v[72:73], v[72:73], v[124:125], v[108:109]
    v_pk_fma_f32 v[74:75], v[74:75], v[126:127], v[110:111]
    v_cvt_pk_bf16_f32 v36, v72, v73
    v_cvt_pk_bf16_f32 v37, v74, v75
    s_cbranch_vccnz x_pr
    v_lshl_or_b32 v72, v36, 16, s60
    v_and_or_b32 v73, v36, v21, s61
    v_lshl_or_b32 v74, v37, 16, s62
    v_and_or_b32 v75, v37, v21, s63
    buffer_store_dwordx4 v[72:75], v3, s[12:15], s70 offen offset:2048
    s_waitcnt vmcnt(3)
    v_xor_b32 v76, s48, v76
    v_xor_b32 v77, s49, v77
    v_xor_b32 v78, s50, v78
    v_xor_b32 v79, s51, v79
    v_or3_b32 v19, v76, v77, v78
    v_or_b32 v19, v19, v79
    v_pk_fma_f32 v[76:77], v[76:77], s[20:21], s[20:21] op_sel:[0,1,0] op_sel_hi:[1,1,0]
    v_pk_fma_f32 v[78:79], v[78:79], s[20:21], s[20:21] op_sel:[0,1,0] op_sel_hi:[1,1,0]
    v_cmp_ne_u16_sdwa vcc, v19, v22 src0_sel:BYTE_0 src1_sel:DWORD
    v_pk_fma_f32 v[76:77], v[76:77], v[128:129], v[112:113]
    v_pk_fma_f32 v[78:79], v[78:79], v[130:131], v[114:115]
    v_cvt_pk_bf16_f32 v38, v76, v77
    v_cvt_pk_bf16_f32 v39, v78, v79
    s_cbranch_vccnz x_pr
    v_lshl_or_b32 v76, v38, 16, s60
    v_and_or_b32 v77, v38, v21, s61
    v_lshl_or_b32 v78, v39, 16, s62
    v_and_or_b32 v79, v39, v21, s63
    buffer_store_dwordx4 v[76:79], v3, s[12:15], s70 offen offset:3072
x_phx:
    buffer_store_dwordx4 v[64:67], v3, s[12:15], s71 offen offset:0 sc1
    buffer_store_dwordx4 v[68:71], v3, s[12:15], s71 offen offset:1024 sc1
    buffer_store_dwordx4 v[72:75], v3, s[12:15], s71 offen offset:2048 sc1
    buffer_store_dwordx4 v[76:79], v3, s[12:15], s71 offen offset:3072 sc1
    v_lshlrev_b32 v100, 16, v32
    v_and_b32 v101, 0xffff0000, v32
    v_lshlrev_b32 v102, 16, v33
    v_and_b32 v103, 0xffff0000, v33
    v_lshlrev_b32 v104, 16, v34
    v_and_b32 v105, 0xffff0000, v34
    v_lshlrev_b32 v106, 16, v35
    v_and_b32 v107, 0xffff0000, v35
    v_lshlrev_b32 v108, 16, v36
    v_and_b32 v109, 0xffff0000, v36
    v_lshlrev_b32 v110, 16, v37
    v_and_b32 v111, 0xffff0000, v37
    v_lshlrev_b32 v112, 16, v38
    v_and_b32 v113, 0xffff0000, v38
    v_lshlrev_b32 v114, 16, v39
    v_and_b32 v115, 0xffff0000, v39
    v_pk_mul_f32 v[8:9], v[48:49], v[100:101]
    v_pk_fma_f32 v[8:9], v[50:51], v[102:103], v[8:9]
    v_pk_fma_f32 v[8:9], v[52:53], v[104:105], v[8:9]
    v_pk_fma_f32 v[8:9], v[54:55], v[106:107], v[8:9]
    v_pk_fma_f32 v[8:9], v[56:57], v[108:109], v[8:9]
    v_pk_fma_f32 v[8:9], v[58:59], v[110:111], v[8:9]
    v_pk_fma_f32 v[8:9], v[60:61], v[112:113], v[8:9]
    v_pk_fma_f32 v[8:9], v[62:63], v[114:115], v[8:9]
    v_add_f32 v8, v8, v9
    s_nop 1
    v_add_f32_dpp v8, v8, v8 row_ror:8 row_mask:0xf bank_mask:0xf
    s_nop 1
    v_add_f32_dpp v8, v8, v8 row_ror:4 row_mask:0xf bank_mask:0xf
    s_nop 1
    v_add_f32_dpp v8, v8, v8 row_ror:2 row_mask:0xf bank_mask:0xf
    s_nop 1
    v_add_f32_dpp v8, v8, v8 row_ror:1 row_mask:0xf bank_mask:0xf
    s_nop 1
    v_add_f32_dpp v8, v8, v8 row_bcast:15 row_mask:0xa bank_mask:0xf
    s_nop 1
    v_add_f32_dpp v8, v8, v8 row_bcast:31 row_mask:0xc bank_mask:0xf
    v_cvt_pk_bf16_f32 v8, v8, v8
    v_lshlrev_b32 v8, 16, v8
    v_mul_f32 v8, 0xbfb8aa3b, v8
    v_exp_f32 v8, v8
    s_nop 0
    v_add_f32 v8, 1.0, v8
    v_rcp_f32 v8, v8
    s_nop 0
    v_cvt_pk_bf16_f32 v8, v8, v8
    v_lshlrev_b32 v8, 16, v8
    s_nop 0
    v_readlane_b32 s46, v8, 63
    v_mov_b32 v44, s32
    v_mov_b32 v45, s33
    v_mov_b32 v47, s46
    s_mov_b64 exec, 0xff
    buffer_store_dwordx4 v[44:47], v3, s[12:15], s73 offen sc1
    s_mov_b64 exec, -1
    s_sleep 20
r_start:
    s_lshl_b32 s62, s34, 1
    s_lshr_b32 s42, s34, 2
    s_add_u32 s62, s62, s42
    s_lshl_b32 s62, s62, 13
    s_add_u32 s62, s62, 17432576
    s_add_u32 s61, s62, 4096
    s_and_b32 s18, s34, 3
    s_lshl_b32 s18, s18, 4
    s_add_u32 s18, s18, s35
    v_mov_b32 v11, 0
    v_and_b32 v4, 3, v0
    v_lshrrev_b32 v7, 4, v2
    v_lshlrev_b32 v5, 3, v4
    v_lshl_add_u32 v5, v7, 1, v5
    v_lshlrev_b32 v6, 10, v4
    v_lshl_add_u32 v6, v7, 2, v6
    v_lshrrev_b32 v86, 1, v4
    v_lshlrev_b32 v86, 9, v86
    v_and_b32 v87, 1, v4
    v_lshl_add_u32 v85, v87, 10, v86
    v_lshl_add_u32 v85, v7, 2, v85
    s_and_b32 s30, s18, 1
    s_bfe_u32 s31, s18, 0x20001
    s_bfe_u32 s40, s18, 0x20003
    s_lshr_b32 s41, s18, 5
    s_lshl_b32 s45, s41, 11
    s_lshl_b32 s42, s30, 8
    s_add_u32 s45, s45, s42
    s_lshl_b32 s42, s40, 6
    s_add_u32 s45, s45, s42
    s_lshl_b32 s31, s31, 4
    s_add_u32 s45, s45, s31
    s_add_u32 s62, s62, s45
    s_lshl_b32 s30, s30, 9
    s_add_u32 s31, s31, s30
    s_lshl_b32 s40, s40, 7
    s_add_u32 s31, s31, s40
    s_lshl_b32 s41, s41, 6
    s_add_u32 s31, s31, s41
    s_add_u32 s31, s31, 16916480
    s_mov_b32 s83, 0
r_ld:
    s_mov_b64 exec, 1
    buffer_load_dwordx4 v[32:35], v11, s[12:15], s61 offen sc1
    s_mov_b64 exec, -1
    buffer_load_dword v41, v85, s[12:15], s62 offen sc1
    buffer_load_dword v91, v6, s[12:15], s31 offen sc1
    s_bitcmp1_b32 s18, 1
    s_cselect_b32 s42, s33, s32
    v_lshlrev_b32 v88, 3, v7
    v_lshrrev_b32_e64 v88, v88, s42
    v_and_b32 v88, 0xff, v88
    v_lshlrev_b32 v89, 4, v7
    v_lshrrev_b64 v[82:83], v89, s[32:33]
    v_and_b32 v82, 0xffff, v82
    s_waitcnt vmcnt(0)
    v_readfirstlane_b32 s50, v32
    v_readfirstlane_b32 s51, v33
    v_readfirstlane_b32 s40, v34
    v_readfirstlane_b32 s46, v35
    v_xor_b32 v91, v88, v91
    v_xor_b32 v41, v82, v41
    v_or_b32 v19, v91, v41
    v_cmp_ne_u16 vcc, 0, v19
    s_xor_b64 s[50:51], s[50:51], s[32:33]
    s_or_b64 vcc, vcc, s[50:51]
    s_cbranch_vccz r_ldx
    s_sleep 2
    s_add_u32 s83, s83, 1
    s_cmp_lt_u32 s83, 0x40000
    s_cbranch_scc1 r_ld
r_ldx:
    v_mul_f32 v80, s46, v91
    s_bfe_u32 s46, s40, 0x70005
    s_bfe_u32 s47, s40, 0x30002
    s_bfe_u32 s60, s40, 0x10001
    s_bfe_u32 s63, s40, 0x70005
    s_lshl_b32 s63, s63, 13
    s_and_b32 s40, s40, 1
    s_lshl_b32 s40, s40, 12
    s_add_u32 s63, s63, s40
    s_add_u32 s63, s63, s45
    s_add_u32 s63, s63, 18874368
    buffer_load_dword v44, v85, s[12:15], s63 offen sc1
    v_lshrrev_b32 v10, 2, v2
    v_lshlrev_b32 v10, 7, v10
    v_lshl_add_u32 v10, v4, 4, v10
    s_lshl_b32 s44, s18, 13
    s_and_b32 s42, s34, 4
    s_lshl_b32 s42, s42, 4
    s_add_u32 s44, s44, s42
    s_add_u32 s44, s44, 17825792
    s_add_u32 s45, s44, 4096
    s_lshr_b32 s61, s46, 4
    s_and_b32 s41, s46, 15
    s_lshl_b32 s41, s41, 4
    s_add_u32 s41, s41, s61
    s_lshr_b32 s61, s46, 3
    s_cmp_eq_u32 s61, 1
    s_cselect_b32 s61, 120, 0
    s_sub_u32 s41, s41, s61
    s_lshl_b32 s61, s47, 8
    s_add_u32 s41, s41, s61
    s_cmp_ge_u32 s47, 4
    s_cselect_b32 s61, 896, 0
    s_cmp_eq_u32 s46, 0
    s_cselect_b32 s61, s61, 0
    s_sub_u32 s41, s41, s61
    s_sub_u32 s61, 2048, s41
    s_cmp_eq_u32 s41, 0
    s_cselect_b32 s61, 1024, s61
    s_cmp_eq_u32 s60, 1
    s_cselect_b32 s41, s61, s41
    s_lshl_b32 s41, s41, 11
    s_lshl_b32 s61, s18, 5
    s_add_u32 s41, s41, s61
    s_mov_b64 exec, 1
    buffer_load_dword v245, v5, s[24:27], s41 offen
    s_mov_b64 exec, -1
    s_waitcnt vmcnt(1)
    v_and_b32 v44, 0xffffff00, v44
    v_fmac_f32 v44, v91, v41
    v_mov_b32 v28, v216
    v_mov_b32 v29, v217
    v_mov_b32 v30, v218
    v_mov_b32 v31, v219
    s_sleep 24
    s_mov_b32 s83, 0
    s_mov_b64 s[64:65], -1
    s_mov_b64 s[66:67], -1
    s_mov_b64 s[68:69], -1
    s_mov_b32 s70, -1
    s_mov_b32 s71, 0
r_p:
    s_mov_b64 exec, s[64:65]
    s_cbranch_execz r_q0
    buffer_load_dwordx4 v[16:19], v10, s[12:15], s44 offen offset:0 sc1
r_q0:
    s_mov_b64 exec, s[66:67]
    s_cbranch_execz r_q1
    buffer_load_dwordx4 v[20:23], v10, s[12:15], s44 offen offset:2048 sc1
r_q1:
    s_mov_b64 exec, s[68:69]
    s_cbranch_execz r_q2
    buffer_load_dwordx4 v[24:27], v10, s[12:15], s45 offen offset:0 sc1
r_q2:
    s_mov_b64 exec, s[70:71]
    s_cbranch_execz r_q3
    buffer_load_dwordx4 v[28:31], v10, s[12:15], s45 offen offset:2048 sc1
r_q3:
    s_mov_b64 exec, -1
    s_waitcnt vmcnt(0)
    v_xor_b32 v48, v216, v16
    v_xor_b32 v49, v217, v17
    v_xor_b32 v50, v218, v18
    v_xor_b32 v51, v219, v19
    v_xor_b32 v52, v216, v20
    v_xor_b32 v53, v217, v21
    v_xor_b32 v54, v218, v22
    v_xor_b32 v55, v219, v23
    v_xor_b32 v56, v216, v24
    v_xor_b32 v57, v217, v25
    v_xor_b32 v58, v218, v26
    v_xor_b32 v59, v219, v27
    v_xor_b32 v60, v216, v28
    v_xor_b32 v61, v217, v29
    v_xor_b32 v62, v218, v30
    v_xor_b32 v63, v219, v31
    v_or3_b32 v12, v48, v49, v50
    v_or3_b32 v13, v52, v53, v54
    v_or3_b32 v14, v56, v57, v58
    v_or3_b32 v15, v60, v61, v62
    v_or_b32 v12, v12, v51
    v_or_b32 v13, v13, v55
    v_or_b32 v14, v14, v59
    v_or_b32 v15, v15, v63
    v_pk_add_f32 v[48:49], v[48:49], v[52:53]
    v_pk_add_f32 v[56:57], v[56:57], v[60:61]
    v_pk_add_f32 v[50:51], v[50:51], v[54:55]
    v_pk_add_f32 v[58:59], v[58:59], v[62:63]
    v_cmp_ne_u16_sdwa s[64:65], v12, v11 src0_sel:BYTE_0 src1_sel:DWORD
    v_cmp_ne_u16_sdwa s[66:67], v13, v11 src0_sel:BYTE_0 src1_sel:DWORD
    v_cmp_ne_u16_sdwa s[68:69], v14, v11 src0_sel:BYTE_0 src1_sel:DWORD
    v_cmp_ne_u16_sdwa s[70:71], v15, v11 src0_sel:BYTE_0 src1_sel:DWORD
    v_pk_add_f32 v[48:49], v[48:49], v[56:57]
    v_pk_add_f32 v[50:51], v[50:51], v[58:59]
    s_or_b64 s[50:51], s[64:65], s[66:67]
    s_or_b64 s[52:53], s[68:69], s[70:71]
    s_or_b64 s[50:51], s[50:51], s[52:53]
    s_cbranch_scc1 r_r
r_x:
    v_permlane32_swap_b32 v48, v50
    v_permlane32_swap_b32 v49, v51
    v_pk_add_f32 v[48:49], v[48:49], v[50:51]
    s_nop 1
    v_permlane16_swap_b32 v48, v49
    v_add_f32 v48, v48, v49
    s_nop 1
    v_add_f32_dpp v48, v48, v48 row_ror:4 row_mask:0xf bank_mask:0xf
    s_nop 1
    v_add_f32_dpp v48, v48, v48 row_ror:8 row_mask:0xf bank_mask:0xf
    v_fmac_f32 v44, v48, v80
    s_mov_b32 exec_lo, 0x000f000f
    s_mov_b32 exec_hi, 0x000f000f
    v_cvt_pk_bf16_f32 v44, v44, v44
    buffer_store_short v44, v5, s[24:27], s41 offen
    s_endpgm
x_pr:
    s_waitcnt vmcnt(0)
    s_add_u32 s83, s83, 1
    s_cmp_lt_u32 s83, 0x40000
    s_cbranch_scc1 x_ph
    s_branch x_phx
r_r:
    s_add_u32 s83, s83, 1
    s_cmp_lt_u32 s83, 0x40000
    s_cbranch_scc1 r_p
    s_branch r_x
f_start:
    s_mov_b32 s20, s26
    s_mov_b32 s21, s27
    s_mov_b32 s26, 4194304
    s_mov_b32 s27, 0x00020000
    s_mov_b32 s22, s50
    s_mov_b32 s23, s51
    s_mov_b32 s28, s54
    s_mov_b32 s29, s55
    s_add_u32 s58, s36, tables-h_pc
    s_addc_u32 s59, s37, 0
    s_lshr_b32 s36, s35, 1
    s_and_b32 s36, s36, 4
    s_xor_b32 s36, s36, s16
    s_and_b32 s37, s34, 4
    s_xor_b32 s37, s37, s16
    s_lshl_b32 s3, s34, 4
    s_add_u32 s3, s3, s35
    v_and_b32 v4, 15, v0
    v_bfe_u32 v5, v0, 4, 2
    v_lshrrev_b32 v248, 3, v2
    v_lshlrev_b32 v248, 18, v248
    v_lshlrev_b32 v249, 1, v5
    v_xor_b32 v249, v249, v0
    v_and_b32 v249, 7, v249
    v_lshl_add_u32 v255, v249, 4, v248
    v_lshlrev_b32 v6, 16, v5
    v_lshl_add_u32 v6, v4, 4, v6
    s_lshl_b32 s60, s16, 15
    s_lshl_b32 s61, s34, 11
    s_add_u32 s60, s60, s61
    s_lshl_b32 s61, s35, 7
    s_add_u32 s60, s60, s61
    s_lshl_b32 s61, s16, 12
    s_add_u32 s61, s61, 61440
    s_lshl_b32 s64, s36, 19
    s_lshl_b32 s65, s35, 3
    s_and_b32 s66, s34, 1
    s_lshl_b32 s66, s66, 2
    s_add_u32 s65, s65, s66
    s_lshr_b32 s66, s34, 1
    s_add_u32 s65, s65, s66
    s_lshl_b32 s65, s65, 8
    s_add_u32 s64, s64, s65
    s_add_u32 s64, s64, 1048576
    s_add_u32 s65, s64, 32768
    s_add_u32 s66, s64, 262144
    s_add_u32 s67, s64, 294912
    s_barrier
    s_cmp_eq_u32 s36, 0
    s_cselect_b32 s42, 2048, 0
    v_add_u32 v248, s42, v3
    global_load_dwordx4 v[236:239], v248, s[58:59]
    global_load_dwordx4 v[240:243], v248, s[58:59] offset:1024
    s_lshr_b32 s42, s3, 4
    s_and_b32 s30, s3, 15
    s_lshl_b32 s30, s30, 4
    s_add_u32 s30, s30, s42
    s_lshr_b32 s42, s3, 3
    s_cmp_eq_u32 s42, 1
    s_cselect_b32 s42, 120, 0
    s_sub_u32 s30, s30, s42
    s_lshl_b32 s42, s16, 8
    s_add_u32 s30, s30, s42
    s_cmp_ge_u32 s16, 4
    s_cselect_b32 s42, 896, 0
    s_cmp_eq_u32 s3, 0
    s_cselect_b32 s42, s42, 0
    s_sub_u32 s30, s30, s42
    s_sub_u32 s31, 2048, s30
    s_cmp_eq_u32 s30, 0
    s_cselect_b32 s31, 1024, s31
    s_lshl_b32 s18, s30, 11
    s_lshl_b32 s19, s31, 11
    s_sub_u32 s75, s19, 2048
    s_lshl_b32 s68, s16, 12
    s_add_u32 s68, s68, 126976
    v_bfe_u32 v248, v0, 2, 1
    v_bfe_u32 v249, v0, 3, 2
    v_lshlrev_b32 v249, 2, v249
    v_lshl_add_u32 v248, v248, 4, v249
    v_and_or_b32 v248, v0, 3, v248
    v_bfe_u32 v249, v0, 5, 3
    v_cvt_f32_u32 v248, v248
    v_cvt_f32_u32 v249, v249
    s_cmp_lt_u32 s16, 4
    s_mov_b32 s42, 0x3d000000
    s_cselect_b32 s42, s42, 0x3a800000
    v_mul_f32 v248, s42, v248
    v_mul_f32 v249, 4.0, v249
    v_mul_f32 v152, v248, v249
    v_add_f32 v153, v152, v248
    v_add_f32 v154, v153, v248
    v_add_f32 v155, v154, v248
    v_sin_f32 v156, v152
    v_sin_f32 v157, v153
    v_sin_f32 v158, v154
    v_sin_f32 v159, v155
    v_cos_f32 v152, v152
    v_cos_f32 v153, v153
    v_cos_f32 v154, v154
    v_cos_f32 v155, v155
    s_cbranch_scc0 f_tw
    v_cvt_pk_f16_f32 v160, v152, v156
    v_cvt_pk_f16_f32 v156, -v156, v152
    v_mov_b32 v152, v160
    v_cvt_pk_f16_f32 v160, v153, v157
    v_cvt_pk_f16_f32 v157, -v157, v153
    v_mov_b32 v153, v160
    v_cvt_pk_f16_f32 v160, v154, v158
    v_cvt_pk_f16_f32 v158, -v158, v154
    v_mov_b32 v154, v160
    v_cvt_pk_f16_f32 v160, v155, v159
    v_cvt_pk_f16_f32 v159, -v159, v155
    v_mov_b32 v155, v160
f_tw:
    s_and_b32 s42, s16, 4
    s_add_u32 s42, s42, s16
    s_lshl_b32 s42, s42, 10
    v_add_u32 v248, s42, v3
    ds_write_b128 v248, v[152:155] offset:0
    ds_write_b128 v248, v[156:159] offset:4096
    v_lshrrev_b32 v248, 1, v4
    v_and_b32 v249, 1, v0
    v_cmp_eq_u32 vcc, 1, v4
    s_nop 1
    v_cndmask_b32_e64 v250, v248, 0, vcc
    v_cndmask_b32_e64 v248, v248, 8, vcc
    v_cndmask_b32_e64 v249, v249, 0, vcc
    v_mad_u32_u24 v251, v248, v5, v249
    v_lshlrev_b32 v251, 5, v251
    v_mad_u32_u24 v251, v250, v1, v251
    v_cvt_f32_u32 v248, v248
    v_cvt_f32_u32 v250, v250
    v_cvt_f32_u32 v251, v251
    v_mul_f32 v248, 0x3d800000, v248
    v_mul_f32 v250, 0x3b800000, v250
    v_mul_f32 v216, 0x3c000000, v251
    v_add_f32 v217, v216, v248
    v_add_f32 v218, v217, v248
    v_add_f32 v219, v218, v248
    v_add_f32 v220, v216, v250
    v_add_f32 v221, v217, v250
    v_add_f32 v222, v218, v250
    v_add_f32 v223, v219, v250
    v_cos_f32 v216, v216
    v_cos_f32 v217, v217
    v_cos_f32 v218, v218
    v_cos_f32 v219, v219
    v_cos_f32 v220, v220
    v_cos_f32 v221, v221
    v_cos_f32 v222, v222
    v_cos_f32 v223, v223
    v_lshrrev_b32 v248, 2, v2
    v_lshlrev_b32 v8, 7, v248
    v_bfe_u32 v248, v0, 3, 2
    v_lshl_add_u32 v8, v248, 5, v8
    v_and_b32 v248, 3, v0
    v_lshl_add_u32 v8, v248, 3, v8
    v_lshl_add_u32 v8, v1, 12, v8
    v_xor_b32 v9, 32, v8
    v_xor_b32 v10, 64, v8
    v_xor_b32 v11, 96, v8
    v_lshlrev_b32 v12, 13, v5
    v_lshl_add_u32 v12, v4, 4, v12
    v_lshlrev_b32 v7, 5, v5
    v_and_b32 v248, 1, v0
    v_lshl_add_u32 v7, v248, 10, v7
    v_and_b32 v248, 2, v0
    v_lshl_add_u32 v7, v248, 3, v7
    s_lshl_b32 s70, s34, 11
    s_lshl_b32 s71, s16, 7
    s_add_u32 s71, s71, s70
    s_add_u32 s71, s71, 16777216
    s_lshl_b32 s42, s16, 7
    s_add_u32 s42, s42, 94208
    v_lshlrev_b32 v213, 3, v4
    v_lshl_add_u32 v212, v5, 13, v213
    v_add_u32 v212, s42, v212
    s_lshl_b32 s42, s36, 12
    s_add_u32 s42, s42, 94208
    v_lshl_add_u32 v213, v5, 8, v213
    v_and_b32 v214, 16, v0
    v_lshl_add_u32 v213, v214, 3, v213
    v_add_u32 v213, s42, v213
    v_xor_b32 v214, 128, v213
    s_mov_b32 s4, 0x3f803f80
    s_mov_b32 s5, 0x3a800000
    s_waitcnt vmcnt(6)
    s_load_dwordx2 s[32:33], s[20:21], 0
    v_dot2_f32_bf16 v108, v64, s4, 0
    v_dot2_f32_bf16 v110, v64, v64, 0
    v_dot2_f32_bf16 v108, v65, s4, v108
    v_dot2_f32_bf16 v110, v65, v65, v110
    v_dot2_f32_bf16 v108, v66, s4, v108
    v_dot2_f32_bf16 v110, v66, v66, v110
    v_dot2_f32_bf16 v108, v67, s4, v108
    v_dot2_f32_bf16 v110, v67, v67, v110
    s_waitcnt vmcnt(5)
    v_dot2_f32_bf16 v109, v72, s4, 0
    v_dot2_f32_bf16 v111, v72, v72, 0
    v_dot2_f32_bf16 v109, v73, s4, v109
    v_dot2_f32_bf16 v111, v73, v73, v111
    v_dot2_f32_bf16 v109, v74, s4, v109
    v_dot2_f32_bf16 v111, v74, v74, v111
    v_dot2_f32_bf16 v109, v75, s4, v109
    v_dot2_f32_bf16 v111, v75, v75, v111
    s_waitcnt vmcnt(4)
    v_dot2_f32_bf16 v108, v68, s4, v108
    v_dot2_f32_bf16 v110, v68, v68, v110
    v_dot2_f32_bf16 v108, v69, s4, v108
    v_dot2_f32_bf16 v110, v69, v69, v110
    v_dot2_f32_bf16 v108, v70, s4, v108
    v_dot2_f32_bf16 v110, v70, v70, v110
    v_dot2_f32_bf16 v108, v71, s4, v108
    v_dot2_f32_bf16 v110, v71, v71, v110
    s_waitcnt vmcnt(3)
    v_dot2_f32_bf16 v109, v76, s4, v109
    v_dot2_f32_bf16 v111, v76, v76, v111
    v_dot2_f32_bf16 v109, v77, s4, v109
    v_dot2_f32_bf16 v111, v77, v77, v111
    v_dot2_f32_bf16 v109, v78, s4, v109
    v_dot2_f32_bf16 v111, v78, v78, v111
    v_dot2_f32_bf16 v109, v79, s4, v109
    v_dot2_f32_bf16 v111, v79, v79, v111
    s_nop 1
    v_permlane32_swap_b32 v108, v109
    v_permlane32_swap_b32 v110, v111
    v_add_f32 v108, v108, v109
    v_add_f32 v110, v110, v111
    s_nop 0
    v_add_f32_dpp v108, v108, v108 row_ror:8 row_mask:0xf bank_mask:0xf
    v_add_f32_dpp v110, v110, v110 row_ror:8 row_mask:0xf bank_mask:0xf
    s_nop 0
    v_add_f32_dpp v108, v108, v108 row_ror:4 row_mask:0xf bank_mask:0xf
    v_add_f32_dpp v110, v110, v110 row_ror:4 row_mask:0xf bank_mask:0xf
    s_nop 0
    v_add_f32_dpp v108, v108, v108 row_ror:2 row_mask:0xf bank_mask:0xf
    v_add_f32_dpp v110, v110, v110 row_ror:2 row_mask:0xf bank_mask:0xf
    s_nop 0
    v_add_f32_dpp v108, v108, v108 row_ror:1 row_mask:0xf bank_mask:0xf
    v_add_f32_dpp v110, v110, v110 row_ror:1 row_mask:0xf bank_mask:0xf
    s_nop 0
    v_add_f32_dpp v108, v108, v108 row_bcast:15 row_mask:0xa bank_mask:0xf
    v_add_f32_dpp v110, v110, v110 row_bcast:15 row_mask:0xa bank_mask:0xf
    v_mul_f32 v108, s5, v108
    v_mul_f32 v110, s5, v110
    v_mul_f32 v116, v108, v108
    v_cvt_pk_bf16_f32 v117, -v108, -v108
    v_sub_f32 v110, v110, v116
    v_mul_f32 v118, 0x44000000, v110
    v_cmp_gt_f32 vcc, v116, v118
    v_readlane_b32 s40, v117, 31
    s_or_b32 s41, vcc_lo, vcc_hi
    s_bitcmp1_b32 s41, 31
    s_cbranch_scc1 f_slowvar
f_var:
    v_cvt_pk_bf16_f32 v110, v110, v110
    v_lshlrev_b32 v110, 16, v110
    v_add_f32 v110, 0x3727c5ac, v110
    v_cvt_pk_bf16_f32 v110, v110, v110
    v_lshlrev_b32 v110, 16, v110
    v_sqrt_f32 v110, v110
    s_and_b32 s40, s40, 0xffff
    v_mov_b32 v114, 0xffff0000
    v_cvt_pk_bf16_f32 v110, v110, v110
    v_lshlrev_b32 v110, 16, v110
    v_mul_f32 v110, 0x41800000, v110
    v_and_or_b32 v114, v117, v114, s40
    v_rcp_f32 v113, v110
    s_waitcnt lgkmcnt(0)
    s_cmp_lg_u32 s32, 0
    s_cbranch_scc1 f_nnx
    s_load_dwordx2 s[32:33], s[20:21], 64
    s_mov_b32 s83, 0
    v_mov_b32 v122, 0
    s_waitcnt lgkmcnt(0)
f_nn:
    s_cmp_lg_u32 s32, 0
    s_cbranch_scc1 f_nnx
    global_load_dwordx2 v[120:121], v122, s[20:21] sc1
    s_waitcnt vmcnt(0)
    v_readfirstlane_b32 s32, v120
    v_readfirstlane_b32 s33, v121
    s_add_u32 s83, s83, 1
    s_cmp_lt_u32 s83, 0x40000
    s_cbranch_scc1 f_nn
f_nnx:
    v_mov_b32 v115, s32
    v_mov_b32_dpp v112, v113 row_bcast:31 row_mask:0xc bank_mask:0xf
    v_mov_b32 v116, 0
    s_mov_b32 exec_lo, 0
    s_mov_b32 exec_hi, 0x80000000
    buffer_store_dwordx4 v[112:115], v116, s[12:15], s62 offen
    v_lshlrev_b32 v117, 4, v1
    v_add_u32 v117, 160768, v117
    ds_write_b128 v117, v[112:115]
    s_mov_b64 exec, -1
    s_mov_b32 m0, s61
    s_add_u32 s42, s60, 0
    s_add_u32 s61, s61, 1024
    buffer_load_dwordx4 v255, s[8:11], s42 offen lds
    s_mov_b32 m0, s61
    s_add_u32 s42, s60, 2097152
    s_add_u32 s61, s61, 1024
    buffer_load_dwordx4 v255, s[8:11], s42 offen lds
    s_mov_b32 m0, s61
    s_add_u32 s42, s60, 16384
    s_add_u32 s61, s61, 1024
    buffer_load_dwordx4 v255, s[8:11], s42 offen lds
    s_mov_b32 m0, s61
    s_add_u32 s42, s60, 2113536
    s_add_u32 s61, s61, 1024
    buffer_load_dwordx4 v255, s[8:11], s42 offen lds
    v_add_u32 v248, s68, v3
    ds_write_b128 v248, v[64:67] offset:0
    ds_write_b128 v248, v[68:71] offset:1024
    v_mov_b32 v244, s32
    v_mov_b32 v245, s33
    v_and_b32 v248, 4, v0
    v_cmp_eq_u32 vcc, 4, v248
    v_and_b32 v248, 3, v0
    v_lshlrev_b32 v248, 2, v248
    v_cndmask_b32 v244, v244, v245, vcc
    v_lshrrev_b32 v244, v248, v244
    s_mov_b32 s54, 0x00010001
    s_mov_b32 s55, 0xfffefffe
    s_mov_b32 s46, 0x05040100
    s_mov_b32 s47, 0x07060302
    v_lshrrev_b32 v245, 1, v244
    v_lshrrev_b32 v246, 2, v244
    v_lshrrev_b32 v247, 3, v244
    v_and_b32 v244, s54, v244
    v_and_b32 v245, s54, v245
    v_and_b32 v246, s54, v246
    v_and_b32 v247, s54, v247
    s_waitcnt vmcnt(2)
    s_mov_b32 exec_lo, 0x000f000f
    s_mov_b32 exec_hi, 0x000f000f
    buffer_load_dwordx4 v[24:27], v7, s[12:15], s71 offen sc1
    s_mov_b64 exec, -1
    s_mov_b32 s83, 0
    s_waitcnt vmcnt(1)
    ds_read_b64_tr_b16 v[40:41], v8 offset:61440
    ds_read_b64_tr_b16 v[42:43], v9 offset:61440
    ds_read_b64_tr_b16 v[44:45], v10 offset:61440
    ds_read_b64_tr_b16 v[46:47], v11 offset:61440
    ds_read_b64_tr_b16 v[48:49], v8 offset:63488
    ds_read_b64_tr_b16 v[50:51], v9 offset:63488
    ds_read_b64_tr_b16 v[52:53], v10 offset:63488
    ds_read_b64_tr_b16 v[54:55], v11 offset:63488
    s_mov_b32 exec_lo, 0x000f000f
    s_mov_b32 exec_hi, 0x000f000f
f_st:
    s_waitcnt vmcnt(0)
    v_cmp_ne_u32 vcc, s32, v27
    s_mov_b64 exec, -1
    s_cbranch_vccnz f_str
f_stx:
    s_setprio 3
    v_mov_b32_dpp v32, v26 row_newbcast:0 row_mask:0xf bank_mask:0xf
    v_mov_b32_dpp v33, v26 row_newbcast:1 row_mask:0xf bank_mask:0xf
    v_mov_b32_dpp v34, v26 row_newbcast:2 row_mask:0xf bank_mask:0xf
    v_mov_b32_dpp v35, v26 row_newbcast:3 row_mask:0xf bank_mask:0xf
    v_mul_f32_dpp v216, v24, v216 row_newbcast:0 row_mask:0xf bank_mask:0xf
    v_mul_f32_dpp v217, v24, v217 row_newbcast:1 row_mask:0xf bank_mask:0xf
    v_mul_f32_dpp v218, v24, v218 row_newbcast:2 row_mask:0xf bank_mask:0xf
    v_mul_f32_dpp v219, v24, v219 row_newbcast:3 row_mask:0xf bank_mask:0xf
    v_perm_b32 v28, v33, v32, s46
    v_perm_b32 v29, v35, v34, s46
    v_cvt_pk_bf16_f32 v224, v216, v217
    v_cvt_pk_bf16_f32 v225, v218, v219
    s_nop 1
    v_mfma_f32_16x16x16_bf16 v[228:231], v[224:225], v[28:29], 0
    v_mul_f32_dpp v220, v25, v220 row_newbcast:0 row_mask:0xf bank_mask:0xf
    v_mul_f32_dpp v221, v25, v221 row_newbcast:1 row_mask:0xf bank_mask:0xf
    v_mul_f32_dpp v222, v25, v222 row_newbcast:2 row_mask:0xf bank_mask:0xf
    v_mul_f32_dpp v223, v25, v223 row_newbcast:3 row_mask:0xf bank_mask:0xf
    v_perm_b32 v30, v33, v32, s47
    v_perm_b32 v31, v35, v34, s47
    v_cvt_pk_bf16_f32 v226, v220, v221
    v_cvt_pk_bf16_f32 v227, v222, v223
    s_nop 1
    v_mfma_f32_16x16x16_bf16 v[232:235], v[226:227], v[30:31], 0
    s_waitcnt lgkmcnt(0)
    v_mfma_f32_16x16x16_bf16 v[56:59], v[224:225], v[40:41], v[228:231]
    v_mfma_f32_16x16x16_bf16 v[60:63], v[226:227], v[48:49], v[232:235]
    v_mfma_f32_16x16x16_bf16 v[64:67], v[224:225], v[42:43], v[228:231]
    v_mfma_f32_16x16x16_bf16 v[68:71], v[226:227], v[50:51], v[232:235]
    s_mov_b32 m0, s68
    s_cmp_eq_u32 s34, 0
    s_cbranch_scc1 f_r0
f_nr:
    buffer_load_dwordx4 v3, s[8:11], s75 offen offset:2048 lds
    buffer_load_dwordx4 v3, s[8:11], s75 offen offset:3072 lds
    v_mfma_f32_16x16x16_bf16 v[72:75], v[224:225], v[44:45], v[228:231]
    v_mfma_f32_16x16x16_bf16 v[76:79], v[226:227], v[52:53], v[232:235]
    v_cvt_pk_f16_f32 v184, v56, v57
    v_cvt_pk_f16_f32 v185, v60, v61
    ds_write_b64 v212, v[184:185] offset:0
    v_cvt_pk_f16_f32 v186, v58, v59
    v_cvt_pk_f16_f32 v187, v62, v63
    ds_write_b64 v212, v[186:187] offset:4096
    v_mfma_f32_16x16x16_bf16 v[80:83], v[224:225], v[46:47], v[228:231]
    v_mfma_f32_16x16x16_bf16 v[84:87], v[226:227], v[54:55], v[232:235]
    v_cvt_pk_f16_f32 v188, v64, v65
    v_cvt_pk_f16_f32 v189, v68, v69
    ds_write_b64 v212, v[188:189] offset:1024
    v_cvt_pk_f16_f32 v190, v66, v67
    v_cvt_pk_f16_f32 v191, v70, v71
    ds_write_b64 v212, v[190:191] offset:5120
    v_cvt_pk_f16_f32 v192, v72, v73
    v_cvt_pk_f16_f32 v193, v76, v77
    ds_write_b64 v212, v[192:193] offset:2048
    v_cvt_pk_f16_f32 v194, v74, v75
    v_cvt_pk_f16_f32 v195, v78, v79
    ds_write_b64 v212, v[194:195] offset:6144
    v_cvt_pk_f16_f32 v196, v80, v81
    v_cvt_pk_f16_f32 v197, v84, v85
    ds_write_b64 v212, v[196:197] offset:3072
    v_cvt_pk_f16_f32 v198, v82, v83
    v_cvt_pk_f16_f32 v199, v86, v87
    ds_write_b64 v212, v[198:199] offset:7168
    s_waitcnt lgkmcnt(0)
    s_barrier
    ds_read_b64 v[152:153], v213 offset:0
    ds_read_b64 v[154:155], v214 offset:0
    ds_read_b64 v[156:157], v213 offset:1024
    ds_read_b64 v[158:159], v214 offset:1024
    ds_read_b64 v[160:161], v213 offset:2048
    ds_read_b64 v[162:163], v214 offset:2048
    ds_read_b64 v[164:165], v213 offset:3072
    ds_read_b64 v[166:167], v214 offset:3072
    s_waitcnt lgkmcnt(6)
    v_mfma_f32_16x16x32_f16 v[56:59], v[236:239], v[152:155], 0
    s_waitcnt lgkmcnt(4)
    v_mfma_f32_16x16x32_f16 v[60:63], v[236:239], v[156:159], 0
    s_waitcnt lgkmcnt(2)
    v_mfma_f32_16x16x32_f16 v[64:67], v[236:239], v[160:163], 0
    s_waitcnt lgkmcnt(0)
    v_mfma_f32_16x16x32_f16 v[68:71], v[236:239], v[164:167], 0
    v_mfma_f32_16x16x32_f16 v[72:75], v[240:243], v[152:155], 0
    v_mfma_f32_16x16x32_f16 v[76:79], v[240:243], v[156:159], 0
    v_mfma_f32_16x16x32_f16 v[80:83], v[240:243], v[160:163], 0
    v_mfma_f32_16x16x32_f16 v[84:87], v[240:243], v[164:167], 0
    v_cvt_pk_f16_f32 v184, v56, v57
    v_cvt_pk_f16_f32 v185, v60, v61
    v_cvt_pk_f16_f32 v186, v64, v65
    s_nop 0
    v_cvt_pk_f16_f32 v187, v68, v69
    v_and_or_b32 v184, v184, s55, v244
    v_and_or_b32 v185, v185, s55, v245
    v_and_or_b32 v186, v186, s55, v246
    v_and_or_b32 v187, v187, s55, v247
    buffer_store_dwordx4 v[184:187], v6, s[12:15], s64 offen sc1
    v_cvt_pk_f16_f32 v188, v58, v59
    v_cvt_pk_f16_f32 v189, v62, v63
    v_cvt_pk_f16_f32 v190, v66, v67
    v_cvt_pk_f16_f32 v191, v70, v71
    v_and_or_b32 v188, v188, s55, v244
    v_and_or_b32 v189, v189, s55, v245
    v_and_or_b32 v190, v190, s55, v246
    v_and_or_b32 v191, v191, s55, v247
    buffer_store_dwordx4 v[188:191], v6, s[12:15], s65 offen sc1
    v_cvt_pk_f16_f32 v192, v72, v73
    v_cvt_pk_f16_f32 v193, v76, v77
    v_cvt_pk_f16_f32 v194, v80, v81
    v_cvt_pk_f16_f32 v195, v84, v85
    v_and_or_b32 v192, v192, s55, v244
    v_and_or_b32 v193, v193, s55, v245
    v_and_or_b32 v194, v194, s55, v246
    v_and_or_b32 v195, v195, s55, v247
    buffer_store_dwordx4 v[192:195], v6, s[12:15], s66 offen sc1
    v_cvt_pk_f16_f32 v196, v74, v75
    v_cvt_pk_f16_f32 v197, v78, v79
    v_cvt_pk_f16_f32 v198, v82, v83
    v_cvt_pk_f16_f32 v199, v86, v87
    v_and_or_b32 v196, v196, s55, v244
    v_and_or_b32 v197, v197, s55, v245
    v_and_or_b32 v198, v198, s55, v246
    v_and_or_b32 v199, v199, s55, v247
    buffer_store_dwordx4 v[196:199], v6, s[12:15], s67 offen sc1
    s_setprio 0
    s_mov_b32 s43, 0
    s_lshr_b32 s42, s3, 4
    s_and_b32 s40, s3, 15
    s_lshl_b32 s40, s40, 4
    s_add_u32 s40, s40, s42
    s_lshr_b32 s42, s3, 3
    s_cmp_eq_u32 s42, 1
    s_cselect_b32 s42, 120, 0
    s_sub_u32 s40, s40, s42
    s_lshl_b32 s42, s43, 8
    s_add_u32 s40, s40, s42
    s_cmp_ge_u32 s43, 4
    s_cselect_b32 s42, 896, 0
    s_cmp_eq_u32 s3, 0
    s_cselect_b32 s42, s42, 0
    s_sub_u32 s40, s40, s42
    v_lshrrev_b32 v248, 1, v4
    v_and_b32 v249, 1, v0
    v_lshlrev_b32 v250, 8, v248
    v_add_u32 v250, s40, v250
    s_cmp_lg_u32 s3, 0
    s_cbranch_scc1 f_a3n
    v_cmp_lt_u32 s[44:45], 3, v248
    v_subrev_u32 v251, 896, v250
    s_nop 0
    v_cndmask_b32 v250, v250, v251, s[44:45]
    v_cmp_eq_u32 vcc, 1, v4
    v_mov_b32 v251, 1024
    s_nop 0
    v_cndmask_b32 v250, v250, v251, vcc
    v_cndmask_b32_e64 v249, v249, 0, vcc
f_a3n:
    v_lshlrev_b32 v251, 1, v5
    v_mul_u32_u24 v251, v251, v250
    v_lshl_add_u32 v251, v249, 9, v251
    v_add_u32 v253, v251, v250
    v_add_u32 v252, 1536, v251
    v_add_u32 v254, 1536, v253
    v_and_b32 v251, 2047, v251
    v_and_b32 v252, 2047, v252
    v_and_b32 v253, 2047, v253
    v_and_b32 v254, 2047, v254
    v_cvt_f32_u32 v251, v251
    v_cvt_f32_u32 v252, v252
    v_cvt_f32_u32 v253, v253
    v_cvt_f32_u32 v254, v254
    v_mul_f32 v251, 0x3a000000, v251
    v_mul_f32 v252, 0x3a000000, v252
    v_mul_f32 v253, 0x3a000000, v253
    v_mul_f32 v254, 0x3a000000, v254
    v_cos_f32 v251, v251
    v_cos_f32 v252, v252
    v_cos_f32 v253, v253
    v_cos_f32 v254, v254
    s_cbranch_scc1 f_a3m
    v_cmp_gt_u32 vcc, 2, v4
    s_nop 1
    v_cndmask_b32_e64 v249, 1.0, 0.5, vcc
    v_mul_f32 v251, v251, v249
    v_mul_f32 v253, v253, v249
    v_cndmask_b32 v252, 0, v251, s[44:45]
    v_cndmask_b32 v254, 0, v253, s[44:45]
    v_cndmask_b32 v251, v251, 0, s[44:45]
    v_cndmask_b32 v253, v253, 0, s[44:45]
f_a3m:
    v_cvt_pk_f16_f32 v22, v251, v252
    v_cvt_pk_f16_f32 v23, v253, v254
    v_and_b32 v248, 3, v0
    v_bfe_u32 v249, v0, 2, 1
    v_bfe_u32 v250, v0, 3, 2
    v_bfe_u32 v251, v0, 5, 1
    v_lshlrev_b32 v13, 10, v249
    v_lshlrev_b32 v15, 11, v249
    v_lshl_add_u32 v15, v251, 8, v15
    v_lshl_add_u32 v15, v250, 6, v15
    v_lshl_add_u32 v15, v248, 4, v15
    v_lshl_add_u32 v13, v250, 8, v13
    v_lshl_add_u32 v13, v248, 6, v13
    v_lshl_add_u32 v13, v251, 5, v13
    v_xor_b32 v14, 2016, v13
    v_add_u32 v13, s68, v13
    v_add_u32 v14, s68, v14
    s_waitcnt vmcnt(4)
    ds_read_b128 v[200:203], v13 offset:0
    ds_read_b128 v[204:207], v13 offset:16
    ds_read_b128 v[208:211], v14 offset:2048
    ds_read_b128 v[212:215], v14 offset:2064
    s_lshl_b32 s72, s3, 15
    s_lshl_b32 s73, s37, 12
    s_add_u32 s72, s72, s73
    s_add_u32 s72, s72, 1048576
    s_waitcnt lgkmcnt(0)
    ds_read_b128 v[88:91], v3 offset:0
    ds_read_b128 v[92:95], v3 offset:1024
    ds_read_b128 v[96:99], v3 offset:2048
    ds_read_b128 v[100:103], v3 offset:3072
    ds_read_b128 v[104:107], v3 offset:4096
    ds_read_b128 v[108:111], v3 offset:5120
    ds_read_b128 v[112:115], v3 offset:6144
    ds_read_b128 v[116:119], v3 offset:7168
    ds_read_b128 v[120:123], v3 offset:8192
    ds_read_b128 v[124:127], v3 offset:9216
    ds_read_b128 v[128:131], v3 offset:10240
    ds_read_b128 v[132:135], v3 offset:11264
    ds_read_b128 v[136:139], v3 offset:12288
    ds_read_b128 v[140:143], v3 offset:13312
    ds_read_b128 v[144:147], v3 offset:14336
    ds_read_b128 v[148:151], v3 offset:15360
    v_lshlrev_b32 v152, 16, v200
    v_and_b32 v153, 0xffff0000, v200
    v_lshlrev_b32 v154, 16, v201
    v_and_b32 v155, 0xffff0000, v201
    v_lshlrev_b32 v156, 16, v202
    v_and_b32 v157, 0xffff0000, v202
    v_lshlrev_b32 v158, 16, v203
    v_and_b32 v159, 0xffff0000, v203
    v_lshlrev_b32 v160, 16, v204
    v_and_b32 v161, 0xffff0000, v204
    v_lshlrev_b32 v162, 16, v205
    v_and_b32 v163, 0xffff0000, v205
    v_lshlrev_b32 v164, 16, v206
    v_and_b32 v165, 0xffff0000, v206
    v_lshlrev_b32 v166, 16, v207
    v_and_b32 v167, 0xffff0000, v207
    v_lshlrev_b32 v168, 16, v208
    v_and_b32 v183, 0xffff0000, v208
    v_lshlrev_b32 v182, 16, v209
    v_and_b32 v181, 0xffff0000, v209
    v_lshlrev_b32 v180, 16, v210
    v_and_b32 v179, 0xffff0000, v210
    v_lshlrev_b32 v178, 16, v211
    v_and_b32 v177, 0xffff0000, v211
    v_lshlrev_b32 v176, 16, v212
    v_and_b32 v175, 0xffff0000, v212
    v_lshlrev_b32 v174, 16, v213
    v_and_b32 v173, 0xffff0000, v213
    v_lshlrev_b32 v172, 16, v214
    v_and_b32 v171, 0xffff0000, v214
    v_lshlrev_b32 v170, 16, v215
    v_and_b32 v169, 0xffff0000, v215
    s_waitcnt vmcnt(0)
    s_barrier
    buffer_load_dwordx4 v[24:27], v3, s[12:15], s72 offen offset:0 sc1
    buffer_load_dwordx4 v[28:31], v3, s[12:15], s72 offen offset:1024 sc1
    buffer_load_dwordx4 v[32:35], v3, s[12:15], s72 offen offset:2048 sc1
    buffer_load_dwordx4 v[36:39], v3, s[12:15], s72 offen offset:3072 sc1
    s_lshl_b32 s80, s3, 7
    s_add_u32 s80, s80, 17039360
    v_lshrrev_b32 v18, 3, v2
    v_lshlrev_b32 v18, 14, v18
    v_and_b32 v248, 0x70, v3
    v_add_u32 v18, v18, v248
    s_cmp_lg_u32 s16, 0
    s_cbranch_scc1 f_sb2
    v_add_u32 v84, 160768, v3
    s_mov_b64 exec, 0xff
    ds_read_b128 v[80:83], v84
    s_waitcnt lgkmcnt(0)
    buffer_store_dwordx4 v[80:83], v3, s[12:15], s63 offen sc1
    s_mov_b64 exec, -1
    v_not_b32 v249, s32
    buffer_store_dwordx4 v[248:251], v18, s[12:15], s80 offen sc1
f_sb2:
    v_xor_b32 v16, 2544, v15
    s_nop 0
    v_subrev_u32 v248, s68, v13
    v_add_u32 v248, 32, v248
    v_bfe_u32 v19, v248, 5, 1
    v_lshlrev_b32 v19, 5, v19
    v_bfe_u32 v249, v248, 8, 2
    v_lshl_add_u32 v19, v249, 3, v19
    v_bfe_u32 v249, v248, 10, 1
    v_lshl_add_u32 v19, v249, 2, v19
    v_bfe_u32 v249, v248, 6, 2
    v_add_lshl_u32 v19, v249, v19, 2
    s_lshl_b32 s74, s34, 14
    s_add_u32 s74, s74, 17039360
    s_lshl_b32 s42, s37, 9
    s_add_u32 s42, s42, 61440
    v_add_u32 v12, s42, v12
    s_mul_i32 s17, s34, 7
    s_lshr_b32 s42, s35, 1
    s_add_u32 s17, s17, s42
    s_lshl_b32 s42, s17, 6
    s_lshr_b32 s43, s16, 2
    s_lshl_b32 s43, s43, 5
    s_add_u32 s42, s42, s43
    s_and_b32 s43, s16, 1
    s_lshl_b32 s43, s43, 4
    s_add_u32 s42, s42, s43
    s_and_b32 s43, s16, 2
    s_lshl_b32 s43, s43, 1
    s_add_u32 s42, s42, s43
    s_lshl_b32 s38, s42, 11
    s_and_b32 s43, s35, 1
    s_lshl_b32 s43, s43, 10
    s_add_u32 s38, s38, s43
    s_lshl_b32 s39, s16, 13
    s_add_u32 s39, s39, 94208
    s_mov_b32 s48, s28
    s_mov_b32 s49, s29
    s_mov_b32 s50, 7340032
    s_mov_b32 s51, 0x00020000
    s_bfe_u32 s4, s32, 524288
    s_bfe_u32 s5, s32, 524296
    s_bfe_u32 s6, s32, 524304
    s_bfe_u32 s7, s32, 524312
    s_bfe_u32 s8, s33, 524288
    s_bfe_u32 s9, s33, 524296
    s_bfe_u32 s10, s33, 524304
    s_bfe_u32 s11, s33, 524312
    v_lshlrev_b32 v17, 7, v4
    s_and_b32 s40, s16, 3
    s_lshl_b32 s76, s40, 10
    v_subrev_u32 v248, s68, v13
    v_lshrrev_b32 v248, 1, v248
    s_lshl_b32 s42, s40, 2
    v_add_u32 v248, s42, v248
    v_bfe_u32 v235, v248, 7, 1
    v_lshlrev_b32 v235, 9, v235
    v_and_b32 v249, 31, v248
    v_lshl_add_u32 v235, v249, 4, v235
    v_bfe_u32 v249, v248, 8, 1
    v_lshl_add_u32 v235, v249, 3, v235
    v_lshrrev_b32 v249, 9, v248
    v_lshl_add_u32 v235, v249, 10, v235
    v_bfe_u32 v249, v248, 5, 2
    v_lshl_add_u32 v235, v249, 1, v235
    v_mov_b32 v8, s32
    v_mov_b32 v9, s33
    v_and_b32 v10, 1, v0
    v_cmp_eq_u32 vcc, 1, v10
    s_nop 1
    v_cndmask_b32 v8, v8, v9, vcc
    v_bfe_u32 v9, v8, 8, 8
    v_bfe_u32 v10, v8, 16, 8
    v_lshrrev_b32 v11, 24, v8
    v_and_b32 v8, 0xff, v8
    s_add_u32 s76, s76, 16875520
    s_mov_b32 s77, 16850944
    s_xor_b32 s79, s35, 1
    s_xor_b32 s43, s16, 5
    s_or_b32 s79, s79, s43
    s_add_u32 s65, s76, 4096
    s_lshl_b32 s42, s16, 11
    v_add_u32 v4, s42, v3
    s_add_u32 s64, s42, 16883712
    s_lshl_b32 s42, s16, 12
    s_add_u32 s42, s42, 61440
    v_add_u32 v7, s42, v3
    v_mov_b32 v20, 159808
    s_cmp_eq_u32 s3, 0
    s_cselect_b64 s[52:53], -1, 1
    v_mov_b32 v196, v8
    v_mov_b32 v197, v9
    v_mov_b32 v198, v10
    v_mov_b32 v199, v11
    s_mov_b32 s83, 0
    s_cmp_ge_u32 s16, 4
    s_cbranch_scc1 f_z1
    s_waitcnt vmcnt(6)
    s_mov_b64 exec, 0xf0ff
    buffer_load_dwordx4 v[236:239], v17, s[12:15], s77 offen sc1
    s_mov_b64 exec, s[52:53]
    buffer_load_dwordx4 v[196:199], v3, s[12:15], s76 offen sc1
    s_mov_b64 exec, -1
    buffer_load_dwordx4 v[192:195], v3, s[12:15], s65 offen sc1
    buffer_load_dwordx4 v[184:187], v3, s[12:15], s64 offen offset:0 sc1
    buffer_load_dwordx4 v[188:191], v3, s[12:15], s64 offen offset:1024 sc1
    s_waitcnt vmcnt(7)
    v_xor_b32 v40, v24, v244
    v_xor_b32 v41, v28, v244
    v_xor_b32 v42, v25, v245
    v_xor_b32 v43, v29, v245
    v_xor_b32 v44, v26, v246
    v_xor_b32 v45, v30, v246
    v_xor_b32 v46, v27, v247
    v_xor_b32 v47, v31, v247
    v_mfma_f32_16x16x16_f16 v[56:59], v[22:23], v[40:41], 0
    v_or3_b32 v248, v40, v41, 0
    v_mfma_f32_16x16x16_f16 v[64:67], v[22:23], v[44:45], 0
    v_or3_b32 v248, v44, v45, v248
    v_mfma_f32_16x16x16_f16 v[60:63], v[22:23], v[42:43], 0
    v_or3_b32 v248, v42, v43, v248
    v_mfma_f32_16x16x16_f16 v[68:71], v[22:23], v[46:47], 0
    v_or3_b32 v248, v46, v47, v248
    s_waitcnt vmcnt(5)
    s_branch f_z2
f_z1:
    s_waitcnt vmcnt(4)
    buffer_load_dwordx4 v[184:187], v3, s[12:15], s64 offen offset:0 sc1
    buffer_load_dwordx4 v[188:191], v3, s[12:15], s64 offen offset:1024 sc1
    s_waitcnt vmcnt(4)
f_zc:
    v_xor_b32 v40, v24, v244
    v_xor_b32 v41, v28, v244
    v_xor_b32 v42, v25, v245
    v_xor_b32 v43, v29, v245
    v_xor_b32 v44, v26, v246
    v_xor_b32 v45, v30, v246
    v_xor_b32 v46, v27, v247
    v_xor_b32 v47, v31, v247
    v_mfma_f32_16x16x16_f16 v[56:59], v[22:23], v[40:41], 0
    v_or3_b32 v248, v40, v41, 0
    v_mfma_f32_16x16x16_f16 v[64:67], v[22:23], v[44:45], 0
    v_or3_b32 v248, v44, v45, v248
    v_mfma_f32_16x16x16_f16 v[60:63], v[22:23], v[42:43], 0
    v_or3_b32 v248, v42, v43, v248
    v_mfma_f32_16x16x16_f16 v[68:71], v[22:23], v[46:47], 0
    v_or3_b32 v248, v46, v47, v248
    s_waitcnt vmcnt(2)
f_z2:
    v_xor_b32 v48, v32, v244
    v_xor_b32 v49, v36, v244
    v_xor_b32 v50, v33, v245
    v_xor_b32 v51, v37, v245
    v_xor_b32 v52, v34, v246
    v_xor_b32 v53, v38, v246
    v_xor_b32 v54, v35, v247
    v_xor_b32 v55, v39, v247
    v_mfma_f32_16x16x16_f16 v[72:75], v[22:23], v[48:49], 0
    v_or3_b32 v248, v48, v49, v248
    v_mfma_f32_16x16x16_f16 v[80:83], v[22:23], v[52:53], 0
    v_or3_b32 v248, v52, v53, v248
    v_mfma_f32_16x16x16_f16 v[76:79], v[22:23], v[50:51], 0
    v_or3_b32 v248, v50, v51, v248
    v_mfma_f32_16x16x16_f16 v[84:87], v[22:23], v[54:55], 0
    v_or3_b32 v248, v54, v55, v248
    v_and_b32 v248, s54, v248
    v_cmp_ne_u32 vcc, 0, v248
    s_cbranch_vccnz f_zr
f_zx:
    v_cvt_pk_f16_f32 v24, v56, v57
    v_cvt_pk_f16_f32 v25, v64, v65
    v_cvt_pk_f16_f32 v26, v72, v73
    v_cvt_pk_f16_f32 v27, v80, v81
    ds_write_b128 v12, v[24:27] offset:0
    v_cvt_pk_f16_f32 v28, v58, v59
    v_cvt_pk_f16_f32 v29, v66, v67
    v_cvt_pk_f16_f32 v30, v74, v75
    v_cvt_pk_f16_f32 v31, v82, v83
    ds_write_b128 v12, v[28:31] offset:4096
    v_cvt_pk_f16_f32 v32, v60, v61
    v_cvt_pk_f16_f32 v33, v68, v69
    v_cvt_pk_f16_f32 v34, v76, v77
    v_cvt_pk_f16_f32 v35, v84, v85
    ds_write_b128 v12, v[32:35] offset:256
    v_cvt_pk_f16_f32 v36, v62, v63
    v_cvt_pk_f16_f32 v37, v70, v71
    v_cvt_pk_f16_f32 v38, v78, v79
    v_cvt_pk_f16_f32 v39, v86, v87
    ds_write_b128 v12, v[36:39] offset:4352
    s_mov_b32 s83, 0
    s_cmp_lt_u32 s16, 4
    s_cbranch_scc1 f_pv
f_qv:
    s_waitcnt vmcnt(1)
    v_xor_b32 v184, v8, v184
    v_xor_b32 v185, v9, v185
    v_xor_b32 v186, v10, v186
    v_xor_b32 v187, v11, v187
    v_or3_b32 v248, v184, v185, 0
    v_or3_b32 v248, v186, v187, v248
    ds_write_b128 v4, v[184:187] offset:20480
    s_waitcnt vmcnt(0)
    v_xor_b32 v188, v8, v188
    v_xor_b32 v189, v9, v189
    v_xor_b32 v190, v10, v190
    v_xor_b32 v191, v11, v191
    v_or3_b32 v248, v188, v189, v248
    v_or3_b32 v248, v190, v191, v248
    ds_write_b128 v4, v[188:191] offset:21504
    v_and_b32 v248, 0xff, v248
    v_cmp_ne_u32 vcc, 0, v248
    s_cbranch_vccnz f_qr
    s_branch f_pvx
f_pv:
    s_waitcnt vmcnt(3)
    v_add_f32_dpp v239, v238, v238 quad_perm:[1,0,3,2] row_mask:0xf bank_mask:0xf
    v_max_f32_dpp v238, v238, v238 quad_perm:[1,0,3,2] row_mask:0xf bank_mask:0xf
    v_cmp_ne_u64 s[44:45], s[32:33], v[236:237]
    v_add_f32_dpp v239, v239, v239 quad_perm:[2,3,0,1] row_mask:0xf bank_mask:0xf
    v_max_f32_dpp v238, v238, v238 quad_perm:[2,3,0,1] row_mask:0xf bank_mask:0xf
    v_xor_b32 v196, v8, v196
    v_xor_b32 v197, v9, v197
    v_xor_b32 v198, v10, v198
    v_xor_b32 v199, v11, v199
    v_or3_b32 v248, v196, v197, 0
    v_or3_b32 v248, v198, v199, v248
    v_max_f32_dpp v238, v238, v238 row_half_mirror row_mask:0xf bank_mask:0xf
    s_mov_b64 exec, 0x1000
    ds_write_b32 v20, v239
    s_mov_b64 exec, -1
    v_frexp_exp_i32_f32 v238, v238
    s_waitcnt vmcnt(2)
    v_xor_b32 v192, v8, v192
    v_xor_b32 v193, v9, v193
    v_xor_b32 v194, v10, v194
    v_xor_b32 v195, v11, v195
    v_or3_b32 v248, v192, v193, v248
    v_or3_b32 v248, v194, v195, v248
    v_readfirstlane_b32 s42, v238
    s_sub_u32 s43, -1, s42
    s_add_u32 s45, s42, 5
    s_and_b32 s44, s44, 0xf0ff
    v_ldexp_f32 v192, v192, s43
    v_ldexp_f32 v193, v193, s43
    v_ldexp_f32 v194, v194, s43
    v_ldexp_f32 v195, v195, s43
    v_cvt_pk_f16_f32 v192, v192, v193
    v_cvt_pk_f16_f32 v194, v194, v195
    ds_write_b16 v235, v192 offset:16384
    ds_write_b16_d16_hi v235, v192 offset:16400
    ds_write_b16 v235, v194 offset:16416
    ds_write_b16_d16_hi v235, v194 offset:16432
    s_waitcnt vmcnt(1)
    v_xor_b32 v184, v8, v184
    v_xor_b32 v185, v9, v185
    v_xor_b32 v186, v10, v186
    v_xor_b32 v187, v11, v187
    v_or3_b32 v248, v184, v185, v248
    v_or3_b32 v248, v186, v187, v248
    v_ldexp_f32 v184, v184, s45
    v_ldexp_f32 v185, v185, s45
    v_ldexp_f32 v186, v186, s45
    v_ldexp_f32 v187, v187, s45
    ds_write_b128 v4, v[184:187] offset:20480
    s_waitcnt vmcnt(0)
    v_xor_b32 v188, v8, v188
    v_xor_b32 v189, v9, v189
    v_xor_b32 v190, v10, v190
    v_xor_b32 v191, v11, v191
    v_or3_b32 v248, v188, v189, v248
    v_or3_b32 v248, v190, v191, v248
    v_ldexp_f32 v188, v188, s45
    v_ldexp_f32 v189, v189, s45
    v_ldexp_f32 v190, v190, s45
    v_ldexp_f32 v191, v191, s45
    ds_write_b128 v4, v[188:191] offset:21504
    v_and_b32 v248, 0xff, v248
    v_cmp_ne_u32 vcc, 0, v248
    s_or_b32 vcc_lo, vcc_lo, s44
    s_cbranch_vccnz f_pr
f_pw:
    s_cmp_eq_u32 s3, 0
    s_cbranch_scc1 f_ps
f_pvx:
    s_waitcnt lgkmcnt(0)
    s_barrier
    ds_read_b128 v[248:251], v3 offset:16384
    ds_read_b128 v[24:27], v7 offset:0
    ds_read_b128 v[28:31], v7 offset:1024
    ds_read_b128 v[252:255], v3 offset:17408
    ds_read_b128 v[32:35], v7 offset:2048
    ds_read_b128 v[36:39], v7 offset:3072
    s_cmp_eq_u32 s30, 0
    s_cbranch_scc1 f_sp
    s_waitcnt lgkmcnt(4)
    v_pk_mul_f16 v40, v24, v248 op_sel:[0,0] op_sel_hi:[1,0]
    v_pk_mul_f16 v41, v25, v248 op_sel:[0,1] op_sel_hi:[1,1]
    v_pk_mul_f16 v42, v26, v249 op_sel:[0,0] op_sel_hi:[1,0]
    v_pk_mul_f16 v43, v27, v249 op_sel:[0,1] op_sel_hi:[1,1]
    s_nop 1
    v_mfma_f32_32x32x16_f16 v[56:71], v[40:43], v[88:91], 0
    s_waitcnt lgkmcnt(3)
    v_pk_mul_f16 v44, v28, v250 op_sel:[0,0] op_sel_hi:[1,0]
    v_pk_mul_f16 v45, v29, v250 op_sel:[0,1] op_sel_hi:[1,1]
    v_pk_mul_f16 v46, v30, v251 op_sel:[0,0] op_sel_hi:[1,0]
    v_pk_mul_f16 v47, v31, v251 op_sel:[0,1] op_sel_hi:[1,1]
    v_mfma_f32_32x32x16_f16 v[72:87], v[40:43], v[104:107], 0
    s_waitcnt lgkmcnt(1)
    v_pk_mul_f16 v48, v32, v252 op_sel:[0,0] op_sel_hi:[1,0]
    v_pk_mul_f16 v49, v33, v252 op_sel:[0,1] op_sel_hi:[1,1]
    v_pk_mul_f16 v50, v34, v253 op_sel:[0,0] op_sel_hi:[1,0]
    v_pk_mul_f16 v51, v35, v253 op_sel:[0,1] op_sel_hi:[1,1]
    v_mfma_f32_32x32x16_f16 v[56:71], v[44:47], v[92:95], v[56:71]
    s_waitcnt lgkmcnt(0)
    v_pk_mul_f16 v52, v36, v254 op_sel:[0,0] op_sel_hi:[1,0]
    v_pk_mul_f16 v53, v37, v254 op_sel:[0,1] op_sel_hi:[1,1]
    v_pk_mul_f16 v54, v38, v255 op_sel:[0,0] op_sel_hi:[1,0]
    v_pk_mul_f16 v55, v39, v255 op_sel:[0,1] op_sel_hi:[1,1]
    v_mfma_f32_32x32x16_f16 v[72:87], v[44:47], v[108:111], v[72:87]
f_st1:
    v_mfma_f32_32x32x16_f16 v[56:71], v[48:51], v[96:99], v[56:71]
    ds_read_b128 v[184:187], v3 offset:20480
    ds_read_b128 v[188:191], v3 offset:21504
    v_mfma_f32_32x32x16_f16 v[72:87], v[48:51], v[112:115], v[72:87]
    ds_read_b128 v[192:195], v3 offset:22528
    ds_read_b128 v[196:199], v3 offset:23552
    v_mfma_f32_32x32x16_f16 v[56:71], v[52:55], v[100:103], v[56:71]
    ds_read_b128 v[200:203], v3 offset:24576
    ds_read_b128 v[204:207], v3 offset:25600
    v_mfma_f32_32x32x16_f16 v[72:87], v[52:55], v[116:119], v[72:87]
    ds_read_b128 v[208:211], v3 offset:26624
    ds_read_b128 v[212:215], v3 offset:27648
    v_mov_b32 v22, 159808
    ds_read_b32 v22, v22
    s_cmp_ge_u32 s35, 14
    s_cbranch_scc1 f_nd0
    s_add_u32 s43, s39, 0
    s_mov_b32 m0, s43
    s_add_u32 s42, s38, 0
    buffer_load_dwordx4 v3, s[48:51], s42 offen nt lds
    s_add_u32 s43, s39, 1024
    s_mov_b32 m0, s43
    s_add_u32 s42, s38, 2048
    v_xor_b32 v7, 32, v3
    buffer_load_dwordx4 v7, s[48:51], s42 offen nt lds
    s_add_u32 s43, s39, 2048
    s_mov_b32 m0, s43
    s_add_u32 s42, s38, 4096
    v_xor_b32 v7, 64, v3
    buffer_load_dwordx4 v7, s[48:51], s42 offen nt lds
f_nd0:
    s_cmp_eq_u32 s30, 0
    s_cbranch_scc1 f_sp2
    v_pk_mul_f32 v[24:25], v[56:57], v[120:121]
    v_pk_mul_f32 v[28:29], v[72:73], v[120:121]
    v_pk_mul_f32 v[26:27], v[58:59], v[122:123]
    v_pk_mul_f32 v[30:31], v[74:75], v[122:123]
    v_pk_fma_f32 v[24:25], v[72:73], v[136:137], v[24:25]
    v_pk_fma_f32 v[28:29], v[56:57], v[136:137], v[28:29] neg_lo:[1,0,0] neg_hi:[1,0,0]
    v_pk_fma_f32 v[26:27], v[74:75], v[138:139], v[26:27]
    v_pk_fma_f32 v[30:31], v[58:59], v[138:139], v[30:31] neg_lo:[1,0,0] neg_hi:[1,0,0]
    v_cvt_pk_f16_f32 v40, v24, v28
    v_cvt_pk_f16_f32 v41, v25, v29
    v_cvt_pk_f16_f32 v42, v26, v30
    v_cvt_pk_f16_f32 v43, v27, v31
    ds_read_b128 v[216:219], v3 offset:28672
    ds_read_b128 v[220:223], v3 offset:29696
    ds_read_b128 v[224:227], v3 offset:30720
    ds_read_b128 v[228:231], v3 offset:31744
    v_pk_mul_f32 v[32:33], v[60:61], v[124:125]
    v_pk_mul_f32 v[36:37], v[76:77], v[124:125]
    v_pk_mul_f32 v[34:35], v[62:63], v[126:127]
    v_pk_mul_f32 v[38:39], v[78:79], v[126:127]
    v_pk_fma_f32 v[32:33], v[76:77], v[140:141], v[32:33]
    v_pk_fma_f32 v[36:37], v[60:61], v[140:141], v[36:37] neg_lo:[1,0,0] neg_hi:[1,0,0]
    v_pk_fma_f32 v[34:35], v[78:79], v[142:143], v[34:35]
    v_pk_fma_f32 v[38:39], v[62:63], v[142:143], v[38:39] neg_lo:[1,0,0] neg_hi:[1,0,0]
    v_cvt_pk_f16_f32 v44, v32, v36
    v_cvt_pk_f16_f32 v45, v33, v37
    v_cvt_pk_f16_f32 v46, v34, v38
    v_cvt_pk_f16_f32 v47, v35, v39
    v_mfma_f32_32x32x16_f16 v[104:119], v[40:43], v[88:91], 0
    ds_read_b128 v[232:235], v3 offset:32768
    ds_read_b128 v[236:239], v3 offset:33792
    ds_read_b128 v[240:243], v3 offset:34816
    ds_read_b128 v[244:247], v3 offset:35840
    v_pk_mul_f32 v[24:25], v[64:65], v[128:129]
    v_pk_mul_f32 v[28:29], v[80:81], v[128:129]
    v_pk_mul_f32 v[26:27], v[66:67], v[130:131]
    v_pk_mul_f32 v[30:31], v[82:83], v[130:131]
    v_pk_fma_f32 v[24:25], v[80:81], v[144:145], v[24:25]
    v_pk_fma_f32 v[28:29], v[64:65], v[144:145], v[28:29] neg_lo:[1,0,0] neg_hi:[1,0,0]
    v_pk_fma_f32 v[26:27], v[82:83], v[146:147], v[26:27]
    v_pk_fma_f32 v[30:31], v[66:67], v[146:147], v[30:31] neg_lo:[1,0,0] neg_hi:[1,0,0]
    v_cvt_pk_f16_f32 v48, v24, v28
    v_cvt_pk_f16_f32 v49, v25, v29
    v_cvt_pk_f16_f32 v50, v26, v30
    v_cvt_pk_f16_f32 v51, v27, v31
    v_mfma_f32_32x32x16_f16 v[104:119], v[44:47], v[92:95], v[104:119]
    v_pk_mul_f32 v[32:33], v[68:69], v[132:133]
    v_pk_mul_f32 v[36:37], v[84:85], v[132:133]
    v_pk_mul_f32 v[34:35], v[70:71], v[134:135]
    v_pk_mul_f32 v[38:39], v[86:87], v[134:135]
    v_pk_fma_f32 v[32:33], v[84:85], v[148:149], v[32:33]
    v_pk_fma_f32 v[36:37], v[68:69], v[148:149], v[36:37] neg_lo:[1,0,0] neg_hi:[1,0,0]
    v_pk_fma_f32 v[34:35], v[86:87], v[150:151], v[34:35]
    v_pk_fma_f32 v[38:39], v[70:71], v[150:151], v[38:39] neg_lo:[1,0,0] neg_hi:[1,0,0]
    v_cvt_pk_f16_f32 v52, v32, v36
    v_cvt_pk_f16_f32 v53, v33, v37
    v_cvt_pk_f16_f32 v54, v34, v38
    v_cvt_pk_f16_f32 v55, v35, v39
    v_mfma_f32_32x32x16_f16 v[104:119], v[48:51], v[96:99], v[104:119]
    s_nop 0
    v_mfma_f32_32x32x16_f16 v[104:119], v[52:55], v[100:103], v[104:119]
    s_nop 11
    ds_bpermute_b32 v12, v19, v104
    s_waitcnt lgkmcnt(1)
    v_pk_fma_f32 v[152:153], v[184:185], v[104:105], v[152:153]
    v_pk_fma_f32 v[154:155], v[186:187], v[106:107], v[154:155]
    v_pk_fma_f32 v[156:157], v[188:189], v[108:109], v[156:157]
    v_pk_fma_f32 v[158:159], v[190:191], v[110:111], v[158:159]
    v_pk_fma_f32 v[160:161], v[192:193], v[112:113], v[160:161]
    v_pk_fma_f32 v[162:163], v[194:195], v[114:115], v[162:163]
    v_pk_fma_f32 v[164:165], v[196:197], v[116:117], v[164:165]
    v_pk_fma_f32 v[166:167], v[198:199], v[118:119], v[166:167]
    v_pk_fma_f32 v[170:171], v[202:203], v[106:107], v[170:171]
    v_pk_fma_f32 v[172:173], v[204:205], v[108:109], v[172:173]
    v_pk_fma_f32 v[174:175], v[206:207], v[110:111], v[174:175]
    v_pk_fma_f32 v[176:177], v[208:209], v[112:113], v[176:177]
    v_pk_fma_f32 v[178:179], v[210:211], v[114:115], v[178:179]
    v_pk_fma_f32 v[180:181], v[212:213], v[116:117], v[180:181]
    v_pk_fma_f32 v[182:183], v[214:215], v[118:119], v[182:183]
    v_fmac_f32 v169, v201, v105
    s_waitcnt lgkmcnt(0)
    v_fmac_f32 v168, v200, v12
f_join:
    v_lshrrev_b32 v17, 3, v0
    v_and_b32 v17, 60, v17
    v_add_u32 v17, 159744, v17
    v_and_b32 v7, 0xf0, v3
    v_lshrrev_b32 v7, 2, v7
    v_add_u32 v7, 159744, v7
    v_pk_add_f32 v[40:41], v[166:167], v[164:165]
    v_pk_add_f32 v[48:49], v[182:183], v[180:181]
    v_pk_add_f32 v[40:41], v[40:41], v[162:163]
    v_pk_add_f32 v[48:49], v[48:49], v[178:179]
    v_pk_add_f32 v[40:41], v[40:41], v[160:161]
    v_pk_add_f32 v[48:49], v[48:49], v[176:177]
    v_pk_add_f32 v[40:41], v[40:41], v[158:159]
    v_pk_add_f32 v[48:49], v[48:49], v[174:175]
    v_pk_add_f32 v[40:41], v[40:41], v[156:157]
    v_pk_add_f32 v[48:49], v[48:49], v[172:173]
    v_pk_add_f32 v[40:41], v[40:41], v[154:155]
    v_pk_add_f32 v[48:49], v[48:49], v[170:171]
    v_pk_add_f32 v[40:41], v[40:41], v[152:153]
    v_pk_add_f32 v[48:49], v[48:49], v[168:169]
    v_pk_mul_f32 v[42:43], v[166:167], v[166:167]
    v_pk_mul_f32 v[44:45], v[166:167], v[230:231]
    v_pk_mul_f32 v[50:51], v[182:183], v[182:183]
    v_pk_mul_f32 v[52:53], v[182:183], v[246:247]
    v_pk_fma_f32 v[42:43], v[164:165], v[164:165], v[42:43]
    v_pk_fma_f32 v[44:45], v[164:165], v[228:229], v[44:45]
    v_pk_fma_f32 v[50:51], v[180:181], v[180:181], v[50:51]
    v_pk_fma_f32 v[52:53], v[180:181], v[244:245], v[52:53]
    v_pk_fma_f32 v[42:43], v[162:163], v[162:163], v[42:43]
    v_pk_fma_f32 v[44:45], v[162:163], v[226:227], v[44:45]
    v_pk_fma_f32 v[50:51], v[178:179], v[178:179], v[50:51]
    v_pk_fma_f32 v[52:53], v[178:179], v[242:243], v[52:53]
    v_pk_fma_f32 v[42:43], v[160:161], v[160:161], v[42:43]
    v_pk_fma_f32 v[44:45], v[160:161], v[224:225], v[44:45]
    v_pk_fma_f32 v[50:51], v[176:177], v[176:177], v[50:51]
    v_pk_fma_f32 v[52:53], v[176:177], v[240:241], v[52:53]
    v_pk_fma_f32 v[42:43], v[158:159], v[158:159], v[42:43]
    v_pk_fma_f32 v[44:45], v[158:159], v[222:223], v[44:45]
    v_pk_fma_f32 v[50:51], v[174:175], v[174:175], v[50:51]
    v_pk_fma_f32 v[52:53], v[174:175], v[238:239], v[52:53]
    v_pk_fma_f32 v[42:43], v[156:157], v[156:157], v[42:43]
    v_pk_fma_f32 v[44:45], v[156:157], v[220:221], v[44:45]
    v_pk_fma_f32 v[50:51], v[172:173], v[172:173], v[50:51]
    v_pk_fma_f32 v[52:53], v[172:173], v[236:237], v[52:53]
    v_pk_fma_f32 v[42:43], v[154:155], v[154:155], v[42:43]
    v_pk_fma_f32 v[44:45], v[154:155], v[218:219], v[44:45]
    v_pk_fma_f32 v[50:51], v[170:171], v[170:171], v[50:51]
    v_pk_fma_f32 v[52:53], v[170:171], v[234:235], v[52:53]
    v_pk_fma_f32 v[42:43], v[152:153], v[152:153], v[42:43]
    v_pk_fma_f32 v[44:45], v[152:153], v[216:217], v[44:45]
    v_pk_fma_f32 v[50:51], v[168:169], v[168:169], v[50:51]
    v_pk_fma_f32 v[52:53], v[168:169], v[232:233], v[52:53]
    v_add_f32 v24, v40, v41
    v_add_f32 v25, v42, v43
    v_add_f32 v26, v44, v45
    v_add_f32 v28, v48, v49
    v_add_f32 v29, v50, v51
    v_add_f32 v30, v52, v53
    s_cmp_eq_u32 s79, 0
    s_cbranch_scc1 f_go
f_ngo:
    v_permlane32_swap_b32 v24, v28
    v_permlane32_swap_b32 v25, v29
    v_permlane32_swap_b32 v26, v30
    v_add_f32 v24, v24, v28
    v_add_f32 v25, v25, v29
    v_add_f32 v26, v26, v30
    v_add_f32_dpp v24, v24, v24 row_ror:8 row_mask:0xf bank_mask:0xf
    v_add_f32_dpp v25, v25, v25 row_ror:8 row_mask:0xf bank_mask:0xf
    v_add_f32_dpp v26, v26, v26 row_ror:8 row_mask:0xf bank_mask:0xf
    v_add_f32_dpp v24, v24, v24 row_ror:4 row_mask:0xf bank_mask:0xf
    v_add_f32_dpp v25, v25, v25 row_ror:4 row_mask:0xf bank_mask:0xf
    v_add_f32_dpp v26, v26, v26 row_ror:4 row_mask:0xf bank_mask:0xf
    v_add_f32_dpp v24, v24, v24 row_ror:2 row_mask:0xf bank_mask:0xf
    v_add_f32_dpp v25, v25, v25 row_ror:2 row_mask:0xf bank_mask:0xf
    v_add_f32_dpp v26, v26, v26 row_ror:2 row_mask:0xf bank_mask:0xf
    v_add_f32_dpp v24, v24, v24 row_ror:1 row_mask:0xf bank_mask:0xf
    v_add_f32_dpp v25, v25, v25 row_ror:1 row_mask:0xf bank_mask:0xf
    v_add_f32_dpp v26, v26, v26 row_ror:1 row_mask:0xf bank_mask:0xf
    v_add_f32_dpp v24, v24, v24 row_bcast:15 row_mask:0xa bank_mask:0xf
    v_add_f32_dpp v25, v25, v25 row_bcast:15 row_mask:0xa bank_mask:0xf
    v_add_f32_dpp v26, v26, v26 row_bcast:15 row_mask:0xa bank_mask:0xf
    v_mul_f32 v24, 0x3a800000, v24
    v_mul_f32 v25, 0x3a800000, v25
    v_mul_f32 v28, v24, v24
    v_fma_f32 v26, -v24, v22, v26
    v_sub_f32 v25, v25, v28
    v_mul_f32 v29, 4.0, v25
    v_cmp_gt_f32 vcc, v28, v29
    v_lshrrev_b32 v30, 4, v0
    s_lshl_b32 s43, s3, 5
    v_and_or_b32 v30, v30, 30, s43
    s_or_b32 s42, vcc_lo, vcc_hi
    s_bitcmp1_b32 s42, 31
    s_cbranch_scc1 f_slow2
f_var2:
    v_cvt_pk_bf16_f32 v25, v25, v25
    v_lshlrev_b32 v25, 16, v25
    v_add_f32 v25, 0x3727c5ac, v25
    v_cvt_pk_bf16_f32 v25, v25, v25
    v_lshlrev_b32 v25, 16, v25
    v_sqrt_f32 v25, v25
    s_nop 0
    v_cvt_pk_bf16_f32 v25, v25, v25
    v_lshlrev_b32 v25, 16, v25
    v_rcp_f32 v25, v25
    s_mov_b32 s42, 0x80000000
    s_movk_i32 s43, 0xf000
    s_mov_b32 exec_lo, s42
    s_mov_b32 exec_hi, s42
    v_mul_f32 v26, v26, v25
    v_ashrrev_i32 v28, 31, v26
    v_or_b32 v28, s42, v28
    v_xor_b32 v26, v26, v28
    v_and_or_b32 v26, v26, s43, v30
    ds_write_b32 v17, v26
    v_mul_f32 v24, -v24, v25
    s_mov_b64 exec, -1
    v_readlane_b32 s60, v26, 31
    v_readlane_b32 s56, v24, 31
    v_readlane_b32 s57, v25, 31
    v_readlane_b32 s61, v26, 63
    v_readlane_b32 s58, v24, 63
    v_readlane_b32 s59, v25, 63
    s_waitcnt lgkmcnt(0)
    s_barrier
    ds_read_b32 v32, v7
    s_mul_i32 s42, s16, 3072
    v_add_u32 v4, s42, v3
    s_add_u32 s64, s42, 16900096
    s_waitcnt lgkmcnt(0)
    v_cmp_lt_u32 vcc, s60, v32
    v_cmp_lt_u32 s[44:45], s61, v32
    s_and_b32 s62, vcc_lo, 0xffff
    s_and_b32 s63, s44, 0xffff
    s_bcnt1_i32_b32 s62, s62
    s_bcnt1_i32_b32 s63, s63
    s_min_u32 s42, s62, s63
    s_cmp_lg_u32 s42, 0
    s_cbranch_scc1 f_nkey
    s_setprio 3
    s_max_u32 s42, s60, s61
    v_cmp_ne_u32 vcc, s42, v32
    v_mov_b32 v36, s42
    v_mov_b32 v37, s32
    v_cndmask_b32 v38, 0, v32, vcc
    v_mov_b32 v39, s33
    s_nop 0
    v_max_u32_dpp v38, v38, v38 row_ror:8 row_mask:0xf bank_mask:0xf
    s_nop 1
    v_max_u32_dpp v38, v38, v38 row_ror:4 row_mask:0xf bank_mask:0xf
    s_nop 1
    v_max_u32_dpp v38, v38, v38 row_ror:2 row_mask:0xf bank_mask:0xf
    s_nop 1
    v_max_u32_dpp v38, v38, v38 row_ror:1 row_mask:0xf bank_mask:0xf
    v_or_b32 v38, 1, v38
    buffer_store_dwordx4 v[36:39], v18, s[12:15], s80 offen sc1
f_nkey:
    s_cmp_ge_u32 s62, 2
    s_cbranch_scc1 f_nc0
f_cand0:
    s_setprio 2
    s_lshl_b32 s43, s3, 1
    s_add_u32 s42, s62, s43
    s_lshl_b32 s43, s42, 7
    s_lshl_b32 s42, s42, 12
    s_add_u32 s42, s42, 18874368
    s_add_u32 s43, s43, 17170432
    v_mov_b32 v12, 0xffffff00
    v_and_or_b32 v56, v152, v12, s4
    v_and_or_b32 v57, v153, v12, s5
    v_and_or_b32 v58, v154, v12, s6
    v_and_or_b32 v59, v155, v12, s7
    buffer_store_dwordx4 v[56:59], v15, s[12:15], s42 offen offset:0 sc1
    v_and_or_b32 v60, v156, v12, s8
    v_and_or_b32 v61, v157, v12, s9
    v_and_or_b32 v62, v158, v12, s10
    v_and_or_b32 v63, v159, v12, s11
    buffer_store_dwordx4 v[60:63], v15, s[12:15], s42 offen offset:1024 sc1
    v_and_or_b32 v64, v160, v12, s4
    v_and_or_b32 v65, v161, v12, s5
    v_and_or_b32 v66, v162, v12, s6
    v_and_or_b32 v67, v163, v12, s7
    buffer_store_dwordx4 v[64:67], v15, s[12:15], s42 offen offset:512 sc1
    v_and_or_b32 v68, v164, v12, s8
    v_and_or_b32 v69, v165, v12, s9
    v_and_or_b32 v70, v166, v12, s10
    v_and_or_b32 v71, v167, v12, s11
    buffer_store_dwordx4 v[68:71], v15, s[12:15], s42 offen offset:1536 sc1
    v_mov_b32 v40, s32
    v_mov_b32 v41, s33
    v_mov_b32 v42, s56
    v_mov_b32 v43, s57
    s_mov_b64 exec, 0xff
    buffer_store_dwordx4 v[40:43], v3, s[12:15], s43 offen sc1
    s_mov_b64 exec, -1
    s_setprio 0
f_nc0:
    s_cmp_ge_u32 s63, 2
    s_cbranch_scc1 f_nc1
f_cand1:
    s_setprio 2
    s_lshl_b32 s43, s3, 1
    s_add_u32 s42, s63, s43
    s_lshl_b32 s43, s42, 7
    s_lshl_b32 s42, s42, 12
    s_add_u32 s42, s42, 18874368
    s_add_u32 s43, s43, 17170432
    v_mov_b32 v12, 0xffffff00
    v_and_or_b32 v72, v168, v12, s4
    v_and_or_b32 v73, v183, v12, s5
    v_and_or_b32 v74, v182, v12, s6
    v_and_or_b32 v75, v181, v12, s7
    buffer_store_dwordx4 v[72:75], v16, s[12:15], s42 offen offset:0 sc1
    v_and_or_b32 v76, v180, v12, s8
    v_and_or_b32 v77, v179, v12, s9
    v_and_or_b32 v78, v178, v12, s10
    v_and_or_b32 v79, v177, v12, s11
    buffer_store_dwordx4 v[76:79], v16, s[12:15], s42 offen offset:1024 sc1
    v_and_or_b32 v80, v176, v12, s4
    v_and_or_b32 v81, v175, v12, s5
    v_and_or_b32 v82, v174, v12, s6
    v_and_or_b32 v83, v173, v12, s7
    buffer_store_dwordx4 v[80:83], v16, s[12:15], s42 offen offset:512 sc1
    v_and_or_b32 v84, v172, v12, s8
    v_and_or_b32 v85, v171, v12, s9
    v_and_or_b32 v86, v170, v12, s10
    v_and_or_b32 v87, v169, v12, s11
    buffer_store_dwordx4 v[84:87], v16, s[12:15], s42 offen offset:1536 sc1
    v_mov_b32 v44, s32
    v_mov_b32 v45, s33
    v_mov_b32 v46, s58
    v_mov_b32 v47, s59
    s_mov_b64 exec, 0xff
    buffer_store_dwordx4 v[44:47], v3, s[12:15], s43 offen sc1
    s_mov_b64 exec, -1
    s_setprio 0
f_nc1:
    buffer_load_dwordx4 v[248:251], v3, s[12:15], s64 offen offset:0 sc1
    buffer_load_dwordx4 v[252:255], v3, s[12:15], s64 offen offset:1024 sc1
    buffer_load_dwordx4 v[136:139], v3, s[12:15], s64 offen offset:2048 sc1
    s_barrier
    s_cmp_ge_u32 s35, 14
    s_cbranch_scc1 f_nd2
    s_add_u32 s43, s39, 3072
    s_mov_b32 m0, s43
    s_add_u32 s42, s38, 6144
    v_xor_b32 v7, 96, v3
    buffer_load_dwordx4 v7, s[48:51], s42 offen nt lds
    s_add_u32 s43, s39, 4096
    s_mov_b32 m0, s43
    s_add_u32 s42, s38, 16384
    v_xor_b32 v7, 128, v3
    buffer_load_dwordx4 v7, s[48:51], s42 offen nt lds
    s_add_u32 s43, s39, 5120
    s_mov_b32 m0, s43
    s_add_u32 s42, s38, 18432
    v_xor_b32 v7, 160, v3
    buffer_load_dwordx4 v7, s[48:51], s42 offen nt lds
    s_add_u32 s43, s39, 6144
    s_mov_b32 m0, s43
    s_add_u32 s42, s38, 20480
    v_xor_b32 v7, 192, v3
    buffer_load_dwordx4 v7, s[48:51], s42 offen nt lds
    s_add_u32 s43, s39, 7168
    s_mov_b32 m0, s43
    s_add_u32 s42, s38, 22528
    v_xor_b32 v7, 224, v3
    buffer_load_dwordx4 v7, s[48:51], s42 offen nt lds
f_nd2:
    v_pk_fma_f32 v[56:57], v[152:153], s[56:57], s[56:57] op_sel:[0,1,0] op_sel_hi:[1,1,0]
    v_pk_fma_f32 v[58:59], v[154:155], s[56:57], s[56:57] op_sel:[0,1,0] op_sel_hi:[1,1,0]
    v_pk_fma_f32 v[60:61], v[156:157], s[56:57], s[56:57] op_sel:[0,1,0] op_sel_hi:[1,1,0]
    v_pk_fma_f32 v[62:63], v[158:159], s[56:57], s[56:57] op_sel:[0,1,0] op_sel_hi:[1,1,0]
    v_pk_fma_f32 v[64:65], v[160:161], s[56:57], s[56:57] op_sel:[0,1,0] op_sel_hi:[1,1,0]
    v_pk_fma_f32 v[66:67], v[162:163], s[56:57], s[56:57] op_sel:[0,1,0] op_sel_hi:[1,1,0]
    v_pk_fma_f32 v[68:69], v[164:165], s[56:57], s[56:57] op_sel:[0,1,0] op_sel_hi:[1,1,0]
    v_pk_fma_f32 v[70:71], v[166:167], s[56:57], s[56:57] op_sel:[0,1,0] op_sel_hi:[1,1,0]
    v_pk_fma_f32 v[72:73], v[168:169], s[58:59], s[58:59] op_sel:[0,1,0] op_sel_hi:[1,1,0]
    v_pk_fma_f32 v[74:75], v[170:171], s[58:59], s[58:59] op_sel:[0,1,0] op_sel_hi:[1,1,0]
    v_pk_fma_f32 v[76:77], v[172:173], s[58:59], s[58:59] op_sel:[0,1,0] op_sel_hi:[1,1,0]
    v_pk_fma_f32 v[78:79], v[174:175], s[58:59], s[58:59] op_sel:[0,1,0] op_sel_hi:[1,1,0]
    v_pk_fma_f32 v[80:81], v[176:177], s[58:59], s[58:59] op_sel:[0,1,0] op_sel_hi:[1,1,0]
    v_pk_fma_f32 v[82:83], v[178:179], s[58:59], s[58:59] op_sel:[0,1,0] op_sel_hi:[1,1,0]
    v_pk_fma_f32 v[84:85], v[180:181], s[58:59], s[58:59] op_sel:[0,1,0] op_sel_hi:[1,1,0]
    v_pk_fma_f32 v[86:87], v[182:183], s[58:59], s[58:59] op_sel:[0,1,0] op_sel_hi:[1,1,0]
    v_subrev_u32 v13, s68, v13
    s_sub_u32 s68, s68, 65536
    v_bfe_u32 v12, v0, 1, 2
    v_lshlrev_b32 v12, 4, v12
    v_xor_b32 v13, v13, v12
    v_xor_b32 v14, 2000, v13
    v_add_u32 v13, s68, v13
    v_add_u32 v14, s68, v14
    v_xor_b32 v20, 16, v13
    v_xor_b32 v21, 16, v14
    v_and_b32 v22, 8, v0
    v_lshlrev_b32 v22, 1, v22
    v_xor_b32 v22, v22, v3
    v_add_u32 v22, s68, v22
    v_xor_b32 v23, 32, v22
    s_mov_b32 s83, 0
    s_cmp_ge_u32 s35, 14
    s_cbranch_scc1 f_p2c
    s_waitcnt vmcnt(5)
f_p2e:
    v_xor_b32 v248, v8, v248
    v_xor_b32 v249, v9, v249
    v_xor_b32 v250, v10, v250
    v_xor_b32 v251, v11, v251
    v_xor_b32 v252, v8, v252
    v_xor_b32 v253, v9, v253
    v_xor_b32 v254, v10, v254
    v_xor_b32 v255, v11, v255
    v_xor_b32 v136, v8, v136
    v_xor_b32 v137, v9, v137
    v_xor_b32 v138, v10, v138
    v_xor_b32 v139, v11, v139
    v_or3_b32 v12, v248, v249, 0
    v_or3_b32 v12, v250, v251, v12
    v_or3_b32 v12, v252, v253, v12
    v_or3_b32 v12, v254, v255, v12
    v_or3_b32 v12, v136, v137, v12
    v_or3_b32 v12, v138, v139, v12
    v_and_b32 v12, 0xff, v12
    v_cmp_ne_u32 vcc, 0, v12
    s_cbranch_vccnz f_p2r
f_p2w:
    ds_write_b128 v4, v[248:251] offset:36864
    ds_write_b128 v4, v[252:255] offset:37888
    ds_write_b128 v4, v[136:139] offset:38912
    s_waitcnt lgkmcnt(0)
    s_barrier
    v_not_b32 v24, v8
    v_bfe_u32 v7, v0, 4, 2
    v_lshlrev_b32 v7, 13, v7
    v_and_b32 v25, 0x70, v3
    v_add_u32 v7, v7, v25
    s_and_b32 s42, s35, 1
    s_lshl_b32 s42, s42, 3
    s_add_u32 s42, s42, s16
    s_lshl_b32 s42, s42, 15
    s_lshl_b32 s43, s17, 7
    s_add_u32 s42, s42, s43
    s_add_u32 s42, s42, 17825792
    s_cmp_ge_u32 s35, 14
    s_cbranch_scc1 f_npw
    s_mov_b32 exec_lo, 0x00ff00ff
    s_mov_b32 exec_hi, 0x00ff00ff
    buffer_store_dwordx4 v[24:27], v7, s[12:15], s42 offen sc1
    s_mov_b64 exec, -1
f_npw:
    ds_read_b128 v[88:91], v3 offset:36864
    ds_read_b128 v[92:95], v3 offset:37888
    ds_read_b128 v[96:99], v3 offset:38912
    ds_read_b128 v[100:103], v3 offset:39936
    ds_read_b128 v[136:139], v3 offset:45056
    ds_read_b128 v[140:143], v3 offset:46080
    ds_read_b128 v[144:147], v3 offset:47104
    ds_read_b128 v[148:151], v3 offset:48128
    ds_read_b128 v[184:187], v3 offset:53248
    ds_read_b128 v[188:191], v3 offset:54272
    ds_read_b128 v[192:195], v3 offset:55296
    ds_read_b128 v[196:199], v3 offset:56320
    s_waitcnt lgkmcnt(4)
    v_pk_fma_f32 v[56:57], v[56:57], v[88:89], v[136:137]
    v_pk_fma_f32 v[58:59], v[58:59], v[90:91], v[138:139]
    v_pk_fma_f32 v[60:61], v[60:61], v[92:93], v[140:141]
    v_pk_fma_f32 v[62:63], v[62:63], v[94:95], v[142:143]
    v_pk_fma_f32 v[64:65], v[64:65], v[96:97], v[144:145]
    v_pk_fma_f32 v[66:67], v[66:67], v[98:99], v[146:147]
    v_pk_fma_f32 v[68:69], v[68:69], v[100:101], v[148:149]
    v_pk_fma_f32 v[70:71], v[70:71], v[102:103], v[150:151]
    s_waitcnt lgkmcnt(0)
    ds_read_b128 v[120:123], v3 offset:40960
    ds_read_b128 v[124:127], v3 offset:41984
    ds_read_b128 v[128:131], v3 offset:43008
    ds_read_b128 v[132:135], v3 offset:44032
    ds_read_b128 v[104:107], v3 offset:49152
    ds_read_b128 v[108:111], v3 offset:50176
    ds_read_b128 v[112:115], v3 offset:51200
    ds_read_b128 v[116:119], v3 offset:52224
    ds_read_b128 v[200:203], v3 offset:57344
    ds_read_b128 v[204:207], v3 offset:58368
    ds_read_b128 v[208:211], v3 offset:59392
    ds_read_b128 v[212:215], v3 offset:60416
    v_pk_fma_f32 v[152:153], v[184:185], v[56:57], v[152:153]
    v_pk_fma_f32 v[154:155], v[186:187], v[58:59], v[154:155]
    v_pk_fma_f32 v[156:157], v[188:189], v[60:61], v[156:157]
    v_pk_fma_f32 v[158:159], v[190:191], v[62:63], v[158:159]
    v_pk_fma_f32 v[160:161], v[192:193], v[64:65], v[160:161]
    v_pk_fma_f32 v[162:163], v[194:195], v[66:67], v[162:163]
    v_pk_fma_f32 v[164:165], v[196:197], v[68:69], v[164:165]
    v_pk_fma_f32 v[166:167], v[198:199], v[70:71], v[166:167]
    v_cvt_pk_bf16_f32 v216, v152, v153
    v_cvt_pk_bf16_f32 v217, v154, v155
    v_cvt_pk_bf16_f32 v218, v156, v157
    v_cvt_pk_bf16_f32 v219, v158, v159
    v_cvt_pk_bf16_f32 v220, v160, v161
    v_cvt_pk_bf16_f32 v221, v162, v163
    v_cvt_pk_bf16_f32 v222, v164, v165
    v_cvt_pk_bf16_f32 v223, v166, v167
    ds_write_b128 v13, v[216:219] offset:0
    ds_write_b128 v20, v[220:223] offset:0
    s_waitcnt lgkmcnt(6)
    v_pk_fma_f32 v[72:73], v[72:73], v[120:121], v[104:105]
    v_pk_fma_f32 v[74:75], v[74:75], v[122:123], v[106:107]
    v_pk_fma_f32 v[76:77], v[76:77], v[124:125], v[108:109]
    v_pk_fma_f32 v[78:79], v[78:79], v[126:127], v[110:111]
    v_pk_fma_f32 v[80:81], v[80:81], v[128:129], v[112:113]
    v_pk_fma_f32 v[82:83], v[82:83], v[130:131], v[114:115]
    v_pk_fma_f32 v[84:85], v[84:85], v[132:133], v[116:117]
    v_pk_fma_f32 v[86:87], v[86:87], v[134:135], v[118:119]
    s_waitcnt lgkmcnt(2)
    v_pk_fma_f32 v[168:169], v[200:201], v[72:73], v[168:169]
    v_pk_fma_f32 v[170:171], v[202:203], v[74:75], v[170:171]
    v_pk_fma_f32 v[172:173], v[204:205], v[76:77], v[172:173]
    v_pk_fma_f32 v[174:175], v[206:207], v[78:79], v[174:175]
    v_pk_fma_f32 v[176:177], v[208:209], v[80:81], v[176:177]
    v_pk_fma_f32 v[178:179], v[210:211], v[82:83], v[178:179]
    v_pk_fma_f32 v[180:181], v[212:213], v[84:85], v[180:181]
    v_pk_fma_f32 v[182:183], v[214:215], v[86:87], v[182:183]
    v_cvt_pk_bf16_f32 v224, v168, v183
    v_cvt_pk_bf16_f32 v225, v182, v181
    v_cvt_pk_bf16_f32 v226, v180, v179
    v_cvt_pk_bf16_f32 v227, v178, v177
    v_cvt_pk_bf16_f32 v228, v176, v175
    v_cvt_pk_bf16_f32 v229, v174, v173
    v_cvt_pk_bf16_f32 v230, v172, v171
    v_cvt_pk_bf16_f32 v231, v170, v169
    ds_write_b128 v14, v[224:227] offset:2048
    ds_write_b128 v21, v[228:231] offset:2048
    s_waitcnt lgkmcnt(0)
    ds_read_b128 v[232:235], v22 offset:0
    ds_read_b128 v[236:239], v23 offset:1024
    ds_read_b128 v[240:243], v22 offset:2048
    ds_read_b128 v[244:247], v23 offset:3072
    v_lshrrev_b32 v144, 2, v2
    v_and_b32 v145, 7, v144
    v_and_b32 v146, 3, v0
    v_lshl_add_u32 v148, v1, 2, v146
    v_xor_b32 v148, v148, v145
    v_lshlrev_b32 v148, 5, v148
    v_lshl_add_u32 v148, v144, 10, v148
    v_add_u32 v148, 94208, v148
    v_cmp_eq_u32 s[44:45], 1, v146
    v_cmp_eq_u32 s[46:47], 2, v146
    v_cmp_eq_u32 s[72:73], 3, v146
    v_bfe_u32 v145, v0, 4, 2
    v_and_b32 v144, 1, v144
    v_lshlrev_b32 v153, 7, v144
    v_lshl_add_u32 v153, v145, 4, v153
    v_add_u32 v153, 159872, v153
    v_lshlrev_b32 v154, 4, v146
    v_lshl_add_u32 v154, v144, 6, v154
    v_lshl_add_u32 v154, v1, 15, v154
    v_lshl_add_u32 v154, v145, 13, v154
    v_and_b32 v144, 15, v0
    v_lshlrev_b32 v152, 1, v144
    v_lshl_add_u32 v152, v1, 5, v152
    v_lshl_add_u32 v152, v145, 7, v152
    v_add_u32 v152, 159872, v152
    s_and_b32 s76, s35, 1
    s_lshl_b32 s76, s76, 18
    s_lshl_b32 s77, s17, 7
    s_add_u32 s76, s76, s77
    s_add_u32 s76, s76, 17825792
    s_movk_i32 s77, 0xff00
    s_lshl_b32 s81, s17, 2
    s_and_b32 s42, s16, 3
    s_add_u32 s81, s81, s42
    s_lshl_b32 s81, s81, 10
    s_add_u32 s82, s81, 18612224
    s_add_u32 s81, s81, 18350080
    v_mov_b32 v5, 159848
    s_waitcnt vmcnt(0)
    s_barrier
    ds_read_b64_tr_b16 v[88:89], v148 offset:0
    ds_read_b64_tr_b16 v[90:91], v148 offset:16384
    ds_read_b64_tr_b16 v[92:93], v148 offset:8
    ds_read_b64_tr_b16 v[94:95], v148 offset:16392
    ds_read_b64_tr_b16 v[96:97], v148 offset:16
    ds_read_b64_tr_b16 v[98:99], v148 offset:16400
    ds_read_b64_tr_b16 v[100:101], v148 offset:24
    ds_read_b64_tr_b16 v[102:103], v148 offset:16408
    ds_read_b64_tr_b16 v[104:105], v148 offset:32768
    ds_read_b64_tr_b16 v[106:107], v148 offset:49152
    ds_read_b64_tr_b16 v[108:109], v148 offset:32776
    ds_read_b64_tr_b16 v[110:111], v148 offset:49160
    ds_read_b64_tr_b16 v[112:113], v148 offset:32784
    ds_read_b64_tr_b16 v[114:115], v148 offset:49168
    ds_read_b64_tr_b16 v[116:117], v148 offset:32792
    ds_read_b64_tr_b16 v[118:119], v148 offset:49176
    v_lshlrev_b32 v40, 13, v2
    s_lshl_b32 s74, s34, 14
    s_add_u32 s74, s74, 17436672
    s_min_u32 s75, s62, s63
    s_cmp_ge_u32 s35, 14
    s_cbranch_scc1 f_na
    s_cmp_ge_u32 s16, 4
    s_cbranch_scc1 f_na
    s_mov_b32 s83, 0
f_px:
    s_and_b32 s42, s83, 63
    s_cmp_eq_u32 s42, 63
    s_cselect_b32 s42, s82, s81
    buffer_load_dwordx4 v[144:147], v3, s[12:15], s42 offen sc1
    s_add_u32 s83, s83, 1
    s_cmp_ge_u32 s83, 0x40000
    s_cbranch_scc1 f_pxx
    s_waitcnt vmcnt(0)
    v_cmp_ne_u16_sdwa vcc, v147, v11 src0_sel:BYTE_0 src1_sel:DWORD
    s_cbranch_vccnz f_px
    v_xor_b32 v144, v8, v144
    v_xor_b32 v145, v9, v145
    v_xor_b32 v146, v10, v146
    v_xor_b32 v147, v11, v147
    v_or3_b32 v4, v144, v145, 0
    v_or3_b32 v4, v146, v147, v4
    v_and_b32 v4, 0xff, v4
    v_cmp_ne_u32 vcc, 0, v4
    s_cbranch_vccnz f_px
f_pxx:
    s_waitcnt vmcnt(0)
    v_permlane32_swap_b32 v144, v146
    v_permlane32_swap_b32 v145, v147
    v_pk_add_f32 v[144:145], v[144:145], v[146:147]
    s_nop 1
    v_permlane16_swap_b32 v144, v145
    v_add_f32 v144, v144, v145
    v_cvt_pk_bf16_f32 v144, v144, v144
    v_lshlrev_b32 v144, 16, v144
    v_mul_f32 v145, 0xbfb8aa3b, v144
    v_exp_f32 v145, v145
    v_mov_b32 v146, v144
    v_add_f32 v145, 1.0, v145
    v_rcp_f32 v145, v145
    v_mov_b32 v147, v144
    v_mul_f32 v145, v144, v145
    s_nop 0
    v_permlane32_swap_b32 v146, v147
    v_cvt_pk_bf16_f32 v145, v145, v145
    v_lshlrev_b32 v145, 16, v145
    v_mul_f32 v145, v145, v147
    v_cvt_pk_bf16_f32 v145, v145, v145
    ds_write_b16 v152, v145
f_na:
    s_waitcnt lgkmcnt(0)
    s_barrier
    s_cmp_ge_u32 s35, 14
    s_cbranch_scc1 f_fin
    ds_read_b128 v[120:123], v153 offset:0
    ds_read_b128 v[124:127], v153 offset:64
    s_cmp_lt_u32 s75, 2
    s_cbranch_scc1 f_rq
f_rqx:
    s_waitcnt lgkmcnt(1)
    v_mfma_f32_16x16x32_bf16 v[128:131], v[88:91], v[120:123], 0
    v_mfma_f32_16x16x32_bf16 v[132:135], v[92:95], v[120:123], 0
    v_mfma_f32_16x16x32_bf16 v[136:139], v[96:99], v[120:123], 0
    v_mfma_f32_16x16x32_bf16 v[140:143], v[100:103], v[120:123], 0
    s_waitcnt lgkmcnt(0)
    v_mfma_f32_16x16x32_bf16 v[128:131], v[104:107], v[124:127], v[128:131]
    v_mfma_f32_16x16x32_bf16 v[132:135], v[108:111], v[124:127], v[132:135]
    v_mfma_f32_16x16x32_bf16 v[136:139], v[112:115], v[124:127], v[136:139]
    v_mfma_f32_16x16x32_bf16 v[140:143], v[116:119], v[124:127], v[140:143]
    s_nop 5
    v_cndmask_b32 v128, v128, v132, s[44:45]
    v_cndmask_b32 v129, v129, v133, s[44:45]
    v_cndmask_b32 v130, v130, v134, s[44:45]
    v_cndmask_b32 v131, v131, v135, s[44:45]
    v_cndmask_b32 v128, v128, v136, s[46:47]
    v_cndmask_b32 v129, v129, v137, s[46:47]
    v_cndmask_b32 v130, v130, v138, s[46:47]
    v_cndmask_b32 v131, v131, v139, s[46:47]
    v_cndmask_b32 v128, v128, v140, s[72:73]
    v_cndmask_b32 v129, v129, v141, s[72:73]
    v_cndmask_b32 v130, v130, v142, s[72:73]
    v_cndmask_b32 v131, v131, v143, s[72:73]
    v_and_or_b32 v128, v128, s77, v8
    v_and_or_b32 v129, v129, s77, v9
    v_and_or_b32 v130, v130, s77, v10
    v_and_or_b32 v131, v131, s77, v11
    s_mov_b32 exec_lo, 0x00ff00ff
    s_mov_b32 exec_hi, 0x00ff00ff
    buffer_store_dwordx4 v[128:131], v154, s[12:15], s76 offen sc1
    s_mov_b64 exec, -1
    s_barrier
f_fin:
    s_cmp_lt_u32 s75, 2
    s_cbranch_scc1 f_sel
    buffer_store_dwordx4 v[232:235], v3, s[24:27], s18 offen offset:0 sc1
    buffer_store_dwordx4 v[236:239], v3, s[24:27], s18 offen offset:1024 sc1
f_g0:
    buffer_store_dwordx4 v[240:243], v3, s[24:27], s19 offen offset:0 sc1
    buffer_store_dwordx4 v[244:247], v3, s[24:27], s19 offen offset:1024 sc1
f_g1:
f_end:
    s_endpgm
f_rq:
    s_mov_b64 exec, 3
    buffer_load_dwordx4 v[32:35], v40, s[12:15], s74 offen sc1
    s_mov_b64 exec, -1
    s_branch f_rqx
f_sel:
    s_mov_b32 s83, 0
    s_cmp_ge_u32 s35, 14
    s_cbranch_scc1 f_sr
    s_waitcnt vmcnt(1)
f_sc:
    v_cmp_ne_u64 vcc, s[32:33], v[32:33]
    v_readlane_b32 s40, v34, 0
    v_readlane_b32 s41, v34, 1
    s_and_b32 s42, vcc_lo, 3
    s_cbranch_scc0 f_sx
    s_sleep 4
f_sr:
    s_mov_b64 exec, 3
    buffer_load_dwordx4 v[32:35], v40, s[12:15], s74 offen sc1
    s_mov_b64 exec, -1
    s_waitcnt vmcnt(0)
    s_add_u32 s83, s83, 1
    s_cmp_lt_u32 s83, 0x40000
    s_cbranch_scc1 f_sc
f_sx:
    s_andn2_b32 s40, s40, 1
    s_andn2_b32 s41, s41, 1
    s_cmp_eq_u32 s60, s40
    s_cbranch_scc1 f_e0
    s_cmp_eq_u32 s60, s41
    s_cbranch_scc1 f_e0
    buffer_store_dwordx4 v[232:235], v3, s[24:27], s18 offen offset:0 sc1
    buffer_store_dwordx4 v[236:239], v3, s[24:27], s18 offen offset:1024 sc1
f_e0:
    s_cmp_eq_u32 s61, s40
    s_cbranch_scc1 f_e1
    s_cmp_eq_u32 s61, s41
    s_cbranch_scc1 f_e1
    buffer_store_dwordx4 v[240:243], v3, s[24:27], s19 offen offset:0 sc1
    buffer_store_dwordx4 v[244:247], v3, s[24:27], s19 offen offset:1024 sc1
f_e1:
    s_branch f_end
f_p2r:
    s_add_u32 s83, s83, 1
    s_cmp_ge_u32 s83, 0x40000
    s_cbranch_scc1 f_p2w
    s_sleep 12
    buffer_load_dwordx4 v[248:251], v3, s[12:15], s64 offen offset:0 sc1
    buffer_load_dwordx4 v[252:255], v3, s[12:15], s64 offen offset:1024 sc1
    buffer_load_dwordx4 v[136:139], v3, s[12:15], s64 offen offset:2048 sc1
f_p2c:
    s_waitcnt vmcnt(0)
    s_branch f_p2e
f_zr:
    v_or3_b32 v248, v40, v42, v44
    v_or_b32 v248, v248, v46
    v_and_b32 v248, s54, v248
    v_cmp_ne_u32 vcc, 0, v248
    s_cbranch_vccz f_zr0
    buffer_load_dwordx4 v[24:27], v3, s[12:15], s72 offen offset:0 sc1
f_zr0:
    v_or3_b32 v248, v41, v43, v45
    v_or_b32 v248, v248, v47
    v_and_b32 v248, s54, v248
    v_cmp_ne_u32 vcc, 0, v248
    s_cbranch_vccz f_zr1
    buffer_load_dwordx4 v[28:31], v3, s[12:15], s72 offen offset:1024 sc1
f_zr1:
    v_or3_b32 v248, v48, v50, v52
    v_or_b32 v248, v248, v54
    v_and_b32 v248, s54, v248
    v_cmp_ne_u32 vcc, 0, v248
    s_cbranch_vccz f_zr2
    buffer_load_dwordx4 v[32:35], v3, s[12:15], s72 offen offset:2048 sc1
f_zr2:
    v_or3_b32 v248, v49, v51, v53
    v_or_b32 v248, v248, v55
    v_and_b32 v248, s54, v248
    v_cmp_ne_u32 vcc, 0, v248
    s_cbranch_vccz f_zr3
    buffer_load_dwordx4 v[36:39], v3, s[12:15], s72 offen offset:3072 sc1
f_zr3:
    s_waitcnt vmcnt(0)
    s_add_u32 s83, s83, 1
    s_cmp_lt_u32 s83, 0x40000
    s_cbranch_scc1 f_zc
    s_branch f_zx
f_r0:
    buffer_load_dwordx4 v3, s[8:11], s18 offen offset:0 lds
    buffer_load_dwordx4 v3, s[8:11], s18 offen offset:1024 lds
    s_branch f_nr
f_str:
    s_and_b32 s42, s83, 31
    s_cmp_lg_u32 s42, 24
    s_cbranch_scc1 f_sb1
    v_add_u32 v84, 160768, v3
    s_mov_b64 exec, 0xff
    ds_read_b128 v[80:83], v84
    s_waitcnt lgkmcnt(0)
    buffer_store_dwordx4 v[80:83], v3, s[12:15], s63 offen sc1
    s_mov_b64 exec, -1
f_sb1:
    s_cmp_eq_u32 s42, 31
    s_cselect_b32 s42, 32768, 0
    s_add_u32 s42, s42, s71
    s_mov_b32 exec_lo, 0x000f000f
    s_mov_b32 exec_hi, 0x000f000f
    buffer_load_dwordx4 v[24:27], v7, s[12:15], s42 offen sc1
    s_add_u32 s83, s83, 1
    s_cmp_lt_u32 s83, 0x40000
    s_cbranch_scc1 f_st
    s_waitcnt vmcnt(0)
    s_mov_b64 exec, -1
    s_branch f_stx
f_pr:
    s_sleep 6
    v_mov_b32 v196, v8
    v_mov_b32 v197, v9
    v_mov_b32 v198, v10
    v_mov_b32 v199, v11
    s_mov_b64 exec, 0xf0ff
    buffer_load_dwordx4 v[236:239], v17, s[12:15], s77 offen sc1
    s_mov_b64 exec, s[52:53]
    buffer_load_dwordx4 v[196:199], v3, s[12:15], s76 offen sc1
    s_mov_b64 exec, -1
    buffer_load_dwordx4 v[192:195], v3, s[12:15], s65 offen sc1
    buffer_load_dwordx4 v[184:187], v3, s[12:15], s64 offen offset:0 sc1
    buffer_load_dwordx4 v[188:191], v3, s[12:15], s64 offen offset:1024 sc1
    s_waitcnt vmcnt(0)
    s_add_u32 s83, s83, 1
    s_cmp_lt_u32 s83, 0x40000
    s_cbranch_scc1 f_pv
    s_waitcnt vmcnt(0)
    s_branch f_pw
f_ps:
    s_sub_u32 s45, 5, s42
    v_ldexp_f32 v196, v196, s45
    v_ldexp_f32 v197, v197, s45
    v_ldexp_f32 v198, v198, s45
    v_ldexp_f32 v199, v199, s45
    v_and_b32 v248, 0x3f0, v235
    v_bfe_u32 v249, v235, 10, 1
    v_lshl_add_u32 v248, v249, 11, v248
    v_bfe_u32 v249, v235, 3, 1
    v_lshl_add_u32 v248, v249, 10, v248
    v_and_b32 v249, 6, v235
    v_lshl_add_u32 v248, v249, 1, v248
    v_cvt_f16_f32 v196, v196
    ds_write_b32 v248, v196 offset:0
    v_cvt_f16_f32 v197, v197
    ds_write_b32 v248, v197 offset:16
    v_cvt_f16_f32 v198, v198
    ds_write_b32 v248, v198 offset:32
    v_cvt_f16_f32 v199, v199
    ds_write_b32 v248, v199 offset:48
    s_branch f_pvx
f_qr:
    s_sleep 6
    buffer_load_dwordx4 v[184:187], v3, s[12:15], s64 offen offset:0 sc1
    buffer_load_dwordx4 v[188:191], v3, s[12:15], s64 offen offset:1024 sc1
    s_add_u32 s83, s83, 1
    s_cmp_lt_u32 s83, 0x40000
    s_cbranch_scc1 f_qv
    s_waitcnt vmcnt(0)
    s_branch f_pvx
f_go:
    s_lshl_b32 s41, s34, 7
    s_add_u32 s41, s41, 16842752
    v_mov_b32 v56, s32
    v_mov_b32 v57, s33
    s_mov_b64 exec, 0xff
    buffer_store_dwordx4 v[56:59], v3, s[12:15], s41 offen sc1
    s_mov_b64 exec, -1
    s_branch f_ngo
f_slow2:
    v_cvt_pk_bf16_f32 v40, v152, v153
    v_lshlrev_b32 v152, 16, v40
    v_and_b32 v153, 0xffff0000, v40
    v_cvt_pk_bf16_f32 v40, v154, v155
    v_lshlrev_b32 v154, 16, v40
    v_and_b32 v155, 0xffff0000, v40
    v_cvt_pk_bf16_f32 v40, v156, v157
    v_lshlrev_b32 v156, 16, v40
    v_and_b32 v157, 0xffff0000, v40
    v_cvt_pk_bf16_f32 v40, v158, v159
    v_lshlrev_b32 v158, 16, v40
    v_and_b32 v159, 0xffff0000, v40
    v_cvt_pk_bf16_f32 v40, v160, v161
    v_lshlrev_b32 v160, 16, v40
    v_and_b32 v161, 0xffff0000, v40
    v_cvt_pk_bf16_f32 v40, v162, v163
    v_lshlrev_b32 v162, 16, v40
    v_and_b32 v163, 0xffff0000, v40
    v_cvt_pk_bf16_f32 v40, v164, v165
    v_lshlrev_b32 v164, 16, v40
    v_and_b32 v165, 0xffff0000, v40
    v_cvt_pk_bf16_f32 v40, v166, v167
    v_lshlrev_b32 v166, 16, v40
    v_and_b32 v167, 0xffff0000, v40
    v_pk_add_f32 v[40:41], v[152:153], v[154:155]
    v_pk_add_f32 v[40:41], v[40:41], v[156:157]
    v_pk_add_f32 v[40:41], v[40:41], v[158:159]
    v_pk_add_f32 v[40:41], v[40:41], v[160:161]
    v_pk_add_f32 v[40:41], v[40:41], v[162:163]
    v_pk_add_f32 v[40:41], v[40:41], v[164:165]
    v_pk_add_f32 v[40:41], v[40:41], v[166:167]
    v_cvt_pk_bf16_f32 v48, v168, v169
    v_lshlrev_b32 v168, 16, v48
    v_and_b32 v169, 0xffff0000, v48
    v_cvt_pk_bf16_f32 v48, v170, v171
    v_lshlrev_b32 v170, 16, v48
    v_and_b32 v171, 0xffff0000, v48
    v_cvt_pk_bf16_f32 v48, v172, v173
    v_lshlrev_b32 v172, 16, v48
    v_and_b32 v173, 0xffff0000, v48
    v_cvt_pk_bf16_f32 v48, v174, v175
    v_lshlrev_b32 v174, 16, v48
    v_and_b32 v175, 0xffff0000, v48
    v_cvt_pk_bf16_f32 v48, v176, v177
    v_lshlrev_b32 v176, 16, v48
    v_and_b32 v177, 0xffff0000, v48
    v_cvt_pk_bf16_f32 v48, v178, v179
    v_lshlrev_b32 v178, 16, v48
    v_and_b32 v179, 0xffff0000, v48
    v_cvt_pk_bf16_f32 v48, v180, v181
    v_lshlrev_b32 v180, 16, v48
    v_and_b32 v181, 0xffff0000, v48
    v_cvt_pk_bf16_f32 v48, v182, v183
    v_lshlrev_b32 v182, 16, v48
    v_and_b32 v183, 0xffff0000, v48
    v_pk_add_f32 v[48:49], v[168:169], v[170:171]
    v_pk_add_f32 v[48:49], v[48:49], v[172:173]
    v_pk_add_f32 v[48:49], v[48:49], v[174:175]
    v_pk_add_f32 v[48:49], v[48:49], v[176:177]
    v_pk_add_f32 v[48:49], v[48:49], v[178:179]
    v_pk_add_f32 v[48:49], v[48:49], v[180:181]
    v_pk_add_f32 v[48:49], v[48:49], v[182:183]
    v_add_f32 v24, v40, v41
    v_add_f32 v28, v48, v49
    s_nop 1
    v_permlane32_swap_b32 v24, v28
    v_add_f32 v24, v24, v28
    s_nop 1
    v_add_f32_dpp v24, v24, v24 row_ror:8 row_mask:0xf bank_mask:0xf
    s_nop 1
    v_add_f32_dpp v24, v24, v24 row_ror:4 row_mask:0xf bank_mask:0xf
    s_nop 1
    v_add_f32_dpp v24, v24, v24 row_ror:2 row_mask:0xf bank_mask:0xf
    s_nop 1
    v_add_f32_dpp v24, v24, v24 row_ror:1 row_mask:0xf bank_mask:0xf
    s_nop 1
    v_add_f32_dpp v24, v24, v24 row_bcast:15 row_mask:0xa bank_mask:0xf
    v_mul_f32 v27, 0x3a800000, v24
    v_cvt_pk_bf16_f32 v24, v27, v27
    v_lshlrev_b32 v24, 16, v24
    v_sub_f32 v27, v27, v24
    v_readlane_b32 s56, v24, 31
    v_readlane_b32 s58, v24, 63
    s_nop 0
    v_pk_add_f32 v[56:57], v[152:153], s[56:57] op_sel:[0,0] op_sel_hi:[1,0] neg_lo:[0,1] neg_hi:[0,1]
    v_pk_add_f32 v[58:59], v[154:155], s[56:57] op_sel:[0,0] op_sel_hi:[1,0] neg_lo:[0,1] neg_hi:[0,1]
    v_pk_add_f32 v[60:61], v[156:157], s[56:57] op_sel:[0,0] op_sel_hi:[1,0] neg_lo:[0,1] neg_hi:[0,1]
    v_pk_add_f32 v[62:63], v[158:159], s[56:57] op_sel:[0,0] op_sel_hi:[1,0] neg_lo:[0,1] neg_hi:[0,1]
    v_pk_add_f32 v[64:65], v[160:161], s[56:57] op_sel:[0,0] op_sel_hi:[1,0] neg_lo:[0,1] neg_hi:[0,1]
    v_pk_add_f32 v[66:67], v[162:163], s[56:57] op_sel:[0,0] op_sel_hi:[1,0] neg_lo:[0,1] neg_hi:[0,1]
    v_pk_add_f32 v[68:69], v[164:165], s[56:57] op_sel:[0,0] op_sel_hi:[1,0] neg_lo:[0,1] neg_hi:[0,1]
    v_pk_add_f32 v[70:71], v[166:167], s[56:57] op_sel:[0,0] op_sel_hi:[1,0] neg_lo:[0,1] neg_hi:[0,1]
    v_pk_add_f32 v[72:73], v[168:169], s[58:59] op_sel:[0,0] op_sel_hi:[1,0] neg_lo:[0,1] neg_hi:[0,1]
    v_pk_add_f32 v[74:75], v[170:171], s[58:59] op_sel:[0,0] op_sel_hi:[1,0] neg_lo:[0,1] neg_hi:[0,1]
    v_pk_add_f32 v[76:77], v[172:173], s[58:59] op_sel:[0,0] op_sel_hi:[1,0] neg_lo:[0,1] neg_hi:[0,1]
    v_pk_add_f32 v[78:79], v[174:175], s[58:59] op_sel:[0,0] op_sel_hi:[1,0] neg_lo:[0,1] neg_hi:[0,1]
    v_pk_add_f32 v[80:81], v[176:177], s[58:59] op_sel:[0,0] op_sel_hi:[1,0] neg_lo:[0,1] neg_hi:[0,1]
    v_pk_add_f32 v[82:83], v[178:179], s[58:59] op_sel:[0,0] op_sel_hi:[1,0] neg_lo:[0,1] neg_hi:[0,1]
    v_pk_add_f32 v[84:85], v[180:181], s[58:59] op_sel:[0,0] op_sel_hi:[1,0] neg_lo:[0,1] neg_hi:[0,1]
    v_pk_add_f32 v[86:87], v[182:183], s[58:59] op_sel:[0,0] op_sel_hi:[1,0] neg_lo:[0,1] neg_hi:[0,1]
    v_mov_b32 v31, v30
    v_pk_mul_f32 v[42:43], v[70:71], v[70:71]
    v_pk_mul_f32 v[44:45], v[70:71], v[230:231]
    v_pk_mul_f32 v[50:51], v[86:87], v[86:87]
    v_pk_mul_f32 v[52:53], v[86:87], v[246:247]
    v_pk_fma_f32 v[42:43], v[68:69], v[68:69], v[42:43]
    v_pk_fma_f32 v[44:45], v[68:69], v[228:229], v[44:45]
    v_pk_fma_f32 v[50:51], v[84:85], v[84:85], v[50:51]
    v_pk_fma_f32 v[52:53], v[84:85], v[244:245], v[52:53]
    v_pk_fma_f32 v[42:43], v[66:67], v[66:67], v[42:43]
    v_pk_fma_f32 v[44:45], v[66:67], v[226:227], v[44:45]
    v_pk_fma_f32 v[50:51], v[82:83], v[82:83], v[50:51]
    v_pk_fma_f32 v[52:53], v[82:83], v[242:243], v[52:53]
    v_pk_fma_f32 v[42:43], v[64:65], v[64:65], v[42:43]
    v_pk_fma_f32 v[44:45], v[64:65], v[224:225], v[44:45]
    v_pk_fma_f32 v[50:51], v[80:81], v[80:81], v[50:51]
    v_pk_fma_f32 v[52:53], v[80:81], v[240:241], v[52:53]
    v_pk_fma_f32 v[42:43], v[62:63], v[62:63], v[42:43]
    v_pk_fma_f32 v[44:45], v[62:63], v[222:223], v[44:45]
    v_pk_fma_f32 v[50:51], v[78:79], v[78:79], v[50:51]
    v_pk_fma_f32 v[52:53], v[78:79], v[238:239], v[52:53]
    v_pk_fma_f32 v[42:43], v[60:61], v[60:61], v[42:43]
    v_pk_fma_f32 v[44:45], v[60:61], v[220:221], v[44:45]
    v_pk_fma_f32 v[50:51], v[76:77], v[76:77], v[50:51]
    v_pk_fma_f32 v[52:53], v[76:77], v[236:237], v[52:53]
    v_pk_fma_f32 v[42:43], v[58:59], v[58:59], v[42:43]
    v_pk_fma_f32 v[44:45], v[58:59], v[218:219], v[44:45]
    v_pk_fma_f32 v[50:51], v[74:75], v[74:75], v[50:51]
    v_pk_fma_f32 v[52:53], v[74:75], v[234:235], v[52:53]
    v_pk_fma_f32 v[42:43], v[56:57], v[56:57], v[42:43]
    v_pk_fma_f32 v[44:45], v[56:57], v[216:217], v[44:45]
    v_pk_fma_f32 v[50:51], v[72:73], v[72:73], v[50:51]
    v_pk_fma_f32 v[52:53], v[72:73], v[232:233], v[52:53]
    v_add_f32 v25, v42, v43
    v_add_f32 v26, v44, v45
    v_add_f32 v29, v50, v51
    v_add_f32 v30, v52, v53
    s_nop 0
    v_permlane32_swap_b32 v25, v29
    v_permlane32_swap_b32 v26, v30
    v_add_f32 v25, v25, v29
    v_add_f32 v26, v26, v30
    s_nop 0
    v_add_f32_dpp v25, v25, v25 row_ror:8 row_mask:0xf bank_mask:0xf
    v_add_f32_dpp v26, v26, v26 row_ror:8 row_mask:0xf bank_mask:0xf
    s_nop 0
    v_add_f32_dpp v25, v25, v25 row_ror:4 row_mask:0xf bank_mask:0xf
    v_add_f32_dpp v26, v26, v26 row_ror:4 row_mask:0xf bank_mask:0xf
    s_nop 0
    v_add_f32_dpp v25, v25, v25 row_ror:2 row_mask:0xf bank_mask:0xf
    v_add_f32_dpp v26, v26, v26 row_ror:2 row_mask:0xf bank_mask:0xf
    s_nop 0
    v_add_f32_dpp v25, v25, v25 row_ror:1 row_mask:0xf bank_mask:0xf
    v_add_f32_dpp v26, v26, v26 row_ror:1 row_mask:0xf bank_mask:0xf
    s_nop 0
    v_add_f32_dpp v25, v25, v25 row_bcast:15 row_mask:0xa bank_mask:0xf
    v_add_f32_dpp v26, v26, v26 row_bcast:15 row_mask:0xa bank_mask:0xf
    v_mul_f32 v25, 0x3a800000, v25
    v_fma_f32 v25, -v27, v27, v25
    v_max_f32 v25, 0, v25
    v_mov_b32 v30, v31
    s_branch f_var2
f_slowvar:
    v_lshlrev_b32 v118, 16, v117
    s_nop 0
    v_readlane_b32 s44, v118, 31
    v_readlane_b32 s46, v118, 63
    v_lshlrev_b32 v120, 16, v64
    v_and_b32 v121, 0xffff0000, v64
    v_pk_add_f32 v[120:121], v[120:121], s[44:45] op_sel_hi:[1,0]
    v_pk_mul_f32 v[122:123], v[120:121], v[120:121]
    v_lshlrev_b32 v120, 16, v65
    v_and_b32 v121, 0xffff0000, v65
    v_pk_add_f32 v[120:121], v[120:121], s[44:45] op_sel_hi:[1,0]
    v_pk_fma_f32 v[122:123], v[120:121], v[120:121], v[122:123]
    v_lshlrev_b32 v120, 16, v66
    v_and_b32 v121, 0xffff0000, v66
    v_pk_add_f32 v[120:121], v[120:121], s[44:45] op_sel_hi:[1,0]
    v_pk_fma_f32 v[122:123], v[120:121], v[120:121], v[122:123]
    v_lshlrev_b32 v120, 16, v67
    v_and_b32 v121, 0xffff0000, v67
    v_pk_add_f32 v[120:121], v[120:121], s[44:45] op_sel_hi:[1,0]
    v_pk_fma_f32 v[122:123], v[120:121], v[120:121], v[122:123]
    v_lshlrev_b32 v120, 16, v68
    v_and_b32 v121, 0xffff0000, v68
    v_pk_add_f32 v[120:121], v[120:121], s[44:45] op_sel_hi:[1,0]
    v_pk_fma_f32 v[122:123], v[120:121], v[120:121], v[122:123]
    v_lshlrev_b32 v120, 16, v69
    v_and_b32 v121, 0xffff0000, v69
    v_pk_add_f32 v[120:121], v[120:121], s[44:45] op_sel_hi:[1,0]
    v_pk_fma_f32 v[122:123], v[120:121], v[120:121], v[122:123]
    v_lshlrev_b32 v120, 16, v70
    v_and_b32 v121, 0xffff0000, v70
    v_pk_add_f32 v[120:121], v[120:121], s[44:45] op_sel_hi:[1,0]
    v_pk_fma_f32 v[122:123], v[120:121], v[120:121], v[122:123]
    v_lshlrev_b32 v120, 16, v71
    v_and_b32 v121, 0xffff0000, v71
    v_pk_add_f32 v[120:121], v[120:121], s[44:45] op_sel_hi:[1,0]
    v_pk_fma_f32 v[122:123], v[120:121], v[120:121], v[122:123]
    v_add_f32 v110, v122, v123
    v_lshlrev_b32 v120, 16, v72
    v_and_b32 v121, 0xffff0000, v72
    v_pk_add_f32 v[120:121], v[120:121], s[46:47] op_sel_hi:[1,0]
    v_pk_mul_f32 v[122:123], v[120:121], v[120:121]
    v_lshlrev_b32 v120, 16, v73
    v_and_b32 v121, 0xffff0000, v73
    v_pk_add_f32 v[120:121], v[120:121], s[46:47] op_sel_hi:[1,0]
    v_pk_fma_f32 v[122:123], v[120:121], v[120:121], v[122:123]
    v_lshlrev_b32 v120, 16, v74
    v_and_b32 v121, 0xffff0000, v74
    v_pk_add_f32 v[120:121], v[120:121], s[46:47] op_sel_hi:[1,0]
    v_pk_fma_f32 v[122:123], v[120:121], v[120:121], v[122:123]
    v_lshlrev_b32 v120, 16, v75
    v_and_b32 v121, 0xffff0000, v75
    v_pk_add_f32 v[120:121], v[120:121], s[46:47] op_sel_hi:[1,0]
    v_pk_fma_f32 v[122:123], v[120:121], v[120:121], v[122:123]
    v_lshlrev_b32 v120, 16, v76
    v_and_b32 v121, 0xffff0000, v76
    v_pk_add_f32 v[120:121], v[120:121], s[46:47] op_sel_hi:[1,0]
    v_pk_fma_f32 v[122:123], v[120:121], v[120:121], v[122:123]
    v_lshlrev_b32 v120, 16, v77
    v_and_b32 v121, 0xffff0000, v77
    v_pk_add_f32 v[120:121], v[120:121], s[46:47] op_sel_hi:[1,0]
    v_pk_fma_f32 v[122:123], v[120:121], v[120:121], v[122:123]
    v_lshlrev_b32 v120, 16, v78
    v_and_b32 v121, 0xffff0000, v78
    v_pk_add_f32 v[120:121], v[120:121], s[46:47] op_sel_hi:[1,0]
    v_pk_fma_f32 v[122:123], v[120:121], v[120:121], v[122:123]
    v_lshlrev_b32 v120, 16, v79
    v_and_b32 v121, 0xffff0000, v79
    v_pk_add_f32 v[120:121], v[120:121], s[46:47] op_sel_hi:[1,0]
    v_pk_fma_f32 v[122:123], v[120:121], v[120:121], v[122:123]
    v_add_f32 v111, v122, v123
    v_add_f32 v118, v118, v108
    s_nop 0
    v_permlane32_swap_b32 v110, v111
    v_add_f32 v110, v110, v111
    s_nop 1
    v_add_f32_dpp v110, v110, v110 row_ror:8 row_mask:0xf bank_mask:0xf
    s_nop 1
    v_add_f32_dpp v110, v110, v110 row_ror:4 row_mask:0xf bank_mask:0xf
    s_nop 1
    v_add_f32_dpp v110, v110, v110 row_ror:2 row_mask:0xf bank_mask:0xf
    s_nop 1
    v_add_f32_dpp v110, v110, v110 row_ror:1 row_mask:0xf bank_mask:0xf
    s_nop 1
    v_add_f32_dpp v110, v110, v110 row_bcast:15 row_mask:0xa bank_mask:0xf
    v_mul_f32 v110, s5, v110
    v_fma_f32 v110, -v118, v118, v110
    v_max_f32 v110, 0, v110
    s_branch f_var
f_sp:
    s_setprio 2
    ds_read_b128 v[56:59], v3 offset:0
    ds_read_b128 v[60:63], v3 offset:1024
    ds_read_b128 v[64:67], v3 offset:2048
    ds_read_b128 v[68:71], v3 offset:3072
    v_and_b32 v12, 31, v0
    v_lshlrev_b32 v12, 2, v12
    v_and_b32 v17, 32, v0
    v_lshl_add_u32 v12, v17, 4, v12
    v_sub_u32 v20, 4096, v12
    v_add_u32 v12, 4096, v12
    v_add_u32 v17, 128, v12
    v_add_u32 v21, 128, v20
    s_waitcnt lgkmcnt(3)
    v_pk_fma_f16 v40, v24, v248, v56 op_sel:[0,0,0] op_sel_hi:[1,0,1]
    v_pk_fma_f16 v41, v25, v248, v57 op_sel:[0,1,0] op_sel_hi:[1,1,1]
    v_pk_fma_f16 v42, v26, v249, v58 op_sel:[0,0,0] op_sel_hi:[1,0,1]
    v_pk_fma_f16 v43, v27, v249, v59 op_sel:[0,1,0] op_sel_hi:[1,1,1]
    ds_write2st64_b32 v12, v40, v42 offset0:0 offset1:1
    ds_write2st64_b32 v17, v41, v43 offset0:0 offset1:1
    s_waitcnt lgkmcnt(4)
    v_pk_fma_f16 v44, v28, v250, v60 op_sel:[0,0,0] op_sel_hi:[1,0,1]
    v_pk_fma_f16 v45, v29, v250, v61 op_sel:[0,1,0] op_sel_hi:[1,1,1]
    v_pk_fma_f16 v46, v30, v251, v62 op_sel:[0,0,0] op_sel_hi:[1,0,1]
    v_pk_fma_f16 v47, v31, v251, v63 op_sel:[0,1,0] op_sel_hi:[1,1,1]
    ds_write2st64_b32 v12, v44, v46 offset0:4 offset1:5
    ds_write2st64_b32 v17, v45, v47 offset0:4 offset1:5
    s_waitcnt lgkmcnt(5)
    v_pk_fma_f16 v48, v32, v252, v64 op_sel:[0,0,0] op_sel_hi:[1,0,1]
    v_pk_fma_f16 v49, v33, v252, v65 op_sel:[0,1,0] op_sel_hi:[1,1,1]
    v_pk_fma_f16 v50, v34, v253, v66 op_sel:[0,0,0] op_sel_hi:[1,0,1]
    v_pk_fma_f16 v51, v35, v253, v67 op_sel:[0,1,0] op_sel_hi:[1,1,1]
    ds_write2st64_b32 v12, v48, v50 offset0:8 offset1:9
    ds_write2st64_b32 v17, v49, v51 offset0:8 offset1:9
    s_waitcnt lgkmcnt(6)
    v_pk_fma_f16 v52, v36, v254, v68 op_sel:[0,0,0] op_sel_hi:[1,0,1]
    v_pk_fma_f16 v53, v37, v254, v69 op_sel:[0,1,0] op_sel_hi:[1,1,1]
    v_pk_fma_f16 v54, v38, v255, v70 op_sel:[0,0,0] op_sel_hi:[1,0,1]
    v_pk_fma_f16 v55, v39, v255, v71 op_sel:[0,1,0] op_sel_hi:[1,1,1]
    ds_write2st64_b32 v12, v52, v54 offset0:12 offset1:13
    ds_write2st64_b32 v17, v53, v55 offset0:12 offset1:13
    s_mov_b64 exec, 1
    ds_write_b32 v12, v40 offset:4096
    s_mov_b64 exec, -1
    ds_read2st64_b32 v[72:73], v20 offset0:16 offset1:15
    ds_read2st64_b32 v[74:75], v21 offset0:15 offset1:14
    ds_read2st64_b32 v[76:77], v20 offset0:12 offset1:11
    ds_read2st64_b32 v[78:79], v21 offset0:11 offset1:10
    ds_read2st64_b32 v[80:81], v20 offset0:8 offset1:7
    ds_read2st64_b32 v[82:83], v21 offset0:7 offset1:6
    ds_read2st64_b32 v[84:85], v20 offset0:4 offset1:3
    ds_read2st64_b32 v[86:87], v21 offset0:3 offset1:2
    s_waitcnt lgkmcnt(6)
    v_pk_add_f16 v40, v40, v72
    v_pk_add_f16 v41, v41, v74
    v_pk_add_f16 v42, v42, v73
    v_pk_add_f16 v43, v43, v75
    s_waitcnt lgkmcnt(4)
    v_pk_add_f16 v44, v44, v76
    v_pk_add_f16 v45, v45, v78
    v_pk_add_f16 v46, v46, v77
    v_pk_add_f16 v47, v47, v79
    s_waitcnt lgkmcnt(2)
    v_pk_add_f16 v48, v48, v80
    v_pk_add_f16 v49, v49, v82
    v_pk_add_f16 v50, v50, v81
    v_pk_add_f16 v51, v51, v83
    s_waitcnt lgkmcnt(0)
    v_pk_add_f16 v52, v52, v84
    v_pk_add_f16 v53, v53, v86
    v_pk_add_f16 v54, v54, v85
    v_pk_add_f16 v55, v55, v87
    v_mfma_f32_32x32x16_f16 v[56:71], v[40:43], v[88:91], 0
    v_mfma_f32_32x32x16_f16 v[72:87], v[40:43], v[104:107], 0
    v_mfma_f32_32x32x16_f16 v[56:71], v[44:47], v[92:95], v[56:71]
    v_mfma_f32_32x32x16_f16 v[72:87], v[44:47], v[108:111], v[72:87]
    s_branch f_st1
f_sp2:
    s_nop 9
    v_pk_mul_f32 v[24:25], v[56:57], v[120:121]
    v_pk_mul_f32 v[28:29], v[72:73], v[120:121]
    v_pk_mul_f32 v[26:27], v[58:59], v[122:123]
    v_pk_mul_f32 v[30:31], v[74:75], v[122:123]
    v_pk_fma_f32 v[24:25], v[72:73], v[136:137], v[24:25]
    v_pk_fma_f32 v[28:29], v[56:57], v[136:137], v[28:29] neg_lo:[1,0,0] neg_hi:[1,0,0]
    v_pk_fma_f32 v[26:27], v[74:75], v[138:139], v[26:27]
    v_pk_fma_f32 v[30:31], v[58:59], v[138:139], v[30:31] neg_lo:[1,0,0] neg_hi:[1,0,0]
    v_cvt_pk_f16_f32 v40, v24, v28
    v_cvt_pk_f16_f32 v41, v25, v29
    v_cvt_pk_f16_f32 v42, v26, v30
    v_cvt_pk_f16_f32 v43, v27, v31
    v_pk_mul_f32 v[32:33], v[60:61], v[124:125]
    v_pk_mul_f32 v[36:37], v[76:77], v[124:125]
    v_pk_mul_f32 v[34:35], v[62:63], v[126:127]
    v_pk_mul_f32 v[38:39], v[78:79], v[126:127]
    v_pk_fma_f32 v[32:33], v[76:77], v[140:141], v[32:33]
    v_pk_fma_f32 v[36:37], v[60:61], v[140:141], v[36:37] neg_lo:[1,0,0] neg_hi:[1,0,0]
    v_pk_fma_f32 v[34:35], v[78:79], v[142:143], v[34:35]
    v_pk_fma_f32 v[38:39], v[62:63], v[142:143], v[38:39] neg_lo:[1,0,0] neg_hi:[1,0,0]
    v_cvt_pk_f16_f32 v44, v32, v36
    v_cvt_pk_f16_f32 v45, v33, v37
    v_cvt_pk_f16_f32 v46, v34, v38
    v_cvt_pk_f16_f32 v47, v35, v39
    v_mfma_f32_32x32x16_f16 v[216:231], v[40:43], v[88:91], 0
    v_mfma_f32_32x32x16_f16 v[232:247], v[40:43], v[104:107], 0
    v_pk_mul_f32 v[24:25], v[64:65], v[128:129]
    v_pk_mul_f32 v[28:29], v[80:81], v[128:129]
    v_pk_mul_f32 v[26:27], v[66:67], v[130:131]
    v_pk_mul_f32 v[30:31], v[82:83], v[130:131]
    v_pk_fma_f32 v[24:25], v[80:81], v[144:145], v[24:25]
    v_pk_fma_f32 v[28:29], v[64:65], v[144:145], v[28:29] neg_lo:[1,0,0] neg_hi:[1,0,0]
    v_pk_fma_f32 v[26:27], v[82:83], v[146:147], v[26:27]
    v_pk_fma_f32 v[30:31], v[66:67], v[146:147], v[30:31] neg_lo:[1,0,0] neg_hi:[1,0,0]
    v_cvt_pk_f16_f32 v48, v24, v28
    v_cvt_pk_f16_f32 v49, v25, v29
    v_cvt_pk_f16_f32 v50, v26, v30
    v_cvt_pk_f16_f32 v51, v27, v31
    v_mfma_f32_32x32x16_f16 v[216:231], v[44:47], v[92:95], v[216:231]
    v_mfma_f32_32x32x16_f16 v[232:247], v[44:47], v[108:111], v[232:247]
    v_pk_mul_f32 v[32:33], v[68:69], v[132:133]
    v_pk_mul_f32 v[36:37], v[84:85], v[132:133]
    v_pk_mul_f32 v[34:35], v[70:71], v[134:135]
    v_pk_mul_f32 v[38:39], v[86:87], v[134:135]
    v_pk_fma_f32 v[32:33], v[84:85], v[148:149], v[32:33]
    v_pk_fma_f32 v[36:37], v[68:69], v[148:149], v[36:37] neg_lo:[1,0,0] neg_hi:[1,0,0]
    v_pk_fma_f32 v[34:35], v[86:87], v[150:151], v[34:35]
    v_pk_fma_f32 v[38:39], v[70:71], v[150:151], v[38:39] neg_lo:[1,0,0] neg_hi:[1,0,0]
    v_cvt_pk_f16_f32 v52, v32, v36
    v_cvt_pk_f16_f32 v53, v33, v37
    v_cvt_pk_f16_f32 v54, v34, v38
    v_cvt_pk_f16_f32 v55, v35, v39
    v_mfma_f32_32x32x16_f16 v[216:231], v[48:51], v[96:99], v[216:231]
    v_mfma_f32_32x32x16_f16 v[232:247], v[48:51], v[112:115], v[232:247]
    v_mfma_f32_32x32x16_f16 v[232:247], v[52:55], v[116:119], v[232:247]
    v_mfma_f32_32x32x16_f16 v[216:231], v[52:55], v[100:103], v[216:231]
    s_nop 10
    ds_bpermute_b32 v12, v19, v232
    s_waitcnt lgkmcnt(1)
    v_pk_fma_f32 v[152:153], v[184:185], v[216:217], v[152:153]
    v_pk_fma_f32 v[154:155], v[186:187], v[218:219], v[154:155]
    v_pk_fma_f32 v[156:157], v[188:189], v[220:221], v[156:157]
    v_pk_fma_f32 v[158:159], v[190:191], v[222:223], v[158:159]
    v_pk_fma_f32 v[160:161], v[192:193], v[224:225], v[160:161]
    v_pk_fma_f32 v[162:163], v[194:195], v[226:227], v[162:163]
    v_pk_fma_f32 v[164:165], v[196:197], v[228:229], v[164:165]
    v_pk_fma_f32 v[166:167], v[198:199], v[230:231], v[166:167]
    v_pk_fma_f32 v[170:171], v[202:203], v[234:235], v[170:171]
    v_pk_fma_f32 v[172:173], v[204:205], v[236:237], v[172:173]
    v_pk_fma_f32 v[174:175], v[206:207], v[238:239], v[174:175]
    v_pk_fma_f32 v[176:177], v[208:209], v[240:241], v[176:177]
    v_pk_fma_f32 v[178:179], v[210:211], v[242:243], v[178:179]
    v_pk_fma_f32 v[180:181], v[212:213], v[244:245], v[180:181]
    v_pk_fma_f32 v[182:183], v[214:215], v[246:247], v[182:183]
    v_fmac_f32 v169, v201, v233
    s_waitcnt lgkmcnt(0)
    v_fmac_f32 v168, v200, v12
    ds_read_b128 v[216:219], v3 offset:28672
    ds_read_b128 v[220:223], v3 offset:29696
    ds_read_b128 v[224:227], v3 offset:30720
    ds_read_b128 v[228:231], v3 offset:31744
    ds_read_b128 v[232:235], v3 offset:32768
    ds_read_b128 v[236:239], v3 offset:33792
    ds_read_b128 v[240:243], v3 offset:34816
    ds_read_b128 v[244:247], v3 offset:35840
    s_waitcnt lgkmcnt(0)
    s_setprio 0
    s_branch f_join
k_done:
    s_endpgm
code_end:
.p2align 8
.type tables,@object
tables:
.long 0x3c00,0x3c00,0x3c00,0x3c00,0x3c008000,0x3c008000,0x3c008000,0x3c008000
.long 0x3c00,0x361f3b64,0x39a839a8,0x3b64361f,0x3c008000,0x3b64b61f,0x39a8b9a8,0x361fbb64
.long 0x3c00,0x39a839a8,0x3c000000,0x39a8b9a8,0x3c008000,0x39a8b9a8,0xbc00,0xb9a8b9a8
.long 0x3c00,0x3b64361f,0x39a8b9a8,0xb61fbb64,0x3c008000,0x361fbb64,0xb9a8b9a8,0xbb64361f
.long 0x3c00,0x3c000000,0xbc00,0xbc008000,0x3c008000,0xbc00,0xbc008000,0x80003c00
.long 0x3c00,0x3b64b61f,0xb9a8b9a8,0xb61f3b64,0x3c008000,0xb61fbb64,0xb9a839a8,0x3b64361f
.long 0x3c00,0x39a8b9a8,0xbc008000,0x39a839a8,0x3c008000,0xb9a8b9a8,0x80003c00,0x39a8b9a8
.long 0x3c00,0x361fbb64,0xb9a839a8,0x3b64b61f,0x3c008000,0xbb64b61f,0x39a839a8,0xb61fbb64
.long 0x3c00,0x3c00,0x3c00,0x3c00,0x3c008000,0x3c008000,0x3c008000,0x3c008000
.long 0x39a8b9a8,0x361fbb64,0x3c000000,0x3b64b61f,0xb9a8b9a8,0xbb64b61f,0xbc00,0xb61fbb64
.long 0xbc008000,0xb9a839a8,0xbc00,0xb9a8b9a8,0x80003c00,0x39a839a8,0xbc008000,0xb9a839a8
.long 0x39a839a8,0x3b64b61f,0xbc008000,0xb61f3b64,0x39a8b9a8,0xb61fbb64,0x80003c00,0x3b64361f
.long 0xbc00,0xbc008000,0x3c00,0x3c000000,0xbc008000,0x80003c00,0x3c008000,0xbc00
.long 0xb9a839a8,0x3b64361f,0x3c000000,0xb61fbb64,0x39a839a8,0x361fbb64,0xbc00,0xbb64361f
.long 0x3c000000,0xb9a8b9a8,0xbc00,0xb9a839a8,0xbc00,0xb9a839a8,0xbc008000,0x39a839a8
.long 0xb9a8b9a8,0x361f3b64,0xbc008000,0x3b64361f,0xb9a839a8,0x3b64b61f,0x80003c00,0x361fbb64
.long 0x3c00,0x3c00,0x3c00,0x3c00,0x3c008000,0x3c008000,0x3c008000,0x3c008000
.long 0xbc00,0xb61fbb64,0xb9a8b9a8,0xbb64b61f,0xbc008000,0xbb64361f,0xb9a839a8,0xb61f3b64
.long 0x3c00,0x39a839a8,0x3c000000,0x39a8b9a8,0x3c008000,0x39a8b9a8,0xbc00,0xb9a8b9a8
.long 0xbc00,0xbb64b61f,0xb9a839a8,0x361f3b64,0xbc008000,0xb61f3b64,0x39a839a8,0x3b64b61f
.long 0x3c00,0x3c000000,0xbc00,0xbc008000,0x3c008000,0xbc00,0xbc008000,0x80003c00
.long 0xbc00,0xbb64361f,0x39a839a8,0x361fbb64,0xbc008000,0x361f3b64,0x39a8b9a8,0xbb64b61f
.long 0x3c00,0x39a8b9a8,0xbc008000,0x39a839a8,0x3c008000,0xb9a8b9a8,0x80003c00,0x39a8b9a8
.long 0xbc00,0xb61f3b64,0x39a8b9a8,0xbb64361f,0xbc008000,0x3b64361f,0xb9a8b9a8,0x361f3b64
.long 0x3c00,0x3c00,0x3c00,0x3c00,0x3c008000,0x3c008000,0x3c008000,0x3c008000
.long 0xb9a839a8,0xb61f3b64,0xbc008000,0xbb64361f,0x39a839a8,0x3b64361f,0x80003c00,0x361f3b64
.long 0xbc008000,0xb9a839a8,0xbc00,0xb9a8b9a8,0x80003c00,0x39a839a8,0xbc008000,0xb9a839a8
.long 0xb9a8b9a8,0xbb64361f,0x3c000000,0x361fbb64,0xb9a839a8,0x361f3b64,0xbc00,0xbb64b61f
.long 0xbc00,0xbc008000,0x3c00,0x3c000000,0xbc008000,0x80003c00,0x3c008000,0xbc00
.long 0x39a8b9a8,0xbb64b61f,0xbc008000,0x361f3b64,0xb9a8b9a8,0xb61f3b64,0x80003c00,0x3b64b61f
.long 0x3c000000,0xb9a8b9a8,0xbc00,0xb9a839a8,0xbc00,0xb9a839a8,0xbc008000,0x39a839a8
.long 0x39a839a8,0xb61fbb64,0x3c000000,0xbb64b61f,0x39a8b9a8,0xbb64361f,0xbc00,0xb61f3b64
.long 0x3c00,0xbc00,0x3c00,0xbc00,0x3c008000,0xbc008000,0x3c008000,0xbc008000
.long 0x3c00,0xb61fbb64,0x39a839a8,0xbb64b61f,0x3c008000,0xbb64361f,0x39a8b9a8,0xb61f3b64
.long 0x3c00,0xb9a8b9a8,0x3c000000,0xb9a839a8,0x3c008000,0xb9a839a8,0xbc00,0x39a839a8
.long 0x3c00,0xbb64b61f,0x39a8b9a8,0x361f3b64,0x3c008000,0xb61f3b64,0xb9a8b9a8,0x3b64b61f
.long 0x3c00,0xbc008000,0xbc00,0x3c000000,0x3c008000,0x80003c00,0xbc008000,0xbc00
.long 0x3c00,0xbb64361f,0xb9a8b9a8,0x361fbb64,0x3c008000,0x361f3b64,0xb9a839a8,0xbb64b61f
.long 0x3c00,0xb9a839a8,0xbc008000,0xb9a8b9a8,0x3c008000,0x39a839a8,0x80003c00,0xb9a839a8
.long 0x3c00,0xb61f3b64,0xb9a839a8,0xbb64361f,0x3c008000,0x3b64361f,0x39a839a8,0x361f3b64
.long 0x3c00,0xbc00,0x3c00,0xbc00,0x3c008000,0xbc008000,0x3c008000,0xbc008000
.long 0x39a8b9a8,0xb61f3b64,0x3c000000,0xbb64361f,0xb9a8b9a8,0x3b64361f,0xbc00,0x361f3b64
.long 0xbc008000,0x39a8b9a8,0xbc00,0x39a839a8,0x80003c00,0xb9a8b9a8,0xbc008000,0x39a8b9a8
.long 0x39a839a8,0xbb64361f,0xbc008000,0x361fbb64,0x39a8b9a8,0x361f3b64,0x80003c00,0xbb64b61f
.long 0xbc00,0x3c000000,0x3c00,0xbc008000,0xbc008000,0xbc00,0x3c008000,0x80003c00
.long 0xb9a839a8,0xbb64b61f,0x3c000000,0x361f3b64,0x39a839a8,0xb61f3b64,0xbc00,0x3b64b61f
.long 0x3c000000,0x39a839a8,0xbc00,0x39a8b9a8,0xbc00,0x39a8b9a8,0xbc008000,0xb9a8b9a8
.long 0xb9a8b9a8,0xb61fbb64,0xbc008000,0xbb64b61f,0xb9a839a8,0xbb64361f,0x80003c00,0xb61f3b64
.long 0x3c00,0xbc00,0x3c00,0xbc00,0x3c008000,0xbc008000,0x3c008000,0xbc008000
.long 0xbc00,0x361f3b64,0xb9a8b9a8,0x3b64361f,0xbc008000,0x3b64b61f,0xb9a839a8,0x361fbb64
.long 0x3c00,0xb9a8b9a8,0x3c000000,0xb9a839a8,0x3c008000,0xb9a839a8,0xbc00,0x39a839a8
.long 0xbc00,0x3b64361f,0xb9a839a8,0xb61fbb64,0xbc008000,0x361fbb64,0x39a839a8,0xbb64361f
.long 0x3c00,0xbc008000,0xbc00,0x3c000000,0x3c008000,0x80003c00,0xbc008000,0xbc00
.long 0xbc00,0x3b64b61f,0x39a839a8,0xb61f3b64,0xbc008000,0xb61fbb64,0x39a8b9a8,0x3b64361f
.long 0x3c00,0xb9a839a8,0xbc008000,0xb9a8b9a8,0x3c008000,0x39a839a8,0x80003c00,0xb9a839a8
.long 0xbc00,0x361fbb64,0x39a8b9a8,0x3b64b61f,0xbc008000,0xbb64b61f,0xb9a8b9a8,0xb61fbb64
.long 0x3c00,0xbc00,0x3c00,0xbc00,0x3c008000,0xbc008000,0x3c008000,0xbc008000
.long 0xb9a839a8,0x361fbb64,0xbc008000,0x3b64b61f,0x39a839a8,0xbb64b61f,0x80003c00,0xb61fbb64
.long 0xbc008000,0x39a8b9a8,0xbc00,0x39a839a8,0x80003c00,0xb9a8b9a8,0xbc008000,0x39a8b9a8
.long 0xb9a8b9a8,0x3b64b61f,0x3c000000,0xb61f3b64,0xb9a839a8,0xb61fbb64,0xbc00,0x3b64361f
.long 0xbc00,0x3c000000,0x3c00,0xbc008000,0xbc008000,0xbc00,0x3c008000,0x80003c00
.long 0x39a8b9a8,0x3b64361f,0xbc008000,0xb61fbb64,0xb9a8b9a8,0x361fbb64,0x80003c00,0xbb64361f
.long 0x3c000000,0x39a839a8,0xbc00,0x39a8b9a8,0xbc00,0x39a8b9a8,0xbc008000,0xb9a8b9a8
.long 0x39a839a8,0x361f3b64,0x3c000000,0x3b64361f,0x39a8b9a8,0x3b64b61f,0xbc00,0x361fbb64
.long 0x3c00,0x3c00,0x3c00,0x3c00,0x3c00,0xbc00,0x3c00,0xbc00
.long 0x3c00,0x3b64,0x39a8,0x361f,0x8000,0xb61f,0xb9a8,0xbb64
.long 0x3c00,0x39a8,0x0,0xb9a8,0x8000,0xb9a8,0xbc00,0xb9a8
.long 0x3c00,0x361f,0xb9a8,0xbb64,0x8000,0xbb64,0xb9a8,0x361f
.long 0x3c00,0x0,0xbc00,0x8000,0x8000,0xbc00,0x8000,0x3c00
.long 0x3c00,0xb61f,0xb9a8,0x3b64,0x8000,0xbb64,0x39a8,0x361f
.long 0x3c00,0xb9a8,0x8000,0x39a8,0x8000,0xb9a8,0x3c00,0xb9a8
.long 0x3c00,0xbb64,0x39a8,0xb61f,0x8000,0xb61f,0x39a8,0xbb64
.long 0x3c00,0x3c00,0x3c00,0x3c00,0x3c00,0xbc00,0x3c00,0xbc00
.long 0xb9a8,0xbb64,0x0,0xb61f,0xb9a8,0xb61f,0xbc00,0xbb64
.long 0x8000,0x39a8,0xbc00,0xb9a8,0x3c00,0x39a8,0x8000,0x39a8
.long 0x39a8,0xb61f,0x8000,0x3b64,0xb9a8,0xbb64,0x3c00,0x361f
.long 0xbc00,0x8000,0x3c00,0x0,0x8000,0x3c00,0x8000,0xbc00
.long 0x39a8,0x361f,0x0,0xbb64,0x39a8,0xbb64,0xbc00,0x361f
.long 0x0,0xb9a8,0xbc00,0x39a8,0xbc00,0x39a8,0x8000,0x39a8
.long 0xb9a8,0x3b64,0x8000,0x361f,0x39a8,0xb61f,0x3c00,0xbb64
.long 0x3c00,0x3c00,0x3c00,0x3c00,0x3c00,0xbc00,0x3c00,0xbc00
.long 0xbc00,0xbb64,0xb9a8,0xb61f,0x8000,0x361f,0x39a8,0x3b64
.long 0x3c00,0x39a8,0x0,0xb9a8,0x8000,0xb9a8,0xbc00,0xb9a8
.long 0xbc00,0xb61f,0x39a8,0x3b64,0x8000,0x3b64,0x39a8,0xb61f
.long 0x3c00,0x0,0xbc00,0x8000,0x8000,0xbc00,0x8000,0x3c00
.long 0xbc00,0x361f,0x39a8,0xbb64,0x8000,0x3b64,0xb9a8,0xb61f
.long 0x3c00,0xb9a8,0x8000,0x39a8,0x8000,0xb9a8,0x3c00,0xb9a8
.long 0xbc00,0x3b64,0xb9a8,0x361f,0x8000,0x361f,0xb9a8,0x3b64
.long 0x3c00,0x3c00,0x3c00,0x3c00,0x3c00,0xbc00,0x3c00,0xbc00
.long 0x39a8,0x3b64,0x8000,0x361f,0x39a8,0x361f,0x3c00,0x3b64
.long 0x8000,0x39a8,0xbc00,0xb9a8,0x3c00,0x39a8,0x8000,0x39a8
.long 0xb9a8,0x361f,0x0,0xbb64,0x39a8,0x3b64,0xbc00,0xb61f
.long 0xbc00,0x8000,0x3c00,0x0,0x8000,0x3c00,0x8000,0xbc00
.long 0xb9a8,0xb61f,0x8000,0x3b64,0xb9a8,0x3b64,0x3c00,0xb61f
.long 0x0,0xb9a8,0xbc00,0x39a8,0xbc00,0x39a8,0x8000,0x39a8
.long 0x39a8,0xbb64,0x0,0xb61f,0xb9a8,0x361f,0xbc00,0x3b64
.long 0x3c000000,0x3bd90000,0x3b640000,0x3aa70000,0x80000000,0xb23e0000,0xb61f0000,0xb8720000
.long 0x3c000000,0x3aa70000,0x361f0000,0xb23e0000,0x80000000,0xb8720000,0xbb640000,0xbbd90000
.long 0x3c000000,0x38720000,0xb61f0000,0xbbd90000,0x80000000,0xbaa70000,0xbb640000,0xb23e0000
.long 0x3c000000,0x323e0000,0xbb640000,0xb8720000,0x80000000,0xbbd90000,0xb61f0000,0x3aa70000
.long 0x3c000000,0xb23e0000,0xbb640000,0x38720000,0x80000000,0xbbd90000,0x361f0000,0x3aa70000
.long 0x3c000000,0xb8720000,0xb61f0000,0x3bd90000,0x80000000,0xbaa70000,0x3b640000,0xb23e0000
.long 0x3c000000,0xbaa70000,0x361f0000,0x323e0000,0x80000000,0xb8720000,0x3b640000,0xbbd90000
.long 0x3c000000,0xbbd90000,0x3b640000,0xbaa70000,0x80000000,0xb23e0000,0x361f0000,0xb8720000
.long 0x361f0000,0x323e0000,0x39a80000,0x38720000,0xbb640000,0xbbd90000,0xb9a80000,0xbaa70000
.long 0xbb640000,0xb8720000,0xb9a80000,0xbbd90000,0x361f0000,0x3aa70000,0xb9a80000,0xb23e0000
.long 0x3b640000,0x3aa70000,0xb9a80000,0x323e0000,0x361f0000,0xb8720000,0x39a80000,0x3bd90000
.long 0xb61f0000,0xbbd90000,0x39a80000,0x3aa70000,0xbb640000,0x323e0000,0x39a80000,0xb8720000
.long 0xb61f0000,0x3bd90000,0x39a80000,0xbaa70000,0x3b640000,0x323e0000,0xb9a80000,0xb8720000
.long 0x3b640000,0xbaa70000,0xb9a80000,0xb23e0000,0xb61f0000,0xb8720000,0xb9a80000,0x3bd90000
.long 0xbb640000,0x38720000,0xb9a80000,0x3bd90000,0xb61f0000,0x3aa70000,0x39a80000,0xb23e0000
.long 0x361f0000,0xb23e0000,0x39a80000,0xb8720000,0x3b640000,0xbbd90000,0x39a80000,0xbaa70000
.long 0x0,0xb23e0000,0xb61f0000,0xb8720000,0xbc000000,0xbbd90000,0xbb640000,0xbaa70000
.long 0x80000000,0x38720000,0x3b640000,0x3bd90000,0x3c000000,0x3aa70000,0x361f0000,0xb23e0000
.long 0x0,0xbaa70000,0xbb640000,0xb23e0000,0xbc000000,0xb8720000,0x361f0000,0x3bd90000
.long 0x80000000,0x3bd90000,0x361f0000,0xbaa70000,0x3c000000,0x323e0000,0xbb640000,0xb8720000
.long 0x0,0xbbd90000,0x361f0000,0x3aa70000,0xbc000000,0x323e0000,0x3b640000,0xb8720000
.long 0x80000000,0x3aa70000,0xbb640000,0x323e0000,0x3c000000,0xb8720000,0xb61f0000,0x3bd90000
.long 0x80000000,0xb8720000,0x3b640000,0xbbd90000,0xbc000000,0x3aa70000,0xb61f0000,0xb23e0000
.long 0x80000000,0x323e0000,0xb61f0000,0x38720000,0x3c000000,0xbbd90000,0x3b640000,0xbaa70000
.long 0xbb640000,0xbbd90000,0xb9a80000,0xbaa70000,0xb61f0000,0xb23e0000,0xb9a80000,0xb8720000
.long 0xb61f0000,0xbaa70000,0x39a80000,0x323e0000,0xbb640000,0xb8720000,0xb9a80000,0xbbd90000
.long 0x361f0000,0xb8720000,0x39a80000,0x3bd90000,0xbb640000,0xbaa70000,0x39a80000,0xb23e0000
.long 0x3b640000,0xb23e0000,0xb9a80000,0x38720000,0xb61f0000,0xbbd90000,0x39a80000,0x3aa70000
.long 0x3b640000,0x323e0000,0xb9a80000,0xb8720000,0x361f0000,0xbbd90000,0xb9a80000,0x3aa70000
.long 0x361f0000,0x38720000,0x39a80000,0xbbd90000,0x3b640000,0xbaa70000,0xb9a80000,0xb23e0000
.long 0xb61f0000,0x3aa70000,0x39a80000,0xb23e0000,0x3b640000,0xb8720000,0x39a80000,0xbbd90000
.long 0xbb640000,0x3bd90000,0xb9a80000,0x3aa70000,0x361f0000,0xb23e0000,0x39a80000,0xb8720000
.size tables, 4096
all_end:
.section .rodata,"a"
.p2align 6
.amdhsa_kernel adaLN_cond__spectral_fnet__moe_arch_mod__prompt_kernel
  .amdhsa_next_free_vgpr 256
  .amdhsa_next_free_sgpr 84
  .amdhsa_accum_offset 256
  .amdhsa_group_segment_fixed_size 0
  .amdhsa_kernarg_size 120
  .amdhsa_user_sgpr_count 2
  .amdhsa_user_sgpr_kernarg_segment_ptr 1
  .amdhsa_system_sgpr_workgroup_id_x 1
  .amdhsa_float_denorm_mode_32 3
  .amdhsa_float_denorm_mode_16_64 3
.end_amdhsa_kernel
```

```asm
; @launch grid=(256,1,1) block=(512,1,1) lds=163840
.amdgcn_target "amdgcn-amd-amdhsa--gfx950"
.text
.globl adaLN_cond__spectral_fnet__moe_arch_mod__prompt_kernel
.p2align 8
.type adaLN_cond__spectral_fnet__moe_arch_mod__prompt_kernel,@function
adaLN_cond__spectral_fnet__moe_arch_mod__prompt_kernel:
    s_cmp_ge_u32 s2, 256
    s_cbranch_scc1 k_done
    s_load_dwordx2 s[4:5], s[0:1], 0
    s_load_dwordx4 s[24:27], s[0:1], 96
    s_load_dwordx2 s[6:7], s[0:1], 112
    s_load_dwordx4 s[56:59], s[0:1], 80
    s_load_dwordx4 s[48:51], s[0:1], 48
    s_load_dwordx4 s[52:55], s[0:1], 64
    s_memrealtime s[32:33]
    v_lshrrev_b32 v1, 6, v0
    v_and_b32 v2, 63, v0
    v_readfirstlane_b32 s16, v1
    v_lshlrev_b32 v3, 4, v2
    v_mov_b32 v4, 0
    s_getpc_b64 s[36:37]
h_pc:
    s_and_b32 s34, s2, 7
    s_bfe_u32 s35, s2, 0x40003
    s_cmp_lg_u32 s16, 7
    s_cbranch_scc1 h_npf
    s_lshr_b32 s42, s2, 3
    s_lshl_b32 s42, s42, 11
    v_lshl_add_u32 v4, v2, 7, s42
    v_min_u32 v4, all_end-h_pc-4, v4
    s_mov_b64 exec, 0xffff
    global_load_dword v199, v4, s[36:37]
    s_mov_b64 exec, -1
h_npf:
    s_mov_b32 s11, 0x00020000
    s_mov_b32 s14, 268435456
    s_mov_b32 s15, 0x00020000
    s_bitcmp0_b32 s2, 7
    s_cbranch_scc1 g_start
    s_lshl_b32 s60, s16, 19
    s_lshl_b32 s61, s35, 15
    s_add_u32 s60, s60, s61
    s_lshl_b32 s61, s34, 11
    s_add_u32 s60, s60, s61
    s_add_u32 s61, s60, 16384
    s_lshl_b32 s62, s34, 11
    s_lshl_b32 s63, s35, 7
    s_add_u32 s62, s62, s63
    s_add_u32 s63, s62, 16809984
    s_lshl_b32 s42, s16, 4
    s_add_u32 s62, s62, s42
    s_add_u32 s62, s62, 16777216
    v_mov_b32 v116, 0
    s_mov_b32 s10, 4194304
    s_waitcnt lgkmcnt(0)
    s_mov_b32 s8, s4
    s_mov_b32 s9, s5
    s_mov_b32 s12, s6
    s_mov_b32 s13, s7
    buffer_load_dwordx4 v[64:67], v3, s[8:11], s60 offen offset:0
    buffer_load_dwordx4 v[72:75], v3, s[8:11], s61 offen offset:0
    buffer_load_dwordx4 v[68:71], v3, s[8:11], s60 offen offset:1024
    buffer_load_dwordx4 v[76:79], v3, s[8:11], s61 offen offset:1024
    s_mov_b64 exec, 1
    buffer_load_dword v215, v116, s[12:15], s62 offen sc1
    s_mov_b64 exec, -1
    s_branch f_start
h_non:
    s_mul_i32 s42, s32, 0x9e3779b1
    s_lshr_b32 s43, s42, 15
    s_xor_b32 s42, s42, s43
    s_mul_i32 s42, s42, 0x85ebca6b
    s_xor_b32 s33, s33, s42
    s_lshr_b32 s43, s42, 13
    s_xor_b32 s42, s42, s43
    s_mul_i32 s33, s33, 0xc2b2ae35
    s_add_u32 s33, s33, s32
    s_lshr_b32 s43, s33, 16
    s_xor_b32 s33, s33, s43
    s_mul_i32 s33, s33, 0x27d4eb2f
    s_or_b32 s32, s42, 1
    s_andn2_b32 s33, s33, 7
    v_mov_b32 v10, s32
    v_mov_b32 v11, s33
    v_lshlrev_b32 v12, 3, v2
    s_mov_b32 exec_hi, 0
    global_store_dwordx2 v12, v[10:11], s[26:27] sc1
    s_mov_b32 exec_hi, -1
    s_branch h_nonx
g_start:
    s_or_b32 s40, s2, s16
    s_xor_b32 s16, s16, 4
    v_xor_b32 v1, 4, v1
    v_xor_b32 v0, 0x100, v0
    v_lshlrev_b32 v13, 2, v2
    v_mov_b32 v220, 0
    v_mov_b32 v221, 0
    v_mov_b32 v233, 0
    v_mov_b32 v234, 0
    v_mov_b32 v235, 0
    s_cmp_lt_u32 s16, 4
    s_cbranch_scc1 g_cons
g_load:
    s_and_b32 s69, s16, 3
    s_and_b32 s42, s16, 1
    s_lshl_b32 s42, s42, 7
    v_xor_b32 v6, s42, v3
    v_xor_b32 v7, 32, v6
    v_xor_b32 v8, 64, v6
    v_xor_b32 v9, 96, v6
    s_lshl_b32 s41, s35, 3
    s_add_u32 s41, s41, s69
    s_mul_i32 s18, s41, 98304
    s_lshl_b32 s41, s34, 10
    s_cmp_ge_u32 s34, 6
    s_cselect_b32 s42, 2048, 0
    s_add_u32 s18, s18, s41
    s_add_u32 s18, s18, s42
    s_lshl_b32 s68, s69, 13
    s_mov_b32 s10, 12582912
    s_waitcnt lgkmcnt(0)
    s_mov_b32 s8, s58
    s_mov_b32 s9, s59
    s_mov_b32 s12, s6
    s_mov_b32 s13, s7
    s_cmp_eq_u32 s40, 0
    s_cbranch_scc1 h_non
h_nonx:
    s_lshl_b32 s42, s69, 7
    s_add_u32 s42, s42, 139264
    s_mov_b32 m0, s42
    s_lshl_b32 s42, s35, 7
    v_add_u32 v10, s42, v13
    s_mov_b32 exec_hi, 0
    global_load_lds_dword v10, s[56:57]
    s_mov_b32 exec_hi, -1
    s_add_u32 s43, s68, 32768
    s_mov_b32 m0, s43
    s_add_u32 s42, s18, 0
    buffer_load_dwordx4 v6, s[8:11], s42 offen nt lds
    s_add_u32 s43, s68, 33792
    s_mov_b32 m0, s43
    s_add_u32 s42, s18, 12288
    buffer_load_dwordx4 v7, s[8:11], s42 offen nt lds
    s_add_u32 s43, s68, 34816
    s_mov_b32 m0, s43
    s_add_u32 s42, s18, 24576
    buffer_load_dwordx4 v8, s[8:11], s42 offen nt lds
    s_add_u32 s43, s68, 35840
    s_mov_b32 m0, s43
    s_add_u32 s42, s18, 36864
    buffer_load_dwordx4 v9, s[8:11], s42 offen nt lds
    s_add_u32 s43, s68, 36864
    s_mov_b32 m0, s43
    s_add_u32 s42, s18, 49152
    buffer_load_dwordx4 v6, s[8:11], s42 offen nt lds
    s_add_u32 s43, s68, 37888
    s_mov_b32 m0, s43
    s_add_u32 s42, s18, 61440
    buffer_load_dwordx4 v7, s[8:11], s42 offen nt lds
    s_add_u32 s43, s68, 38912
    s_mov_b32 m0, s43
    s_add_u32 s42, s18, 73728
    buffer_load_dwordx4 v8, s[8:11], s42 offen nt lds
    s_add_u32 s43, s68, 39936
    s_mov_b32 m0, s43
    s_add_u32 s42, s18, 86016
    buffer_load_dwordx4 v9, s[8:11], s42 offen nt lds
    s_lshl_b32 s19, s35, 2
    s_add_u32 s19, s19, s69
    s_mul_i32 s19, s19, 196608
    s_lshl_b32 s42, s34, 9
    s_add_u32 s19, s19, s42
    s_and_b32 s42, s34, 4
    s_lshl_b32 s42, s42, 9
    s_add_u32 s19, s19, s42
    s_add_u32 s19, s19, 6144
    v_lshrrev_b32 v5, 5, v2
    v_and_b32 v14, 0x1f0, v3
    v_lshlrev_b32 v12, 5, v5
    v_xor_b32 v14, v14, v12
    s_movk_i32 s42, 12288
    v_mad_u32_u24 v14, v5, s42, v14
    v_bfe_u32 v5, v0, 5, 1
    v_lshlrev_b32 v5, 3, v5
    v_bfe_u32 v12, v0, 3, 2
    v_add_u32 v5, v5, v12
    v_bfe_u32 v12, v0, 4, 2
    v_lshlrev_b32 v12, 1, v12
    v_xor_b32 v12, v12, v0
    v_and_b32 v12, 7, v12
    v_lshlrev_b32 v12, 4, v12
    s_movk_i32 s42, 7168
    v_mad_u32_u24 v5, v5, s42, v12
    s_mov_b32 s20, s26
    s_mov_b32 s21, s27
    s_mov_b32 s26, 4194304
    s_mov_b32 s27, 0x00020000
    s_and_b32 s65, s35, 1
    s_lshr_b32 s40, s35, 1
    s_mul_i32 s64, s34, 7
    s_add_u32 s64, s64, s40
    s_lshl_b32 s41, s34, 1
    s_add_u32 s41, s41, s65
    s_cmp_ge_u32 s35, 14
    s_cselect_b32 s66, 1, 0
    s_cselect_b32 s64, s41, s64
    v_lshrrev_b32 v10, 2, v2
    v_and_b32 v15, 3, v0
    v_bfe_u32 v11, v0, 3, 2
    v_xor_b32 v12, v11, v1
    v_and_b32 v12, 3, v12
    v_lshlrev_b32 v12, 5, v12
    v_lshl_add_u32 v12, v10, 7, v12
    v_lshl_add_u32 v12, v15, 3, v12
    v_lshrrev_b32 v16, 2, v1
    v_lshl_add_u32 v12, v16, 15, v12
    v_add_u32 v21, 65536, v12
    s_lshl_b32 s67, s65, 3
    s_add_u32 s67, s67, s69
    s_mul_i32 s67, s67, 458752
    s_lshl_b32 s42, s64, 7
    s_add_u32 s67, s67, s42
    s_mov_b32 s56, s50
    s_mov_b32 s57, s51
    s_mov_b32 s58, 7340032
    s_mov_b32 s59, 0x00020000
    s_mov_b32 s44, s52
    s_mov_b32 s45, s53
    s_mov_b32 s46, 7340032
    s_mov_b32 s47, 0x00020000
    s_waitcnt vmcnt(7)
    s_add_u32 s43, s68, 65536
    s_mov_b32 m0, s43
    s_add_u32 s42, s18, 393216
    buffer_load_dwordx4 v6, s[8:11], s42 offen nt lds
    s_waitcnt vmcnt(7)
    s_add_u32 s43, s68, 66560
    s_mov_b32 m0, s43
    s_add_u32 s42, s18, 405504
    buffer_load_dwordx4 v7, s[8:11], s42 offen nt lds
    s_load_dwordx2 s[32:33], s[20:21], 128
    s_waitcnt vmcnt(7)
    s_add_u32 s43, s68, 67584
    s_mov_b32 m0, s43
    s_add_u32 s42, s18, 417792
    buffer_load_dwordx4 v8, s[8:11], s42 offen nt lds
    s_waitcnt vmcnt(7)
    s_add_u32 s43, s68, 68608
    s_mov_b32 m0, s43
    s_add_u32 s42, s18, 430080
    buffer_load_dwordx4 v9, s[8:11], s42 offen nt lds
    s_waitcnt vmcnt(7)
    s_add_u32 s43, s68, 69632
    s_mov_b32 m0, s43
    s_add_u32 s42, s18, 442368
    buffer_load_dwordx4 v6, s[8:11], s42 offen nt lds
    s_waitcnt vmcnt(7)
    s_add_u32 s43, s68, 70656
    s_mov_b32 m0, s43
    s_add_u32 s42, s18, 454656
    buffer_load_dwordx4 v7, s[8:11], s42 offen nt lds
    s_waitcnt vmcnt(7)
    s_add_u32 s43, s68, 71680
    s_mov_b32 m0, s43
    s_add_u32 s42, s18, 466944
    buffer_load_dwordx4 v8, s[8:11], s42 offen nt lds
    s_waitcnt vmcnt(7)
    s_barrier
    s_add_u32 s43, s68, 72704
    s_mov_b32 m0, s43
    s_add_u32 s42, s18, 479232
    buffer_load_dwordx4 v9, s[8:11], s42 offen nt lds
    s_waitcnt lgkmcnt(0)
    s_cmp_lg_u32 s32, 0
    s_cbranch_scc1 g_n2x
    s_load_dwordx2 s[32:33], s[20:21], 192
    s_mov_b32 s83, 0
    v_mov_b32 v122, 0
    s_waitcnt lgkmcnt(0)
g_n2:
    s_cmp_lg_u32 s32, 0
    s_cbranch_scc1 g_n2x
    global_load_dwordx2 v[120:121], v122, s[20:21] sc1
    s_waitcnt vmcnt(0)
    v_readfirstlane_b32 s32, v120
    v_readfirstlane_b32 s33, v121
    s_add_u32 s83, s83, 1
    s_cmp_lt_u32 s83, 0x40000
    s_cbranch_scc1 g_n2
g_n2x:
    s_cmp_eq_u32 s66, 0
    s_cbranch_scc1 m_load
    v_mov_b32 v216, s32
    v_mov_b32 v217, s33
    v_and_b32 v218, 1, v0
    v_cmp_eq_u32 vcc, 1, v218
    s_nop 1
    v_cndmask_b32 v216, v216, v217, vcc
    v_bfe_u32 v217, v216, 8, 8
    v_bfe_u32 v218, v216, 16, 8
    v_lshrrev_b32 v219, 24, v216
    v_and_b32 v216, 0xff, v216
    s_lshl_b32 s81, s34, 16
    s_lshl_b32 s42, s16, 13
    s_add_u32 s81, s81, s42
    s_add_u32 s81, s81, 19922944
    s_lshl_b32 s42, s65, 9
    s_add_u32 s80, s81, s42
    s_add_u32 s81, s80, s42
    v_lshlrev_b32 v222, 4, v0
    v_lshrrev_b32 v223, 5, v2
    v_and_b32 v24, 0x1f0, v3
    v_lshl_add_u32 v223, v223, 12, v24
    s_lshl_b32 s39, s34, 4
    s_add_u32 s39, s39, s35
    s_lshl_b32 s39, s39, 12
    s_add_u32 s39, s39, 19922944
    s_bitcmp1_b32 s64, 2
    s_cselect_b32 s28, 1.0, 0
    s_waitcnt vmcnt(0)
    s_barrier
    s_branch x_start
m_load:
    s_waitcnt vmcnt(7)
    v_xor_b32 v4, 0, v14
    s_add_u32 s43, s68, 98304
    s_mov_b32 m0, s43
    s_add_u32 s42, s19, 0
    buffer_load_dwordx4 v4, s[8:11], s42 offen nt lds
    s_waitcnt vmcnt(7)
    v_xor_b32 v4, 64, v14
    s_add_u32 s43, s68, 99328
    s_mov_b32 m0, s43
    s_add_u32 s42, s19, 24576
    buffer_load_dwordx4 v4, s[8:11], s42 offen nt lds
    s_waitcnt vmcnt(7)
    v_xor_b32 v4, 0, v14
    s_add_u32 s43, s68, 100352
    s_mov_b32 m0, s43
    s_add_u32 s42, s19, 49152
    buffer_load_dwordx4 v4, s[8:11], s42 offen nt lds
    s_waitcnt vmcnt(7)
    v_xor_b32 v4, 64, v14
    s_add_u32 s43, s68, 101376
    s_mov_b32 m0, s43
    s_add_u32 s42, s19, 73728
    buffer_load_dwordx4 v4, s[8:11], s42 offen nt lds
    s_waitcnt vmcnt(4)
    s_barrier
    s_barrier
    s_waitcnt vmcnt(7)
    v_xor_b32 v4, 128, v14
    s_add_u32 s43, s68, 102400
    s_mov_b32 m0, s43
    s_add_u32 s42, s19, 98304
    buffer_load_dwordx4 v4, s[8:11], s42 offen nt lds
    s_waitcnt vmcnt(7)
    v_xor_b32 v4, 192, v14
    s_add_u32 s43, s68, 103424
    s_mov_b32 m0, s43
    s_add_u32 s42, s19, 122880
    buffer_load_dwordx4 v4, s[8:11], s42 offen nt lds
    s_waitcnt vmcnt(7)
    v_xor_b32 v4, 128, v14
    s_add_u32 s43, s68, 104448
    s_mov_b32 m0, s43
    s_add_u32 s42, s19, 147456
    buffer_load_dwordx4 v4, s[8:11], s42 offen nt lds
    s_waitcnt vmcnt(7)
    v_xor_b32 v4, 192, v14
    s_add_u32 s43, s68, 105472
    s_mov_b32 m0, s43
    s_add_u32 s42, s19, 172032
    buffer_load_dwordx4 v4, s[8:11], s42 offen nt lds
    s_waitcnt vmcnt(7)
    s_add_u32 s43, s68, 0
    s_mov_b32 m0, s43
    s_add_u32 s42, s67, 0
    buffer_load_dwordx4 v5, s[56:59], s42 offen nt lds
    s_waitcnt vmcnt(7)
    s_add_u32 s43, s68, 1024
    s_mov_b32 m0, s43
    s_add_u32 s42, s67, 114688
    buffer_load_dwordx4 v5, s[56:59], s42 offen nt lds
    s_waitcnt vmcnt(7)
    s_add_u32 s43, s68, 2048
    s_mov_b32 m0, s43
    s_add_u32 s42, s67, 28672
    buffer_load_dwordx4 v5, s[56:59], s42 offen nt lds
    s_waitcnt vmcnt(7)
    s_add_u32 s43, s68, 3072
    s_mov_b32 m0, s43
    s_add_u32 s42, s67, 143360
    buffer_load_dwordx4 v5, s[56:59], s42 offen nt lds
    s_waitcnt vmcnt(7)
    s_add_u32 s43, s68, 4096
    s_mov_b32 m0, s43
    s_add_u32 s42, s67, 229376
    buffer_load_dwordx4 v5, s[56:59], s42 offen nt lds
    s_waitcnt vmcnt(7)
    s_add_u32 s43, s68, 5120
    s_mov_b32 m0, s43
    s_add_u32 s42, s67, 344064
    buffer_load_dwordx4 v5, s[56:59], s42 offen nt lds
    s_waitcnt vmcnt(6)
    s_barrier
    s_barrier
    s_waitcnt vmcnt(7)
    s_add_u32 s43, s68, 6144
    s_mov_b32 m0, s43
    s_add_u32 s42, s67, 258048
    buffer_load_dwordx4 v5, s[56:59], s42 offen nt lds
    s_waitcnt vmcnt(7)
    s_add_u32 s43, s68, 7168
    s_mov_b32 m0, s43
    s_add_u32 s42, s67, 372736
    buffer_load_dwordx4 v5, s[56:59], s42 offen nt lds
    s_waitcnt vmcnt(9)
    s_add_u32 s43, s68, 32768
    s_mov_b32 m0, s43
    s_add_u32 s42, s67, 1835008
    buffer_load_dwordx4 v5, s[56:59], s42 offen nt lds
    s_waitcnt vmcnt(9)
    s_add_u32 s43, s68, 33792
    s_mov_b32 m0, s43
    s_add_u32 s42, s67, 1949696
    buffer_load_dwordx4 v5, s[56:59], s42 offen nt lds
    s_waitcnt vmcnt(9)
    s_add_u32 s43, s68, 34816
    s_mov_b32 m0, s43
    s_add_u32 s42, s67, 1863680
    buffer_load_dwordx4 v5, s[56:59], s42 offen nt lds
    s_waitcnt vmcnt(9)
    s_add_u32 s43, s68, 35840
    s_mov_b32 m0, s43
    s_add_u32 s42, s67, 1978368
    buffer_load_dwordx4 v5, s[56:59], s42 offen nt lds
    s_waitcnt vmcnt(9)
    s_add_u32 s43, s68, 36864
    s_mov_b32 m0, s43
    s_add_u32 s42, s67, 2064384
    buffer_load_dwordx4 v5, s[56:59], s42 offen nt lds
    s_waitcnt vmcnt(9)
    s_add_u32 s43, s68, 37888
    s_mov_b32 m0, s43
    s_add_u32 s42, s67, 2179072
    buffer_load_dwordx4 v5, s[56:59], s42 offen nt lds
    s_waitcnt vmcnt(9)
    s_add_u32 s43, s68, 38912
    s_mov_b32 m0, s43
    s_add_u32 s42, s67, 2093056
    buffer_load_dwordx4 v5, s[56:59], s42 offen nt lds
    s_waitcnt vmcnt(9)
    s_add_u32 s43, s68, 39936
    s_mov_b32 m0, s43
    s_add_u32 s42, s67, 2207744
    buffer_load_dwordx4 v5, s[56:59], s42 offen nt lds
    s_waitcnt vmcnt(9)
    s_add_u32 s43, s68, 65536
    s_mov_b32 m0, s43
    s_add_u32 s42, s67, 0
    buffer_load_dwordx4 v5, s[44:47], s42 offen nt lds
    s_waitcnt vmcnt(9)
    s_barrier
    s_add_u32 s43, s68, 66560
    s_mov_b32 m0, s43
    s_add_u32 s42, s67, 114688
    buffer_load_dwordx4 v5, s[44:47], s42 offen nt lds
    s_waitcnt vmcnt(9)
    s_add_u32 s43, s68, 67584
    s_mov_b32 m0, s43
    s_add_u32 s42, s67, 28672
    buffer_load_dwordx4 v5, s[44:47], s42 offen nt lds
    s_waitcnt vmcnt(9)
    s_add_u32 s43, s68, 68608
    s_mov_b32 m0, s43
    s_add_u32 s42, s67, 143360
    buffer_load_dwordx4 v5, s[44:47], s42 offen nt lds
    s_waitcnt vmcnt(9)
    s_add_u32 s43, s68, 69632
    s_mov_b32 m0, s43
    s_add_u32 s42, s67, 229376
    buffer_load_dwordx4 v5, s[44:47], s42 offen nt lds
    s_waitcnt vmcnt(9)
    s_add_u32 s43, s68, 70656
    s_mov_b32 m0, s43
    s_add_u32 s42, s67, 344064
    buffer_load_dwordx4 v5, s[44:47], s42 offen nt lds
    s_waitcnt vmcnt(9)
    s_add_u32 s43, s68, 71680
    s_mov_b32 m0, s43
    s_add_u32 s42, s67, 258048
    buffer_load_dwordx4 v5, s[44:47], s42 offen nt lds
    s_waitcnt vmcnt(9)
    s_add_u32 s43, s68, 72704
    s_mov_b32 m0, s43
    s_add_u32 s42, s67, 372736
    buffer_load_dwordx4 v5, s[44:47], s42 offen nt lds
    s_waitcnt vmcnt(9)
    s_add_u32 s43, s68, 98304
    s_mov_b32 m0, s43
    s_add_u32 s42, s67, 1835008
    buffer_load_dwordx4 v5, s[44:47], s42 offen nt lds
    s_waitcnt vmcnt(9)
    s_barrier
    ds_read_b64_tr_b16 v[64:65], v12 offset:0
    ds_read_b64_tr_b16 v[66:67], v12 offset:2048
    ds_read_b64_tr_b16 v[68:69], v12 offset:4096
    ds_read_b64_tr_b16 v[70:71], v12 offset:6144
    ds_read_b64_tr_b16 v[72:73], v12 offset:8192
    ds_read_b64_tr_b16 v[74:75], v12 offset:10240
    ds_read_b64_tr_b16 v[76:77], v12 offset:12288
    ds_read_b64_tr_b16 v[78:79], v12 offset:14336
    ds_read_b64_tr_b16 v[80:81], v12 offset:16384
    ds_read_b64_tr_b16 v[82:83], v12 offset:18432
    ds_read_b64_tr_b16 v[84:85], v12 offset:20480
    ds_read_b64_tr_b16 v[86:87], v12 offset:22528
    ds_read_b64_tr_b16 v[88:89], v12 offset:24576
    ds_read_b64_tr_b16 v[90:91], v12 offset:26624
    ds_read_b64_tr_b16 v[92:93], v12 offset:28672
    ds_read_b64_tr_b16 v[94:95], v12 offset:30720
    s_add_u32 s43, s68, 99328
    s_mov_b32 m0, s43
    s_add_u32 s42, s67, 1949696
    buffer_load_dwordx4 v5, s[44:47], s42 offen nt lds
    s_waitcnt vmcnt(9)
    s_add_u32 s43, s68, 100352
    s_mov_b32 m0, s43
    s_add_u32 s42, s67, 1863680
    buffer_load_dwordx4 v5, s[44:47], s42 offen nt lds
    s_waitcnt vmcnt(9)
    s_add_u32 s43, s68, 101376
    s_mov_b32 m0, s43
    s_add_u32 s42, s67, 1978368
    buffer_load_dwordx4 v5, s[44:47], s42 offen nt lds
    s_waitcnt vmcnt(9)
    s_add_u32 s43, s68, 102400
    s_mov_b32 m0, s43
    s_add_u32 s42, s67, 2064384
    buffer_load_dwordx4 v5, s[44:47], s42 offen nt lds
    s_waitcnt vmcnt(9)
    s_add_u32 s43, s68, 103424
    s_mov_b32 m0, s43
    s_add_u32 s42, s67, 2179072
    buffer_load_dwordx4 v5, s[44:47], s42 offen nt lds
    s_waitcnt vmcnt(9)
    s_add_u32 s43, s68, 104448
    s_mov_b32 m0, s43
    s_add_u32 s42, s67, 2093056
    buffer_load_dwordx4 v5, s[44:47], s42 offen nt lds
    s_waitcnt vmcnt(9)
    s_add_u32 s43, s68, 105472
    s_mov_b32 m0, s43
    s_add_u32 s42, s67, 2207744
    buffer_load_dwordx4 v5, s[44:47], s42 offen nt lds
    s_branch m_join
g_cons:
    s_lshl_b32 s29, s34, 4
    s_add_u32 s29, s29, s35
    s_lshl_b32 s29, s29, 12
    s_add_u32 s29, s29, 19922944
    s_lshl_b32 s30, s16, 9
    s_add_u32 s30, s30, s29
    s_lshl_b32 s31, s16, 8
    s_add_u32 s31, s31, s29
    s_add_u32 s31, s31, 2048
    v_lshlrev_b32 v8, 1, v2
    v_lshlrev_b32 v9, 7, v2
    v_mov_b32 v104, -1
    v_mov_b32 v105, -1
    v_mov_b32 v106, -1
    v_mov_b32 v107, -1
    s_waitcnt lgkmcnt(0)
    s_mov_b32 s12, s6
    s_mov_b32 s13, s7
    s_cmp_eq_u32 s16, 1
    s_cselect_b64 exec, 0xffffff, 1
    buffer_load_dword v245, v9, s[12:15], s29 offen sc1
    s_mov_b64 exec, -1
    v_mov_b32 v14, 0
    s_mov_b32 s8, s58
    s_mov_b32 s9, s59
    s_mov_b32 s10, 12582912
    s_mov_b32 s11, 0x00020000
    s_mov_b32 s20, s26
    s_mov_b32 s21, s27
    s_mov_b32 s26, 4194304
    s_mov_b32 s27, 0x00020000
    s_and_b32 s65, s35, 1
    s_lshr_b32 s40, s35, 1
    s_mul_i32 s64, s34, 7
    s_add_u32 s64, s64, s40
    s_lshl_b32 s41, s34, 1
    s_add_u32 s41, s41, s65
    s_cmp_ge_u32 s35, 14
    s_cselect_b32 s66, 1, 0
    s_cselect_b32 s64, s41, s64
    v_lshrrev_b32 v10, 2, v2
    v_and_b32 v15, 3, v0
    v_bfe_u32 v11, v0, 3, 2
    v_xor_b32 v12, v11, v1
    v_and_b32 v12, 3, v12
    v_lshlrev_b32 v12, 5, v12
    v_lshl_add_u32 v12, v10, 7, v12
    v_lshl_add_u32 v12, v15, 3, v12
    v_lshrrev_b32 v16, 2, v1
    v_lshl_add_u32 v12, v16, 15, v12
    v_add_u32 v21, 65536, v12
    v_bfe_u32 v22, v0, 2, 3
    v_lshlrev_b32 v22, 5, v22
    v_lshl_add_u32 v22, v15, 3, v22
    v_bfe_u32 v23, v0, 2, 2
    v_bfe_u32 v24, v0, 4, 2
    v_lshl_add_u32 v23, v24, 3, v23
    v_lshl_add_u32 v200, v23, 10, v22
    v_lshl_add_u32 v200, v1, 8, v200
    v_add_u32 v200, 32768, v200
    v_lshlrev_b32 v25, 7, v1
    v_xor_b32 v22, v22, v25
    v_lshl_add_u32 v208, v23, 9, v22
    v_add_u32 v208, 98304, v208
    v_cmp_eq_u32 s[60:61], 1, v24
    v_cmp_eq_u32 s[62:63], 2, v24
    v_cmp_eq_u32 s[72:73], 3, v24
    v_add_u32 v8, v8, v25
    v_add_u32 v8, 139264, v8
    v_lshl_add_u32 v10, v24, 4, v25
    v_add_u32 v10, 139264, v10
    v_xor_b32 v201, 32, v200
    v_xor_b32 v202, 64, v200
    v_xor_b32 v203, 96, v200
    v_xor_b32 v204, 128, v200
    v_xor_b32 v205, 160, v200
    v_xor_b32 v206, 192, v200
    v_xor_b32 v207, 224, v200
    v_xor_b32 v209, 32, v208
    v_xor_b32 v210, 64, v208
    v_xor_b32 v211, 96, v208
    s_sleep 8
    s_load_dwordx2 s[32:33], s[20:21], 128
    s_waitcnt lgkmcnt(0)
    s_cmp_lg_u32 s32, 0
    s_cbranch_scc1 g_nnx
    s_load_dwordx2 s[32:33], s[20:21], 192
    s_mov_b32 s83, 0
    v_mov_b32 v114, 0
    s_waitcnt lgkmcnt(0)
g_nn:
    s_cmp_lg_u32 s32, 0
    s_cbranch_scc1 g_nnx
    global_load_dwordx2 v[112:113], v114, s[20:21] sc1
    s_waitcnt vmcnt(0)
    v_readfirstlane_b32 s32, v112
    v_readfirstlane_b32 s33, v113
    s_add_u32 s83, s83, 1
    s_cmp_lt_u32 s83, 0x40000
    s_cbranch_scc1 g_nn
g_nnx:
    v_mov_b32 v212, s32
    v_mov_b32 v213, s33
    v_and_b32 v214, 7, v0
    v_lshlrev_b32 v214, 3, v214
    v_lshrrev_b64 v[212:213], v214, v[212:213]
    v_and_b32 v212, 0xff, v212
    s_movk_i32 s74, 0xff00
    s_cmp_ge_u32 s16, s66
    s_cbranch_scc1 g_nw
    s_lshr_b32 s22, s64, 2
    s_cmp_eq_u32 s22, 3
    s_cselect_b32 s22, 6, s22
    s_lshl_b32 s22, s22, 12
    s_add_u32 s22, s22, 16875520
    s_lshr_b32 s23, s64, 3
    s_lshl_b32 s23, s23, 13
    s_add_u32 s23, s23, 16908288
    s_mov_b32 s75, 16891904
    v_bfe_u32 v24, v0, 2, 1
    v_bfe_u32 v25, v0, 3, 2
    v_bfe_u32 v26, v0, 5, 1
    v_lshlrev_b32 v220, 4, v15
    v_lshl_add_u32 v220, v24, 9, v220
    v_lshl_add_u32 v220, v25, 10, v220
    s_and_b32 s42, s64, 3
    s_lshl_b32 s42, s42, 7
    s_and_b32 s43, s64, 4
    s_lshl_b32 s43, s43, 4
    s_add_u32 s42, s42, s43
    v_add_u32 v233, s42, v220
    v_lshl_add_u32 v220, v26, 7, v220
    s_and_b32 s42, s64, 1
    s_lshl_b32 s42, s42, 8
    s_and_b32 s43, s64, 2
    s_lshl_b32 s43, s43, 5
    s_add_u32 s42, s42, s43
    v_add_u32 v220, s42, v220
    v_xor_b32 v234, 8176, v220
    v_xor_b32 v235, 8176, v233
    v_lshlrev_b32 v221, 7, v15
    v_lshl_add_u32 v221, v24, 6, v221
    v_lshl_add_u32 v221, v25, 4, v221
    v_lshl_add_u32 v221, v26, 9, v221
    v_add_u32 v232, 8, v2
    v_and_b32 v232, 31, v232
    v_lshl_add_u32 v232, v26, 5, v232
    v_lshlrev_b32 v232, 2, v232
    s_lshl_b32 s79, s64, 7
    s_add_u32 s79, s79, 16850944
    v_xor_b32 v0, 1, v0
    v_mov_b32 v228, s32
    v_mov_b32 v229, s33
    v_and_b32 v230, 1, v0
    v_cmp_eq_u32 vcc, 1, v230
    s_nop 1
    v_cndmask_b32 v228, v228, v229, vcc
    v_bfe_u32 v229, v228, 8, 8
    v_bfe_u32 v230, v228, 16, 8
    v_lshrrev_b32 v231, 24, v228
    v_and_b32 v228, 0xff, v228
    v_xor_b32 v0, 1, v0
    s_mov_b32 s44, s48
    s_mov_b32 s45, s49
    s_mov_b32 s46, 2048
    s_mov_b32 s47, 0x00020000
    v_lshrrev_b32 v11, 1, v221
    s_and_b32 s42, s64, 3
    s_lshl_b32 s42, s42, 9
    buffer_load_dwordx2 v[52:53], v11, s[44:47], s42 offen
    v_mov_b32 v216, s32
    v_mov_b32 v217, s33
    v_and_b32 v218, 1, v0
    v_cmp_eq_u32 vcc, 1, v218
    s_nop 1
    v_cndmask_b32 v216, v216, v217, vcc
    v_bfe_u32 v217, v216, 8, 8
    v_bfe_u32 v218, v216, 16, 8
    v_lshrrev_b32 v219, 24, v216
    v_and_b32 v216, 0xff, v216
    v_not_b32 v24, v216
    v_not_b32 v25, v229
    buffer_store_dwordx4 v[24:27], v220, s[12:15], s22 offen sc1
    s_mov_b32 exec_hi, 0
    buffer_store_dwordx4 v[24:27], v233, s[12:15], s23 offen sc1
    buffer_store_dwordx4 v[24:27], v235, s[12:15], s23 offen sc1
    s_mov_b64 exec, 0xff
    buffer_store_dwordx4 v[104:107], v3, s[12:15], s79 offen sc1
    s_mov_b64 exec, -1
    s_cmp_lt_u32 s64, 8
    s_cbranch_scc1 g_nw
    buffer_store_dwordx4 v[24:27], v234, s[12:15], s22 offen sc1
    s_cmp_lt_u32 s64, 12
    s_cbranch_scc1 g_nw
    buffer_store_dwordx4 v[24:27], v220, s[12:15], s75 offen sc1
    buffer_store_dwordx4 v[24:27], v234, s[12:15], s75 offen sc1
g_nw:
    s_barrier
    ds_read_u16 v6, v8
    s_waitcnt lgkmcnt(0)
    v_lshlrev_b32 v6, 16, v6
    v_mul_f32 v24, 0xbfb8aa3b, v6
    v_exp_f32 v24, v24
    s_nop 0
    v_add_f32 v24, 1.0, v24
    v_rcp_f32 v24, v24
    s_nop 0
    v_mul_f32 v6, v6, v24
    v_cvt_pk_bf16_f32 v6, v6, v6
    ds_write_b16 v8, v6
    ds_read_b128 v[120:123], v10
    ds_read_b128 v[124:127], v10 offset:64
    ds_read_b64_tr_b16 v[128:129], v200 offset:0
    ds_read_b64_tr_b16 v[130:131], v200 offset:4096
    ds_read_b64_tr_b16 v[132:133], v201 offset:0
    ds_read_b64_tr_b16 v[134:135], v201 offset:4096
    ds_read_b64_tr_b16 v[136:137], v202 offset:0
    ds_read_b64_tr_b16 v[138:139], v202 offset:4096
    ds_read_b64_tr_b16 v[140:141], v203 offset:0
    ds_read_b64_tr_b16 v[142:143], v203 offset:4096
    ds_read_b64_tr_b16 v[144:145], v204 offset:0
    ds_read_b64_tr_b16 v[146:147], v204 offset:4096
    ds_read_b64_tr_b16 v[148:149], v205 offset:0
    ds_read_b64_tr_b16 v[150:151], v205 offset:4096
    ds_read_b64_tr_b16 v[152:153], v206 offset:0
    ds_read_b64_tr_b16 v[154:155], v206 offset:4096
    s_waitcnt lgkmcnt(12)
    v_mfma_f32_16x16x32_bf16 v[64:67], v[120:123], v[128:131], 0
    ds_read_b64_tr_b16 v[156:157], v207 offset:0
    ds_read_b64_tr_b16 v[158:159], v207 offset:4096
    s_waitcnt lgkmcnt(12)
    v_mfma_f32_16x16x32_bf16 v[68:71], v[120:123], v[132:135], 0
    s_waitcnt lgkmcnt(10)
    v_mfma_f32_16x16x32_bf16 v[72:75], v[120:123], v[136:139], 0
    s_waitcnt lgkmcnt(8)
    v_mfma_f32_16x16x32_bf16 v[76:79], v[120:123], v[140:143], 0
    s_waitcnt lgkmcnt(6)
    v_mfma_f32_16x16x32_bf16 v[80:83], v[120:123], v[144:147], 0
    s_waitcnt lgkmcnt(4)
    v_mfma_f32_16x16x32_bf16 v[84:87], v[120:123], v[148:151], 0
    s_waitcnt lgkmcnt(2)
    v_mfma_f32_16x16x32_bf16 v[88:91], v[120:123], v[152:155], 0
    s_waitcnt lgkmcnt(0)
    v_mfma_f32_16x16x32_bf16 v[92:95], v[120:123], v[156:159], 0
    v_mov_b32 v216, s32
    v_mov_b32 v217, s33
    v_and_b32 v218, 1, v0
    v_cmp_eq_u32 vcc, 1, v218
    s_nop 1
    v_cndmask_b32 v216, v216, v217, vcc
    v_bfe_u32 v217, v216, 8, 8
    v_bfe_u32 v218, v216, 16, 8
    v_lshrrev_b32 v219, 24, v216
    v_and_b32 v216, 0xff, v216
    s_lshl_b32 s81, s34, 16
    s_lshl_b32 s42, s16, 13
    s_add_u32 s81, s81, s42
    s_add_u32 s81, s81, 19922944
    s_lshl_b32 s42, s65, 9
    s_add_u32 s80, s81, s42
    s_add_u32 s81, s80, s42
    v_lshlrev_b32 v222, 4, v0
    v_lshrrev_b32 v223, 5, v2
    v_and_b32 v24, 0x1f0, v3
    v_lshl_add_u32 v223, v223, 12, v24
    s_lshl_b32 s39, s34, 4
    s_add_u32 s39, s39, s35
    s_lshl_b32 s39, s39, 12
    s_add_u32 s39, s39, 19922944
    s_bitcmp1_b32 s64, 2
    s_cselect_b32 s28, 1.0, 0
    s_barrier
    ds_read_b64_tr_b16 v[128:129], v200 offset:32768
    ds_read_b64_tr_b16 v[130:131], v200 offset:36864
    ds_read_b64_tr_b16 v[132:133], v201 offset:32768
    ds_read_b64_tr_b16 v[134:135], v201 offset:36864
    ds_read_b64_tr_b16 v[136:137], v202 offset:32768
    ds_read_b64_tr_b16 v[138:139], v202 offset:36864
    ds_read_b64_tr_b16 v[140:141], v203 offset:32768
    ds_read_b64_tr_b16 v[142:143], v203 offset:36864
    ds_read_b64_tr_b16 v[144:145], v204 offset:32768
    ds_read_b64_tr_b16 v[146:147], v204 offset:36864
    ds_read_b64_tr_b16 v[148:149], v205 offset:32768
    ds_read_b64_tr_b16 v[150:151], v205 offset:36864
    ds_read_b64_tr_b16 v[152:153], v206 offset:32768
    ds_read_b64_tr_b16 v[154:155], v206 offset:36864
    s_waitcnt lgkmcnt(12)
    v_mfma_f32_16x16x32_bf16 v[64:67], v[124:127], v[128:131], v[64:67]
    ds_read_b64_tr_b16 v[156:157], v207 offset:32768
    ds_read_b64_tr_b16 v[158:159], v207 offset:36864
    s_waitcnt lgkmcnt(12)
    v_mfma_f32_16x16x32_bf16 v[68:71], v[124:127], v[132:135], v[68:71]
    s_waitcnt lgkmcnt(10)
    v_mfma_f32_16x16x32_bf16 v[72:75], v[124:127], v[136:139], v[72:75]
    s_waitcnt lgkmcnt(8)
    v_mfma_f32_16x16x32_bf16 v[76:79], v[124:127], v[140:143], v[76:79]
    s_waitcnt lgkmcnt(6)
    v_mfma_f32_16x16x32_bf16 v[80:83], v[124:127], v[144:147], v[80:83]
    s_waitcnt lgkmcnt(4)
    v_mfma_f32_16x16x32_bf16 v[84:87], v[124:127], v[148:151], v[84:87]
    s_waitcnt lgkmcnt(2)
    v_mfma_f32_16x16x32_bf16 v[88:91], v[124:127], v[152:155], v[88:91]
    s_waitcnt lgkmcnt(0)
    v_mfma_f32_16x16x32_bf16 v[92:95], v[124:127], v[156:159], v[92:95]
    v_cndmask_b32 v64, v64, v68, s[60:61]
    v_cndmask_b32 v64, v64, v72, s[62:63]
    v_cndmask_b32 v64, v64, v76, s[72:73]
    v_and_or_b32 v224, v64, s74, v212
    v_cndmask_b32 v80, v80, v84, s[60:61]
    s_nop 0
    v_cndmask_b32 v80, v80, v88, s[62:63]
    s_nop 0
    v_cndmask_b32 v80, v80, v92, s[72:73]
    v_and_or_b32 v225, v80, s74, v212
    buffer_store_dword v224, v13, s[12:15], s30 offen offset:0
    buffer_store_dword v225, v13, s[12:15], s30 offen offset:256
    s_cmp_eq_u32 s66, 1
    s_cbranch_scc1 x_start
    s_barrier
    s_barrier
    ds_read_b64_tr_b16 v[128:129], v208 offset:0
    ds_read_b64_tr_b16 v[130:131], v208 offset:2048
    ds_read_b64_tr_b16 v[132:133], v209 offset:0
    ds_read_b64_tr_b16 v[134:135], v209 offset:2048
    ds_read_b64_tr_b16 v[136:137], v210 offset:0
    ds_read_b64_tr_b16 v[138:139], v210 offset:2048
    ds_read_b64_tr_b16 v[140:141], v211 offset:0
    ds_read_b64_tr_b16 v[142:143], v211 offset:2048
    ds_read_b64_tr_b16 v[144:145], v208 offset:16384
    ds_read_b64_tr_b16 v[146:147], v208 offset:18432
    ds_read_b64_tr_b16 v[148:149], v209 offset:16384
    ds_read_b64_tr_b16 v[150:151], v209 offset:18432
    ds_read_b64_tr_b16 v[152:153], v210 offset:16384
    ds_read_b64_tr_b16 v[154:155], v210 offset:18432
    s_waitcnt lgkmcnt(12)
    v_mfma_f32_16x16x32_bf16 v[64:67], v[120:123], v[128:131], 0
    ds_read_b64_tr_b16 v[156:157], v211 offset:16384
    ds_read_b64_tr_b16 v[158:159], v211 offset:18432
    s_waitcnt lgkmcnt(12)
    v_mfma_f32_16x16x32_bf16 v[68:71], v[120:123], v[132:135], 0
    s_waitcnt lgkmcnt(10)
    v_mfma_f32_16x16x32_bf16 v[72:75], v[120:123], v[136:139], 0
    s_waitcnt lgkmcnt(8)
    v_mfma_f32_16x16x32_bf16 v[76:79], v[120:123], v[140:143], 0
    s_waitcnt lgkmcnt(6)
    v_mfma_f32_16x16x32_bf16 v[64:67], v[124:127], v[144:147], v[64:67]
    s_waitcnt lgkmcnt(4)
    v_mfma_f32_16x16x32_bf16 v[68:71], v[124:127], v[148:151], v[68:71]
    s_waitcnt lgkmcnt(2)
    v_mfma_f32_16x16x32_bf16 v[72:75], v[124:127], v[152:155], v[72:75]
    s_waitcnt lgkmcnt(0)
    v_mfma_f32_16x16x32_bf16 v[76:79], v[124:127], v[156:159], v[76:79]
    s_nop 3
    v_cndmask_b32 v64, v64, v68, s[60:61]
    s_nop 0
    v_cndmask_b32 v64, v64, v72, s[62:63]
    s_nop 0
    v_cndmask_b32 v64, v64, v76, s[72:73]
    v_and_or_b32 v226, v64, s74, v212
    buffer_store_dword v226, v13, s[12:15], s31 offen offset:0
    s_barrier
    s_bitcmp1_b32 s16, 0
    s_cselect_b32 s8, s52, s50
    s_cselect_b32 s9, s53, s51
    s_mov_b32 s10, 7340032
    s_lshr_b32 s42, s8, 7
    s_sub_u32 s42, 3, s42
    s_add_u32 s42, s42, s34
    s_and_b32 s42, s42, 7
    s_cmp_eq_u32 s42, 7
    s_cbranch_scc1 m_nh2
    s_mul_i32 s43, s34, 7
    s_add_u32 s42, s42, s43
    s_lshl_b32 s42, s42, 7
    s_lshl_b32 s43, s35, 1
    s_lshr_b32 s40, s16, 1
    s_add_u32 s43, s43, s40
    s_mul_i32 s43, s43, 265216
    s_add_u32 s42, s42, s43
    v_mul_u32_u24 v24, 7168, v2
    s_mov_b32 exec_lo, 4294967295
    s_mov_b32 exec_hi, 31
    buffer_load_dword v245, v24, s[8:11], s42 offen
    s_mov_b64 exec, -1
m_nh2:
    s_barrier
    ds_read_b64_tr_b16 v[64:65], v12 offset:0
    ds_read_b64_tr_b16 v[66:67], v12 offset:2048
    ds_read_b64_tr_b16 v[68:69], v12 offset:4096
    ds_read_b64_tr_b16 v[70:71], v12 offset:6144
    ds_read_b64_tr_b16 v[72:73], v12 offset:8192
    ds_read_b64_tr_b16 v[74:75], v12 offset:10240
    ds_read_b64_tr_b16 v[76:77], v12 offset:12288
    ds_read_b64_tr_b16 v[78:79], v12 offset:14336
    ds_read_b64_tr_b16 v[80:81], v12 offset:16384
    ds_read_b64_tr_b16 v[82:83], v12 offset:18432
    ds_read_b64_tr_b16 v[84:85], v12 offset:20480
    ds_read_b64_tr_b16 v[86:87], v12 offset:22528
    ds_read_b64_tr_b16 v[88:89], v12 offset:24576
    ds_read_b64_tr_b16 v[90:91], v12 offset:26624
    ds_read_b64_tr_b16 v[92:93], v12 offset:28672
    ds_read_b64_tr_b16 v[94:95], v12 offset:30720
    s_waitcnt vmcnt(0)
    s_barrier
    s_sub_u32 s42, s16, 1
    s_cmp_ge_u32 s42, 3
    s_cbranch_scc1 m_nb
    s_lshl_b32 s42, s42, 10
    s_add_u32 s42, s42, s29
    s_add_u32 s43, s42, 524288
    buffer_load_dwordx4 v[44:47], v3, s[12:15], s42 offen sc1
    s_waitcnt vmcnt(0)
    buffer_store_dwordx4 v[44:47], v3, s[12:15], s43 offen sc1
m_nb:
m_join:
    v_bfe_u32 v7, v0, 4, 2
    v_and_b32 v6, 1, v0
    v_lshlrev_b32 v17, 10, v6
    v_lshl_add_u32 v17, v16, 9, v17
    v_lshl_add_u32 v17, v7, 4, v17
    v_add_u32 v17, 131072, v17
    v_and_b32 v6, 15, v0
    v_lshlrev_b32 v13, 6, v6
    v_bfe_u32 v22, v0, 4, 1
    v_lshl_add_u32 v13, v22, 5, v13
    v_bfe_u32 v22, v0, 5, 1
    v_lshl_add_u32 v13, v22, 4, v13
    v_add_u32 v13, 131072, v13
    v_lshl_add_u32 v13, v1, 10, v13
    s_lshl_b32 s70, s34, 1
    s_add_u32 s70, s70, s16
    s_lshl_b32 s70, s70, 13
    s_lshl_b32 s71, s65, 11
    s_add_u32 s70, s70, s71
    s_add_u32 s70, s70, 17301504
    s_mov_b32 s71, 0x07060302
    s_lshl_b32 s69, s64, 2
    s_and_b32 s42, s16, 3
    s_add_u32 s69, s69, s42
    s_lshl_b32 s69, s69, 10
    s_lshl_b32 s76, s65, 1
    s_lshr_b32 s42, s16, 2
    s_add_u32 s76, s76, s42
    s_lshl_b32 s76, s76, 8
    s_add_u32 s76, s76, s69
    s_add_u32 s77, s76, 18612224
    s_add_u32 s76, s76, 18350080
    s_add_u32 s69, s69, 18350080
    s_cmp_lg_u32 s16, 2
    s_cbranch_scc1 m_n0
    v_lshlrev_b32 v4, 7, v2
    s_sub_u32 s69, s69, 2048
    s_mov_b32 exec_hi, 0
    buffer_load_dword v5, v4, s[12:15], s69 offen sc1
    s_mov_b32 exec_hi, -1
m_n0:
    s_cmp_ge_u32 s16, 2
    s_cbranch_scc1 m_n1
    v_lshlrev_b32 v4, 7, v2
    s_mov_b64 exec, 0xffff
    buffer_load_dword v5, v4, s[12:15], s70 offen sc1
    s_mov_b64 exec, -1
m_n1:
    v_mov_b32 v216, s32
    v_mov_b32 v217, s33
    v_and_b32 v218, 1, v0
    v_cmp_eq_u32 vcc, 1, v218
    s_nop 1
    v_cndmask_b32 v216, v216, v217, vcc
    v_bfe_u32 v217, v216, 8, 8
    v_bfe_u32 v218, v216, 16, 8
    v_lshrrev_b32 v219, 24, v216
    v_and_b32 v216, 0xff, v216
    s_and_b32 s60, s32, 0xffff
    s_lshr_b32 s61, s32, 16
    s_and_b32 s62, s33, 0xffff
    s_lshr_b32 s63, s33, 16
    s_movk_i32 s74, 0xff00
    s_waitcnt vmcnt(0)
    s_barrier
    s_cmp_ge_u32 s16, 2
    s_cselect_b64 exec, 1, -1
    buffer_load_dwordx4 v[176:179], v3, s[12:15], s70 offen sc1
    buffer_load_dwordx4 v[180:183], v3, s[12:15], s70 offen offset:1024 sc1
    s_mov_b64 exec, -1
    ds_read_b64_tr_b16 v[96:97], v21 offset:0
    ds_read_b64_tr_b16 v[98:99], v21 offset:2048
    ds_read_b64_tr_b16 v[100:101], v21 offset:4096
    ds_read_b64_tr_b16 v[102:103], v21 offset:6144
    ds_read_b64_tr_b16 v[104:105], v21 offset:8192
    ds_read_b64_tr_b16 v[106:107], v21 offset:10240
    ds_read_b64_tr_b16 v[108:109], v21 offset:12288
    ds_read_b64_tr_b16 v[110:111], v21 offset:14336
    ds_read_b64_tr_b16 v[112:113], v21 offset:16384
    ds_read_b64_tr_b16 v[114:115], v21 offset:18432
    ds_read_b64_tr_b16 v[116:117], v21 offset:20480
    ds_read_b64_tr_b16 v[118:119], v21 offset:22528
    ds_read_b64_tr_b16 v[120:121], v21 offset:24576
    ds_read_b64_tr_b16 v[122:123], v21 offset:26624
    ds_read_b64_tr_b16 v[124:125], v21 offset:28672
    ds_read_b64_tr_b16 v[126:127], v21 offset:30720
    s_cbranch_scc1 m_nk
    s_mov_b32 s83, 0
    s_branch m_ph
m_pr:
    s_and_b32 s42, s83, 63
    s_cmp_eq_u32 s42, 63
    s_cselect_b32 s42, 131072, 0
    s_add_u32 s42, s42, s70
    buffer_load_dwordx4 v[176:179], v3, s[12:15], s42 offen sc1
    buffer_load_dwordx4 v[180:183], v3, s[12:15], s42 offen offset:1024 sc1
    s_add_u32 s83, s83, 1
    s_cmp_ge_u32 s83, 0x40000
    s_cbranch_scc1 m_phx
m_ph:
    s_waitcnt vmcnt(0)
    v_cmp_ne_u16 vcc, s63, v183
    s_cbranch_vccnz m_pr
    v_perm_b32 v184, v177, v176, s71
    v_perm_b32 v185, v179, v178, s71
    v_perm_b32 v186, v181, v180, s71
    v_perm_b32 v187, v183, v182, s71
    ds_write_b128 v13, v[184:187]
    v_xor_b32 v176, s60, v176
    v_xor_b32 v177, s61, v177
    v_xor_b32 v178, s62, v178
    v_xor_b32 v179, s63, v179
    v_xor_b32 v180, s60, v180
    v_xor_b32 v181, s61, v181
    v_xor_b32 v182, s62, v182
    v_xor_b32 v183, s63, v183
    v_or3_b32 v4, v176, v177, 0
    v_or3_b32 v4, v178, v179, v4
    v_or3_b32 v4, v180, v181, v4
    v_or3_b32 v4, v182, v183, v4
    v_cmp_ne_u16 vcc, 0, v4
    s_cbranch_vccnz m_pr
m_phx:
m_nk:
    s_waitcnt lgkmcnt(0)
    s_barrier
    ds_read_b128 v[128:131], v17 offset:0
    ds_read_b128 v[132:135], v17 offset:64
    ds_read_b128 v[136:139], v17 offset:128
    ds_read_b128 v[140:143], v17 offset:192
    ds_read_b128 v[144:147], v17 offset:256
    ds_read_b128 v[148:151], v17 offset:320
    ds_read_b128 v[152:155], v17 offset:384
    ds_read_b128 v[156:159], v17 offset:448
    s_waitcnt lgkmcnt(7)
    v_mfma_f32_16x16x32_bf16 v[160:163], v[128:131], v[64:67], 0
    v_mfma_f32_16x16x32_bf16 v[164:167], v[128:131], v[96:99], 0
    s_waitcnt lgkmcnt(6)
    v_mfma_f32_16x16x32_bf16 v[160:163], v[132:135], v[68:71], v[160:163]
    v_mfma_f32_16x16x32_bf16 v[164:167], v[132:135], v[100:103], v[164:167]
    s_waitcnt lgkmcnt(5)
    v_mfma_f32_16x16x32_bf16 v[160:163], v[136:139], v[72:75], v[160:163]
    v_mfma_f32_16x16x32_bf16 v[164:167], v[136:139], v[104:107], v[164:167]
    s_waitcnt lgkmcnt(4)
    v_mfma_f32_16x16x32_bf16 v[160:163], v[140:143], v[76:79], v[160:163]
    v_mfma_f32_16x16x32_bf16 v[164:167], v[140:143], v[108:111], v[164:167]
    s_waitcnt lgkmcnt(3)
    v_mfma_f32_16x16x32_bf16 v[160:163], v[144:147], v[80:83], v[160:163]
    v_mfma_f32_16x16x32_bf16 v[164:167], v[144:147], v[112:115], v[164:167]
    s_waitcnt lgkmcnt(2)
    v_mfma_f32_16x16x32_bf16 v[160:163], v[148:151], v[84:87], v[160:163]
    v_mfma_f32_16x16x32_bf16 v[164:167], v[148:151], v[116:119], v[164:167]
    s_waitcnt lgkmcnt(1)
    v_mfma_f32_16x16x32_bf16 v[160:163], v[152:155], v[88:91], v[160:163]
    v_mfma_f32_16x16x32_bf16 v[164:167], v[152:155], v[120:123], v[164:167]
    s_waitcnt lgkmcnt(0)
    v_mfma_f32_16x16x32_bf16 v[160:163], v[156:159], v[92:95], v[160:163]
    v_mfma_f32_16x16x32_bf16 v[164:167], v[156:159], v[124:127], v[164:167]
    s_nop 6
    v_and_or_b32 v184, v160, s74, v216
    v_and_or_b32 v185, v161, s74, v217
    v_and_or_b32 v186, v164, s74, v218
    v_and_or_b32 v187, v165, s74, v219
    s_mov_b64 exec, 0xffff
    buffer_store_dwordx4 v[184:187], v3, s[12:15], s76 offen
    buffer_store_dwordx4 v[184:187], v3, s[12:15], s77 offen sc1
    s_mov_b64 exec, -1
    s_cmp_eq_u32 s16, 0
    s_cbranch_scc1 r_start
g_end:
    s_endpgm
x_start:
    s_mov_b32 s83, 0
x_g0:
    s_and_b32 s42, s83, 63
    s_cmp_eq_u32 s42, 63
    s_cselect_b32 s42, 524288, 0
    s_add_u32 s42, s42, s81
    s_add_u32 s43, s42, 4096
    buffer_load_dwordx4 v[32:35], v3, s[12:15], s42 offen sc1
    buffer_load_dwordx4 v[36:39], v3, s[12:15], s43 offen sc1
    s_waitcnt vmcnt(0)
    v_xor_b32 v32, v216, v32
    v_xor_b32 v33, v217, v33
    v_xor_b32 v34, v218, v34
    v_xor_b32 v35, v219, v35
    v_xor_b32 v36, v216, v36
    v_xor_b32 v37, v217, v37
    v_xor_b32 v38, v218, v38
    v_xor_b32 v39, v219, v39
    v_or3_b32 v17, v32, v33, 0
    v_or3_b32 v17, v34, v35, v17
    v_or3_b32 v17, v36, v37, v17
    v_or3_b32 v17, v38, v39, v17
    v_and_b32 v17, 0xff, v17
    v_cmp_ne_u32 vcc, 0, v17
    s_cbranch_vccz x_g0x
    s_and_b32 s42, s83, 63
    s_cmp_lg_u32 s42, 48
    s_cbranch_scc1 x_g0n
    s_add_u32 s43, s39, 524288
    buffer_load_dwordx4 v[44:47], v3, s[12:15], s39 offen offset:0 sc1
    s_waitcnt vmcnt(0)
    buffer_store_dwordx4 v[44:47], v3, s[12:15], s43 offen offset:0 sc1
    s_waitcnt vmcnt(0)
    buffer_load_dwordx4 v[44:47], v3, s[12:15], s39 offen offset:1024 sc1
    s_waitcnt vmcnt(0)
    buffer_store_dwordx4 v[44:47], v3, s[12:15], s43 offen offset:1024 sc1
    s_waitcnt vmcnt(0)
x_g0n:
    s_add_u32 s83, s83, 1
    s_cmp_lt_u32 s83, 0x40000
    s_cbranch_scc1 x_g0
x_g0x:
    v_pk_add_f32 v[32:33], v[32:33], v[36:37]
    v_pk_add_f32 v[34:35], v[34:35], v[38:39]
    ds_write_b128 v222, v[32:35] offset:0
    s_waitcnt lgkmcnt(0)
    s_barrier
    s_cmp_lg_u32 s16, 0
    s_cbranch_scc1 x_g0e
    ds_read_b128 v[160:163], v221 offset:0
    ds_read_b128 v[164:167], v221 offset:1024
    ds_read_b128 v[168:171], v221 offset:2048
    ds_read_b128 v[172:175], v221 offset:3072
    ds_read_b128 v[176:179], v221 offset:4096
    ds_read_b128 v[180:183], v221 offset:5120
    ds_read_b128 v[184:187], v221 offset:6144
    ds_read_b128 v[188:191], v221 offset:7168
    s_waitcnt lgkmcnt(6)
    v_pk_add_f32 v[160:161], v[160:161], v[164:165]
    v_pk_add_f32 v[162:163], v[162:163], v[166:167]
    s_waitcnt lgkmcnt(4)
    v_pk_add_f32 v[168:169], v[168:169], v[172:173]
    v_pk_add_f32 v[170:171], v[170:171], v[174:175]
    s_waitcnt lgkmcnt(2)
    v_pk_add_f32 v[176:177], v[176:177], v[180:181]
    v_pk_add_f32 v[178:179], v[178:179], v[182:183]
    s_waitcnt lgkmcnt(0)
    v_pk_add_f32 v[184:185], v[184:185], v[188:189]
    v_pk_add_f32 v[186:187], v[186:187], v[190:191]
    v_pk_add_f32 v[160:161], v[160:161], v[168:169]
    v_pk_add_f32 v[176:177], v[176:177], v[184:185]
    v_pk_add_f32 v[162:163], v[162:163], v[170:171]
    v_pk_add_f32 v[178:179], v[178:179], v[186:187]
    v_pk_add_f32 v[160:161], v[160:161], v[176:177]
    v_pk_add_f32 v[162:163], v[162:163], v[178:179]
    v_cvt_pk_bf16_f32 v17, v160, v161
    v_lshlrev_b32 v160, 16, v17
    v_and_b32 v161, 0xffff0000, v17
    v_cvt_pk_bf16_f32 v18, v162, v163
    v_lshlrev_b32 v162, 16, v18
    v_and_b32 v163, 0xffff0000, v18
    v_add_f32 v160, s28, v160
    v_add_f32 v161, s28, v161
    v_add_f32 v162, s28, v162
    v_add_f32 v163, s28, v163
    v_cvt_pk_bf16_f32 v17, v160, v161
    v_lshlrev_b32 v160, 16, v17
    v_and_b32 v161, 0xffff0000, v17
    v_cvt_pk_bf16_f32 v18, v162, v163
    v_lshlrev_b32 v162, 16, v18
    v_and_b32 v163, 0xffff0000, v18
    v_mov_b32 v48, s32
    v_mov_b32 v49, s33
    s_cmp_ge_u32 s64, 8
    s_cbranch_scc1 x_q
    v_and_or_b32 v168, v160, s74, v216
    v_and_or_b32 v169, v161, s74, v217
    v_and_or_b32 v170, v162, s74, v218
    v_and_or_b32 v171, v163, s74, v219
    buffer_store_dwordx4 v[168:171], v220, s[12:15], s22 offen sc1
    v_max3_f32 v50, abs(v160), abs(v161), abs(v162)
    v_max_f32_e64 v50, v50, abs(v163)
    s_nop 1
    v_max_f32_dpp v50, v50, v50 row_ror:8 row_mask:0xf bank_mask:0xf
    s_nop 1
    v_max_f32_dpp v50, v50, v50 row_ror:4 row_mask:0xf bank_mask:0xf
    s_nop 1
    v_max_f32_dpp v50, v50, v50 row_ror:2 row_mask:0xf bank_mask:0xf
    s_nop 1
    v_max_f32_dpp v50, v50, v50 row_ror:1 row_mask:0xf bank_mask:0xf
    s_nop 1
    v_max_f32_dpp v50, v50, v50 row_bcast:15 row_mask:0xa bank_mask:0xf
    s_nop 1
    v_max_f32_dpp v50, v50, v50 row_bcast:31 row_mask:0xc bank_mask:0xf
    s_nop 0
    v_readlane_b32 s42, v50, 63
    s_nop 1
    v_mov_b32 v50, s42
    s_mov_b64 exec, 0xff
    buffer_store_dwordx4 v[48:51], v3, s[12:15], s79 offen sc1
    s_mov_b64 exec, -1
    s_branch x_g0e
x_q:
    s_cmp_lt_u32 s64, 12
    s_cbranch_scc1 x_nq
    v_lshlrev_b32 v164, 16, v52
    v_and_b32 v165, 0xffff0000, v52
    v_lshlrev_b32 v166, 16, v53
    v_and_b32 v167, 0xffff0000, v53
    v_pk_mul_f32 v[164:165], v[164:165], v[160:161]
    v_pk_mul_f32 v[166:167], v[166:167], v[162:163]
    ds_bpermute_b32 v180, v232, v164
    v_and_or_b32 v176, v164, s74, v216
    v_and_or_b32 v177, v165, s74, v217
    v_and_or_b32 v178, v166, s74, v218
    v_and_or_b32 v179, v167, s74, v219
    buffer_store_dwordx4 v[176:179], v220, s[12:15], s75 offen sc1
    v_and_or_b32 v181, v167, s74, v229
    v_and_or_b32 v182, v166, s74, v230
    v_and_or_b32 v183, v165, s74, v231
    s_waitcnt lgkmcnt(0)
    v_and_or_b32 v180, v180, s74, v228
    buffer_store_dwordx4 v[180:183], v234, s[12:15], s75 offen sc1
    v_and_b32 v164, s74, v164
    v_and_b32 v165, s74, v165
    v_and_b32 v166, s74, v166
    v_and_b32 v167, s74, v167
    v_pk_add_f32 v[164:165], v[164:165], v[166:167]
    v_add_f32 v50, v164, v165
    s_nop 1
    v_add_f32_dpp v50, v50, v50 row_ror:8 row_mask:0xf bank_mask:0xf
    s_nop 1
    v_add_f32_dpp v50, v50, v50 row_ror:4 row_mask:0xf bank_mask:0xf
    s_nop 1
    v_add_f32_dpp v50, v50, v50 row_ror:2 row_mask:0xf bank_mask:0xf
    s_nop 1
    v_add_f32_dpp v50, v50, v50 row_ror:1 row_mask:0xf bank_mask:0xf
    s_nop 1
    v_add_f32_dpp v50, v50, v50 row_bcast:15 row_mask:0xa bank_mask:0xf
    s_nop 1
    v_add_f32_dpp v50, v50, v50 row_bcast:31 row_mask:0xc bank_mask:0xf
    s_nop 0
    v_readlane_b32 s42, v50, 63
    s_nop 1
    v_mov_b32 v50, s42
    s_mov_b64 exec, 0xff
    buffer_store_dwordx4 v[48:51], v3, s[12:15], s79 offen sc1
    s_mov_b64 exec, -1
x_nq:
    ds_bpermute_b32 v172, v232, v160
    v_and_or_b32 v168, v160, s74, v216
    v_and_or_b32 v169, v161, s74, v217
    v_and_or_b32 v170, v162, s74, v218
    v_and_or_b32 v171, v163, s74, v219
    buffer_store_dwordx4 v[168:171], v220, s[12:15], s22 offen sc1
    v_and_or_b32 v173, v163, s74, v229
    v_and_or_b32 v174, v162, s74, v230
    v_and_or_b32 v175, v161, s74, v231
    s_waitcnt lgkmcnt(0)
    v_and_or_b32 v172, v172, s74, v228
    buffer_store_dwordx4 v[172:175], v234, s[12:15], s22 offen sc1
x_g0e:
    s_barrier
    s_cmp_lt_u32 s16, 4
    s_cbranch_scc1 x_t1
    v_xor_b32 v4, 0, v14
    s_add_u32 s43, s68, 98304
    s_mov_b32 m0, s43
    s_add_u32 s42, s19, 0
    buffer_load_dwordx4 v4, s[8:11], s42 offen nt lds
    v_xor_b32 v4, 64, v14
    s_add_u32 s43, s68, 99328
    s_mov_b32 m0, s43
    s_add_u32 s42, s19, 24576
    buffer_load_dwordx4 v4, s[8:11], s42 offen nt lds
    v_xor_b32 v4, 0, v14
    s_add_u32 s43, s68, 100352
    s_mov_b32 m0, s43
    s_add_u32 s42, s19, 49152
    buffer_load_dwordx4 v4, s[8:11], s42 offen nt lds
    v_xor_b32 v4, 64, v14
    s_add_u32 s43, s68, 101376
    s_mov_b32 m0, s43
    s_add_u32 s42, s19, 73728
    buffer_load_dwordx4 v4, s[8:11], s42 offen nt lds
    v_xor_b32 v4, 128, v14
    s_add_u32 s43, s68, 102400
    s_mov_b32 m0, s43
    s_add_u32 s42, s19, 98304
    buffer_load_dwordx4 v4, s[8:11], s42 offen nt lds
    v_xor_b32 v4, 192, v14
    s_add_u32 s43, s68, 103424
    s_mov_b32 m0, s43
    s_add_u32 s42, s19, 122880
    buffer_load_dwordx4 v4, s[8:11], s42 offen nt lds
    v_xor_b32 v4, 128, v14
    s_add_u32 s43, s68, 104448
    s_mov_b32 m0, s43
    s_add_u32 s42, s19, 147456
    buffer_load_dwordx4 v4, s[8:11], s42 offen nt lds
    v_xor_b32 v4, 192, v14
    s_add_u32 s43, s68, 105472
    s_mov_b32 m0, s43
    s_add_u32 s42, s19, 172032
    buffer_load_dwordx4 v4, s[8:11], s42 offen nt lds
    s_waitcnt vmcnt(0)
    s_barrier
    s_branch x_t2
x_t1:
    s_barrier
    ds_read_b64_tr_b16 v[128:129], v208 offset:0
    ds_read_b64_tr_b16 v[130:131], v208 offset:2048
    ds_read_b64_tr_b16 v[132:133], v209 offset:0
    ds_read_b64_tr_b16 v[134:135], v209 offset:2048
    ds_read_b64_tr_b16 v[136:137], v210 offset:0
    ds_read_b64_tr_b16 v[138:139], v210 offset:2048
    ds_read_b64_tr_b16 v[140:141], v211 offset:0
    ds_read_b64_tr_b16 v[142:143], v211 offset:2048
    ds_read_b64_tr_b16 v[144:145], v208 offset:16384
    ds_read_b64_tr_b16 v[146:147], v208 offset:18432
    ds_read_b64_tr_b16 v[148:149], v209 offset:16384
    ds_read_b64_tr_b16 v[150:151], v209 offset:18432
    ds_read_b64_tr_b16 v[152:153], v210 offset:16384
    ds_read_b64_tr_b16 v[154:155], v210 offset:18432
    s_waitcnt lgkmcnt(12)
    v_mfma_f32_16x16x32_bf16 v[64:67], v[120:123], v[128:131], 0
    ds_read_b64_tr_b16 v[156:157], v211 offset:16384
    ds_read_b64_tr_b16 v[158:159], v211 offset:18432
    s_waitcnt lgkmcnt(12)
    v_mfma_f32_16x16x32_bf16 v[68:71], v[120:123], v[132:135], 0
    s_waitcnt lgkmcnt(10)
    v_mfma_f32_16x16x32_bf16 v[72:75], v[120:123], v[136:139], 0
    s_waitcnt lgkmcnt(8)
    v_mfma_f32_16x16x32_bf16 v[76:79], v[120:123], v[140:143], 0
    s_waitcnt lgkmcnt(6)
    v_mfma_f32_16x16x32_bf16 v[64:67], v[124:127], v[144:147], v[64:67]
    s_waitcnt lgkmcnt(4)
    v_mfma_f32_16x16x32_bf16 v[68:71], v[124:127], v[148:151], v[68:71]
    s_waitcnt lgkmcnt(2)
    v_mfma_f32_16x16x32_bf16 v[72:75], v[124:127], v[152:155], v[72:75]
    s_waitcnt lgkmcnt(0)
    v_mfma_f32_16x16x32_bf16 v[76:79], v[124:127], v[156:159], v[76:79]
    s_nop 3
    v_cndmask_b32 v64, v64, v68, s[60:61]
    s_nop 0
    v_cndmask_b32 v64, v64, v72, s[62:63]
    s_nop 0
    v_cndmask_b32 v64, v64, v76, s[72:73]
    v_and_or_b32 v226, v64, s74, v212
    buffer_store_dword v226, v13, s[12:15], s31 offen offset:0
x_t2:
    s_mov_b32 s83, 0
x_g1:
    s_and_b32 s42, s83, 63
    s_cmp_eq_u32 s42, 63
    s_cselect_b32 s42, 524288, 0
    s_add_u32 s42, s42, s80
    buffer_load_dwordx4 v[32:35], v223, s[12:15], s42 offen offset:2048 sc1
    s_waitcnt vmcnt(0)
    v_xor_b32 v32, v216, v32
    v_xor_b32 v33, v217, v33
    v_xor_b32 v34, v218, v34
    v_xor_b32 v35, v219, v35
    v_or3_b32 v17, v32, v33, 0
    v_or3_b32 v17, v34, v35, v17
    v_and_b32 v17, 0xff, v17
    v_cmp_ne_u32 vcc, 0, v17
    s_cbranch_vccz x_g1x
    s_and_b32 s42, s83, 63
    s_cmp_lg_u32 s42, 48
    s_cbranch_scc1 x_g1n
    s_add_u32 s43, s39, 524288
    buffer_load_dwordx4 v[44:47], v3, s[12:15], s39 offen offset:0 sc1
    s_waitcnt vmcnt(0)
    buffer_store_dwordx4 v[44:47], v3, s[12:15], s43 offen offset:0 sc1
    s_waitcnt vmcnt(0)
    buffer_load_dwordx4 v[44:47], v3, s[12:15], s39 offen offset:1024 sc1
    s_waitcnt vmcnt(0)
    buffer_store_dwordx4 v[44:47], v3, s[12:15], s43 offen offset:1024 sc1
    s_waitcnt vmcnt(0)
    buffer_load_dwordx4 v[44:47], v3, s[12:15], s39 offen offset:2048 sc1
    s_waitcnt vmcnt(0)
    buffer_store_dwordx4 v[44:47], v3, s[12:15], s43 offen offset:2048 sc1
    s_waitcnt vmcnt(0)
x_g1n:
    s_add_u32 s83, s83, 1
    s_cmp_lt_u32 s83, 0x40000
    s_cbranch_scc1 x_g1
x_g1x:
    ds_write_b128 v222, v[32:35] offset:8192
    s_waitcnt lgkmcnt(0)
    s_barrier
    s_cmp_lg_u32 s16, 0
    s_cbranch_scc1 x_g1e
    ds_read_b128 v[160:163], v221 offset:8192
    ds_read_b128 v[164:167], v221 offset:9216
    ds_read_b128 v[168:171], v221 offset:10240
    ds_read_b128 v[172:175], v221 offset:11264
    ds_read_b128 v[176:179], v221 offset:12288
    ds_read_b128 v[180:183], v221 offset:13312
    ds_read_b128 v[184:187], v221 offset:14336
    ds_read_b128 v[188:191], v221 offset:15360
    s_waitcnt lgkmcnt(6)
    v_pk_add_f32 v[160:161], v[160:161], v[164:165]
    v_pk_add_f32 v[162:163], v[162:163], v[166:167]
    s_waitcnt lgkmcnt(4)
    v_pk_add_f32 v[168:169], v[168:169], v[172:173]
    v_pk_add_f32 v[170:171], v[170:171], v[174:175]
    s_waitcnt lgkmcnt(2)
    v_pk_add_f32 v[176:177], v[176:177], v[180:181]
    v_pk_add_f32 v[178:179], v[178:179], v[182:183]
    s_waitcnt lgkmcnt(0)
    v_pk_add_f32 v[184:185], v[184:185], v[188:189]
    v_pk_add_f32 v[186:187], v[186:187], v[190:191]
    v_pk_add_f32 v[160:161], v[160:161], v[168:169]
    v_pk_add_f32 v[176:177], v[176:177], v[184:185]
    v_pk_add_f32 v[162:163], v[162:163], v[170:171]
    v_pk_add_f32 v[178:179], v[178:179], v[186:187]
    v_pk_add_f32 v[160:161], v[160:161], v[176:177]
    v_pk_add_f32 v[162:163], v[162:163], v[178:179]
    v_mov_b32 v164, v160
    v_mov_b32 v165, v161
    v_mov_b32 v166, v162
    v_mov_b32 v167, v163
    v_permlane32_swap_b32 v160, v164
    v_permlane32_swap_b32 v161, v165
    v_permlane32_swap_b32 v162, v166
    v_permlane32_swap_b32 v163, v167
    v_pk_add_f32 v[160:161], v[160:161], v[164:165]
    v_pk_add_f32 v[162:163], v[162:163], v[166:167]
    v_cvt_pk_bf16_f32 v17, v160, v161
    v_lshlrev_b32 v160, 16, v17
    v_and_b32 v161, 0xffff0000, v17
    v_cvt_pk_bf16_f32 v18, v162, v163
    v_lshlrev_b32 v162, 16, v18
    v_and_b32 v163, 0xffff0000, v18
    s_mov_b32 exec_hi, 0
    ds_bpermute_b32 v172, v232, v160
    v_and_or_b32 v168, v160, s74, v216
    v_and_or_b32 v169, v161, s74, v217
    v_and_or_b32 v170, v162, s74, v218
    v_and_or_b32 v171, v163, s74, v219
    buffer_store_dwordx4 v[168:171], v233, s[12:15], s23 offen sc1
    v_and_or_b32 v173, v163, s74, v229
    v_and_or_b32 v174, v162, s74, v230
    v_and_or_b32 v175, v161, s74, v231
    s_waitcnt lgkmcnt(0)
    v_and_or_b32 v172, v172, s74, v228
    buffer_store_dwordx4 v[172:175], v235, s[12:15], s23 offen sc1
    s_mov_b32 exec_hi, -1
x_g1e:
    s_sub_u32 s42, s16, 0
    s_cmp_ge_u32 s42, 3
    s_cbranch_scc1 x_nb
    s_lshl_b32 s42, s42, 10
    s_add_u32 s42, s42, s29
    s_add_u32 s43, s42, 524288
    buffer_load_dwordx4 v[44:47], v3, s[12:15], s42 offen sc1
    s_waitcnt vmcnt(0)
    buffer_store_dwordx4 v[44:47], v3, s[12:15], s43 offen sc1
x_nb:
    s_cmp_lg_u32 s16, 0
    s_cbranch_scc1 g_end
    s_lshl_b32 s78, s34, 14
    s_add_u32 s78, s78, 17039360
    s_lshl_b32 s79, s34, 7
    s_add_u32 s79, s79, 16842752
    v_mov_b32 v22, 0
    s_mov_b32 s56, s48
    s_mov_b32 s57, s49
    s_mov_b32 s58, 2048
    s_mov_b32 s59, 0x00020000
    s_and_b32 s60, s32, 0xffff
    s_lshr_b32 s61, s32, 16
    s_and_b32 s62, s33, 0xffff
    s_lshr_b32 s63, s33, 16
    s_bfe_u32 s44, s32, 524288
    s_bfe_u32 s45, s32, 524296
    s_bfe_u32 s46, s32, 524304
    s_bfe_u32 s47, s32, 524312
    s_bfe_u32 s48, s33, 524288
    s_bfe_u32 s49, s33, 524296
    s_bfe_u32 s50, s33, 524304
    s_bfe_u32 s51, s33, 524312
    v_and_b32 v9, 15, v0
    v_lshlrev_b32 v9, 6, v9
    v_bfe_u32 v19, v0, 4, 1
    v_lshl_add_u32 v9, v19, 5, v9
    v_lshlrev_b32 v18, 9, v19
    v_bfe_u32 v19, v0, 5, 1
    v_lshl_add_u32 v9, v19, 4, v9
    v_lshl_add_u32 v18, v19, 11, v18
    v_bfe_u32 v19, v0, 2, 2
    v_lshl_add_u32 v18, v19, 7, v18
    v_lshl_add_u32 v18, v15, 4, v18
    s_mov_b32 s43, 16908288
    s_lshl_b32 s70, s64, 13
    s_add_u32 s70, s70, 17301504
    s_add_u32 s71, s70, 131072
    s_add_u32 s72, s70, 4096
    s_add_u32 s73, s71, 4096
    v_mov_b32 v21, 0xffff0000
    buffer_load_dwordx4 v[92:95], v9, s[56:59], 0 offen offset:0
    buffer_load_dwordx4 v[96:99], v9, s[56:59], 0 offen offset:1024
    s_mov_b32 s76, s43
    s_sub_u32 s42, s43, 8192
    s_mov_b32 s83, 0
x_cb:
    buffer_load_dwordx4 v[116:119], v18, s[12:15], s42 offen offset:0 sc1
    buffer_load_dwordx4 v[120:123], v18, s[12:15], s42 offen offset:1024 sc1
    buffer_load_dwordx4 v[124:127], v18, s[12:15], s42 offen offset:64 sc1
    buffer_load_dwordx4 v[128:131], v18, s[12:15], s42 offen offset:1088 sc1
    s_waitcnt vmcnt(0)
    v_xor_b32 v116, v216, v116
    v_xor_b32 v117, v217, v117
    v_xor_b32 v118, v218, v118
    v_xor_b32 v119, v219, v119
    v_xor_b32 v120, v216, v120
    v_xor_b32 v121, v217, v121
    v_xor_b32 v122, v218, v122
    v_xor_b32 v123, v219, v123
    v_xor_b32 v124, v216, v124
    v_xor_b32 v125, v217, v125
    v_xor_b32 v126, v218, v126
    v_xor_b32 v127, v219, v127
    v_xor_b32 v128, v216, v128
    v_xor_b32 v129, v217, v129
    v_xor_b32 v130, v218, v130
    v_xor_b32 v131, v219, v131
    v_or3_b32 v19, v116, v117, 0
    v_or3_b32 v19, v118, v119, v19
    v_or3_b32 v19, v120, v121, v19
    v_or3_b32 v19, v122, v123, v19
    v_or3_b32 v19, v124, v125, v19
    v_or3_b32 v19, v126, v127, v19
    v_or3_b32 v19, v128, v129, v19
    v_or3_b32 v19, v130, v131, v19
    v_and_b32 v19, 0xff, v19
    v_cmp_ne_u32 vcc, 0, v19
    s_cbranch_vccz x_cbx
    s_sleep 8
    s_add_u32 s83, s83, 1
    s_cmp_lt_u32 s83, 0x40000
    s_cbranch_scc1 x_cb
x_cbx:
    v_lshlrev_b32 v48, 16, v92
    v_and_b32 v49, 0xffff0000, v92
    v_lshlrev_b32 v50, 16, v93
    v_and_b32 v51, 0xffff0000, v93
    v_lshlrev_b32 v52, 16, v94
    v_and_b32 v53, 0xffff0000, v94
    v_lshlrev_b32 v54, 16, v95
    v_and_b32 v55, 0xffff0000, v95
    v_lshlrev_b32 v56, 16, v96
    v_and_b32 v57, 0xffff0000, v96
    v_lshlrev_b32 v58, 16, v97
    v_and_b32 v59, 0xffff0000, v97
    v_lshlrev_b32 v60, 16, v98
    v_and_b32 v61, 0xffff0000, v98
    v_lshlrev_b32 v62, 16, v99
    v_and_b32 v63, 0xffff0000, v99
    s_mov_b32 s83, 0
    s_mov_b64 exec, 1
x_go:
    buffer_load_dwordx2 v[28:29], v22, s[12:15], s79 offen sc1
    s_waitcnt vmcnt(0)
    v_cmp_ne_u64 vcc, s[32:33], v[28:29]
    s_cbranch_vccz x_goy
    s_sleep 1
    s_add_u32 s83, s83, 1
    s_cmp_lt_u32 s83, 0x40000
    s_cbranch_scc1 x_go
x_goy:
    s_mov_b64 exec, -1
x_gox:
    s_lshl_b32 s42, s65, 13
    s_add_u32 s78, s78, s42
    buffer_load_dwordx4 v[100:103], v18, s[12:15], s76 offen offset:0 sc1
    buffer_load_dwordx4 v[104:107], v18, s[12:15], s76 offen offset:1024 sc1
    buffer_load_dwordx4 v[108:111], v18, s[12:15], s76 offen offset:64 sc1
    buffer_load_dwordx4 v[112:115], v18, s[12:15], s76 offen offset:1088 sc1
    v_lshlrev_b32 v32, 7, v2
    s_xor_b32 s42, s78, 8192
    s_mov_b32 s83, 0
    s_mov_b64 vcc, -1
    s_mov_b64 s[40:41], -1
x_pk:
    s_mov_b64 exec, vcc
    s_cbranch_execz x_pka
    buffer_load_dwordx4 v[24:27], v32, s[12:15], s78 offen sc1
x_pka:
    s_mov_b64 exec, s[40:41]
    s_cbranch_execz x_pkb
    buffer_load_dwordx4 v[28:31], v32, s[12:15], s42 offen sc1
x_pkb:
    s_mov_b64 exec, -1
    s_waitcnt vmcnt(0)
x_pkc:
    v_cmp_ne_u32 vcc, s32, v25
    v_cmp_ne_u32 s[20:21], s33, v27
    v_cmp_ne_u32 s[40:41], s32, v29
    v_cmp_ne_u32 s[22:23], s33, v31
    v_max_u32 v33, v24, v28
    v_min_u32 v34, v24, v28
    s_or_b64 vcc, vcc, s[20:21]
    s_or_b64 s[40:41], s[40:41], s[22:23]
    s_or_b64 s[20:21], vcc, s[40:41]
    s_cbranch_scc0 x_pkx
    s_add_u32 s83, s83, 1
    s_cmp_lt_u32 s83, 0x40000
    s_cbranch_scc1 x_pk
x_pkx:
    v_mov_b32 v35, v33
    v_max3_u32 v34, v34, v26, v30
    s_nop 0
    v_max_u32_dpp v35, v35, v35 row_ror:8 row_mask:0xf bank_mask:0xf
    s_nop 1
    v_max_u32_dpp v35, v35, v35 row_ror:4 row_mask:0xf bank_mask:0xf
    s_nop 1
    v_max_u32_dpp v35, v35, v35 row_ror:2 row_mask:0xf bank_mask:0xf
    s_nop 1
    v_max_u32_dpp v35, v35, v35 row_ror:1 row_mask:0xf bank_mask:0xf
    s_nop 1
    v_max_u32_dpp v35, v35, v35 row_bcast:15 row_mask:0xa bank_mask:0xf
    s_nop 1
    v_max_u32_dpp v35, v35, v35 row_bcast:31 row_mask:0xc bank_mask:0xf
    s_nop 0
    v_readlane_b32 s40, v35, 63
    s_cmp_eq_u32 s65, 0
    s_cbranch_scc1 x_t1st
    v_cmp_eq_u32 vcc, s40, v33
    s_nop 1
    v_cndmask_b32 v35, v33, v34, vcc
    s_nop 1
    v_max_u32_dpp v35, v35, v35 row_ror:8 row_mask:0xf bank_mask:0xf
    s_nop 1
    v_max_u32_dpp v35, v35, v35 row_ror:4 row_mask:0xf bank_mask:0xf
    s_nop 1
    v_max_u32_dpp v35, v35, v35 row_ror:2 row_mask:0xf bank_mask:0xf
    s_nop 1
    v_max_u32_dpp v35, v35, v35 row_ror:1 row_mask:0xf bank_mask:0xf
    s_nop 1
    v_max_u32_dpp v35, v35, v35 row_bcast:15 row_mask:0xa bank_mask:0xf
    s_nop 1
    v_max_u32_dpp v35, v35, v35 row_bcast:31 row_mask:0xc bank_mask:0xf
    s_nop 0
    v_readlane_b32 s41, v35, 63
    s_mov_b32 s40, s41
x_t1st:
    v_mov_b32 v46, s40
    s_bfe_u32 s42, s40, 0x70005
    s_lshl_b32 s42, s42, 13
    s_and_b32 s40, s40, 1
    s_lshl_b32 s40, s40, 12
    s_add_u32 s42, s42, s40
    s_lshr_b32 s43, s42, 5
    s_add_u32 s42, s42, 18874368
    s_add_u32 s43, s43, 17170432
    s_mov_b32 s83, 0
x_ph:
    s_mov_b64 exec, 1
    buffer_load_dwordx4 v[28:31], v22, s[12:15], s43 offen sc1
    s_mov_b64 exec, -1
    buffer_load_dwordx4 v[64:67], v3, s[12:15], s42 offen offset:0 sc1
    buffer_load_dwordx4 v[68:71], v3, s[12:15], s42 offen offset:1024 sc1
    buffer_load_dwordx4 v[72:75], v3, s[12:15], s42 offen offset:2048 sc1
    buffer_load_dwordx4 v[76:79], v3, s[12:15], s42 offen offset:3072 sc1
    s_cmp_lg_u32 s83, 0
    s_cbranch_scc1 x_sbx
x_sb:
    v_xor_b32 v100, v216, v100
    v_xor_b32 v101, v217, v101
    v_xor_b32 v102, v218, v102
    v_xor_b32 v103, v219, v103
    v_xor_b32 v104, v216, v104
    v_xor_b32 v105, v217, v105
    v_xor_b32 v106, v218, v106
    v_xor_b32 v107, v219, v107
    v_xor_b32 v108, v216, v108
    v_xor_b32 v109, v217, v109
    v_xor_b32 v110, v218, v110
    v_xor_b32 v111, v219, v111
    v_xor_b32 v112, v216, v112
    v_xor_b32 v113, v217, v113
    v_xor_b32 v114, v218, v114
    v_xor_b32 v115, v219, v115
    v_or3_b32 v19, v100, v101, 0
    v_or3_b32 v19, v102, v103, v19
    v_or3_b32 v19, v104, v105, v19
    v_or3_b32 v19, v106, v107, v19
    v_or3_b32 v19, v108, v109, v19
    v_or3_b32 v19, v110, v111, v19
    v_or3_b32 v19, v112, v113, v19
    v_or3_b32 v19, v114, v115, v19
    v_and_b32 v19, 0xff, v19
    v_cmp_ne_u32 vcc, 0, v19
    s_cbranch_vccnz x_sr
x_sbx:
    s_waitcnt vmcnt(4)
    v_readfirstlane_b32 s22, v28
    v_readfirstlane_b32 s23, v29
    v_readfirstlane_b32 s20, v30
    v_readfirstlane_b32 s21, v31
    s_xor_b64 s[22:23], s[22:23], s[32:33]
    s_cbranch_scc1 x_pr
    s_waitcnt vmcnt(3)
    v_xor_b32 v64, s44, v64
    v_xor_b32 v65, s45, v65
    v_xor_b32 v66, s46, v66
    v_xor_b32 v67, s47, v67
    v_or3_b32 v19, v64, v65, v66
    v_or_b32 v19, v19, v67
    v_pk_fma_f32 v[64:65], v[64:65], s[20:21], s[20:21] op_sel:[0,1,0] op_sel_hi:[1,1,0]
    v_pk_fma_f32 v[66:67], v[66:67], s[20:21], s[20:21] op_sel:[0,1,0] op_sel_hi:[1,1,0]
    v_cmp_ne_u16_sdwa vcc, v19, v22 src0_sel:BYTE_0 src1_sel:DWORD
    v_pk_fma_f32 v[64:65], v[64:65], v[116:117], v[100:101]
    v_pk_fma_f32 v[66:67], v[66:67], v[118:119], v[102:103]
    v_cvt_pk_bf16_f32 v32, v64, v65
    v_cvt_pk_bf16_f32 v33, v66, v67
    s_cbranch_vccnz x_pr
    v_lshl_or_b32 v64, v32, 16, s60
    v_and_or_b32 v65, v32, v21, s61
    v_lshl_or_b32 v66, v33, 16, s62
    v_and_or_b32 v67, v33, v21, s63
    buffer_store_dwordx4 v[64:67], v3, s[12:15], s70 offen offset:0
    s_waitcnt vmcnt(3)
    v_xor_b32 v68, s48, v68
    v_xor_b32 v69, s49, v69
    v_xor_b32 v70, s50, v70
    v_xor_b32 v71, s51, v71
    v_or3_b32 v19, v68, v69, v70
    v_or_b32 v19, v19, v71
    v_pk_fma_f32 v[68:69], v[68:69], s[20:21], s[20:21] op_sel:[0,1,0] op_sel_hi:[1,1,0]
    v_pk_fma_f32 v[70:71], v[70:71], s[20:21], s[20:21] op_sel:[0,1,0] op_sel_hi:[1,1,0]
    v_cmp_ne_u16_sdwa vcc, v19, v22 src0_sel:BYTE_0 src1_sel:DWORD
    v_pk_fma_f32 v[68:69], v[68:69], v[120:121], v[104:105]
    v_pk_fma_f32 v[70:71], v[70:71], v[122:123], v[106:107]
    v_cvt_pk_bf16_f32 v34, v68, v69
    v_cvt_pk_bf16_f32 v35, v70, v71
    s_cbranch_vccnz x_pr
    v_lshl_or_b32 v68, v34, 16, s60
    v_and_or_b32 v69, v34, v21, s61
    v_lshl_or_b32 v70, v35, 16, s62
    v_and_or_b32 v71, v35, v21, s63
    buffer_store_dwordx4 v[68:71], v3, s[12:15], s70 offen offset:1024
    s_waitcnt vmcnt(3)
    v_xor_b32 v72, s44, v72
    v_xor_b32 v73, s45, v73
    v_xor_b32 v74, s46, v74
    v_xor_b32 v75, s47, v75
    v_or3_b32 v19, v72, v73, v74
    v_or_b32 v19, v19, v75
    v_pk_fma_f32 v[72:73], v[72:73], s[20:21], s[20:21] op_sel:[0,1,0] op_sel_hi:[1,1,0]
    v_pk_fma_f32 v[74:75], v[74:75], s[20:21], s[20:21] op_sel:[0,1,0] op_sel_hi:[1,1,0]
    v_cmp_ne_u16_sdwa vcc, v19, v22 src0_sel:BYTE_0 src1_sel:DWORD
    v_pk_fma_f32 v[72:73], v[72:73], v[124:125], v[108:109]
    v_pk_fma_f32 v[74:75], v[74:75], v[126:127], v[110:111]
    v_cvt_pk_bf16_f32 v36, v72, v73
    v_cvt_pk_bf16_f32 v37, v74, v75
    s_cbranch_vccnz x_pr
    v_lshl_or_b32 v72, v36, 16, s60
    v_and_or_b32 v73, v36, v21, s61
    v_lshl_or_b32 v74, v37, 16, s62
    v_and_or_b32 v75, v37, v21, s63
    buffer_store_dwordx4 v[72:75], v3, s[12:15], s70 offen offset:2048
    s_waitcnt vmcnt(3)
    v_xor_b32 v76, s48, v76
    v_xor_b32 v77, s49, v77
    v_xor_b32 v78, s50, v78
    v_xor_b32 v79, s51, v79
    v_or3_b32 v19, v76, v77, v78
    v_or_b32 v19, v19, v79
    v_pk_fma_f32 v[76:77], v[76:77], s[20:21], s[20:21] op_sel:[0,1,0] op_sel_hi:[1,1,0]
    v_pk_fma_f32 v[78:79], v[78:79], s[20:21], s[20:21] op_sel:[0,1,0] op_sel_hi:[1,1,0]
    v_cmp_ne_u16_sdwa vcc, v19, v22 src0_sel:BYTE_0 src1_sel:DWORD
    v_pk_fma_f32 v[76:77], v[76:77], v[128:129], v[112:113]
    v_pk_fma_f32 v[78:79], v[78:79], v[130:131], v[114:115]
    v_cvt_pk_bf16_f32 v38, v76, v77
    v_cvt_pk_bf16_f32 v39, v78, v79
    s_cbranch_vccnz x_pr
    v_lshl_or_b32 v76, v38, 16, s60
    v_and_or_b32 v77, v38, v21, s61
    v_lshl_or_b32 v78, v39, 16, s62
    v_and_or_b32 v79, v39, v21, s63
    buffer_store_dwordx4 v[76:79], v3, s[12:15], s70 offen offset:3072
x_phx:
    buffer_store_dwordx4 v[64:67], v3, s[12:15], s71 offen offset:0 sc1
    buffer_store_dwordx4 v[68:71], v3, s[12:15], s71 offen offset:1024 sc1
    buffer_store_dwordx4 v[72:75], v3, s[12:15], s71 offen offset:2048 sc1
    buffer_store_dwordx4 v[76:79], v3, s[12:15], s71 offen offset:3072 sc1
    v_lshlrev_b32 v100, 16, v32
    v_and_b32 v101, 0xffff0000, v32
    v_lshlrev_b32 v102, 16, v33
    v_and_b32 v103, 0xffff0000, v33
    v_lshlrev_b32 v104, 16, v34
    v_and_b32 v105, 0xffff0000, v34
    v_lshlrev_b32 v106, 16, v35
    v_and_b32 v107, 0xffff0000, v35
    v_lshlrev_b32 v108, 16, v36
    v_and_b32 v109, 0xffff0000, v36
    v_lshlrev_b32 v110, 16, v37
    v_and_b32 v111, 0xffff0000, v37
    v_lshlrev_b32 v112, 16, v38
    v_and_b32 v113, 0xffff0000, v38
    v_lshlrev_b32 v114, 16, v39
    v_and_b32 v115, 0xffff0000, v39
    v_pk_mul_f32 v[8:9], v[48:49], v[100:101]
    v_pk_fma_f32 v[8:9], v[50:51], v[102:103], v[8:9]
    v_pk_fma_f32 v[8:9], v[52:53], v[104:105], v[8:9]
    v_pk_fma_f32 v[8:9], v[54:55], v[106:107], v[8:9]
    v_pk_fma_f32 v[8:9], v[56:57], v[108:109], v[8:9]
    v_pk_fma_f32 v[8:9], v[58:59], v[110:111], v[8:9]
    v_pk_fma_f32 v[8:9], v[60:61], v[112:113], v[8:9]
    v_pk_fma_f32 v[8:9], v[62:63], v[114:115], v[8:9]
    v_add_f32 v8, v8, v9
    s_nop 1
    v_add_f32_dpp v8, v8, v8 row_ror:8 row_mask:0xf bank_mask:0xf
    s_nop 1
    v_add_f32_dpp v8, v8, v8 row_ror:4 row_mask:0xf bank_mask:0xf
    s_nop 1
    v_add_f32_dpp v8, v8, v8 row_ror:2 row_mask:0xf bank_mask:0xf
    s_nop 1
    v_add_f32_dpp v8, v8, v8 row_ror:1 row_mask:0xf bank_mask:0xf
    s_nop 1
    v_add_f32_dpp v8, v8, v8 row_bcast:15 row_mask:0xa bank_mask:0xf
    s_nop 1
    v_add_f32_dpp v8, v8, v8 row_bcast:31 row_mask:0xc bank_mask:0xf
    v_cvt_pk_bf16_f32 v8, v8, v8
    v_lshlrev_b32 v8, 16, v8
    v_mul_f32 v8, 0xbfb8aa3b, v8
    v_exp_f32 v8, v8
    s_nop 0
    v_add_f32 v8, 1.0, v8
    v_rcp_f32 v8, v8
    s_nop 0
    v_cvt_pk_bf16_f32 v8, v8, v8
    v_lshlrev_b32 v8, 16, v8
    s_nop 0
    v_readlane_b32 s46, v8, 63
    v_mov_b32 v44, s32
    v_mov_b32 v45, s33
    v_mov_b32 v47, s46
    s_mov_b64 exec, 0xff
    buffer_store_dwordx4 v[44:47], v3, s[12:15], s73 offen sc1
    s_mov_b64 exec, -1
    s_sleep 20
r_start:
    s_lshl_b32 s62, s34, 1
    s_lshr_b32 s42, s34, 2
    s_add_u32 s62, s62, s42
    s_lshl_b32 s62, s62, 13
    s_add_u32 s62, s62, 17432576
    s_add_u32 s61, s62, 4096
    s_and_b32 s18, s34, 3
    s_lshl_b32 s18, s18, 4
    s_add_u32 s18, s18, s35
    v_mov_b32 v11, 0
    v_and_b32 v4, 3, v0
    v_lshrrev_b32 v7, 4, v2
    v_lshlrev_b32 v5, 3, v4
    v_lshl_add_u32 v5, v7, 1, v5
    v_lshlrev_b32 v6, 10, v4
    v_lshl_add_u32 v6, v7, 2, v6
    v_lshrrev_b32 v86, 1, v4
    v_lshlrev_b32 v86, 9, v86
    v_and_b32 v87, 1, v4
    v_lshl_add_u32 v85, v87, 10, v86
    v_lshl_add_u32 v85, v7, 2, v85
    s_and_b32 s30, s18, 1
    s_bfe_u32 s31, s18, 0x20001
    s_bfe_u32 s40, s18, 0x20003
    s_lshr_b32 s41, s18, 5
    s_lshl_b32 s45, s41, 11
    s_lshl_b32 s42, s30, 8
    s_add_u32 s45, s45, s42
    s_lshl_b32 s42, s40, 6
    s_add_u32 s45, s45, s42
    s_lshl_b32 s31, s31, 4
    s_add_u32 s45, s45, s31
    s_add_u32 s62, s62, s45
    s_lshl_b32 s30, s30, 9
    s_add_u32 s31, s31, s30
    s_lshl_b32 s40, s40, 7
    s_add_u32 s31, s31, s40
    s_lshl_b32 s41, s41, 6
    s_add_u32 s31, s31, s41
    s_add_u32 s31, s31, 16916480
    s_mov_b32 s83, 0
r_ld:
    s_mov_b64 exec, 1
    buffer_load_dwordx4 v[32:35], v11, s[12:15], s61 offen sc1
    s_mov_b64 exec, -1
    buffer_load_dword v41, v85, s[12:15], s62 offen sc1
    buffer_load_dword v91, v6, s[12:15], s31 offen sc1
    s_bitcmp1_b32 s18, 1
    s_cselect_b32 s42, s33, s32
    v_lshlrev_b32 v88, 3, v7
    v_lshrrev_b32_e64 v88, v88, s42
    v_and_b32 v88, 0xff, v88
    v_lshlrev_b32 v89, 4, v7
    v_lshrrev_b64 v[82:83], v89, s[32:33]
    v_and_b32 v82, 0xffff, v82
    s_waitcnt vmcnt(0)
    v_readfirstlane_b32 s50, v32
    v_readfirstlane_b32 s51, v33
    v_readfirstlane_b32 s40, v34
    v_readfirstlane_b32 s46, v35
    v_xor_b32 v91, v88, v91
    v_xor_b32 v41, v82, v41
    v_or_b32 v19, v91, v41
    v_cmp_ne_u16 vcc, 0, v19
    s_xor_b64 s[50:51], s[50:51], s[32:33]
    s_or_b64 vcc, vcc, s[50:51]
    s_cbranch_vccz r_ldx
    s_sleep 2
    s_add_u32 s83, s83, 1
    s_cmp_lt_u32 s83, 0x40000
    s_cbranch_scc1 r_ld
r_ldx:
    v_mul_f32 v80, s46, v91
    s_bfe_u32 s46, s40, 0x70005
    s_bfe_u32 s47, s40, 0x30002
    s_bfe_u32 s60, s40, 0x10001
    s_bfe_u32 s63, s40, 0x70005
    s_lshl_b32 s63, s63, 13
    s_and_b32 s40, s40, 1
    s_lshl_b32 s40, s40, 12
    s_add_u32 s63, s63, s40
    s_add_u32 s63, s63, s45
    s_add_u32 s63, s63, 18874368
    buffer_load_dword v44, v85, s[12:15], s63 offen sc1
    v_lshrrev_b32 v10, 2, v2
    v_lshlrev_b32 v10, 7, v10
    v_lshl_add_u32 v10, v4, 4, v10
    s_lshl_b32 s44, s18, 13
    s_and_b32 s42, s34, 4
    s_lshl_b32 s42, s42, 4
    s_add_u32 s44, s44, s42
    s_add_u32 s44, s44, 17825792
    s_add_u32 s45, s44, 4096
    s_lshr_b32 s61, s46, 4
    s_and_b32 s41, s46, 15
    s_lshl_b32 s41, s41, 4
    s_add_u32 s41, s41, s61
    s_lshr_b32 s61, s46, 3
    s_cmp_eq_u32 s61, 1
    s_cselect_b32 s61, 120, 0
    s_sub_u32 s41, s41, s61
    s_lshl_b32 s61, s47, 8
    s_add_u32 s41, s41, s61
    s_cmp_ge_u32 s47, 4
    s_cselect_b32 s61, 896, 0
    s_cmp_eq_u32 s46, 0
    s_cselect_b32 s61, s61, 0
    s_sub_u32 s41, s41, s61
    s_sub_u32 s61, 2048, s41
    s_cmp_eq_u32 s41, 0
    s_cselect_b32 s61, 1024, s61
    s_cmp_eq_u32 s60, 1
    s_cselect_b32 s41, s61, s41
    s_lshl_b32 s41, s41, 11
    s_lshl_b32 s61, s18, 5
    s_add_u32 s41, s41, s61
    s_mov_b64 exec, 1
    buffer_load_dword v245, v5, s[24:27], s41 offen
    s_mov_b64 exec, -1
    s_waitcnt vmcnt(1)
    v_and_b32 v44, 0xffffff00, v44
    v_fmac_f32 v44, v91, v41
    v_mov_b32 v28, v216
    v_mov_b32 v29, v217
    v_mov_b32 v30, v218
    v_mov_b32 v31, v219
    s_sleep 24
    s_mov_b32 s83, 0
    s_mov_b64 s[64:65], -1
    s_mov_b64 s[66:67], -1
    s_mov_b64 s[68:69], -1
    s_mov_b32 s70, -1
    s_mov_b32 s71, 0
r_p:
    s_mov_b64 exec, s[64:65]
    s_cbranch_execz r_q0
    buffer_load_dwordx4 v[16:19], v10, s[12:15], s44 offen offset:0 sc1
r_q0:
    s_mov_b64 exec, s[66:67]
    s_cbranch_execz r_q1
    buffer_load_dwordx4 v[20:23], v10, s[12:15], s44 offen offset:2048 sc1
r_q1:
    s_mov_b64 exec, s[68:69]
    s_cbranch_execz r_q2
    buffer_load_dwordx4 v[24:27], v10, s[12:15], s45 offen offset:0 sc1
r_q2:
    s_mov_b64 exec, s[70:71]
    s_cbranch_execz r_q3
    buffer_load_dwordx4 v[28:31], v10, s[12:15], s45 offen offset:2048 sc1
r_q3:
    s_mov_b64 exec, -1
    s_waitcnt vmcnt(0)
    v_xor_b32 v48, v216, v16
    v_xor_b32 v49, v217, v17
    v_xor_b32 v50, v218, v18
    v_xor_b32 v51, v219, v19
    v_xor_b32 v52, v216, v20
    v_xor_b32 v53, v217, v21
    v_xor_b32 v54, v218, v22
    v_xor_b32 v55, v219, v23
    v_xor_b32 v56, v216, v24
    v_xor_b32 v57, v217, v25
    v_xor_b32 v58, v218, v26
    v_xor_b32 v59, v219, v27
    v_xor_b32 v60, v216, v28
    v_xor_b32 v61, v217, v29
    v_xor_b32 v62, v218, v30
    v_xor_b32 v63, v219, v31
    v_or3_b32 v12, v48, v49, v50
    v_or3_b32 v13, v52, v53, v54
    v_or3_b32 v14, v56, v57, v58
    v_or3_b32 v15, v60, v61, v62
    v_or_b32 v12, v12, v51
    v_or_b32 v13, v13, v55
    v_or_b32 v14, v14, v59
    v_or_b32 v15, v15, v63
    v_pk_add_f32 v[48:49], v[48:49], v[52:53]
    v_pk_add_f32 v[56:57], v[56:57], v[60:61]
    v_pk_add_f32 v[50:51], v[50:51], v[54:55]
    v_pk_add_f32 v[58:59], v[58:59], v[62:63]
    v_cmp_ne_u16_sdwa s[64:65], v12, v11 src0_sel:BYTE_0 src1_sel:DWORD
    v_cmp_ne_u16_sdwa s[66:67], v13, v11 src0_sel:BYTE_0 src1_sel:DWORD
    v_cmp_ne_u16_sdwa s[68:69], v14, v11 src0_sel:BYTE_0 src1_sel:DWORD
    v_cmp_ne_u16_sdwa s[70:71], v15, v11 src0_sel:BYTE_0 src1_sel:DWORD
    v_pk_add_f32 v[48:49], v[48:49], v[56:57]
    v_pk_add_f32 v[50:51], v[50:51], v[58:59]
    s_or_b64 s[50:51], s[64:65], s[66:67]
    s_or_b64 s[52:53], s[68:69], s[70:71]
    s_or_b64 s[50:51], s[50:51], s[52:53]
    s_cbranch_scc1 r_r
r_x:
    v_permlane32_swap_b32 v48, v50
    v_permlane32_swap_b32 v49, v51
    v_pk_add_f32 v[48:49], v[48:49], v[50:51]
    s_nop 1
    v_permlane16_swap_b32 v48, v49
    v_add_f32 v48, v48, v49
    s_nop 1
    v_add_f32_dpp v48, v48, v48 row_ror:4 row_mask:0xf bank_mask:0xf
    s_nop 1
    v_add_f32_dpp v48, v48, v48 row_ror:8 row_mask:0xf bank_mask:0xf
    v_fmac_f32 v44, v48, v80
    s_mov_b32 exec_lo, 0x000f000f
    s_mov_b32 exec_hi, 0x000f000f
    v_cvt_pk_bf16_f32 v44, v44, v44
    buffer_store_short v44, v5, s[24:27], s41 offen
    s_endpgm
x_pr:
    s_waitcnt vmcnt(0)
    s_add_u32 s83, s83, 1
    s_cmp_lt_u32 s83, 0x40000
    s_cbranch_scc1 x_ph
    s_branch x_phx
x_sr:
    buffer_load_dwordx4 v[100:103], v18, s[12:15], s76 offen offset:0 sc1
    buffer_load_dwordx4 v[104:107], v18, s[12:15], s76 offen offset:1024 sc1
    buffer_load_dwordx4 v[108:111], v18, s[12:15], s76 offen offset:64 sc1
    buffer_load_dwordx4 v[112:115], v18, s[12:15], s76 offen offset:1088 sc1
    s_waitcnt vmcnt(0)
    s_sleep 2
    s_add_u32 s83, s83, 1
    s_cmp_lt_u32 s83, 0x40000
    s_cbranch_scc1 x_sb
    s_branch x_sbx
r_r:
    s_add_u32 s83, s83, 1
    s_cmp_lt_u32 s83, 0x40000
    s_cbranch_scc1 r_p
    s_branch r_x
f_start:
    s_mov_b32 s20, s26
    s_mov_b32 s21, s27
    s_mov_b32 s26, 4194304
    s_mov_b32 s27, 0x00020000
    s_mov_b32 s22, s50
    s_mov_b32 s23, s51
    s_mov_b32 s28, s54
    s_mov_b32 s29, s55
    s_add_u32 s58, s36, tables-h_pc
    s_addc_u32 s59, s37, 0
    s_lshr_b32 s36, s35, 1
    s_and_b32 s36, s36, 4
    s_xor_b32 s36, s36, s16
    s_and_b32 s37, s34, 4
    s_xor_b32 s37, s37, s16
    s_lshl_b32 s3, s34, 4
    s_add_u32 s3, s3, s35
    v_and_b32 v4, 15, v0
    v_bfe_u32 v5, v0, 4, 2
    v_lshrrev_b32 v248, 3, v2
    v_lshlrev_b32 v248, 18, v248
    v_lshlrev_b32 v249, 1, v5
    v_xor_b32 v249, v249, v0
    v_and_b32 v249, 7, v249
    v_lshl_add_u32 v255, v249, 4, v248
    v_lshlrev_b32 v6, 16, v5
    v_lshl_add_u32 v6, v4, 4, v6
    s_lshl_b32 s60, s16, 15
    s_lshl_b32 s61, s34, 11
    s_add_u32 s60, s60, s61
    s_lshl_b32 s61, s35, 7
    s_add_u32 s60, s60, s61
    s_lshl_b32 s61, s16, 12
    s_add_u32 s61, s61, 61440
    s_lshl_b32 s64, s36, 19
    s_lshl_b32 s65, s35, 3
    s_and_b32 s66, s34, 1
    s_lshl_b32 s66, s66, 2
    s_add_u32 s65, s65, s66
    s_lshr_b32 s66, s34, 1
    s_add_u32 s65, s65, s66
    s_lshl_b32 s65, s65, 8
    s_add_u32 s64, s64, s65
    s_add_u32 s64, s64, 1048576
    s_add_u32 s65, s64, 32768
    s_add_u32 s66, s64, 262144
    s_add_u32 s67, s64, 294912
    s_barrier
    s_cmp_eq_u32 s36, 0
    s_cselect_b32 s42, 2048, 0
    v_add_u32 v248, s42, v3
    global_load_dwordx4 v[236:239], v248, s[58:59]
    global_load_dwordx4 v[240:243], v248, s[58:59] offset:1024
    s_lshr_b32 s42, s3, 4
    s_and_b32 s30, s3, 15
    s_lshl_b32 s30, s30, 4
    s_add_u32 s30, s30, s42
    s_lshr_b32 s42, s3, 3
    s_cmp_eq_u32 s42, 1
    s_cselect_b32 s42, 120, 0
    s_sub_u32 s30, s30, s42
    s_lshl_b32 s42, s16, 8
    s_add_u32 s30, s30, s42
    s_cmp_ge_u32 s16, 4
    s_cselect_b32 s42, 896, 0
    s_cmp_eq_u32 s3, 0
    s_cselect_b32 s42, s42, 0
    s_sub_u32 s30, s30, s42
    s_sub_u32 s31, 2048, s30
    s_cmp_eq_u32 s30, 0
    s_cselect_b32 s31, 1024, s31
    s_lshl_b32 s18, s30, 11
    s_lshl_b32 s19, s31, 11
    s_sub_u32 s75, s19, 2048
    s_lshl_b32 s68, s16, 12
    s_add_u32 s68, s68, 126976
    v_bfe_u32 v248, v0, 2, 1
    v_bfe_u32 v249, v0, 3, 2
    v_lshlrev_b32 v249, 2, v249
    v_lshl_add_u32 v248, v248, 4, v249
    v_and_or_b32 v248, v0, 3, v248
    v_bfe_u32 v249, v0, 5, 3
    v_cvt_f32_u32 v248, v248
    v_cvt_f32_u32 v249, v249
    s_cmp_lt_u32 s16, 4
    s_mov_b32 s42, 0x3d000000
    s_cselect_b32 s42, s42, 0x3a800000
    v_mul_f32 v248, s42, v248
    v_mul_f32 v249, 4.0, v249
    v_mul_f32 v152, v248, v249
    v_add_f32 v153, v152, v248
    v_add_f32 v154, v153, v248
    v_add_f32 v155, v154, v248
    v_sin_f32 v156, v152
    v_sin_f32 v157, v153
    v_sin_f32 v158, v154
    v_sin_f32 v159, v155
    v_cos_f32 v152, v152
    v_cos_f32 v153, v153
    v_cos_f32 v154, v154
    v_cos_f32 v155, v155
    s_cbranch_scc0 f_tw
    v_cvt_pk_f16_f32 v160, v152, v156
    v_cvt_pk_f16_f32 v156, -v156, v152
    v_mov_b32 v152, v160
    v_cvt_pk_f16_f32 v160, v153, v157
    v_cvt_pk_f16_f32 v157, -v157, v153
    v_mov_b32 v153, v160
    v_cvt_pk_f16_f32 v160, v154, v158
    v_cvt_pk_f16_f32 v158, -v158, v154
    v_mov_b32 v154, v160
    v_cvt_pk_f16_f32 v160, v155, v159
    v_cvt_pk_f16_f32 v159, -v159, v155
    v_mov_b32 v155, v160
f_tw:
    s_and_b32 s42, s16, 4
    s_add_u32 s42, s42, s16
    s_lshl_b32 s42, s42, 10
    v_add_u32 v248, s42, v3
    ds_write_b128 v248, v[152:155] offset:0
    ds_write_b128 v248, v[156:159] offset:4096
    v_lshrrev_b32 v248, 1, v4
    v_and_b32 v249, 1, v0
    v_cmp_eq_u32 vcc, 1, v4
    s_nop 1
    v_cndmask_b32_e64 v250, v248, 0, vcc
    v_cndmask_b32_e64 v248, v248, 8, vcc
    v_cndmask_b32_e64 v249, v249, 0, vcc
    v_mad_u32_u24 v251, v248, v5, v249
    v_lshlrev_b32 v251, 5, v251
    v_mad_u32_u24 v251, v250, v1, v251
    v_cvt_f32_u32 v248, v248
    v_cvt_f32_u32 v250, v250
    v_cvt_f32_u32 v251, v251
    v_mul_f32 v248, 0x3d800000, v248
    v_mul_f32 v250, 0x3b800000, v250
    v_mul_f32 v216, 0x3c000000, v251
    v_add_f32 v217, v216, v248
    v_add_f32 v218, v217, v248
    v_add_f32 v219, v218, v248
    v_add_f32 v220, v216, v250
    v_add_f32 v221, v217, v250
    v_add_f32 v222, v218, v250
    v_add_f32 v223, v219, v250
    v_cos_f32 v216, v216
    v_cos_f32 v217, v217
    v_cos_f32 v218, v218
    v_cos_f32 v219, v219
    v_cos_f32 v220, v220
    v_cos_f32 v221, v221
    v_cos_f32 v222, v222
    v_cos_f32 v223, v223
    v_lshrrev_b32 v248, 2, v2
    v_lshlrev_b32 v8, 7, v248
    v_bfe_u32 v248, v0, 3, 2
    v_lshl_add_u32 v8, v248, 5, v8
    v_and_b32 v248, 3, v0
    v_lshl_add_u32 v8, v248, 3, v8
    v_lshl_add_u32 v8, v1, 12, v8
    v_xor_b32 v9, 32, v8
    v_xor_b32 v10, 64, v8
    v_xor_b32 v11, 96, v8
    v_lshlrev_b32 v12, 13, v5
    v_lshl_add_u32 v12, v4, 4, v12
    v_lshlrev_b32 v7, 5, v5
    v_and_b32 v248, 1, v0
    v_lshl_add_u32 v7, v248, 10, v7
    v_and_b32 v248, 2, v0
    v_lshl_add_u32 v7, v248, 3, v7
    s_lshl_b32 s70, s34, 11
    s_lshl_b32 s71, s16, 7
    s_add_u32 s71, s71, s70
    s_add_u32 s71, s71, 16777216
    s_lshl_b32 s42, s16, 7
    s_add_u32 s42, s42, 94208
    v_lshlrev_b32 v213, 3, v4
    v_lshl_add_u32 v212, v5, 13, v213
    v_add_u32 v212, s42, v212
    s_lshl_b32 s42, s36, 12
    s_add_u32 s42, s42, 94208
    v_lshl_add_u32 v213, v5, 8, v213
    v_and_b32 v214, 16, v0
    v_lshl_add_u32 v213, v214, 3, v213
    v_add_u32 v213, s42, v213
    v_xor_b32 v214, 128, v213
    s_mov_b32 s4, 0x3f803f80
    s_mov_b32 s5, 0x3a800000
    s_waitcnt vmcnt(6)
    s_load_dwordx2 s[32:33], s[20:21], 0
    v_dot2_f32_bf16 v108, v64, s4, 0
    v_dot2_f32_bf16 v110, v64, v64, 0
    v_dot2_f32_bf16 v108, v65, s4, v108
    v_dot2_f32_bf16 v110, v65, v65, v110
    v_dot2_f32_bf16 v108, v66, s4, v108
    v_dot2_f32_bf16 v110, v66, v66, v110
    v_dot2_f32_bf16 v108, v67, s4, v108
    v_dot2_f32_bf16 v110, v67, v67, v110
    s_waitcnt vmcnt(5)
    v_dot2_f32_bf16 v109, v72, s4, 0
    v_dot2_f32_bf16 v111, v72, v72, 0
    v_dot2_f32_bf16 v109, v73, s4, v109
    v_dot2_f32_bf16 v111, v73, v73, v111
    v_dot2_f32_bf16 v109, v74, s4, v109
    v_dot2_f32_bf16 v111, v74, v74, v111
    v_dot2_f32_bf16 v109, v75, s4, v109
    v_dot2_f32_bf16 v111, v75, v75, v111
    s_waitcnt vmcnt(4)
    v_dot2_f32_bf16 v108, v68, s4, v108
    v_dot2_f32_bf16 v110, v68, v68, v110
    v_dot2_f32_bf16 v108, v69, s4, v108
    v_dot2_f32_bf16 v110, v69, v69, v110
    v_dot2_f32_bf16 v108, v70, s4, v108
    v_dot2_f32_bf16 v110, v70, v70, v110
    v_dot2_f32_bf16 v108, v71, s4, v108
    v_dot2_f32_bf16 v110, v71, v71, v110
    s_waitcnt vmcnt(3)
    v_dot2_f32_bf16 v109, v76, s4, v109
    v_dot2_f32_bf16 v111, v76, v76, v111
    v_dot2_f32_bf16 v109, v77, s4, v109
    v_dot2_f32_bf16 v111, v77, v77, v111
    v_dot2_f32_bf16 v109, v78, s4, v109
    v_dot2_f32_bf16 v111, v78, v78, v111
    v_dot2_f32_bf16 v109, v79, s4, v109
    v_dot2_f32_bf16 v111, v79, v79, v111
    s_nop 1
    v_permlane32_swap_b32 v108, v109
    v_permlane32_swap_b32 v110, v111
    v_add_f32 v108, v108, v109
    v_add_f32 v110, v110, v111
    s_nop 0
    v_add_f32_dpp v108, v108, v108 row_ror:8 row_mask:0xf bank_mask:0xf
    v_add_f32_dpp v110, v110, v110 row_ror:8 row_mask:0xf bank_mask:0xf
    s_nop 0
    v_add_f32_dpp v108, v108, v108 row_ror:4 row_mask:0xf bank_mask:0xf
    v_add_f32_dpp v110, v110, v110 row_ror:4 row_mask:0xf bank_mask:0xf
    s_nop 0
    v_add_f32_dpp v108, v108, v108 row_ror:2 row_mask:0xf bank_mask:0xf
    v_add_f32_dpp v110, v110, v110 row_ror:2 row_mask:0xf bank_mask:0xf
    s_nop 0
    v_add_f32_dpp v108, v108, v108 row_ror:1 row_mask:0xf bank_mask:0xf
    v_add_f32_dpp v110, v110, v110 row_ror:1 row_mask:0xf bank_mask:0xf
    s_nop 0
    v_add_f32_dpp v108, v108, v108 row_bcast:15 row_mask:0xa bank_mask:0xf
    v_add_f32_dpp v110, v110, v110 row_bcast:15 row_mask:0xa bank_mask:0xf
    v_mul_f32 v108, s5, v108
    v_mul_f32 v110, s5, v110
    v_mul_f32 v116, v108, v108
    v_cvt_pk_bf16_f32 v117, -v108, -v108
    v_sub_f32 v110, v110, v116
    v_mul_f32 v118, 0x44000000, v110
    v_cmp_gt_f32 vcc, v116, v118
    v_readlane_b32 s40, v117, 31
    s_or_b32 s41, vcc_lo, vcc_hi
    s_bitcmp1_b32 s41, 31
    s_cbranch_scc1 f_slowvar
f_var:
    v_cvt_pk_bf16_f32 v110, v110, v110
    v_lshlrev_b32 v110, 16, v110
    v_add_f32 v110, 0x3727c5ac, v110
    v_cvt_pk_bf16_f32 v110, v110, v110
    v_lshlrev_b32 v110, 16, v110
    v_sqrt_f32 v110, v110
    s_and_b32 s40, s40, 0xffff
    v_mov_b32 v114, 0xffff0000
    v_cvt_pk_bf16_f32 v110, v110, v110
    v_lshlrev_b32 v110, 16, v110
    v_mul_f32 v110, 0x41800000, v110
    v_and_or_b32 v114, v117, v114, s40
    v_rcp_f32 v113, v110
    s_waitcnt lgkmcnt(0)
    s_cmp_lg_u32 s32, 0
    s_cbranch_scc1 f_nnx
    s_load_dwordx2 s[32:33], s[20:21], 64
    s_mov_b32 s83, 0
    v_mov_b32 v122, 0
    s_waitcnt lgkmcnt(0)
f_nn:
    s_cmp_lg_u32 s32, 0
    s_cbranch_scc1 f_nnx
    global_load_dwordx2 v[120:121], v122, s[20:21] sc1
    s_waitcnt vmcnt(0)
    v_readfirstlane_b32 s32, v120
    v_readfirstlane_b32 s33, v121
    s_add_u32 s83, s83, 1
    s_cmp_lt_u32 s83, 0x40000
    s_cbranch_scc1 f_nn
f_nnx:
    v_mov_b32 v115, s32
    v_mov_b32_dpp v112, v113 row_bcast:31 row_mask:0xc bank_mask:0xf
    v_mov_b32 v116, 0
    s_mov_b32 exec_lo, 0
    s_mov_b32 exec_hi, 0x80000000
    buffer_store_dwordx4 v[112:115], v116, s[12:15], s62 offen
    v_lshlrev_b32 v117, 4, v1
    v_add_u32 v117, 160768, v117
    ds_write_b128 v117, v[112:115]
    s_mov_b64 exec, -1
    s_mov_b32 m0, s61
    s_add_u32 s42, s60, 0
    s_add_u32 s61, s61, 1024
    buffer_load_dwordx4 v255, s[8:11], s42 offen lds
    s_mov_b32 m0, s61
    s_add_u32 s42, s60, 2097152
    s_add_u32 s61, s61, 1024
    buffer_load_dwordx4 v255, s[8:11], s42 offen lds
    s_mov_b32 m0, s61
    s_add_u32 s42, s60, 16384
    s_add_u32 s61, s61, 1024
    buffer_load_dwordx4 v255, s[8:11], s42 offen lds
    s_mov_b32 m0, s61
    s_add_u32 s42, s60, 2113536
    s_add_u32 s61, s61, 1024
    buffer_load_dwordx4 v255, s[8:11], s42 offen lds
    v_add_u32 v248, s68, v3
    ds_write_b128 v248, v[64:67] offset:0
    ds_write_b128 v248, v[68:71] offset:1024
    v_mov_b32 v244, s32
    v_mov_b32 v245, s33
    v_and_b32 v248, 4, v0
    v_cmp_eq_u32 vcc, 4, v248
    v_and_b32 v248, 3, v0
    v_lshlrev_b32 v248, 2, v248
    v_cndmask_b32 v244, v244, v245, vcc
    v_lshrrev_b32 v244, v248, v244
    s_mov_b32 s54, 0x00010001
    s_mov_b32 s55, 0xfffefffe
    s_mov_b32 s46, 0x05040100
    s_mov_b32 s47, 0x07060302
    v_lshrrev_b32 v245, 1, v244
    v_lshrrev_b32 v246, 2, v244
    v_lshrrev_b32 v247, 3, v244
    v_and_b32 v244, s54, v244
    v_and_b32 v245, s54, v245
    v_and_b32 v246, s54, v246
    v_and_b32 v247, s54, v247
    s_waitcnt vmcnt(2)
    s_mov_b32 exec_lo, 0x000f000f
    s_mov_b32 exec_hi, 0x000f000f
    buffer_load_dwordx4 v[24:27], v7, s[12:15], s71 offen sc1
    s_mov_b64 exec, -1
    s_mov_b32 s83, 0
    s_waitcnt vmcnt(1)
    ds_read_b64_tr_b16 v[40:41], v8 offset:61440
    ds_read_b64_tr_b16 v[42:43], v9 offset:61440
    ds_read_b64_tr_b16 v[44:45], v10 offset:61440
    ds_read_b64_tr_b16 v[46:47], v11 offset:61440
    ds_read_b64_tr_b16 v[48:49], v8 offset:63488
    ds_read_b64_tr_b16 v[50:51], v9 offset:63488
    ds_read_b64_tr_b16 v[52:53], v10 offset:63488
    ds_read_b64_tr_b16 v[54:55], v11 offset:63488
    s_mov_b32 exec_lo, 0x000f000f
    s_mov_b32 exec_hi, 0x000f000f
f_st:
    s_waitcnt vmcnt(0)
    v_cmp_ne_u32 vcc, s32, v27
    s_mov_b64 exec, -1
    s_cbranch_vccnz f_str
f_stx:
    s_setprio 3
    v_mov_b32_dpp v32, v26 row_newbcast:0 row_mask:0xf bank_mask:0xf
    v_mov_b32_dpp v33, v26 row_newbcast:1 row_mask:0xf bank_mask:0xf
    v_mov_b32_dpp v34, v26 row_newbcast:2 row_mask:0xf bank_mask:0xf
    v_mov_b32_dpp v35, v26 row_newbcast:3 row_mask:0xf bank_mask:0xf
    v_mul_f32_dpp v216, v24, v216 row_newbcast:0 row_mask:0xf bank_mask:0xf
    v_mul_f32_dpp v217, v24, v217 row_newbcast:1 row_mask:0xf bank_mask:0xf
    v_mul_f32_dpp v218, v24, v218 row_newbcast:2 row_mask:0xf bank_mask:0xf
    v_mul_f32_dpp v219, v24, v219 row_newbcast:3 row_mask:0xf bank_mask:0xf
    v_perm_b32 v28, v33, v32, s46
    v_perm_b32 v29, v35, v34, s46
    v_cvt_pk_bf16_f32 v224, v216, v217
    v_cvt_pk_bf16_f32 v225, v218, v219
    s_nop 1
    v_mfma_f32_16x16x16_bf16 v[228:231], v[224:225], v[28:29], 0
    v_mul_f32_dpp v220, v25, v220 row_newbcast:0 row_mask:0xf bank_mask:0xf
    v_mul_f32_dpp v221, v25, v221 row_newbcast:1 row_mask:0xf bank_mask:0xf
    v_mul_f32_dpp v222, v25, v222 row_newbcast:2 row_mask:0xf bank_mask:0xf
    v_mul_f32_dpp v223, v25, v223 row_newbcast:3 row_mask:0xf bank_mask:0xf
    v_perm_b32 v30, v33, v32, s47
    v_perm_b32 v31, v35, v34, s47
    v_cvt_pk_bf16_f32 v226, v220, v221
    v_cvt_pk_bf16_f32 v227, v222, v223
    s_nop 1
    v_mfma_f32_16x16x16_bf16 v[232:235], v[226:227], v[30:31], 0
    s_waitcnt lgkmcnt(0)
    v_mfma_f32_16x16x16_bf16 v[56:59], v[224:225], v[40:41], v[228:231]
    v_mfma_f32_16x16x16_bf16 v[60:63], v[226:227], v[48:49], v[232:235]
    v_mfma_f32_16x16x16_bf16 v[64:67], v[224:225], v[42:43], v[228:231]
    v_mfma_f32_16x16x16_bf16 v[68:71], v[226:227], v[50:51], v[232:235]
    s_mov_b32 m0, s68
    s_cmp_eq_u32 s34, 0
    s_cbranch_scc1 f_r0
f_nr:
    buffer_load_dwordx4 v3, s[8:11], s75 offen offset:2048 lds
    buffer_load_dwordx4 v3, s[8:11], s75 offen offset:3072 lds
    v_mfma_f32_16x16x16_bf16 v[72:75], v[224:225], v[44:45], v[228:231]
    v_mfma_f32_16x16x16_bf16 v[76:79], v[226:227], v[52:53], v[232:235]
    v_cvt_pk_f16_f32 v184, v56, v57
    v_cvt_pk_f16_f32 v185, v60, v61
    ds_write_b64 v212, v[184:185] offset:0
    v_cvt_pk_f16_f32 v186, v58, v59
    v_cvt_pk_f16_f32 v187, v62, v63
    ds_write_b64 v212, v[186:187] offset:4096
    v_mfma_f32_16x16x16_bf16 v[80:83], v[224:225], v[46:47], v[228:231]
    v_mfma_f32_16x16x16_bf16 v[84:87], v[226:227], v[54:55], v[232:235]
    v_cvt_pk_f16_f32 v188, v64, v65
    v_cvt_pk_f16_f32 v189, v68, v69
    ds_write_b64 v212, v[188:189] offset:1024
    v_cvt_pk_f16_f32 v190, v66, v67
    v_cvt_pk_f16_f32 v191, v70, v71
    ds_write_b64 v212, v[190:191] offset:5120
    v_cvt_pk_f16_f32 v192, v72, v73
    v_cvt_pk_f16_f32 v193, v76, v77
    ds_write_b64 v212, v[192:193] offset:2048
    v_cvt_pk_f16_f32 v194, v74, v75
    v_cvt_pk_f16_f32 v195, v78, v79
    ds_write_b64 v212, v[194:195] offset:6144
    v_cvt_pk_f16_f32 v196, v80, v81
    v_cvt_pk_f16_f32 v197, v84, v85
    ds_write_b64 v212, v[196:197] offset:3072
    v_cvt_pk_f16_f32 v198, v82, v83
    v_cvt_pk_f16_f32 v199, v86, v87
    ds_write_b64 v212, v[198:199] offset:7168
    s_waitcnt lgkmcnt(0)
    s_barrier
    ds_read_b64 v[152:153], v213 offset:0
    ds_read_b64 v[154:155], v214 offset:0
    ds_read_b64 v[156:157], v213 offset:1024
    ds_read_b64 v[158:159], v214 offset:1024
    ds_read_b64 v[160:161], v213 offset:2048
    ds_read_b64 v[162:163], v214 offset:2048
    ds_read_b64 v[164:165], v213 offset:3072
    ds_read_b64 v[166:167], v214 offset:3072
    s_waitcnt lgkmcnt(6)
    v_mfma_f32_16x16x32_f16 v[56:59], v[236:239], v[152:155], 0
    s_waitcnt lgkmcnt(4)
    v_mfma_f32_16x16x32_f16 v[60:63], v[236:239], v[156:159], 0
    s_waitcnt lgkmcnt(2)
    v_mfma_f32_16x16x32_f16 v[64:67], v[236:239], v[160:163], 0
    s_waitcnt lgkmcnt(0)
    v_mfma_f32_16x16x32_f16 v[68:71], v[236:239], v[164:167], 0
    v_mfma_f32_16x16x32_f16 v[72:75], v[240:243], v[152:155], 0
    v_mfma_f32_16x16x32_f16 v[76:79], v[240:243], v[156:159], 0
    v_mfma_f32_16x16x32_f16 v[80:83], v[240:243], v[160:163], 0
    v_mfma_f32_16x16x32_f16 v[84:87], v[240:243], v[164:167], 0
    v_cvt_pk_f16_f32 v184, v56, v57
    v_cvt_pk_f16_f32 v185, v60, v61
    v_cvt_pk_f16_f32 v186, v64, v65
    s_nop 0
    v_cvt_pk_f16_f32 v187, v68, v69
    v_and_or_b32 v184, v184, s55, v244
    v_and_or_b32 v185, v185, s55, v245
    v_and_or_b32 v186, v186, s55, v246
    v_and_or_b32 v187, v187, s55, v247
    buffer_store_dwordx4 v[184:187], v6, s[12:15], s64 offen sc1
    v_cvt_pk_f16_f32 v188, v58, v59
    v_cvt_pk_f16_f32 v189, v62, v63
    v_cvt_pk_f16_f32 v190, v66, v67
    v_cvt_pk_f16_f32 v191, v70, v71
    v_and_or_b32 v188, v188, s55, v244
    v_and_or_b32 v189, v189, s55, v245
    v_and_or_b32 v190, v190, s55, v246
    v_and_or_b32 v191, v191, s55, v247
    buffer_store_dwordx4 v[188:191], v6, s[12:15], s65 offen sc1
    v_cvt_pk_f16_f32 v192, v72, v73
    v_cvt_pk_f16_f32 v193, v76, v77
    v_cvt_pk_f16_f32 v194, v80, v81
    v_cvt_pk_f16_f32 v195, v84, v85
    v_and_or_b32 v192, v192, s55, v244
    v_and_or_b32 v193, v193, s55, v245
    v_and_or_b32 v194, v194, s55, v246
    v_and_or_b32 v195, v195, s55, v247
    buffer_store_dwordx4 v[192:195], v6, s[12:15], s66 offen sc1
    v_cvt_pk_f16_f32 v196, v74, v75
    v_cvt_pk_f16_f32 v197, v78, v79
    v_cvt_pk_f16_f32 v198, v82, v83
    v_cvt_pk_f16_f32 v199, v86, v87
    v_and_or_b32 v196, v196, s55, v244
    v_and_or_b32 v197, v197, s55, v245
    v_and_or_b32 v198, v198, s55, v246
    v_and_or_b32 v199, v199, s55, v247
    buffer_store_dwordx4 v[196:199], v6, s[12:15], s67 offen sc1
    s_setprio 0
    s_mov_b32 s43, 0
    s_lshr_b32 s42, s3, 4
    s_and_b32 s40, s3, 15
    s_lshl_b32 s40, s40, 4
    s_add_u32 s40, s40, s42
    s_lshr_b32 s42, s3, 3
    s_cmp_eq_u32 s42, 1
    s_cselect_b32 s42, 120, 0
    s_sub_u32 s40, s40, s42
    s_lshl_b32 s42, s43, 8
    s_add_u32 s40, s40, s42
    s_cmp_ge_u32 s43, 4
    s_cselect_b32 s42, 896, 0
    s_cmp_eq_u32 s3, 0
    s_cselect_b32 s42, s42, 0
    s_sub_u32 s40, s40, s42
    v_lshrrev_b32 v248, 1, v4
    v_and_b32 v249, 1, v0
    v_lshlrev_b32 v250, 8, v248
    v_add_u32 v250, s40, v250
    s_cmp_lg_u32 s3, 0
    s_cbranch_scc1 f_a3n
    v_cmp_lt_u32 s[44:45], 3, v248
    v_subrev_u32 v251, 896, v250
    s_nop 0
    v_cndmask_b32 v250, v250, v251, s[44:45]
    v_cmp_eq_u32 vcc, 1, v4
    v_mov_b32 v251, 1024
    s_nop 0
    v_cndmask_b32 v250, v250, v251, vcc
    v_cndmask_b32_e64 v249, v249, 0, vcc
f_a3n:
    v_lshlrev_b32 v251, 1, v5
    v_mul_u32_u24 v251, v251, v250
    v_lshl_add_u32 v251, v249, 9, v251
    v_add_u32 v253, v251, v250
    v_add_u32 v252, 1536, v251
    v_add_u32 v254, 1536, v253
    v_and_b32 v251, 2047, v251
    v_and_b32 v252, 2047, v252
    v_and_b32 v253, 2047, v253
    v_and_b32 v254, 2047, v254
    v_cvt_f32_u32 v251, v251
    v_cvt_f32_u32 v252, v252
    v_cvt_f32_u32 v253, v253
    v_cvt_f32_u32 v254, v254
    v_mul_f32 v251, 0x3a000000, v251
    v_mul_f32 v252, 0x3a000000, v252
    v_mul_f32 v253, 0x3a000000, v253
    v_mul_f32 v254, 0x3a000000, v254
    v_cos_f32 v251, v251
    v_cos_f32 v252, v252
    v_cos_f32 v253, v253
    v_cos_f32 v254, v254
    s_cbranch_scc1 f_a3m
    v_cmp_gt_u32 vcc, 2, v4
    s_nop 1
    v_cndmask_b32_e64 v249, 1.0, 0.5, vcc
    v_mul_f32 v251, v251, v249
    v_mul_f32 v253, v253, v249
    v_cndmask_b32 v252, 0, v251, s[44:45]
    v_cndmask_b32 v254, 0, v253, s[44:45]
    v_cndmask_b32 v251, v251, 0, s[44:45]
    v_cndmask_b32 v253, v253, 0, s[44:45]
f_a3m:
    v_cvt_pk_f16_f32 v22, v251, v252
    v_cvt_pk_f16_f32 v23, v253, v254
    v_and_b32 v248, 3, v0
    v_bfe_u32 v249, v0, 2, 1
    v_bfe_u32 v250, v0, 3, 2
    v_bfe_u32 v251, v0, 5, 1
    v_lshlrev_b32 v13, 10, v249
    v_lshlrev_b32 v15, 11, v249
    v_lshl_add_u32 v15, v251, 8, v15
    v_lshl_add_u32 v15, v250, 6, v15
    v_lshl_add_u32 v15, v248, 4, v15
    v_lshl_add_u32 v13, v250, 8, v13
    v_lshl_add_u32 v13, v248, 6, v13
    v_lshl_add_u32 v13, v251, 5, v13
    v_xor_b32 v14, 2016, v13
    v_add_u32 v13, s68, v13
    v_add_u32 v14, s68, v14
    s_waitcnt vmcnt(4)
    ds_read_b128 v[200:203], v13 offset:0
    ds_read_b128 v[204:207], v13 offset:16
    ds_read_b128 v[208:211], v14 offset:2048
    ds_read_b128 v[212:215], v14 offset:2064
    s_lshl_b32 s72, s3, 15
    s_lshl_b32 s73, s37, 12
    s_add_u32 s72, s72, s73
    s_add_u32 s72, s72, 1048576
    s_waitcnt lgkmcnt(0)
    ds_read_b128 v[88:91], v3 offset:0
    ds_read_b128 v[92:95], v3 offset:1024
    ds_read_b128 v[96:99], v3 offset:2048
    ds_read_b128 v[100:103], v3 offset:3072
    ds_read_b128 v[104:107], v3 offset:4096
    ds_read_b128 v[108:111], v3 offset:5120
    ds_read_b128 v[112:115], v3 offset:6144
    ds_read_b128 v[116:119], v3 offset:7168
    ds_read_b128 v[120:123], v3 offset:8192
    ds_read_b128 v[124:127], v3 offset:9216
    ds_read_b128 v[128:131], v3 offset:10240
    ds_read_b128 v[132:135], v3 offset:11264
    ds_read_b128 v[136:139], v3 offset:12288
    ds_read_b128 v[140:143], v3 offset:13312
    ds_read_b128 v[144:147], v3 offset:14336
    ds_read_b128 v[148:151], v3 offset:15360
    v_lshlrev_b32 v152, 16, v200
    v_and_b32 v153, 0xffff0000, v200
    v_lshlrev_b32 v154, 16, v201
    v_and_b32 v155, 0xffff0000, v201
    v_lshlrev_b32 v156, 16, v202
    v_and_b32 v157, 0xffff0000, v202
    v_lshlrev_b32 v158, 16, v203
    v_and_b32 v159, 0xffff0000, v203
    v_lshlrev_b32 v160, 16, v204
    v_and_b32 v161, 0xffff0000, v204
    v_lshlrev_b32 v162, 16, v205
    v_and_b32 v163, 0xffff0000, v205
    v_lshlrev_b32 v164, 16, v206
    v_and_b32 v165, 0xffff0000, v206
    v_lshlrev_b32 v166, 16, v207
    v_and_b32 v167, 0xffff0000, v207
    v_lshlrev_b32 v168, 16, v208
    v_and_b32 v183, 0xffff0000, v208
    v_lshlrev_b32 v182, 16, v209
    v_and_b32 v181, 0xffff0000, v209
    v_lshlrev_b32 v180, 16, v210
    v_and_b32 v179, 0xffff0000, v210
    v_lshlrev_b32 v178, 16, v211
    v_and_b32 v177, 0xffff0000, v211
    v_lshlrev_b32 v176, 16, v212
    v_and_b32 v175, 0xffff0000, v212
    v_lshlrev_b32 v174, 16, v213
    v_and_b32 v173, 0xffff0000, v213
    v_lshlrev_b32 v172, 16, v214
    v_and_b32 v171, 0xffff0000, v214
    v_lshlrev_b32 v170, 16, v215
    v_and_b32 v169, 0xffff0000, v215
    s_waitcnt vmcnt(0)
    s_barrier
    buffer_load_dwordx4 v[24:27], v3, s[12:15], s72 offen offset:0 sc1
    buffer_load_dwordx4 v[28:31], v3, s[12:15], s72 offen offset:1024 sc1
    buffer_load_dwordx4 v[32:35], v3, s[12:15], s72 offen offset:2048 sc1
    buffer_load_dwordx4 v[36:39], v3, s[12:15], s72 offen offset:3072 sc1
    s_lshl_b32 s80, s3, 7
    s_add_u32 s80, s80, 17039360
    v_lshrrev_b32 v18, 3, v2
    v_lshlrev_b32 v18, 14, v18
    v_and_b32 v248, 0x70, v3
    v_add_u32 v18, v18, v248
    s_cmp_lg_u32 s16, 0
    s_cbranch_scc1 f_sb2
    v_add_u32 v84, 160768, v3
    s_mov_b64 exec, 0xff
    ds_read_b128 v[80:83], v84
    s_waitcnt lgkmcnt(0)
    buffer_store_dwordx4 v[80:83], v3, s[12:15], s63 offen sc1
    s_mov_b64 exec, -1
    v_not_b32 v249, s32
    buffer_store_dwordx4 v[248:251], v18, s[12:15], s80 offen sc1
f_sb2:
    v_xor_b32 v16, 2544, v15
    s_nop 0
    v_subrev_u32 v248, s68, v13
    v_add_u32 v248, 32, v248
    v_bfe_u32 v19, v248, 5, 1
    v_lshlrev_b32 v19, 5, v19
    v_bfe_u32 v249, v248, 8, 2
    v_lshl_add_u32 v19, v249, 3, v19
    v_bfe_u32 v249, v248, 10, 1
    v_lshl_add_u32 v19, v249, 2, v19
    v_bfe_u32 v249, v248, 6, 2
    v_add_lshl_u32 v19, v249, v19, 2
    s_lshl_b32 s74, s34, 14
    s_add_u32 s74, s74, 17039360
    s_lshl_b32 s42, s37, 9
    s_add_u32 s42, s42, 61440
    v_add_u32 v12, s42, v12
    s_mul_i32 s17, s34, 7
    s_lshr_b32 s42, s35, 1
    s_add_u32 s17, s17, s42
    s_lshl_b32 s42, s17, 6
    s_lshr_b32 s43, s16, 2
    s_lshl_b32 s43, s43, 5
    s_add_u32 s42, s42, s43
    s_and_b32 s43, s16, 1
    s_lshl_b32 s43, s43, 4
    s_add_u32 s42, s42, s43
    s_and_b32 s43, s16, 2
    s_lshl_b32 s43, s43, 1
    s_add_u32 s42, s42, s43
    s_lshl_b32 s38, s42, 11
    s_and_b32 s43, s35, 1
    s_lshl_b32 s43, s43, 10
    s_add_u32 s38, s38, s43
    s_lshl_b32 s39, s16, 13
    s_add_u32 s39, s39, 94208
    s_mov_b32 s48, s28
    s_mov_b32 s49, s29
    s_mov_b32 s50, 7340032
    s_mov_b32 s51, 0x00020000
    s_bfe_u32 s4, s32, 524288
    s_bfe_u32 s5, s32, 524296
    s_bfe_u32 s6, s32, 524304
    s_bfe_u32 s7, s32, 524312
    s_bfe_u32 s8, s33, 524288
    s_bfe_u32 s9, s33, 524296
    s_bfe_u32 s10, s33, 524304
    s_bfe_u32 s11, s33, 524312
    v_lshlrev_b32 v17, 7, v4
    s_and_b32 s40, s16, 3
    s_lshl_b32 s76, s40, 10
    v_subrev_u32 v248, s68, v13
    v_lshrrev_b32 v248, 1, v248
    s_lshl_b32 s42, s40, 2
    v_add_u32 v248, s42, v248
    v_bfe_u32 v235, v248, 7, 1
    v_lshlrev_b32 v235, 9, v235
    v_and_b32 v249, 31, v248
    v_lshl_add_u32 v235, v249, 4, v235
    v_bfe_u32 v249, v248, 8, 1
    v_lshl_add_u32 v235, v249, 3, v235
    v_lshrrev_b32 v249, 9, v248
    v_lshl_add_u32 v235, v249, 10, v235
    v_bfe_u32 v249, v248, 5, 2
    v_lshl_add_u32 v235, v249, 1, v235
    v_mov_b32 v8, s32
    v_mov_b32 v9, s33
    v_and_b32 v10, 1, v0
    v_cmp_eq_u32 vcc, 1, v10
    s_nop 1
    v_cndmask_b32 v8, v8, v9, vcc
    v_bfe_u32 v9, v8, 8, 8
    v_bfe_u32 v10, v8, 16, 8
    v_lshrrev_b32 v11, 24, v8
    v_and_b32 v8, 0xff, v8
    s_add_u32 s76, s76, 16875520
    s_mov_b32 s77, 16850944
    s_xor_b32 s79, s35, 1
    s_xor_b32 s43, s16, 5
    s_or_b32 s79, s79, s43
    s_add_u32 s65, s76, 4096
    s_lshl_b32 s42, s16, 11
    v_add_u32 v4, s42, v3
    s_add_u32 s64, s42, 16883712
    s_lshl_b32 s42, s16, 12
    s_add_u32 s42, s42, 61440
    v_add_u32 v7, s42, v3
    v_mov_b32 v20, 159808
    s_cmp_eq_u32 s3, 0
    s_cselect_b64 s[52:53], -1, 1
    v_mov_b32 v196, v8
    v_mov_b32 v197, v9
    v_mov_b32 v198, v10
    v_mov_b32 v199, v11
    s_mov_b32 s83, 0
    s_cmp_ge_u32 s16, 4
    s_cbranch_scc1 f_z1
    s_waitcnt vmcnt(6)
    s_mov_b64 exec, 0xf0ff
    buffer_load_dwordx4 v[236:239], v17, s[12:15], s77 offen sc1
    s_mov_b64 exec, s[52:53]
    buffer_load_dwordx4 v[196:199], v3, s[12:15], s76 offen sc1
    s_mov_b64 exec, -1
    buffer_load_dwordx4 v[192:195], v3, s[12:15], s65 offen sc1
    buffer_load_dwordx4 v[184:187], v3, s[12:15], s64 offen offset:0 sc1
    buffer_load_dwordx4 v[188:191], v3, s[12:15], s64 offen offset:1024 sc1
    s_waitcnt vmcnt(7)
    v_xor_b32 v40, v24, v244
    v_xor_b32 v41, v28, v244
    v_xor_b32 v42, v25, v245
    v_xor_b32 v43, v29, v245
    v_xor_b32 v44, v26, v246
    v_xor_b32 v45, v30, v246
    v_xor_b32 v46, v27, v247
    v_xor_b32 v47, v31, v247
    v_mfma_f32_16x16x16_f16 v[56:59], v[22:23], v[40:41], 0
    v_or3_b32 v248, v40, v41, 0
    v_mfma_f32_16x16x16_f16 v[64:67], v[22:23], v[44:45], 0
    v_or3_b32 v248, v44, v45, v248
    v_mfma_f32_16x16x16_f16 v[60:63], v[22:23], v[42:43], 0
    v_or3_b32 v248, v42, v43, v248
    v_mfma_f32_16x16x16_f16 v[68:71], v[22:23], v[46:47], 0
    v_or3_b32 v248, v46, v47, v248
    s_waitcnt vmcnt(5)
    s_branch f_z2
f_z1:
    s_waitcnt vmcnt(4)
    buffer_load_dwordx4 v[184:187], v3, s[12:15], s64 offen offset:0 sc1
    buffer_load_dwordx4 v[188:191], v3, s[12:15], s64 offen offset:1024 sc1
    s_waitcnt vmcnt(4)
f_zc:
    v_xor_b32 v40, v24, v244
    v_xor_b32 v41, v28, v244
    v_xor_b32 v42, v25, v245
    v_xor_b32 v43, v29, v245
    v_xor_b32 v44, v26, v246
    v_xor_b32 v45, v30, v246
    v_xor_b32 v46, v27, v247
    v_xor_b32 v47, v31, v247
    v_mfma_f32_16x16x16_f16 v[56:59], v[22:23], v[40:41], 0
    v_or3_b32 v248, v40, v41, 0
    v_mfma_f32_16x16x16_f16 v[64:67], v[22:23], v[44:45], 0
    v_or3_b32 v248, v44, v45, v248
    v_mfma_f32_16x16x16_f16 v[60:63], v[22:23], v[42:43], 0
    v_or3_b32 v248, v42, v43, v248
    v_mfma_f32_16x16x16_f16 v[68:71], v[22:23], v[46:47], 0
    v_or3_b32 v248, v46, v47, v248
    s_waitcnt vmcnt(2)
f_z2:
    v_xor_b32 v48, v32, v244
    v_xor_b32 v49, v36, v244
    v_xor_b32 v50, v33, v245
    v_xor_b32 v51, v37, v245
    v_xor_b32 v52, v34, v246
    v_xor_b32 v53, v38, v246
    v_xor_b32 v54, v35, v247
    v_xor_b32 v55, v39, v247
    v_mfma_f32_16x16x16_f16 v[72:75], v[22:23], v[48:49], 0
    v_or3_b32 v248, v48, v49, v248
    v_mfma_f32_16x16x16_f16 v[80:83], v[22:23], v[52:53], 0
    v_or3_b32 v248, v52, v53, v248
    v_mfma_f32_16x16x16_f16 v[76:79], v[22:23], v[50:51], 0
    v_or3_b32 v248, v50, v51, v248
    v_mfma_f32_16x16x16_f16 v[84:87], v[22:23], v[54:55], 0
    v_or3_b32 v248, v54, v55, v248
    v_and_b32 v248, s54, v248
    v_cmp_ne_u32 vcc, 0, v248
    s_cbranch_vccnz f_zr
f_zx:
    v_cvt_pk_f16_f32 v24, v56, v57
    v_cvt_pk_f16_f32 v25, v64, v65
    v_cvt_pk_f16_f32 v26, v72, v73
    v_cvt_pk_f16_f32 v27, v80, v81
    ds_write_b128 v12, v[24:27] offset:0
    v_cvt_pk_f16_f32 v28, v58, v59
    v_cvt_pk_f16_f32 v29, v66, v67
    v_cvt_pk_f16_f32 v30, v74, v75
    v_cvt_pk_f16_f32 v31, v82, v83
    ds_write_b128 v12, v[28:31] offset:4096
    v_cvt_pk_f16_f32 v32, v60, v61
    v_cvt_pk_f16_f32 v33, v68, v69
    v_cvt_pk_f16_f32 v34, v76, v77
    v_cvt_pk_f16_f32 v35, v84, v85
    ds_write_b128 v12, v[32:35] offset:256
    v_cvt_pk_f16_f32 v36, v62, v63
    v_cvt_pk_f16_f32 v37, v70, v71
    v_cvt_pk_f16_f32 v38, v78, v79
    v_cvt_pk_f16_f32 v39, v86, v87
    ds_write_b128 v12, v[36:39] offset:4352
    s_mov_b32 s83, 0
    s_cmp_lt_u32 s16, 4
    s_cbranch_scc1 f_pv
f_qv:
    s_waitcnt vmcnt(1)
    v_xor_b32 v184, v8, v184
    v_xor_b32 v185, v9, v185
    v_xor_b32 v186, v10, v186
    v_xor_b32 v187, v11, v187
    v_or3_b32 v248, v184, v185, 0
    v_or3_b32 v248, v186, v187, v248
    ds_write_b128 v4, v[184:187] offset:20480
    s_waitcnt vmcnt(0)
    v_xor_b32 v188, v8, v188
    v_xor_b32 v189, v9, v189
    v_xor_b32 v190, v10, v190
    v_xor_b32 v191, v11, v191
    v_or3_b32 v248, v188, v189, v248
    v_or3_b32 v248, v190, v191, v248
    ds_write_b128 v4, v[188:191] offset:21504
    v_and_b32 v248, 0xff, v248
    v_cmp_ne_u32 vcc, 0, v248
    s_cbranch_vccnz f_qr
    s_branch f_pvx
f_pv:
    s_waitcnt vmcnt(3)
    v_add_f32_dpp v239, v238, v238 quad_perm:[1,0,3,2] row_mask:0xf bank_mask:0xf
    v_max_f32_dpp v238, v238, v238 quad_perm:[1,0,3,2] row_mask:0xf bank_mask:0xf
    v_cmp_ne_u64 s[44:45], s[32:33], v[236:237]
    v_add_f32_dpp v239, v239, v239 quad_perm:[2,3,0,1] row_mask:0xf bank_mask:0xf
    v_max_f32_dpp v238, v238, v238 quad_perm:[2,3,0,1] row_mask:0xf bank_mask:0xf
    v_xor_b32 v196, v8, v196
    v_xor_b32 v197, v9, v197
    v_xor_b32 v198, v10, v198
    v_xor_b32 v199, v11, v199
    v_or3_b32 v248, v196, v197, 0
    v_or3_b32 v248, v198, v199, v248
    v_max_f32_dpp v238, v238, v238 row_half_mirror row_mask:0xf bank_mask:0xf
    s_mov_b64 exec, 0x1000
    ds_write_b32 v20, v239
    s_mov_b64 exec, -1
    v_frexp_exp_i32_f32 v238, v238
    s_waitcnt vmcnt(2)
    v_xor_b32 v192, v8, v192
    v_xor_b32 v193, v9, v193
    v_xor_b32 v194, v10, v194
    v_xor_b32 v195, v11, v195
    v_or3_b32 v248, v192, v193, v248
    v_or3_b32 v248, v194, v195, v248
    v_readfirstlane_b32 s42, v238
    s_sub_u32 s43, -1, s42
    s_add_u32 s45, s42, 5
    s_and_b32 s44, s44, 0xf0ff
    v_ldexp_f32 v192, v192, s43
    v_ldexp_f32 v193, v193, s43
    v_ldexp_f32 v194, v194, s43
    v_ldexp_f32 v195, v195, s43
    v_cvt_pk_f16_f32 v192, v192, v193
    v_cvt_pk_f16_f32 v194, v194, v195
    ds_write_b16 v235, v192 offset:16384
    ds_write_b16_d16_hi v235, v192 offset:16400
    ds_write_b16 v235, v194 offset:16416
    ds_write_b16_d16_hi v235, v194 offset:16432
    s_waitcnt vmcnt(1)
    v_xor_b32 v184, v8, v184
    v_xor_b32 v185, v9, v185
    v_xor_b32 v186, v10, v186
    v_xor_b32 v187, v11, v187
    v_or3_b32 v248, v184, v185, v248
    v_or3_b32 v248, v186, v187, v248
    v_ldexp_f32 v184, v184, s45
    v_ldexp_f32 v185, v185, s45
    v_ldexp_f32 v186, v186, s45
    v_ldexp_f32 v187, v187, s45
    ds_write_b128 v4, v[184:187] offset:20480
    s_waitcnt vmcnt(0)
    v_xor_b32 v188, v8, v188
    v_xor_b32 v189, v9, v189
    v_xor_b32 v190, v10, v190
    v_xor_b32 v191, v11, v191
    v_or3_b32 v248, v188, v189, v248
    v_or3_b32 v248, v190, v191, v248
    v_ldexp_f32 v188, v188, s45
    v_ldexp_f32 v189, v189, s45
    v_ldexp_f32 v190, v190, s45
    v_ldexp_f32 v191, v191, s45
    ds_write_b128 v4, v[188:191] offset:21504
    v_and_b32 v248, 0xff, v248
    v_cmp_ne_u32 vcc, 0, v248
    s_or_b32 vcc_lo, vcc_lo, s44
    s_cbranch_vccnz f_pr
f_pw:
    s_cmp_eq_u32 s3, 0
    s_cbranch_scc1 f_ps
f_pvx:
    s_setprio 2
    s_waitcnt lgkmcnt(0)
    s_barrier
    ds_read_b128 v[248:251], v3 offset:16384
    ds_read_b128 v[24:27], v7 offset:0
    ds_read_b128 v[28:31], v7 offset:1024
    ds_read_b128 v[252:255], v3 offset:17408
    ds_read_b128 v[32:35], v7 offset:2048
    ds_read_b128 v[36:39], v7 offset:3072
    s_cmp_eq_u32 s30, 0
    s_cbranch_scc1 f_sp
    s_waitcnt lgkmcnt(4)
    v_pk_mul_f16 v40, v24, v248 op_sel:[0,0] op_sel_hi:[1,0]
    v_pk_mul_f16 v41, v25, v248 op_sel:[0,1] op_sel_hi:[1,1]
    v_pk_mul_f16 v42, v26, v249 op_sel:[0,0] op_sel_hi:[1,0]
    v_pk_mul_f16 v43, v27, v249 op_sel:[0,1] op_sel_hi:[1,1]
    s_nop 1
    v_mfma_f32_32x32x16_f16 v[56:71], v[40:43], v[88:91], 0
    s_waitcnt lgkmcnt(3)
    v_pk_mul_f16 v44, v28, v250 op_sel:[0,0] op_sel_hi:[1,0]
    v_pk_mul_f16 v45, v29, v250 op_sel:[0,1] op_sel_hi:[1,1]
    v_pk_mul_f16 v46, v30, v251 op_sel:[0,0] op_sel_hi:[1,0]
    v_pk_mul_f16 v47, v31, v251 op_sel:[0,1] op_sel_hi:[1,1]
    v_mfma_f32_32x32x16_f16 v[72:87], v[40:43], v[104:107], 0
    s_waitcnt lgkmcnt(1)
    v_pk_mul_f16 v48, v32, v252 op_sel:[0,0] op_sel_hi:[1,0]
    v_pk_mul_f16 v49, v33, v252 op_sel:[0,1] op_sel_hi:[1,1]
    v_pk_mul_f16 v50, v34, v253 op_sel:[0,0] op_sel_hi:[1,0]
    v_pk_mul_f16 v51, v35, v253 op_sel:[0,1] op_sel_hi:[1,1]
    v_mfma_f32_32x32x16_f16 v[56:71], v[44:47], v[92:95], v[56:71]
    s_waitcnt lgkmcnt(0)
    v_pk_mul_f16 v52, v36, v254 op_sel:[0,0] op_sel_hi:[1,0]
    v_pk_mul_f16 v53, v37, v254 op_sel:[0,1] op_sel_hi:[1,1]
    v_pk_mul_f16 v54, v38, v255 op_sel:[0,0] op_sel_hi:[1,0]
    v_pk_mul_f16 v55, v39, v255 op_sel:[0,1] op_sel_hi:[1,1]
    v_mfma_f32_32x32x16_f16 v[72:87], v[44:47], v[108:111], v[72:87]
f_st1:
    v_mfma_f32_32x32x16_f16 v[56:71], v[48:51], v[96:99], v[56:71]
    ds_read_b128 v[184:187], v3 offset:20480
    ds_read_b128 v[188:191], v3 offset:21504
    v_mfma_f32_32x32x16_f16 v[72:87], v[48:51], v[112:115], v[72:87]
    ds_read_b128 v[192:195], v3 offset:22528
    ds_read_b128 v[196:199], v3 offset:23552
    v_mfma_f32_32x32x16_f16 v[56:71], v[52:55], v[100:103], v[56:71]
    ds_read_b128 v[200:203], v3 offset:24576
    ds_read_b128 v[204:207], v3 offset:25600
    v_mfma_f32_32x32x16_f16 v[72:87], v[52:55], v[116:119], v[72:87]
    ds_read_b128 v[208:211], v3 offset:26624
    ds_read_b128 v[212:215], v3 offset:27648
    v_mov_b32 v22, 159808
    ds_read_b32 v22, v22
    s_cmp_ge_u32 s35, 14
    s_cbranch_scc1 f_nd0
    s_add_u32 s43, s39, 0
    s_mov_b32 m0, s43
    s_add_u32 s42, s38, 0
    buffer_load_dwordx4 v3, s[48:51], s42 offen nt lds
    s_add_u32 s43, s39, 1024
    s_mov_b32 m0, s43
    s_add_u32 s42, s38, 2048
    v_xor_b32 v7, 32, v3
    buffer_load_dwordx4 v7, s[48:51], s42 offen nt lds
    s_add_u32 s43, s39, 2048
    s_mov_b32 m0, s43
    s_add_u32 s42, s38, 4096
    v_xor_b32 v7, 64, v3
    buffer_load_dwordx4 v7, s[48:51], s42 offen nt lds
f_nd0:
    s_cmp_eq_u32 s30, 0
    s_cbranch_scc1 f_sp2
    v_pk_mul_f32 v[24:25], v[56:57], v[120:121]
    v_pk_mul_f32 v[28:29], v[72:73], v[120:121]
    v_pk_mul_f32 v[26:27], v[58:59], v[122:123]
    v_pk_mul_f32 v[30:31], v[74:75], v[122:123]
    v_pk_fma_f32 v[24:25], v[72:73], v[136:137], v[24:25]
    v_pk_fma_f32 v[28:29], v[56:57], v[136:137], v[28:29] neg_lo:[1,0,0] neg_hi:[1,0,0]
    v_pk_fma_f32 v[26:27], v[74:75], v[138:139], v[26:27]
    v_pk_fma_f32 v[30:31], v[58:59], v[138:139], v[30:31] neg_lo:[1,0,0] neg_hi:[1,0,0]
    v_cvt_pk_f16_f32 v40, v24, v28
    v_cvt_pk_f16_f32 v41, v25, v29
    v_cvt_pk_f16_f32 v42, v26, v30
    v_cvt_pk_f16_f32 v43, v27, v31
    ds_read_b128 v[216:219], v3 offset:28672
    ds_read_b128 v[220:223], v3 offset:29696
    ds_read_b128 v[224:227], v3 offset:30720
    ds_read_b128 v[228:231], v3 offset:31744
    v_pk_mul_f32 v[32:33], v[60:61], v[124:125]
    v_pk_mul_f32 v[36:37], v[76:77], v[124:125]
    v_pk_mul_f32 v[34:35], v[62:63], v[126:127]
    v_pk_mul_f32 v[38:39], v[78:79], v[126:127]
    v_pk_fma_f32 v[32:33], v[76:77], v[140:141], v[32:33]
    v_pk_fma_f32 v[36:37], v[60:61], v[140:141], v[36:37] neg_lo:[1,0,0] neg_hi:[1,0,0]
    v_pk_fma_f32 v[34:35], v[78:79], v[142:143], v[34:35]
    v_pk_fma_f32 v[38:39], v[62:63], v[142:143], v[38:39] neg_lo:[1,0,0] neg_hi:[1,0,0]
    v_cvt_pk_f16_f32 v44, v32, v36
    v_cvt_pk_f16_f32 v45, v33, v37
    v_cvt_pk_f16_f32 v46, v34, v38
    v_cvt_pk_f16_f32 v47, v35, v39
    v_mfma_f32_32x32x16_f16 v[104:119], v[40:43], v[88:91], 0
    ds_read_b128 v[232:235], v3 offset:32768
    ds_read_b128 v[236:239], v3 offset:33792
    ds_read_b128 v[240:243], v3 offset:34816
    ds_read_b128 v[244:247], v3 offset:35840
    v_pk_mul_f32 v[24:25], v[64:65], v[128:129]
    v_pk_mul_f32 v[28:29], v[80:81], v[128:129]
    v_pk_mul_f32 v[26:27], v[66:67], v[130:131]
    v_pk_mul_f32 v[30:31], v[82:83], v[130:131]
    v_pk_fma_f32 v[24:25], v[80:81], v[144:145], v[24:25]
    v_pk_fma_f32 v[28:29], v[64:65], v[144:145], v[28:29] neg_lo:[1,0,0] neg_hi:[1,0,0]
    v_pk_fma_f32 v[26:27], v[82:83], v[146:147], v[26:27]
    v_pk_fma_f32 v[30:31], v[66:67], v[146:147], v[30:31] neg_lo:[1,0,0] neg_hi:[1,0,0]
    v_cvt_pk_f16_f32 v48, v24, v28
    v_cvt_pk_f16_f32 v49, v25, v29
    v_cvt_pk_f16_f32 v50, v26, v30
    v_cvt_pk_f16_f32 v51, v27, v31
    v_mfma_f32_32x32x16_f16 v[104:119], v[44:47], v[92:95], v[104:119]
    v_pk_mul_f32 v[32:33], v[68:69], v[132:133]
    v_pk_mul_f32 v[36:37], v[84:85], v[132:133]
    v_pk_mul_f32 v[34:35], v[70:71], v[134:135]
    v_pk_mul_f32 v[38:39], v[86:87], v[134:135]
    v_pk_fma_f32 v[32:33], v[84:85], v[148:149], v[32:33]
    v_pk_fma_f32 v[36:37], v[68:69], v[148:149], v[36:37] neg_lo:[1,0,0] neg_hi:[1,0,0]
    v_pk_fma_f32 v[34:35], v[86:87], v[150:151], v[34:35]
    v_pk_fma_f32 v[38:39], v[70:71], v[150:151], v[38:39] neg_lo:[1,0,0] neg_hi:[1,0,0]
    v_cvt_pk_f16_f32 v52, v32, v36
    v_cvt_pk_f16_f32 v53, v33, v37
    v_cvt_pk_f16_f32 v54, v34, v38
    v_cvt_pk_f16_f32 v55, v35, v39
    v_mfma_f32_32x32x16_f16 v[104:119], v[48:51], v[96:99], v[104:119]
    s_nop 0
    v_mfma_f32_32x32x16_f16 v[104:119], v[52:55], v[100:103], v[104:119]
    s_nop 11
    ds_bpermute_b32 v12, v19, v104
    s_waitcnt lgkmcnt(1)
    v_pk_fma_f32 v[152:153], v[184:185], v[104:105], v[152:153]
    v_pk_fma_f32 v[154:155], v[186:187], v[106:107], v[154:155]
    v_pk_fma_f32 v[156:157], v[188:189], v[108:109], v[156:157]
    v_pk_fma_f32 v[158:159], v[190:191], v[110:111], v[158:159]
    v_pk_fma_f32 v[160:161], v[192:193], v[112:113], v[160:161]
    v_pk_fma_f32 v[162:163], v[194:195], v[114:115], v[162:163]
    v_pk_fma_f32 v[164:165], v[196:197], v[116:117], v[164:165]
    v_pk_fma_f32 v[166:167], v[198:199], v[118:119], v[166:167]
    v_pk_fma_f32 v[170:171], v[202:203], v[106:107], v[170:171]
    v_pk_fma_f32 v[172:173], v[204:205], v[108:109], v[172:173]
    v_pk_fma_f32 v[174:175], v[206:207], v[110:111], v[174:175]
    v_pk_fma_f32 v[176:177], v[208:209], v[112:113], v[176:177]
    v_pk_fma_f32 v[178:179], v[210:211], v[114:115], v[178:179]
    v_pk_fma_f32 v[180:181], v[212:213], v[116:117], v[180:181]
    v_pk_fma_f32 v[182:183], v[214:215], v[118:119], v[182:183]
    v_fmac_f32 v169, v201, v105
    s_waitcnt lgkmcnt(0)
    v_fmac_f32 v168, v200, v12
f_join:
    s_setprio 1
    v_lshrrev_b32 v17, 3, v0
    v_and_b32 v17, 60, v17
    v_add_u32 v17, 159744, v17
    v_and_b32 v7, 0xf0, v3
    v_lshrrev_b32 v7, 2, v7
    v_add_u32 v7, 159744, v7
    v_pk_add_f32 v[40:41], v[166:167], v[164:165]
    v_pk_add_f32 v[48:49], v[182:183], v[180:181]
    v_pk_add_f32 v[40:41], v[40:41], v[162:163]
    v_pk_add_f32 v[48:49], v[48:49], v[178:179]
    v_pk_add_f32 v[40:41], v[40:41], v[160:161]
    v_pk_add_f32 v[48:49], v[48:49], v[176:177]
    v_pk_add_f32 v[40:41], v[40:41], v[158:159]
    v_pk_add_f32 v[48:49], v[48:49], v[174:175]
    v_pk_add_f32 v[40:41], v[40:41], v[156:157]
    v_pk_add_f32 v[48:49], v[48:49], v[172:173]
    v_pk_add_f32 v[40:41], v[40:41], v[154:155]
    v_pk_add_f32 v[48:49], v[48:49], v[170:171]
    v_pk_add_f32 v[40:41], v[40:41], v[152:153]
    v_pk_add_f32 v[48:49], v[48:49], v[168:169]
    v_pk_mul_f32 v[42:43], v[166:167], v[166:167]
    v_pk_mul_f32 v[44:45], v[166:167], v[230:231]
    v_pk_mul_f32 v[50:51], v[182:183], v[182:183]
    v_pk_mul_f32 v[52:53], v[182:183], v[246:247]
    v_pk_fma_f32 v[42:43], v[164:165], v[164:165], v[42:43]
    v_pk_fma_f32 v[44:45], v[164:165], v[228:229], v[44:45]
    v_pk_fma_f32 v[50:51], v[180:181], v[180:181], v[50:51]
    v_pk_fma_f32 v[52:53], v[180:181], v[244:245], v[52:53]
    v_pk_fma_f32 v[42:43], v[162:163], v[162:163], v[42:43]
    v_pk_fma_f32 v[44:45], v[162:163], v[226:227], v[44:45]
    v_pk_fma_f32 v[50:51], v[178:179], v[178:179], v[50:51]
    v_pk_fma_f32 v[52:53], v[178:179], v[242:243], v[52:53]
    v_pk_fma_f32 v[42:43], v[160:161], v[160:161], v[42:43]
    v_pk_fma_f32 v[44:45], v[160:161], v[224:225], v[44:45]
    v_pk_fma_f32 v[50:51], v[176:177], v[176:177], v[50:51]
    v_pk_fma_f32 v[52:53], v[176:177], v[240:241], v[52:53]
    v_pk_fma_f32 v[42:43], v[158:159], v[158:159], v[42:43]
    v_pk_fma_f32 v[44:45], v[158:159], v[222:223], v[44:45]
    v_pk_fma_f32 v[50:51], v[174:175], v[174:175], v[50:51]
    v_pk_fma_f32 v[52:53], v[174:175], v[238:239], v[52:53]
    v_pk_fma_f32 v[42:43], v[156:157], v[156:157], v[42:43]
    v_pk_fma_f32 v[44:45], v[156:157], v[220:221], v[44:45]
    v_pk_fma_f32 v[50:51], v[172:173], v[172:173], v[50:51]
    v_pk_fma_f32 v[52:53], v[172:173], v[236:237], v[52:53]
    v_pk_fma_f32 v[42:43], v[154:155], v[154:155], v[42:43]
    v_pk_fma_f32 v[44:45], v[154:155], v[218:219], v[44:45]
    v_pk_fma_f32 v[50:51], v[170:171], v[170:171], v[50:51]
    v_pk_fma_f32 v[52:53], v[170:171], v[234:235], v[52:53]
    v_pk_fma_f32 v[42:43], v[152:153], v[152:153], v[42:43]
    v_pk_fma_f32 v[44:45], v[152:153], v[216:217], v[44:45]
    v_pk_fma_f32 v[50:51], v[168:169], v[168:169], v[50:51]
    v_pk_fma_f32 v[52:53], v[168:169], v[232:233], v[52:53]
    v_add_f32 v24, v40, v41
    v_add_f32 v25, v42, v43
    v_add_f32 v26, v44, v45
    v_add_f32 v28, v48, v49
    v_add_f32 v29, v50, v51
    v_add_f32 v30, v52, v53
    s_cmp_eq_u32 s79, 0
    s_cbranch_scc1 f_go
f_ngo:
    s_setprio 0
    v_permlane32_swap_b32 v24, v28
    v_permlane32_swap_b32 v25, v29
    v_permlane32_swap_b32 v26, v30
    v_add_f32 v24, v24, v28
    v_add_f32 v25, v25, v29
    v_add_f32 v26, v26, v30
    v_add_f32_dpp v24, v24, v24 row_ror:8 row_mask:0xf bank_mask:0xf
    v_add_f32_dpp v25, v25, v25 row_ror:8 row_mask:0xf bank_mask:0xf
    v_add_f32_dpp v26, v26, v26 row_ror:8 row_mask:0xf bank_mask:0xf
    v_add_f32_dpp v24, v24, v24 row_ror:4 row_mask:0xf bank_mask:0xf
    v_add_f32_dpp v25, v25, v25 row_ror:4 row_mask:0xf bank_mask:0xf
    v_add_f32_dpp v26, v26, v26 row_ror:4 row_mask:0xf bank_mask:0xf
    v_add_f32_dpp v24, v24, v24 row_ror:2 row_mask:0xf bank_mask:0xf
    v_add_f32_dpp v25, v25, v25 row_ror:2 row_mask:0xf bank_mask:0xf
    v_add_f32_dpp v26, v26, v26 row_ror:2 row_mask:0xf bank_mask:0xf
    v_add_f32_dpp v24, v24, v24 row_ror:1 row_mask:0xf bank_mask:0xf
    v_add_f32_dpp v25, v25, v25 row_ror:1 row_mask:0xf bank_mask:0xf
    v_add_f32_dpp v26, v26, v26 row_ror:1 row_mask:0xf bank_mask:0xf
    v_add_f32_dpp v24, v24, v24 row_bcast:15 row_mask:0xa bank_mask:0xf
    v_add_f32_dpp v25, v25, v25 row_bcast:15 row_mask:0xa bank_mask:0xf
    v_add_f32_dpp v26, v26, v26 row_bcast:15 row_mask:0xa bank_mask:0xf
    v_mul_f32 v24, 0x3a800000, v24
    v_mul_f32 v25, 0x3a800000, v25
    v_mul_f32 v28, v24, v24
    v_fma_f32 v26, -v24, v22, v26
    v_sub_f32 v25, v25, v28
    v_mul_f32 v29, 4.0, v25
    v_cmp_gt_f32 vcc, v28, v29
    v_lshrrev_b32 v30, 4, v0
    s_lshl_b32 s43, s3, 5
    v_and_or_b32 v30, v30, 30, s43
    s_or_b32 s42, vcc_lo, vcc_hi
    s_bitcmp1_b32 s42, 31
    s_cbranch_scc1 f_slow2
f_var2:
    v_cvt_pk_bf16_f32 v25, v25, v25
    v_lshlrev_b32 v25, 16, v25
    v_add_f32 v25, 0x3727c5ac, v25
    v_cvt_pk_bf16_f32 v25, v25, v25
    v_lshlrev_b32 v25, 16, v25
    v_sqrt_f32 v25, v25
    s_nop 0
    v_cvt_pk_bf16_f32 v25, v25, v25
    v_lshlrev_b32 v25, 16, v25
    v_rcp_f32 v25, v25
    s_mov_b32 s42, 0x80000000
    s_movk_i32 s43, 0xf000
    s_mov_b32 exec_lo, s42
    s_mov_b32 exec_hi, s42
    v_mul_f32 v26, v26, v25
    v_ashrrev_i32 v28, 31, v26
    v_or_b32 v28, s42, v28
    v_xor_b32 v26, v26, v28
    v_and_or_b32 v26, v26, s43, v30
    ds_write_b32 v17, v26
    v_mul_f32 v24, -v24, v25
    s_mov_b64 exec, -1
    v_readlane_b32 s60, v26, 31
    v_readlane_b32 s56, v24, 31
    v_readlane_b32 s57, v25, 31
    v_readlane_b32 s61, v26, 63
    v_readlane_b32 s58, v24, 63
    v_readlane_b32 s59, v25, 63
    s_waitcnt lgkmcnt(0)
    s_setprio 0
    s_barrier
    ds_read_b32 v32, v7
    s_mul_i32 s42, s16, 3072
    v_add_u32 v4, s42, v3
    s_add_u32 s64, s42, 16900096
    s_waitcnt lgkmcnt(0)
    v_cmp_lt_u32 vcc, s60, v32
    v_cmp_lt_u32 s[44:45], s61, v32
    s_and_b32 s62, vcc_lo, 0xffff
    s_and_b32 s63, s44, 0xffff
    s_bcnt1_i32_b32 s62, s62
    s_bcnt1_i32_b32 s63, s63
    s_min_u32 s42, s62, s63
    s_cmp_lg_u32 s42, 0
    s_cbranch_scc1 f_nkey
    s_setprio 3
    s_max_u32 s42, s60, s61
    v_cmp_ne_u32 vcc, s42, v32
    v_mov_b32 v36, s42
    v_mov_b32 v37, s32
    v_cndmask_b32 v38, 0, v32, vcc
    v_mov_b32 v39, s33
    s_nop 0
    v_max_u32_dpp v38, v38, v38 row_ror:8 row_mask:0xf bank_mask:0xf
    s_nop 1
    v_max_u32_dpp v38, v38, v38 row_ror:4 row_mask:0xf bank_mask:0xf
    s_nop 1
    v_max_u32_dpp v38, v38, v38 row_ror:2 row_mask:0xf bank_mask:0xf
    s_nop 1
    v_max_u32_dpp v38, v38, v38 row_ror:1 row_mask:0xf bank_mask:0xf
    v_or_b32 v38, 1, v38
    buffer_store_dwordx4 v[36:39], v18, s[12:15], s80 offen sc1
f_nkey:
    s_cmp_ge_u32 s62, 2
    s_cbranch_scc1 f_nc0
f_cand0:
    s_setprio 2
    s_lshl_b32 s43, s3, 1
    s_add_u32 s42, s62, s43
    s_lshl_b32 s43, s42, 7
    s_lshl_b32 s42, s42, 12
    s_add_u32 s42, s42, 18874368
    s_add_u32 s43, s43, 17170432
    v_mov_b32 v12, 0xffffff00
    v_and_or_b32 v56, v152, v12, s4
    v_and_or_b32 v57, v153, v12, s5
    v_and_or_b32 v58, v154, v12, s6
    v_and_or_b32 v59, v155, v12, s7
    buffer_store_dwordx4 v[56:59], v15, s[12:15], s42 offen offset:0 sc1
    v_and_or_b32 v60, v156, v12, s8
    v_and_or_b32 v61, v157, v12, s9
    v_and_or_b32 v62, v158, v12, s10
    v_and_or_b32 v63, v159, v12, s11
    buffer_store_dwordx4 v[60:63], v15, s[12:15], s42 offen offset:1024 sc1
    v_and_or_b32 v64, v160, v12, s4
    v_and_or_b32 v65, v161, v12, s5
    v_and_or_b32 v66, v162, v12, s6
    v_and_or_b32 v67, v163, v12, s7
    buffer_store_dwordx4 v[64:67], v15, s[12:15], s42 offen offset:512 sc1
    v_and_or_b32 v68, v164, v12, s8
    v_and_or_b32 v69, v165, v12, s9
    v_and_or_b32 v70, v166, v12, s10
    v_and_or_b32 v71, v167, v12, s11
    buffer_store_dwordx4 v[68:71], v15, s[12:15], s42 offen offset:1536 sc1
    v_mov_b32 v40, s32
    v_mov_b32 v41, s33
    v_mov_b32 v42, s56
    v_mov_b32 v43, s57
    s_mov_b64 exec, 0xff
    buffer_store_dwordx4 v[40:43], v3, s[12:15], s43 offen sc1
    s_mov_b64 exec, -1
    s_setprio 0
f_nc0:
    s_cmp_ge_u32 s63, 2
    s_cbranch_scc1 f_nc1
f_cand1:
    s_setprio 2
    s_lshl_b32 s43, s3, 1
    s_add_u32 s42, s63, s43
    s_lshl_b32 s43, s42, 7
    s_lshl_b32 s42, s42, 12
    s_add_u32 s42, s42, 18874368
    s_add_u32 s43, s43, 17170432
    v_mov_b32 v12, 0xffffff00
    v_and_or_b32 v72, v168, v12, s4
    v_and_or_b32 v73, v183, v12, s5
    v_and_or_b32 v74, v182, v12, s6
    v_and_or_b32 v75, v181, v12, s7
    buffer_store_dwordx4 v[72:75], v16, s[12:15], s42 offen offset:0 sc1
    v_and_or_b32 v76, v180, v12, s8
    v_and_or_b32 v77, v179, v12, s9
    v_and_or_b32 v78, v178, v12, s10
    v_and_or_b32 v79, v177, v12, s11
    buffer_store_dwordx4 v[76:79], v16, s[12:15], s42 offen offset:1024 sc1
    v_and_or_b32 v80, v176, v12, s4
    v_and_or_b32 v81, v175, v12, s5
    v_and_or_b32 v82, v174, v12, s6
    v_and_or_b32 v83, v173, v12, s7
    buffer_store_dwordx4 v[80:83], v16, s[12:15], s42 offen offset:512 sc1
    v_and_or_b32 v84, v172, v12, s8
    v_and_or_b32 v85, v171, v12, s9
    v_and_or_b32 v86, v170, v12, s10
    v_and_or_b32 v87, v169, v12, s11
    buffer_store_dwordx4 v[84:87], v16, s[12:15], s42 offen offset:1536 sc1
    v_mov_b32 v44, s32
    v_mov_b32 v45, s33
    v_mov_b32 v46, s58
    v_mov_b32 v47, s59
    s_mov_b64 exec, 0xff
    buffer_store_dwordx4 v[44:47], v3, s[12:15], s43 offen sc1
    s_mov_b64 exec, -1
    s_setprio 0
f_nc1:
    buffer_load_dwordx4 v[248:251], v3, s[12:15], s64 offen offset:0 sc1
    buffer_load_dwordx4 v[252:255], v3, s[12:15], s64 offen offset:1024 sc1
    buffer_load_dwordx4 v[136:139], v3, s[12:15], s64 offen offset:2048 sc1
    s_barrier
    s_cmp_ge_u32 s35, 14
    s_cbranch_scc1 f_nd2
    s_add_u32 s43, s39, 3072
    s_mov_b32 m0, s43
    s_add_u32 s42, s38, 6144
    v_xor_b32 v7, 96, v3
    buffer_load_dwordx4 v7, s[48:51], s42 offen nt lds
    s_add_u32 s43, s39, 4096
    s_mov_b32 m0, s43
    s_add_u32 s42, s38, 16384
    v_xor_b32 v7, 128, v3
    buffer_load_dwordx4 v7, s[48:51], s42 offen nt lds
    s_add_u32 s43, s39, 5120
    s_mov_b32 m0, s43
    s_add_u32 s42, s38, 18432
    v_xor_b32 v7, 160, v3
    buffer_load_dwordx4 v7, s[48:51], s42 offen nt lds
    s_add_u32 s43, s39, 6144
    s_mov_b32 m0, s43
    s_add_u32 s42, s38, 20480
    v_xor_b32 v7, 192, v3
    buffer_load_dwordx4 v7, s[48:51], s42 offen nt lds
    s_add_u32 s43, s39, 7168
    s_mov_b32 m0, s43
    s_add_u32 s42, s38, 22528
    v_xor_b32 v7, 224, v3
    buffer_load_dwordx4 v7, s[48:51], s42 offen nt lds
f_nd2:
    v_pk_fma_f32 v[56:57], v[152:153], s[56:57], s[56:57] op_sel:[0,1,0] op_sel_hi:[1,1,0]
    v_pk_fma_f32 v[58:59], v[154:155], s[56:57], s[56:57] op_sel:[0,1,0] op_sel_hi:[1,1,0]
    v_pk_fma_f32 v[60:61], v[156:157], s[56:57], s[56:57] op_sel:[0,1,0] op_sel_hi:[1,1,0]
    v_pk_fma_f32 v[62:63], v[158:159], s[56:57], s[56:57] op_sel:[0,1,0] op_sel_hi:[1,1,0]
    v_pk_fma_f32 v[64:65], v[160:161], s[56:57], s[56:57] op_sel:[0,1,0] op_sel_hi:[1,1,0]
    v_pk_fma_f32 v[66:67], v[162:163], s[56:57], s[56:57] op_sel:[0,1,0] op_sel_hi:[1,1,0]
    v_pk_fma_f32 v[68:69], v[164:165], s[56:57], s[56:57] op_sel:[0,1,0] op_sel_hi:[1,1,0]
    v_pk_fma_f32 v[70:71], v[166:167], s[56:57], s[56:57] op_sel:[0,1,0] op_sel_hi:[1,1,0]
    v_pk_fma_f32 v[72:73], v[168:169], s[58:59], s[58:59] op_sel:[0,1,0] op_sel_hi:[1,1,0]
    v_pk_fma_f32 v[74:75], v[170:171], s[58:59], s[58:59] op_sel:[0,1,0] op_sel_hi:[1,1,0]
    v_pk_fma_f32 v[76:77], v[172:173], s[58:59], s[58:59] op_sel:[0,1,0] op_sel_hi:[1,1,0]
    v_pk_fma_f32 v[78:79], v[174:175], s[58:59], s[58:59] op_sel:[0,1,0] op_sel_hi:[1,1,0]
    v_pk_fma_f32 v[80:81], v[176:177], s[58:59], s[58:59] op_sel:[0,1,0] op_sel_hi:[1,1,0]
    v_pk_fma_f32 v[82:83], v[178:179], s[58:59], s[58:59] op_sel:[0,1,0] op_sel_hi:[1,1,0]
    v_pk_fma_f32 v[84:85], v[180:181], s[58:59], s[58:59] op_sel:[0,1,0] op_sel_hi:[1,1,0]
    v_pk_fma_f32 v[86:87], v[182:183], s[58:59], s[58:59] op_sel:[0,1,0] op_sel_hi:[1,1,0]
    v_subrev_u32 v13, s68, v13
    s_sub_u32 s68, s68, 65536
    v_bfe_u32 v12, v0, 1, 2
    v_lshlrev_b32 v12, 4, v12
    v_xor_b32 v13, v13, v12
    v_xor_b32 v14, 2000, v13
    v_add_u32 v13, s68, v13
    v_add_u32 v14, s68, v14
    v_xor_b32 v20, 16, v13
    v_xor_b32 v21, 16, v14
    v_and_b32 v22, 8, v0
    v_lshlrev_b32 v22, 1, v22
    v_xor_b32 v22, v22, v3
    v_add_u32 v22, s68, v22
    v_xor_b32 v23, 32, v22
    s_mov_b32 s83, 0
    s_cmp_ge_u32 s35, 14
    s_cbranch_scc1 f_p2c
    s_waitcnt vmcnt(5)
f_p2e:
    v_xor_b32 v248, v8, v248
    v_xor_b32 v249, v9, v249
    v_xor_b32 v250, v10, v250
    v_xor_b32 v251, v11, v251
    v_xor_b32 v252, v8, v252
    v_xor_b32 v253, v9, v253
    v_xor_b32 v254, v10, v254
    v_xor_b32 v255, v11, v255
    v_xor_b32 v136, v8, v136
    v_xor_b32 v137, v9, v137
    v_xor_b32 v138, v10, v138
    v_xor_b32 v139, v11, v139
    v_or3_b32 v12, v248, v249, 0
    v_or3_b32 v12, v250, v251, v12
    v_or3_b32 v12, v252, v253, v12
    v_or3_b32 v12, v254, v255, v12
    v_or3_b32 v12, v136, v137, v12
    v_or3_b32 v12, v138, v139, v12
    v_and_b32 v12, 0xff, v12
    v_cmp_ne_u32 vcc, 0, v12
    s_cbranch_vccnz f_p2r
f_p2w:
    ds_write_b128 v4, v[248:251] offset:36864
    ds_write_b128 v4, v[252:255] offset:37888
    ds_write_b128 v4, v[136:139] offset:38912
    s_waitcnt lgkmcnt(0)
    s_barrier
    v_not_b32 v24, v8
    v_bfe_u32 v7, v0, 4, 2
    v_lshlrev_b32 v7, 13, v7
    v_and_b32 v25, 0x70, v3
    v_add_u32 v7, v7, v25
    s_and_b32 s42, s35, 1
    s_lshl_b32 s42, s42, 3
    s_add_u32 s42, s42, s16
    s_lshl_b32 s42, s42, 15
    s_lshl_b32 s43, s17, 7
    s_add_u32 s42, s42, s43
    s_add_u32 s42, s42, 17825792
    s_cmp_ge_u32 s35, 14
    s_cbranch_scc1 f_npw
    s_mov_b32 exec_lo, 0x00ff00ff
    s_mov_b32 exec_hi, 0x00ff00ff
    buffer_store_dwordx4 v[24:27], v7, s[12:15], s42 offen sc1
    s_mov_b64 exec, -1
f_npw:
    ds_read_b128 v[88:91], v3 offset:36864
    ds_read_b128 v[92:95], v3 offset:37888
    ds_read_b128 v[96:99], v3 offset:38912
    ds_read_b128 v[100:103], v3 offset:39936
    ds_read_b128 v[136:139], v3 offset:45056
    ds_read_b128 v[140:143], v3 offset:46080
    ds_read_b128 v[144:147], v3 offset:47104
    ds_read_b128 v[148:151], v3 offset:48128
    ds_read_b128 v[184:187], v3 offset:53248
    ds_read_b128 v[188:191], v3 offset:54272
    ds_read_b128 v[192:195], v3 offset:55296
    ds_read_b128 v[196:199], v3 offset:56320
    s_waitcnt lgkmcnt(4)
    v_pk_fma_f32 v[56:57], v[56:57], v[88:89], v[136:137]
    v_pk_fma_f32 v[58:59], v[58:59], v[90:91], v[138:139]
    v_pk_fma_f32 v[60:61], v[60:61], v[92:93], v[140:141]
    v_pk_fma_f32 v[62:63], v[62:63], v[94:95], v[142:143]
    v_pk_fma_f32 v[64:65], v[64:65], v[96:97], v[144:145]
    v_pk_fma_f32 v[66:67], v[66:67], v[98:99], v[146:147]
    v_pk_fma_f32 v[68:69], v[68:69], v[100:101], v[148:149]
    v_pk_fma_f32 v[70:71], v[70:71], v[102:103], v[150:151]
    s_waitcnt lgkmcnt(0)
    ds_read_b128 v[120:123], v3 offset:40960
    ds_read_b128 v[124:127], v3 offset:41984
    ds_read_b128 v[128:131], v3 offset:43008
    ds_read_b128 v[132:135], v3 offset:44032
    ds_read_b128 v[104:107], v3 offset:49152
    ds_read_b128 v[108:111], v3 offset:50176
    ds_read_b128 v[112:115], v3 offset:51200
    ds_read_b128 v[116:119], v3 offset:52224
    ds_read_b128 v[200:203], v3 offset:57344
    ds_read_b128 v[204:207], v3 offset:58368
    ds_read_b128 v[208:211], v3 offset:59392
    ds_read_b128 v[212:215], v3 offset:60416
    v_pk_fma_f32 v[152:153], v[184:185], v[56:57], v[152:153]
    v_pk_fma_f32 v[154:155], v[186:187], v[58:59], v[154:155]
    v_pk_fma_f32 v[156:157], v[188:189], v[60:61], v[156:157]
    v_pk_fma_f32 v[158:159], v[190:191], v[62:63], v[158:159]
    v_pk_fma_f32 v[160:161], v[192:193], v[64:65], v[160:161]
    v_pk_fma_f32 v[162:163], v[194:195], v[66:67], v[162:163]
    v_pk_fma_f32 v[164:165], v[196:197], v[68:69], v[164:165]
    v_pk_fma_f32 v[166:167], v[198:199], v[70:71], v[166:167]
    v_cvt_pk_bf16_f32 v216, v152, v153
    v_cvt_pk_bf16_f32 v217, v154, v155
    v_cvt_pk_bf16_f32 v218, v156, v157
    v_cvt_pk_bf16_f32 v219, v158, v159
    v_cvt_pk_bf16_f32 v220, v160, v161
    v_cvt_pk_bf16_f32 v221, v162, v163
    v_cvt_pk_bf16_f32 v222, v164, v165
    v_cvt_pk_bf16_f32 v223, v166, v167
    ds_write_b128 v13, v[216:219] offset:0
    ds_write_b128 v20, v[220:223] offset:0
    s_waitcnt lgkmcnt(6)
    v_pk_fma_f32 v[72:73], v[72:73], v[120:121], v[104:105]
    v_pk_fma_f32 v[74:75], v[74:75], v[122:123], v[106:107]
    v_pk_fma_f32 v[76:77], v[76:77], v[124:125], v[108:109]
    v_pk_fma_f32 v[78:79], v[78:79], v[126:127], v[110:111]
    v_pk_fma_f32 v[80:81], v[80:81], v[128:129], v[112:113]
    v_pk_fma_f32 v[82:83], v[82:83], v[130:131], v[114:115]
    v_pk_fma_f32 v[84:85], v[84:85], v[132:133], v[116:117]
    v_pk_fma_f32 v[86:87], v[86:87], v[134:135], v[118:119]
    s_waitcnt lgkmcnt(2)
    v_pk_fma_f32 v[168:169], v[200:201], v[72:73], v[168:169]
    v_pk_fma_f32 v[170:171], v[202:203], v[74:75], v[170:171]
    v_pk_fma_f32 v[172:173], v[204:205], v[76:77], v[172:173]
    v_pk_fma_f32 v[174:175], v[206:207], v[78:79], v[174:175]
    v_pk_fma_f32 v[176:177], v[208:209], v[80:81], v[176:177]
    v_pk_fma_f32 v[178:179], v[210:211], v[82:83], v[178:179]
    v_pk_fma_f32 v[180:181], v[212:213], v[84:85], v[180:181]
    v_pk_fma_f32 v[182:183], v[214:215], v[86:87], v[182:183]
    v_cvt_pk_bf16_f32 v224, v168, v183
    v_cvt_pk_bf16_f32 v225, v182, v181
    v_cvt_pk_bf16_f32 v226, v180, v179
    v_cvt_pk_bf16_f32 v227, v178, v177
    v_cvt_pk_bf16_f32 v228, v176, v175
    v_cvt_pk_bf16_f32 v229, v174, v173
    v_cvt_pk_bf16_f32 v230, v172, v171
    v_cvt_pk_bf16_f32 v231, v170, v169
    ds_write_b128 v14, v[224:227] offset:2048
    ds_write_b128 v21, v[228:231] offset:2048
    s_waitcnt lgkmcnt(0)
    ds_read_b128 v[232:235], v22 offset:0
    ds_read_b128 v[236:239], v23 offset:1024
    ds_read_b128 v[240:243], v22 offset:2048
    ds_read_b128 v[244:247], v23 offset:3072
    v_lshrrev_b32 v144, 2, v2
    v_and_b32 v145, 7, v144
    v_and_b32 v146, 3, v0
    v_lshl_add_u32 v148, v1, 2, v146
    v_xor_b32 v148, v148, v145
    v_lshlrev_b32 v148, 5, v148
    v_lshl_add_u32 v148, v144, 10, v148
    v_add_u32 v148, 94208, v148
    v_cmp_eq_u32 s[44:45], 1, v146
    v_cmp_eq_u32 s[46:47], 2, v146
    v_cmp_eq_u32 s[72:73], 3, v146
    v_bfe_u32 v145, v0, 4, 2
    v_and_b32 v144, 1, v144
    v_lshlrev_b32 v153, 7, v144
    v_lshl_add_u32 v153, v145, 4, v153
    v_add_u32 v153, 159872, v153
    v_lshlrev_b32 v154, 4, v146
    v_lshl_add_u32 v154, v144, 6, v154
    v_lshl_add_u32 v154, v1, 15, v154
    v_lshl_add_u32 v154, v145, 13, v154
    v_and_b32 v144, 15, v0
    v_lshlrev_b32 v152, 1, v144
    v_lshl_add_u32 v152, v1, 5, v152
    v_lshl_add_u32 v152, v145, 7, v152
    v_add_u32 v152, 159872, v152
    s_and_b32 s76, s35, 1
    s_lshl_b32 s76, s76, 18
    s_lshl_b32 s77, s17, 7
    s_add_u32 s76, s76, s77
    s_add_u32 s76, s76, 17825792
    s_movk_i32 s77, 0xff00
    s_lshl_b32 s81, s17, 2
    s_and_b32 s42, s16, 3
    s_add_u32 s81, s81, s42
    s_lshl_b32 s81, s81, 10
    s_add_u32 s82, s81, 18612224
    s_add_u32 s81, s81, 18350080
    v_mov_b32 v5, 159848
    s_waitcnt vmcnt(0)
    s_barrier
    ds_read_b64_tr_b16 v[88:89], v148 offset:0
    ds_read_b64_tr_b16 v[90:91], v148 offset:16384
    ds_read_b64_tr_b16 v[92:93], v148 offset:8
    ds_read_b64_tr_b16 v[94:95], v148 offset:16392
    ds_read_b64_tr_b16 v[96:97], v148 offset:16
    ds_read_b64_tr_b16 v[98:99], v148 offset:16400
    ds_read_b64_tr_b16 v[100:101], v148 offset:24
    ds_read_b64_tr_b16 v[102:103], v148 offset:16408
    ds_read_b64_tr_b16 v[104:105], v148 offset:32768
    ds_read_b64_tr_b16 v[106:107], v148 offset:49152
    ds_read_b64_tr_b16 v[108:109], v148 offset:32776
    ds_read_b64_tr_b16 v[110:111], v148 offset:49160
    ds_read_b64_tr_b16 v[112:113], v148 offset:32784
    ds_read_b64_tr_b16 v[114:115], v148 offset:49168
    ds_read_b64_tr_b16 v[116:117], v148 offset:32792
    ds_read_b64_tr_b16 v[118:119], v148 offset:49176
    v_lshlrev_b32 v40, 13, v2
    s_lshl_b32 s74, s34, 14
    s_add_u32 s74, s74, 17436672
    s_min_u32 s75, s62, s63
    s_cmp_ge_u32 s35, 14
    s_cbranch_scc1 f_na
    s_cmp_ge_u32 s16, 4
    s_cbranch_scc1 f_na
    s_mov_b32 s83, 0
f_px:
    s_and_b32 s42, s83, 63
    s_cmp_eq_u32 s42, 63
    s_cselect_b32 s42, s82, s81
    buffer_load_dwordx4 v[144:147], v3, s[12:15], s42 offen sc1
    s_add_u32 s83, s83, 1
    s_cmp_ge_u32 s83, 0x40000
    s_cbranch_scc1 f_pxx
    s_waitcnt vmcnt(0)
    v_cmp_ne_u16_sdwa vcc, v147, v11 src0_sel:BYTE_0 src1_sel:DWORD
    s_cbranch_vccnz f_px
    v_xor_b32 v144, v8, v144
    v_xor_b32 v145, v9, v145
    v_xor_b32 v146, v10, v146
    v_xor_b32 v147, v11, v147
    v_or3_b32 v4, v144, v145, 0
    v_or3_b32 v4, v146, v147, v4
    v_and_b32 v4, 0xff, v4
    v_cmp_ne_u32 vcc, 0, v4
    s_cbranch_vccnz f_px
f_pxx:
    s_waitcnt vmcnt(0)
    v_permlane32_swap_b32 v144, v146
    v_permlane32_swap_b32 v145, v147
    v_pk_add_f32 v[144:145], v[144:145], v[146:147]
    s_nop 1
    v_permlane16_swap_b32 v144, v145
    v_add_f32 v144, v144, v145
    v_cvt_pk_bf16_f32 v144, v144, v144
    v_lshlrev_b32 v144, 16, v144
    v_mul_f32 v145, 0xbfb8aa3b, v144
    v_exp_f32 v145, v145
    v_mov_b32 v146, v144
    v_add_f32 v145, 1.0, v145
    v_rcp_f32 v145, v145
    v_mov_b32 v147, v144
    v_mul_f32 v145, v144, v145
    s_nop 0
    v_permlane32_swap_b32 v146, v147
    v_cvt_pk_bf16_f32 v145, v145, v145
    v_lshlrev_b32 v145, 16, v145
    v_mul_f32 v145, v145, v147
    v_cvt_pk_bf16_f32 v145, v145, v145
    ds_write_b16 v152, v145
f_na:
    s_waitcnt lgkmcnt(0)
    s_barrier
    s_cmp_ge_u32 s35, 14
    s_cbranch_scc1 f_fin
    ds_read_b128 v[120:123], v153 offset:0
    ds_read_b128 v[124:127], v153 offset:64
    s_cmp_lt_u32 s75, 2
    s_cbranch_scc1 f_rq
f_rqx:
    s_waitcnt lgkmcnt(1)
    v_mfma_f32_16x16x32_bf16 v[128:131], v[88:91], v[120:123], 0
    v_mfma_f32_16x16x32_bf16 v[132:135], v[92:95], v[120:123], 0
    v_mfma_f32_16x16x32_bf16 v[136:139], v[96:99], v[120:123], 0
    v_mfma_f32_16x16x32_bf16 v[140:143], v[100:103], v[120:123], 0
    s_waitcnt lgkmcnt(0)
    v_mfma_f32_16x16x32_bf16 v[128:131], v[104:107], v[124:127], v[128:131]
    v_mfma_f32_16x16x32_bf16 v[132:135], v[108:111], v[124:127], v[132:135]
    v_mfma_f32_16x16x32_bf16 v[136:139], v[112:115], v[124:127], v[136:139]
    v_mfma_f32_16x16x32_bf16 v[140:143], v[116:119], v[124:127], v[140:143]
    s_nop 5
    v_cndmask_b32 v128, v128, v132, s[44:45]
    v_cndmask_b32 v129, v129, v133, s[44:45]
    v_cndmask_b32 v130, v130, v134, s[44:45]
    v_cndmask_b32 v131, v131, v135, s[44:45]
    v_cndmask_b32 v128, v128, v136, s[46:47]
    v_cndmask_b32 v129, v129, v137, s[46:47]
    v_cndmask_b32 v130, v130, v138, s[46:47]
    v_cndmask_b32 v131, v131, v139, s[46:47]
    v_cndmask_b32 v128, v128, v140, s[72:73]
    v_cndmask_b32 v129, v129, v141, s[72:73]
    v_cndmask_b32 v130, v130, v142, s[72:73]
    v_cndmask_b32 v131, v131, v143, s[72:73]
    v_and_or_b32 v128, v128, s77, v8
    v_and_or_b32 v129, v129, s77, v9
    v_and_or_b32 v130, v130, s77, v10
    v_and_or_b32 v131, v131, s77, v11
    s_mov_b32 exec_lo, 0x00ff00ff
    s_mov_b32 exec_hi, 0x00ff00ff
    buffer_store_dwordx4 v[128:131], v154, s[12:15], s76 offen sc1
    s_mov_b64 exec, -1
    s_barrier
f_fin:
    s_cmp_lt_u32 s75, 2
    s_cbranch_scc1 f_sel
    buffer_store_dwordx4 v[232:235], v3, s[24:27], s18 offen offset:0 sc1
    buffer_store_dwordx4 v[236:239], v3, s[24:27], s18 offen offset:1024 sc1
f_g0:
    buffer_store_dwordx4 v[240:243], v3, s[24:27], s19 offen offset:0 sc1
    buffer_store_dwordx4 v[244:247], v3, s[24:27], s19 offen offset:1024 sc1
f_g1:
f_end:
    s_endpgm
f_rq:
    s_mov_b64 exec, 3
    buffer_load_dwordx4 v[32:35], v40, s[12:15], s74 offen sc1
    s_mov_b64 exec, -1
    s_branch f_rqx
f_sel:
    s_mov_b32 s83, 0
    s_cmp_ge_u32 s35, 14
    s_cbranch_scc1 f_sr
    s_waitcnt vmcnt(1)
f_sc:
    v_cmp_ne_u64 vcc, s[32:33], v[32:33]
    v_readlane_b32 s40, v34, 0
    v_readlane_b32 s41, v34, 1
    s_and_b32 s42, vcc_lo, 3
    s_cbranch_scc0 f_sx
    s_sleep 4
f_sr:
    s_mov_b64 exec, 3
    buffer_load_dwordx4 v[32:35], v40, s[12:15], s74 offen sc1
    s_mov_b64 exec, -1
    s_waitcnt vmcnt(0)
    s_add_u32 s83, s83, 1
    s_cmp_lt_u32 s83, 0x40000
    s_cbranch_scc1 f_sc
f_sx:
    s_andn2_b32 s40, s40, 1
    s_andn2_b32 s41, s41, 1
    s_cmp_eq_u32 s60, s40
    s_cbranch_scc1 f_e0
    s_cmp_eq_u32 s60, s41
    s_cbranch_scc1 f_e0
    buffer_store_dwordx4 v[232:235], v3, s[24:27], s18 offen offset:0 sc1
    buffer_store_dwordx4 v[236:239], v3, s[24:27], s18 offen offset:1024 sc1
f_e0:
    s_cmp_eq_u32 s61, s40
    s_cbranch_scc1 f_e1
    s_cmp_eq_u32 s61, s41
    s_cbranch_scc1 f_e1
    buffer_store_dwordx4 v[240:243], v3, s[24:27], s19 offen offset:0 sc1
    buffer_store_dwordx4 v[244:247], v3, s[24:27], s19 offen offset:1024 sc1
f_e1:
    s_branch f_end
f_p2r:
    s_add_u32 s83, s83, 1
    s_cmp_ge_u32 s83, 0x40000
    s_cbranch_scc1 f_p2w
    s_sleep 12
    buffer_load_dwordx4 v[248:251], v3, s[12:15], s64 offen offset:0 sc1
    buffer_load_dwordx4 v[252:255], v3, s[12:15], s64 offen offset:1024 sc1
    buffer_load_dwordx4 v[136:139], v3, s[12:15], s64 offen offset:2048 sc1
f_p2c:
    s_waitcnt vmcnt(0)
    s_branch f_p2e
f_zr:
    v_or3_b32 v248, v40, v42, v44
    v_or_b32 v248, v248, v46
    v_and_b32 v248, s54, v248
    v_cmp_ne_u32 vcc, 0, v248
    s_cbranch_vccz f_zr0
    buffer_load_dwordx4 v[24:27], v3, s[12:15], s72 offen offset:0 sc1
f_zr0:
    v_or3_b32 v248, v41, v43, v45
    v_or_b32 v248, v248, v47
    v_and_b32 v248, s54, v248
    v_cmp_ne_u32 vcc, 0, v248
    s_cbranch_vccz f_zr1
    buffer_load_dwordx4 v[28:31], v3, s[12:15], s72 offen offset:1024 sc1
f_zr1:
    v_or3_b32 v248, v48, v50, v52
    v_or_b32 v248, v248, v54
    v_and_b32 v248, s54, v248
    v_cmp_ne_u32 vcc, 0, v248
    s_cbranch_vccz f_zr2
    buffer_load_dwordx4 v[32:35], v3, s[12:15], s72 offen offset:2048 sc1
f_zr2:
    v_or3_b32 v248, v49, v51, v53
    v_or_b32 v248, v248, v55
    v_and_b32 v248, s54, v248
    v_cmp_ne_u32 vcc, 0, v248
    s_cbranch_vccz f_zr3
    buffer_load_dwordx4 v[36:39], v3, s[12:15], s72 offen offset:3072 sc1
f_zr3:
    s_waitcnt vmcnt(0)
    s_add_u32 s83, s83, 1
    s_cmp_lt_u32 s83, 0x40000
    s_cbranch_scc1 f_zc
    s_branch f_zx
f_r0:
    buffer_load_dwordx4 v3, s[8:11], s18 offen offset:0 lds
    buffer_load_dwordx4 v3, s[8:11], s18 offen offset:1024 lds
    s_branch f_nr
f_str:
    s_and_b32 s42, s83, 31
    s_cmp_lg_u32 s42, 24
    s_cbranch_scc1 f_sb1
    v_add_u32 v84, 160768, v3
    s_mov_b64 exec, 0xff
    ds_read_b128 v[80:83], v84
    s_waitcnt lgkmcnt(0)
    buffer_store_dwordx4 v[80:83], v3, s[12:15], s63 offen sc1
    s_mov_b64 exec, -1
f_sb1:
    s_cmp_eq_u32 s42, 31
    s_cselect_b32 s42, 32768, 0
    s_add_u32 s42, s42, s71
    s_mov_b32 exec_lo, 0x000f000f
    s_mov_b32 exec_hi, 0x000f000f
    buffer_load_dwordx4 v[24:27], v7, s[12:15], s42 offen sc1
    s_add_u32 s83, s83, 1
    s_cmp_lt_u32 s83, 0x40000
    s_cbranch_scc1 f_st
    s_waitcnt vmcnt(0)
    s_mov_b64 exec, -1
    s_branch f_stx
f_pr:
    s_sleep 6
    v_mov_b32 v196, v8
    v_mov_b32 v197, v9
    v_mov_b32 v198, v10
    v_mov_b32 v199, v11
    s_mov_b64 exec, 0xf0ff
    buffer_load_dwordx4 v[236:239], v17, s[12:15], s77 offen sc1
    s_mov_b64 exec, s[52:53]
    buffer_load_dwordx4 v[196:199], v3, s[12:15], s76 offen sc1
    s_mov_b64 exec, -1
    buffer_load_dwordx4 v[192:195], v3, s[12:15], s65 offen sc1
    buffer_load_dwordx4 v[184:187], v3, s[12:15], s64 offen offset:0 sc1
    buffer_load_dwordx4 v[188:191], v3, s[12:15], s64 offen offset:1024 sc1
    s_waitcnt vmcnt(0)
    s_add_u32 s83, s83, 1
    s_cmp_lt_u32 s83, 0x40000
    s_cbranch_scc1 f_pv
    s_waitcnt vmcnt(0)
    s_branch f_pw
f_ps:
    s_sub_u32 s45, 5, s42
    v_ldexp_f32 v196, v196, s45
    v_ldexp_f32 v197, v197, s45
    v_ldexp_f32 v198, v198, s45
    v_ldexp_f32 v199, v199, s45
    v_and_b32 v248, 0x3f0, v235
    v_bfe_u32 v249, v235, 10, 1
    v_lshl_add_u32 v248, v249, 11, v248
    v_bfe_u32 v249, v235, 3, 1
    v_lshl_add_u32 v248, v249, 10, v248
    v_and_b32 v249, 6, v235
    v_lshl_add_u32 v248, v249, 1, v248
    v_cvt_f16_f32 v196, v196
    ds_write_b32 v248, v196 offset:0
    v_cvt_f16_f32 v197, v197
    ds_write_b32 v248, v197 offset:16
    v_cvt_f16_f32 v198, v198
    ds_write_b32 v248, v198 offset:32
    v_cvt_f16_f32 v199, v199
    ds_write_b32 v248, v199 offset:48
    s_branch f_pvx
f_qr:
    s_sleep 6
    buffer_load_dwordx4 v[184:187], v3, s[12:15], s64 offen offset:0 sc1
    buffer_load_dwordx4 v[188:191], v3, s[12:15], s64 offen offset:1024 sc1
    s_add_u32 s83, s83, 1
    s_cmp_lt_u32 s83, 0x40000
    s_cbranch_scc1 f_qv
    s_waitcnt vmcnt(0)
    s_branch f_pvx
f_go:
    s_lshl_b32 s41, s34, 7
    s_add_u32 s41, s41, 16842752
    v_mov_b32 v56, s32
    v_mov_b32 v57, s33
    s_mov_b64 exec, 0xff
    buffer_store_dwordx4 v[56:59], v3, s[12:15], s41 offen sc1
    s_mov_b64 exec, -1
    s_branch f_ngo
f_slow2:
    v_cvt_pk_bf16_f32 v40, v152, v153
    v_lshlrev_b32 v152, 16, v40
    v_and_b32 v153, 0xffff0000, v40
    v_cvt_pk_bf16_f32 v40, v154, v155
    v_lshlrev_b32 v154, 16, v40
    v_and_b32 v155, 0xffff0000, v40
    v_cvt_pk_bf16_f32 v40, v156, v157
    v_lshlrev_b32 v156, 16, v40
    v_and_b32 v157, 0xffff0000, v40
    v_cvt_pk_bf16_f32 v40, v158, v159
    v_lshlrev_b32 v158, 16, v40
    v_and_b32 v159, 0xffff0000, v40
    v_cvt_pk_bf16_f32 v40, v160, v161
    v_lshlrev_b32 v160, 16, v40
    v_and_b32 v161, 0xffff0000, v40
    v_cvt_pk_bf16_f32 v40, v162, v163
    v_lshlrev_b32 v162, 16, v40
    v_and_b32 v163, 0xffff0000, v40
    v_cvt_pk_bf16_f32 v40, v164, v165
    v_lshlrev_b32 v164, 16, v40
    v_and_b32 v165, 0xffff0000, v40
    v_cvt_pk_bf16_f32 v40, v166, v167
    v_lshlrev_b32 v166, 16, v40
    v_and_b32 v167, 0xffff0000, v40
    v_pk_add_f32 v[40:41], v[152:153], v[154:155]
    v_pk_add_f32 v[40:41], v[40:41], v[156:157]
    v_pk_add_f32 v[40:41], v[40:41], v[158:159]
    v_pk_add_f32 v[40:41], v[40:41], v[160:161]
    v_pk_add_f32 v[40:41], v[40:41], v[162:163]
    v_pk_add_f32 v[40:41], v[40:41], v[164:165]
    v_pk_add_f32 v[40:41], v[40:41], v[166:167]
    v_cvt_pk_bf16_f32 v48, v168, v169
    v_lshlrev_b32 v168, 16, v48
    v_and_b32 v169, 0xffff0000, v48
    v_cvt_pk_bf16_f32 v48, v170, v171
    v_lshlrev_b32 v170, 16, v48
    v_and_b32 v171, 0xffff0000, v48
    v_cvt_pk_bf16_f32 v48, v172, v173
    v_lshlrev_b32 v172, 16, v48
    v_and_b32 v173, 0xffff0000, v48
    v_cvt_pk_bf16_f32 v48, v174, v175
    v_lshlrev_b32 v174, 16, v48
    v_and_b32 v175, 0xffff0000, v48
    v_cvt_pk_bf16_f32 v48, v176, v177
    v_lshlrev_b32 v176, 16, v48
    v_and_b32 v177, 0xffff0000, v48
    v_cvt_pk_bf16_f32 v48, v178, v179
    v_lshlrev_b32 v178, 16, v48
    v_and_b32 v179, 0xffff0000, v48
    v_cvt_pk_bf16_f32 v48, v180, v181
    v_lshlrev_b32 v180, 16, v48
    v_and_b32 v181, 0xffff0000, v48
    v_cvt_pk_bf16_f32 v48, v182, v183
    v_lshlrev_b32 v182, 16, v48
    v_and_b32 v183, 0xffff0000, v48
    v_pk_add_f32 v[48:49], v[168:169], v[170:171]
    v_pk_add_f32 v[48:49], v[48:49], v[172:173]
    v_pk_add_f32 v[48:49], v[48:49], v[174:175]
    v_pk_add_f32 v[48:49], v[48:49], v[176:177]
    v_pk_add_f32 v[48:49], v[48:49], v[178:179]
    v_pk_add_f32 v[48:49], v[48:49], v[180:181]
    v_pk_add_f32 v[48:49], v[48:49], v[182:183]
    v_add_f32 v24, v40, v41
    v_add_f32 v28, v48, v49
    s_nop 1
    v_permlane32_swap_b32 v24, v28
    v_add_f32 v24, v24, v28
    s_nop 1
    v_add_f32_dpp v24, v24, v24 row_ror:8 row_mask:0xf bank_mask:0xf
    s_nop 1
    v_add_f32_dpp v24, v24, v24 row_ror:4 row_mask:0xf bank_mask:0xf
    s_nop 1
    v_add_f32_dpp v24, v24, v24 row_ror:2 row_mask:0xf bank_mask:0xf
    s_nop 1
    v_add_f32_dpp v24, v24, v24 row_ror:1 row_mask:0xf bank_mask:0xf
    s_nop 1
    v_add_f32_dpp v24, v24, v24 row_bcast:15 row_mask:0xa bank_mask:0xf
    v_mul_f32 v27, 0x3a800000, v24
    v_cvt_pk_bf16_f32 v24, v27, v27
    v_lshlrev_b32 v24, 16, v24
    v_sub_f32 v27, v27, v24
    v_readlane_b32 s56, v24, 31
    v_readlane_b32 s58, v24, 63
    s_nop 0
    v_pk_add_f32 v[56:57], v[152:153], s[56:57] op_sel:[0,0] op_sel_hi:[1,0] neg_lo:[0,1] neg_hi:[0,1]
    v_pk_add_f32 v[58:59], v[154:155], s[56:57] op_sel:[0,0] op_sel_hi:[1,0] neg_lo:[0,1] neg_hi:[0,1]
    v_pk_add_f32 v[60:61], v[156:157], s[56:57] op_sel:[0,0] op_sel_hi:[1,0] neg_lo:[0,1] neg_hi:[0,1]
    v_pk_add_f32 v[62:63], v[158:159], s[56:57] op_sel:[0,0] op_sel_hi:[1,0] neg_lo:[0,1] neg_hi:[0,1]
    v_pk_add_f32 v[64:65], v[160:161], s[56:57] op_sel:[0,0] op_sel_hi:[1,0] neg_lo:[0,1] neg_hi:[0,1]
    v_pk_add_f32 v[66:67], v[162:163], s[56:57] op_sel:[0,0] op_sel_hi:[1,0] neg_lo:[0,1] neg_hi:[0,1]
    v_pk_add_f32 v[68:69], v[164:165], s[56:57] op_sel:[0,0] op_sel_hi:[1,0] neg_lo:[0,1] neg_hi:[0,1]
    v_pk_add_f32 v[70:71], v[166:167], s[56:57] op_sel:[0,0] op_sel_hi:[1,0] neg_lo:[0,1] neg_hi:[0,1]
    v_pk_add_f32 v[72:73], v[168:169], s[58:59] op_sel:[0,0] op_sel_hi:[1,0] neg_lo:[0,1] neg_hi:[0,1]
    v_pk_add_f32 v[74:75], v[170:171], s[58:59] op_sel:[0,0] op_sel_hi:[1,0] neg_lo:[0,1] neg_hi:[0,1]
    v_pk_add_f32 v[76:77], v[172:173], s[58:59] op_sel:[0,0] op_sel_hi:[1,0] neg_lo:[0,1] neg_hi:[0,1]
    v_pk_add_f32 v[78:79], v[174:175], s[58:59] op_sel:[0,0] op_sel_hi:[1,0] neg_lo:[0,1] neg_hi:[0,1]
    v_pk_add_f32 v[80:81], v[176:177], s[58:59] op_sel:[0,0] op_sel_hi:[1,0] neg_lo:[0,1] neg_hi:[0,1]
    v_pk_add_f32 v[82:83], v[178:179], s[58:59] op_sel:[0,0] op_sel_hi:[1,0] neg_lo:[0,1] neg_hi:[0,1]
    v_pk_add_f32 v[84:85], v[180:181], s[58:59] op_sel:[0,0] op_sel_hi:[1,0] neg_lo:[0,1] neg_hi:[0,1]
    v_pk_add_f32 v[86:87], v[182:183], s[58:59] op_sel:[0,0] op_sel_hi:[1,0] neg_lo:[0,1] neg_hi:[0,1]
    v_mov_b32 v31, v30
    v_pk_mul_f32 v[42:43], v[70:71], v[70:71]
    v_pk_mul_f32 v[44:45], v[70:71], v[230:231]
    v_pk_mul_f32 v[50:51], v[86:87], v[86:87]
    v_pk_mul_f32 v[52:53], v[86:87], v[246:247]
    v_pk_fma_f32 v[42:43], v[68:69], v[68:69], v[42:43]
    v_pk_fma_f32 v[44:45], v[68:69], v[228:229], v[44:45]
    v_pk_fma_f32 v[50:51], v[84:85], v[84:85], v[50:51]
    v_pk_fma_f32 v[52:53], v[84:85], v[244:245], v[52:53]
    v_pk_fma_f32 v[42:43], v[66:67], v[66:67], v[42:43]
    v_pk_fma_f32 v[44:45], v[66:67], v[226:227], v[44:45]
    v_pk_fma_f32 v[50:51], v[82:83], v[82:83], v[50:51]
    v_pk_fma_f32 v[52:53], v[82:83], v[242:243], v[52:53]
    v_pk_fma_f32 v[42:43], v[64:65], v[64:65], v[42:43]
    v_pk_fma_f32 v[44:45], v[64:65], v[224:225], v[44:45]
    v_pk_fma_f32 v[50:51], v[80:81], v[80:81], v[50:51]
    v_pk_fma_f32 v[52:53], v[80:81], v[240:241], v[52:53]
    v_pk_fma_f32 v[42:43], v[62:63], v[62:63], v[42:43]
    v_pk_fma_f32 v[44:45], v[62:63], v[222:223], v[44:45]
    v_pk_fma_f32 v[50:51], v[78:79], v[78:79], v[50:51]
    v_pk_fma_f32 v[52:53], v[78:79], v[238:239], v[52:53]
    v_pk_fma_f32 v[42:43], v[60:61], v[60:61], v[42:43]
    v_pk_fma_f32 v[44:45], v[60:61], v[220:221], v[44:45]
    v_pk_fma_f32 v[50:51], v[76:77], v[76:77], v[50:51]
    v_pk_fma_f32 v[52:53], v[76:77], v[236:237], v[52:53]
    v_pk_fma_f32 v[42:43], v[58:59], v[58:59], v[42:43]
    v_pk_fma_f32 v[44:45], v[58:59], v[218:219], v[44:45]
    v_pk_fma_f32 v[50:51], v[74:75], v[74:75], v[50:51]
    v_pk_fma_f32 v[52:53], v[74:75], v[234:235], v[52:53]
    v_pk_fma_f32 v[42:43], v[56:57], v[56:57], v[42:43]
    v_pk_fma_f32 v[44:45], v[56:57], v[216:217], v[44:45]
    v_pk_fma_f32 v[50:51], v[72:73], v[72:73], v[50:51]
    v_pk_fma_f32 v[52:53], v[72:73], v[232:233], v[52:53]
    v_add_f32 v25, v42, v43
    v_add_f32 v26, v44, v45
    v_add_f32 v29, v50, v51
    v_add_f32 v30, v52, v53
    s_nop 0
    v_permlane32_swap_b32 v25, v29
    v_permlane32_swap_b32 v26, v30
    v_add_f32 v25, v25, v29
    v_add_f32 v26, v26, v30
    s_nop 0
    v_add_f32_dpp v25, v25, v25 row_ror:8 row_mask:0xf bank_mask:0xf
    v_add_f32_dpp v26, v26, v26 row_ror:8 row_mask:0xf bank_mask:0xf
    s_nop 0
    v_add_f32_dpp v25, v25, v25 row_ror:4 row_mask:0xf bank_mask:0xf
    v_add_f32_dpp v26, v26, v26 row_ror:4 row_mask:0xf bank_mask:0xf
    s_nop 0
    v_add_f32_dpp v25, v25, v25 row_ror:2 row_mask:0xf bank_mask:0xf
    v_add_f32_dpp v26, v26, v26 row_ror:2 row_mask:0xf bank_mask:0xf
    s_nop 0
    v_add_f32_dpp v25, v25, v25 row_ror:1 row_mask:0xf bank_mask:0xf
    v_add_f32_dpp v26, v26, v26 row_ror:1 row_mask:0xf bank_mask:0xf
    s_nop 0
    v_add_f32_dpp v25, v25, v25 row_bcast:15 row_mask:0xa bank_mask:0xf
    v_add_f32_dpp v26, v26, v26 row_bcast:15 row_mask:0xa bank_mask:0xf
    v_mul_f32 v25, 0x3a800000, v25
    v_fma_f32 v25, -v27, v27, v25
    v_max_f32 v25, 0, v25
    v_mov_b32 v30, v31
    s_branch f_var2
f_slowvar:
    v_lshlrev_b32 v118, 16, v117
    s_nop 0
    v_readlane_b32 s44, v118, 31
    v_readlane_b32 s46, v118, 63
    v_lshlrev_b32 v120, 16, v64
    v_and_b32 v121, 0xffff0000, v64
    v_pk_add_f32 v[120:121], v[120:121], s[44:45] op_sel_hi:[1,0]
    v_pk_mul_f32 v[122:123], v[120:121], v[120:121]
    v_lshlrev_b32 v120, 16, v65
    v_and_b32 v121, 0xffff0000, v65
    v_pk_add_f32 v[120:121], v[120:121], s[44:45] op_sel_hi:[1,0]
    v_pk_fma_f32 v[122:123], v[120:121], v[120:121], v[122:123]
    v_lshlrev_b32 v120, 16, v66
    v_and_b32 v121, 0xffff0000, v66
    v_pk_add_f32 v[120:121], v[120:121], s[44:45] op_sel_hi:[1,0]
    v_pk_fma_f32 v[122:123], v[120:121], v[120:121], v[122:123]
    v_lshlrev_b32 v120, 16, v67
    v_and_b32 v121, 0xffff0000, v67
    v_pk_add_f32 v[120:121], v[120:121], s[44:45] op_sel_hi:[1,0]
    v_pk_fma_f32 v[122:123], v[120:121], v[120:121], v[122:123]
    v_lshlrev_b32 v120, 16, v68
    v_and_b32 v121, 0xffff0000, v68
    v_pk_add_f32 v[120:121], v[120:121], s[44:45] op_sel_hi:[1,0]
    v_pk_fma_f32 v[122:123], v[120:121], v[120:121], v[122:123]
    v_lshlrev_b32 v120, 16, v69
    v_and_b32 v121, 0xffff0000, v69
    v_pk_add_f32 v[120:121], v[120:121], s[44:45] op_sel_hi:[1,0]
    v_pk_fma_f32 v[122:123], v[120:121], v[120:121], v[122:123]
    v_lshlrev_b32 v120, 16, v70
    v_and_b32 v121, 0xffff0000, v70
    v_pk_add_f32 v[120:121], v[120:121], s[44:45] op_sel_hi:[1,0]
    v_pk_fma_f32 v[122:123], v[120:121], v[120:121], v[122:123]
    v_lshlrev_b32 v120, 16, v71
    v_and_b32 v121, 0xffff0000, v71
    v_pk_add_f32 v[120:121], v[120:121], s[44:45] op_sel_hi:[1,0]
    v_pk_fma_f32 v[122:123], v[120:121], v[120:121], v[122:123]
    v_add_f32 v110, v122, v123
    v_lshlrev_b32 v120, 16, v72
    v_and_b32 v121, 0xffff0000, v72
    v_pk_add_f32 v[120:121], v[120:121], s[46:47] op_sel_hi:[1,0]
    v_pk_mul_f32 v[122:123], v[120:121], v[120:121]
    v_lshlrev_b32 v120, 16, v73
    v_and_b32 v121, 0xffff0000, v73
    v_pk_add_f32 v[120:121], v[120:121], s[46:47] op_sel_hi:[1,0]
    v_pk_fma_f32 v[122:123], v[120:121], v[120:121], v[122:123]
    v_lshlrev_b32 v120, 16, v74
    v_and_b32 v121, 0xffff0000, v74
    v_pk_add_f32 v[120:121], v[120:121], s[46:47] op_sel_hi:[1,0]
    v_pk_fma_f32 v[122:123], v[120:121], v[120:121], v[122:123]
    v_lshlrev_b32 v120, 16, v75
    v_and_b32 v121, 0xffff0000, v75
    v_pk_add_f32 v[120:121], v[120:121], s[46:47] op_sel_hi:[1,0]
    v_pk_fma_f32 v[122:123], v[120:121], v[120:121], v[122:123]
    v_lshlrev_b32 v120, 16, v76
    v_and_b32 v121, 0xffff0000, v76
    v_pk_add_f32 v[120:121], v[120:121], s[46:47] op_sel_hi:[1,0]
    v_pk_fma_f32 v[122:123], v[120:121], v[120:121], v[122:123]
    v_lshlrev_b32 v120, 16, v77
    v_and_b32 v121, 0xffff0000, v77
    v_pk_add_f32 v[120:121], v[120:121], s[46:47] op_sel_hi:[1,0]
    v_pk_fma_f32 v[122:123], v[120:121], v[120:121], v[122:123]
    v_lshlrev_b32 v120, 16, v78
    v_and_b32 v121, 0xffff0000, v78
    v_pk_add_f32 v[120:121], v[120:121], s[46:47] op_sel_hi:[1,0]
    v_pk_fma_f32 v[122:123], v[120:121], v[120:121], v[122:123]
    v_lshlrev_b32 v120, 16, v79
    v_and_b32 v121, 0xffff0000, v79
    v_pk_add_f32 v[120:121], v[120:121], s[46:47] op_sel_hi:[1,0]
    v_pk_fma_f32 v[122:123], v[120:121], v[120:121], v[122:123]
    v_add_f32 v111, v122, v123
    v_add_f32 v118, v118, v108
    s_nop 0
    v_permlane32_swap_b32 v110, v111
    v_add_f32 v110, v110, v111
    s_nop 1
    v_add_f32_dpp v110, v110, v110 row_ror:8 row_mask:0xf bank_mask:0xf
    s_nop 1
    v_add_f32_dpp v110, v110, v110 row_ror:4 row_mask:0xf bank_mask:0xf
    s_nop 1
    v_add_f32_dpp v110, v110, v110 row_ror:2 row_mask:0xf bank_mask:0xf
    s_nop 1
    v_add_f32_dpp v110, v110, v110 row_ror:1 row_mask:0xf bank_mask:0xf
    s_nop 1
    v_add_f32_dpp v110, v110, v110 row_bcast:15 row_mask:0xa bank_mask:0xf
    v_mul_f32 v110, s5, v110
    v_fma_f32 v110, -v118, v118, v110
    v_max_f32 v110, 0, v110
    s_branch f_var
f_sp:
    s_setprio 3
    ds_read_b128 v[56:59], v3 offset:0
    ds_read_b128 v[60:63], v3 offset:1024
    ds_read_b128 v[64:67], v3 offset:2048
    ds_read_b128 v[68:71], v3 offset:3072
    v_and_b32 v12, 31, v0
    v_lshlrev_b32 v12, 2, v12
    v_and_b32 v17, 32, v0
    v_lshl_add_u32 v12, v17, 4, v12
    v_sub_u32 v20, 4096, v12
    v_add_u32 v12, 4096, v12
    v_add_u32 v17, 128, v12
    v_add_u32 v21, 128, v20
    s_waitcnt lgkmcnt(3)
    v_pk_fma_f16 v40, v24, v248, v56 op_sel:[0,0,0] op_sel_hi:[1,0,1]
    v_pk_fma_f16 v41, v25, v248, v57 op_sel:[0,1,0] op_sel_hi:[1,1,1]
    v_pk_fma_f16 v42, v26, v249, v58 op_sel:[0,0,0] op_sel_hi:[1,0,1]
    v_pk_fma_f16 v43, v27, v249, v59 op_sel:[0,1,0] op_sel_hi:[1,1,1]
    ds_write2st64_b32 v12, v40, v42 offset0:0 offset1:1
    ds_write2st64_b32 v17, v41, v43 offset0:0 offset1:1
    s_waitcnt lgkmcnt(4)
    v_pk_fma_f16 v44, v28, v250, v60 op_sel:[0,0,0] op_sel_hi:[1,0,1]
    v_pk_fma_f16 v45, v29, v250, v61 op_sel:[0,1,0] op_sel_hi:[1,1,1]
    v_pk_fma_f16 v46, v30, v251, v62 op_sel:[0,0,0] op_sel_hi:[1,0,1]
    v_pk_fma_f16 v47, v31, v251, v63 op_sel:[0,1,0] op_sel_hi:[1,1,1]
    ds_write2st64_b32 v12, v44, v46 offset0:4 offset1:5
    ds_write2st64_b32 v17, v45, v47 offset0:4 offset1:5
    s_waitcnt lgkmcnt(5)
    v_pk_fma_f16 v48, v32, v252, v64 op_sel:[0,0,0] op_sel_hi:[1,0,1]
    v_pk_fma_f16 v49, v33, v252, v65 op_sel:[0,1,0] op_sel_hi:[1,1,1]
    v_pk_fma_f16 v50, v34, v253, v66 op_sel:[0,0,0] op_sel_hi:[1,0,1]
    v_pk_fma_f16 v51, v35, v253, v67 op_sel:[0,1,0] op_sel_hi:[1,1,1]
    ds_write2st64_b32 v12, v48, v50 offset0:8 offset1:9
    ds_write2st64_b32 v17, v49, v51 offset0:8 offset1:9
    s_waitcnt lgkmcnt(6)
    v_pk_fma_f16 v52, v36, v254, v68 op_sel:[0,0,0] op_sel_hi:[1,0,1]
    v_pk_fma_f16 v53, v37, v254, v69 op_sel:[0,1,0] op_sel_hi:[1,1,1]
    v_pk_fma_f16 v54, v38, v255, v70 op_sel:[0,0,0] op_sel_hi:[1,0,1]
    v_pk_fma_f16 v55, v39, v255, v71 op_sel:[0,1,0] op_sel_hi:[1,1,1]
    ds_write2st64_b32 v12, v52, v54 offset0:12 offset1:13
    ds_write2st64_b32 v17, v53, v55 offset0:12 offset1:13
    s_mov_b64 exec, 1
    ds_write_b32 v12, v40 offset:4096
    s_mov_b64 exec, -1
    ds_read2st64_b32 v[72:73], v20 offset0:16 offset1:15
    ds_read2st64_b32 v[74:75], v21 offset0:15 offset1:14
    ds_read2st64_b32 v[76:77], v20 offset0:12 offset1:11
    ds_read2st64_b32 v[78:79], v21 offset0:11 offset1:10
    ds_read2st64_b32 v[80:81], v20 offset0:8 offset1:7
    ds_read2st64_b32 v[82:83], v21 offset0:7 offset1:6
    ds_read2st64_b32 v[84:85], v20 offset0:4 offset1:3
    ds_read2st64_b32 v[86:87], v21 offset0:3 offset1:2
    s_waitcnt lgkmcnt(6)
    v_pk_add_f16 v40, v40, v72
    v_pk_add_f16 v41, v41, v74
    v_pk_add_f16 v42, v42, v73
    v_pk_add_f16 v43, v43, v75
    s_waitcnt lgkmcnt(4)
    v_pk_add_f16 v44, v44, v76
    v_pk_add_f16 v45, v45, v78
    v_pk_add_f16 v46, v46, v77
    v_pk_add_f16 v47, v47, v79
    s_waitcnt lgkmcnt(2)
    v_pk_add_f16 v48, v48, v80
    v_pk_add_f16 v49, v49, v82
    v_pk_add_f16 v50, v50, v81
    v_pk_add_f16 v51, v51, v83
    s_waitcnt lgkmcnt(0)
    v_pk_add_f16 v52, v52, v84
    v_pk_add_f16 v53, v53, v86
    v_pk_add_f16 v54, v54, v85
    v_pk_add_f16 v55, v55, v87
    v_mfma_f32_32x32x16_f16 v[56:71], v[40:43], v[88:91], 0
    v_mfma_f32_32x32x16_f16 v[72:87], v[40:43], v[104:107], 0
    v_mfma_f32_32x32x16_f16 v[56:71], v[44:47], v[92:95], v[56:71]
    v_mfma_f32_32x32x16_f16 v[72:87], v[44:47], v[108:111], v[72:87]
    s_branch f_st1
f_sp2:
    s_nop 9
    v_pk_mul_f32 v[24:25], v[56:57], v[120:121]
    v_pk_mul_f32 v[28:29], v[72:73], v[120:121]
    v_pk_mul_f32 v[26:27], v[58:59], v[122:123]
    v_pk_mul_f32 v[30:31], v[74:75], v[122:123]
    v_pk_fma_f32 v[24:25], v[72:73], v[136:137], v[24:25]
    v_pk_fma_f32 v[28:29], v[56:57], v[136:137], v[28:29] neg_lo:[1,0,0] neg_hi:[1,0,0]
    v_pk_fma_f32 v[26:27], v[74:75], v[138:139], v[26:27]
    v_pk_fma_f32 v[30:31], v[58:59], v[138:139], v[30:31] neg_lo:[1,0,0] neg_hi:[1,0,0]
    v_cvt_pk_f16_f32 v40, v24, v28
    v_cvt_pk_f16_f32 v41, v25, v29
    v_cvt_pk_f16_f32 v42, v26, v30
    v_cvt_pk_f16_f32 v43, v27, v31
    v_pk_mul_f32 v[32:33], v[60:61], v[124:125]
    v_pk_mul_f32 v[36:37], v[76:77], v[124:125]
    v_pk_mul_f32 v[34:35], v[62:63], v[126:127]
    v_pk_mul_f32 v[38:39], v[78:79], v[126:127]
    v_pk_fma_f32 v[32:33], v[76:77], v[140:141], v[32:33]
    v_pk_fma_f32 v[36:37], v[60:61], v[140:141], v[36:37] neg_lo:[1,0,0] neg_hi:[1,0,0]
    v_pk_fma_f32 v[34:35], v[78:79], v[142:143], v[34:35]
    v_pk_fma_f32 v[38:39], v[62:63], v[142:143], v[38:39] neg_lo:[1,0,0] neg_hi:[1,0,0]
    v_cvt_pk_f16_f32 v44, v32, v36
    v_cvt_pk_f16_f32 v45, v33, v37
    v_cvt_pk_f16_f32 v46, v34, v38
    v_cvt_pk_f16_f32 v47, v35, v39
    v_mfma_f32_32x32x16_f16 v[216:231], v[40:43], v[88:91], 0
    v_mfma_f32_32x32x16_f16 v[232:247], v[40:43], v[104:107], 0
    v_pk_mul_f32 v[24:25], v[64:65], v[128:129]
    v_pk_mul_f32 v[28:29], v[80:81], v[128:129]
    v_pk_mul_f32 v[26:27], v[66:67], v[130:131]
    v_pk_mul_f32 v[30:31], v[82:83], v[130:131]
    v_pk_fma_f32 v[24:25], v[80:81], v[144:145], v[24:25]
    v_pk_fma_f32 v[28:29], v[64:65], v[144:145], v[28:29] neg_lo:[1,0,0] neg_hi:[1,0,0]
    v_pk_fma_f32 v[26:27], v[82:83], v[146:147], v[26:27]
    v_pk_fma_f32 v[30:31], v[66:67], v[146:147], v[30:31] neg_lo:[1,0,0] neg_hi:[1,0,0]
    v_cvt_pk_f16_f32 v48, v24, v28
    v_cvt_pk_f16_f32 v49, v25, v29
    v_cvt_pk_f16_f32 v50, v26, v30
    v_cvt_pk_f16_f32 v51, v27, v31
    v_mfma_f32_32x32x16_f16 v[216:231], v[44:47], v[92:95], v[216:231]
    v_mfma_f32_32x32x16_f16 v[232:247], v[44:47], v[108:111], v[232:247]
    v_pk_mul_f32 v[32:33], v[68:69], v[132:133]
    v_pk_mul_f32 v[36:37], v[84:85], v[132:133]
    v_pk_mul_f32 v[34:35], v[70:71], v[134:135]
    v_pk_mul_f32 v[38:39], v[86:87], v[134:135]
    v_pk_fma_f32 v[32:33], v[84:85], v[148:149], v[32:33]
    v_pk_fma_f32 v[36:37], v[68:69], v[148:149], v[36:37] neg_lo:[1,0,0] neg_hi:[1,0,0]
    v_pk_fma_f32 v[34:35], v[86:87], v[150:151], v[34:35]
    v_pk_fma_f32 v[38:39], v[70:71], v[150:151], v[38:39] neg_lo:[1,0,0] neg_hi:[1,0,0]
    v_cvt_pk_f16_f32 v52, v32, v36
    v_cvt_pk_f16_f32 v53, v33, v37
    v_cvt_pk_f16_f32 v54, v34, v38
    v_cvt_pk_f16_f32 v55, v35, v39
    v_mfma_f32_32x32x16_f16 v[216:231], v[48:51], v[96:99], v[216:231]
    v_mfma_f32_32x32x16_f16 v[232:247], v[48:51], v[112:115], v[232:247]
    v_mfma_f32_32x32x16_f16 v[232:247], v[52:55], v[116:119], v[232:247]
    v_mfma_f32_32x32x16_f16 v[216:231], v[52:55], v[100:103], v[216:231]
    s_nop 10
    ds_bpermute_b32 v12, v19, v232
    s_waitcnt lgkmcnt(1)
    v_pk_fma_f32 v[152:153], v[184:185], v[216:217], v[152:153]
    v_pk_fma_f32 v[154:155], v[186:187], v[218:219], v[154:155]
    v_pk_fma_f32 v[156:157], v[188:189], v[220:221], v[156:157]
    v_pk_fma_f32 v[158:159], v[190:191], v[222:223], v[158:159]
    v_pk_fma_f32 v[160:161], v[192:193], v[224:225], v[160:161]
    v_pk_fma_f32 v[162:163], v[194:195], v[226:227], v[162:163]
    v_pk_fma_f32 v[164:165], v[196:197], v[228:229], v[164:165]
    v_pk_fma_f32 v[166:167], v[198:199], v[230:231], v[166:167]
    v_pk_fma_f32 v[170:171], v[202:203], v[234:235], v[170:171]
    v_pk_fma_f32 v[172:173], v[204:205], v[236:237], v[172:173]
    v_pk_fma_f32 v[174:175], v[206:207], v[238:239], v[174:175]
    v_pk_fma_f32 v[176:177], v[208:209], v[240:241], v[176:177]
    v_pk_fma_f32 v[178:179], v[210:211], v[242:243], v[178:179]
    v_pk_fma_f32 v[180:181], v[212:213], v[244:245], v[180:181]
    v_pk_fma_f32 v[182:183], v[214:215], v[246:247], v[182:183]
    v_fmac_f32 v169, v201, v233
    s_waitcnt lgkmcnt(0)
    v_fmac_f32 v168, v200, v12
    ds_read_b128 v[216:219], v3 offset:28672
    ds_read_b128 v[220:223], v3 offset:29696
    ds_read_b128 v[224:227], v3 offset:30720
    ds_read_b128 v[228:231], v3 offset:31744
    ds_read_b128 v[232:235], v3 offset:32768
    ds_read_b128 v[236:239], v3 offset:33792
    ds_read_b128 v[240:243], v3 offset:34816
    ds_read_b128 v[244:247], v3 offset:35840
    s_waitcnt lgkmcnt(0)
    s_setprio 2
    s_branch f_join
k_done:
    s_endpgm
code_end:
.p2align 8
.type tables,@object
tables:
.long 0x3c00,0x3c00,0x3c00,0x3c00,0x3c008000,0x3c008000,0x3c008000,0x3c008000
.long 0x3c00,0x361f3b64,0x39a839a8,0x3b64361f,0x3c008000,0x3b64b61f,0x39a8b9a8,0x361fbb64
.long 0x3c00,0x39a839a8,0x3c000000,0x39a8b9a8,0x3c008000,0x39a8b9a8,0xbc00,0xb9a8b9a8
.long 0x3c00,0x3b64361f,0x39a8b9a8,0xb61fbb64,0x3c008000,0x361fbb64,0xb9a8b9a8,0xbb64361f
.long 0x3c00,0x3c000000,0xbc00,0xbc008000,0x3c008000,0xbc00,0xbc008000,0x80003c00
.long 0x3c00,0x3b64b61f,0xb9a8b9a8,0xb61f3b64,0x3c008000,0xb61fbb64,0xb9a839a8,0x3b64361f
.long 0x3c00,0x39a8b9a8,0xbc008000,0x39a839a8,0x3c008000,0xb9a8b9a8,0x80003c00,0x39a8b9a8
.long 0x3c00,0x361fbb64,0xb9a839a8,0x3b64b61f,0x3c008000,0xbb64b61f,0x39a839a8,0xb61fbb64
.long 0x3c00,0x3c00,0x3c00,0x3c00,0x3c008000,0x3c008000,0x3c008000,0x3c008000
.long 0x39a8b9a8,0x361fbb64,0x3c000000,0x3b64b61f,0xb9a8b9a8,0xbb64b61f,0xbc00,0xb61fbb64
.long 0xbc008000,0xb9a839a8,0xbc00,0xb9a8b9a8,0x80003c00,0x39a839a8,0xbc008000,0xb9a839a8
.long 0x39a839a8,0x3b64b61f,0xbc008000,0xb61f3b64,0x39a8b9a8,0xb61fbb64,0x80003c00,0x3b64361f
.long 0xbc00,0xbc008000,0x3c00,0x3c000000,0xbc008000,0x80003c00,0x3c008000,0xbc00
.long 0xb9a839a8,0x3b64361f,0x3c000000,0xb61fbb64,0x39a839a8,0x361fbb64,0xbc00,0xbb64361f
.long 0x3c000000,0xb9a8b9a8,0xbc00,0xb9a839a8,0xbc00,0xb9a839a8,0xbc008000,0x39a839a8
.long 0xb9a8b9a8,0x361f3b64,0xbc008000,0x3b64361f,0xb9a839a8,0x3b64b61f,0x80003c00,0x361fbb64
.long 0x3c00,0x3c00,0x3c00,0x3c00,0x3c008000,0x3c008000,0x3c008000,0x3c008000
.long 0xbc00,0xb61fbb64,0xb9a8b9a8,0xbb64b61f,0xbc008000,0xbb64361f,0xb9a839a8,0xb61f3b64
.long 0x3c00,0x39a839a8,0x3c000000,0x39a8b9a8,0x3c008000,0x39a8b9a8,0xbc00,0xb9a8b9a8
.long 0xbc00,0xbb64b61f,0xb9a839a8,0x361f3b64,0xbc008000,0xb61f3b64,0x39a839a8,0x3b64b61f
.long 0x3c00,0x3c000000,0xbc00,0xbc008000,0x3c008000,0xbc00,0xbc008000,0x80003c00
.long 0xbc00,0xbb64361f,0x39a839a8,0x361fbb64,0xbc008000,0x361f3b64,0x39a8b9a8,0xbb64b61f
.long 0x3c00,0x39a8b9a8,0xbc008000,0x39a839a8,0x3c008000,0xb9a8b9a8,0x80003c00,0x39a8b9a8
.long 0xbc00,0xb61f3b64,0x39a8b9a8,0xbb64361f,0xbc008000,0x3b64361f,0xb9a8b9a8,0x361f3b64
.long 0x3c00,0x3c00,0x3c00,0x3c00,0x3c008000,0x3c008000,0x3c008000,0x3c008000
.long 0xb9a839a8,0xb61f3b64,0xbc008000,0xbb64361f,0x39a839a8,0x3b64361f,0x80003c00,0x361f3b64
.long 0xbc008000,0xb9a839a8,0xbc00,0xb9a8b9a8,0x80003c00,0x39a839a8,0xbc008000,0xb9a839a8
.long 0xb9a8b9a8,0xbb64361f,0x3c000000,0x361fbb64,0xb9a839a8,0x361f3b64,0xbc00,0xbb64b61f
.long 0xbc00,0xbc008000,0x3c00,0x3c000000,0xbc008000,0x80003c00,0x3c008000,0xbc00
.long 0x39a8b9a8,0xbb64b61f,0xbc008000,0x361f3b64,0xb9a8b9a8,0xb61f3b64,0x80003c00,0x3b64b61f
.long 0x3c000000,0xb9a8b9a8,0xbc00,0xb9a839a8,0xbc00,0xb9a839a8,0xbc008000,0x39a839a8
.long 0x39a839a8,0xb61fbb64,0x3c000000,0xbb64b61f,0x39a8b9a8,0xbb64361f,0xbc00,0xb61f3b64
.long 0x3c00,0xbc00,0x3c00,0xbc00,0x3c008000,0xbc008000,0x3c008000,0xbc008000
.long 0x3c00,0xb61fbb64,0x39a839a8,0xbb64b61f,0x3c008000,0xbb64361f,0x39a8b9a8,0xb61f3b64
.long 0x3c00,0xb9a8b9a8,0x3c000000,0xb9a839a8,0x3c008000,0xb9a839a8,0xbc00,0x39a839a8
.long 0x3c00,0xbb64b61f,0x39a8b9a8,0x361f3b64,0x3c008000,0xb61f3b64,0xb9a8b9a8,0x3b64b61f
.long 0x3c00,0xbc008000,0xbc00,0x3c000000,0x3c008000,0x80003c00,0xbc008000,0xbc00
.long 0x3c00,0xbb64361f,0xb9a8b9a8,0x361fbb64,0x3c008000,0x361f3b64,0xb9a839a8,0xbb64b61f
.long 0x3c00,0xb9a839a8,0xbc008000,0xb9a8b9a8,0x3c008000,0x39a839a8,0x80003c00,0xb9a839a8
.long 0x3c00,0xb61f3b64,0xb9a839a8,0xbb64361f,0x3c008000,0x3b64361f,0x39a839a8,0x361f3b64
.long 0x3c00,0xbc00,0x3c00,0xbc00,0x3c008000,0xbc008000,0x3c008000,0xbc008000
.long 0x39a8b9a8,0xb61f3b64,0x3c000000,0xbb64361f,0xb9a8b9a8,0x3b64361f,0xbc00,0x361f3b64
.long 0xbc008000,0x39a8b9a8,0xbc00,0x39a839a8,0x80003c00,0xb9a8b9a8,0xbc008000,0x39a8b9a8
.long 0x39a839a8,0xbb64361f,0xbc008000,0x361fbb64,0x39a8b9a8,0x361f3b64,0x80003c00,0xbb64b61f
.long 0xbc00,0x3c000000,0x3c00,0xbc008000,0xbc008000,0xbc00,0x3c008000,0x80003c00
.long 0xb9a839a8,0xbb64b61f,0x3c000000,0x361f3b64,0x39a839a8,0xb61f3b64,0xbc00,0x3b64b61f
.long 0x3c000000,0x39a839a8,0xbc00,0x39a8b9a8,0xbc00,0x39a8b9a8,0xbc008000,0xb9a8b9a8
.long 0xb9a8b9a8,0xb61fbb64,0xbc008000,0xbb64b61f,0xb9a839a8,0xbb64361f,0x80003c00,0xb61f3b64
.long 0x3c00,0xbc00,0x3c00,0xbc00,0x3c008000,0xbc008000,0x3c008000,0xbc008000
.long 0xbc00,0x361f3b64,0xb9a8b9a8,0x3b64361f,0xbc008000,0x3b64b61f,0xb9a839a8,0x361fbb64
.long 0x3c00,0xb9a8b9a8,0x3c000000,0xb9a839a8,0x3c008000,0xb9a839a8,0xbc00,0x39a839a8
.long 0xbc00,0x3b64361f,0xb9a839a8,0xb61fbb64,0xbc008000,0x361fbb64,0x39a839a8,0xbb64361f
.long 0x3c00,0xbc008000,0xbc00,0x3c000000,0x3c008000,0x80003c00,0xbc008000,0xbc00
.long 0xbc00,0x3b64b61f,0x39a839a8,0xb61f3b64,0xbc008000,0xb61fbb64,0x39a8b9a8,0x3b64361f
.long 0x3c00,0xb9a839a8,0xbc008000,0xb9a8b9a8,0x3c008000,0x39a839a8,0x80003c00,0xb9a839a8
.long 0xbc00,0x361fbb64,0x39a8b9a8,0x3b64b61f,0xbc008000,0xbb64b61f,0xb9a8b9a8,0xb61fbb64
.long 0x3c00,0xbc00,0x3c00,0xbc00,0x3c008000,0xbc008000,0x3c008000,0xbc008000
.long 0xb9a839a8,0x361fbb64,0xbc008000,0x3b64b61f,0x39a839a8,0xbb64b61f,0x80003c00,0xb61fbb64
.long 0xbc008000,0x39a8b9a8,0xbc00,0x39a839a8,0x80003c00,0xb9a8b9a8,0xbc008000,0x39a8b9a8
.long 0xb9a8b9a8,0x3b64b61f,0x3c000000,0xb61f3b64,0xb9a839a8,0xb61fbb64,0xbc00,0x3b64361f
.long 0xbc00,0x3c000000,0x3c00,0xbc008000,0xbc008000,0xbc00,0x3c008000,0x80003c00
.long 0x39a8b9a8,0x3b64361f,0xbc008000,0xb61fbb64,0xb9a8b9a8,0x361fbb64,0x80003c00,0xbb64361f
.long 0x3c000000,0x39a839a8,0xbc00,0x39a8b9a8,0xbc00,0x39a8b9a8,0xbc008000,0xb9a8b9a8
.long 0x39a839a8,0x361f3b64,0x3c000000,0x3b64361f,0x39a8b9a8,0x3b64b61f,0xbc00,0x361fbb64
.long 0x3c00,0x3c00,0x3c00,0x3c00,0x3c00,0xbc00,0x3c00,0xbc00
.long 0x3c00,0x3b64,0x39a8,0x361f,0x8000,0xb61f,0xb9a8,0xbb64
.long 0x3c00,0x39a8,0x0,0xb9a8,0x8000,0xb9a8,0xbc00,0xb9a8
.long 0x3c00,0x361f,0xb9a8,0xbb64,0x8000,0xbb64,0xb9a8,0x361f
.long 0x3c00,0x0,0xbc00,0x8000,0x8000,0xbc00,0x8000,0x3c00
.long 0x3c00,0xb61f,0xb9a8,0x3b64,0x8000,0xbb64,0x39a8,0x361f
.long 0x3c00,0xb9a8,0x8000,0x39a8,0x8000,0xb9a8,0x3c00,0xb9a8
.long 0x3c00,0xbb64,0x39a8,0xb61f,0x8000,0xb61f,0x39a8,0xbb64
.long 0x3c00,0x3c00,0x3c00,0x3c00,0x3c00,0xbc00,0x3c00,0xbc00
.long 0xb9a8,0xbb64,0x0,0xb61f,0xb9a8,0xb61f,0xbc00,0xbb64
.long 0x8000,0x39a8,0xbc00,0xb9a8,0x3c00,0x39a8,0x8000,0x39a8
.long 0x39a8,0xb61f,0x8000,0x3b64,0xb9a8,0xbb64,0x3c00,0x361f
.long 0xbc00,0x8000,0x3c00,0x0,0x8000,0x3c00,0x8000,0xbc00
.long 0x39a8,0x361f,0x0,0xbb64,0x39a8,0xbb64,0xbc00,0x361f
.long 0x0,0xb9a8,0xbc00,0x39a8,0xbc00,0x39a8,0x8000,0x39a8
.long 0xb9a8,0x3b64,0x8000,0x361f,0x39a8,0xb61f,0x3c00,0xbb64
.long 0x3c00,0x3c00,0x3c00,0x3c00,0x3c00,0xbc00,0x3c00,0xbc00
.long 0xbc00,0xbb64,0xb9a8,0xb61f,0x8000,0x361f,0x39a8,0x3b64
.long 0x3c00,0x39a8,0x0,0xb9a8,0x8000,0xb9a8,0xbc00,0xb9a8
.long 0xbc00,0xb61f,0x39a8,0x3b64,0x8000,0x3b64,0x39a8,0xb61f
.long 0x3c00,0x0,0xbc00,0x8000,0x8000,0xbc00,0x8000,0x3c00
.long 0xbc00,0x361f,0x39a8,0xbb64,0x8000,0x3b64,0xb9a8,0xb61f
.long 0x3c00,0xb9a8,0x8000,0x39a8,0x8000,0xb9a8,0x3c00,0xb9a8
.long 0xbc00,0x3b64,0xb9a8,0x361f,0x8000,0x361f,0xb9a8,0x3b64
.long 0x3c00,0x3c00,0x3c00,0x3c00,0x3c00,0xbc00,0x3c00,0xbc00
.long 0x39a8,0x3b64,0x8000,0x361f,0x39a8,0x361f,0x3c00,0x3b64
.long 0x8000,0x39a8,0xbc00,0xb9a8,0x3c00,0x39a8,0x8000,0x39a8
.long 0xb9a8,0x361f,0x0,0xbb64,0x39a8,0x3b64,0xbc00,0xb61f
.long 0xbc00,0x8000,0x3c00,0x0,0x8000,0x3c00,0x8000,0xbc00
.long 0xb9a8,0xb61f,0x8000,0x3b64,0xb9a8,0x3b64,0x3c00,0xb61f
.long 0x0,0xb9a8,0xbc00,0x39a8,0xbc00,0x39a8,0x8000,0x39a8
.long 0x39a8,0xbb64,0x0,0xb61f,0xb9a8,0x361f,0xbc00,0x3b64
.long 0x3c000000,0x3bd90000,0x3b640000,0x3aa70000,0x80000000,0xb23e0000,0xb61f0000,0xb8720000
.long 0x3c000000,0x3aa70000,0x361f0000,0xb23e0000,0x80000000,0xb8720000,0xbb640000,0xbbd90000
.long 0x3c000000,0x38720000,0xb61f0000,0xbbd90000,0x80000000,0xbaa70000,0xbb640000,0xb23e0000
.long 0x3c000000,0x323e0000,0xbb640000,0xb8720000,0x80000000,0xbbd90000,0xb61f0000,0x3aa70000
.long 0x3c000000,0xb23e0000,0xbb640000,0x38720000,0x80000000,0xbbd90000,0x361f0000,0x3aa70000
.long 0x3c000000,0xb8720000,0xb61f0000,0x3bd90000,0x80000000,0xbaa70000,0x3b640000,0xb23e0000
.long 0x3c000000,0xbaa70000,0x361f0000,0x323e0000,0x80000000,0xb8720000,0x3b640000,0xbbd90000
.long 0x3c000000,0xbbd90000,0x3b640000,0xbaa70000,0x80000000,0xb23e0000,0x361f0000,0xb8720000
.long 0x361f0000,0x323e0000,0x39a80000,0x38720000,0xbb640000,0xbbd90000,0xb9a80000,0xbaa70000
.long 0xbb640000,0xb8720000,0xb9a80000,0xbbd90000,0x361f0000,0x3aa70000,0xb9a80000,0xb23e0000
.long 0x3b640000,0x3aa70000,0xb9a80000,0x323e0000,0x361f0000,0xb8720000,0x39a80000,0x3bd90000
.long 0xb61f0000,0xbbd90000,0x39a80000,0x3aa70000,0xbb640000,0x323e0000,0x39a80000,0xb8720000
.long 0xb61f0000,0x3bd90000,0x39a80000,0xbaa70000,0x3b640000,0x323e0000,0xb9a80000,0xb8720000
.long 0x3b640000,0xbaa70000,0xb9a80000,0xb23e0000,0xb61f0000,0xb8720000,0xb9a80000,0x3bd90000
.long 0xbb640000,0x38720000,0xb9a80000,0x3bd90000,0xb61f0000,0x3aa70000,0x39a80000,0xb23e0000
.long 0x361f0000,0xb23e0000,0x39a80000,0xb8720000,0x3b640000,0xbbd90000,0x39a80000,0xbaa70000
.long 0x0,0xb23e0000,0xb61f0000,0xb8720000,0xbc000000,0xbbd90000,0xbb640000,0xbaa70000
.long 0x80000000,0x38720000,0x3b640000,0x3bd90000,0x3c000000,0x3aa70000,0x361f0000,0xb23e0000
.long 0x0,0xbaa70000,0xbb640000,0xb23e0000,0xbc000000,0xb8720000,0x361f0000,0x3bd90000
.long 0x80000000,0x3bd90000,0x361f0000,0xbaa70000,0x3c000000,0x323e0000,0xbb640000,0xb8720000
.long 0x0,0xbbd90000,0x361f0000,0x3aa70000,0xbc000000,0x323e0000,0x3b640000,0xb8720000
.long 0x80000000,0x3aa70000,0xbb640000,0x323e0000,0x3c000000,0xb8720000,0xb61f0000,0x3bd90000
.long 0x80000000,0xb8720000,0x3b640000,0xbbd90000,0xbc000000,0x3aa70000,0xb61f0000,0xb23e0000
.long 0x80000000,0x323e0000,0xb61f0000,0x38720000,0x3c000000,0xbbd90000,0x3b640000,0xbaa70000
.long 0xbb640000,0xbbd90000,0xb9a80000,0xbaa70000,0xb61f0000,0xb23e0000,0xb9a80000,0xb8720000
.long 0xb61f0000,0xbaa70000,0x39a80000,0x323e0000,0xbb640000,0xb8720000,0xb9a80000,0xbbd90000
.long 0x361f0000,0xb8720000,0x39a80000,0x3bd90000,0xbb640000,0xbaa70000,0x39a80000,0xb23e0000
.long 0x3b640000,0xb23e0000,0xb9a80000,0x38720000,0xb61f0000,0xbbd90000,0x39a80000,0x3aa70000
.long 0x3b640000,0x323e0000,0xb9a80000,0xb8720000,0x361f0000,0xbbd90000,0xb9a80000,0x3aa70000
.long 0x361f0000,0x38720000,0x39a80000,0xbbd90000,0x3b640000,0xbaa70000,0xb9a80000,0xb23e0000
.long 0xb61f0000,0x3aa70000,0x39a80000,0xb23e0000,0x3b640000,0xb8720000,0x39a80000,0xbbd90000
.long 0xbb640000,0x3bd90000,0xb9a80000,0x3aa70000,0x361f0000,0xb23e0000,0x39a80000,0xb8720000
.size tables, 4096
all_end:
.section .rodata,"a"
.p2align 6
.amdhsa_kernel adaLN_cond__spectral_fnet__moe_arch_mod__prompt_kernel
  .amdhsa_next_free_vgpr 256
  .amdhsa_next_free_sgpr 84
  .amdhsa_accum_offset 256
  .amdhsa_group_segment_fixed_size 0
  .amdhsa_kernarg_size 120
  .amdhsa_user_sgpr_count 2
  .amdhsa_user_sgpr_kernarg_segment_ptr 1
  .amdhsa_system_sgpr_workgroup_id_x 1
  .amdhsa_float_denorm_mode_32 3
  .amdhsa_float_denorm_mode_16_64 3
.end_amdhsa_kernel
```

```asm
; @launch grid=(256,1,1) block=(512,1,1) lds=163840
.amdgcn_target "amdgcn-amd-amdhsa--gfx950"
.text
.globl adaLN_cond__spectral_fnet__moe_arch_mod__prompt_kernel
.p2align 8
.type adaLN_cond__spectral_fnet__moe_arch_mod__prompt_kernel,@function
adaLN_cond__spectral_fnet__moe_arch_mod__prompt_kernel:
    s_cmp_ge_u32 s2, 256
    s_cbranch_scc1 k_done
    s_load_dwordx2 s[4:5], s[0:1], 0
    s_load_dwordx4 s[24:27], s[0:1], 96
    s_load_dwordx2 s[6:7], s[0:1], 112
    s_load_dwordx4 s[56:59], s[0:1], 80
    s_load_dwordx4 s[48:51], s[0:1], 48
    s_load_dwordx4 s[52:55], s[0:1], 64
    s_memrealtime s[32:33]
    v_lshrrev_b32 v1, 6, v0
    v_and_b32 v2, 63, v0
    v_readfirstlane_b32 s16, v1
    v_lshlrev_b32 v3, 4, v2
    v_mov_b32 v4, 0
    s_getpc_b64 s[36:37]
h_pc:
    s_and_b32 s34, s2, 7
    s_bfe_u32 s35, s2, 0x40003
    s_cmp_lg_u32 s16, 7
    s_cbranch_scc1 h_npf
    s_lshr_b32 s42, s2, 3
    s_lshl_b32 s42, s42, 11
    v_lshl_add_u32 v4, v2, 7, s42
    v_min_u32 v4, all_end-h_pc-4, v4
    s_mov_b64 exec, 0xffff
    global_load_dword v199, v4, s[36:37]
    s_mov_b64 exec, -1
h_npf:
    s_mov_b32 s11, 0x00020000
    s_mov_b32 s14, 268435456
    s_mov_b32 s15, 0x00020000
    s_bitcmp0_b32 s2, 7
    s_cbranch_scc1 g_start
    s_lshl_b32 s60, s16, 19
    s_lshl_b32 s61, s35, 15
    s_add_u32 s60, s60, s61
    s_lshl_b32 s61, s34, 11
    s_add_u32 s60, s60, s61
    s_add_u32 s61, s60, 16384
    s_lshl_b32 s62, s34, 11
    s_lshl_b32 s63, s35, 7
    s_add_u32 s62, s62, s63
    s_add_u32 s63, s62, 16809984
    s_lshl_b32 s42, s16, 4
    s_add_u32 s62, s62, s42
    s_add_u32 s62, s62, 16777216
    v_mov_b32 v116, 0
    s_mov_b32 s10, 4194304
    s_waitcnt lgkmcnt(0)
    s_mov_b32 s8, s4
    s_mov_b32 s9, s5
    s_mov_b32 s12, s6
    s_mov_b32 s13, s7
    buffer_load_dwordx4 v[64:67], v3, s[8:11], s60 offen offset:0
    buffer_load_dwordx4 v[72:75], v3, s[8:11], s61 offen offset:0
    buffer_load_dwordx4 v[68:71], v3, s[8:11], s60 offen offset:1024
    buffer_load_dwordx4 v[76:79], v3, s[8:11], s61 offen offset:1024
    s_mov_b64 exec, 1
    buffer_load_dword v215, v116, s[12:15], s62 offen sc1
    s_mov_b64 exec, -1
    s_branch f_start
h_non:
    s_mul_i32 s42, s32, 0x9e3779b1
    s_lshr_b32 s43, s42, 15
    s_xor_b32 s42, s42, s43
    s_mul_i32 s42, s42, 0x85ebca6b
    s_xor_b32 s33, s33, s42
    s_lshr_b32 s43, s42, 13
    s_xor_b32 s42, s42, s43
    s_mul_i32 s33, s33, 0xc2b2ae35
    s_add_u32 s33, s33, s32
    s_lshr_b32 s43, s33, 16
    s_xor_b32 s33, s33, s43
    s_mul_i32 s33, s33, 0x27d4eb2f
    s_or_b32 s32, s42, 1
    s_andn2_b32 s33, s33, 7
    v_mov_b32 v10, s32
    v_mov_b32 v11, s33
    v_lshlrev_b32 v12, 3, v2
    s_mov_b32 exec_hi, 0
    global_store_dwordx2 v12, v[10:11], s[26:27] sc1
    s_mov_b32 exec_hi, -1
    s_branch h_nonx
g_start:
    s_or_b32 s40, s2, s16
    s_xor_b32 s16, s16, 4
    v_xor_b32 v1, 4, v1
    v_xor_b32 v0, 0x100, v0
    v_lshlrev_b32 v13, 2, v2
    v_mov_b32 v220, 0
    v_mov_b32 v221, 0
    v_mov_b32 v233, 0
    v_mov_b32 v234, 0
    v_mov_b32 v235, 0
    s_cmp_lt_u32 s16, 4
    s_cbranch_scc1 g_cons
g_load:
    s_and_b32 s69, s16, 3
    s_and_b32 s42, s16, 1
    s_lshl_b32 s42, s42, 7
    v_xor_b32 v6, s42, v3
    v_xor_b32 v7, 32, v6
    v_xor_b32 v8, 64, v6
    v_xor_b32 v9, 96, v6
    s_lshl_b32 s41, s35, 3
    s_add_u32 s41, s41, s69
    s_mul_i32 s18, s41, 98304
    s_lshl_b32 s41, s34, 10
    s_cmp_ge_u32 s34, 6
    s_cselect_b32 s42, 2048, 0
    s_add_u32 s18, s18, s41
    s_add_u32 s18, s18, s42
    s_lshl_b32 s68, s69, 13
    s_mov_b32 s10, 12582912
    s_waitcnt lgkmcnt(0)
    s_mov_b32 s8, s58
    s_mov_b32 s9, s59
    s_mov_b32 s12, s6
    s_mov_b32 s13, s7
    s_cmp_eq_u32 s40, 0
    s_cbranch_scc1 h_non
h_nonx:
    s_lshl_b32 s42, s69, 7
    s_add_u32 s42, s42, 139264
    s_mov_b32 m0, s42
    s_lshl_b32 s42, s35, 7
    v_add_u32 v10, s42, v13
    s_mov_b32 exec_hi, 0
    global_load_lds_dword v10, s[56:57]
    s_mov_b32 exec_hi, -1
    s_add_u32 s43, s68, 32768
    s_mov_b32 m0, s43
    s_add_u32 s42, s18, 0
    buffer_load_dwordx4 v6, s[8:11], s42 offen nt lds
    s_add_u32 s43, s68, 33792
    s_mov_b32 m0, s43
    s_add_u32 s42, s18, 12288
    buffer_load_dwordx4 v7, s[8:11], s42 offen nt lds
    s_add_u32 s43, s68, 34816
    s_mov_b32 m0, s43
    s_add_u32 s42, s18, 24576
    buffer_load_dwordx4 v8, s[8:11], s42 offen nt lds
    s_add_u32 s43, s68, 35840
    s_mov_b32 m0, s43
    s_add_u32 s42, s18, 36864
    buffer_load_dwordx4 v9, s[8:11], s42 offen nt lds
    s_add_u32 s43, s68, 36864
    s_mov_b32 m0, s43
    s_add_u32 s42, s18, 49152
    buffer_load_dwordx4 v6, s[8:11], s42 offen nt lds
    s_add_u32 s43, s68, 37888
    s_mov_b32 m0, s43
    s_add_u32 s42, s18, 61440
    buffer_load_dwordx4 v7, s[8:11], s42 offen nt lds
    s_add_u32 s43, s68, 38912
    s_mov_b32 m0, s43
    s_add_u32 s42, s18, 73728
    buffer_load_dwordx4 v8, s[8:11], s42 offen nt lds
    s_add_u32 s43, s68, 39936
    s_mov_b32 m0, s43
    s_add_u32 s42, s18, 86016
    buffer_load_dwordx4 v9, s[8:11], s42 offen nt lds
    s_lshl_b32 s19, s35, 2
    s_add_u32 s19, s19, s69
    s_mul_i32 s19, s19, 196608
    s_lshl_b32 s42, s34, 9
    s_add_u32 s19, s19, s42
    s_and_b32 s42, s34, 4
    s_lshl_b32 s42, s42, 9
    s_add_u32 s19, s19, s42
    s_add_u32 s19, s19, 6144
    v_lshrrev_b32 v5, 5, v2
    v_and_b32 v14, 0x1f0, v3
    v_lshlrev_b32 v12, 5, v5
    v_xor_b32 v14, v14, v12
    s_movk_i32 s42, 12288
    v_mad_u32_u24 v14, v5, s42, v14
    v_bfe_u32 v5, v0, 5, 1
    v_lshlrev_b32 v5, 3, v5
    v_bfe_u32 v12, v0, 3, 2
    v_add_u32 v5, v5, v12
    v_bfe_u32 v12, v0, 4, 2
    v_lshlrev_b32 v12, 1, v12
    v_xor_b32 v12, v12, v0
    v_and_b32 v12, 7, v12
    v_lshlrev_b32 v12, 4, v12
    s_movk_i32 s42, 7168
    v_mad_u32_u24 v5, v5, s42, v12
    s_mov_b32 s20, s26
    s_mov_b32 s21, s27
    s_mov_b32 s26, 4194304
    s_mov_b32 s27, 0x00020000
    s_and_b32 s65, s35, 1
    s_lshr_b32 s40, s35, 1
    s_mul_i32 s64, s34, 7
    s_add_u32 s64, s64, s40
    s_lshl_b32 s41, s34, 1
    s_add_u32 s41, s41, s65
    s_cmp_ge_u32 s35, 14
    s_cselect_b32 s66, 1, 0
    s_cselect_b32 s64, s41, s64
    v_lshrrev_b32 v10, 2, v2
    v_and_b32 v15, 3, v0
    v_bfe_u32 v11, v0, 3, 2
    v_xor_b32 v12, v11, v1
    v_and_b32 v12, 3, v12
    v_lshlrev_b32 v12, 5, v12
    v_lshl_add_u32 v12, v10, 7, v12
    v_lshl_add_u32 v12, v15, 3, v12
    v_lshrrev_b32 v16, 2, v1
    v_lshl_add_u32 v12, v16, 15, v12
    v_add_u32 v21, 65536, v12
    s_lshl_b32 s67, s65, 3
    s_add_u32 s67, s67, s69
    s_mul_i32 s67, s67, 458752
    s_lshl_b32 s42, s64, 7
    s_add_u32 s67, s67, s42
    s_mov_b32 s56, s50
    s_mov_b32 s57, s51
    s_mov_b32 s58, 7340032
    s_mov_b32 s59, 0x00020000
    s_mov_b32 s44, s52
    s_mov_b32 s45, s53
    s_mov_b32 s46, 7340032
    s_mov_b32 s47, 0x00020000
    s_waitcnt vmcnt(7)
    s_add_u32 s43, s68, 65536
    s_mov_b32 m0, s43
    s_add_u32 s42, s18, 393216
    buffer_load_dwordx4 v6, s[8:11], s42 offen nt lds
    s_waitcnt vmcnt(7)
    s_add_u32 s43, s68, 66560
    s_mov_b32 m0, s43
    s_add_u32 s42, s18, 405504
    buffer_load_dwordx4 v7, s[8:11], s42 offen nt lds
    s_load_dwordx2 s[32:33], s[20:21], 128
    s_waitcnt vmcnt(7)
    s_add_u32 s43, s68, 67584
    s_mov_b32 m0, s43
    s_add_u32 s42, s18, 417792
    buffer_load_dwordx4 v8, s[8:11], s42 offen nt lds
    s_waitcnt vmcnt(7)
    s_add_u32 s43, s68, 68608
    s_mov_b32 m0, s43
    s_add_u32 s42, s18, 430080
    buffer_load_dwordx4 v9, s[8:11], s42 offen nt lds
    s_waitcnt vmcnt(7)
    s_add_u32 s43, s68, 69632
    s_mov_b32 m0, s43
    s_add_u32 s42, s18, 442368
    buffer_load_dwordx4 v6, s[8:11], s42 offen nt lds
    s_waitcnt vmcnt(7)
    s_add_u32 s43, s68, 70656
    s_mov_b32 m0, s43
    s_add_u32 s42, s18, 454656
    buffer_load_dwordx4 v7, s[8:11], s42 offen nt lds
    s_waitcnt vmcnt(7)
    s_add_u32 s43, s68, 71680
    s_mov_b32 m0, s43
    s_add_u32 s42, s18, 466944
    buffer_load_dwordx4 v8, s[8:11], s42 offen nt lds
    s_waitcnt vmcnt(7)
    s_barrier
    s_add_u32 s43, s68, 72704
    s_mov_b32 m0, s43
    s_add_u32 s42, s18, 479232
    buffer_load_dwordx4 v9, s[8:11], s42 offen nt lds
    s_waitcnt lgkmcnt(0)
    s_cmp_lg_u32 s32, 0
    s_cbranch_scc1 g_n2x
    s_load_dwordx2 s[32:33], s[20:21], 192
    s_mov_b32 s83, 0
    v_mov_b32 v122, 0
    s_waitcnt lgkmcnt(0)
g_n2:
    s_cmp_lg_u32 s32, 0
    s_cbranch_scc1 g_n2x
    global_load_dwordx2 v[120:121], v122, s[20:21] sc1
    s_waitcnt vmcnt(0)
    v_readfirstlane_b32 s32, v120
    v_readfirstlane_b32 s33, v121
    s_add_u32 s83, s83, 1
    s_cmp_lt_u32 s83, 0x40000
    s_cbranch_scc1 g_n2
g_n2x:
    s_cmp_eq_u32 s66, 0
    s_cbranch_scc1 m_load
    v_mov_b32 v216, s32
    v_mov_b32 v217, s33
    v_and_b32 v218, 1, v0
    v_cmp_eq_u32 vcc, 1, v218
    s_nop 1
    v_cndmask_b32 v216, v216, v217, vcc
    v_bfe_u32 v217, v216, 8, 8
    v_bfe_u32 v218, v216, 16, 8
    v_lshrrev_b32 v219, 24, v216
    v_and_b32 v216, 0xff, v216
    s_lshl_b32 s81, s34, 16
    s_lshl_b32 s42, s16, 13
    s_add_u32 s81, s81, s42
    s_add_u32 s81, s81, 19922944
    s_lshl_b32 s42, s65, 9
    s_add_u32 s80, s81, s42
    s_add_u32 s81, s80, s42
    v_lshlrev_b32 v222, 4, v0
    v_lshrrev_b32 v223, 5, v2
    v_and_b32 v24, 0x1f0, v3
    v_lshl_add_u32 v223, v223, 12, v24
    s_lshl_b32 s39, s34, 4
    s_add_u32 s39, s39, s35
    s_lshl_b32 s39, s39, 12
    s_add_u32 s39, s39, 19922944
    s_bitcmp1_b32 s64, 2
    s_cselect_b32 s28, 1.0, 0
    s_waitcnt vmcnt(0)
    s_barrier
    s_branch x_start
m_load:
    s_waitcnt vmcnt(7)
    v_xor_b32 v4, 0, v14
    s_add_u32 s43, s68, 98304
    s_mov_b32 m0, s43
    s_add_u32 s42, s19, 0
    buffer_load_dwordx4 v4, s[8:11], s42 offen nt lds
    s_waitcnt vmcnt(7)
    v_xor_b32 v4, 64, v14
    s_add_u32 s43, s68, 99328
    s_mov_b32 m0, s43
    s_add_u32 s42, s19, 24576
    buffer_load_dwordx4 v4, s[8:11], s42 offen nt lds
    s_waitcnt vmcnt(7)
    v_xor_b32 v4, 0, v14
    s_add_u32 s43, s68, 100352
    s_mov_b32 m0, s43
    s_add_u32 s42, s19, 49152
    buffer_load_dwordx4 v4, s[8:11], s42 offen nt lds
    s_waitcnt vmcnt(7)
    v_xor_b32 v4, 64, v14
    s_add_u32 s43, s68, 101376
    s_mov_b32 m0, s43
    s_add_u32 s42, s19, 73728
    buffer_load_dwordx4 v4, s[8:11], s42 offen nt lds
    s_waitcnt vmcnt(4)
    s_barrier
    s_barrier
    s_waitcnt vmcnt(7)
    v_xor_b32 v4, 128, v14
    s_add_u32 s43, s68, 102400
    s_mov_b32 m0, s43
    s_add_u32 s42, s19, 98304
    buffer_load_dwordx4 v4, s[8:11], s42 offen nt lds
    s_waitcnt vmcnt(7)
    v_xor_b32 v4, 192, v14
    s_add_u32 s43, s68, 103424
    s_mov_b32 m0, s43
    s_add_u32 s42, s19, 122880
    buffer_load_dwordx4 v4, s[8:11], s42 offen nt lds
    s_waitcnt vmcnt(7)
    v_xor_b32 v4, 128, v14
    s_add_u32 s43, s68, 104448
    s_mov_b32 m0, s43
    s_add_u32 s42, s19, 147456
    buffer_load_dwordx4 v4, s[8:11], s42 offen nt lds
    s_waitcnt vmcnt(7)
    v_xor_b32 v4, 192, v14
    s_add_u32 s43, s68, 105472
    s_mov_b32 m0, s43
    s_add_u32 s42, s19, 172032
    buffer_load_dwordx4 v4, s[8:11], s42 offen nt lds
    s_waitcnt vmcnt(7)
    s_add_u32 s43, s68, 0
    s_mov_b32 m0, s43
    s_add_u32 s42, s67, 0
    buffer_load_dwordx4 v5, s[56:59], s42 offen nt lds
    s_waitcnt vmcnt(7)
    s_add_u32 s43, s68, 1024
    s_mov_b32 m0, s43
    s_add_u32 s42, s67, 114688
    buffer_load_dwordx4 v5, s[56:59], s42 offen nt lds
    s_waitcnt vmcnt(7)
    s_add_u32 s43, s68, 2048
    s_mov_b32 m0, s43
    s_add_u32 s42, s67, 28672
    buffer_load_dwordx4 v5, s[56:59], s42 offen nt lds
    s_waitcnt vmcnt(7)
    s_add_u32 s43, s68, 3072
    s_mov_b32 m0, s43
    s_add_u32 s42, s67, 143360
    buffer_load_dwordx4 v5, s[56:59], s42 offen nt lds
    s_waitcnt vmcnt(7)
    s_add_u32 s43, s68, 4096
    s_mov_b32 m0, s43
    s_add_u32 s42, s67, 229376
    buffer_load_dwordx4 v5, s[56:59], s42 offen nt lds
    s_waitcnt vmcnt(7)
    s_add_u32 s43, s68, 5120
    s_mov_b32 m0, s43
    s_add_u32 s42, s67, 344064
    buffer_load_dwordx4 v5, s[56:59], s42 offen nt lds
    s_waitcnt vmcnt(6)
    s_barrier
    s_barrier
    s_waitcnt vmcnt(7)
    s_add_u32 s43, s68, 6144
    s_mov_b32 m0, s43
    s_add_u32 s42, s67, 258048
    buffer_load_dwordx4 v5, s[56:59], s42 offen nt lds
    s_waitcnt vmcnt(7)
    s_add_u32 s43, s68, 7168
    s_mov_b32 m0, s43
    s_add_u32 s42, s67, 372736
    buffer_load_dwordx4 v5, s[56:59], s42 offen nt lds
    s_waitcnt vmcnt(9)
    s_add_u32 s43, s68, 32768
    s_mov_b32 m0, s43
    s_add_u32 s42, s67, 1835008
    buffer_load_dwordx4 v5, s[56:59], s42 offen nt lds
    s_waitcnt vmcnt(9)
    s_add_u32 s43, s68, 33792
    s_mov_b32 m0, s43
    s_add_u32 s42, s67, 1949696
    buffer_load_dwordx4 v5, s[56:59], s42 offen nt lds
    s_waitcnt vmcnt(9)
    s_add_u32 s43, s68, 34816
    s_mov_b32 m0, s43
    s_add_u32 s42, s67, 1863680
    buffer_load_dwordx4 v5, s[56:59], s42 offen nt lds
    s_waitcnt vmcnt(9)
    s_add_u32 s43, s68, 35840
    s_mov_b32 m0, s43
    s_add_u32 s42, s67, 1978368
    buffer_load_dwordx4 v5, s[56:59], s42 offen nt lds
    s_waitcnt vmcnt(9)
    s_add_u32 s43, s68, 36864
    s_mov_b32 m0, s43
    s_add_u32 s42, s67, 2064384
    buffer_load_dwordx4 v5, s[56:59], s42 offen nt lds
    s_waitcnt vmcnt(9)
    s_add_u32 s43, s68, 37888
    s_mov_b32 m0, s43
    s_add_u32 s42, s67, 2179072
    buffer_load_dwordx4 v5, s[56:59], s42 offen nt lds
    s_waitcnt vmcnt(9)
    s_add_u32 s43, s68, 38912
    s_mov_b32 m0, s43
    s_add_u32 s42, s67, 2093056
    buffer_load_dwordx4 v5, s[56:59], s42 offen nt lds
    s_waitcnt vmcnt(9)
    s_add_u32 s43, s68, 39936
    s_mov_b32 m0, s43
    s_add_u32 s42, s67, 2207744
    buffer_load_dwordx4 v5, s[56:59], s42 offen nt lds
    s_waitcnt vmcnt(9)
    s_add_u32 s43, s68, 65536
    s_mov_b32 m0, s43
    s_add_u32 s42, s67, 0
    buffer_load_dwordx4 v5, s[44:47], s42 offen nt lds
    s_waitcnt vmcnt(9)
    s_barrier
    s_add_u32 s43, s68, 66560
    s_mov_b32 m0, s43
    s_add_u32 s42, s67, 114688
    buffer_load_dwordx4 v5, s[44:47], s42 offen nt lds
    s_waitcnt vmcnt(9)
    s_add_u32 s43, s68, 67584
    s_mov_b32 m0, s43
    s_add_u32 s42, s67, 28672
    buffer_load_dwordx4 v5, s[44:47], s42 offen nt lds
    s_waitcnt vmcnt(9)
    s_add_u32 s43, s68, 68608
    s_mov_b32 m0, s43
    s_add_u32 s42, s67, 143360
    buffer_load_dwordx4 v5, s[44:47], s42 offen nt lds
    s_waitcnt vmcnt(9)
    s_add_u32 s43, s68, 69632
    s_mov_b32 m0, s43
    s_add_u32 s42, s67, 229376
    buffer_load_dwordx4 v5, s[44:47], s42 offen nt lds
    s_waitcnt vmcnt(9)
    s_add_u32 s43, s68, 70656
    s_mov_b32 m0, s43
    s_add_u32 s42, s67, 344064
    buffer_load_dwordx4 v5, s[44:47], s42 offen nt lds
    s_waitcnt vmcnt(9)
    s_add_u32 s43, s68, 71680
    s_mov_b32 m0, s43
    s_add_u32 s42, s67, 258048
    buffer_load_dwordx4 v5, s[44:47], s42 offen nt lds
    s_waitcnt vmcnt(9)
    s_add_u32 s43, s68, 72704
    s_mov_b32 m0, s43
    s_add_u32 s42, s67, 372736
    buffer_load_dwordx4 v5, s[44:47], s42 offen nt lds
    s_waitcnt vmcnt(9)
    s_add_u32 s43, s68, 98304
    s_mov_b32 m0, s43
    s_add_u32 s42, s67, 1835008
    buffer_load_dwordx4 v5, s[44:47], s42 offen nt lds
    s_waitcnt vmcnt(9)
    s_barrier
    ds_read_b64_tr_b16 v[64:65], v12 offset:0
    ds_read_b64_tr_b16 v[66:67], v12 offset:2048
    ds_read_b64_tr_b16 v[68:69], v12 offset:4096
    ds_read_b64_tr_b16 v[70:71], v12 offset:6144
    ds_read_b64_tr_b16 v[72:73], v12 offset:8192
    ds_read_b64_tr_b16 v[74:75], v12 offset:10240
    ds_read_b64_tr_b16 v[76:77], v12 offset:12288
    ds_read_b64_tr_b16 v[78:79], v12 offset:14336
    ds_read_b64_tr_b16 v[80:81], v12 offset:16384
    ds_read_b64_tr_b16 v[82:83], v12 offset:18432
    ds_read_b64_tr_b16 v[84:85], v12 offset:20480
    ds_read_b64_tr_b16 v[86:87], v12 offset:22528
    ds_read_b64_tr_b16 v[88:89], v12 offset:24576
    ds_read_b64_tr_b16 v[90:91], v12 offset:26624
    ds_read_b64_tr_b16 v[92:93], v12 offset:28672
    ds_read_b64_tr_b16 v[94:95], v12 offset:30720
    s_add_u32 s43, s68, 99328
    s_mov_b32 m0, s43
    s_add_u32 s42, s67, 1949696
    buffer_load_dwordx4 v5, s[44:47], s42 offen nt lds
    s_waitcnt vmcnt(9)
    s_add_u32 s43, s68, 100352
    s_mov_b32 m0, s43
    s_add_u32 s42, s67, 1863680
    buffer_load_dwordx4 v5, s[44:47], s42 offen nt lds
    s_waitcnt vmcnt(9)
    s_add_u32 s43, s68, 101376
    s_mov_b32 m0, s43
    s_add_u32 s42, s67, 1978368
    buffer_load_dwordx4 v5, s[44:47], s42 offen nt lds
    s_waitcnt vmcnt(9)
    s_add_u32 s43, s68, 102400
    s_mov_b32 m0, s43
    s_add_u32 s42, s67, 2064384
    buffer_load_dwordx4 v5, s[44:47], s42 offen nt lds
    s_waitcnt vmcnt(9)
    s_add_u32 s43, s68, 103424
    s_mov_b32 m0, s43
    s_add_u32 s42, s67, 2179072
    buffer_load_dwordx4 v5, s[44:47], s42 offen nt lds
    s_waitcnt vmcnt(9)
    s_add_u32 s43, s68, 104448
    s_mov_b32 m0, s43
    s_add_u32 s42, s67, 2093056
    buffer_load_dwordx4 v5, s[44:47], s42 offen nt lds
    s_waitcnt vmcnt(9)
    s_add_u32 s43, s68, 105472
    s_mov_b32 m0, s43
    s_add_u32 s42, s67, 2207744
    buffer_load_dwordx4 v5, s[44:47], s42 offen nt lds
    s_branch m_join
g_cons:
    s_lshl_b32 s29, s34, 4
    s_add_u32 s29, s29, s35
    s_lshl_b32 s29, s29, 12
    s_add_u32 s29, s29, 19922944
    s_lshl_b32 s30, s16, 9
    s_add_u32 s30, s30, s29
    s_lshl_b32 s31, s16, 8
    s_add_u32 s31, s31, s29
    s_add_u32 s31, s31, 2048
    v_lshlrev_b32 v8, 1, v2
    v_lshlrev_b32 v9, 7, v2
    v_mov_b32 v104, -1
    v_mov_b32 v105, -1
    v_mov_b32 v106, -1
    v_mov_b32 v107, -1
    s_waitcnt lgkmcnt(0)
    s_mov_b32 s12, s6
    s_mov_b32 s13, s7
    s_cmp_eq_u32 s16, 1
    s_cselect_b64 exec, 0xffffff, 1
    buffer_load_dword v245, v9, s[12:15], s29 offen sc1
    s_mov_b64 exec, -1
    v_mov_b32 v14, 0
    s_mov_b32 s8, s58
    s_mov_b32 s9, s59
    s_mov_b32 s10, 12582912
    s_mov_b32 s11, 0x00020000
    s_mov_b32 s20, s26
    s_mov_b32 s21, s27
    s_mov_b32 s26, 4194304
    s_mov_b32 s27, 0x00020000
    s_and_b32 s65, s35, 1
    s_lshr_b32 s40, s35, 1
    s_mul_i32 s64, s34, 7
    s_add_u32 s64, s64, s40
    s_lshl_b32 s41, s34, 1
    s_add_u32 s41, s41, s65
    s_cmp_ge_u32 s35, 14
    s_cselect_b32 s66, 1, 0
    s_cselect_b32 s64, s41, s64
    v_lshrrev_b32 v10, 2, v2
    v_and_b32 v15, 3, v0
    v_bfe_u32 v11, v0, 3, 2
    v_xor_b32 v12, v11, v1
    v_and_b32 v12, 3, v12
    v_lshlrev_b32 v12, 5, v12
    v_lshl_add_u32 v12, v10, 7, v12
    v_lshl_add_u32 v12, v15, 3, v12
    v_lshrrev_b32 v16, 2, v1
    v_lshl_add_u32 v12, v16, 15, v12
    v_add_u32 v21, 65536, v12
    v_bfe_u32 v22, v0, 2, 3
    v_lshlrev_b32 v22, 5, v22
    v_lshl_add_u32 v22, v15, 3, v22
    v_bfe_u32 v23, v0, 2, 2
    v_bfe_u32 v24, v0, 4, 2
    v_lshl_add_u32 v23, v24, 3, v23
    v_lshl_add_u32 v200, v23, 10, v22
    v_lshl_add_u32 v200, v1, 8, v200
    v_add_u32 v200, 32768, v200
    v_lshlrev_b32 v25, 7, v1
    v_xor_b32 v22, v22, v25
    v_lshl_add_u32 v208, v23, 9, v22
    v_add_u32 v208, 98304, v208
    v_cmp_eq_u32 s[60:61], 1, v24
    v_cmp_eq_u32 s[62:63], 2, v24
    v_cmp_eq_u32 s[72:73], 3, v24
    v_add_u32 v8, v8, v25
    v_add_u32 v8, 139264, v8
    v_lshl_add_u32 v10, v24, 4, v25
    v_add_u32 v10, 139264, v10
    v_xor_b32 v201, 32, v200
    v_xor_b32 v202, 64, v200
    v_xor_b32 v203, 96, v200
    v_xor_b32 v204, 128, v200
    v_xor_b32 v205, 160, v200
    v_xor_b32 v206, 192, v200
    v_xor_b32 v207, 224, v200
    v_xor_b32 v209, 32, v208
    v_xor_b32 v210, 64, v208
    v_xor_b32 v211, 96, v208
    s_sleep 8
    s_load_dwordx2 s[32:33], s[20:21], 128
    s_waitcnt lgkmcnt(0)
    s_cmp_lg_u32 s32, 0
    s_cbranch_scc1 g_nnx
    s_load_dwordx2 s[32:33], s[20:21], 192
    s_mov_b32 s83, 0
    v_mov_b32 v114, 0
    s_waitcnt lgkmcnt(0)
g_nn:
    s_cmp_lg_u32 s32, 0
    s_cbranch_scc1 g_nnx
    global_load_dwordx2 v[112:113], v114, s[20:21] sc1
    s_waitcnt vmcnt(0)
    v_readfirstlane_b32 s32, v112
    v_readfirstlane_b32 s33, v113
    s_add_u32 s83, s83, 1
    s_cmp_lt_u32 s83, 0x40000
    s_cbranch_scc1 g_nn
g_nnx:
    v_mov_b32 v212, s32
    v_mov_b32 v213, s33
    v_and_b32 v214, 7, v0
    v_lshlrev_b32 v214, 3, v214
    v_lshrrev_b64 v[212:213], v214, v[212:213]
    v_and_b32 v212, 0xff, v212
    s_movk_i32 s74, 0xff00
    s_cmp_ge_u32 s16, s66
    s_cbranch_scc1 g_nw
    s_lshr_b32 s22, s64, 2
    s_cmp_eq_u32 s22, 3
    s_cselect_b32 s22, 6, s22
    s_lshl_b32 s22, s22, 12
    s_add_u32 s22, s22, 16875520
    s_lshr_b32 s23, s64, 3
    s_lshl_b32 s23, s23, 13
    s_add_u32 s23, s23, 16908288
    s_mov_b32 s75, 16891904
    v_bfe_u32 v24, v0, 2, 1
    v_bfe_u32 v25, v0, 3, 2
    v_bfe_u32 v26, v0, 5, 1
    v_lshlrev_b32 v220, 4, v15
    v_lshl_add_u32 v220, v24, 9, v220
    v_lshl_add_u32 v220, v25, 10, v220
    s_and_b32 s42, s64, 3
    s_lshl_b32 s42, s42, 7
    s_and_b32 s43, s64, 4
    s_lshl_b32 s43, s43, 4
    s_add_u32 s42, s42, s43
    v_add_u32 v233, s42, v220
    v_lshl_add_u32 v220, v26, 7, v220
    s_and_b32 s42, s64, 1
    s_lshl_b32 s42, s42, 8
    s_and_b32 s43, s64, 2
    s_lshl_b32 s43, s43, 5
    s_add_u32 s42, s42, s43
    v_add_u32 v220, s42, v220
    v_xor_b32 v234, 8176, v220
    v_xor_b32 v235, 8176, v233
    v_lshlrev_b32 v221, 7, v15
    v_lshl_add_u32 v221, v24, 6, v221
    v_lshl_add_u32 v221, v25, 4, v221
    v_lshl_add_u32 v221, v26, 9, v221
    v_add_u32 v232, 8, v2
    v_and_b32 v232, 31, v232
    v_lshl_add_u32 v232, v26, 5, v232
    v_lshlrev_b32 v232, 2, v232
    s_lshl_b32 s79, s64, 7
    s_add_u32 s79, s79, 16850944
    v_xor_b32 v0, 1, v0
    v_mov_b32 v228, s32
    v_mov_b32 v229, s33
    v_and_b32 v230, 1, v0
    v_cmp_eq_u32 vcc, 1, v230
    s_nop 1
    v_cndmask_b32 v228, v228, v229, vcc
    v_bfe_u32 v229, v228, 8, 8
    v_bfe_u32 v230, v228, 16, 8
    v_lshrrev_b32 v231, 24, v228
    v_and_b32 v228, 0xff, v228
    v_xor_b32 v0, 1, v0
    s_mov_b32 s44, s48
    s_mov_b32 s45, s49
    s_mov_b32 s46, 2048
    s_mov_b32 s47, 0x00020000
    v_lshrrev_b32 v11, 1, v221
    s_and_b32 s42, s64, 3
    s_lshl_b32 s42, s42, 9
    buffer_load_dwordx2 v[52:53], v11, s[44:47], s42 offen
    v_mov_b32 v216, s32
    v_mov_b32 v217, s33
    v_and_b32 v218, 1, v0
    v_cmp_eq_u32 vcc, 1, v218
    s_nop 1
    v_cndmask_b32 v216, v216, v217, vcc
    v_bfe_u32 v217, v216, 8, 8
    v_bfe_u32 v218, v216, 16, 8
    v_lshrrev_b32 v219, 24, v216
    v_and_b32 v216, 0xff, v216
    v_not_b32 v24, v216
    v_not_b32 v25, v229
    buffer_store_dwordx4 v[24:27], v220, s[12:15], s22 offen sc1
    s_mov_b32 exec_hi, 0
    buffer_store_dwordx4 v[24:27], v233, s[12:15], s23 offen sc1
    buffer_store_dwordx4 v[24:27], v235, s[12:15], s23 offen sc1
    s_mov_b64 exec, 0xff
    buffer_store_dwordx4 v[104:107], v3, s[12:15], s79 offen sc1
    s_mov_b64 exec, -1
    s_cmp_lt_u32 s64, 8
    s_cbranch_scc1 g_nw
    buffer_store_dwordx4 v[24:27], v234, s[12:15], s22 offen sc1
    s_cmp_lt_u32 s64, 12
    s_cbranch_scc1 g_nw
    buffer_store_dwordx4 v[24:27], v220, s[12:15], s75 offen sc1
    buffer_store_dwordx4 v[24:27], v234, s[12:15], s75 offen sc1
g_nw:
    s_barrier
    ds_read_u16 v6, v8
    s_waitcnt lgkmcnt(0)
    v_lshlrev_b32 v6, 16, v6
    v_mul_f32 v24, 0xbfb8aa3b, v6
    v_exp_f32 v24, v24
    s_nop 0
    v_add_f32 v24, 1.0, v24
    v_rcp_f32 v24, v24
    s_nop 0
    v_mul_f32 v6, v6, v24
    v_cvt_pk_bf16_f32 v6, v6, v6
    ds_write_b16 v8, v6
    ds_read_b128 v[120:123], v10
    ds_read_b128 v[124:127], v10 offset:64
    ds_read_b64_tr_b16 v[128:129], v200 offset:0
    ds_read_b64_tr_b16 v[130:131], v200 offset:4096
    ds_read_b64_tr_b16 v[132:133], v201 offset:0
    ds_read_b64_tr_b16 v[134:135], v201 offset:4096
    ds_read_b64_tr_b16 v[136:137], v202 offset:0
    ds_read_b64_tr_b16 v[138:139], v202 offset:4096
    ds_read_b64_tr_b16 v[140:141], v203 offset:0
    ds_read_b64_tr_b16 v[142:143], v203 offset:4096
    ds_read_b64_tr_b16 v[144:145], v204 offset:0
    ds_read_b64_tr_b16 v[146:147], v204 offset:4096
    ds_read_b64_tr_b16 v[148:149], v205 offset:0
    ds_read_b64_tr_b16 v[150:151], v205 offset:4096
    ds_read_b64_tr_b16 v[152:153], v206 offset:0
    ds_read_b64_tr_b16 v[154:155], v206 offset:4096
    s_waitcnt lgkmcnt(12)
    v_mfma_f32_16x16x32_bf16 v[64:67], v[120:123], v[128:131], 0
    ds_read_b64_tr_b16 v[156:157], v207 offset:0
    ds_read_b64_tr_b16 v[158:159], v207 offset:4096
    s_waitcnt lgkmcnt(12)
    v_mfma_f32_16x16x32_bf16 v[68:71], v[120:123], v[132:135], 0
    s_waitcnt lgkmcnt(10)
    v_mfma_f32_16x16x32_bf16 v[72:75], v[120:123], v[136:139], 0
    s_waitcnt lgkmcnt(8)
    v_mfma_f32_16x16x32_bf16 v[76:79], v[120:123], v[140:143], 0
    s_waitcnt lgkmcnt(6)
    v_mfma_f32_16x16x32_bf16 v[80:83], v[120:123], v[144:147], 0
    s_waitcnt lgkmcnt(4)
    v_mfma_f32_16x16x32_bf16 v[84:87], v[120:123], v[148:151], 0
    s_waitcnt lgkmcnt(2)
    v_mfma_f32_16x16x32_bf16 v[88:91], v[120:123], v[152:155], 0
    s_waitcnt lgkmcnt(0)
    v_mfma_f32_16x16x32_bf16 v[92:95], v[120:123], v[156:159], 0
    v_mov_b32 v216, s32
    v_mov_b32 v217, s33
    v_and_b32 v218, 1, v0
    v_cmp_eq_u32 vcc, 1, v218
    s_nop 1
    v_cndmask_b32 v216, v216, v217, vcc
    v_bfe_u32 v217, v216, 8, 8
    v_bfe_u32 v218, v216, 16, 8
    v_lshrrev_b32 v219, 24, v216
    v_and_b32 v216, 0xff, v216
    s_lshl_b32 s81, s34, 16
    s_lshl_b32 s42, s16, 13
    s_add_u32 s81, s81, s42
    s_add_u32 s81, s81, 19922944
    s_lshl_b32 s42, s65, 9
    s_add_u32 s80, s81, s42
    s_add_u32 s81, s80, s42
    v_lshlrev_b32 v222, 4, v0
    v_lshrrev_b32 v223, 5, v2
    v_and_b32 v24, 0x1f0, v3
    v_lshl_add_u32 v223, v223, 12, v24
    s_lshl_b32 s39, s34, 4
    s_add_u32 s39, s39, s35
    s_lshl_b32 s39, s39, 12
    s_add_u32 s39, s39, 19922944
    s_bitcmp1_b32 s64, 2
    s_cselect_b32 s28, 1.0, 0
    s_barrier
    ds_read_b64_tr_b16 v[128:129], v200 offset:32768
    ds_read_b64_tr_b16 v[130:131], v200 offset:36864
    ds_read_b64_tr_b16 v[132:133], v201 offset:32768
    ds_read_b64_tr_b16 v[134:135], v201 offset:36864
    ds_read_b64_tr_b16 v[136:137], v202 offset:32768
    ds_read_b64_tr_b16 v[138:139], v202 offset:36864
    ds_read_b64_tr_b16 v[140:141], v203 offset:32768
    ds_read_b64_tr_b16 v[142:143], v203 offset:36864
    ds_read_b64_tr_b16 v[144:145], v204 offset:32768
    ds_read_b64_tr_b16 v[146:147], v204 offset:36864
    ds_read_b64_tr_b16 v[148:149], v205 offset:32768
    ds_read_b64_tr_b16 v[150:151], v205 offset:36864
    ds_read_b64_tr_b16 v[152:153], v206 offset:32768
    ds_read_b64_tr_b16 v[154:155], v206 offset:36864
    s_waitcnt lgkmcnt(12)
    v_mfma_f32_16x16x32_bf16 v[64:67], v[124:127], v[128:131], v[64:67]
    ds_read_b64_tr_b16 v[156:157], v207 offset:32768
    ds_read_b64_tr_b16 v[158:159], v207 offset:36864
    s_waitcnt lgkmcnt(12)
    v_mfma_f32_16x16x32_bf16 v[68:71], v[124:127], v[132:135], v[68:71]
    s_waitcnt lgkmcnt(10)
    v_mfma_f32_16x16x32_bf16 v[72:75], v[124:127], v[136:139], v[72:75]
    s_waitcnt lgkmcnt(8)
    v_mfma_f32_16x16x32_bf16 v[76:79], v[124:127], v[140:143], v[76:79]
    s_waitcnt lgkmcnt(6)
    v_mfma_f32_16x16x32_bf16 v[80:83], v[124:127], v[144:147], v[80:83]
    s_waitcnt lgkmcnt(4)
    v_mfma_f32_16x16x32_bf16 v[84:87], v[124:127], v[148:151], v[84:87]
    s_waitcnt lgkmcnt(2)
    v_mfma_f32_16x16x32_bf16 v[88:91], v[124:127], v[152:155], v[88:91]
    s_waitcnt lgkmcnt(0)
    v_mfma_f32_16x16x32_bf16 v[92:95], v[124:127], v[156:159], v[92:95]
    v_cndmask_b32 v64, v64, v68, s[60:61]
    v_cndmask_b32 v64, v64, v72, s[62:63]
    v_cndmask_b32 v64, v64, v76, s[72:73]
    v_and_or_b32 v224, v64, s74, v212
    v_cndmask_b32 v80, v80, v84, s[60:61]
    s_nop 0
    v_cndmask_b32 v80, v80, v88, s[62:63]
    s_nop 0
    v_cndmask_b32 v80, v80, v92, s[72:73]
    v_and_or_b32 v225, v80, s74, v212
    buffer_store_dword v224, v13, s[12:15], s30 offen offset:0
    buffer_store_dword v225, v13, s[12:15], s30 offen offset:256
    s_cmp_eq_u32 s66, 1
    s_cbranch_scc1 x_start
    s_barrier
    s_barrier
    ds_read_b64_tr_b16 v[128:129], v208 offset:0
    ds_read_b64_tr_b16 v[130:131], v208 offset:2048
    ds_read_b64_tr_b16 v[132:133], v209 offset:0
    ds_read_b64_tr_b16 v[134:135], v209 offset:2048
    ds_read_b64_tr_b16 v[136:137], v210 offset:0
    ds_read_b64_tr_b16 v[138:139], v210 offset:2048
    ds_read_b64_tr_b16 v[140:141], v211 offset:0
    ds_read_b64_tr_b16 v[142:143], v211 offset:2048
    ds_read_b64_tr_b16 v[144:145], v208 offset:16384
    ds_read_b64_tr_b16 v[146:147], v208 offset:18432
    ds_read_b64_tr_b16 v[148:149], v209 offset:16384
    ds_read_b64_tr_b16 v[150:151], v209 offset:18432
    ds_read_b64_tr_b16 v[152:153], v210 offset:16384
    ds_read_b64_tr_b16 v[154:155], v210 offset:18432
    s_waitcnt lgkmcnt(12)
    v_mfma_f32_16x16x32_bf16 v[64:67], v[120:123], v[128:131], 0
    ds_read_b64_tr_b16 v[156:157], v211 offset:16384
    ds_read_b64_tr_b16 v[158:159], v211 offset:18432
    s_waitcnt lgkmcnt(12)
    v_mfma_f32_16x16x32_bf16 v[68:71], v[120:123], v[132:135], 0
    s_waitcnt lgkmcnt(10)
    v_mfma_f32_16x16x32_bf16 v[72:75], v[120:123], v[136:139], 0
    s_waitcnt lgkmcnt(8)
    v_mfma_f32_16x16x32_bf16 v[76:79], v[120:123], v[140:143], 0
    s_waitcnt lgkmcnt(6)
    v_mfma_f32_16x16x32_bf16 v[64:67], v[124:127], v[144:147], v[64:67]
    s_waitcnt lgkmcnt(4)
    v_mfma_f32_16x16x32_bf16 v[68:71], v[124:127], v[148:151], v[68:71]
    s_waitcnt lgkmcnt(2)
    v_mfma_f32_16x16x32_bf16 v[72:75], v[124:127], v[152:155], v[72:75]
    s_waitcnt lgkmcnt(0)
    v_mfma_f32_16x16x32_bf16 v[76:79], v[124:127], v[156:159], v[76:79]
    s_nop 3
    v_cndmask_b32 v64, v64, v68, s[60:61]
    s_nop 0
    v_cndmask_b32 v64, v64, v72, s[62:63]
    s_nop 0
    v_cndmask_b32 v64, v64, v76, s[72:73]
    v_and_or_b32 v226, v64, s74, v212
    buffer_store_dword v226, v13, s[12:15], s31 offen offset:0
    s_barrier
    s_bitcmp1_b32 s16, 0
    s_cselect_b32 s8, s52, s50
    s_cselect_b32 s9, s53, s51
    s_mov_b32 s10, 7340032
    s_lshr_b32 s42, s8, 7
    s_sub_u32 s42, 3, s42
    s_add_u32 s42, s42, s34
    s_and_b32 s42, s42, 7
    s_cmp_eq_u32 s42, 7
    s_cbranch_scc1 m_nh2
    s_mul_i32 s43, s34, 7
    s_add_u32 s42, s42, s43
    s_lshl_b32 s42, s42, 7
    s_lshl_b32 s43, s35, 1
    s_lshr_b32 s40, s16, 1
    s_add_u32 s43, s43, s40
    s_mul_i32 s43, s43, 265216
    s_add_u32 s42, s42, s43
    v_mul_u32_u24 v24, 7168, v2
    s_mov_b32 exec_lo, 4294967295
    s_mov_b32 exec_hi, 31
    buffer_load_dword v245, v24, s[8:11], s42 offen
    s_mov_b64 exec, -1
m_nh2:
    s_barrier
    ds_read_b64_tr_b16 v[64:65], v12 offset:0
    ds_read_b64_tr_b16 v[66:67], v12 offset:2048
    ds_read_b64_tr_b16 v[68:69], v12 offset:4096
    ds_read_b64_tr_b16 v[70:71], v12 offset:6144
    ds_read_b64_tr_b16 v[72:73], v12 offset:8192
    ds_read_b64_tr_b16 v[74:75], v12 offset:10240
    ds_read_b64_tr_b16 v[76:77], v12 offset:12288
    ds_read_b64_tr_b16 v[78:79], v12 offset:14336
    ds_read_b64_tr_b16 v[80:81], v12 offset:16384
    ds_read_b64_tr_b16 v[82:83], v12 offset:18432
    ds_read_b64_tr_b16 v[84:85], v12 offset:20480
    ds_read_b64_tr_b16 v[86:87], v12 offset:22528
    ds_read_b64_tr_b16 v[88:89], v12 offset:24576
    ds_read_b64_tr_b16 v[90:91], v12 offset:26624
    ds_read_b64_tr_b16 v[92:93], v12 offset:28672
    ds_read_b64_tr_b16 v[94:95], v12 offset:30720
    s_waitcnt vmcnt(0)
    s_barrier
    s_sub_u32 s42, s16, 1
    s_cmp_ge_u32 s42, 3
    s_cbranch_scc1 m_nb
    s_lshl_b32 s42, s42, 10
    s_add_u32 s42, s42, s29
    s_add_u32 s43, s42, 524288
    buffer_load_dwordx4 v[44:47], v3, s[12:15], s42 offen sc1
    s_waitcnt vmcnt(0)
    buffer_store_dwordx4 v[44:47], v3, s[12:15], s43 offen sc1
m_nb:
m_join:
    v_bfe_u32 v7, v0, 4, 2
    v_and_b32 v6, 3, v0
    v_mul_u32_u24 v17, 576, v6
    v_lshl_add_u32 v17, v16, 8, v17
    v_lshl_add_u32 v17, v7, 4, v17
    v_add_u32 v17, 131072, v17
    v_cmp_lt_u32 vcc, 1, v6
    v_mov_b32 v19, 0x44444444
    v_mov_b32 v22, 0xeeeeeeee
    v_cndmask_b32 v19, v19, v22, vcc
    v_and_b32 v6, 15, v0
    v_lshlrev_b32 v13, 5, v6
    v_bfe_u32 v22, v0, 4, 1
    v_lshl_add_u32 v13, v22, 4, v13
    v_bfe_u32 v22, v0, 5, 1
    v_lshl_add_u32 v13, v22, 3, v13
    v_mul_u32_u24 v22, 576, v1
    v_add_u32 v13, v13, v22
    v_add_u32 v13, 131072, v13
    s_lshl_b32 s70, s34, 1
    s_add_u32 s70, s70, s16
    s_lshl_b32 s70, s70, 13
    s_lshl_b32 s71, s65, 11
    s_add_u32 s70, s70, s71
    s_add_u32 s70, s70, 17301504
    s_mov_b32 s71, 0x07060302
    s_lshl_b32 s69, s64, 2
    s_and_b32 s42, s16, 3
    s_add_u32 s69, s69, s42
    s_lshl_b32 s69, s69, 10
    s_lshl_b32 s76, s65, 1
    s_lshr_b32 s42, s16, 2
    s_add_u32 s76, s76, s42
    s_lshl_b32 s76, s76, 8
    s_add_u32 s76, s76, s69
    s_add_u32 s77, s76, 18612224
    s_add_u32 s76, s76, 18350080
    s_add_u32 s69, s69, 18350080
    s_cmp_lg_u32 s16, 2
    s_cbranch_scc1 m_n0
    v_lshlrev_b32 v4, 7, v2
    s_sub_u32 s69, s69, 2048
    s_mov_b32 exec_hi, 0
    buffer_load_dword v5, v4, s[12:15], s69 offen sc1
    s_mov_b32 exec_hi, -1
m_n0:
    s_cmp_ge_u32 s16, 2
    s_cbranch_scc1 m_n1
    v_lshlrev_b32 v4, 7, v2
    s_mov_b64 exec, 0xffff
    buffer_load_dword v5, v4, s[12:15], s70 offen sc1
    s_mov_b64 exec, -1
m_n1:
    v_mov_b32 v216, s32
    v_mov_b32 v217, s33
    v_and_b32 v218, 1, v0
    v_cmp_eq_u32 vcc, 1, v218
    s_nop 1
    v_cndmask_b32 v216, v216, v217, vcc
    v_bfe_u32 v217, v216, 8, 8
    v_bfe_u32 v218, v216, 16, 8
    v_lshrrev_b32 v219, 24, v216
    v_and_b32 v216, 0xff, v216
    s_and_b32 s60, s32, 0xffff
    s_lshr_b32 s61, s32, 16
    s_and_b32 s62, s33, 0xffff
    s_lshr_b32 s63, s33, 16
    s_movk_i32 s74, 0xff00
    s_waitcnt vmcnt(0)
    s_barrier
    s_cmp_ge_u32 s16, 2
    s_cselect_b64 exec, 1, -1
    buffer_load_dwordx4 v[176:179], v3, s[12:15], s70 offen sc1
    buffer_load_dwordx4 v[180:183], v3, s[12:15], s70 offen offset:1024 sc1
    s_mov_b64 exec, -1
    ds_read_b64_tr_b16 v[96:97], v21 offset:0
    ds_read_b64_tr_b16 v[98:99], v21 offset:2048
    ds_read_b64_tr_b16 v[100:101], v21 offset:4096
    ds_read_b64_tr_b16 v[102:103], v21 offset:6144
    ds_read_b64_tr_b16 v[104:105], v21 offset:8192
    ds_read_b64_tr_b16 v[106:107], v21 offset:10240
    ds_read_b64_tr_b16 v[108:109], v21 offset:12288
    ds_read_b64_tr_b16 v[110:111], v21 offset:14336
    ds_read_b64_tr_b16 v[112:113], v21 offset:16384
    ds_read_b64_tr_b16 v[114:115], v21 offset:18432
    ds_read_b64_tr_b16 v[116:117], v21 offset:20480
    ds_read_b64_tr_b16 v[118:119], v21 offset:22528
    ds_read_b64_tr_b16 v[120:121], v21 offset:24576
    ds_read_b64_tr_b16 v[122:123], v21 offset:26624
    ds_read_b64_tr_b16 v[124:125], v21 offset:28672
    ds_read_b64_tr_b16 v[126:127], v21 offset:30720
    v_mov_b32 v160, 0
    v_mov_b32 v161, 0
    v_mov_b32 v162, 0
    v_mov_b32 v163, 0
    v_mov_b32 v164, 0
    v_mov_b32 v165, 0
    v_mov_b32 v166, 0
    v_mov_b32 v167, 0
    s_cbranch_scc1 m_nk
    s_mov_b32 s83, 0
    s_branch m_ph
m_pr:
    s_and_b32 s42, s83, 63
    s_cmp_eq_u32 s42, 63
    s_cselect_b32 s42, 131072, 0
    s_add_u32 s42, s42, s70
    buffer_load_dwordx4 v[176:179], v3, s[12:15], s42 offen sc1
    buffer_load_dwordx4 v[180:183], v3, s[12:15], s42 offen offset:1024 sc1
    s_add_u32 s83, s83, 1
    s_cmp_ge_u32 s83, 0x40000
    s_cbranch_scc1 m_phx
m_ph:
    s_waitcnt vmcnt(0)
    v_cmp_ne_u16 vcc, s63, v183
    s_cbranch_vccnz m_pr
    v_perm_b32 v184, v177, v176, s71
    v_perm_b32 v186, v179, v178, s71
    v_perm_b32 v185, v181, v180, s71
    v_perm_b32 v187, v183, v182, s71
    ds_write2_b64 v13, v[184:185], v[186:187] offset0:0 offset1:144
    v_xor_b32 v176, s60, v176
    v_xor_b32 v177, s61, v177
    v_xor_b32 v178, s62, v178
    v_xor_b32 v179, s63, v179
    v_xor_b32 v180, s60, v180
    v_xor_b32 v181, s61, v181
    v_xor_b32 v182, s62, v182
    v_xor_b32 v183, s63, v183
    v_or3_b32 v4, v176, v177, 0
    v_or3_b32 v4, v178, v179, v4
    v_or3_b32 v4, v180, v181, v4
    v_or3_b32 v4, v182, v183, v4
    v_cmp_ne_u16 vcc, 0, v4
    s_cbranch_vccnz m_pr
m_phx:
m_nk:
    s_waitcnt lgkmcnt(0)
    s_barrier
    ds_read_b128 v[128:131], v17 offset:0
    ds_read_b128 v[132:135], v17 offset:64
    ds_read_b128 v[136:139], v17 offset:128
    ds_read_b128 v[140:143], v17 offset:192
    s_waitcnt lgkmcnt(3)
    v_smfmac_f32_16x16x64_bf16 v[160:163], v[128:131], v[64:71], v19
    v_smfmac_f32_16x16x64_bf16 v[164:167], v[128:131], v[96:103], v19
    s_waitcnt lgkmcnt(2)
    v_smfmac_f32_16x16x64_bf16 v[160:163], v[132:135], v[72:79], v19
    v_smfmac_f32_16x16x64_bf16 v[164:167], v[132:135], v[104:111], v19
    s_waitcnt lgkmcnt(1)
    v_smfmac_f32_16x16x64_bf16 v[160:163], v[136:139], v[80:87], v19
    v_smfmac_f32_16x16x64_bf16 v[164:167], v[136:139], v[112:119], v19
    s_waitcnt lgkmcnt(0)
    v_smfmac_f32_16x16x64_bf16 v[160:163], v[140:143], v[88:95], v19
    v_smfmac_f32_16x16x64_bf16 v[164:167], v[140:143], v[120:127], v19
    s_nop 6
    v_pk_add_f32 v[160:161], v[160:161], v[162:163]
    v_pk_add_f32 v[164:165], v[164:165], v[166:167]
    v_and_or_b32 v184, v160, s74, v216
    v_and_or_b32 v185, v161, s74, v217
    v_and_or_b32 v186, v164, s74, v218
    v_and_or_b32 v187, v165, s74, v219
    s_mov_b64 exec, 0xffff
    buffer_store_dwordx4 v[184:187], v3, s[12:15], s76 offen
    buffer_store_dwordx4 v[184:187], v3, s[12:15], s77 offen sc1
    s_mov_b64 exec, -1
    s_cmp_eq_u32 s16, 0
    s_cbranch_scc1 r_start
g_end:
    s_endpgm
x_start:
    s_mov_b32 s83, 0
x_g0:
    s_and_b32 s42, s83, 63
    s_cmp_eq_u32 s42, 63
    s_cselect_b32 s42, 524288, 0
    s_add_u32 s42, s42, s81
    s_add_u32 s43, s42, 4096
    buffer_load_dwordx4 v[32:35], v3, s[12:15], s42 offen sc1
    buffer_load_dwordx4 v[36:39], v3, s[12:15], s43 offen sc1
    s_waitcnt vmcnt(0)
    v_xor_b32 v32, v216, v32
    v_xor_b32 v33, v217, v33
    v_xor_b32 v34, v218, v34
    v_xor_b32 v35, v219, v35
    v_xor_b32 v36, v216, v36
    v_xor_b32 v37, v217, v37
    v_xor_b32 v38, v218, v38
    v_xor_b32 v39, v219, v39
    v_or3_b32 v17, v32, v33, 0
    v_or3_b32 v17, v34, v35, v17
    v_or3_b32 v17, v36, v37, v17
    v_or3_b32 v17, v38, v39, v17
    v_and_b32 v17, 0xff, v17
    v_cmp_ne_u32 vcc, 0, v17
    s_cbranch_vccz x_g0x
    s_and_b32 s42, s83, 63
    s_cmp_lg_u32 s42, 48
    s_cbranch_scc1 x_g0n
    s_add_u32 s43, s39, 524288
    buffer_load_dwordx4 v[44:47], v3, s[12:15], s39 offen offset:0 sc1
    s_waitcnt vmcnt(0)
    buffer_store_dwordx4 v[44:47], v3, s[12:15], s43 offen offset:0 sc1
    s_waitcnt vmcnt(0)
    buffer_load_dwordx4 v[44:47], v3, s[12:15], s39 offen offset:1024 sc1
    s_waitcnt vmcnt(0)
    buffer_store_dwordx4 v[44:47], v3, s[12:15], s43 offen offset:1024 sc1
    s_waitcnt vmcnt(0)
x_g0n:
    s_add_u32 s83, s83, 1
    s_cmp_lt_u32 s83, 0x40000
    s_cbranch_scc1 x_g0
x_g0x:
    v_pk_add_f32 v[32:33], v[32:33], v[36:37]
    v_pk_add_f32 v[34:35], v[34:35], v[38:39]
    ds_write_b128 v222, v[32:35] offset:0
    s_waitcnt lgkmcnt(0)
    s_barrier
    s_cmp_lg_u32 s16, 0
    s_cbranch_scc1 x_g0e
    ds_read_b128 v[160:163], v221 offset:0
    ds_read_b128 v[164:167], v221 offset:1024
    ds_read_b128 v[168:171], v221 offset:2048
    ds_read_b128 v[172:175], v221 offset:3072
    ds_read_b128 v[176:179], v221 offset:4096
    ds_read_b128 v[180:183], v221 offset:5120
    ds_read_b128 v[184:187], v221 offset:6144
    ds_read_b128 v[188:191], v221 offset:7168
    s_waitcnt lgkmcnt(6)
    v_pk_add_f32 v[160:161], v[160:161], v[164:165]
    v_pk_add_f32 v[162:163], v[162:163], v[166:167]
    s_waitcnt lgkmcnt(4)
    v_pk_add_f32 v[168:169], v[168:169], v[172:173]
    v_pk_add_f32 v[170:171], v[170:171], v[174:175]
    s_waitcnt lgkmcnt(2)
    v_pk_add_f32 v[176:177], v[176:177], v[180:181]
    v_pk_add_f32 v[178:179], v[178:179], v[182:183]
    s_waitcnt lgkmcnt(0)
    v_pk_add_f32 v[184:185], v[184:185], v[188:189]
    v_pk_add_f32 v[186:187], v[186:187], v[190:191]
    v_pk_add_f32 v[160:161], v[160:161], v[168:169]
    v_pk_add_f32 v[176:177], v[176:177], v[184:185]
    v_pk_add_f32 v[162:163], v[162:163], v[170:171]
    v_pk_add_f32 v[178:179], v[178:179], v[186:187]
    v_pk_add_f32 v[160:161], v[160:161], v[176:177]
    v_pk_add_f32 v[162:163], v[162:163], v[178:179]
    v_cvt_pk_bf16_f32 v17, v160, v161
    v_lshlrev_b32 v160, 16, v17
    v_and_b32 v161, 0xffff0000, v17
    v_cvt_pk_bf16_f32 v18, v162, v163
    v_lshlrev_b32 v162, 16, v18
    v_and_b32 v163, 0xffff0000, v18
    v_add_f32 v160, s28, v160
    v_add_f32 v161, s28, v161
    v_add_f32 v162, s28, v162
    v_add_f32 v163, s28, v163
    v_cvt_pk_bf16_f32 v17, v160, v161
    v_lshlrev_b32 v160, 16, v17
    v_and_b32 v161, 0xffff0000, v17
    v_cvt_pk_bf16_f32 v18, v162, v163
    v_lshlrev_b32 v162, 16, v18
    v_and_b32 v163, 0xffff0000, v18
    v_mov_b32 v48, s32
    v_mov_b32 v49, s33
    s_cmp_ge_u32 s64, 8
    s_cbranch_scc1 x_q
    v_and_or_b32 v168, v160, s74, v216
    v_and_or_b32 v169, v161, s74, v217
    v_and_or_b32 v170, v162, s74, v218
    v_and_or_b32 v171, v163, s74, v219
    buffer_store_dwordx4 v[168:171], v220, s[12:15], s22 offen sc1
    v_max3_f32 v50, abs(v160), abs(v161), abs(v162)
    v_max_f32_e64 v50, v50, abs(v163)
    s_nop 1
    v_max_f32_dpp v50, v50, v50 row_ror:8 row_mask:0xf bank_mask:0xf
    s_nop 1
    v_max_f32_dpp v50, v50, v50 row_ror:4 row_mask:0xf bank_mask:0xf
    s_nop 1
    v_max_f32_dpp v50, v50, v50 row_ror:2 row_mask:0xf bank_mask:0xf
    s_nop 1
    v_max_f32_dpp v50, v50, v50 row_ror:1 row_mask:0xf bank_mask:0xf
    s_nop 1
    v_max_f32_dpp v50, v50, v50 row_bcast:15 row_mask:0xa bank_mask:0xf
    s_nop 1
    v_max_f32_dpp v50, v50, v50 row_bcast:31 row_mask:0xc bank_mask:0xf
    s_nop 0
    v_readlane_b32 s42, v50, 63
    s_nop 1
    v_mov_b32 v50, s42
    s_mov_b64 exec, 0xff
    buffer_store_dwordx4 v[48:51], v3, s[12:15], s79 offen sc1
    s_mov_b64 exec, -1
    s_branch x_g0e
x_q:
    s_cmp_lt_u32 s64, 12
    s_cbranch_scc1 x_nq
    v_lshlrev_b32 v164, 16, v52
    v_and_b32 v165, 0xffff0000, v52
    v_lshlrev_b32 v166, 16, v53
    v_and_b32 v167, 0xffff0000, v53
    v_pk_mul_f32 v[164:165], v[164:165], v[160:161]
    v_pk_mul_f32 v[166:167], v[166:167], v[162:163]
    ds_bpermute_b32 v180, v232, v164
    v_and_or_b32 v176, v164, s74, v216
    v_and_or_b32 v177, v165, s74, v217
    v_and_or_b32 v178, v166, s74, v218
    v_and_or_b32 v179, v167, s74, v219
    buffer_store_dwordx4 v[176:179], v220, s[12:15], s75 offen sc1
    v_and_or_b32 v181, v167, s74, v229
    v_and_or_b32 v182, v166, s74, v230
    v_and_or_b32 v183, v165, s74, v231
    s_waitcnt lgkmcnt(0)
    v_and_or_b32 v180, v180, s74, v228
    buffer_store_dwordx4 v[180:183], v234, s[12:15], s75 offen sc1
    v_and_b32 v164, s74, v164
    v_and_b32 v165, s74, v165
    v_and_b32 v166, s74, v166
    v_and_b32 v167, s74, v167
    v_pk_add_f32 v[164:165], v[164:165], v[166:167]
    v_add_f32 v50, v164, v165
    s_nop 1
    v_add_f32_dpp v50, v50, v50 row_ror:8 row_mask:0xf bank_mask:0xf
    s_nop 1
    v_add_f32_dpp v50, v50, v50 row_ror:4 row_mask:0xf bank_mask:0xf
    s_nop 1
    v_add_f32_dpp v50, v50, v50 row_ror:2 row_mask:0xf bank_mask:0xf
    s_nop 1
    v_add_f32_dpp v50, v50, v50 row_ror:1 row_mask:0xf bank_mask:0xf
    s_nop 1
    v_add_f32_dpp v50, v50, v50 row_bcast:15 row_mask:0xa bank_mask:0xf
    s_nop 1
    v_add_f32_dpp v50, v50, v50 row_bcast:31 row_mask:0xc bank_mask:0xf
    s_nop 0
    v_readlane_b32 s42, v50, 63
    s_nop 1
    v_mov_b32 v50, s42
    s_mov_b64 exec, 0xff
    buffer_store_dwordx4 v[48:51], v3, s[12:15], s79 offen sc1
    s_mov_b64 exec, -1
x_nq:
    ds_bpermute_b32 v172, v232, v160
    v_and_or_b32 v168, v160, s74, v216
    v_and_or_b32 v169, v161, s74, v217
    v_and_or_b32 v170, v162, s74, v218
    v_and_or_b32 v171, v163, s74, v219
    buffer_store_dwordx4 v[168:171], v220, s[12:15], s22 offen sc1
    v_and_or_b32 v173, v163, s74, v229
    v_and_or_b32 v174, v162, s74, v230
    v_and_or_b32 v175, v161, s74, v231
    s_waitcnt lgkmcnt(0)
    v_and_or_b32 v172, v172, s74, v228
    buffer_store_dwordx4 v[172:175], v234, s[12:15], s22 offen sc1
x_g0e:
    s_barrier
    s_cmp_lt_u32 s16, 4
    s_cbranch_scc1 x_t1
    v_xor_b32 v4, 0, v14
    s_add_u32 s43, s68, 98304
    s_mov_b32 m0, s43
    s_add_u32 s42, s19, 0
    buffer_load_dwordx4 v4, s[8:11], s42 offen nt lds
    v_xor_b32 v4, 64, v14
    s_add_u32 s43, s68, 99328
    s_mov_b32 m0, s43
    s_add_u32 s42, s19, 24576
    buffer_load_dwordx4 v4, s[8:11], s42 offen nt lds
    v_xor_b32 v4, 0, v14
    s_add_u32 s43, s68, 100352
    s_mov_b32 m0, s43
    s_add_u32 s42, s19, 49152
    buffer_load_dwordx4 v4, s[8:11], s42 offen nt lds
    v_xor_b32 v4, 64, v14
    s_add_u32 s43, s68, 101376
    s_mov_b32 m0, s43
    s_add_u32 s42, s19, 73728
    buffer_load_dwordx4 v4, s[8:11], s42 offen nt lds
    v_xor_b32 v4, 128, v14
    s_add_u32 s43, s68, 102400
    s_mov_b32 m0, s43
    s_add_u32 s42, s19, 98304
    buffer_load_dwordx4 v4, s[8:11], s42 offen nt lds
    v_xor_b32 v4, 192, v14
    s_add_u32 s43, s68, 103424
    s_mov_b32 m0, s43
    s_add_u32 s42, s19, 122880
    buffer_load_dwordx4 v4, s[8:11], s42 offen nt lds
    v_xor_b32 v4, 128, v14
    s_add_u32 s43, s68, 104448
    s_mov_b32 m0, s43
    s_add_u32 s42, s19, 147456
    buffer_load_dwordx4 v4, s[8:11], s42 offen nt lds
    v_xor_b32 v4, 192, v14
    s_add_u32 s43, s68, 105472
    s_mov_b32 m0, s43
    s_add_u32 s42, s19, 172032
    buffer_load_dwordx4 v4, s[8:11], s42 offen nt lds
    s_waitcnt vmcnt(0)
    s_barrier
    s_branch x_t2
x_t1:
    s_barrier
    ds_read_b64_tr_b16 v[128:129], v208 offset:0
    ds_read_b64_tr_b16 v[130:131], v208 offset:2048
    ds_read_b64_tr_b16 v[132:133], v209 offset:0
    ds_read_b64_tr_b16 v[134:135], v209 offset:2048
    ds_read_b64_tr_b16 v[136:137], v210 offset:0
    ds_read_b64_tr_b16 v[138:139], v210 offset:2048
    ds_read_b64_tr_b16 v[140:141], v211 offset:0
    ds_read_b64_tr_b16 v[142:143], v211 offset:2048
    ds_read_b64_tr_b16 v[144:145], v208 offset:16384
    ds_read_b64_tr_b16 v[146:147], v208 offset:18432
    ds_read_b64_tr_b16 v[148:149], v209 offset:16384
    ds_read_b64_tr_b16 v[150:151], v209 offset:18432
    ds_read_b64_tr_b16 v[152:153], v210 offset:16384
    ds_read_b64_tr_b16 v[154:155], v210 offset:18432
    s_waitcnt lgkmcnt(12)
    v_mfma_f32_16x16x32_bf16 v[64:67], v[120:123], v[128:131], 0
    ds_read_b64_tr_b16 v[156:157], v211 offset:16384
    ds_read_b64_tr_b16 v[158:159], v211 offset:18432
    s_waitcnt lgkmcnt(12)
    v_mfma_f32_16x16x32_bf16 v[68:71], v[120:123], v[132:135], 0
    s_waitcnt lgkmcnt(10)
    v_mfma_f32_16x16x32_bf16 v[72:75], v[120:123], v[136:139], 0
    s_waitcnt lgkmcnt(8)
    v_mfma_f32_16x16x32_bf16 v[76:79], v[120:123], v[140:143], 0
    s_waitcnt lgkmcnt(6)
    v_mfma_f32_16x16x32_bf16 v[64:67], v[124:127], v[144:147], v[64:67]
    s_waitcnt lgkmcnt(4)
    v_mfma_f32_16x16x32_bf16 v[68:71], v[124:127], v[148:151], v[68:71]
    s_waitcnt lgkmcnt(2)
    v_mfma_f32_16x16x32_bf16 v[72:75], v[124:127], v[152:155], v[72:75]
    s_waitcnt lgkmcnt(0)
    v_mfma_f32_16x16x32_bf16 v[76:79], v[124:127], v[156:159], v[76:79]
    s_nop 3
    v_cndmask_b32 v64, v64, v68, s[60:61]
    s_nop 0
    v_cndmask_b32 v64, v64, v72, s[62:63]
    s_nop 0
    v_cndmask_b32 v64, v64, v76, s[72:73]
    v_and_or_b32 v226, v64, s74, v212
    buffer_store_dword v226, v13, s[12:15], s31 offen offset:0
x_t2:
    s_mov_b32 s83, 0
x_g1:
    s_and_b32 s42, s83, 63
    s_cmp_eq_u32 s42, 63
    s_cselect_b32 s42, 524288, 0
    s_add_u32 s42, s42, s80
    buffer_load_dwordx4 v[32:35], v223, s[12:15], s42 offen offset:2048 sc1
    s_waitcnt vmcnt(0)
    v_xor_b32 v32, v216, v32
    v_xor_b32 v33, v217, v33
    v_xor_b32 v34, v218, v34
    v_xor_b32 v35, v219, v35
    v_or3_b32 v17, v32, v33, 0
    v_or3_b32 v17, v34, v35, v17
    v_and_b32 v17, 0xff, v17
    v_cmp_ne_u32 vcc, 0, v17
    s_cbranch_vccz x_g1x
    s_and_b32 s42, s83, 63
    s_cmp_lg_u32 s42, 48
    s_cbranch_scc1 x_g1n
    s_add_u32 s43, s39, 524288
    buffer_load_dwordx4 v[44:47], v3, s[12:15], s39 offen offset:0 sc1
    s_waitcnt vmcnt(0)
    buffer_store_dwordx4 v[44:47], v3, s[12:15], s43 offen offset:0 sc1
    s_waitcnt vmcnt(0)
    buffer_load_dwordx4 v[44:47], v3, s[12:15], s39 offen offset:1024 sc1
    s_waitcnt vmcnt(0)
    buffer_store_dwordx4 v[44:47], v3, s[12:15], s43 offen offset:1024 sc1
    s_waitcnt vmcnt(0)
    buffer_load_dwordx4 v[44:47], v3, s[12:15], s39 offen offset:2048 sc1
    s_waitcnt vmcnt(0)
    buffer_store_dwordx4 v[44:47], v3, s[12:15], s43 offen offset:2048 sc1
    s_waitcnt vmcnt(0)
x_g1n:
    s_add_u32 s83, s83, 1
    s_cmp_lt_u32 s83, 0x40000
    s_cbranch_scc1 x_g1
x_g1x:
    ds_write_b128 v222, v[32:35] offset:8192
    s_waitcnt lgkmcnt(0)
    s_barrier
    s_cmp_lg_u32 s16, 0
    s_cbranch_scc1 x_g1e
    ds_read_b128 v[160:163], v221 offset:8192
    ds_read_b128 v[164:167], v221 offset:9216
    ds_read_b128 v[168:171], v221 offset:10240
    ds_read_b128 v[172:175], v221 offset:11264
    ds_read_b128 v[176:179], v221 offset:12288
    ds_read_b128 v[180:183], v221 offset:13312
    ds_read_b128 v[184:187], v221 offset:14336
    ds_read_b128 v[188:191], v221 offset:15360
    s_waitcnt lgkmcnt(6)
    v_pk_add_f32 v[160:161], v[160:161], v[164:165]
    v_pk_add_f32 v[162:163], v[162:163], v[166:167]
    s_waitcnt lgkmcnt(4)
    v_pk_add_f32 v[168:169], v[168:169], v[172:173]
    v_pk_add_f32 v[170:171], v[170:171], v[174:175]
    s_waitcnt lgkmcnt(2)
    v_pk_add_f32 v[176:177], v[176:177], v[180:181]
    v_pk_add_f32 v[178:179], v[178:179], v[182:183]
    s_waitcnt lgkmcnt(0)
    v_pk_add_f32 v[184:185], v[184:185], v[188:189]
    v_pk_add_f32 v[186:187], v[186:187], v[190:191]
    v_pk_add_f32 v[160:161], v[160:161], v[168:169]
    v_pk_add_f32 v[176:177], v[176:177], v[184:185]
    v_pk_add_f32 v[162:163], v[162:163], v[170:171]
    v_pk_add_f32 v[178:179], v[178:179], v[186:187]
    v_pk_add_f32 v[160:161], v[160:161], v[176:177]
    v_pk_add_f32 v[162:163], v[162:163], v[178:179]
    v_mov_b32 v164, v160
    v_mov_b32 v165, v161
    v_mov_b32 v166, v162
    v_mov_b32 v167, v163
    v_permlane32_swap_b32 v160, v164
    v_permlane32_swap_b32 v161, v165
    v_permlane32_swap_b32 v162, v166
    v_permlane32_swap_b32 v163, v167
    v_pk_add_f32 v[160:161], v[160:161], v[164:165]
    v_pk_add_f32 v[162:163], v[162:163], v[166:167]
    v_cvt_pk_bf16_f32 v17, v160, v161
    v_lshlrev_b32 v160, 16, v17
    v_and_b32 v161, 0xffff0000, v17
    v_cvt_pk_bf16_f32 v18, v162, v163
    v_lshlrev_b32 v162, 16, v18
    v_and_b32 v163, 0xffff0000, v18
    s_mov_b32 exec_hi, 0
    ds_bpermute_b32 v172, v232, v160
    v_and_or_b32 v168, v160, s74, v216
    v_and_or_b32 v169, v161, s74, v217
    v_and_or_b32 v170, v162, s74, v218
    v_and_or_b32 v171, v163, s74, v219
    buffer_store_dwordx4 v[168:171], v233, s[12:15], s23 offen sc1
    v_and_or_b32 v173, v163, s74, v229
    v_and_or_b32 v174, v162, s74, v230
    v_and_or_b32 v175, v161, s74, v231
    s_waitcnt lgkmcnt(0)
    v_and_or_b32 v172, v172, s74, v228
    buffer_store_dwordx4 v[172:175], v235, s[12:15], s23 offen sc1
    s_mov_b32 exec_hi, -1
x_g1e:
    s_sub_u32 s42, s16, 0
    s_cmp_ge_u32 s42, 3
    s_cbranch_scc1 x_nb
    s_lshl_b32 s42, s42, 10
    s_add_u32 s42, s42, s29
    s_add_u32 s43, s42, 524288
    buffer_load_dwordx4 v[44:47], v3, s[12:15], s42 offen sc1
    s_waitcnt vmcnt(0)
    buffer_store_dwordx4 v[44:47], v3, s[12:15], s43 offen sc1
x_nb:
    s_cmp_lg_u32 s16, 0
    s_cbranch_scc1 g_end
    s_lshl_b32 s78, s34, 14
    s_add_u32 s78, s78, 17039360
    s_lshl_b32 s79, s34, 7
    s_add_u32 s79, s79, 16842752
    v_mov_b32 v22, 0
    s_mov_b32 s56, s48
    s_mov_b32 s57, s49
    s_mov_b32 s58, 2048
    s_mov_b32 s59, 0x00020000
    s_and_b32 s60, s32, 0xffff
    s_lshr_b32 s61, s32, 16
    s_and_b32 s62, s33, 0xffff
    s_lshr_b32 s63, s33, 16
    s_bfe_u32 s44, s32, 524288
    s_bfe_u32 s45, s32, 524296
    s_bfe_u32 s46, s32, 524304
    s_bfe_u32 s47, s32, 524312
    s_bfe_u32 s48, s33, 524288
    s_bfe_u32 s49, s33, 524296
    s_bfe_u32 s50, s33, 524304
    s_bfe_u32 s51, s33, 524312
    v_and_b32 v9, 15, v0
    v_lshlrev_b32 v9, 6, v9
    v_bfe_u32 v19, v0, 4, 1
    v_lshl_add_u32 v9, v19, 5, v9
    v_lshlrev_b32 v18, 9, v19
    v_bfe_u32 v19, v0, 5, 1
    v_lshl_add_u32 v9, v19, 4, v9
    v_lshl_add_u32 v18, v19, 11, v18
    v_bfe_u32 v19, v0, 2, 2
    v_lshl_add_u32 v18, v19, 7, v18
    v_lshl_add_u32 v18, v15, 4, v18
    s_mov_b32 s43, 16908288
    s_lshl_b32 s70, s64, 13
    s_add_u32 s70, s70, 17301504
    s_add_u32 s71, s70, 131072
    s_add_u32 s72, s70, 4096
    s_add_u32 s73, s71, 4096
    v_mov_b32 v21, 0xffff0000
    buffer_load_dwordx4 v[92:95], v9, s[56:59], 0 offen offset:0
    buffer_load_dwordx4 v[96:99], v9, s[56:59], 0 offen offset:1024
    s_mov_b32 s76, s43
    s_sub_u32 s42, s43, 8192
    s_mov_b32 s83, 0
x_cb:
    buffer_load_dwordx4 v[116:119], v18, s[12:15], s42 offen offset:0 sc1
    buffer_load_dwordx4 v[120:123], v18, s[12:15], s42 offen offset:1024 sc1
    buffer_load_dwordx4 v[124:127], v18, s[12:15], s42 offen offset:64 sc1
    buffer_load_dwordx4 v[128:131], v18, s[12:15], s42 offen offset:1088 sc1
    s_waitcnt vmcnt(0)
    v_xor_b32 v116, v216, v116
    v_xor_b32 v117, v217, v117
    v_xor_b32 v118, v218, v118
    v_xor_b32 v119, v219, v119
    v_xor_b32 v120, v216, v120
    v_xor_b32 v121, v217, v121
    v_xor_b32 v122, v218, v122
    v_xor_b32 v123, v219, v123
    v_xor_b32 v124, v216, v124
    v_xor_b32 v125, v217, v125
    v_xor_b32 v126, v218, v126
    v_xor_b32 v127, v219, v127
    v_xor_b32 v128, v216, v128
    v_xor_b32 v129, v217, v129
    v_xor_b32 v130, v218, v130
    v_xor_b32 v131, v219, v131
    v_or3_b32 v19, v116, v117, 0
    v_or3_b32 v19, v118, v119, v19
    v_or3_b32 v19, v120, v121, v19
    v_or3_b32 v19, v122, v123, v19
    v_or3_b32 v19, v124, v125, v19
    v_or3_b32 v19, v126, v127, v19
    v_or3_b32 v19, v128, v129, v19
    v_or3_b32 v19, v130, v131, v19
    v_and_b32 v19, 0xff, v19
    v_cmp_ne_u32 vcc, 0, v19
    s_cbranch_vccz x_cbx
    s_sleep 8
    s_add_u32 s83, s83, 1
    s_cmp_lt_u32 s83, 0x40000
    s_cbranch_scc1 x_cb
x_cbx:
    v_lshlrev_b32 v48, 16, v92
    v_and_b32 v49, 0xffff0000, v92
    v_lshlrev_b32 v50, 16, v93
    v_and_b32 v51, 0xffff0000, v93
    v_lshlrev_b32 v52, 16, v94
    v_and_b32 v53, 0xffff0000, v94
    v_lshlrev_b32 v54, 16, v95
    v_and_b32 v55, 0xffff0000, v95
    v_lshlrev_b32 v56, 16, v96
    v_and_b32 v57, 0xffff0000, v96
    v_lshlrev_b32 v58, 16, v97
    v_and_b32 v59, 0xffff0000, v97
    v_lshlrev_b32 v60, 16, v98
    v_and_b32 v61, 0xffff0000, v98
    v_lshlrev_b32 v62, 16, v99
    v_and_b32 v63, 0xffff0000, v99
    s_mov_b32 s83, 0
    s_mov_b64 exec, 1
x_go:
    buffer_load_dwordx2 v[28:29], v22, s[12:15], s79 offen sc1
    s_waitcnt vmcnt(0)
    v_cmp_ne_u64 vcc, s[32:33], v[28:29]
    s_cbranch_vccz x_goy
    s_sleep 1
    s_add_u32 s83, s83, 1
    s_cmp_lt_u32 s83, 0x40000
    s_cbranch_scc1 x_go
x_goy:
    s_mov_b64 exec, -1
x_gox:
    s_lshl_b32 s42, s65, 13
    s_add_u32 s78, s78, s42
    buffer_load_dwordx4 v[100:103], v18, s[12:15], s76 offen offset:0 sc1
    buffer_load_dwordx4 v[104:107], v18, s[12:15], s76 offen offset:1024 sc1
    buffer_load_dwordx4 v[108:111], v18, s[12:15], s76 offen offset:64 sc1
    buffer_load_dwordx4 v[112:115], v18, s[12:15], s76 offen offset:1088 sc1
    v_lshlrev_b32 v32, 7, v2
    s_xor_b32 s42, s78, 8192
    s_mov_b32 s83, 0
    s_mov_b64 vcc, -1
    s_mov_b64 s[40:41], -1
x_pk:
    s_mov_b64 exec, vcc
    s_cbranch_execz x_pka
    buffer_load_dwordx4 v[24:27], v32, s[12:15], s78 offen sc1
x_pka:
    s_mov_b64 exec, s[40:41]
    s_cbranch_execz x_pkb
    buffer_load_dwordx4 v[28:31], v32, s[12:15], s42 offen sc1
x_pkb:
    s_mov_b64 exec, -1
    s_waitcnt vmcnt(0)
x_pkc:
    v_cmp_ne_u32 vcc, s32, v25
    v_cmp_ne_u32 s[20:21], s33, v27
    v_cmp_ne_u32 s[40:41], s32, v29
    v_cmp_ne_u32 s[22:23], s33, v31
    v_max_u32 v33, v24, v28
    v_min_u32 v34, v24, v28
    s_or_b64 vcc, vcc, s[20:21]
    s_or_b64 s[40:41], s[40:41], s[22:23]
    s_or_b64 s[20:21], vcc, s[40:41]
    s_cbranch_scc0 x_pkx
    s_add_u32 s83, s83, 1
    s_cmp_lt_u32 s83, 0x40000
    s_cbranch_scc1 x_pk
x_pkx:
    v_mov_b32 v35, v33
    v_max3_u32 v34, v34, v26, v30
    s_nop 0
    v_max_u32_dpp v35, v35, v35 row_ror:8 row_mask:0xf bank_mask:0xf
    s_nop 1
    v_max_u32_dpp v35, v35, v35 row_ror:4 row_mask:0xf bank_mask:0xf
    s_nop 1
    v_max_u32_dpp v35, v35, v35 row_ror:2 row_mask:0xf bank_mask:0xf
    s_nop 1
    v_max_u32_dpp v35, v35, v35 row_ror:1 row_mask:0xf bank_mask:0xf
    s_nop 1
    v_max_u32_dpp v35, v35, v35 row_bcast:15 row_mask:0xa bank_mask:0xf
    s_nop 1
    v_max_u32_dpp v35, v35, v35 row_bcast:31 row_mask:0xc bank_mask:0xf
    s_nop 0
    v_readlane_b32 s40, v35, 63
    s_cmp_eq_u32 s65, 0
    s_cbranch_scc1 x_t1st
    v_cmp_eq_u32 vcc, s40, v33
    s_nop 1
    v_cndmask_b32 v35, v33, v34, vcc
    s_nop 1
    v_max_u32_dpp v35, v35, v35 row_ror:8 row_mask:0xf bank_mask:0xf
    s_nop 1
    v_max_u32_dpp v35, v35, v35 row_ror:4 row_mask:0xf bank_mask:0xf
    s_nop 1
    v_max_u32_dpp v35, v35, v35 row_ror:2 row_mask:0xf bank_mask:0xf
    s_nop 1
    v_max_u32_dpp v35, v35, v35 row_ror:1 row_mask:0xf bank_mask:0xf
    s_nop 1
    v_max_u32_dpp v35, v35, v35 row_bcast:15 row_mask:0xa bank_mask:0xf
    s_nop 1
    v_max_u32_dpp v35, v35, v35 row_bcast:31 row_mask:0xc bank_mask:0xf
    s_nop 0
    v_readlane_b32 s41, v35, 63
    s_mov_b32 s40, s41
x_t1st:
    v_mov_b32 v46, s40
    s_bfe_u32 s42, s40, 0x70005
    s_lshl_b32 s42, s42, 13
    s_and_b32 s40, s40, 1
    s_lshl_b32 s40, s40, 12
    s_add_u32 s42, s42, s40
    s_lshr_b32 s43, s42, 5
    s_add_u32 s42, s42, 18874368
    s_add_u32 s43, s43, 17170432
    s_mov_b32 s83, 0
x_ph:
    s_mov_b64 exec, 1
    buffer_load_dwordx4 v[28:31], v22, s[12:15], s43 offen sc1
    s_mov_b64 exec, -1
    buffer_load_dwordx4 v[64:67], v3, s[12:15], s42 offen offset:0 sc1
    buffer_load_dwordx4 v[68:71], v3, s[12:15], s42 offen offset:1024 sc1
    buffer_load_dwordx4 v[72:75], v3, s[12:15], s42 offen offset:2048 sc1
    buffer_load_dwordx4 v[76:79], v3, s[12:15], s42 offen offset:3072 sc1
    s_cmp_lg_u32 s83, 0
    s_cbranch_scc1 x_sbx
x_sb:
    v_xor_b32 v100, v216, v100
    v_xor_b32 v101, v217, v101
    v_xor_b32 v102, v218, v102
    v_xor_b32 v103, v219, v103
    v_xor_b32 v104, v216, v104
    v_xor_b32 v105, v217, v105
    v_xor_b32 v106, v218, v106
    v_xor_b32 v107, v219, v107
    v_xor_b32 v108, v216, v108
    v_xor_b32 v109, v217, v109
    v_xor_b32 v110, v218, v110
    v_xor_b32 v111, v219, v111
    v_xor_b32 v112, v216, v112
    v_xor_b32 v113, v217, v113
    v_xor_b32 v114, v218, v114
    v_xor_b32 v115, v219, v115
    v_or3_b32 v19, v100, v101, 0
    v_or3_b32 v19, v102, v103, v19
    v_or3_b32 v19, v104, v105, v19
    v_or3_b32 v19, v106, v107, v19
    v_or3_b32 v19, v108, v109, v19
    v_or3_b32 v19, v110, v111, v19
    v_or3_b32 v19, v112, v113, v19
    v_or3_b32 v19, v114, v115, v19
    v_and_b32 v19, 0xff, v19
    v_cmp_ne_u32 vcc, 0, v19
    s_cbranch_vccnz x_sr
x_sbx:
    s_waitcnt vmcnt(4)
    v_readfirstlane_b32 s22, v28
    v_readfirstlane_b32 s23, v29
    v_readfirstlane_b32 s20, v30
    v_readfirstlane_b32 s21, v31
    s_xor_b64 s[22:23], s[22:23], s[32:33]
    s_cbranch_scc1 x_pr
    s_waitcnt vmcnt(3)
    v_xor_b32 v64, s44, v64
    v_xor_b32 v65, s45, v65
    v_xor_b32 v66, s46, v66
    v_xor_b32 v67, s47, v67
    v_or3_b32 v19, v64, v65, v66
    v_or_b32 v19, v19, v67
    v_pk_fma_f32 v[64:65], v[64:65], s[20:21], s[20:21] op_sel:[0,1,0] op_sel_hi:[1,1,0]
    v_pk_fma_f32 v[66:67], v[66:67], s[20:21], s[20:21] op_sel:[0,1,0] op_sel_hi:[1,1,0]
    v_cmp_ne_u16_sdwa vcc, v19, v22 src0_sel:BYTE_0 src1_sel:DWORD
    v_pk_fma_f32 v[64:65], v[64:65], v[116:117], v[100:101]
    v_pk_fma_f32 v[66:67], v[66:67], v[118:119], v[102:103]
    v_cvt_pk_bf16_f32 v32, v64, v65
    v_cvt_pk_bf16_f32 v33, v66, v67
    s_cbranch_vccnz x_pr
    v_lshl_or_b32 v64, v32, 16, s60
    v_and_or_b32 v65, v32, v21, s61
    v_lshl_or_b32 v66, v33, 16, s62
    v_and_or_b32 v67, v33, v21, s63
    buffer_store_dwordx4 v[64:67], v3, s[12:15], s70 offen offset:0
    s_waitcnt vmcnt(3)
    v_xor_b32 v68, s48, v68
    v_xor_b32 v69, s49, v69
    v_xor_b32 v70, s50, v70
    v_xor_b32 v71, s51, v71
    v_or3_b32 v19, v68, v69, v70
    v_or_b32 v19, v19, v71
    v_pk_fma_f32 v[68:69], v[68:69], s[20:21], s[20:21] op_sel:[0,1,0] op_sel_hi:[1,1,0]
    v_pk_fma_f32 v[70:71], v[70:71], s[20:21], s[20:21] op_sel:[0,1,0] op_sel_hi:[1,1,0]
    v_cmp_ne_u16_sdwa vcc, v19, v22 src0_sel:BYTE_0 src1_sel:DWORD
    v_pk_fma_f32 v[68:69], v[68:69], v[120:121], v[104:105]
    v_pk_fma_f32 v[70:71], v[70:71], v[122:123], v[106:107]
    v_cvt_pk_bf16_f32 v34, v68, v69
    v_cvt_pk_bf16_f32 v35, v70, v71
    s_cbranch_vccnz x_pr
    v_lshl_or_b32 v68, v34, 16, s60
    v_and_or_b32 v69, v34, v21, s61
    v_lshl_or_b32 v70, v35, 16, s62
    v_and_or_b32 v71, v35, v21, s63
    buffer_store_dwordx4 v[68:71], v3, s[12:15], s70 offen offset:1024
    s_waitcnt vmcnt(3)
    v_xor_b32 v72, s44, v72
    v_xor_b32 v73, s45, v73
    v_xor_b32 v74, s46, v74
    v_xor_b32 v75, s47, v75
    v_or3_b32 v19, v72, v73, v74
    v_or_b32 v19, v19, v75
    v_pk_fma_f32 v[72:73], v[72:73], s[20:21], s[20:21] op_sel:[0,1,0] op_sel_hi:[1,1,0]
    v_pk_fma_f32 v[74:75], v[74:75], s[20:21], s[20:21] op_sel:[0,1,0] op_sel_hi:[1,1,0]
    v_cmp_ne_u16_sdwa vcc, v19, v22 src0_sel:BYTE_0 src1_sel:DWORD
    v_pk_fma_f32 v[72:73], v[72:73], v[124:125], v[108:109]
    v_pk_fma_f32 v[74:75], v[74:75], v[126:127], v[110:111]
    v_cvt_pk_bf16_f32 v36, v72, v73
    v_cvt_pk_bf16_f32 v37, v74, v75
    s_cbranch_vccnz x_pr
    v_lshl_or_b32 v72, v36, 16, s60
    v_and_or_b32 v73, v36, v21, s61
    v_lshl_or_b32 v74, v37, 16, s62
    v_and_or_b32 v75, v37, v21, s63
    buffer_store_dwordx4 v[72:75], v3, s[12:15], s70 offen offset:2048
    s_waitcnt vmcnt(3)
    v_xor_b32 v76, s48, v76
    v_xor_b32 v77, s49, v77
    v_xor_b32 v78, s50, v78
    v_xor_b32 v79, s51, v79
    v_or3_b32 v19, v76, v77, v78
    v_or_b32 v19, v19, v79
    v_pk_fma_f32 v[76:77], v[76:77], s[20:21], s[20:21] op_sel:[0,1,0] op_sel_hi:[1,1,0]
    v_pk_fma_f32 v[78:79], v[78:79], s[20:21], s[20:21] op_sel:[0,1,0] op_sel_hi:[1,1,0]
    v_cmp_ne_u16_sdwa vcc, v19, v22 src0_sel:BYTE_0 src1_sel:DWORD
    v_pk_fma_f32 v[76:77], v[76:77], v[128:129], v[112:113]
    v_pk_fma_f32 v[78:79], v[78:79], v[130:131], v[114:115]
    v_cvt_pk_bf16_f32 v38, v76, v77
    v_cvt_pk_bf16_f32 v39, v78, v79
    s_cbranch_vccnz x_pr
    v_lshl_or_b32 v76, v38, 16, s60
    v_and_or_b32 v77, v38, v21, s61
    v_lshl_or_b32 v78, v39, 16, s62
    v_and_or_b32 v79, v39, v21, s63
    buffer_store_dwordx4 v[76:79], v3, s[12:15], s70 offen offset:3072
x_phx:
    buffer_store_dwordx4 v[64:67], v3, s[12:15], s71 offen offset:0 sc1
    buffer_store_dwordx4 v[68:71], v3, s[12:15], s71 offen offset:1024 sc1
    buffer_store_dwordx4 v[72:75], v3, s[12:15], s71 offen offset:2048 sc1
    buffer_store_dwordx4 v[76:79], v3, s[12:15], s71 offen offset:3072 sc1
    v_lshlrev_b32 v100, 16, v32
    v_and_b32 v101, 0xffff0000, v32
    v_lshlrev_b32 v102, 16, v33
    v_and_b32 v103, 0xffff0000, v33
    v_lshlrev_b32 v104, 16, v34
    v_and_b32 v105, 0xffff0000, v34
    v_lshlrev_b32 v106, 16, v35
    v_and_b32 v107, 0xffff0000, v35
    v_lshlrev_b32 v108, 16, v36
    v_and_b32 v109, 0xffff0000, v36
    v_lshlrev_b32 v110, 16, v37
    v_and_b32 v111, 0xffff0000, v37
    v_lshlrev_b32 v112, 16, v38
    v_and_b32 v113, 0xffff0000, v38
    v_lshlrev_b32 v114, 16, v39
    v_and_b32 v115, 0xffff0000, v39
    v_pk_mul_f32 v[8:9], v[48:49], v[100:101]
    v_pk_fma_f32 v[8:9], v[50:51], v[102:103], v[8:9]
    v_pk_fma_f32 v[8:9], v[52:53], v[104:105], v[8:9]
    v_pk_fma_f32 v[8:9], v[54:55], v[106:107], v[8:9]
    v_pk_fma_f32 v[8:9], v[56:57], v[108:109], v[8:9]
    v_pk_fma_f32 v[8:9], v[58:59], v[110:111], v[8:9]
    v_pk_fma_f32 v[8:9], v[60:61], v[112:113], v[8:9]
    v_pk_fma_f32 v[8:9], v[62:63], v[114:115], v[8:9]
    v_add_f32 v8, v8, v9
    s_nop 1
    v_add_f32_dpp v8, v8, v8 row_ror:8 row_mask:0xf bank_mask:0xf
    s_nop 1
    v_add_f32_dpp v8, v8, v8 row_ror:4 row_mask:0xf bank_mask:0xf
    s_nop 1
    v_add_f32_dpp v8, v8, v8 row_ror:2 row_mask:0xf bank_mask:0xf
    s_nop 1
    v_add_f32_dpp v8, v8, v8 row_ror:1 row_mask:0xf bank_mask:0xf
    s_nop 1
    v_add_f32_dpp v8, v8, v8 row_bcast:15 row_mask:0xa bank_mask:0xf
    s_nop 1
    v_add_f32_dpp v8, v8, v8 row_bcast:31 row_mask:0xc bank_mask:0xf
    v_cvt_pk_bf16_f32 v8, v8, v8
    v_lshlrev_b32 v8, 16, v8
    v_mul_f32 v8, 0xbfb8aa3b, v8
    v_exp_f32 v8, v8
    s_nop 0
    v_add_f32 v8, 1.0, v8
    v_rcp_f32 v8, v8
    s_nop 0
    v_cvt_pk_bf16_f32 v8, v8, v8
    v_lshlrev_b32 v8, 16, v8
    s_nop 0
    v_readlane_b32 s46, v8, 63
    v_mov_b32 v44, s32
    v_mov_b32 v45, s33
    v_mov_b32 v47, s46
    s_mov_b64 exec, 0xff
    buffer_store_dwordx4 v[44:47], v3, s[12:15], s73 offen sc1
    s_mov_b64 exec, -1
    s_sleep 16
r_start:
    s_lshl_b32 s62, s34, 1
    s_lshr_b32 s42, s34, 2
    s_add_u32 s62, s62, s42
    s_lshl_b32 s62, s62, 13
    s_add_u32 s62, s62, 17432576
    s_add_u32 s61, s62, 4096
    s_and_b32 s18, s34, 3
    s_lshl_b32 s18, s18, 4
    s_add_u32 s18, s18, s35
    v_mov_b32 v11, 0
    v_and_b32 v4, 3, v0
    v_lshrrev_b32 v7, 4, v2
    v_lshlrev_b32 v5, 3, v4
    v_lshl_add_u32 v5, v7, 1, v5
    v_lshlrev_b32 v6, 10, v4
    v_lshl_add_u32 v6, v7, 2, v6
    v_lshrrev_b32 v86, 1, v4
    v_lshlrev_b32 v86, 9, v86
    v_and_b32 v87, 1, v4
    v_lshl_add_u32 v85, v87, 10, v86
    v_lshl_add_u32 v85, v7, 2, v85
    s_and_b32 s30, s18, 1
    s_bfe_u32 s31, s18, 0x20001
    s_bfe_u32 s40, s18, 0x20003
    s_lshr_b32 s41, s18, 5
    s_lshl_b32 s45, s41, 11
    s_lshl_b32 s42, s30, 8
    s_add_u32 s45, s45, s42
    s_lshl_b32 s42, s40, 6
    s_add_u32 s45, s45, s42
    s_lshl_b32 s31, s31, 4
    s_add_u32 s45, s45, s31
    s_add_u32 s62, s62, s45
    s_lshl_b32 s30, s30, 9
    s_add_u32 s31, s31, s30
    s_lshl_b32 s40, s40, 7
    s_add_u32 s31, s31, s40
    s_lshl_b32 s41, s41, 6
    s_add_u32 s31, s31, s41
    s_add_u32 s31, s31, 16916480
    s_mov_b32 s83, 0
r_ld:
    s_mov_b64 exec, 1
    buffer_load_dwordx4 v[32:35], v11, s[12:15], s61 offen sc1
    s_mov_b64 exec, -1
    buffer_load_dword v41, v85, s[12:15], s62 offen sc1
    buffer_load_dword v91, v6, s[12:15], s31 offen sc1
    s_bitcmp1_b32 s18, 1
    s_cselect_b32 s42, s33, s32
    v_lshlrev_b32 v88, 3, v7
    v_lshrrev_b32_e64 v88, v88, s42
    v_and_b32 v88, 0xff, v88
    v_lshlrev_b32 v89, 4, v7
    v_lshrrev_b64 v[82:83], v89, s[32:33]
    v_and_b32 v82, 0xffff, v82
    s_waitcnt vmcnt(0)
    v_readfirstlane_b32 s50, v32
    v_readfirstlane_b32 s51, v33
    v_readfirstlane_b32 s40, v34
    v_readfirstlane_b32 s46, v35
    v_xor_b32 v91, v88, v91
    v_xor_b32 v41, v82, v41
    v_or_b32 v19, v91, v41
    v_cmp_ne_u16 vcc, 0, v19
    s_xor_b64 s[50:51], s[50:51], s[32:33]
    s_or_b64 vcc, vcc, s[50:51]
    s_cbranch_vccz r_ldx
    s_sleep 2
    s_add_u32 s83, s83, 1
    s_cmp_lt_u32 s83, 0x40000
    s_cbranch_scc1 r_ld
r_ldx:
    v_mul_f32 v80, s46, v91
    s_bfe_u32 s46, s40, 0x70005
    s_bfe_u32 s47, s40, 0x30002
    s_bfe_u32 s60, s40, 0x10001
    s_bfe_u32 s63, s40, 0x70005
    s_lshl_b32 s63, s63, 13
    s_and_b32 s40, s40, 1
    s_lshl_b32 s40, s40, 12
    s_add_u32 s63, s63, s40
    s_add_u32 s63, s63, s45
    s_add_u32 s63, s63, 18874368
    buffer_load_dword v44, v85, s[12:15], s63 offen sc1
    v_lshrrev_b32 v10, 2, v2
    v_lshlrev_b32 v10, 7, v10
    v_lshl_add_u32 v10, v4, 4, v10
    s_lshl_b32 s44, s18, 13
    s_and_b32 s42, s34, 4
    s_lshl_b32 s42, s42, 4
    s_add_u32 s44, s44, s42
    s_add_u32 s44, s44, 17825792
    s_add_u32 s45, s44, 4096
    s_lshr_b32 s61, s46, 4
    s_and_b32 s41, s46, 15
    s_lshl_b32 s41, s41, 4
    s_add_u32 s41, s41, s61
    s_lshr_b32 s61, s46, 3
    s_cmp_eq_u32 s61, 1
    s_cselect_b32 s61, 120, 0
    s_sub_u32 s41, s41, s61
    s_lshl_b32 s61, s47, 8
    s_add_u32 s41, s41, s61
    s_cmp_ge_u32 s47, 4
    s_cselect_b32 s61, 896, 0
    s_cmp_eq_u32 s46, 0
    s_cselect_b32 s61, s61, 0
    s_sub_u32 s41, s41, s61
    s_sub_u32 s61, 2048, s41
    s_cmp_eq_u32 s41, 0
    s_cselect_b32 s61, 1024, s61
    s_cmp_eq_u32 s60, 1
    s_cselect_b32 s41, s61, s41
    s_lshl_b32 s41, s41, 11
    s_lshl_b32 s61, s18, 5
    s_add_u32 s41, s41, s61
    s_waitcnt vmcnt(0)
    v_and_b32 v44, 0xffffff00, v44
    v_fmac_f32 v44, v91, v41
    v_mov_b32 v28, v216
    v_mov_b32 v29, v217
    v_mov_b32 v30, v218
    v_mov_b32 v31, v219
    s_sleep 24
    s_mov_b32 s83, 0
    s_mov_b64 s[64:65], -1
    s_mov_b64 s[66:67], -1
    s_mov_b64 s[68:69], -1
    s_mov_b32 s70, -1
    s_mov_b32 s71, 0
r_p:
    s_mov_b64 exec, s[64:65]
    s_cbranch_execz r_q0
    buffer_load_dwordx4 v[16:19], v10, s[12:15], s44 offen offset:0 sc1
r_q0:
    s_mov_b64 exec, s[66:67]
    s_cbranch_execz r_q1
    buffer_load_dwordx4 v[20:23], v10, s[12:15], s44 offen offset:2048 sc1
r_q1:
    s_mov_b64 exec, s[68:69]
    s_cbranch_execz r_q2
    buffer_load_dwordx4 v[24:27], v10, s[12:15], s45 offen offset:0 sc1
r_q2:
    s_mov_b64 exec, s[70:71]
    s_cbranch_execz r_q3
    buffer_load_dwordx4 v[28:31], v10, s[12:15], s45 offen offset:2048 sc1
r_q3:
    s_mov_b64 exec, -1
    s_waitcnt vmcnt(0)
    v_xor_b32 v48, v216, v16
    v_xor_b32 v49, v217, v17
    v_xor_b32 v50, v218, v18
    v_xor_b32 v51, v219, v19
    v_xor_b32 v52, v216, v20
    v_xor_b32 v53, v217, v21
    v_xor_b32 v54, v218, v22
    v_xor_b32 v55, v219, v23
    v_xor_b32 v56, v216, v24
    v_xor_b32 v57, v217, v25
    v_xor_b32 v58, v218, v26
    v_xor_b32 v59, v219, v27
    v_xor_b32 v60, v216, v28
    v_xor_b32 v61, v217, v29
    v_xor_b32 v62, v218, v30
    v_xor_b32 v63, v219, v31
    v_or3_b32 v12, v48, v49, v50
    v_or3_b32 v13, v52, v53, v54
    v_or3_b32 v14, v56, v57, v58
    v_or3_b32 v15, v60, v61, v62
    v_or_b32 v12, v12, v51
    v_or_b32 v13, v13, v55
    v_or_b32 v14, v14, v59
    v_or_b32 v15, v15, v63
    v_pk_add_f32 v[48:49], v[48:49], v[52:53]
    v_pk_add_f32 v[56:57], v[56:57], v[60:61]
    v_pk_add_f32 v[50:51], v[50:51], v[54:55]
    v_pk_add_f32 v[58:59], v[58:59], v[62:63]
    v_cmp_ne_u16_sdwa s[64:65], v12, v11 src0_sel:BYTE_0 src1_sel:DWORD
    v_cmp_ne_u16_sdwa s[66:67], v13, v11 src0_sel:BYTE_0 src1_sel:DWORD
    v_cmp_ne_u16_sdwa s[68:69], v14, v11 src0_sel:BYTE_0 src1_sel:DWORD
    v_cmp_ne_u16_sdwa s[70:71], v15, v11 src0_sel:BYTE_0 src1_sel:DWORD
    v_pk_add_f32 v[48:49], v[48:49], v[56:57]
    v_pk_add_f32 v[50:51], v[50:51], v[58:59]
    s_or_b64 s[50:51], s[64:65], s[66:67]
    s_or_b64 s[52:53], s[68:69], s[70:71]
    s_or_b64 s[50:51], s[50:51], s[52:53]
    s_cbranch_scc1 r_r
r_x:
    v_permlane32_swap_b32 v48, v50
    v_permlane32_swap_b32 v49, v51
    v_pk_add_f32 v[48:49], v[48:49], v[50:51]
    s_nop 1
    v_permlane16_swap_b32 v48, v49
    v_add_f32 v48, v48, v49
    s_nop 1
    v_add_f32_dpp v48, v48, v48 row_ror:4 row_mask:0xf bank_mask:0xf
    s_nop 1
    v_add_f32_dpp v48, v48, v48 row_ror:8 row_mask:0xf bank_mask:0xf
    v_fmac_f32 v44, v48, v80
    s_mov_b32 exec_lo, 0x000f000f
    s_mov_b32 exec_hi, 0x000f000f
    v_cvt_pk_bf16_f32 v44, v44, v44
    buffer_store_short v44, v5, s[24:27], s41 offen
    s_endpgm
x_pr:
    s_waitcnt vmcnt(0)
    s_add_u32 s83, s83, 1
    s_cmp_lt_u32 s83, 0x40000
    s_cbranch_scc1 x_ph
    s_branch x_phx
x_sr:
    buffer_load_dwordx4 v[100:103], v18, s[12:15], s76 offen offset:0 sc1
    buffer_load_dwordx4 v[104:107], v18, s[12:15], s76 offen offset:1024 sc1
    buffer_load_dwordx4 v[108:111], v18, s[12:15], s76 offen offset:64 sc1
    buffer_load_dwordx4 v[112:115], v18, s[12:15], s76 offen offset:1088 sc1
    s_waitcnt vmcnt(0)
    s_sleep 2
    s_add_u32 s83, s83, 1
    s_cmp_lt_u32 s83, 0x40000
    s_cbranch_scc1 x_sb
    s_branch x_sbx
r_r:
    s_add_u32 s83, s83, 1
    s_cmp_lt_u32 s83, 0x40000
    s_cbranch_scc1 r_p
    s_branch r_x
f_start:
    s_mov_b32 s20, s26
    s_mov_b32 s21, s27
    s_mov_b32 s26, 4194304
    s_mov_b32 s27, 0x00020000
    s_mov_b32 s22, s50
    s_mov_b32 s23, s51
    s_mov_b32 s28, s54
    s_mov_b32 s29, s55
    s_add_u32 s58, s36, tables-h_pc
    s_addc_u32 s59, s37, 0
    s_lshr_b32 s36, s35, 1
    s_and_b32 s36, s36, 4
    s_xor_b32 s36, s36, s16
    s_and_b32 s37, s34, 4
    s_xor_b32 s37, s37, s16
    s_lshl_b32 s3, s34, 4
    s_add_u32 s3, s3, s35
    v_and_b32 v4, 15, v0
    v_bfe_u32 v5, v0, 4, 2
    v_lshrrev_b32 v248, 3, v2
    v_lshlrev_b32 v248, 18, v248
    v_lshlrev_b32 v249, 1, v5
    v_xor_b32 v249, v249, v0
    v_and_b32 v249, 7, v249
    v_lshl_add_u32 v255, v249, 4, v248
    v_lshlrev_b32 v6, 16, v5
    v_lshl_add_u32 v6, v4, 4, v6
    s_lshl_b32 s60, s16, 15
    s_lshl_b32 s61, s34, 11
    s_add_u32 s60, s60, s61
    s_lshl_b32 s61, s35, 7
    s_add_u32 s60, s60, s61
    s_lshl_b32 s61, s16, 12
    s_add_u32 s61, s61, 61440
    s_lshl_b32 s64, s36, 19
    s_lshl_b32 s65, s35, 3
    s_and_b32 s66, s34, 1
    s_lshl_b32 s66, s66, 2
    s_add_u32 s65, s65, s66
    s_lshr_b32 s66, s34, 1
    s_add_u32 s65, s65, s66
    s_lshl_b32 s65, s65, 8
    s_add_u32 s64, s64, s65
    s_add_u32 s64, s64, 1048576
    s_add_u32 s65, s64, 32768
    s_add_u32 s66, s64, 262144
    s_add_u32 s67, s64, 294912
    s_barrier
    s_cmp_eq_u32 s36, 0
    s_cselect_b32 s42, 2048, 0
    v_add_u32 v248, s42, v3
    global_load_dwordx4 v[236:239], v248, s[58:59]
    global_load_dwordx4 v[240:243], v248, s[58:59] offset:1024
    s_lshr_b32 s42, s3, 4
    s_and_b32 s30, s3, 15
    s_lshl_b32 s30, s30, 4
    s_add_u32 s30, s30, s42
    s_lshr_b32 s42, s3, 3
    s_cmp_eq_u32 s42, 1
    s_cselect_b32 s42, 120, 0
    s_sub_u32 s30, s30, s42
    s_lshl_b32 s42, s16, 8
    s_add_u32 s30, s30, s42
    s_cmp_ge_u32 s16, 4
    s_cselect_b32 s42, 896, 0
    s_cmp_eq_u32 s3, 0
    s_cselect_b32 s42, s42, 0
    s_sub_u32 s30, s30, s42
    s_sub_u32 s31, 2048, s30
    s_cmp_eq_u32 s30, 0
    s_cselect_b32 s31, 1024, s31
    s_lshl_b32 s18, s30, 11
    s_lshl_b32 s19, s31, 11
    s_sub_u32 s75, s19, 2048
    s_lshl_b32 s68, s16, 12
    s_add_u32 s68, s68, 126976
    v_bfe_u32 v248, v0, 2, 1
    v_bfe_u32 v249, v0, 3, 2
    v_lshlrev_b32 v249, 2, v249
    v_lshl_add_u32 v248, v248, 4, v249
    v_and_or_b32 v248, v0, 3, v248
    v_bfe_u32 v249, v0, 5, 3
    v_cvt_f32_u32 v248, v248
    v_cvt_f32_u32 v249, v249
    s_cmp_lt_u32 s16, 4
    s_mov_b32 s42, 0x3d000000
    s_cselect_b32 s42, s42, 0x3a800000
    v_mul_f32 v248, s42, v248
    v_mul_f32 v249, 4.0, v249
    v_mul_f32 v152, v248, v249
    v_add_f32 v153, v152, v248
    v_add_f32 v154, v153, v248
    v_add_f32 v155, v154, v248
    v_sin_f32 v156, v152
    v_sin_f32 v157, v153
    v_sin_f32 v158, v154
    v_sin_f32 v159, v155
    v_cos_f32 v152, v152
    v_cos_f32 v153, v153
    v_cos_f32 v154, v154
    v_cos_f32 v155, v155
    s_cbranch_scc0 f_tw
    v_cvt_pk_f16_f32 v160, v152, v156
    v_cvt_pk_f16_f32 v156, -v156, v152
    v_mov_b32 v152, v160
    v_cvt_pk_f16_f32 v160, v153, v157
    v_cvt_pk_f16_f32 v157, -v157, v153
    v_mov_b32 v153, v160
    v_cvt_pk_f16_f32 v160, v154, v158
    v_cvt_pk_f16_f32 v158, -v158, v154
    v_mov_b32 v154, v160
    v_cvt_pk_f16_f32 v160, v155, v159
    v_cvt_pk_f16_f32 v159, -v159, v155
    v_mov_b32 v155, v160
f_tw:
    s_and_b32 s42, s16, 4
    s_add_u32 s42, s42, s16
    s_lshl_b32 s42, s42, 10
    v_add_u32 v248, s42, v3
    ds_write_b128 v248, v[152:155] offset:0
    ds_write_b128 v248, v[156:159] offset:4096
    v_lshrrev_b32 v248, 1, v4
    v_and_b32 v249, 1, v0
    v_cmp_eq_u32 vcc, 1, v4
    s_nop 1
    v_cndmask_b32_e64 v250, v248, 0, vcc
    v_cndmask_b32_e64 v248, v248, 8, vcc
    v_cndmask_b32_e64 v249, v249, 0, vcc
    v_mad_u32_u24 v251, v248, v5, v249
    v_lshlrev_b32 v251, 5, v251
    v_mad_u32_u24 v251, v250, v1, v251
    v_cvt_f32_u32 v248, v248
    v_cvt_f32_u32 v250, v250
    v_cvt_f32_u32 v251, v251
    v_mul_f32 v248, 0x3d800000, v248
    v_mul_f32 v250, 0x3b800000, v250
    v_mul_f32 v216, 0x3c000000, v251
    v_add_f32 v217, v216, v248
    v_add_f32 v218, v217, v248
    v_add_f32 v219, v218, v248
    v_add_f32 v220, v216, v250
    v_add_f32 v221, v217, v250
    v_add_f32 v222, v218, v250
    v_add_f32 v223, v219, v250
    v_cos_f32 v216, v216
    v_cos_f32 v217, v217
    v_cos_f32 v218, v218
    v_cos_f32 v219, v219
    v_cos_f32 v220, v220
    v_cos_f32 v221, v221
    v_cos_f32 v222, v222
    v_cos_f32 v223, v223
    v_lshrrev_b32 v248, 2, v2
    v_lshlrev_b32 v8, 7, v248
    v_bfe_u32 v248, v0, 3, 2
    v_lshl_add_u32 v8, v248, 5, v8
    v_and_b32 v248, 3, v0
    v_lshl_add_u32 v8, v248, 3, v8
    v_lshl_add_u32 v8, v1, 12, v8
    v_xor_b32 v9, 32, v8
    v_xor_b32 v10, 64, v8
    v_xor_b32 v11, 96, v8
    v_lshlrev_b32 v12, 13, v5
    v_lshl_add_u32 v12, v4, 4, v12
    v_lshlrev_b32 v7, 5, v5
    v_and_b32 v248, 1, v0
    v_lshl_add_u32 v7, v248, 10, v7
    v_and_b32 v248, 2, v0
    v_lshl_add_u32 v7, v248, 3, v7
    s_lshl_b32 s70, s34, 11
    s_lshl_b32 s71, s16, 7
    s_add_u32 s71, s71, s70
    s_add_u32 s71, s71, 16777216
    s_lshl_b32 s42, s16, 7
    s_add_u32 s42, s42, 94208
    v_lshlrev_b32 v213, 3, v4
    v_lshl_add_u32 v212, v5, 13, v213
    v_add_u32 v212, s42, v212
    s_lshl_b32 s42, s36, 12
    s_add_u32 s42, s42, 94208
    v_lshl_add_u32 v213, v5, 8, v213
    v_and_b32 v214, 16, v0
    v_lshl_add_u32 v213, v214, 3, v213
    v_add_u32 v213, s42, v213
    v_xor_b32 v214, 128, v213
    s_mov_b32 s4, 0x3f803f80
    s_mov_b32 s5, 0x3a800000
    s_waitcnt vmcnt(6)
    s_load_dwordx2 s[32:33], s[20:21], 0
    v_dot2_f32_bf16 v108, v64, s4, 0
    v_dot2_f32_bf16 v110, v64, v64, 0
    v_dot2_f32_bf16 v108, v65, s4, v108
    v_dot2_f32_bf16 v110, v65, v65, v110
    v_dot2_f32_bf16 v108, v66, s4, v108
    v_dot2_f32_bf16 v110, v66, v66, v110
    v_dot2_f32_bf16 v108, v67, s4, v108
    v_dot2_f32_bf16 v110, v67, v67, v110
    s_waitcnt vmcnt(5)
    v_dot2_f32_bf16 v109, v72, s4, 0
    v_dot2_f32_bf16 v111, v72, v72, 0
    v_dot2_f32_bf16 v109, v73, s4, v109
    v_dot2_f32_bf16 v111, v73, v73, v111
    v_dot2_f32_bf16 v109, v74, s4, v109
    v_dot2_f32_bf16 v111, v74, v74, v111
    v_dot2_f32_bf16 v109, v75, s4, v109
    v_dot2_f32_bf16 v111, v75, v75, v111
    s_waitcnt vmcnt(4)
    v_dot2_f32_bf16 v108, v68, s4, v108
    v_dot2_f32_bf16 v110, v68, v68, v110
    v_dot2_f32_bf16 v108, v69, s4, v108
    v_dot2_f32_bf16 v110, v69, v69, v110
    v_dot2_f32_bf16 v108, v70, s4, v108
    v_dot2_f32_bf16 v110, v70, v70, v110
    v_dot2_f32_bf16 v108, v71, s4, v108
    v_dot2_f32_bf16 v110, v71, v71, v110
    s_waitcnt vmcnt(3)
    v_dot2_f32_bf16 v109, v76, s4, v109
    v_dot2_f32_bf16 v111, v76, v76, v111
    v_dot2_f32_bf16 v109, v77, s4, v109
    v_dot2_f32_bf16 v111, v77, v77, v111
    v_dot2_f32_bf16 v109, v78, s4, v109
    v_dot2_f32_bf16 v111, v78, v78, v111
    v_dot2_f32_bf16 v109, v79, s4, v109
    v_dot2_f32_bf16 v111, v79, v79, v111
    s_nop 1
    v_permlane32_swap_b32 v108, v109
    v_permlane32_swap_b32 v110, v111
    v_add_f32 v108, v108, v109
    v_add_f32 v110, v110, v111
    s_nop 0
    v_add_f32_dpp v108, v108, v108 row_ror:8 row_mask:0xf bank_mask:0xf
    v_add_f32_dpp v110, v110, v110 row_ror:8 row_mask:0xf bank_mask:0xf
    s_nop 0
    v_add_f32_dpp v108, v108, v108 row_ror:4 row_mask:0xf bank_mask:0xf
    v_add_f32_dpp v110, v110, v110 row_ror:4 row_mask:0xf bank_mask:0xf
    s_nop 0
    v_add_f32_dpp v108, v108, v108 row_ror:2 row_mask:0xf bank_mask:0xf
    v_add_f32_dpp v110, v110, v110 row_ror:2 row_mask:0xf bank_mask:0xf
    s_nop 0
    v_add_f32_dpp v108, v108, v108 row_ror:1 row_mask:0xf bank_mask:0xf
    v_add_f32_dpp v110, v110, v110 row_ror:1 row_mask:0xf bank_mask:0xf
    s_nop 0
    v_add_f32_dpp v108, v108, v108 row_bcast:15 row_mask:0xa bank_mask:0xf
    v_add_f32_dpp v110, v110, v110 row_bcast:15 row_mask:0xa bank_mask:0xf
    v_mul_f32 v108, s5, v108
    v_mul_f32 v110, s5, v110
    v_mul_f32 v116, v108, v108
    v_cvt_pk_bf16_f32 v117, -v108, -v108
    v_sub_f32 v110, v110, v116
    v_mul_f32 v118, 0x44000000, v110
    v_cmp_gt_f32 vcc, v116, v118
    v_readlane_b32 s40, v117, 31
    s_or_b32 s41, vcc_lo, vcc_hi
    s_bitcmp1_b32 s41, 31
    s_cbranch_scc1 f_slowvar
f_var:
    v_cvt_pk_bf16_f32 v110, v110, v110
    v_lshlrev_b32 v110, 16, v110
    v_add_f32 v110, 0x3727c5ac, v110
    v_cvt_pk_bf16_f32 v110, v110, v110
    v_lshlrev_b32 v110, 16, v110
    v_sqrt_f32 v110, v110
    s_and_b32 s40, s40, 0xffff
    v_mov_b32 v114, 0xffff0000
    v_cvt_pk_bf16_f32 v110, v110, v110
    v_lshlrev_b32 v110, 16, v110
    v_mul_f32 v110, 0x41800000, v110
    v_and_or_b32 v114, v117, v114, s40
    v_rcp_f32 v113, v110
    s_waitcnt lgkmcnt(0)
    s_cmp_lg_u32 s32, 0
    s_cbranch_scc1 f_nnx
    s_load_dwordx2 s[32:33], s[20:21], 64
    s_mov_b32 s83, 0
    v_mov_b32 v122, 0
    s_waitcnt lgkmcnt(0)
f_nn:
    s_cmp_lg_u32 s32, 0
    s_cbranch_scc1 f_nnx
    global_load_dwordx2 v[120:121], v122, s[20:21] sc1
    s_waitcnt vmcnt(0)
    v_readfirstlane_b32 s32, v120
    v_readfirstlane_b32 s33, v121
    s_add_u32 s83, s83, 1
    s_cmp_lt_u32 s83, 0x40000
    s_cbranch_scc1 f_nn
f_nnx:
    v_mov_b32 v115, s32
    v_mov_b32_dpp v112, v113 row_bcast:31 row_mask:0xc bank_mask:0xf
    v_mov_b32 v116, 0
    s_mov_b32 exec_lo, 0
    s_mov_b32 exec_hi, 0x80000000
    buffer_store_dwordx4 v[112:115], v116, s[12:15], s62 offen
    v_lshlrev_b32 v117, 4, v1
    v_add_u32 v117, 160768, v117
    ds_write_b128 v117, v[112:115]
    s_mov_b64 exec, -1
    s_mov_b32 m0, s61
    s_add_u32 s42, s60, 0
    s_add_u32 s61, s61, 1024
    buffer_load_dwordx4 v255, s[8:11], s42 offen lds
    s_mov_b32 m0, s61
    s_add_u32 s42, s60, 2097152
    s_add_u32 s61, s61, 1024
    buffer_load_dwordx4 v255, s[8:11], s42 offen lds
    s_mov_b32 m0, s61
    s_add_u32 s42, s60, 16384
    s_add_u32 s61, s61, 1024
    buffer_load_dwordx4 v255, s[8:11], s42 offen lds
    s_mov_b32 m0, s61
    s_add_u32 s42, s60, 2113536
    s_add_u32 s61, s61, 1024
    buffer_load_dwordx4 v255, s[8:11], s42 offen lds
    v_add_u32 v248, s68, v3
    ds_write_b128 v248, v[64:67] offset:0
    ds_write_b128 v248, v[68:71] offset:1024
    v_mov_b32 v244, s32
    v_mov_b32 v245, s33
    v_and_b32 v248, 4, v0
    v_cmp_eq_u32 vcc, 4, v248
    v_and_b32 v248, 3, v0
    v_lshlrev_b32 v248, 2, v248
    v_cndmask_b32 v244, v244, v245, vcc
    v_lshrrev_b32 v244, v248, v244
    s_mov_b32 s54, 0x00010001
    s_mov_b32 s55, 0xfffefffe
    s_mov_b32 s46, 0x05040100
    s_mov_b32 s47, 0x07060302
    v_lshrrev_b32 v245, 1, v244
    v_lshrrev_b32 v246, 2, v244
    v_lshrrev_b32 v247, 3, v244
    v_and_b32 v244, s54, v244
    v_and_b32 v245, s54, v245
    v_and_b32 v246, s54, v246
    v_and_b32 v247, s54, v247
    s_waitcnt vmcnt(2)
    s_mov_b32 exec_lo, 0x000f000f
    s_mov_b32 exec_hi, 0x000f000f
    buffer_load_dwordx4 v[24:27], v7, s[12:15], s71 offen sc1
    s_mov_b64 exec, -1
    s_mov_b32 s83, 0
    s_waitcnt vmcnt(1)
    ds_read_b64_tr_b16 v[40:41], v8 offset:61440
    ds_read_b64_tr_b16 v[42:43], v9 offset:61440
    ds_read_b64_tr_b16 v[44:45], v10 offset:61440
    ds_read_b64_tr_b16 v[46:47], v11 offset:61440
    ds_read_b64_tr_b16 v[48:49], v8 offset:63488
    ds_read_b64_tr_b16 v[50:51], v9 offset:63488
    ds_read_b64_tr_b16 v[52:53], v10 offset:63488
    ds_read_b64_tr_b16 v[54:55], v11 offset:63488
    s_mov_b32 exec_lo, 0x000f000f
    s_mov_b32 exec_hi, 0x000f000f
f_st:
    s_waitcnt vmcnt(0)
    v_cmp_ne_u32 vcc, s32, v27
    s_mov_b64 exec, -1
    s_cbranch_vccnz f_str
f_stx:
    s_setprio 3
    v_mov_b32_dpp v32, v26 row_newbcast:0 row_mask:0xf bank_mask:0xf
    v_mov_b32_dpp v33, v26 row_newbcast:1 row_mask:0xf bank_mask:0xf
    v_mov_b32_dpp v34, v26 row_newbcast:2 row_mask:0xf bank_mask:0xf
    v_mov_b32_dpp v35, v26 row_newbcast:3 row_mask:0xf bank_mask:0xf
    v_mul_f32_dpp v216, v24, v216 row_newbcast:0 row_mask:0xf bank_mask:0xf
    v_mul_f32_dpp v217, v24, v217 row_newbcast:1 row_mask:0xf bank_mask:0xf
    v_mul_f32_dpp v218, v24, v218 row_newbcast:2 row_mask:0xf bank_mask:0xf
    v_mul_f32_dpp v219, v24, v219 row_newbcast:3 row_mask:0xf bank_mask:0xf
    v_perm_b32 v28, v33, v32, s46
    v_perm_b32 v29, v35, v34, s46
    v_cvt_pk_bf16_f32 v224, v216, v217
    v_cvt_pk_bf16_f32 v225, v218, v219
    s_nop 1
    v_mfma_f32_16x16x16_bf16 v[228:231], v[224:225], v[28:29], 0
    v_mul_f32_dpp v220, v25, v220 row_newbcast:0 row_mask:0xf bank_mask:0xf
    v_mul_f32_dpp v221, v25, v221 row_newbcast:1 row_mask:0xf bank_mask:0xf
    v_mul_f32_dpp v222, v25, v222 row_newbcast:2 row_mask:0xf bank_mask:0xf
    v_mul_f32_dpp v223, v25, v223 row_newbcast:3 row_mask:0xf bank_mask:0xf
    v_perm_b32 v30, v33, v32, s47
    v_perm_b32 v31, v35, v34, s47
    v_cvt_pk_bf16_f32 v226, v220, v221
    v_cvt_pk_bf16_f32 v227, v222, v223
    s_nop 1
    v_mfma_f32_16x16x16_bf16 v[232:235], v[226:227], v[30:31], 0
    s_waitcnt lgkmcnt(0)
    v_mfma_f32_16x16x16_bf16 v[56:59], v[224:225], v[40:41], v[228:231]
    v_mfma_f32_16x16x16_bf16 v[60:63], v[226:227], v[48:49], v[232:235]
    v_mfma_f32_16x16x16_bf16 v[64:67], v[224:225], v[42:43], v[228:231]
    v_mfma_f32_16x16x16_bf16 v[68:71], v[226:227], v[50:51], v[232:235]
    s_mov_b32 m0, s68
    s_cmp_eq_u32 s34, 0
    s_cbranch_scc1 f_r0
f_nr:
    buffer_load_dwordx4 v3, s[8:11], s75 offen offset:2048 lds
    buffer_load_dwordx4 v3, s[8:11], s75 offen offset:3072 lds
    v_mfma_f32_16x16x16_bf16 v[72:75], v[224:225], v[44:45], v[228:231]
    v_mfma_f32_16x16x16_bf16 v[76:79], v[226:227], v[52:53], v[232:235]
    v_cvt_pk_f16_f32 v184, v56, v57
    v_cvt_pk_f16_f32 v185, v60, v61
    ds_write_b64 v212, v[184:185] offset:0
    v_cvt_pk_f16_f32 v186, v58, v59
    v_cvt_pk_f16_f32 v187, v62, v63
    ds_write_b64 v212, v[186:187] offset:4096
    v_mfma_f32_16x16x16_bf16 v[80:83], v[224:225], v[46:47], v[228:231]
    v_mfma_f32_16x16x16_bf16 v[84:87], v[226:227], v[54:55], v[232:235]
    v_cvt_pk_f16_f32 v188, v64, v65
    v_cvt_pk_f16_f32 v189, v68, v69
    ds_write_b64 v212, v[188:189] offset:1024
    v_cvt_pk_f16_f32 v190, v66, v67
    v_cvt_pk_f16_f32 v191, v70, v71
    ds_write_b64 v212, v[190:191] offset:5120
    v_cvt_pk_f16_f32 v192, v72, v73
    v_cvt_pk_f16_f32 v193, v76, v77
    ds_write_b64 v212, v[192:193] offset:2048
    v_cvt_pk_f16_f32 v194, v74, v75
    v_cvt_pk_f16_f32 v195, v78, v79
    ds_write_b64 v212, v[194:195] offset:6144
    v_cvt_pk_f16_f32 v196, v80, v81
    v_cvt_pk_f16_f32 v197, v84, v85
    ds_write_b64 v212, v[196:197] offset:3072
    v_cvt_pk_f16_f32 v198, v82, v83
    v_cvt_pk_f16_f32 v199, v86, v87
    ds_write_b64 v212, v[198:199] offset:7168
    s_waitcnt lgkmcnt(0)
    s_barrier
    ds_read_b64 v[152:153], v213 offset:0
    ds_read_b64 v[154:155], v214 offset:0
    ds_read_b64 v[156:157], v213 offset:1024
    ds_read_b64 v[158:159], v214 offset:1024
    ds_read_b64 v[160:161], v213 offset:2048
    ds_read_b64 v[162:163], v214 offset:2048
    ds_read_b64 v[164:165], v213 offset:3072
    ds_read_b64 v[166:167], v214 offset:3072
    s_waitcnt lgkmcnt(6)
    v_mfma_f32_16x16x32_f16 v[56:59], v[236:239], v[152:155], 0
    s_waitcnt lgkmcnt(4)
    v_mfma_f32_16x16x32_f16 v[60:63], v[236:239], v[156:159], 0
    s_waitcnt lgkmcnt(2)
    v_mfma_f32_16x16x32_f16 v[64:67], v[236:239], v[160:163], 0
    s_waitcnt lgkmcnt(0)
    v_mfma_f32_16x16x32_f16 v[68:71], v[236:239], v[164:167], 0
    v_mfma_f32_16x16x32_f16 v[72:75], v[240:243], v[152:155], 0
    v_mfma_f32_16x16x32_f16 v[76:79], v[240:243], v[156:159], 0
    v_mfma_f32_16x16x32_f16 v[80:83], v[240:243], v[160:163], 0
    v_mfma_f32_16x16x32_f16 v[84:87], v[240:243], v[164:167], 0
    v_cvt_pk_f16_f32 v184, v56, v57
    v_cvt_pk_f16_f32 v185, v60, v61
    v_cvt_pk_f16_f32 v186, v64, v65
    s_nop 0
    v_cvt_pk_f16_f32 v187, v68, v69
    v_and_or_b32 v184, v184, s55, v244
    v_and_or_b32 v185, v185, s55, v245
    v_and_or_b32 v186, v186, s55, v246
    v_and_or_b32 v187, v187, s55, v247
    buffer_store_dwordx4 v[184:187], v6, s[12:15], s64 offen sc1
    v_cvt_pk_f16_f32 v188, v58, v59
    v_cvt_pk_f16_f32 v189, v62, v63
    v_cvt_pk_f16_f32 v190, v66, v67
    v_cvt_pk_f16_f32 v191, v70, v71
    v_and_or_b32 v188, v188, s55, v244
    v_and_or_b32 v189, v189, s55, v245
    v_and_or_b32 v190, v190, s55, v246
    v_and_or_b32 v191, v191, s55, v247
    buffer_store_dwordx4 v[188:191], v6, s[12:15], s65 offen sc1
    v_cvt_pk_f16_f32 v192, v72, v73
    v_cvt_pk_f16_f32 v193, v76, v77
    v_cvt_pk_f16_f32 v194, v80, v81
    v_cvt_pk_f16_f32 v195, v84, v85
    v_and_or_b32 v192, v192, s55, v244
    v_and_or_b32 v193, v193, s55, v245
    v_and_or_b32 v194, v194, s55, v246
    v_and_or_b32 v195, v195, s55, v247
    buffer_store_dwordx4 v[192:195], v6, s[12:15], s66 offen sc1
    v_cvt_pk_f16_f32 v196, v74, v75
    v_cvt_pk_f16_f32 v197, v78, v79
    v_cvt_pk_f16_f32 v198, v82, v83
    v_cvt_pk_f16_f32 v199, v86, v87
    v_and_or_b32 v196, v196, s55, v244
    v_and_or_b32 v197, v197, s55, v245
    v_and_or_b32 v198, v198, s55, v246
    v_and_or_b32 v199, v199, s55, v247
    buffer_store_dwordx4 v[196:199], v6, s[12:15], s67 offen sc1
    s_setprio 0
    s_mov_b32 s43, 0
    s_lshr_b32 s42, s3, 4
    s_and_b32 s40, s3, 15
    s_lshl_b32 s40, s40, 4
    s_add_u32 s40, s40, s42
    s_lshr_b32 s42, s3, 3
    s_cmp_eq_u32 s42, 1
    s_cselect_b32 s42, 120, 0
    s_sub_u32 s40, s40, s42
    s_lshl_b32 s42, s43, 8
    s_add_u32 s40, s40, s42
    s_cmp_ge_u32 s43, 4
    s_cselect_b32 s42, 896, 0
    s_cmp_eq_u32 s3, 0
    s_cselect_b32 s42, s42, 0
    s_sub_u32 s40, s40, s42
    v_lshrrev_b32 v248, 1, v4
    v_and_b32 v249, 1, v0
    v_lshlrev_b32 v250, 8, v248
    v_add_u32 v250, s40, v250
    s_cmp_lg_u32 s3, 0
    s_cbranch_scc1 f_a3n
    v_cmp_lt_u32 s[44:45], 3, v248
    v_subrev_u32 v251, 896, v250
    s_nop 0
    v_cndmask_b32 v250, v250, v251, s[44:45]
    v_cmp_eq_u32 vcc, 1, v4
    v_mov_b32 v251, 1024
    s_nop 0
    v_cndmask_b32 v250, v250, v251, vcc
    v_cndmask_b32_e64 v249, v249, 0, vcc
f_a3n:
    v_lshlrev_b32 v251, 1, v5
    v_mul_u32_u24 v251, v251, v250
    v_lshl_add_u32 v251, v249, 9, v251
    v_add_u32 v253, v251, v250
    v_add_u32 v252, 1536, v251
    v_add_u32 v254, 1536, v253
    v_and_b32 v251, 2047, v251
    v_and_b32 v252, 2047, v252
    v_and_b32 v253, 2047, v253
    v_and_b32 v254, 2047, v254
    v_cvt_f32_u32 v251, v251
    v_cvt_f32_u32 v252, v252
    v_cvt_f32_u32 v253, v253
    v_cvt_f32_u32 v254, v254
    v_mul_f32 v251, 0x3a000000, v251
    v_mul_f32 v252, 0x3a000000, v252
    v_mul_f32 v253, 0x3a000000, v253
    v_mul_f32 v254, 0x3a000000, v254
    v_cos_f32 v251, v251
    v_cos_f32 v252, v252
    v_cos_f32 v253, v253
    v_cos_f32 v254, v254
    s_cbranch_scc1 f_a3m
    v_cmp_gt_u32 vcc, 2, v4
    s_nop 1
    v_cndmask_b32_e64 v249, 1.0, 0.5, vcc
    v_mul_f32 v251, v251, v249
    v_mul_f32 v253, v253, v249
    v_cndmask_b32 v252, 0, v251, s[44:45]
    v_cndmask_b32 v254, 0, v253, s[44:45]
    v_cndmask_b32 v251, v251, 0, s[44:45]
    v_cndmask_b32 v253, v253, 0, s[44:45]
f_a3m:
    v_cvt_pk_f16_f32 v22, v251, v252
    v_cvt_pk_f16_f32 v23, v253, v254
    v_and_b32 v248, 3, v0
    v_bfe_u32 v249, v0, 2, 1
    v_bfe_u32 v250, v0, 3, 2
    v_bfe_u32 v251, v0, 5, 1
    v_lshlrev_b32 v13, 10, v249
    v_lshlrev_b32 v15, 11, v249
    v_lshl_add_u32 v15, v251, 8, v15
    v_lshl_add_u32 v15, v250, 6, v15
    v_lshl_add_u32 v15, v248, 4, v15
    v_lshl_add_u32 v13, v250, 8, v13
    v_lshl_add_u32 v13, v248, 6, v13
    v_lshl_add_u32 v13, v251, 5, v13
    v_xor_b32 v14, 2016, v13
    v_add_u32 v13, s68, v13
    v_add_u32 v14, s68, v14
    s_waitcnt vmcnt(4)
    ds_read_b128 v[200:203], v13 offset:0
    ds_read_b128 v[204:207], v13 offset:16
    ds_read_b128 v[208:211], v14 offset:2048
    ds_read_b128 v[212:215], v14 offset:2064
    s_lshl_b32 s72, s3, 15
    s_lshl_b32 s73, s37, 12
    s_add_u32 s72, s72, s73
    s_add_u32 s72, s72, 1048576
    s_waitcnt lgkmcnt(0)
    ds_read_b128 v[88:91], v3 offset:0
    ds_read_b128 v[92:95], v3 offset:1024
    ds_read_b128 v[96:99], v3 offset:2048
    ds_read_b128 v[100:103], v3 offset:3072
    ds_read_b128 v[104:107], v3 offset:4096
    ds_read_b128 v[108:111], v3 offset:5120
    ds_read_b128 v[112:115], v3 offset:6144
    ds_read_b128 v[116:119], v3 offset:7168
    ds_read_b128 v[120:123], v3 offset:8192
    ds_read_b128 v[124:127], v3 offset:9216
    ds_read_b128 v[128:131], v3 offset:10240
    ds_read_b128 v[132:135], v3 offset:11264
    ds_read_b128 v[136:139], v3 offset:12288
    ds_read_b128 v[140:143], v3 offset:13312
    ds_read_b128 v[144:147], v3 offset:14336
    ds_read_b128 v[148:151], v3 offset:15360
    v_lshlrev_b32 v152, 16, v200
    v_and_b32 v153, 0xffff0000, v200
    v_lshlrev_b32 v154, 16, v201
    v_and_b32 v155, 0xffff0000, v201
    v_lshlrev_b32 v156, 16, v202
    v_and_b32 v157, 0xffff0000, v202
    v_lshlrev_b32 v158, 16, v203
    v_and_b32 v159, 0xffff0000, v203
    v_lshlrev_b32 v160, 16, v204
    v_and_b32 v161, 0xffff0000, v204
    v_lshlrev_b32 v162, 16, v205
    v_and_b32 v163, 0xffff0000, v205
    v_lshlrev_b32 v164, 16, v206
    v_and_b32 v165, 0xffff0000, v206
    v_lshlrev_b32 v166, 16, v207
    v_and_b32 v167, 0xffff0000, v207
    v_lshlrev_b32 v168, 16, v208
    v_and_b32 v183, 0xffff0000, v208
    v_lshlrev_b32 v182, 16, v209
    v_and_b32 v181, 0xffff0000, v209
    v_lshlrev_b32 v180, 16, v210
    v_and_b32 v179, 0xffff0000, v210
    v_lshlrev_b32 v178, 16, v211
    v_and_b32 v177, 0xffff0000, v211
    v_lshlrev_b32 v176, 16, v212
    v_and_b32 v175, 0xffff0000, v212
    v_lshlrev_b32 v174, 16, v213
    v_and_b32 v173, 0xffff0000, v213
    v_lshlrev_b32 v172, 16, v214
    v_and_b32 v171, 0xffff0000, v214
    v_lshlrev_b32 v170, 16, v215
    v_and_b32 v169, 0xffff0000, v215
    s_waitcnt vmcnt(0) lgkmcnt(0)
    s_barrier
    buffer_load_dwordx4 v[24:27], v3, s[12:15], s72 offen offset:0 sc1
    buffer_load_dwordx4 v[28:31], v3, s[12:15], s72 offen offset:1024 sc1
    buffer_load_dwordx4 v[32:35], v3, s[12:15], s72 offen offset:2048 sc1
    buffer_load_dwordx4 v[36:39], v3, s[12:15], s72 offen offset:3072 sc1
    s_lshl_b32 s80, s3, 7
    s_add_u32 s80, s80, 17039360
    v_lshrrev_b32 v18, 3, v2
    v_lshlrev_b32 v18, 14, v18
    v_and_b32 v248, 0x70, v3
    v_add_u32 v18, v18, v248
    s_cmp_lg_u32 s16, 0
    s_cbranch_scc1 f_sb2
    v_add_u32 v84, 160768, v3
    s_mov_b64 exec, 0xff
    ds_read_b128 v[80:83], v84
    s_waitcnt lgkmcnt(0)
    buffer_store_dwordx4 v[80:83], v3, s[12:15], s63 offen sc1
    s_mov_b64 exec, -1
    v_not_b32 v249, s32
    buffer_store_dwordx4 v[248:251], v18, s[12:15], s80 offen sc1
f_sb2:
    v_xor_b32 v16, 2544, v15
    s_nop 0
    v_subrev_u32 v248, s68, v13
    v_add_u32 v248, 32, v248
    v_bfe_u32 v19, v248, 5, 1
    v_lshlrev_b32 v19, 5, v19
    v_bfe_u32 v249, v248, 8, 2
    v_lshl_add_u32 v19, v249, 3, v19
    v_bfe_u32 v249, v248, 10, 1
    v_lshl_add_u32 v19, v249, 2, v19
    v_bfe_u32 v249, v248, 6, 2
    v_add_lshl_u32 v19, v249, v19, 2
    s_lshl_b32 s74, s34, 14
    s_add_u32 s74, s74, 17039360
    s_lshl_b32 s42, s37, 9
    s_add_u32 s42, s42, 61440
    v_add_u32 v12, s42, v12
    s_mul_i32 s17, s34, 7
    s_lshr_b32 s42, s35, 1
    s_add_u32 s17, s17, s42
    s_lshl_b32 s42, s17, 6
    s_lshr_b32 s43, s16, 2
    s_lshl_b32 s43, s43, 5
    s_add_u32 s42, s42, s43
    s_and_b32 s43, s16, 1
    s_lshl_b32 s43, s43, 4
    s_add_u32 s42, s42, s43
    s_and_b32 s43, s16, 2
    s_lshl_b32 s43, s43, 1
    s_add_u32 s42, s42, s43
    s_lshl_b32 s38, s42, 11
    s_and_b32 s43, s35, 1
    s_lshl_b32 s43, s43, 10
    s_add_u32 s38, s38, s43
    s_lshl_b32 s39, s16, 13
    s_add_u32 s39, s39, 94208
    s_mov_b32 s48, s28
    s_mov_b32 s49, s29
    s_mov_b32 s50, 7340032
    s_mov_b32 s51, 0x00020000
    s_bfe_u32 s4, s32, 524288
    s_bfe_u32 s5, s32, 524296
    s_bfe_u32 s6, s32, 524304
    s_bfe_u32 s7, s32, 524312
    s_bfe_u32 s8, s33, 524288
    s_bfe_u32 s9, s33, 524296
    s_bfe_u32 s10, s33, 524304
    s_bfe_u32 s11, s33, 524312
    v_lshlrev_b32 v17, 7, v4
    s_and_b32 s40, s16, 3
    s_lshl_b32 s76, s40, 10
    v_subrev_u32 v248, s68, v13
    v_lshrrev_b32 v248, 1, v248
    s_lshl_b32 s42, s40, 2
    v_add_u32 v248, s42, v248
    v_bfe_u32 v235, v248, 7, 1
    v_lshlrev_b32 v235, 9, v235
    v_and_b32 v249, 31, v248
    v_lshl_add_u32 v235, v249, 4, v235
    v_bfe_u32 v249, v248, 8, 1
    v_lshl_add_u32 v235, v249, 3, v235
    v_lshrrev_b32 v249, 9, v248
    v_lshl_add_u32 v235, v249, 10, v235
    v_bfe_u32 v249, v248, 5, 2
    v_lshl_add_u32 v235, v249, 1, v235
    v_mov_b32 v8, s32
    v_mov_b32 v9, s33
    v_and_b32 v10, 1, v0
    v_cmp_eq_u32 vcc, 1, v10
    s_nop 1
    v_cndmask_b32 v8, v8, v9, vcc
    v_bfe_u32 v9, v8, 8, 8
    v_bfe_u32 v10, v8, 16, 8
    v_lshrrev_b32 v11, 24, v8
    v_and_b32 v8, 0xff, v8
    s_add_u32 s76, s76, 16875520
    s_mov_b32 s77, 16850944
    s_xor_b32 s79, s35, 1
    s_xor_b32 s43, s16, 5
    s_or_b32 s79, s79, s43
    s_add_u32 s65, s76, 4096
    s_lshl_b32 s42, s16, 11
    v_add_u32 v4, s42, v3
    s_add_u32 s64, s42, 16883712
    s_lshl_b32 s42, s16, 12
    s_add_u32 s42, s42, 61440
    v_add_u32 v7, s42, v3
    v_mov_b32 v20, 159808
    s_cmp_eq_u32 s3, 0
    s_cselect_b64 s[52:53], -1, 1
    v_mov_b32 v196, v8
    v_mov_b32 v197, v9
    v_mov_b32 v198, v10
    v_mov_b32 v199, v11
    s_mov_b32 s83, 0
    s_cmp_ge_u32 s16, 4
    s_cbranch_scc1 f_z1
    s_waitcnt vmcnt(6)
    s_mov_b64 exec, 0xf0ff
    buffer_load_dwordx4 v[236:239], v17, s[12:15], s77 offen sc1
    s_mov_b64 exec, s[52:53]
    buffer_load_dwordx4 v[196:199], v3, s[12:15], s76 offen sc1
    s_mov_b64 exec, -1
    buffer_load_dwordx4 v[192:195], v3, s[12:15], s65 offen sc1
    buffer_load_dwordx4 v[184:187], v3, s[12:15], s64 offen offset:0 sc1
    buffer_load_dwordx4 v[188:191], v3, s[12:15], s64 offen offset:1024 sc1
    s_waitcnt vmcnt(7)
    v_xor_b32 v40, v24, v244
    v_xor_b32 v41, v28, v244
    v_xor_b32 v42, v25, v245
    v_xor_b32 v43, v29, v245
    v_xor_b32 v44, v26, v246
    v_xor_b32 v45, v30, v246
    v_xor_b32 v46, v27, v247
    v_xor_b32 v47, v31, v247
    v_mfma_f32_16x16x16_f16 v[56:59], v[22:23], v[40:41], 0
    v_or3_b32 v248, v40, v41, 0
    v_mfma_f32_16x16x16_f16 v[64:67], v[22:23], v[44:45], 0
    v_or3_b32 v248, v44, v45, v248
    v_mfma_f32_16x16x16_f16 v[60:63], v[22:23], v[42:43], 0
    v_or3_b32 v248, v42, v43, v248
    v_mfma_f32_16x16x16_f16 v[68:71], v[22:23], v[46:47], 0
    v_or3_b32 v248, v46, v47, v248
    s_waitcnt vmcnt(5)
    s_branch f_z2
f_z1:
    s_waitcnt vmcnt(4)
    buffer_load_dwordx4 v[184:187], v3, s[12:15], s64 offen offset:0 sc1
    buffer_load_dwordx4 v[188:191], v3, s[12:15], s64 offen offset:1024 sc1
    s_waitcnt vmcnt(4)
f_zc:
    v_xor_b32 v40, v24, v244
    v_xor_b32 v41, v28, v244
    v_xor_b32 v42, v25, v245
    v_xor_b32 v43, v29, v245
    v_xor_b32 v44, v26, v246
    v_xor_b32 v45, v30, v246
    v_xor_b32 v46, v27, v247
    v_xor_b32 v47, v31, v247
    v_mfma_f32_16x16x16_f16 v[56:59], v[22:23], v[40:41], 0
    v_or3_b32 v248, v40, v41, 0
    v_mfma_f32_16x16x16_f16 v[64:67], v[22:23], v[44:45], 0
    v_or3_b32 v248, v44, v45, v248
    v_mfma_f32_16x16x16_f16 v[60:63], v[22:23], v[42:43], 0
    v_or3_b32 v248, v42, v43, v248
    v_mfma_f32_16x16x16_f16 v[68:71], v[22:23], v[46:47], 0
    v_or3_b32 v248, v46, v47, v248
    s_waitcnt vmcnt(2)
f_z2:
    v_xor_b32 v48, v32, v244
    v_xor_b32 v49, v36, v244
    v_xor_b32 v50, v33, v245
    v_xor_b32 v51, v37, v245
    v_xor_b32 v52, v34, v246
    v_xor_b32 v53, v38, v246
    v_xor_b32 v54, v35, v247
    v_xor_b32 v55, v39, v247
    v_mfma_f32_16x16x16_f16 v[72:75], v[22:23], v[48:49], 0
    v_or3_b32 v248, v48, v49, v248
    v_mfma_f32_16x16x16_f16 v[80:83], v[22:23], v[52:53], 0
    v_or3_b32 v248, v52, v53, v248
    v_mfma_f32_16x16x16_f16 v[76:79], v[22:23], v[50:51], 0
    v_or3_b32 v248, v50, v51, v248
    v_mfma_f32_16x16x16_f16 v[84:87], v[22:23], v[54:55], 0
    v_or3_b32 v248, v54, v55, v248
    v_and_b32 v248, s54, v248
    v_cmp_ne_u32 vcc, 0, v248
    s_cbranch_vccnz f_zr
f_zx:
    v_cvt_pk_f16_f32 v24, v56, v57
    v_cvt_pk_f16_f32 v25, v64, v65
    v_cvt_pk_f16_f32 v26, v72, v73
    v_cvt_pk_f16_f32 v27, v80, v81
    ds_write_b128 v12, v[24:27] offset:0
    v_cvt_pk_f16_f32 v28, v58, v59
    v_cvt_pk_f16_f32 v29, v66, v67
    v_cvt_pk_f16_f32 v30, v74, v75
    v_cvt_pk_f16_f32 v31, v82, v83
    ds_write_b128 v12, v[28:31] offset:4096
    v_cvt_pk_f16_f32 v32, v60, v61
    v_cvt_pk_f16_f32 v33, v68, v69
    v_cvt_pk_f16_f32 v34, v76, v77
    v_cvt_pk_f16_f32 v35, v84, v85
    ds_write_b128 v12, v[32:35] offset:256
    v_cvt_pk_f16_f32 v36, v62, v63
    v_cvt_pk_f16_f32 v37, v70, v71
    v_cvt_pk_f16_f32 v38, v78, v79
    v_cvt_pk_f16_f32 v39, v86, v87
    ds_write_b128 v12, v[36:39] offset:4352
    s_mov_b32 s83, 0
    s_cmp_lt_u32 s16, 4
    s_cbranch_scc1 f_pv
f_qv:
    s_waitcnt vmcnt(1)
    v_xor_b32 v184, v8, v184
    v_xor_b32 v185, v9, v185
    v_xor_b32 v186, v10, v186
    v_xor_b32 v187, v11, v187
    v_or3_b32 v248, v184, v185, 0
    v_or3_b32 v248, v186, v187, v248
    ds_write_b128 v4, v[184:187] offset:20480
    s_waitcnt vmcnt(0)
    v_xor_b32 v188, v8, v188
    v_xor_b32 v189, v9, v189
    v_xor_b32 v190, v10, v190
    v_xor_b32 v191, v11, v191
    v_or3_b32 v248, v188, v189, v248
    v_or3_b32 v248, v190, v191, v248
    ds_write_b128 v4, v[188:191] offset:21504
    v_and_b32 v248, 0xff, v248
    v_cmp_ne_u32 vcc, 0, v248
    s_cbranch_vccnz f_qr
    s_branch f_pvx
f_pv:
    s_waitcnt vmcnt(3)
    v_add_f32_dpp v239, v238, v238 quad_perm:[1,0,3,2] row_mask:0xf bank_mask:0xf
    v_max_f32_dpp v238, v238, v238 quad_perm:[1,0,3,2] row_mask:0xf bank_mask:0xf
    v_cmp_ne_u64 s[44:45], s[32:33], v[236:237]
    v_add_f32_dpp v239, v239, v239 quad_perm:[2,3,0,1] row_mask:0xf bank_mask:0xf
    v_max_f32_dpp v238, v238, v238 quad_perm:[2,3,0,1] row_mask:0xf bank_mask:0xf
    v_xor_b32 v196, v8, v196
    v_xor_b32 v197, v9, v197
    v_xor_b32 v198, v10, v198
    v_xor_b32 v199, v11, v199
    v_or3_b32 v248, v196, v197, 0
    v_or3_b32 v248, v198, v199, v248
    v_max_f32_dpp v238, v238, v238 row_half_mirror row_mask:0xf bank_mask:0xf
    s_mov_b64 exec, 0x1000
    ds_write_b32 v20, v239
    s_mov_b64 exec, -1
    v_frexp_exp_i32_f32 v238, v238
    s_waitcnt vmcnt(2)
    v_xor_b32 v192, v8, v192
    v_xor_b32 v193, v9, v193
    v_xor_b32 v194, v10, v194
    v_xor_b32 v195, v11, v195
    v_or3_b32 v248, v192, v193, v248
    v_or3_b32 v248, v194, v195, v248
    v_readfirstlane_b32 s42, v238
    s_sub_u32 s43, -1, s42
    s_add_u32 s45, s42, 5
    s_and_b32 s44, s44, 0xf0ff
    v_ldexp_f32 v192, v192, s43
    v_ldexp_f32 v193, v193, s43
    v_ldexp_f32 v194, v194, s43
    v_ldexp_f32 v195, v195, s43
    v_cvt_pk_f16_f32 v192, v192, v193
    v_cvt_pk_f16_f32 v194, v194, v195
    ds_write_b16 v235, v192 offset:16384
    ds_write_b16_d16_hi v235, v192 offset:16400
    ds_write_b16 v235, v194 offset:16416
    ds_write_b16_d16_hi v235, v194 offset:16432
    s_waitcnt vmcnt(1)
    v_xor_b32 v184, v8, v184
    v_xor_b32 v185, v9, v185
    v_xor_b32 v186, v10, v186
    v_xor_b32 v187, v11, v187
    v_or3_b32 v248, v184, v185, v248
    v_or3_b32 v248, v186, v187, v248
    v_ldexp_f32 v184, v184, s45
    v_ldexp_f32 v185, v185, s45
    v_ldexp_f32 v186, v186, s45
    v_ldexp_f32 v187, v187, s45
    ds_write_b128 v4, v[184:187] offset:20480
    s_waitcnt vmcnt(0)
    v_xor_b32 v188, v8, v188
    v_xor_b32 v189, v9, v189
    v_xor_b32 v190, v10, v190
    v_xor_b32 v191, v11, v191
    v_or3_b32 v248, v188, v189, v248
    v_or3_b32 v248, v190, v191, v248
    v_ldexp_f32 v188, v188, s45
    v_ldexp_f32 v189, v189, s45
    v_ldexp_f32 v190, v190, s45
    v_ldexp_f32 v191, v191, s45
    ds_write_b128 v4, v[188:191] offset:21504
    v_and_b32 v248, 0xff, v248
    v_cmp_ne_u32 vcc, 0, v248
    s_or_b32 vcc_lo, vcc_lo, s44
    s_cbranch_vccnz f_pr
f_pw:
    s_cmp_eq_u32 s3, 0
    s_cbranch_scc1 f_ps
f_pvx:
    s_setprio 2
    s_waitcnt lgkmcnt(0)
    s_barrier
    ds_read_b128 v[248:251], v3 offset:16384
    ds_read_b128 v[24:27], v7 offset:0
    ds_read_b128 v[28:31], v7 offset:1024
    ds_read_b128 v[252:255], v3 offset:17408
    ds_read_b128 v[32:35], v7 offset:2048
    ds_read_b128 v[36:39], v7 offset:3072
    s_cmp_eq_u32 s30, 0
    s_cbranch_scc1 f_sp
    s_waitcnt lgkmcnt(4)
    v_pk_mul_f16 v40, v24, v248 op_sel:[0,0] op_sel_hi:[1,0]
    v_pk_mul_f16 v41, v25, v248 op_sel:[0,1] op_sel_hi:[1,1]
    v_pk_mul_f16 v42, v26, v249 op_sel:[0,0] op_sel_hi:[1,0]
    v_pk_mul_f16 v43, v27, v249 op_sel:[0,1] op_sel_hi:[1,1]
    s_nop 1
    v_mfma_f32_32x32x16_f16 v[56:71], v[40:43], v[88:91], 0
    s_waitcnt lgkmcnt(3)
    v_pk_mul_f16 v44, v28, v250 op_sel:[0,0] op_sel_hi:[1,0]
    v_pk_mul_f16 v45, v29, v250 op_sel:[0,1] op_sel_hi:[1,1]
    v_pk_mul_f16 v46, v30, v251 op_sel:[0,0] op_sel_hi:[1,0]
    v_pk_mul_f16 v47, v31, v251 op_sel:[0,1] op_sel_hi:[1,1]
    v_mfma_f32_32x32x16_f16 v[72:87], v[40:43], v[104:107], 0
    s_waitcnt lgkmcnt(1)
    v_pk_mul_f16 v48, v32, v252 op_sel:[0,0] op_sel_hi:[1,0]
    v_pk_mul_f16 v49, v33, v252 op_sel:[0,1] op_sel_hi:[1,1]
    v_pk_mul_f16 v50, v34, v253 op_sel:[0,0] op_sel_hi:[1,0]
    v_pk_mul_f16 v51, v35, v253 op_sel:[0,1] op_sel_hi:[1,1]
    v_mfma_f32_32x32x16_f16 v[56:71], v[44:47], v[92:95], v[56:71]
    s_waitcnt lgkmcnt(0)
    v_pk_mul_f16 v52, v36, v254 op_sel:[0,0] op_sel_hi:[1,0]
    v_pk_mul_f16 v53, v37, v254 op_sel:[0,1] op_sel_hi:[1,1]
    v_pk_mul_f16 v54, v38, v255 op_sel:[0,0] op_sel_hi:[1,0]
    v_pk_mul_f16 v55, v39, v255 op_sel:[0,1] op_sel_hi:[1,1]
    v_mfma_f32_32x32x16_f16 v[72:87], v[44:47], v[108:111], v[72:87]
f_st1:
    v_mfma_f32_32x32x16_f16 v[56:71], v[48:51], v[96:99], v[56:71]
    ds_read_b128 v[184:187], v3 offset:20480
    ds_read_b128 v[188:191], v3 offset:21504
    v_mfma_f32_32x32x16_f16 v[72:87], v[48:51], v[112:115], v[72:87]
    ds_read_b128 v[192:195], v3 offset:22528
    ds_read_b128 v[196:199], v3 offset:23552
    v_mfma_f32_32x32x16_f16 v[56:71], v[52:55], v[100:103], v[56:71]
    ds_read_b128 v[200:203], v3 offset:24576
    ds_read_b128 v[204:207], v3 offset:25600
    v_mfma_f32_32x32x16_f16 v[72:87], v[52:55], v[116:119], v[72:87]
    ds_read_b128 v[208:211], v3 offset:26624
    ds_read_b128 v[212:215], v3 offset:27648
    v_mov_b32 v22, 159808
    ds_read_b32 v22, v22
    s_cmp_ge_u32 s35, 14
    s_cbranch_scc1 f_nd0
    s_add_u32 s43, s39, 0
    s_mov_b32 m0, s43
    s_add_u32 s42, s38, 0
    buffer_load_dwordx4 v3, s[48:51], s42 offen nt lds
    s_add_u32 s43, s39, 1024
    s_mov_b32 m0, s43
    s_add_u32 s42, s38, 2048
    v_xor_b32 v7, 32, v3
    buffer_load_dwordx4 v7, s[48:51], s42 offen nt lds
    s_add_u32 s43, s39, 2048
    s_mov_b32 m0, s43
    s_add_u32 s42, s38, 4096
    v_xor_b32 v7, 64, v3
    buffer_load_dwordx4 v7, s[48:51], s42 offen nt lds
f_nd0:
    s_cmp_eq_u32 s30, 0
    s_cbranch_scc1 f_sp2
    v_pk_mul_f32 v[24:25], v[56:57], v[120:121]
    v_pk_mul_f32 v[28:29], v[72:73], v[120:121]
    v_pk_mul_f32 v[26:27], v[58:59], v[122:123]
    v_pk_mul_f32 v[30:31], v[74:75], v[122:123]
    v_pk_fma_f32 v[24:25], v[72:73], v[136:137], v[24:25]
    v_pk_fma_f32 v[28:29], v[56:57], v[136:137], v[28:29] neg_lo:[1,0,0] neg_hi:[1,0,0]
    v_pk_fma_f32 v[26:27], v[74:75], v[138:139], v[26:27]
    v_pk_fma_f32 v[30:31], v[58:59], v[138:139], v[30:31] neg_lo:[1,0,0] neg_hi:[1,0,0]
    v_cvt_pk_f16_f32 v40, v24, v28
    v_cvt_pk_f16_f32 v41, v25, v29
    v_cvt_pk_f16_f32 v42, v26, v30
    v_cvt_pk_f16_f32 v43, v27, v31
    ds_read_b128 v[216:219], v3 offset:28672
    ds_read_b128 v[220:223], v3 offset:29696
    ds_read_b128 v[224:227], v3 offset:30720
    ds_read_b128 v[228:231], v3 offset:31744
    v_pk_mul_f32 v[32:33], v[60:61], v[124:125]
    v_pk_mul_f32 v[36:37], v[76:77], v[124:125]
    v_pk_mul_f32 v[34:35], v[62:63], v[126:127]
    v_pk_mul_f32 v[38:39], v[78:79], v[126:127]
    v_pk_fma_f32 v[32:33], v[76:77], v[140:141], v[32:33]
    v_pk_fma_f32 v[36:37], v[60:61], v[140:141], v[36:37] neg_lo:[1,0,0] neg_hi:[1,0,0]
    v_pk_fma_f32 v[34:35], v[78:79], v[142:143], v[34:35]
    v_pk_fma_f32 v[38:39], v[62:63], v[142:143], v[38:39] neg_lo:[1,0,0] neg_hi:[1,0,0]
    v_cvt_pk_f16_f32 v44, v32, v36
    v_cvt_pk_f16_f32 v45, v33, v37
    v_cvt_pk_f16_f32 v46, v34, v38
    v_cvt_pk_f16_f32 v47, v35, v39
    v_mfma_f32_32x32x16_f16 v[104:119], v[40:43], v[88:91], 0
    ds_read_b128 v[232:235], v3 offset:32768
    ds_read_b128 v[236:239], v3 offset:33792
    ds_read_b128 v[240:243], v3 offset:34816
    ds_read_b128 v[244:247], v3 offset:35840
    v_pk_mul_f32 v[24:25], v[64:65], v[128:129]
    v_pk_mul_f32 v[28:29], v[80:81], v[128:129]
    v_pk_mul_f32 v[26:27], v[66:67], v[130:131]
    v_pk_mul_f32 v[30:31], v[82:83], v[130:131]
    v_pk_fma_f32 v[24:25], v[80:81], v[144:145], v[24:25]
    v_pk_fma_f32 v[28:29], v[64:65], v[144:145], v[28:29] neg_lo:[1,0,0] neg_hi:[1,0,0]
    v_pk_fma_f32 v[26:27], v[82:83], v[146:147], v[26:27]
    v_pk_fma_f32 v[30:31], v[66:67], v[146:147], v[30:31] neg_lo:[1,0,0] neg_hi:[1,0,0]
    v_cvt_pk_f16_f32 v48, v24, v28
    v_cvt_pk_f16_f32 v49, v25, v29
    v_cvt_pk_f16_f32 v50, v26, v30
    v_cvt_pk_f16_f32 v51, v27, v31
    v_mfma_f32_32x32x16_f16 v[104:119], v[44:47], v[92:95], v[104:119]
    v_pk_mul_f32 v[32:33], v[68:69], v[132:133]
    v_pk_mul_f32 v[36:37], v[84:85], v[132:133]
    v_pk_mul_f32 v[34:35], v[70:71], v[134:135]
    v_pk_mul_f32 v[38:39], v[86:87], v[134:135]
    v_pk_fma_f32 v[32:33], v[84:85], v[148:149], v[32:33]
    v_pk_fma_f32 v[36:37], v[68:69], v[148:149], v[36:37] neg_lo:[1,0,0] neg_hi:[1,0,0]
    v_pk_fma_f32 v[34:35], v[86:87], v[150:151], v[34:35]
    v_pk_fma_f32 v[38:39], v[70:71], v[150:151], v[38:39] neg_lo:[1,0,0] neg_hi:[1,0,0]
    v_cvt_pk_f16_f32 v52, v32, v36
    v_cvt_pk_f16_f32 v53, v33, v37
    v_cvt_pk_f16_f32 v54, v34, v38
    v_cvt_pk_f16_f32 v55, v35, v39
    v_mfma_f32_32x32x16_f16 v[104:119], v[48:51], v[96:99], v[104:119]
    s_nop 0
    v_mfma_f32_32x32x16_f16 v[104:119], v[52:55], v[100:103], v[104:119]
    s_nop 11
    ds_bpermute_b32 v12, v19, v104
    s_waitcnt lgkmcnt(1)
    v_pk_fma_f32 v[152:153], v[184:185], v[104:105], v[152:153]
    v_pk_fma_f32 v[154:155], v[186:187], v[106:107], v[154:155]
    v_pk_fma_f32 v[156:157], v[188:189], v[108:109], v[156:157]
    v_pk_fma_f32 v[158:159], v[190:191], v[110:111], v[158:159]
    v_pk_fma_f32 v[160:161], v[192:193], v[112:113], v[160:161]
    v_pk_fma_f32 v[162:163], v[194:195], v[114:115], v[162:163]
    v_pk_fma_f32 v[164:165], v[196:197], v[116:117], v[164:165]
    v_pk_fma_f32 v[166:167], v[198:199], v[118:119], v[166:167]
    v_pk_fma_f32 v[170:171], v[202:203], v[106:107], v[170:171]
    v_pk_fma_f32 v[172:173], v[204:205], v[108:109], v[172:173]
    v_pk_fma_f32 v[174:175], v[206:207], v[110:111], v[174:175]
    v_pk_fma_f32 v[176:177], v[208:209], v[112:113], v[176:177]
    v_pk_fma_f32 v[178:179], v[210:211], v[114:115], v[178:179]
    v_pk_fma_f32 v[180:181], v[212:213], v[116:117], v[180:181]
    v_pk_fma_f32 v[182:183], v[214:215], v[118:119], v[182:183]
    v_fmac_f32 v169, v201, v105
    s_waitcnt lgkmcnt(0)
    v_fmac_f32 v168, v200, v12
f_join:
    s_setprio 1
    v_lshrrev_b32 v17, 3, v0
    v_and_b32 v17, 60, v17
    v_add_u32 v17, 159744, v17
    v_and_b32 v7, 0xf0, v3
    v_lshrrev_b32 v7, 2, v7
    v_add_u32 v7, 159744, v7
    v_pk_add_f32 v[40:41], v[166:167], v[164:165]
    v_pk_add_f32 v[48:49], v[182:183], v[180:181]
    v_pk_add_f32 v[40:41], v[40:41], v[162:163]
    v_pk_add_f32 v[48:49], v[48:49], v[178:179]
    v_pk_add_f32 v[40:41], v[40:41], v[160:161]
    v_pk_add_f32 v[48:49], v[48:49], v[176:177]
    v_pk_add_f32 v[40:41], v[40:41], v[158:159]
    v_pk_add_f32 v[48:49], v[48:49], v[174:175]
    v_pk_add_f32 v[40:41], v[40:41], v[156:157]
    v_pk_add_f32 v[48:49], v[48:49], v[172:173]
    v_pk_add_f32 v[40:41], v[40:41], v[154:155]
    v_pk_add_f32 v[48:49], v[48:49], v[170:171]
    v_pk_add_f32 v[40:41], v[40:41], v[152:153]
    v_pk_add_f32 v[48:49], v[48:49], v[168:169]
    v_pk_mul_f32 v[42:43], v[166:167], v[166:167]
    v_pk_mul_f32 v[44:45], v[166:167], v[230:231]
    v_pk_mul_f32 v[50:51], v[182:183], v[182:183]
    v_pk_mul_f32 v[52:53], v[182:183], v[246:247]
    v_pk_fma_f32 v[42:43], v[164:165], v[164:165], v[42:43]
    v_pk_fma_f32 v[44:45], v[164:165], v[228:229], v[44:45]
    v_pk_fma_f32 v[50:51], v[180:181], v[180:181], v[50:51]
    v_pk_fma_f32 v[52:53], v[180:181], v[244:245], v[52:53]
    v_pk_fma_f32 v[42:43], v[162:163], v[162:163], v[42:43]
    v_pk_fma_f32 v[44:45], v[162:163], v[226:227], v[44:45]
    v_pk_fma_f32 v[50:51], v[178:179], v[178:179], v[50:51]
    v_pk_fma_f32 v[52:53], v[178:179], v[242:243], v[52:53]
    v_pk_fma_f32 v[42:43], v[160:161], v[160:161], v[42:43]
    v_pk_fma_f32 v[44:45], v[160:161], v[224:225], v[44:45]
    v_pk_fma_f32 v[50:51], v[176:177], v[176:177], v[50:51]
    v_pk_fma_f32 v[52:53], v[176:177], v[240:241], v[52:53]
    v_pk_fma_f32 v[42:43], v[158:159], v[158:159], v[42:43]
    v_pk_fma_f32 v[44:45], v[158:159], v[222:223], v[44:45]
    v_pk_fma_f32 v[50:51], v[174:175], v[174:175], v[50:51]
    v_pk_fma_f32 v[52:53], v[174:175], v[238:239], v[52:53]
    v_pk_fma_f32 v[42:43], v[156:157], v[156:157], v[42:43]
    v_pk_fma_f32 v[44:45], v[156:157], v[220:221], v[44:45]
    v_pk_fma_f32 v[50:51], v[172:173], v[172:173], v[50:51]
    v_pk_fma_f32 v[52:53], v[172:173], v[236:237], v[52:53]
    v_pk_fma_f32 v[42:43], v[154:155], v[154:155], v[42:43]
    v_pk_fma_f32 v[44:45], v[154:155], v[218:219], v[44:45]
    v_pk_fma_f32 v[50:51], v[170:171], v[170:171], v[50:51]
    v_pk_fma_f32 v[52:53], v[170:171], v[234:235], v[52:53]
    v_pk_fma_f32 v[42:43], v[152:153], v[152:153], v[42:43]
    v_pk_fma_f32 v[44:45], v[152:153], v[216:217], v[44:45]
    v_pk_fma_f32 v[50:51], v[168:169], v[168:169], v[50:51]
    v_pk_fma_f32 v[52:53], v[168:169], v[232:233], v[52:53]
    v_add_f32 v24, v40, v41
    v_add_f32 v25, v42, v43
    v_add_f32 v26, v44, v45
    v_add_f32 v28, v48, v49
    v_add_f32 v29, v50, v51
    v_add_f32 v30, v52, v53
    s_cmp_eq_u32 s79, 0
    s_cbranch_scc1 f_go
f_ngo:
    s_setprio 0
    v_permlane32_swap_b32 v24, v28
    v_permlane32_swap_b32 v25, v29
    v_permlane32_swap_b32 v26, v30
    v_add_f32 v24, v24, v28
    v_add_f32 v25, v25, v29
    v_add_f32 v26, v26, v30
    v_add_f32_dpp v24, v24, v24 row_ror:8 row_mask:0xf bank_mask:0xf
    v_add_f32_dpp v25, v25, v25 row_ror:8 row_mask:0xf bank_mask:0xf
    v_add_f32_dpp v26, v26, v26 row_ror:8 row_mask:0xf bank_mask:0xf
    v_add_f32_dpp v24, v24, v24 row_ror:4 row_mask:0xf bank_mask:0xf
    v_add_f32_dpp v25, v25, v25 row_ror:4 row_mask:0xf bank_mask:0xf
    v_add_f32_dpp v26, v26, v26 row_ror:4 row_mask:0xf bank_mask:0xf
    v_add_f32_dpp v24, v24, v24 row_ror:2 row_mask:0xf bank_mask:0xf
    v_add_f32_dpp v25, v25, v25 row_ror:2 row_mask:0xf bank_mask:0xf
    v_add_f32_dpp v26, v26, v26 row_ror:2 row_mask:0xf bank_mask:0xf
    v_add_f32_dpp v24, v24, v24 row_ror:1 row_mask:0xf bank_mask:0xf
    v_add_f32_dpp v25, v25, v25 row_ror:1 row_mask:0xf bank_mask:0xf
    v_add_f32_dpp v26, v26, v26 row_ror:1 row_mask:0xf bank_mask:0xf
    v_add_f32_dpp v24, v24, v24 row_bcast:15 row_mask:0xa bank_mask:0xf
    v_add_f32_dpp v25, v25, v25 row_bcast:15 row_mask:0xa bank_mask:0xf
    v_add_f32_dpp v26, v26, v26 row_bcast:15 row_mask:0xa bank_mask:0xf
    v_mul_f32 v24, 0x3a800000, v24
    v_mul_f32 v25, 0x3a800000, v25
    v_mul_f32 v28, v24, v24
    v_fma_f32 v26, -v24, v22, v26
    v_sub_f32 v25, v25, v28
    v_mul_f32 v29, 4.0, v25
    v_cmp_gt_f32 vcc, v28, v29
    v_lshrrev_b32 v30, 4, v0
    s_lshl_b32 s43, s3, 5
    v_and_or_b32 v30, v30, 30, s43
    s_or_b32 s42, vcc_lo, vcc_hi
    s_bitcmp1_b32 s42, 31
    s_cbranch_scc1 f_slow2
f_var2:
    v_cvt_pk_bf16_f32 v25, v25, v25
    v_lshlrev_b32 v25, 16, v25
    v_add_f32 v25, 0x3727c5ac, v25
    v_cvt_pk_bf16_f32 v25, v25, v25
    v_lshlrev_b32 v25, 16, v25
    v_sqrt_f32 v25, v25
    s_nop 0
    v_cvt_pk_bf16_f32 v25, v25, v25
    v_lshlrev_b32 v25, 16, v25
    v_rcp_f32 v25, v25
    s_mov_b32 s42, 0x80000000
    s_movk_i32 s43, 0xf000
    s_mov_b32 exec_lo, s42
    s_mov_b32 exec_hi, s42
    v_mul_f32 v26, v26, v25
    v_ashrrev_i32 v28, 31, v26
    v_or_b32 v28, s42, v28
    v_xor_b32 v26, v26, v28
    v_and_or_b32 v26, v26, s43, v30
    ds_write_b32 v17, v26
    v_mul_f32 v24, -v24, v25
    s_mov_b64 exec, -1
    v_readlane_b32 s60, v26, 31
    v_readlane_b32 s56, v24, 31
    v_readlane_b32 s57, v25, 31
    v_readlane_b32 s61, v26, 63
    v_readlane_b32 s58, v24, 63
    v_readlane_b32 s59, v25, 63
    s_waitcnt lgkmcnt(0)
    s_setprio 0
    s_barrier
    ds_read_b32 v32, v7
    s_mul_i32 s42, s16, 3072
    v_add_u32 v4, s42, v3
    s_add_u32 s64, s42, 16900096
    s_waitcnt lgkmcnt(0)
    v_cmp_lt_u32 vcc, s60, v32
    v_cmp_lt_u32 s[44:45], s61, v32
    s_and_b32 s62, vcc_lo, 0xffff
    s_and_b32 s63, s44, 0xffff
    s_bcnt1_i32_b32 s62, s62
    s_bcnt1_i32_b32 s63, s63
    s_min_u32 s42, s62, s63
    s_cmp_lg_u32 s42, 0
    s_cbranch_scc1 f_nkey
    s_setprio 3
    s_max_u32 s42, s60, s61
    v_cmp_ne_u32 vcc, s42, v32
    v_mov_b32 v36, s42
    v_mov_b32 v37, s32
    v_cndmask_b32 v38, 0, v32, vcc
    v_mov_b32 v39, s33
    s_nop 0
    v_max_u32_dpp v38, v38, v38 row_ror:8 row_mask:0xf bank_mask:0xf
    s_nop 1
    v_max_u32_dpp v38, v38, v38 row_ror:4 row_mask:0xf bank_mask:0xf
    s_nop 1
    v_max_u32_dpp v38, v38, v38 row_ror:2 row_mask:0xf bank_mask:0xf
    s_nop 1
    v_max_u32_dpp v38, v38, v38 row_ror:1 row_mask:0xf bank_mask:0xf
    v_or_b32 v38, 1, v38
    buffer_store_dwordx4 v[36:39], v18, s[12:15], s80 offen sc1
f_nkey:
    s_cmp_ge_u32 s62, 2
    s_cbranch_scc1 f_nc0
f_cand0:
    s_setprio 2
    s_lshl_b32 s43, s3, 1
    s_add_u32 s42, s62, s43
    s_lshl_b32 s43, s42, 7
    s_lshl_b32 s42, s42, 12
    s_add_u32 s42, s42, 18874368
    s_add_u32 s43, s43, 17170432
    v_mov_b32 v12, 0xffffff00
    v_and_or_b32 v56, v152, v12, s4
    v_and_or_b32 v57, v153, v12, s5
    v_and_or_b32 v58, v154, v12, s6
    v_and_or_b32 v59, v155, v12, s7
    buffer_store_dwordx4 v[56:59], v15, s[12:15], s42 offen offset:0 sc1
    v_and_or_b32 v60, v156, v12, s8
    v_and_or_b32 v61, v157, v12, s9
    v_and_or_b32 v62, v158, v12, s10
    v_and_or_b32 v63, v159, v12, s11
    buffer_store_dwordx4 v[60:63], v15, s[12:15], s42 offen offset:1024 sc1
    v_and_or_b32 v64, v160, v12, s4
    v_and_or_b32 v65, v161, v12, s5
    v_and_or_b32 v66, v162, v12, s6
    v_and_or_b32 v67, v163, v12, s7
    buffer_store_dwordx4 v[64:67], v15, s[12:15], s42 offen offset:512 sc1
    v_and_or_b32 v68, v164, v12, s8
    v_and_or_b32 v69, v165, v12, s9
    v_and_or_b32 v70, v166, v12, s10
    v_and_or_b32 v71, v167, v12, s11
    buffer_store_dwordx4 v[68:71], v15, s[12:15], s42 offen offset:1536 sc1
    v_mov_b32 v40, s32
    v_mov_b32 v41, s33
    v_mov_b32 v42, s56
    v_mov_b32 v43, s57
    s_mov_b64 exec, 0xff
    buffer_store_dwordx4 v[40:43], v3, s[12:15], s43 offen sc1
    s_mov_b64 exec, -1
    s_setprio 0
f_nc0:
    s_cmp_ge_u32 s63, 2
    s_cbranch_scc1 f_nc1
f_cand1:
    s_setprio 2
    s_lshl_b32 s43, s3, 1
    s_add_u32 s42, s63, s43
    s_lshl_b32 s43, s42, 7
    s_lshl_b32 s42, s42, 12
    s_add_u32 s42, s42, 18874368
    s_add_u32 s43, s43, 17170432
    v_mov_b32 v12, 0xffffff00
    v_and_or_b32 v72, v168, v12, s4
    v_and_or_b32 v73, v183, v12, s5
    v_and_or_b32 v74, v182, v12, s6
    v_and_or_b32 v75, v181, v12, s7
    buffer_store_dwordx4 v[72:75], v16, s[12:15], s42 offen offset:0 sc1
    v_and_or_b32 v76, v180, v12, s8
    v_and_or_b32 v77, v179, v12, s9
    v_and_or_b32 v78, v178, v12, s10
    v_and_or_b32 v79, v177, v12, s11
    buffer_store_dwordx4 v[76:79], v16, s[12:15], s42 offen offset:1024 sc1
    v_and_or_b32 v80, v176, v12, s4
    v_and_or_b32 v81, v175, v12, s5
    v_and_or_b32 v82, v174, v12, s6
    v_and_or_b32 v83, v173, v12, s7
    buffer_store_dwordx4 v[80:83], v16, s[12:15], s42 offen offset:512 sc1
    v_and_or_b32 v84, v172, v12, s8
    v_and_or_b32 v85, v171, v12, s9
    v_and_or_b32 v86, v170, v12, s10
    v_and_or_b32 v87, v169, v12, s11
    buffer_store_dwordx4 v[84:87], v16, s[12:15], s42 offen offset:1536 sc1
    v_mov_b32 v44, s32
    v_mov_b32 v45, s33
    v_mov_b32 v46, s58
    v_mov_b32 v47, s59
    s_mov_b64 exec, 0xff
    buffer_store_dwordx4 v[44:47], v3, s[12:15], s43 offen sc1
    s_mov_b64 exec, -1
    s_setprio 0
f_nc1:
    buffer_load_dwordx4 v[248:251], v3, s[12:15], s64 offen offset:0 sc1
    buffer_load_dwordx4 v[252:255], v3, s[12:15], s64 offen offset:1024 sc1
    buffer_load_dwordx4 v[136:139], v3, s[12:15], s64 offen offset:2048 sc1
    s_barrier
    s_cmp_ge_u32 s35, 14
    s_cbranch_scc1 f_nd2
    s_add_u32 s43, s39, 3072
    s_mov_b32 m0, s43
    s_add_u32 s42, s38, 6144
    v_xor_b32 v7, 96, v3
    buffer_load_dwordx4 v7, s[48:51], s42 offen nt lds
    s_add_u32 s43, s39, 4096
    s_mov_b32 m0, s43
    s_add_u32 s42, s38, 16384
    v_xor_b32 v7, 128, v3
    buffer_load_dwordx4 v7, s[48:51], s42 offen nt lds
    s_add_u32 s43, s39, 5120
    s_mov_b32 m0, s43
    s_add_u32 s42, s38, 18432
    v_xor_b32 v7, 160, v3
    buffer_load_dwordx4 v7, s[48:51], s42 offen nt lds
    s_add_u32 s43, s39, 6144
    s_mov_b32 m0, s43
    s_add_u32 s42, s38, 20480
    v_xor_b32 v7, 192, v3
    buffer_load_dwordx4 v7, s[48:51], s42 offen nt lds
    s_add_u32 s43, s39, 7168
    s_mov_b32 m0, s43
    s_add_u32 s42, s38, 22528
    v_xor_b32 v7, 224, v3
    buffer_load_dwordx4 v7, s[48:51], s42 offen nt lds
f_nd2:
    v_pk_fma_f32 v[56:57], v[152:153], s[56:57], s[56:57] op_sel:[0,1,0] op_sel_hi:[1,1,0]
    v_pk_fma_f32 v[58:59], v[154:155], s[56:57], s[56:57] op_sel:[0,1,0] op_sel_hi:[1,1,0]
    v_pk_fma_f32 v[60:61], v[156:157], s[56:57], s[56:57] op_sel:[0,1,0] op_sel_hi:[1,1,0]
    v_pk_fma_f32 v[62:63], v[158:159], s[56:57], s[56:57] op_sel:[0,1,0] op_sel_hi:[1,1,0]
    v_pk_fma_f32 v[64:65], v[160:161], s[56:57], s[56:57] op_sel:[0,1,0] op_sel_hi:[1,1,0]
    v_pk_fma_f32 v[66:67], v[162:163], s[56:57], s[56:57] op_sel:[0,1,0] op_sel_hi:[1,1,0]
    v_pk_fma_f32 v[68:69], v[164:165], s[56:57], s[56:57] op_sel:[0,1,0] op_sel_hi:[1,1,0]
    v_pk_fma_f32 v[70:71], v[166:167], s[56:57], s[56:57] op_sel:[0,1,0] op_sel_hi:[1,1,0]
    v_pk_fma_f32 v[72:73], v[168:169], s[58:59], s[58:59] op_sel:[0,1,0] op_sel_hi:[1,1,0]
    v_pk_fma_f32 v[74:75], v[170:171], s[58:59], s[58:59] op_sel:[0,1,0] op_sel_hi:[1,1,0]
    v_pk_fma_f32 v[76:77], v[172:173], s[58:59], s[58:59] op_sel:[0,1,0] op_sel_hi:[1,1,0]
    v_pk_fma_f32 v[78:79], v[174:175], s[58:59], s[58:59] op_sel:[0,1,0] op_sel_hi:[1,1,0]
    v_pk_fma_f32 v[80:81], v[176:177], s[58:59], s[58:59] op_sel:[0,1,0] op_sel_hi:[1,1,0]
    v_pk_fma_f32 v[82:83], v[178:179], s[58:59], s[58:59] op_sel:[0,1,0] op_sel_hi:[1,1,0]
    v_pk_fma_f32 v[84:85], v[180:181], s[58:59], s[58:59] op_sel:[0,1,0] op_sel_hi:[1,1,0]
    v_pk_fma_f32 v[86:87], v[182:183], s[58:59], s[58:59] op_sel:[0,1,0] op_sel_hi:[1,1,0]
    v_subrev_u32 v13, s68, v13
    s_sub_u32 s68, s68, 65536
    v_bfe_u32 v12, v0, 1, 2
    v_lshlrev_b32 v12, 4, v12
    v_xor_b32 v13, v13, v12
    v_xor_b32 v14, 2000, v13
    v_add_u32 v13, s68, v13
    v_add_u32 v14, s68, v14
    v_xor_b32 v20, 16, v13
    v_xor_b32 v21, 16, v14
    v_and_b32 v22, 8, v0
    v_lshlrev_b32 v22, 1, v22
    v_xor_b32 v22, v22, v3
    v_add_u32 v22, s68, v22
    v_xor_b32 v23, 32, v22
    s_mov_b32 s83, 0
    s_cmp_ge_u32 s35, 14
    s_cbranch_scc1 f_p2c
    s_waitcnt vmcnt(5)
f_p2e:
    v_xor_b32 v248, v8, v248
    v_xor_b32 v249, v9, v249
    v_xor_b32 v250, v10, v250
    v_xor_b32 v251, v11, v251
    v_xor_b32 v252, v8, v252
    v_xor_b32 v253, v9, v253
    v_xor_b32 v254, v10, v254
    v_xor_b32 v255, v11, v255
    v_xor_b32 v136, v8, v136
    v_xor_b32 v137, v9, v137
    v_xor_b32 v138, v10, v138
    v_xor_b32 v139, v11, v139
    v_or3_b32 v12, v248, v249, 0
    v_or3_b32 v12, v250, v251, v12
    v_or3_b32 v12, v252, v253, v12
    v_or3_b32 v12, v254, v255, v12
    v_or3_b32 v12, v136, v137, v12
    v_or3_b32 v12, v138, v139, v12
    v_and_b32 v12, 0xff, v12
    v_cmp_ne_u32 vcc, 0, v12
    s_cbranch_vccnz f_p2r
f_p2w:
    ds_write_b128 v4, v[248:251] offset:36864
    ds_write_b128 v4, v[252:255] offset:37888
    ds_write_b128 v4, v[136:139] offset:38912
    s_waitcnt lgkmcnt(0)
    s_barrier
    v_not_b32 v24, v8
    v_bfe_u32 v7, v0, 4, 2
    v_lshlrev_b32 v7, 13, v7
    v_and_b32 v25, 0x70, v3
    v_add_u32 v7, v7, v25
    s_and_b32 s42, s35, 1
    s_lshl_b32 s42, s42, 3
    s_add_u32 s42, s42, s16
    s_lshl_b32 s42, s42, 15
    s_lshl_b32 s43, s17, 7
    s_add_u32 s42, s42, s43
    s_add_u32 s42, s42, 17825792
    s_cmp_ge_u32 s35, 14
    s_cbranch_scc1 f_npw
    s_mov_b32 exec_lo, 0x00ff00ff
    s_mov_b32 exec_hi, 0x00ff00ff
    buffer_store_dwordx4 v[24:27], v7, s[12:15], s42 offen sc1
    s_mov_b64 exec, -1
f_npw:
    ds_read_b128 v[88:91], v3 offset:36864
    ds_read_b128 v[92:95], v3 offset:37888
    ds_read_b128 v[96:99], v3 offset:38912
    ds_read_b128 v[100:103], v3 offset:39936
    ds_read_b128 v[136:139], v3 offset:45056
    ds_read_b128 v[140:143], v3 offset:46080
    ds_read_b128 v[144:147], v3 offset:47104
    ds_read_b128 v[148:151], v3 offset:48128
    ds_read_b128 v[184:187], v3 offset:53248
    ds_read_b128 v[188:191], v3 offset:54272
    ds_read_b128 v[192:195], v3 offset:55296
    ds_read_b128 v[196:199], v3 offset:56320
    s_waitcnt lgkmcnt(4)
    v_pk_fma_f32 v[56:57], v[56:57], v[88:89], v[136:137]
    v_pk_fma_f32 v[58:59], v[58:59], v[90:91], v[138:139]
    v_pk_fma_f32 v[60:61], v[60:61], v[92:93], v[140:141]
    v_pk_fma_f32 v[62:63], v[62:63], v[94:95], v[142:143]
    v_pk_fma_f32 v[64:65], v[64:65], v[96:97], v[144:145]
    v_pk_fma_f32 v[66:67], v[66:67], v[98:99], v[146:147]
    v_pk_fma_f32 v[68:69], v[68:69], v[100:101], v[148:149]
    v_pk_fma_f32 v[70:71], v[70:71], v[102:103], v[150:151]
    s_waitcnt lgkmcnt(0)
    ds_read_b128 v[120:123], v3 offset:40960
    ds_read_b128 v[124:127], v3 offset:41984
    ds_read_b128 v[128:131], v3 offset:43008
    ds_read_b128 v[132:135], v3 offset:44032
    ds_read_b128 v[104:107], v3 offset:49152
    ds_read_b128 v[108:111], v3 offset:50176
    ds_read_b128 v[112:115], v3 offset:51200
    ds_read_b128 v[116:119], v3 offset:52224
    ds_read_b128 v[200:203], v3 offset:57344
    ds_read_b128 v[204:207], v3 offset:58368
    ds_read_b128 v[208:211], v3 offset:59392
    ds_read_b128 v[212:215], v3 offset:60416
    v_pk_fma_f32 v[152:153], v[184:185], v[56:57], v[152:153]
    v_pk_fma_f32 v[154:155], v[186:187], v[58:59], v[154:155]
    v_pk_fma_f32 v[156:157], v[188:189], v[60:61], v[156:157]
    v_pk_fma_f32 v[158:159], v[190:191], v[62:63], v[158:159]
    v_pk_fma_f32 v[160:161], v[192:193], v[64:65], v[160:161]
    v_pk_fma_f32 v[162:163], v[194:195], v[66:67], v[162:163]
    v_pk_fma_f32 v[164:165], v[196:197], v[68:69], v[164:165]
    v_pk_fma_f32 v[166:167], v[198:199], v[70:71], v[166:167]
    v_cvt_pk_bf16_f32 v216, v152, v153
    v_cvt_pk_bf16_f32 v217, v154, v155
    v_cvt_pk_bf16_f32 v218, v156, v157
    v_cvt_pk_bf16_f32 v219, v158, v159
    v_cvt_pk_bf16_f32 v220, v160, v161
    v_cvt_pk_bf16_f32 v221, v162, v163
    v_cvt_pk_bf16_f32 v222, v164, v165
    v_cvt_pk_bf16_f32 v223, v166, v167
    ds_write_b128 v13, v[216:219] offset:0
    ds_write_b128 v20, v[220:223] offset:0
    s_waitcnt lgkmcnt(6)
    v_pk_fma_f32 v[72:73], v[72:73], v[120:121], v[104:105]
    v_pk_fma_f32 v[74:75], v[74:75], v[122:123], v[106:107]
    v_pk_fma_f32 v[76:77], v[76:77], v[124:125], v[108:109]
    v_pk_fma_f32 v[78:79], v[78:79], v[126:127], v[110:111]
    v_pk_fma_f32 v[80:81], v[80:81], v[128:129], v[112:113]
    v_pk_fma_f32 v[82:83], v[82:83], v[130:131], v[114:115]
    v_pk_fma_f32 v[84:85], v[84:85], v[132:133], v[116:117]
    v_pk_fma_f32 v[86:87], v[86:87], v[134:135], v[118:119]
    s_waitcnt lgkmcnt(2)
    v_pk_fma_f32 v[168:169], v[200:201], v[72:73], v[168:169]
    v_pk_fma_f32 v[170:171], v[202:203], v[74:75], v[170:171]
    v_pk_fma_f32 v[172:173], v[204:205], v[76:77], v[172:173]
    v_pk_fma_f32 v[174:175], v[206:207], v[78:79], v[174:175]
    v_pk_fma_f32 v[176:177], v[208:209], v[80:81], v[176:177]
    v_pk_fma_f32 v[178:179], v[210:211], v[82:83], v[178:179]
    v_pk_fma_f32 v[180:181], v[212:213], v[84:85], v[180:181]
    v_pk_fma_f32 v[182:183], v[214:215], v[86:87], v[182:183]
    v_cvt_pk_bf16_f32 v224, v168, v183
    v_cvt_pk_bf16_f32 v225, v182, v181
    v_cvt_pk_bf16_f32 v226, v180, v179
    v_cvt_pk_bf16_f32 v227, v178, v177
    v_cvt_pk_bf16_f32 v228, v176, v175
    v_cvt_pk_bf16_f32 v229, v174, v173
    v_cvt_pk_bf16_f32 v230, v172, v171
    v_cvt_pk_bf16_f32 v231, v170, v169
    ds_write_b128 v14, v[224:227] offset:2048
    ds_write_b128 v21, v[228:231] offset:2048
    s_waitcnt lgkmcnt(0)
    ds_read_b128 v[232:235], v22 offset:0
    ds_read_b128 v[236:239], v23 offset:1024
    ds_read_b128 v[240:243], v22 offset:2048
    ds_read_b128 v[244:247], v23 offset:3072
    v_lshrrev_b32 v144, 2, v2
    v_and_b32 v145, 7, v144
    v_and_b32 v146, 3, v0
    v_lshl_add_u32 v148, v1, 2, v146
    v_xor_b32 v148, v148, v145
    v_lshlrev_b32 v148, 5, v148
    v_lshl_add_u32 v148, v144, 10, v148
    v_add_u32 v148, 94208, v148
    v_cmp_eq_u32 s[44:45], 1, v146
    v_cmp_eq_u32 s[46:47], 2, v146
    v_cmp_eq_u32 s[72:73], 3, v146
    v_bfe_u32 v145, v0, 4, 2
    v_and_b32 v144, 1, v144
    v_lshlrev_b32 v153, 7, v144
    v_lshl_add_u32 v153, v145, 4, v153
    v_add_u32 v153, 159872, v153
    v_lshlrev_b32 v154, 4, v146
    v_lshl_add_u32 v154, v144, 6, v154
    v_lshl_add_u32 v154, v1, 15, v154
    v_lshl_add_u32 v154, v145, 13, v154
    v_and_b32 v144, 15, v0
    v_lshlrev_b32 v152, 1, v144
    v_lshl_add_u32 v152, v1, 5, v152
    v_lshl_add_u32 v152, v145, 7, v152
    v_add_u32 v152, 159872, v152
    s_and_b32 s76, s35, 1
    s_lshl_b32 s76, s76, 18
    s_lshl_b32 s77, s17, 7
    s_add_u32 s76, s76, s77
    s_add_u32 s76, s76, 17825792
    s_movk_i32 s77, 0xff00
    s_lshl_b32 s81, s17, 2
    s_and_b32 s42, s16, 3
    s_add_u32 s81, s81, s42
    s_lshl_b32 s81, s81, 10
    s_add_u32 s82, s81, 18612224
    s_add_u32 s81, s81, 18350080
    v_mov_b32 v5, 159848
    s_waitcnt vmcnt(0)
    s_barrier
    ds_read_b64_tr_b16 v[88:89], v148 offset:0
    ds_read_b64_tr_b16 v[90:91], v148 offset:16384
    ds_read_b64_tr_b16 v[92:93], v148 offset:8
    ds_read_b64_tr_b16 v[94:95], v148 offset:16392
    ds_read_b64_tr_b16 v[96:97], v148 offset:16
    ds_read_b64_tr_b16 v[98:99], v148 offset:16400
    ds_read_b64_tr_b16 v[100:101], v148 offset:24
    ds_read_b64_tr_b16 v[102:103], v148 offset:16408
    ds_read_b64_tr_b16 v[104:105], v148 offset:32768
    ds_read_b64_tr_b16 v[106:107], v148 offset:49152
    ds_read_b64_tr_b16 v[108:109], v148 offset:32776
    ds_read_b64_tr_b16 v[110:111], v148 offset:49160
    ds_read_b64_tr_b16 v[112:113], v148 offset:32784
    ds_read_b64_tr_b16 v[114:115], v148 offset:49168
    ds_read_b64_tr_b16 v[116:117], v148 offset:32792
    ds_read_b64_tr_b16 v[118:119], v148 offset:49176
    v_lshlrev_b32 v40, 13, v2
    s_lshl_b32 s74, s34, 14
    s_add_u32 s74, s74, 17436672
    s_min_u32 s75, s62, s63
    s_cmp_ge_u32 s35, 14
    s_cbranch_scc1 f_na
    s_cmp_ge_u32 s16, 4
    s_cbranch_scc1 f_na
    s_mov_b32 s83, 0
f_px:
    s_and_b32 s42, s83, 63
    s_cmp_eq_u32 s42, 63
    s_cselect_b32 s42, s82, s81
    buffer_load_dwordx4 v[144:147], v3, s[12:15], s42 offen sc1
    s_add_u32 s83, s83, 1
    s_cmp_ge_u32 s83, 0x40000
    s_cbranch_scc1 f_pxx
    s_waitcnt vmcnt(0)
    v_cmp_ne_u16_sdwa vcc, v147, v11 src0_sel:BYTE_0 src1_sel:DWORD
    s_cbranch_vccnz f_px
    v_xor_b32 v144, v8, v144
    v_xor_b32 v145, v9, v145
    v_xor_b32 v146, v10, v146
    v_xor_b32 v147, v11, v147
    v_or3_b32 v4, v144, v145, 0
    v_or3_b32 v4, v146, v147, v4
    v_and_b32 v4, 0xff, v4
    v_cmp_ne_u32 vcc, 0, v4
    s_cbranch_vccnz f_px
f_pxx:
    s_waitcnt vmcnt(0)
    v_permlane32_swap_b32 v144, v146
    v_permlane32_swap_b32 v145, v147
    v_pk_add_f32 v[144:145], v[144:145], v[146:147]
    s_nop 1
    v_permlane16_swap_b32 v144, v145
    v_add_f32 v144, v144, v145
    v_cvt_pk_bf16_f32 v144, v144, v144
    v_lshlrev_b32 v144, 16, v144
    v_mul_f32 v145, 0xbfb8aa3b, v144
    v_exp_f32 v145, v145
    v_mov_b32 v146, v144
    v_add_f32 v145, 1.0, v145
    v_rcp_f32 v145, v145
    v_mov_b32 v147, v144
    v_mul_f32 v145, v144, v145
    s_nop 0
    v_permlane32_swap_b32 v146, v147
    v_cvt_pk_bf16_f32 v145, v145, v145
    v_lshlrev_b32 v145, 16, v145
    v_mul_f32 v145, v145, v147
    v_cvt_pk_bf16_f32 v145, v145, v145
    ds_write_b16 v152, v145
f_na:
    s_waitcnt lgkmcnt(0)
    s_barrier
    s_cmp_ge_u32 s35, 14
    s_cbranch_scc1 f_fin
    ds_read_b128 v[120:123], v153 offset:0
    ds_read_b128 v[124:127], v153 offset:64
    s_cmp_lt_u32 s75, 2
    s_cbranch_scc1 f_rq
f_rqx:
    s_waitcnt lgkmcnt(1)
    v_mfma_f32_16x16x32_bf16 v[128:131], v[88:91], v[120:123], 0
    v_mfma_f32_16x16x32_bf16 v[132:135], v[92:95], v[120:123], 0
    v_mfma_f32_16x16x32_bf16 v[136:139], v[96:99], v[120:123], 0
    v_mfma_f32_16x16x32_bf16 v[140:143], v[100:103], v[120:123], 0
    s_waitcnt lgkmcnt(0)
    v_mfma_f32_16x16x32_bf16 v[128:131], v[104:107], v[124:127], v[128:131]
    v_mfma_f32_16x16x32_bf16 v[132:135], v[108:111], v[124:127], v[132:135]
    v_mfma_f32_16x16x32_bf16 v[136:139], v[112:115], v[124:127], v[136:139]
    v_mfma_f32_16x16x32_bf16 v[140:143], v[116:119], v[124:127], v[140:143]
    s_nop 5
    v_cndmask_b32 v128, v128, v132, s[44:45]
    v_cndmask_b32 v129, v129, v133, s[44:45]
    v_cndmask_b32 v130, v130, v134, s[44:45]
    v_cndmask_b32 v131, v131, v135, s[44:45]
    v_cndmask_b32 v128, v128, v136, s[46:47]
    v_cndmask_b32 v129, v129, v137, s[46:47]
    v_cndmask_b32 v130, v130, v138, s[46:47]
    v_cndmask_b32 v131, v131, v139, s[46:47]
    v_cndmask_b32 v128, v128, v140, s[72:73]
    v_cndmask_b32 v129, v129, v141, s[72:73]
    v_cndmask_b32 v130, v130, v142, s[72:73]
    v_cndmask_b32 v131, v131, v143, s[72:73]
    v_and_or_b32 v128, v128, s77, v8
    v_and_or_b32 v129, v129, s77, v9
    v_and_or_b32 v130, v130, s77, v10
    v_and_or_b32 v131, v131, s77, v11
    s_mov_b32 exec_lo, 0x00ff00ff
    s_mov_b32 exec_hi, 0x00ff00ff
    buffer_store_dwordx4 v[128:131], v154, s[12:15], s76 offen sc1
    s_mov_b64 exec, -1
    s_barrier
f_fin:
    s_cmp_lt_u32 s75, 2
    s_cbranch_scc1 f_sel
    buffer_store_dwordx4 v[232:235], v3, s[24:27], s18 offen offset:0 sc1
    buffer_store_dwordx4 v[236:239], v3, s[24:27], s18 offen offset:1024 sc1
f_g0:
    buffer_store_dwordx4 v[240:243], v3, s[24:27], s19 offen offset:0 sc1
    buffer_store_dwordx4 v[244:247], v3, s[24:27], s19 offen offset:1024 sc1
f_g1:
f_end:
    s_endpgm
f_rq:
    s_mov_b64 exec, 3
    buffer_load_dwordx4 v[32:35], v40, s[12:15], s74 offen sc1
    s_mov_b64 exec, -1
    s_branch f_rqx
f_sel:
    s_mov_b32 s83, 0
    s_cmp_ge_u32 s35, 14
    s_cbranch_scc1 f_sr
    s_waitcnt vmcnt(1)
f_sc:
    v_cmp_ne_u64 vcc, s[32:33], v[32:33]
    v_readlane_b32 s40, v34, 0
    v_readlane_b32 s41, v34, 1
    s_and_b32 s42, vcc_lo, 3
    s_cbranch_scc0 f_sx
    s_sleep 4
f_sr:
    s_mov_b64 exec, 3
    buffer_load_dwordx4 v[32:35], v40, s[12:15], s74 offen sc1
    s_mov_b64 exec, -1
    s_waitcnt vmcnt(0)
    s_add_u32 s83, s83, 1
    s_cmp_lt_u32 s83, 0x40000
    s_cbranch_scc1 f_sc
f_sx:
    s_andn2_b32 s40, s40, 1
    s_andn2_b32 s41, s41, 1
    s_cmp_eq_u32 s60, s40
    s_cbranch_scc1 f_e0
    s_cmp_eq_u32 s60, s41
    s_cbranch_scc1 f_e0
    buffer_store_dwordx4 v[232:235], v3, s[24:27], s18 offen offset:0 sc1
    buffer_store_dwordx4 v[236:239], v3, s[24:27], s18 offen offset:1024 sc1
f_e0:
    s_cmp_eq_u32 s61, s40
    s_cbranch_scc1 f_e1
    s_cmp_eq_u32 s61, s41
    s_cbranch_scc1 f_e1
    buffer_store_dwordx4 v[240:243], v3, s[24:27], s19 offen offset:0 sc1
    buffer_store_dwordx4 v[244:247], v3, s[24:27], s19 offen offset:1024 sc1
f_e1:
    s_branch f_end
f_p2r:
    s_add_u32 s83, s83, 1
    s_cmp_ge_u32 s83, 0x40000
    s_cbranch_scc1 f_p2w
    s_sleep 12
    buffer_load_dwordx4 v[248:251], v3, s[12:15], s64 offen offset:0 sc1
    buffer_load_dwordx4 v[252:255], v3, s[12:15], s64 offen offset:1024 sc1
    buffer_load_dwordx4 v[136:139], v3, s[12:15], s64 offen offset:2048 sc1
f_p2c:
    s_waitcnt vmcnt(0)
    s_branch f_p2e
f_zr:
    v_or3_b32 v248, v40, v42, v44
    v_or_b32 v248, v248, v46
    v_and_b32 v248, s54, v248
    v_cmp_ne_u32 vcc, 0, v248
    s_cbranch_vccz f_zr0
    buffer_load_dwordx4 v[24:27], v3, s[12:15], s72 offen offset:0 sc1
f_zr0:
    v_or3_b32 v248, v41, v43, v45
    v_or_b32 v248, v248, v47
    v_and_b32 v248, s54, v248
    v_cmp_ne_u32 vcc, 0, v248
    s_cbranch_vccz f_zr1
    buffer_load_dwordx4 v[28:31], v3, s[12:15], s72 offen offset:1024 sc1
f_zr1:
    v_or3_b32 v248, v48, v50, v52
    v_or_b32 v248, v248, v54
    v_and_b32 v248, s54, v248
    v_cmp_ne_u32 vcc, 0, v248
    s_cbranch_vccz f_zr2
    buffer_load_dwordx4 v[32:35], v3, s[12:15], s72 offen offset:2048 sc1
f_zr2:
    v_or3_b32 v248, v49, v51, v53
    v_or_b32 v248, v248, v55
    v_and_b32 v248, s54, v248
    v_cmp_ne_u32 vcc, 0, v248
    s_cbranch_vccz f_zr3
    buffer_load_dwordx4 v[36:39], v3, s[12:15], s72 offen offset:3072 sc1
f_zr3:
    s_waitcnt vmcnt(0)
    s_add_u32 s83, s83, 1
    s_cmp_lt_u32 s83, 0x40000
    s_cbranch_scc1 f_zc
    s_branch f_zx
f_r0:
    buffer_load_dwordx4 v3, s[8:11], s18 offen offset:0 lds
    buffer_load_dwordx4 v3, s[8:11], s18 offen offset:1024 lds
    s_branch f_nr
f_str:
    s_and_b32 s42, s83, 31
    s_cmp_lg_u32 s42, 24
    s_cbranch_scc1 f_sb1
    v_add_u32 v84, 160768, v3
    s_mov_b64 exec, 0xff
    ds_read_b128 v[80:83], v84
    s_waitcnt lgkmcnt(0)
    buffer_store_dwordx4 v[80:83], v3, s[12:15], s63 offen sc1
    s_mov_b64 exec, -1
f_sb1:
    s_cmp_eq_u32 s42, 31
    s_cselect_b32 s42, 32768, 0
    s_add_u32 s42, s42, s71
    s_mov_b32 exec_lo, 0x000f000f
    s_mov_b32 exec_hi, 0x000f000f
    buffer_load_dwordx4 v[24:27], v7, s[12:15], s42 offen sc1
    s_add_u32 s83, s83, 1
    s_cmp_lt_u32 s83, 0x40000
    s_cbranch_scc1 f_st
    s_waitcnt vmcnt(0)
    s_mov_b64 exec, -1
    s_branch f_stx
f_pr:
    s_sleep 6
    v_mov_b32 v196, v8
    v_mov_b32 v197, v9
    v_mov_b32 v198, v10
    v_mov_b32 v199, v11
    s_mov_b64 exec, 0xf0ff
    buffer_load_dwordx4 v[236:239], v17, s[12:15], s77 offen sc1
    s_mov_b64 exec, s[52:53]
    buffer_load_dwordx4 v[196:199], v3, s[12:15], s76 offen sc1
    s_mov_b64 exec, -1
    buffer_load_dwordx4 v[192:195], v3, s[12:15], s65 offen sc1
    buffer_load_dwordx4 v[184:187], v3, s[12:15], s64 offen offset:0 sc1
    buffer_load_dwordx4 v[188:191], v3, s[12:15], s64 offen offset:1024 sc1
    s_waitcnt vmcnt(0)
    s_add_u32 s83, s83, 1
    s_cmp_lt_u32 s83, 0x40000
    s_cbranch_scc1 f_pv
    s_waitcnt vmcnt(0)
    s_branch f_pw
f_ps:
    s_sub_u32 s45, 5, s42
    v_ldexp_f32 v196, v196, s45
    v_ldexp_f32 v197, v197, s45
    v_ldexp_f32 v198, v198, s45
    v_ldexp_f32 v199, v199, s45
    v_and_b32 v248, 0x3f0, v235
    v_bfe_u32 v249, v235, 10, 1
    v_lshl_add_u32 v248, v249, 11, v248
    v_bfe_u32 v249, v235, 3, 1
    v_lshl_add_u32 v248, v249, 10, v248
    v_and_b32 v249, 6, v235
    v_lshl_add_u32 v248, v249, 1, v248
    v_cvt_f16_f32 v196, v196
    ds_write_b32 v248, v196 offset:0
    v_cvt_f16_f32 v197, v197
    ds_write_b32 v248, v197 offset:16
    v_cvt_f16_f32 v198, v198
    ds_write_b32 v248, v198 offset:32
    v_cvt_f16_f32 v199, v199
    ds_write_b32 v248, v199 offset:48
    s_branch f_pvx
f_qr:
    s_sleep 6
    buffer_load_dwordx4 v[184:187], v3, s[12:15], s64 offen offset:0 sc1
    buffer_load_dwordx4 v[188:191], v3, s[12:15], s64 offen offset:1024 sc1
    s_add_u32 s83, s83, 1
    s_cmp_lt_u32 s83, 0x40000
    s_cbranch_scc1 f_qv
    s_waitcnt vmcnt(0)
    s_branch f_pvx
f_go:
    s_lshl_b32 s41, s34, 7
    s_add_u32 s41, s41, 16842752
    v_mov_b32 v56, s32
    v_mov_b32 v57, s33
    s_mov_b64 exec, 0xff
    buffer_store_dwordx4 v[56:59], v3, s[12:15], s41 offen sc1
    s_mov_b64 exec, -1
    s_branch f_ngo
f_slow2:
    v_cvt_pk_bf16_f32 v40, v152, v153
    v_lshlrev_b32 v152, 16, v40
    v_and_b32 v153, 0xffff0000, v40
    v_cvt_pk_bf16_f32 v40, v154, v155
    v_lshlrev_b32 v154, 16, v40
    v_and_b32 v155, 0xffff0000, v40
    v_cvt_pk_bf16_f32 v40, v156, v157
    v_lshlrev_b32 v156, 16, v40
    v_and_b32 v157, 0xffff0000, v40
    v_cvt_pk_bf16_f32 v40, v158, v159
    v_lshlrev_b32 v158, 16, v40
    v_and_b32 v159, 0xffff0000, v40
    v_cvt_pk_bf16_f32 v40, v160, v161
    v_lshlrev_b32 v160, 16, v40
    v_and_b32 v161, 0xffff0000, v40
    v_cvt_pk_bf16_f32 v40, v162, v163
    v_lshlrev_b32 v162, 16, v40
    v_and_b32 v163, 0xffff0000, v40
    v_cvt_pk_bf16_f32 v40, v164, v165
    v_lshlrev_b32 v164, 16, v40
    v_and_b32 v165, 0xffff0000, v40
    v_cvt_pk_bf16_f32 v40, v166, v167
    v_lshlrev_b32 v166, 16, v40
    v_and_b32 v167, 0xffff0000, v40
    v_pk_add_f32 v[40:41], v[152:153], v[154:155]
    v_pk_add_f32 v[40:41], v[40:41], v[156:157]
    v_pk_add_f32 v[40:41], v[40:41], v[158:159]
    v_pk_add_f32 v[40:41], v[40:41], v[160:161]
    v_pk_add_f32 v[40:41], v[40:41], v[162:163]
    v_pk_add_f32 v[40:41], v[40:41], v[164:165]
    v_pk_add_f32 v[40:41], v[40:41], v[166:167]
    v_cvt_pk_bf16_f32 v48, v168, v169
    v_lshlrev_b32 v168, 16, v48
    v_and_b32 v169, 0xffff0000, v48
    v_cvt_pk_bf16_f32 v48, v170, v171
    v_lshlrev_b32 v170, 16, v48
    v_and_b32 v171, 0xffff0000, v48
    v_cvt_pk_bf16_f32 v48, v172, v173
    v_lshlrev_b32 v172, 16, v48
    v_and_b32 v173, 0xffff0000, v48
    v_cvt_pk_bf16_f32 v48, v174, v175
    v_lshlrev_b32 v174, 16, v48
    v_and_b32 v175, 0xffff0000, v48
    v_cvt_pk_bf16_f32 v48, v176, v177
    v_lshlrev_b32 v176, 16, v48
    v_and_b32 v177, 0xffff0000, v48
    v_cvt_pk_bf16_f32 v48, v178, v179
    v_lshlrev_b32 v178, 16, v48
    v_and_b32 v179, 0xffff0000, v48
    v_cvt_pk_bf16_f32 v48, v180, v181
    v_lshlrev_b32 v180, 16, v48
    v_and_b32 v181, 0xffff0000, v48
    v_cvt_pk_bf16_f32 v48, v182, v183
    v_lshlrev_b32 v182, 16, v48
    v_and_b32 v183, 0xffff0000, v48
    v_pk_add_f32 v[48:49], v[168:169], v[170:171]
    v_pk_add_f32 v[48:49], v[48:49], v[172:173]
    v_pk_add_f32 v[48:49], v[48:49], v[174:175]
    v_pk_add_f32 v[48:49], v[48:49], v[176:177]
    v_pk_add_f32 v[48:49], v[48:49], v[178:179]
    v_pk_add_f32 v[48:49], v[48:49], v[180:181]
    v_pk_add_f32 v[48:49], v[48:49], v[182:183]
    v_add_f32 v24, v40, v41
    v_add_f32 v28, v48, v49
    s_nop 1
    v_permlane32_swap_b32 v24, v28
    v_add_f32 v24, v24, v28
    s_nop 1
    v_add_f32_dpp v24, v24, v24 row_ror:8 row_mask:0xf bank_mask:0xf
    s_nop 1
    v_add_f32_dpp v24, v24, v24 row_ror:4 row_mask:0xf bank_mask:0xf
    s_nop 1
    v_add_f32_dpp v24, v24, v24 row_ror:2 row_mask:0xf bank_mask:0xf
    s_nop 1
    v_add_f32_dpp v24, v24, v24 row_ror:1 row_mask:0xf bank_mask:0xf
    s_nop 1
    v_add_f32_dpp v24, v24, v24 row_bcast:15 row_mask:0xa bank_mask:0xf
    v_mul_f32 v27, 0x3a800000, v24
    v_cvt_pk_bf16_f32 v24, v27, v27
    v_lshlrev_b32 v24, 16, v24
    v_sub_f32 v27, v27, v24
    v_readlane_b32 s56, v24, 31
    v_readlane_b32 s58, v24, 63
    s_nop 0
    v_pk_add_f32 v[56:57], v[152:153], s[56:57] op_sel:[0,0] op_sel_hi:[1,0] neg_lo:[0,1] neg_hi:[0,1]
    v_pk_add_f32 v[58:59], v[154:155], s[56:57] op_sel:[0,0] op_sel_hi:[1,0] neg_lo:[0,1] neg_hi:[0,1]
    v_pk_add_f32 v[60:61], v[156:157], s[56:57] op_sel:[0,0] op_sel_hi:[1,0] neg_lo:[0,1] neg_hi:[0,1]
    v_pk_add_f32 v[62:63], v[158:159], s[56:57] op_sel:[0,0] op_sel_hi:[1,0] neg_lo:[0,1] neg_hi:[0,1]
    v_pk_add_f32 v[64:65], v[160:161], s[56:57] op_sel:[0,0] op_sel_hi:[1,0] neg_lo:[0,1] neg_hi:[0,1]
    v_pk_add_f32 v[66:67], v[162:163], s[56:57] op_sel:[0,0] op_sel_hi:[1,0] neg_lo:[0,1] neg_hi:[0,1]
    v_pk_add_f32 v[68:69], v[164:165], s[56:57] op_sel:[0,0] op_sel_hi:[1,0] neg_lo:[0,1] neg_hi:[0,1]
    v_pk_add_f32 v[70:71], v[166:167], s[56:57] op_sel:[0,0] op_sel_hi:[1,0] neg_lo:[0,1] neg_hi:[0,1]
    v_pk_add_f32 v[72:73], v[168:169], s[58:59] op_sel:[0,0] op_sel_hi:[1,0] neg_lo:[0,1] neg_hi:[0,1]
    v_pk_add_f32 v[74:75], v[170:171], s[58:59] op_sel:[0,0] op_sel_hi:[1,0] neg_lo:[0,1] neg_hi:[0,1]
    v_pk_add_f32 v[76:77], v[172:173], s[58:59] op_sel:[0,0] op_sel_hi:[1,0] neg_lo:[0,1] neg_hi:[0,1]
    v_pk_add_f32 v[78:79], v[174:175], s[58:59] op_sel:[0,0] op_sel_hi:[1,0] neg_lo:[0,1] neg_hi:[0,1]
    v_pk_add_f32 v[80:81], v[176:177], s[58:59] op_sel:[0,0] op_sel_hi:[1,0] neg_lo:[0,1] neg_hi:[0,1]
    v_pk_add_f32 v[82:83], v[178:179], s[58:59] op_sel:[0,0] op_sel_hi:[1,0] neg_lo:[0,1] neg_hi:[0,1]
    v_pk_add_f32 v[84:85], v[180:181], s[58:59] op_sel:[0,0] op_sel_hi:[1,0] neg_lo:[0,1] neg_hi:[0,1]
    v_pk_add_f32 v[86:87], v[182:183], s[58:59] op_sel:[0,0] op_sel_hi:[1,0] neg_lo:[0,1] neg_hi:[0,1]
    v_mov_b32 v31, v30
    v_pk_mul_f32 v[42:43], v[70:71], v[70:71]
    v_pk_mul_f32 v[44:45], v[70:71], v[230:231]
    v_pk_mul_f32 v[50:51], v[86:87], v[86:87]
    v_pk_mul_f32 v[52:53], v[86:87], v[246:247]
    v_pk_fma_f32 v[42:43], v[68:69], v[68:69], v[42:43]
    v_pk_fma_f32 v[44:45], v[68:69], v[228:229], v[44:45]
    v_pk_fma_f32 v[50:51], v[84:85], v[84:85], v[50:51]
    v_pk_fma_f32 v[52:53], v[84:85], v[244:245], v[52:53]
    v_pk_fma_f32 v[42:43], v[66:67], v[66:67], v[42:43]
    v_pk_fma_f32 v[44:45], v[66:67], v[226:227], v[44:45]
    v_pk_fma_f32 v[50:51], v[82:83], v[82:83], v[50:51]
    v_pk_fma_f32 v[52:53], v[82:83], v[242:243], v[52:53]
    v_pk_fma_f32 v[42:43], v[64:65], v[64:65], v[42:43]
    v_pk_fma_f32 v[44:45], v[64:65], v[224:225], v[44:45]
    v_pk_fma_f32 v[50:51], v[80:81], v[80:81], v[50:51]
    v_pk_fma_f32 v[52:53], v[80:81], v[240:241], v[52:53]
    v_pk_fma_f32 v[42:43], v[62:63], v[62:63], v[42:43]
    v_pk_fma_f32 v[44:45], v[62:63], v[222:223], v[44:45]
    v_pk_fma_f32 v[50:51], v[78:79], v[78:79], v[50:51]
    v_pk_fma_f32 v[52:53], v[78:79], v[238:239], v[52:53]
    v_pk_fma_f32 v[42:43], v[60:61], v[60:61], v[42:43]
    v_pk_fma_f32 v[44:45], v[60:61], v[220:221], v[44:45]
    v_pk_fma_f32 v[50:51], v[76:77], v[76:77], v[50:51]
    v_pk_fma_f32 v[52:53], v[76:77], v[236:237], v[52:53]
    v_pk_fma_f32 v[42:43], v[58:59], v[58:59], v[42:43]
    v_pk_fma_f32 v[44:45], v[58:59], v[218:219], v[44:45]
    v_pk_fma_f32 v[50:51], v[74:75], v[74:75], v[50:51]
    v_pk_fma_f32 v[52:53], v[74:75], v[234:235], v[52:53]
    v_pk_fma_f32 v[42:43], v[56:57], v[56:57], v[42:43]
    v_pk_fma_f32 v[44:45], v[56:57], v[216:217], v[44:45]
    v_pk_fma_f32 v[50:51], v[72:73], v[72:73], v[50:51]
    v_pk_fma_f32 v[52:53], v[72:73], v[232:233], v[52:53]
    v_add_f32 v25, v42, v43
    v_add_f32 v26, v44, v45
    v_add_f32 v29, v50, v51
    v_add_f32 v30, v52, v53
    s_nop 0
    v_permlane32_swap_b32 v25, v29
    v_permlane32_swap_b32 v26, v30
    v_add_f32 v25, v25, v29
    v_add_f32 v26, v26, v30
    s_nop 0
    v_add_f32_dpp v25, v25, v25 row_ror:8 row_mask:0xf bank_mask:0xf
    v_add_f32_dpp v26, v26, v26 row_ror:8 row_mask:0xf bank_mask:0xf
    s_nop 0
    v_add_f32_dpp v25, v25, v25 row_ror:4 row_mask:0xf bank_mask:0xf
    v_add_f32_dpp v26, v26, v26 row_ror:4 row_mask:0xf bank_mask:0xf
    s_nop 0
    v_add_f32_dpp v25, v25, v25 row_ror:2 row_mask:0xf bank_mask:0xf
    v_add_f32_dpp v26, v26, v26 row_ror:2 row_mask:0xf bank_mask:0xf
    s_nop 0
    v_add_f32_dpp v25, v25, v25 row_ror:1 row_mask:0xf bank_mask:0xf
    v_add_f32_dpp v26, v26, v26 row_ror:1 row_mask:0xf bank_mask:0xf
    s_nop 0
    v_add_f32_dpp v25, v25, v25 row_bcast:15 row_mask:0xa bank_mask:0xf
    v_add_f32_dpp v26, v26, v26 row_bcast:15 row_mask:0xa bank_mask:0xf
    v_mul_f32 v25, 0x3a800000, v25
    v_fma_f32 v25, -v27, v27, v25
    v_max_f32 v25, 0, v25
    v_mov_b32 v30, v31
    s_branch f_var2
f_slowvar:
    v_lshlrev_b32 v118, 16, v117
    s_nop 0
    v_readlane_b32 s44, v118, 31
    v_readlane_b32 s46, v118, 63
    v_lshlrev_b32 v120, 16, v64
    v_and_b32 v121, 0xffff0000, v64
    v_pk_add_f32 v[120:121], v[120:121], s[44:45] op_sel_hi:[1,0]
    v_pk_mul_f32 v[122:123], v[120:121], v[120:121]
    v_lshlrev_b32 v120, 16, v65
    v_and_b32 v121, 0xffff0000, v65
    v_pk_add_f32 v[120:121], v[120:121], s[44:45] op_sel_hi:[1,0]
    v_pk_fma_f32 v[122:123], v[120:121], v[120:121], v[122:123]
    v_lshlrev_b32 v120, 16, v66
    v_and_b32 v121, 0xffff0000, v66
    v_pk_add_f32 v[120:121], v[120:121], s[44:45] op_sel_hi:[1,0]
    v_pk_fma_f32 v[122:123], v[120:121], v[120:121], v[122:123]
    v_lshlrev_b32 v120, 16, v67
    v_and_b32 v121, 0xffff0000, v67
    v_pk_add_f32 v[120:121], v[120:121], s[44:45] op_sel_hi:[1,0]
    v_pk_fma_f32 v[122:123], v[120:121], v[120:121], v[122:123]
    v_lshlrev_b32 v120, 16, v68
    v_and_b32 v121, 0xffff0000, v68
    v_pk_add_f32 v[120:121], v[120:121], s[44:45] op_sel_hi:[1,0]
    v_pk_fma_f32 v[122:123], v[120:121], v[120:121], v[122:123]
    v_lshlrev_b32 v120, 16, v69
    v_and_b32 v121, 0xffff0000, v69
    v_pk_add_f32 v[120:121], v[120:121], s[44:45] op_sel_hi:[1,0]
    v_pk_fma_f32 v[122:123], v[120:121], v[120:121], v[122:123]
    v_lshlrev_b32 v120, 16, v70
    v_and_b32 v121, 0xffff0000, v70
    v_pk_add_f32 v[120:121], v[120:121], s[44:45] op_sel_hi:[1,0]
    v_pk_fma_f32 v[122:123], v[120:121], v[120:121], v[122:123]
    v_lshlrev_b32 v120, 16, v71
    v_and_b32 v121, 0xffff0000, v71
    v_pk_add_f32 v[120:121], v[120:121], s[44:45] op_sel_hi:[1,0]
    v_pk_fma_f32 v[122:123], v[120:121], v[120:121], v[122:123]
    v_add_f32 v110, v122, v123
    v_lshlrev_b32 v120, 16, v72
    v_and_b32 v121, 0xffff0000, v72
    v_pk_add_f32 v[120:121], v[120:121], s[46:47] op_sel_hi:[1,0]
    v_pk_mul_f32 v[122:123], v[120:121], v[120:121]
    v_lshlrev_b32 v120, 16, v73
    v_and_b32 v121, 0xffff0000, v73
    v_pk_add_f32 v[120:121], v[120:121], s[46:47] op_sel_hi:[1,0]
    v_pk_fma_f32 v[122:123], v[120:121], v[120:121], v[122:123]
    v_lshlrev_b32 v120, 16, v74
    v_and_b32 v121, 0xffff0000, v74
    v_pk_add_f32 v[120:121], v[120:121], s[46:47] op_sel_hi:[1,0]
    v_pk_fma_f32 v[122:123], v[120:121], v[120:121], v[122:123]
    v_lshlrev_b32 v120, 16, v75
    v_and_b32 v121, 0xffff0000, v75
    v_pk_add_f32 v[120:121], v[120:121], s[46:47] op_sel_hi:[1,0]
    v_pk_fma_f32 v[122:123], v[120:121], v[120:121], v[122:123]
    v_lshlrev_b32 v120, 16, v76
    v_and_b32 v121, 0xffff0000, v76
    v_pk_add_f32 v[120:121], v[120:121], s[46:47] op_sel_hi:[1,0]
    v_pk_fma_f32 v[122:123], v[120:121], v[120:121], v[122:123]
    v_lshlrev_b32 v120, 16, v77
    v_and_b32 v121, 0xffff0000, v77
    v_pk_add_f32 v[120:121], v[120:121], s[46:47] op_sel_hi:[1,0]
    v_pk_fma_f32 v[122:123], v[120:121], v[120:121], v[122:123]
    v_lshlrev_b32 v120, 16, v78
    v_and_b32 v121, 0xffff0000, v78
    v_pk_add_f32 v[120:121], v[120:121], s[46:47] op_sel_hi:[1,0]
    v_pk_fma_f32 v[122:123], v[120:121], v[120:121], v[122:123]
    v_lshlrev_b32 v120, 16, v79
    v_and_b32 v121, 0xffff0000, v79
    v_pk_add_f32 v[120:121], v[120:121], s[46:47] op_sel_hi:[1,0]
    v_pk_fma_f32 v[122:123], v[120:121], v[120:121], v[122:123]
    v_add_f32 v111, v122, v123
    v_add_f32 v118, v118, v108
    s_nop 0
    v_permlane32_swap_b32 v110, v111
    v_add_f32 v110, v110, v111
    s_nop 1
    v_add_f32_dpp v110, v110, v110 row_ror:8 row_mask:0xf bank_mask:0xf
    s_nop 1
    v_add_f32_dpp v110, v110, v110 row_ror:4 row_mask:0xf bank_mask:0xf
    s_nop 1
    v_add_f32_dpp v110, v110, v110 row_ror:2 row_mask:0xf bank_mask:0xf
    s_nop 1
    v_add_f32_dpp v110, v110, v110 row_ror:1 row_mask:0xf bank_mask:0xf
    s_nop 1
    v_add_f32_dpp v110, v110, v110 row_bcast:15 row_mask:0xa bank_mask:0xf
    v_mul_f32 v110, s5, v110
    v_fma_f32 v110, -v118, v118, v110
    v_max_f32 v110, 0, v110
    s_branch f_var
f_sp:
    s_setprio 3
    ds_read_b128 v[56:59], v3 offset:0
    ds_read_b128 v[60:63], v3 offset:1024
    ds_read_b128 v[64:67], v3 offset:2048
    ds_read_b128 v[68:71], v3 offset:3072
    v_and_b32 v12, 31, v0
    v_lshlrev_b32 v12, 2, v12
    v_and_b32 v17, 32, v0
    v_lshl_add_u32 v12, v17, 4, v12
    v_sub_u32 v20, 4096, v12
    v_add_u32 v12, 4096, v12
    v_add_u32 v17, 128, v12
    v_add_u32 v21, 128, v20
    s_waitcnt lgkmcnt(3)
    v_pk_fma_f16 v40, v24, v248, v56 op_sel:[0,0,0] op_sel_hi:[1,0,1]
    v_pk_fma_f16 v41, v25, v248, v57 op_sel:[0,1,0] op_sel_hi:[1,1,1]
    v_pk_fma_f16 v42, v26, v249, v58 op_sel:[0,0,0] op_sel_hi:[1,0,1]
    v_pk_fma_f16 v43, v27, v249, v59 op_sel:[0,1,0] op_sel_hi:[1,1,1]
    ds_write2st64_b32 v12, v40, v42 offset0:0 offset1:1
    ds_write2st64_b32 v17, v41, v43 offset0:0 offset1:1
    s_waitcnt lgkmcnt(4)
    v_pk_fma_f16 v44, v28, v250, v60 op_sel:[0,0,0] op_sel_hi:[1,0,1]
    v_pk_fma_f16 v45, v29, v250, v61 op_sel:[0,1,0] op_sel_hi:[1,1,1]
    v_pk_fma_f16 v46, v30, v251, v62 op_sel:[0,0,0] op_sel_hi:[1,0,1]
    v_pk_fma_f16 v47, v31, v251, v63 op_sel:[0,1,0] op_sel_hi:[1,1,1]
    ds_write2st64_b32 v12, v44, v46 offset0:4 offset1:5
    ds_write2st64_b32 v17, v45, v47 offset0:4 offset1:5
    s_waitcnt lgkmcnt(5)
    v_pk_fma_f16 v48, v32, v252, v64 op_sel:[0,0,0] op_sel_hi:[1,0,1]
    v_pk_fma_f16 v49, v33, v252, v65 op_sel:[0,1,0] op_sel_hi:[1,1,1]
    v_pk_fma_f16 v50, v34, v253, v66 op_sel:[0,0,0] op_sel_hi:[1,0,1]
    v_pk_fma_f16 v51, v35, v253, v67 op_sel:[0,1,0] op_sel_hi:[1,1,1]
    ds_write2st64_b32 v12, v48, v50 offset0:8 offset1:9
    ds_write2st64_b32 v17, v49, v51 offset0:8 offset1:9
    s_waitcnt lgkmcnt(6)
    v_pk_fma_f16 v52, v36, v254, v68 op_sel:[0,0,0] op_sel_hi:[1,0,1]
    v_pk_fma_f16 v53, v37, v254, v69 op_sel:[0,1,0] op_sel_hi:[1,1,1]
    v_pk_fma_f16 v54, v38, v255, v70 op_sel:[0,0,0] op_sel_hi:[1,0,1]
    v_pk_fma_f16 v55, v39, v255, v71 op_sel:[0,1,0] op_sel_hi:[1,1,1]
    ds_write2st64_b32 v12, v52, v54 offset0:12 offset1:13
    ds_write2st64_b32 v17, v53, v55 offset0:12 offset1:13
    s_mov_b64 exec, 1
    ds_write_b32 v12, v40 offset:4096
    s_mov_b64 exec, -1
    ds_read2st64_b32 v[72:73], v20 offset0:16 offset1:15
    ds_read2st64_b32 v[74:75], v21 offset0:15 offset1:14
    ds_read2st64_b32 v[76:77], v20 offset0:12 offset1:11
    ds_read2st64_b32 v[78:79], v21 offset0:11 offset1:10
    ds_read2st64_b32 v[80:81], v20 offset0:8 offset1:7
    ds_read2st64_b32 v[82:83], v21 offset0:7 offset1:6
    ds_read2st64_b32 v[84:85], v20 offset0:4 offset1:3
    ds_read2st64_b32 v[86:87], v21 offset0:3 offset1:2
    s_waitcnt lgkmcnt(6)
    v_pk_add_f16 v40, v40, v72
    v_pk_add_f16 v41, v41, v74
    v_pk_add_f16 v42, v42, v73
    v_pk_add_f16 v43, v43, v75
    s_waitcnt lgkmcnt(4)
    v_pk_add_f16 v44, v44, v76
    v_pk_add_f16 v45, v45, v78
    v_pk_add_f16 v46, v46, v77
    v_pk_add_f16 v47, v47, v79
    s_waitcnt lgkmcnt(2)
    v_pk_add_f16 v48, v48, v80
    v_pk_add_f16 v49, v49, v82
    v_pk_add_f16 v50, v50, v81
    v_pk_add_f16 v51, v51, v83
    s_waitcnt lgkmcnt(0)
    v_pk_add_f16 v52, v52, v84
    v_pk_add_f16 v53, v53, v86
    v_pk_add_f16 v54, v54, v85
    v_pk_add_f16 v55, v55, v87
    v_mfma_f32_32x32x16_f16 v[56:71], v[40:43], v[88:91], 0
    v_mfma_f32_32x32x16_f16 v[72:87], v[40:43], v[104:107], 0
    v_mfma_f32_32x32x16_f16 v[56:71], v[44:47], v[92:95], v[56:71]
    v_mfma_f32_32x32x16_f16 v[72:87], v[44:47], v[108:111], v[72:87]
    s_branch f_st1
f_sp2:
    s_nop 9
    v_pk_mul_f32 v[24:25], v[56:57], v[120:121]
    v_pk_mul_f32 v[28:29], v[72:73], v[120:121]
    v_pk_mul_f32 v[26:27], v[58:59], v[122:123]
    v_pk_mul_f32 v[30:31], v[74:75], v[122:123]
    v_pk_fma_f32 v[24:25], v[72:73], v[136:137], v[24:25]
    v_pk_fma_f32 v[28:29], v[56:57], v[136:137], v[28:29] neg_lo:[1,0,0] neg_hi:[1,0,0]
    v_pk_fma_f32 v[26:27], v[74:75], v[138:139], v[26:27]
    v_pk_fma_f32 v[30:31], v[58:59], v[138:139], v[30:31] neg_lo:[1,0,0] neg_hi:[1,0,0]
    v_cvt_pk_f16_f32 v40, v24, v28
    v_cvt_pk_f16_f32 v41, v25, v29
    v_cvt_pk_f16_f32 v42, v26, v30
    v_cvt_pk_f16_f32 v43, v27, v31
    v_pk_mul_f32 v[32:33], v[60:61], v[124:125]
    v_pk_mul_f32 v[36:37], v[76:77], v[124:125]
    v_pk_mul_f32 v[34:35], v[62:63], v[126:127]
    v_pk_mul_f32 v[38:39], v[78:79], v[126:127]
    v_pk_fma_f32 v[32:33], v[76:77], v[140:141], v[32:33]
    v_pk_fma_f32 v[36:37], v[60:61], v[140:141], v[36:37] neg_lo:[1,0,0] neg_hi:[1,0,0]
    v_pk_fma_f32 v[34:35], v[78:79], v[142:143], v[34:35]
    v_pk_fma_f32 v[38:39], v[62:63], v[142:143], v[38:39] neg_lo:[1,0,0] neg_hi:[1,0,0]
    v_cvt_pk_f16_f32 v44, v32, v36
    v_cvt_pk_f16_f32 v45, v33, v37
    v_cvt_pk_f16_f32 v46, v34, v38
    v_cvt_pk_f16_f32 v47, v35, v39
    v_mfma_f32_32x32x16_f16 v[216:231], v[40:43], v[88:91], 0
    v_mfma_f32_32x32x16_f16 v[232:247], v[40:43], v[104:107], 0
    v_pk_mul_f32 v[24:25], v[64:65], v[128:129]
    v_pk_mul_f32 v[28:29], v[80:81], v[128:129]
    v_pk_mul_f32 v[26:27], v[66:67], v[130:131]
    v_pk_mul_f32 v[30:31], v[82:83], v[130:131]
    v_pk_fma_f32 v[24:25], v[80:81], v[144:145], v[24:25]
    v_pk_fma_f32 v[28:29], v[64:65], v[144:145], v[28:29] neg_lo:[1,0,0] neg_hi:[1,0,0]
    v_pk_fma_f32 v[26:27], v[82:83], v[146:147], v[26:27]
    v_pk_fma_f32 v[30:31], v[66:67], v[146:147], v[30:31] neg_lo:[1,0,0] neg_hi:[1,0,0]
    v_cvt_pk_f16_f32 v48, v24, v28
    v_cvt_pk_f16_f32 v49, v25, v29
    v_cvt_pk_f16_f32 v50, v26, v30
    v_cvt_pk_f16_f32 v51, v27, v31
    v_mfma_f32_32x32x16_f16 v[216:231], v[44:47], v[92:95], v[216:231]
    v_mfma_f32_32x32x16_f16 v[232:247], v[44:47], v[108:111], v[232:247]
    v_pk_mul_f32 v[32:33], v[68:69], v[132:133]
    v_pk_mul_f32 v[36:37], v[84:85], v[132:133]
    v_pk_mul_f32 v[34:35], v[70:71], v[134:135]
    v_pk_mul_f32 v[38:39], v[86:87], v[134:135]
    v_pk_fma_f32 v[32:33], v[84:85], v[148:149], v[32:33]
    v_pk_fma_f32 v[36:37], v[68:69], v[148:149], v[36:37] neg_lo:[1,0,0] neg_hi:[1,0,0]
    v_pk_fma_f32 v[34:35], v[86:87], v[150:151], v[34:35]
    v_pk_fma_f32 v[38:39], v[70:71], v[150:151], v[38:39] neg_lo:[1,0,0] neg_hi:[1,0,0]
    v_cvt_pk_f16_f32 v52, v32, v36
    v_cvt_pk_f16_f32 v53, v33, v37
    v_cvt_pk_f16_f32 v54, v34, v38
    v_cvt_pk_f16_f32 v55, v35, v39
    v_mfma_f32_32x32x16_f16 v[216:231], v[48:51], v[96:99], v[216:231]
    v_mfma_f32_32x32x16_f16 v[232:247], v[48:51], v[112:115], v[232:247]
    v_mfma_f32_32x32x16_f16 v[232:247], v[52:55], v[116:119], v[232:247]
    v_mfma_f32_32x32x16_f16 v[216:231], v[52:55], v[100:103], v[216:231]
    s_nop 10
    ds_bpermute_b32 v12, v19, v232
    s_waitcnt lgkmcnt(1)
    v_pk_fma_f32 v[152:153], v[184:185], v[216:217], v[152:153]
    v_pk_fma_f32 v[154:155], v[186:187], v[218:219], v[154:155]
    v_pk_fma_f32 v[156:157], v[188:189], v[220:221], v[156:157]
    v_pk_fma_f32 v[158:159], v[190:191], v[222:223], v[158:159]
    v_pk_fma_f32 v[160:161], v[192:193], v[224:225], v[160:161]
    v_pk_fma_f32 v[162:163], v[194:195], v[226:227], v[162:163]
    v_pk_fma_f32 v[164:165], v[196:197], v[228:229], v[164:165]
    v_pk_fma_f32 v[166:167], v[198:199], v[230:231], v[166:167]
    v_pk_fma_f32 v[170:171], v[202:203], v[234:235], v[170:171]
    v_pk_fma_f32 v[172:173], v[204:205], v[236:237], v[172:173]
    v_pk_fma_f32 v[174:175], v[206:207], v[238:239], v[174:175]
    v_pk_fma_f32 v[176:177], v[208:209], v[240:241], v[176:177]
    v_pk_fma_f32 v[178:179], v[210:211], v[242:243], v[178:179]
    v_pk_fma_f32 v[180:181], v[212:213], v[244:245], v[180:181]
    v_pk_fma_f32 v[182:183], v[214:215], v[246:247], v[182:183]
    v_fmac_f32 v169, v201, v233
    s_waitcnt lgkmcnt(0)
    v_fmac_f32 v168, v200, v12
    ds_read_b128 v[216:219], v3 offset:28672
    ds_read_b128 v[220:223], v3 offset:29696
    ds_read_b128 v[224:227], v3 offset:30720
    ds_read_b128 v[228:231], v3 offset:31744
    ds_read_b128 v[232:235], v3 offset:32768
    ds_read_b128 v[236:239], v3 offset:33792
    ds_read_b128 v[240:243], v3 offset:34816
    ds_read_b128 v[244:247], v3 offset:35840
    s_waitcnt lgkmcnt(0)
    s_setprio 2
    s_branch f_join
k_done:
    s_endpgm
code_end:
.p2align 8
.type tables,@object
tables:
.long 0x3c00,0x3c00,0x3c00,0x3c00,0x3c008000,0x3c008000,0x3c008000,0x3c008000
.long 0x3c00,0x361f3b64,0x39a839a8,0x3b64361f,0x3c008000,0x3b64b61f,0x39a8b9a8,0x361fbb64
.long 0x3c00,0x39a839a8,0x3c000000,0x39a8b9a8,0x3c008000,0x39a8b9a8,0xbc00,0xb9a8b9a8
.long 0x3c00,0x3b64361f,0x39a8b9a8,0xb61fbb64,0x3c008000,0x361fbb64,0xb9a8b9a8,0xbb64361f
.long 0x3c00,0x3c000000,0xbc00,0xbc008000,0x3c008000,0xbc00,0xbc008000,0x80003c00
.long 0x3c00,0x3b64b61f,0xb9a8b9a8,0xb61f3b64,0x3c008000,0xb61fbb64,0xb9a839a8,0x3b64361f
.long 0x3c00,0x39a8b9a8,0xbc008000,0x39a839a8,0x3c008000,0xb9a8b9a8,0x80003c00,0x39a8b9a8
.long 0x3c00,0x361fbb64,0xb9a839a8,0x3b64b61f,0x3c008000,0xbb64b61f,0x39a839a8,0xb61fbb64
.long 0x3c00,0x3c00,0x3c00,0x3c00,0x3c008000,0x3c008000,0x3c008000,0x3c008000
.long 0x39a8b9a8,0x361fbb64,0x3c000000,0x3b64b61f,0xb9a8b9a8,0xbb64b61f,0xbc00,0xb61fbb64
.long 0xbc008000,0xb9a839a8,0xbc00,0xb9a8b9a8,0x80003c00,0x39a839a8,0xbc008000,0xb9a839a8
.long 0x39a839a8,0x3b64b61f,0xbc008000,0xb61f3b64,0x39a8b9a8,0xb61fbb64,0x80003c00,0x3b64361f
.long 0xbc00,0xbc008000,0x3c00,0x3c000000,0xbc008000,0x80003c00,0x3c008000,0xbc00
.long 0xb9a839a8,0x3b64361f,0x3c000000,0xb61fbb64,0x39a839a8,0x361fbb64,0xbc00,0xbb64361f
.long 0x3c000000,0xb9a8b9a8,0xbc00,0xb9a839a8,0xbc00,0xb9a839a8,0xbc008000,0x39a839a8
.long 0xb9a8b9a8,0x361f3b64,0xbc008000,0x3b64361f,0xb9a839a8,0x3b64b61f,0x80003c00,0x361fbb64
.long 0x3c00,0x3c00,0x3c00,0x3c00,0x3c008000,0x3c008000,0x3c008000,0x3c008000
.long 0xbc00,0xb61fbb64,0xb9a8b9a8,0xbb64b61f,0xbc008000,0xbb64361f,0xb9a839a8,0xb61f3b64
.long 0x3c00,0x39a839a8,0x3c000000,0x39a8b9a8,0x3c008000,0x39a8b9a8,0xbc00,0xb9a8b9a8
.long 0xbc00,0xbb64b61f,0xb9a839a8,0x361f3b64,0xbc008000,0xb61f3b64,0x39a839a8,0x3b64b61f
.long 0x3c00,0x3c000000,0xbc00,0xbc008000,0x3c008000,0xbc00,0xbc008000,0x80003c00
.long 0xbc00,0xbb64361f,0x39a839a8,0x361fbb64,0xbc008000,0x361f3b64,0x39a8b9a8,0xbb64b61f
.long 0x3c00,0x39a8b9a8,0xbc008000,0x39a839a8,0x3c008000,0xb9a8b9a8,0x80003c00,0x39a8b9a8
.long 0xbc00,0xb61f3b64,0x39a8b9a8,0xbb64361f,0xbc008000,0x3b64361f,0xb9a8b9a8,0x361f3b64
.long 0x3c00,0x3c00,0x3c00,0x3c00,0x3c008000,0x3c008000,0x3c008000,0x3c008000
.long 0xb9a839a8,0xb61f3b64,0xbc008000,0xbb64361f,0x39a839a8,0x3b64361f,0x80003c00,0x361f3b64
.long 0xbc008000,0xb9a839a8,0xbc00,0xb9a8b9a8,0x80003c00,0x39a839a8,0xbc008000,0xb9a839a8
.long 0xb9a8b9a8,0xbb64361f,0x3c000000,0x361fbb64,0xb9a839a8,0x361f3b64,0xbc00,0xbb64b61f
.long 0xbc00,0xbc008000,0x3c00,0x3c000000,0xbc008000,0x80003c00,0x3c008000,0xbc00
.long 0x39a8b9a8,0xbb64b61f,0xbc008000,0x361f3b64,0xb9a8b9a8,0xb61f3b64,0x80003c00,0x3b64b61f
.long 0x3c000000,0xb9a8b9a8,0xbc00,0xb9a839a8,0xbc00,0xb9a839a8,0xbc008000,0x39a839a8
.long 0x39a839a8,0xb61fbb64,0x3c000000,0xbb64b61f,0x39a8b9a8,0xbb64361f,0xbc00,0xb61f3b64
.long 0x3c00,0xbc00,0x3c00,0xbc00,0x3c008000,0xbc008000,0x3c008000,0xbc008000
.long 0x3c00,0xb61fbb64,0x39a839a8,0xbb64b61f,0x3c008000,0xbb64361f,0x39a8b9a8,0xb61f3b64
.long 0x3c00,0xb9a8b9a8,0x3c000000,0xb9a839a8,0x3c008000,0xb9a839a8,0xbc00,0x39a839a8
.long 0x3c00,0xbb64b61f,0x39a8b9a8,0x361f3b64,0x3c008000,0xb61f3b64,0xb9a8b9a8,0x3b64b61f
.long 0x3c00,0xbc008000,0xbc00,0x3c000000,0x3c008000,0x80003c00,0xbc008000,0xbc00
.long 0x3c00,0xbb64361f,0xb9a8b9a8,0x361fbb64,0x3c008000,0x361f3b64,0xb9a839a8,0xbb64b61f
.long 0x3c00,0xb9a839a8,0xbc008000,0xb9a8b9a8,0x3c008000,0x39a839a8,0x80003c00,0xb9a839a8
.long 0x3c00,0xb61f3b64,0xb9a839a8,0xbb64361f,0x3c008000,0x3b64361f,0x39a839a8,0x361f3b64
.long 0x3c00,0xbc00,0x3c00,0xbc00,0x3c008000,0xbc008000,0x3c008000,0xbc008000
.long 0x39a8b9a8,0xb61f3b64,0x3c000000,0xbb64361f,0xb9a8b9a8,0x3b64361f,0xbc00,0x361f3b64
.long 0xbc008000,0x39a8b9a8,0xbc00,0x39a839a8,0x80003c00,0xb9a8b9a8,0xbc008000,0x39a8b9a8
.long 0x39a839a8,0xbb64361f,0xbc008000,0x361fbb64,0x39a8b9a8,0x361f3b64,0x80003c00,0xbb64b61f
.long 0xbc00,0x3c000000,0x3c00,0xbc008000,0xbc008000,0xbc00,0x3c008000,0x80003c00
.long 0xb9a839a8,0xbb64b61f,0x3c000000,0x361f3b64,0x39a839a8,0xb61f3b64,0xbc00,0x3b64b61f
.long 0x3c000000,0x39a839a8,0xbc00,0x39a8b9a8,0xbc00,0x39a8b9a8,0xbc008000,0xb9a8b9a8
.long 0xb9a8b9a8,0xb61fbb64,0xbc008000,0xbb64b61f,0xb9a839a8,0xbb64361f,0x80003c00,0xb61f3b64
.long 0x3c00,0xbc00,0x3c00,0xbc00,0x3c008000,0xbc008000,0x3c008000,0xbc008000
.long 0xbc00,0x361f3b64,0xb9a8b9a8,0x3b64361f,0xbc008000,0x3b64b61f,0xb9a839a8,0x361fbb64
.long 0x3c00,0xb9a8b9a8,0x3c000000,0xb9a839a8,0x3c008000,0xb9a839a8,0xbc00,0x39a839a8
.long 0xbc00,0x3b64361f,0xb9a839a8,0xb61fbb64,0xbc008000,0x361fbb64,0x39a839a8,0xbb64361f
.long 0x3c00,0xbc008000,0xbc00,0x3c000000,0x3c008000,0x80003c00,0xbc008000,0xbc00
.long 0xbc00,0x3b64b61f,0x39a839a8,0xb61f3b64,0xbc008000,0xb61fbb64,0x39a8b9a8,0x3b64361f
.long 0x3c00,0xb9a839a8,0xbc008000,0xb9a8b9a8,0x3c008000,0x39a839a8,0x80003c00,0xb9a839a8
.long 0xbc00,0x361fbb64,0x39a8b9a8,0x3b64b61f,0xbc008000,0xbb64b61f,0xb9a8b9a8,0xb61fbb64
.long 0x3c00,0xbc00,0x3c00,0xbc00,0x3c008000,0xbc008000,0x3c008000,0xbc008000
.long 0xb9a839a8,0x361fbb64,0xbc008000,0x3b64b61f,0x39a839a8,0xbb64b61f,0x80003c00,0xb61fbb64
.long 0xbc008000,0x39a8b9a8,0xbc00,0x39a839a8,0x80003c00,0xb9a8b9a8,0xbc008000,0x39a8b9a8
.long 0xb9a8b9a8,0x3b64b61f,0x3c000000,0xb61f3b64,0xb9a839a8,0xb61fbb64,0xbc00,0x3b64361f
.long 0xbc00,0x3c000000,0x3c00,0xbc008000,0xbc008000,0xbc00,0x3c008000,0x80003c00
.long 0x39a8b9a8,0x3b64361f,0xbc008000,0xb61fbb64,0xb9a8b9a8,0x361fbb64,0x80003c00,0xbb64361f
.long 0x3c000000,0x39a839a8,0xbc00,0x39a8b9a8,0xbc00,0x39a8b9a8,0xbc008000,0xb9a8b9a8
.long 0x39a839a8,0x361f3b64,0x3c000000,0x3b64361f,0x39a8b9a8,0x3b64b61f,0xbc00,0x361fbb64
.long 0x3c00,0x3c00,0x3c00,0x3c00,0x3c00,0xbc00,0x3c00,0xbc00
.long 0x3c00,0x3b64,0x39a8,0x361f,0x8000,0xb61f,0xb9a8,0xbb64
.long 0x3c00,0x39a8,0x0,0xb9a8,0x8000,0xb9a8,0xbc00,0xb9a8
.long 0x3c00,0x361f,0xb9a8,0xbb64,0x8000,0xbb64,0xb9a8,0x361f
.long 0x3c00,0x0,0xbc00,0x8000,0x8000,0xbc00,0x8000,0x3c00
.long 0x3c00,0xb61f,0xb9a8,0x3b64,0x8000,0xbb64,0x39a8,0x361f
.long 0x3c00,0xb9a8,0x8000,0x39a8,0x8000,0xb9a8,0x3c00,0xb9a8
.long 0x3c00,0xbb64,0x39a8,0xb61f,0x8000,0xb61f,0x39a8,0xbb64
.long 0x3c00,0x3c00,0x3c00,0x3c00,0x3c00,0xbc00,0x3c00,0xbc00
.long 0xb9a8,0xbb64,0x0,0xb61f,0xb9a8,0xb61f,0xbc00,0xbb64
.long 0x8000,0x39a8,0xbc00,0xb9a8,0x3c00,0x39a8,0x8000,0x39a8
.long 0x39a8,0xb61f,0x8000,0x3b64,0xb9a8,0xbb64,0x3c00,0x361f
.long 0xbc00,0x8000,0x3c00,0x0,0x8000,0x3c00,0x8000,0xbc00
.long 0x39a8,0x361f,0x0,0xbb64,0x39a8,0xbb64,0xbc00,0x361f
.long 0x0,0xb9a8,0xbc00,0x39a8,0xbc00,0x39a8,0x8000,0x39a8
.long 0xb9a8,0x3b64,0x8000,0x361f,0x39a8,0xb61f,0x3c00,0xbb64
.long 0x3c00,0x3c00,0x3c00,0x3c00,0x3c00,0xbc00,0x3c00,0xbc00
.long 0xbc00,0xbb64,0xb9a8,0xb61f,0x8000,0x361f,0x39a8,0x3b64
.long 0x3c00,0x39a8,0x0,0xb9a8,0x8000,0xb9a8,0xbc00,0xb9a8
.long 0xbc00,0xb61f,0x39a8,0x3b64,0x8000,0x3b64,0x39a8,0xb61f
.long 0x3c00,0x0,0xbc00,0x8000,0x8000,0xbc00,0x8000,0x3c00
.long 0xbc00,0x361f,0x39a8,0xbb64,0x8000,0x3b64,0xb9a8,0xb61f
.long 0x3c00,0xb9a8,0x8000,0x39a8,0x8000,0xb9a8,0x3c00,0xb9a8
.long 0xbc00,0x3b64,0xb9a8,0x361f,0x8000,0x361f,0xb9a8,0x3b64
.long 0x3c00,0x3c00,0x3c00,0x3c00,0x3c00,0xbc00,0x3c00,0xbc00
.long 0x39a8,0x3b64,0x8000,0x361f,0x39a8,0x361f,0x3c00,0x3b64
.long 0x8000,0x39a8,0xbc00,0xb9a8,0x3c00,0x39a8,0x8000,0x39a8
.long 0xb9a8,0x361f,0x0,0xbb64,0x39a8,0x3b64,0xbc00,0xb61f
.long 0xbc00,0x8000,0x3c00,0x0,0x8000,0x3c00,0x8000,0xbc00
.long 0xb9a8,0xb61f,0x8000,0x3b64,0xb9a8,0x3b64,0x3c00,0xb61f
.long 0x0,0xb9a8,0xbc00,0x39a8,0xbc00,0x39a8,0x8000,0x39a8
.long 0x39a8,0xbb64,0x0,0xb61f,0xb9a8,0x361f,0xbc00,0x3b64
.long 0x3c000000,0x3bd90000,0x3b640000,0x3aa70000,0x80000000,0xb23e0000,0xb61f0000,0xb8720000
.long 0x3c000000,0x3aa70000,0x361f0000,0xb23e0000,0x80000000,0xb8720000,0xbb640000,0xbbd90000
.long 0x3c000000,0x38720000,0xb61f0000,0xbbd90000,0x80000000,0xbaa70000,0xbb640000,0xb23e0000
.long 0x3c000000,0x323e0000,0xbb640000,0xb8720000,0x80000000,0xbbd90000,0xb61f0000,0x3aa70000
.long 0x3c000000,0xb23e0000,0xbb640000,0x38720000,0x80000000,0xbbd90000,0x361f0000,0x3aa70000
.long 0x3c000000,0xb8720000,0xb61f0000,0x3bd90000,0x80000000,0xbaa70000,0x3b640000,0xb23e0000
.long 0x3c000000,0xbaa70000,0x361f0000,0x323e0000,0x80000000,0xb8720000,0x3b640000,0xbbd90000
.long 0x3c000000,0xbbd90000,0x3b640000,0xbaa70000,0x80000000,0xb23e0000,0x361f0000,0xb8720000
.long 0x361f0000,0x323e0000,0x39a80000,0x38720000,0xbb640000,0xbbd90000,0xb9a80000,0xbaa70000
.long 0xbb640000,0xb8720000,0xb9a80000,0xbbd90000,0x361f0000,0x3aa70000,0xb9a80000,0xb23e0000
.long 0x3b640000,0x3aa70000,0xb9a80000,0x323e0000,0x361f0000,0xb8720000,0x39a80000,0x3bd90000
.long 0xb61f0000,0xbbd90000,0x39a80000,0x3aa70000,0xbb640000,0x323e0000,0x39a80000,0xb8720000
.long 0xb61f0000,0x3bd90000,0x39a80000,0xbaa70000,0x3b640000,0x323e0000,0xb9a80000,0xb8720000
.long 0x3b640000,0xbaa70000,0xb9a80000,0xb23e0000,0xb61f0000,0xb8720000,0xb9a80000,0x3bd90000
.long 0xbb640000,0x38720000,0xb9a80000,0x3bd90000,0xb61f0000,0x3aa70000,0x39a80000,0xb23e0000
.long 0x361f0000,0xb23e0000,0x39a80000,0xb8720000,0x3b640000,0xbbd90000,0x39a80000,0xbaa70000
.long 0x0,0xb23e0000,0xb61f0000,0xb8720000,0xbc000000,0xbbd90000,0xbb640000,0xbaa70000
.long 0x80000000,0x38720000,0x3b640000,0x3bd90000,0x3c000000,0x3aa70000,0x361f0000,0xb23e0000
.long 0x0,0xbaa70000,0xbb640000,0xb23e0000,0xbc000000,0xb8720000,0x361f0000,0x3bd90000
.long 0x80000000,0x3bd90000,0x361f0000,0xbaa70000,0x3c000000,0x323e0000,0xbb640000,0xb8720000
.long 0x0,0xbbd90000,0x361f0000,0x3aa70000,0xbc000000,0x323e0000,0x3b640000,0xb8720000
.long 0x80000000,0x3aa70000,0xbb640000,0x323e0000,0x3c000000,0xb8720000,0xb61f0000,0x3bd90000
.long 0x80000000,0xb8720000,0x3b640000,0xbbd90000,0xbc000000,0x3aa70000,0xb61f0000,0xb23e0000
.long 0x80000000,0x323e0000,0xb61f0000,0x38720000,0x3c000000,0xbbd90000,0x3b640000,0xbaa70000
.long 0xbb640000,0xbbd90000,0xb9a80000,0xbaa70000,0xb61f0000,0xb23e0000,0xb9a80000,0xb8720000
.long 0xb61f0000,0xbaa70000,0x39a80000,0x323e0000,0xbb640000,0xb8720000,0xb9a80000,0xbbd90000
.long 0x361f0000,0xb8720000,0x39a80000,0x3bd90000,0xbb640000,0xbaa70000,0x39a80000,0xb23e0000
.long 0x3b640000,0xb23e0000,0xb9a80000,0x38720000,0xb61f0000,0xbbd90000,0x39a80000,0x3aa70000
.long 0x3b640000,0x323e0000,0xb9a80000,0xb8720000,0x361f0000,0xbbd90000,0xb9a80000,0x3aa70000
.long 0x361f0000,0x38720000,0x39a80000,0xbbd90000,0x3b640000,0xbaa70000,0xb9a80000,0xb23e0000
.long 0xb61f0000,0x3aa70000,0x39a80000,0xb23e0000,0x3b640000,0xb8720000,0x39a80000,0xbbd90000
.long 0xbb640000,0x3bd90000,0xb9a80000,0x3aa70000,0x361f0000,0xb23e0000,0x39a80000,0xb8720000
.size tables, 4096
all_end:
.section .rodata,"a"
.p2align 6
.amdhsa_kernel adaLN_cond__spectral_fnet__moe_arch_mod__prompt_kernel
  .amdhsa_next_free_vgpr 256
  .amdhsa_next_free_sgpr 84
  .amdhsa_accum_offset 256
  .amdhsa_group_segment_fixed_size 0
  .amdhsa_kernarg_size 120
  .amdhsa_user_sgpr_count 2
  .amdhsa_user_sgpr_kernarg_segment_ptr 1
  .amdhsa_system_sgpr_workgroup_id_x 1
  .amdhsa_float_denorm_mode_32 3
  .amdhsa_float_denorm_mode_16_64 3
.end_amdhsa_kernel
```

```asm
; @launch grid=(256,1,1) block=(512,1,1) lds=163840
.amdgcn_target "amdgcn-amd-amdhsa--gfx950"
.text
.globl adaLN_cond__spectral_fnet__moe_arch_mod__prompt_kernel
.p2align 8
.type adaLN_cond__spectral_fnet__moe_arch_mod__prompt_kernel,@function
adaLN_cond__spectral_fnet__moe_arch_mod__prompt_kernel:
    s_cmp_ge_u32 s2, 256
    s_cbranch_scc1 k_done
    s_load_dwordx2 s[8:9], s[0:1], 0
    s_load_dwordx4 s[56:59], s[0:1], 80
    s_load_dwordx4 s[24:27], s[0:1], 96
    s_load_dwordx2 s[12:13], s[0:1], 112
    s_load_dwordx8 s[48:55], s[0:1], 48
    s_memrealtime s[32:33]
    v_lshrrev_b32 v1, 6, v0
    v_and_b32 v2, 63, v0
    v_readfirstlane_b32 s16, v1
    v_lshlrev_b32 v3, 4, v2
    s_and_b32 s34, s2, 7
    s_bfe_u32 s35, s2, 0x40003
    s_mov_b32 s11, 0x00020000
    s_lshl_b32 s60, s35, 4
    s_add_u32 s60, s60, s34
    s_lshl_b32 s60, s60, 11
    s_bitcmp0_b32 s2, 7
    s_cbranch_scc1 g_start
    s_lshl_b32 s61, s16, 19
    s_add_u32 s60, s60, s61
    s_add_u32 s61, s60, 16384
    s_lshl_b32 s10, 1, 22
    s_waitcnt lgkmcnt(0)
    buffer_load_dwordx4 v[64:67], v3, s[8:11], s60 offen offset:0
    buffer_load_dwordx4 v[72:75], v3, s[8:11], s61 offen offset:0
    buffer_load_dwordx4 v[68:71], v3, s[8:11], s60 offen offset:1024
    buffer_load_dwordx4 v[76:79], v3, s[8:11], s61 offen offset:1024
    s_branch f_start
g_start:
    s_cmp_lt_u32 s16, 4
    s_cbranch_scc1 g_load
    s_getpc_b64 s[36:37]
g_pc:
    s_lshl_b32 s42, s35, 2
    s_add_u32 s42, s42, s16
    s_sub_u32 s42, s42, 4
    s_lshl_b32 s42, s42, 10
    v_lshl_add_u32 v4, v2, 7, s42
    v_min_u32 v4, all_end-g_pc-4, v4
    s_mov_b64 exec, 0xff
    global_load_dword v199, v4, s[36:37]
    s_mov_b64 exec, -1
    s_branch g_cons
h_non:
    s_mul_i32 s44, s32, 0x9e3779b1
    s_lshr_b32 s45, s44, 15
    s_xor_b32 s44, s44, s45
    s_mul_i32 s44, s44, 0x85ebca6b
    s_xor_b32 s33, s33, s44
    s_lshr_b32 s45, s44, 13
    s_xor_b32 s44, s44, s45
    s_mul_i32 s33, s33, 0xc2b2ae35
    s_add_u32 s33, s33, s32
    s_lshr_b32 s45, s33, 16
    s_xor_b32 s33, s33, s45
    s_mul_i32 s33, s33, 0x27d4eb2f
    s_or_b32 s32, s44, 1
    s_andn2_b32 s33, s33, 7
    v_mov_b32 v24, s32
    v_mov_b32 v25, s33
    v_lshlrev_b32 v26, 3, v2
    s_mov_b32 exec_hi, 0
    global_store_dwordx2 v26, v[24:25], s[26:27] sc1
    s_mov_b32 exec_hi, -1
    s_branch h_nonx
g_load:
    s_lshl_b32 s42, s16, 7
    s_and_b32 s42, s42, 128
    v_xor_b32 v6, s42, v3
    v_xor_b32 v7, 32, v6
    v_xor_b32 v8, 64, v6
    v_xor_b32 v9, 32, v8
    s_lshl_b32 s41, s35, 3
    s_add_u32 s41, s41, s16
    s_mul_i32 s18, s41, 96
    s_add_u32 s18, s18, s34
    s_cmp_ge_u32 s34, 6
    s_cselect_b32 s42, 2, 0
    s_add_u32 s18, s18, s42
    s_lshl_b32 s18, s18, 10
    s_lshl_b32 s68, s16, 13
    s_or_b32 m0, s68, 32768
    s_movk_i32 s43, 12288
    s_lshl_b32 s66, s43, 10
    s_mov_b32 s67, s11
    s_mov_b32 s42, s18
    s_or_b32 s40, s2, s16
    s_waitcnt lgkmcnt(0)
    s_cbranch_scc0 h_non
h_nonx:
    s_mov_b32 s64, s58
    s_mov_b32 s65, s59
    buffer_load_dwordx4 v6, s[64:67], s42 offen nt lds
    s_addk_i32 m0, 1024
    s_add_u32 s42, s42, s43
    buffer_load_dwordx4 v7, s[64:67], s42 offen nt lds
    s_addk_i32 m0, 1024
    s_add_u32 s42, s42, s43
    buffer_load_dwordx4 v8, s[64:67], s42 offen nt lds
    s_addk_i32 m0, 1024
    s_add_u32 s42, s42, s43
    buffer_load_dwordx4 v9, s[64:67], s42 offen nt lds
    s_addk_i32 m0, 1024
    s_add_u32 s42, s42, s43
    buffer_load_dwordx4 v6, s[64:67], s42 offen nt lds
    s_addk_i32 m0, 1024
    s_add_u32 s42, s42, s43
    buffer_load_dwordx4 v7, s[64:67], s42 offen nt lds
    s_addk_i32 m0, 1024
    s_add_u32 s42, s42, s43
    buffer_load_dwordx4 v8, s[64:67], s42 offen nt lds
    s_addk_i32 m0, 1024
    s_add_u32 s42, s42, s43
    buffer_load_dwordx4 v9, s[64:67], s42 offen nt lds
    s_addk_i32 m0, 1024
    s_add_u32 s42, s42, s43
    s_mov_b32 s69, s16
    s_xor_b32 s16, s16, 4
    v_xor_b32 v1, 4, v1
    v_xor_b32 v0, 0x100, v0
    v_lshlrev_b32 v13, 2, v2
    v_mov_b32 v220, 0
    v_mov_b32 v221, 0
    v_mov_b32 v233, 0
    v_mov_b32 v234, 0
    v_mov_b32 v235, 0
    s_mov_b32 s8, s58
    s_mov_b32 s9, s59
    s_mov_b32 s10, s66
    s_mov_b32 s14, 268435456
    s_mov_b32 s15, s11
    v_mov_b32 v4, 0
    s_lshl_b32 s42, s69, 7
    s_add_u32 s42, s42, 139264
    s_mov_b32 m0, s42
    s_lshl_b32 s42, s35, 7
    v_add_u32 v10, s42, v13
    s_mov_b32 exec_hi, 0
    global_load_lds_dword v10, s[56:57]
    s_mov_b32 exec_hi, -1
    s_lshl_b32 s19, s35, 2
    s_add_u32 s19, s19, s69
    s_mul_i32 s19, s19, 196608
    s_lshl_b32 s42, s34, 9
    s_add_u32 s19, s19, s42
    s_and_b32 s42, s34, 4
    s_lshl_b32 s42, s42, 9
    s_add_u32 s19, s19, s42
    s_add_u32 s19, s19, 6144
    v_lshrrev_b32 v5, 5, v2
    v_and_b32 v14, 0x1f0, v3
    v_lshlrev_b32 v12, 5, v5
    v_xor_b32 v14, v14, v12
    s_movk_i32 s42, 12288
    v_mad_u32_u24 v14, v5, s42, v14
    v_bfe_u32 v5, v0, 5, 1
    v_lshlrev_b32 v5, 3, v5
    v_bfe_u32 v12, v0, 3, 2
    v_add_u32 v5, v5, v12
    v_bfe_u32 v12, v0, 4, 2
    v_lshlrev_b32 v12, 1, v12
    v_xor_b32 v12, v12, v0
    v_and_b32 v12, 7, v12
    v_lshlrev_b32 v12, 4, v12
    s_movk_i32 s42, 7168
    v_mad_u32_u24 v5, v5, s42, v12
    s_mov_b32 s20, s26
    s_mov_b32 s21, s27
    s_mov_b32 s26, 4194304
    s_mov_b32 s27, 0x00020000
    s_and_b32 s65, s35, 1
    s_lshr_b32 s40, s35, 1
    s_mul_i32 s64, s34, 7
    s_add_u32 s64, s64, s40
    s_lshl_b32 s41, s34, 1
    s_add_u32 s41, s41, s65
    s_cmp_ge_u32 s35, 14
    s_cselect_b32 s66, 1, 0
    s_cselect_b32 s64, s41, s64
    v_lshrrev_b32 v10, 2, v2
    v_and_b32 v15, 3, v0
    v_bfe_u32 v11, v0, 3, 2
    v_xor_b32 v12, v11, v1
    v_and_b32 v12, 3, v12
    v_lshlrev_b32 v12, 5, v12
    v_lshl_add_u32 v12, v10, 7, v12
    v_lshl_add_u32 v12, v15, 3, v12
    v_lshrrev_b32 v16, 2, v1
    v_lshl_add_u32 v12, v16, 15, v12
    v_add_u32 v21, 65536, v12
    s_lshl_b32 s67, s65, 3
    s_add_u32 s67, s67, s69
    s_mul_i32 s67, s67, 458752
    s_lshl_b32 s42, s64, 7
    s_add_u32 s67, s67, s42
    s_mov_b32 s56, s50
    s_mov_b32 s57, s51
    s_mov_b32 s58, 7340032
    s_mov_b32 s59, 0x00020000
    s_mov_b32 s44, s52
    s_mov_b32 s45, s53
    s_mov_b32 s46, 7340032
    s_mov_b32 s47, 0x00020000
    s_waitcnt vmcnt(7)
    s_add_u32 s43, s68, 65536
    s_mov_b32 m0, s43
    s_add_u32 s42, s18, 393216
    buffer_load_dwordx4 v6, s[8:11], s42 offen nt lds
    s_waitcnt vmcnt(7)
    s_add_u32 s43, s68, 66560
    s_mov_b32 m0, s43
    s_add_u32 s42, s18, 405504
    buffer_load_dwordx4 v7, s[8:11], s42 offen nt lds
    s_load_dwordx2 s[32:33], s[20:21], 128
    s_waitcnt vmcnt(7)
    s_add_u32 s43, s68, 67584
    s_mov_b32 m0, s43
    s_add_u32 s42, s18, 417792
    buffer_load_dwordx4 v8, s[8:11], s42 offen nt lds
    s_waitcnt vmcnt(7)
    s_add_u32 s43, s68, 68608
    s_mov_b32 m0, s43
    s_add_u32 s42, s18, 430080
    buffer_load_dwordx4 v9, s[8:11], s42 offen nt lds
    s_waitcnt vmcnt(7)
    s_add_u32 s43, s68, 69632
    s_mov_b32 m0, s43
    s_add_u32 s42, s18, 442368
    buffer_load_dwordx4 v6, s[8:11], s42 offen nt lds
    s_waitcnt vmcnt(7)
    s_add_u32 s43, s68, 70656
    s_mov_b32 m0, s43
    s_add_u32 s42, s18, 454656
    buffer_load_dwordx4 v7, s[8:11], s42 offen nt lds
    s_waitcnt vmcnt(7)
    s_add_u32 s43, s68, 71680
    s_mov_b32 m0, s43
    s_add_u32 s42, s18, 466944
    buffer_load_dwordx4 v8, s[8:11], s42 offen nt lds
    s_waitcnt vmcnt(7)
    s_barrier
    s_add_u32 s43, s68, 72704
    s_mov_b32 m0, s43
    s_add_u32 s42, s18, 479232
    buffer_load_dwordx4 v9, s[8:11], s42 offen nt lds
    s_waitcnt lgkmcnt(0)
    s_cmp_lg_u32 s32, 0
    s_cbranch_scc1 g_n2x
    s_load_dwordx2 s[32:33], s[20:21], 192
    s_mov_b32 s83, 0
    v_mov_b32 v122, 0
    s_waitcnt lgkmcnt(0)
g_n2:
    s_cmp_lg_u32 s32, 0
    s_cbranch_scc1 g_n2x
    global_load_dwordx2 v[120:121], v122, s[20:21] sc1
    s_waitcnt vmcnt(0)
    v_readfirstlane_b32 s32, v120
    v_readfirstlane_b32 s33, v121
    s_add_u32 s83, s83, 1
    s_cmp_lt_u32 s83, 0x40000
    s_cbranch_scc1 g_n2
g_n2x:
    s_cmp_eq_u32 s66, 0
    s_cbranch_scc1 m_load
    v_mov_b32 v216, s32
    v_mov_b32 v217, s33
    v_and_b32 v218, 1, v0
    v_cmp_eq_u32 vcc, 1, v218
    s_nop 1
    v_cndmask_b32 v216, v216, v217, vcc
    v_bfe_u32 v217, v216, 8, 8
    v_bfe_u32 v218, v216, 16, 8
    v_lshrrev_b32 v219, 24, v216
    v_and_b32 v216, 0xff, v216
    s_lshl_b32 s81, s34, 16
    s_lshl_b32 s42, s16, 13
    s_add_u32 s81, s81, s42
    s_add_u32 s81, s81, 19922944
    s_lshl_b32 s42, s65, 9
    s_add_u32 s80, s81, s42
    s_add_u32 s81, s80, s42
    v_lshlrev_b32 v222, 4, v0
    v_lshrrev_b32 v223, 5, v2
    v_and_b32 v24, 0x1f0, v3
    v_lshl_add_u32 v223, v223, 12, v24
    s_lshl_b32 s39, s34, 4
    s_add_u32 s39, s39, s35
    s_lshl_b32 s39, s39, 12
    s_add_u32 s39, s39, 19922944
    s_bitcmp1_b32 s64, 2
    s_cselect_b32 s28, 1.0, 0
    s_waitcnt vmcnt(0)
    s_barrier
    s_branch x_start
m_load:
    s_waitcnt vmcnt(7)
    v_xor_b32 v4, 0, v14
    s_add_u32 s43, s68, 98304
    s_mov_b32 m0, s43
    s_add_u32 s42, s19, 0
    buffer_load_dwordx4 v4, s[8:11], s42 offen nt lds
    s_waitcnt vmcnt(7)
    v_xor_b32 v4, 64, v14
    s_add_u32 s43, s68, 99328
    s_mov_b32 m0, s43
    s_add_u32 s42, s19, 24576
    buffer_load_dwordx4 v4, s[8:11], s42 offen nt lds
    s_waitcnt vmcnt(7)
    v_xor_b32 v4, 0, v14
    s_add_u32 s43, s68, 100352
    s_mov_b32 m0, s43
    s_add_u32 s42, s19, 49152
    buffer_load_dwordx4 v4, s[8:11], s42 offen nt lds
    s_waitcnt vmcnt(7)
    v_xor_b32 v4, 64, v14
    s_add_u32 s43, s68, 101376
    s_mov_b32 m0, s43
    s_add_u32 s42, s19, 73728
    buffer_load_dwordx4 v4, s[8:11], s42 offen nt lds
    s_waitcnt vmcnt(4)
    s_barrier
    s_barrier
    s_waitcnt vmcnt(7)
    v_xor_b32 v4, 128, v14
    s_add_u32 s43, s68, 102400
    s_mov_b32 m0, s43
    s_add_u32 s42, s19, 98304
    buffer_load_dwordx4 v4, s[8:11], s42 offen nt lds
    s_waitcnt vmcnt(7)
    v_xor_b32 v4, 192, v14
    s_add_u32 s43, s68, 103424
    s_mov_b32 m0, s43
    s_add_u32 s42, s19, 122880
    buffer_load_dwordx4 v4, s[8:11], s42 offen nt lds
    s_waitcnt vmcnt(7)
    v_xor_b32 v4, 128, v14
    s_add_u32 s43, s68, 104448
    s_mov_b32 m0, s43
    s_add_u32 s42, s19, 147456
    buffer_load_dwordx4 v4, s[8:11], s42 offen nt lds
    s_waitcnt vmcnt(7)
    v_xor_b32 v4, 192, v14
    s_add_u32 s43, s68, 105472
    s_mov_b32 m0, s43
    s_add_u32 s42, s19, 172032
    buffer_load_dwordx4 v4, s[8:11], s42 offen nt lds
    s_waitcnt vmcnt(7)
    s_add_u32 s43, s68, 0
    s_mov_b32 m0, s43
    s_add_u32 s42, s67, 0
    buffer_load_dwordx4 v5, s[56:59], s42 offen nt lds
    s_waitcnt vmcnt(7)
    s_add_u32 s43, s68, 1024
    s_mov_b32 m0, s43
    s_add_u32 s42, s67, 114688
    buffer_load_dwordx4 v5, s[56:59], s42 offen nt lds
    s_waitcnt vmcnt(7)
    s_add_u32 s43, s68, 2048
    s_mov_b32 m0, s43
    s_add_u32 s42, s67, 28672
    buffer_load_dwordx4 v5, s[56:59], s42 offen nt lds
    s_waitcnt vmcnt(7)
    s_add_u32 s43, s68, 3072
    s_mov_b32 m0, s43
    s_add_u32 s42, s67, 143360
    buffer_load_dwordx4 v5, s[56:59], s42 offen nt lds
    s_waitcnt vmcnt(7)
    s_add_u32 s43, s68, 4096
    s_mov_b32 m0, s43
    s_add_u32 s42, s67, 229376
    buffer_load_dwordx4 v5, s[56:59], s42 offen nt lds
    s_waitcnt vmcnt(7)
    s_add_u32 s43, s68, 5120
    s_mov_b32 m0, s43
    s_add_u32 s42, s67, 344064
    buffer_load_dwordx4 v5, s[56:59], s42 offen nt lds
    s_waitcnt vmcnt(6)
    s_barrier
    s_barrier
    s_waitcnt vmcnt(7)
    s_add_u32 s43, s68, 6144
    s_mov_b32 m0, s43
    s_add_u32 s42, s67, 258048
    buffer_load_dwordx4 v5, s[56:59], s42 offen nt lds
    s_waitcnt vmcnt(7)
    s_add_u32 s43, s68, 7168
    s_mov_b32 m0, s43
    s_add_u32 s42, s67, 372736
    buffer_load_dwordx4 v5, s[56:59], s42 offen nt lds
    s_waitcnt vmcnt(9)
    s_add_u32 s43, s68, 32768
    s_mov_b32 m0, s43
    s_add_u32 s42, s67, 1835008
    buffer_load_dwordx4 v5, s[56:59], s42 offen nt lds
    s_waitcnt vmcnt(9)
    s_add_u32 s43, s68, 33792
    s_mov_b32 m0, s43
    s_add_u32 s42, s67, 1949696
    buffer_load_dwordx4 v5, s[56:59], s42 offen nt lds
    s_waitcnt vmcnt(9)
    s_add_u32 s43, s68, 34816
    s_mov_b32 m0, s43
    s_add_u32 s42, s67, 1863680
    buffer_load_dwordx4 v5, s[56:59], s42 offen nt lds
    s_waitcnt vmcnt(9)
    s_add_u32 s43, s68, 35840
    s_mov_b32 m0, s43
    s_add_u32 s42, s67, 1978368
    buffer_load_dwordx4 v5, s[56:59], s42 offen nt lds
    s_waitcnt vmcnt(9)
    s_add_u32 s43, s68, 36864
    s_mov_b32 m0, s43
    s_add_u32 s42, s67, 2064384
    buffer_load_dwordx4 v5, s[56:59], s42 offen nt lds
    s_waitcnt vmcnt(9)
    s_add_u32 s43, s68, 37888
    s_mov_b32 m0, s43
    s_add_u32 s42, s67, 2179072
    buffer_load_dwordx4 v5, s[56:59], s42 offen nt lds
    s_waitcnt vmcnt(9)
    s_add_u32 s43, s68, 38912
    s_mov_b32 m0, s43
    s_add_u32 s42, s67, 2093056
    buffer_load_dwordx4 v5, s[56:59], s42 offen nt lds
    s_waitcnt vmcnt(9)
    s_add_u32 s43, s68, 39936
    s_mov_b32 m0, s43
    s_add_u32 s42, s67, 2207744
    buffer_load_dwordx4 v5, s[56:59], s42 offen nt lds
    s_waitcnt vmcnt(9)
    s_add_u32 s43, s68, 65536
    s_mov_b32 m0, s43
    s_add_u32 s42, s67, 0
    buffer_load_dwordx4 v5, s[44:47], s42 offen nt lds
    s_waitcnt vmcnt(9)
    s_barrier
    s_add_u32 s43, s68, 66560
    s_mov_b32 m0, s43
    s_add_u32 s42, s67, 114688
    buffer_load_dwordx4 v5, s[44:47], s42 offen nt lds
    s_waitcnt vmcnt(9)
    s_add_u32 s43, s68, 67584
    s_mov_b32 m0, s43
    s_add_u32 s42, s67, 28672
    buffer_load_dwordx4 v5, s[44:47], s42 offen nt lds
    s_waitcnt vmcnt(9)
    s_add_u32 s43, s68, 68608
    s_mov_b32 m0, s43
    s_add_u32 s42, s67, 143360
    buffer_load_dwordx4 v5, s[44:47], s42 offen nt lds
    s_waitcnt vmcnt(9)
    s_add_u32 s43, s68, 69632
    s_mov_b32 m0, s43
    s_add_u32 s42, s67, 229376
    buffer_load_dwordx4 v5, s[44:47], s42 offen nt lds
    s_waitcnt vmcnt(9)
    s_add_u32 s43, s68, 70656
    s_mov_b32 m0, s43
    s_add_u32 s42, s67, 344064
    buffer_load_dwordx4 v5, s[44:47], s42 offen nt lds
    s_waitcnt vmcnt(9)
    s_add_u32 s43, s68, 71680
    s_mov_b32 m0, s43
    s_add_u32 s42, s67, 258048
    buffer_load_dwordx4 v5, s[44:47], s42 offen nt lds
    s_waitcnt vmcnt(9)
    s_add_u32 s43, s68, 72704
    s_mov_b32 m0, s43
    s_add_u32 s42, s67, 372736
    buffer_load_dwordx4 v5, s[44:47], s42 offen nt lds
    s_waitcnt vmcnt(9)
    s_add_u32 s43, s68, 98304
    s_mov_b32 m0, s43
    s_add_u32 s42, s67, 1835008
    buffer_load_dwordx4 v5, s[44:47], s42 offen nt lds
    s_waitcnt vmcnt(9)
    s_barrier
    ds_read_b64_tr_b16 v[64:65], v12 offset:0
    ds_read_b64_tr_b16 v[66:67], v12 offset:2048
    ds_read_b64_tr_b16 v[68:69], v12 offset:4096
    ds_read_b64_tr_b16 v[70:71], v12 offset:6144
    ds_read_b64_tr_b16 v[72:73], v12 offset:8192
    ds_read_b64_tr_b16 v[74:75], v12 offset:10240
    ds_read_b64_tr_b16 v[76:77], v12 offset:12288
    ds_read_b64_tr_b16 v[78:79], v12 offset:14336
    ds_read_b64_tr_b16 v[80:81], v12 offset:16384
    ds_read_b64_tr_b16 v[82:83], v12 offset:18432
    ds_read_b64_tr_b16 v[84:85], v12 offset:20480
    ds_read_b64_tr_b16 v[86:87], v12 offset:22528
    ds_read_b64_tr_b16 v[88:89], v12 offset:24576
    ds_read_b64_tr_b16 v[90:91], v12 offset:26624
    ds_read_b64_tr_b16 v[92:93], v12 offset:28672
    ds_read_b64_tr_b16 v[94:95], v12 offset:30720
    s_add_u32 s43, s68, 99328
    s_mov_b32 m0, s43
    s_add_u32 s42, s67, 1949696
    buffer_load_dwordx4 v5, s[44:47], s42 offen nt lds
    s_waitcnt vmcnt(9)
    s_add_u32 s43, s68, 100352
    s_mov_b32 m0, s43
    s_add_u32 s42, s67, 1863680
    buffer_load_dwordx4 v5, s[44:47], s42 offen nt lds
    s_waitcnt vmcnt(9)
    s_add_u32 s43, s68, 101376
    s_mov_b32 m0, s43
    s_add_u32 s42, s67, 1978368
    buffer_load_dwordx4 v5, s[44:47], s42 offen nt lds
    s_waitcnt vmcnt(9)
    s_add_u32 s43, s68, 102400
    s_mov_b32 m0, s43
    s_add_u32 s42, s67, 2064384
    buffer_load_dwordx4 v5, s[44:47], s42 offen nt lds
    s_waitcnt vmcnt(9)
    s_add_u32 s43, s68, 103424
    s_mov_b32 m0, s43
    s_add_u32 s42, s67, 2179072
    buffer_load_dwordx4 v5, s[44:47], s42 offen nt lds
    s_waitcnt vmcnt(9)
    s_add_u32 s43, s68, 104448
    s_mov_b32 m0, s43
    s_add_u32 s42, s67, 2093056
    buffer_load_dwordx4 v5, s[44:47], s42 offen nt lds
    s_waitcnt vmcnt(9)
    s_add_u32 s43, s68, 105472
    s_mov_b32 m0, s43
    s_add_u32 s42, s67, 2207744
    buffer_load_dwordx4 v5, s[44:47], s42 offen nt lds
    s_branch m_join
g_cons:
    s_xor_b32 s16, s16, 4
    v_xor_b32 v1, 4, v1
    v_xor_b32 v0, 0x100, v0
    v_lshlrev_b32 v13, 2, v2
    v_mov_b32 v220, 0
    v_mov_b32 v221, 0
    v_mov_b32 v233, 0
    v_mov_b32 v234, 0
    v_mov_b32 v235, 0
    s_mov_b32 s14, 268435456
    s_mov_b32 s15, s11
    s_lshl_b32 s29, s34, 4
    s_add_u32 s29, s29, s35
    s_lshl_b32 s29, s29, 12
    s_add_u32 s29, s29, 19922944
    s_lshl_b32 s30, s16, 9
    s_add_u32 s30, s30, s29
    s_lshl_b32 s31, s16, 8
    s_add_u32 s31, s31, s29
    s_add_u32 s31, s31, 2048
    v_lshlrev_b32 v8, 1, v2
    v_lshlrev_b32 v9, 7, v2
    v_mov_b32 v104, -1
    v_mov_b32 v105, -1
    v_mov_b32 v106, -1
    v_mov_b32 v107, -1
    s_waitcnt lgkmcnt(0)
    s_cmp_eq_u32 s16, 1
    s_cselect_b64 exec, 0xffffff, 1
    buffer_load_dword v245, v9, s[12:15], s29 offen sc1
    s_mov_b64 exec, -1
    v_mov_b32 v14, 0
    s_mov_b32 s8, s58
    s_mov_b32 s9, s59
    s_mov_b32 s10, 12582912
    s_mov_b32 s11, 0x00020000
    s_mov_b32 s20, s26
    s_mov_b32 s21, s27
    s_mov_b32 s26, 4194304
    s_mov_b32 s27, 0x00020000
    s_and_b32 s65, s35, 1
    s_lshr_b32 s40, s35, 1
    s_mul_i32 s64, s34, 7
    s_add_u32 s64, s64, s40
    s_lshl_b32 s41, s34, 1
    s_add_u32 s41, s41, s65
    s_cmp_ge_u32 s35, 14
    s_cselect_b32 s66, 1, 0
    s_cselect_b32 s64, s41, s64
    v_lshrrev_b32 v10, 2, v2
    v_and_b32 v15, 3, v0
    v_bfe_u32 v11, v0, 3, 2
    v_xor_b32 v12, v11, v1
    v_and_b32 v12, 3, v12
    v_lshlrev_b32 v12, 5, v12
    v_lshl_add_u32 v12, v10, 7, v12
    v_lshl_add_u32 v12, v15, 3, v12
    v_lshrrev_b32 v16, 2, v1
    v_lshl_add_u32 v12, v16, 15, v12
    v_add_u32 v21, 65536, v12
    v_bfe_u32 v22, v0, 2, 3
    v_lshlrev_b32 v22, 5, v22
    v_lshl_add_u32 v22, v15, 3, v22
    v_bfe_u32 v23, v0, 2, 2
    v_bfe_u32 v24, v0, 4, 2
    v_lshl_add_u32 v23, v24, 3, v23
    v_lshl_add_u32 v200, v23, 10, v22
    v_lshl_add_u32 v200, v1, 8, v200
    v_add_u32 v200, 32768, v200
    v_lshlrev_b32 v25, 7, v1
    v_xor_b32 v22, v22, v25
    v_lshl_add_u32 v208, v23, 9, v22
    v_add_u32 v208, 98304, v208
    v_cmp_eq_u32 s[60:61], 1, v24
    v_cmp_eq_u32 s[62:63], 2, v24
    v_cmp_eq_u32 s[72:73], 3, v24
    v_add_u32 v8, v8, v25
    v_add_u32 v8, 139264, v8
    v_lshl_add_u32 v10, v24, 4, v25
    v_add_u32 v10, 139264, v10
    v_xor_b32 v201, 32, v200
    v_xor_b32 v202, 64, v200
    v_xor_b32 v203, 96, v200
    v_xor_b32 v204, 128, v200
    v_xor_b32 v205, 160, v200
    v_xor_b32 v206, 192, v200
    v_xor_b32 v207, 224, v200
    v_xor_b32 v209, 32, v208
    v_xor_b32 v210, 64, v208
    v_xor_b32 v211, 96, v208
    s_sleep 8
    s_load_dwordx2 s[32:33], s[20:21], 128
    s_waitcnt lgkmcnt(0)
    s_cmp_lg_u32 s32, 0
    s_cbranch_scc1 g_nnx
    s_load_dwordx2 s[32:33], s[20:21], 192
    s_mov_b32 s83, 0
    v_mov_b32 v114, 0
    s_waitcnt lgkmcnt(0)
g_nn:
    s_cmp_lg_u32 s32, 0
    s_cbranch_scc1 g_nnx
    global_load_dwordx2 v[112:113], v114, s[20:21] sc1
    s_waitcnt vmcnt(0)
    v_readfirstlane_b32 s32, v112
    v_readfirstlane_b32 s33, v113
    s_add_u32 s83, s83, 1
    s_cmp_lt_u32 s83, 0x40000
    s_cbranch_scc1 g_nn
g_nnx:
    v_mov_b32 v212, s32
    v_mov_b32 v213, s33
    v_and_b32 v214, 7, v0
    v_lshlrev_b32 v214, 3, v214
    v_lshrrev_b64 v[212:213], v214, v[212:213]
    v_and_b32 v212, 0xff, v212
    s_movk_i32 s74, 0xff00
    s_cmp_ge_u32 s16, s66
    s_cbranch_scc1 g_nw
    s_lshr_b32 s22, s64, 2
    s_cmp_eq_u32 s22, 3
    s_cselect_b32 s22, 6, s22
    s_lshl_b32 s22, s22, 12
    s_add_u32 s22, s22, 16875520
    s_lshr_b32 s23, s64, 3
    s_lshl_b32 s23, s23, 13
    s_add_u32 s23, s23, 16908288
    s_mov_b32 s75, 16891904
    v_bfe_u32 v24, v0, 2, 1
    v_bfe_u32 v25, v0, 3, 2
    v_bfe_u32 v26, v0, 5, 1
    v_lshlrev_b32 v220, 4, v15
    v_lshl_add_u32 v220, v24, 9, v220
    v_lshl_add_u32 v220, v25, 10, v220
    s_and_b32 s42, s64, 3
    s_lshl_b32 s42, s42, 7
    s_and_b32 s43, s64, 4
    s_lshl_b32 s43, s43, 4
    s_add_u32 s42, s42, s43
    v_add_u32 v233, s42, v220
    v_lshl_add_u32 v220, v26, 7, v220
    s_and_b32 s42, s64, 1
    s_lshl_b32 s42, s42, 8
    s_and_b32 s43, s64, 2
    s_lshl_b32 s43, s43, 5
    s_add_u32 s42, s42, s43
    v_add_u32 v220, s42, v220
    v_xor_b32 v234, 8176, v220
    v_xor_b32 v235, 8176, v233
    v_lshlrev_b32 v221, 7, v15
    v_lshl_add_u32 v221, v24, 6, v221
    v_lshl_add_u32 v221, v25, 4, v221
    v_lshl_add_u32 v221, v26, 9, v221
    v_add_u32 v232, 8, v2
    v_and_b32 v232, 31, v232
    v_lshl_add_u32 v232, v26, 5, v232
    v_lshlrev_b32 v232, 2, v232
    s_lshl_b32 s79, s64, 7
    s_add_u32 s79, s79, 16850944
    v_xor_b32 v0, 1, v0
    v_mov_b32 v228, s32
    v_mov_b32 v229, s33
    v_and_b32 v230, 1, v0
    v_cmp_eq_u32 vcc, 1, v230
    s_nop 1
    v_cndmask_b32 v228, v228, v229, vcc
    v_bfe_u32 v229, v228, 8, 8
    v_bfe_u32 v230, v228, 16, 8
    v_lshrrev_b32 v231, 24, v228
    v_and_b32 v228, 0xff, v228
    v_xor_b32 v0, 1, v0
    s_mov_b32 s44, s48
    s_mov_b32 s45, s49
    s_mov_b32 s46, 2048
    s_mov_b32 s47, 0x00020000
    v_lshrrev_b32 v11, 1, v221
    s_and_b32 s42, s64, 3
    s_lshl_b32 s42, s42, 9
    buffer_load_dwordx2 v[52:53], v11, s[44:47], s42 offen
    v_mov_b32 v216, s32
    v_mov_b32 v217, s33
    v_and_b32 v218, 1, v0
    v_cmp_eq_u32 vcc, 1, v218
    s_nop 1
    v_cndmask_b32 v216, v216, v217, vcc
    v_bfe_u32 v217, v216, 8, 8
    v_bfe_u32 v218, v216, 16, 8
    v_lshrrev_b32 v219, 24, v216
    v_and_b32 v216, 0xff, v216
    v_not_b32 v24, v216
    v_not_b32 v25, v229
    buffer_store_dwordx4 v[24:27], v220, s[12:15], s22 offen sc1
    s_mov_b32 exec_hi, 0
    buffer_store_dwordx4 v[24:27], v233, s[12:15], s23 offen sc1
    buffer_store_dwordx4 v[24:27], v235, s[12:15], s23 offen sc1
    s_mov_b64 exec, 0xff
    buffer_store_dwordx4 v[104:107], v3, s[12:15], s79 offen sc1
    s_mov_b64 exec, -1
    s_cmp_lt_u32 s64, 8
    s_cbranch_scc1 g_nw
    buffer_store_dwordx4 v[24:27], v234, s[12:15], s22 offen sc1
    s_cmp_lt_u32 s64, 12
    s_cbranch_scc1 g_nw
    buffer_store_dwordx4 v[24:27], v220, s[12:15], s75 offen sc1
    buffer_store_dwordx4 v[24:27], v234, s[12:15], s75 offen sc1
g_nw:
    s_barrier
    ds_read_u16 v6, v8
    s_waitcnt lgkmcnt(0)
    v_lshlrev_b32 v6, 16, v6
    v_mul_f32 v24, 0xbfb8aa3b, v6
    v_exp_f32 v24, v24
    s_nop 0
    v_add_f32 v24, 1.0, v24
    v_rcp_f32 v24, v24
    s_nop 0
    v_mul_f32 v6, v6, v24
    v_cvt_pk_bf16_f32 v6, v6, v6
    ds_write_b16 v8, v6
    ds_read_b128 v[120:123], v10
    ds_read_b128 v[124:127], v10 offset:64
    ds_read_b64_tr_b16 v[128:129], v200 offset:0
    ds_read_b64_tr_b16 v[130:131], v200 offset:4096
    ds_read_b64_tr_b16 v[132:133], v201 offset:0
    ds_read_b64_tr_b16 v[134:135], v201 offset:4096
    ds_read_b64_tr_b16 v[136:137], v202 offset:0
    ds_read_b64_tr_b16 v[138:139], v202 offset:4096
    ds_read_b64_tr_b16 v[140:141], v203 offset:0
    ds_read_b64_tr_b16 v[142:143], v203 offset:4096
    ds_read_b64_tr_b16 v[144:145], v204 offset:0
    ds_read_b64_tr_b16 v[146:147], v204 offset:4096
    ds_read_b64_tr_b16 v[148:149], v205 offset:0
    ds_read_b64_tr_b16 v[150:151], v205 offset:4096
    ds_read_b64_tr_b16 v[152:153], v206 offset:0
    ds_read_b64_tr_b16 v[154:155], v206 offset:4096
    s_waitcnt lgkmcnt(12)
    v_mfma_f32_16x16x32_bf16 v[64:67], v[120:123], v[128:131], 0
    ds_read_b64_tr_b16 v[156:157], v207 offset:0
    ds_read_b64_tr_b16 v[158:159], v207 offset:4096
    s_waitcnt lgkmcnt(12)
    v_mfma_f32_16x16x32_bf16 v[68:71], v[120:123], v[132:135], 0
    s_waitcnt lgkmcnt(10)
    v_mfma_f32_16x16x32_bf16 v[72:75], v[120:123], v[136:139], 0
    s_waitcnt lgkmcnt(8)
    v_mfma_f32_16x16x32_bf16 v[76:79], v[120:123], v[140:143], 0
    s_waitcnt lgkmcnt(6)
    v_mfma_f32_16x16x32_bf16 v[80:83], v[120:123], v[144:147], 0
    s_waitcnt lgkmcnt(4)
    v_mfma_f32_16x16x32_bf16 v[84:87], v[120:123], v[148:151], 0
    s_waitcnt lgkmcnt(2)
    v_mfma_f32_16x16x32_bf16 v[88:91], v[120:123], v[152:155], 0
    s_waitcnt lgkmcnt(0)
    v_mfma_f32_16x16x32_bf16 v[92:95], v[120:123], v[156:159], 0
    v_mov_b32 v216, s32
    v_mov_b32 v217, s33
    v_and_b32 v218, 1, v0
    v_cmp_eq_u32 vcc, 1, v218
    s_nop 1
    v_cndmask_b32 v216, v216, v217, vcc
    v_bfe_u32 v217, v216, 8, 8
    v_bfe_u32 v218, v216, 16, 8
    v_lshrrev_b32 v219, 24, v216
    v_and_b32 v216, 0xff, v216
    s_lshl_b32 s81, s34, 16
    s_lshl_b32 s42, s16, 13
    s_add_u32 s81, s81, s42
    s_add_u32 s81, s81, 19922944
    s_lshl_b32 s42, s65, 9
    s_add_u32 s80, s81, s42
    s_add_u32 s81, s80, s42
    v_lshlrev_b32 v222, 4, v0
    v_lshrrev_b32 v223, 5, v2
    v_and_b32 v24, 0x1f0, v3
    v_lshl_add_u32 v223, v223, 12, v24
    s_lshl_b32 s39, s34, 4
    s_add_u32 s39, s39, s35
    s_lshl_b32 s39, s39, 12
    s_add_u32 s39, s39, 19922944
    s_bitcmp1_b32 s64, 2
    s_cselect_b32 s28, 1.0, 0
    s_barrier
    ds_read_b64_tr_b16 v[128:129], v200 offset:32768
    ds_read_b64_tr_b16 v[130:131], v200 offset:36864
    ds_read_b64_tr_b16 v[132:133], v201 offset:32768
    ds_read_b64_tr_b16 v[134:135], v201 offset:36864
    ds_read_b64_tr_b16 v[136:137], v202 offset:32768
    ds_read_b64_tr_b16 v[138:139], v202 offset:36864
    ds_read_b64_tr_b16 v[140:141], v203 offset:32768
    ds_read_b64_tr_b16 v[142:143], v203 offset:36864
    ds_read_b64_tr_b16 v[144:145], v204 offset:32768
    ds_read_b64_tr_b16 v[146:147], v204 offset:36864
    ds_read_b64_tr_b16 v[148:149], v205 offset:32768
    ds_read_b64_tr_b16 v[150:151], v205 offset:36864
    ds_read_b64_tr_b16 v[152:153], v206 offset:32768
    ds_read_b64_tr_b16 v[154:155], v206 offset:36864
    s_waitcnt lgkmcnt(12)
    v_mfma_f32_16x16x32_bf16 v[64:67], v[124:127], v[128:131], v[64:67]
    ds_read_b64_tr_b16 v[156:157], v207 offset:32768
    ds_read_b64_tr_b16 v[158:159], v207 offset:36864
    s_waitcnt lgkmcnt(12)
    v_mfma_f32_16x16x32_bf16 v[68:71], v[124:127], v[132:135], v[68:71]
    s_waitcnt lgkmcnt(10)
    v_mfma_f32_16x16x32_bf16 v[72:75], v[124:127], v[136:139], v[72:75]
    s_waitcnt lgkmcnt(8)
    v_mfma_f32_16x16x32_bf16 v[76:79], v[124:127], v[140:143], v[76:79]
    s_waitcnt lgkmcnt(6)
    v_mfma_f32_16x16x32_bf16 v[80:83], v[124:127], v[144:147], v[80:83]
    s_waitcnt lgkmcnt(4)
    v_mfma_f32_16x16x32_bf16 v[84:87], v[124:127], v[148:151], v[84:87]
    s_waitcnt lgkmcnt(2)
    v_mfma_f32_16x16x32_bf16 v[88:91], v[124:127], v[152:155], v[88:91]
    s_waitcnt lgkmcnt(0)
    v_mfma_f32_16x16x32_bf16 v[92:95], v[124:127], v[156:159], v[92:95]
    v_cndmask_b32 v64, v64, v68, s[60:61]
    v_cndmask_b32 v64, v64, v72, s[62:63]
    v_cndmask_b32 v64, v64, v76, s[72:73]
    v_and_or_b32 v224, v64, s74, v212
    v_cndmask_b32 v80, v80, v84, s[60:61]
    s_nop 0
    v_cndmask_b32 v80, v80, v88, s[62:63]
    s_nop 0
    v_cndmask_b32 v80, v80, v92, s[72:73]
    v_and_or_b32 v225, v80, s74, v212
    buffer_store_dword v224, v13, s[12:15], s30 offen offset:0
    buffer_store_dword v225, v13, s[12:15], s30 offen offset:256
    s_cmp_eq_u32 s66, 1
    s_cbranch_scc1 x_start
    s_barrier
    s_barrier
    ds_read_b64_tr_b16 v[128:129], v208 offset:0
    ds_read_b64_tr_b16 v[130:131], v208 offset:2048
    ds_read_b64_tr_b16 v[132:133], v209 offset:0
    ds_read_b64_tr_b16 v[134:135], v209 offset:2048
    ds_read_b64_tr_b16 v[136:137], v210 offset:0
    ds_read_b64_tr_b16 v[138:139], v210 offset:2048
    ds_read_b64_tr_b16 v[140:141], v211 offset:0
    ds_read_b64_tr_b16 v[142:143], v211 offset:2048
    ds_read_b64_tr_b16 v[144:145], v208 offset:16384
    ds_read_b64_tr_b16 v[146:147], v208 offset:18432
    ds_read_b64_tr_b16 v[148:149], v209 offset:16384
    ds_read_b64_tr_b16 v[150:151], v209 offset:18432
    ds_read_b64_tr_b16 v[152:153], v210 offset:16384
    ds_read_b64_tr_b16 v[154:155], v210 offset:18432
    s_waitcnt lgkmcnt(12)
    v_mfma_f32_16x16x32_bf16 v[64:67], v[120:123], v[128:131], 0
    ds_read_b64_tr_b16 v[156:157], v211 offset:16384
    ds_read_b64_tr_b16 v[158:159], v211 offset:18432
    s_waitcnt lgkmcnt(12)
    v_mfma_f32_16x16x32_bf16 v[68:71], v[120:123], v[132:135], 0
    s_waitcnt lgkmcnt(10)
    v_mfma_f32_16x16x32_bf16 v[72:75], v[120:123], v[136:139], 0
    s_waitcnt lgkmcnt(8)
    v_mfma_f32_16x16x32_bf16 v[76:79], v[120:123], v[140:143], 0
    s_waitcnt lgkmcnt(6)
    v_mfma_f32_16x16x32_bf16 v[64:67], v[124:127], v[144:147], v[64:67]
    s_waitcnt lgkmcnt(4)
    v_mfma_f32_16x16x32_bf16 v[68:71], v[124:127], v[148:151], v[68:71]
    s_waitcnt lgkmcnt(2)
    v_mfma_f32_16x16x32_bf16 v[72:75], v[124:127], v[152:155], v[72:75]
    s_waitcnt lgkmcnt(0)
    v_mfma_f32_16x16x32_bf16 v[76:79], v[124:127], v[156:159], v[76:79]
    s_nop 3
    v_cndmask_b32 v64, v64, v68, s[60:61]
    s_nop 0
    v_cndmask_b32 v64, v64, v72, s[62:63]
    s_nop 0
    v_cndmask_b32 v64, v64, v76, s[72:73]
    v_and_or_b32 v226, v64, s74, v212
    buffer_store_dword v226, v13, s[12:15], s31 offen offset:0
    s_barrier
    s_bitcmp1_b32 s16, 0
    s_cselect_b32 s8, s52, s50
    s_cselect_b32 s9, s53, s51
    s_mov_b32 s10, 7340032
    s_lshr_b32 s42, s8, 7
    s_sub_u32 s42, 3, s42
    s_add_u32 s42, s42, s34
    s_and_b32 s42, s42, 7
    s_cmp_eq_u32 s42, 7
    s_cbranch_scc1 m_nh2
    s_mul_i32 s43, s34, 7
    s_add_u32 s42, s42, s43
    s_lshl_b32 s42, s42, 7
    s_lshl_b32 s43, s35, 1
    s_lshr_b32 s40, s16, 1
    s_add_u32 s43, s43, s40
    s_mul_i32 s43, s43, 265216
    s_add_u32 s42, s42, s43
    v_mul_u32_u24 v24, 7168, v2
    s_mov_b32 exec_lo, 4294967295
    s_mov_b32 exec_hi, 31
    buffer_load_dword v245, v24, s[8:11], s42 offen
    s_mov_b64 exec, -1
m_nh2:
    s_barrier
    ds_read_b64_tr_b16 v[64:65], v12 offset:0
    ds_read_b64_tr_b16 v[66:67], v12 offset:2048
    ds_read_b64_tr_b16 v[68:69], v12 offset:4096
    ds_read_b64_tr_b16 v[70:71], v12 offset:6144
    ds_read_b64_tr_b16 v[72:73], v12 offset:8192
    ds_read_b64_tr_b16 v[74:75], v12 offset:10240
    ds_read_b64_tr_b16 v[76:77], v12 offset:12288
    ds_read_b64_tr_b16 v[78:79], v12 offset:14336
    ds_read_b64_tr_b16 v[80:81], v12 offset:16384
    ds_read_b64_tr_b16 v[82:83], v12 offset:18432
    ds_read_b64_tr_b16 v[84:85], v12 offset:20480
    ds_read_b64_tr_b16 v[86:87], v12 offset:22528
    ds_read_b64_tr_b16 v[88:89], v12 offset:24576
    ds_read_b64_tr_b16 v[90:91], v12 offset:26624
    ds_read_b64_tr_b16 v[92:93], v12 offset:28672
    ds_read_b64_tr_b16 v[94:95], v12 offset:30720
    s_waitcnt vmcnt(0)
    s_barrier
    s_sub_u32 s42, s16, 1
    s_cmp_ge_u32 s42, 3
    s_cbranch_scc1 m_nb
    s_lshl_b32 s42, s42, 10
    s_add_u32 s42, s42, s29
    s_add_u32 s43, s42, 524288
    buffer_load_dwordx4 v[44:47], v3, s[12:15], s42 offen sc1
    s_waitcnt vmcnt(0)
    buffer_store_dwordx4 v[44:47], v3, s[12:15], s43 offen sc1
m_nb:
m_join:
    v_bfe_u32 v7, v0, 4, 2
    v_and_b32 v6, 3, v0
    v_mul_u32_u24 v17, 576, v6
    v_lshl_add_u32 v17, v16, 8, v17
    v_lshl_add_u32 v17, v7, 4, v17
    v_add_u32 v17, 131072, v17
    v_cmp_lt_u32 vcc, 1, v6
    v_mov_b32 v19, 0x44444444
    v_mov_b32 v22, 0xeeeeeeee
    v_cndmask_b32 v19, v19, v22, vcc
    v_and_b32 v6, 15, v0
    v_lshlrev_b32 v13, 5, v6
    v_bfe_u32 v22, v0, 4, 1
    v_lshl_add_u32 v13, v22, 4, v13
    v_bfe_u32 v22, v0, 5, 1
    v_lshl_add_u32 v13, v22, 3, v13
    v_mul_u32_u24 v22, 576, v1
    v_add_u32 v13, v13, v22
    v_add_u32 v13, 131072, v13
    s_lshl_b32 s70, s34, 1
    s_add_u32 s70, s70, s16
    s_lshl_b32 s70, s70, 13
    s_lshl_b32 s71, s65, 11
    s_add_u32 s70, s70, s71
    s_add_u32 s70, s70, 17301504
    s_mov_b32 s71, 0x07060302
    s_lshl_b32 s69, s64, 2
    s_and_b32 s42, s16, 3
    s_add_u32 s69, s69, s42
    s_lshl_b32 s69, s69, 10
    s_lshl_b32 s76, s65, 1
    s_lshr_b32 s42, s16, 2
    s_add_u32 s76, s76, s42
    s_lshl_b32 s76, s76, 8
    s_add_u32 s76, s76, s69
    s_add_u32 s77, s76, 18612224
    s_add_u32 s76, s76, 18350080
    s_add_u32 s69, s69, 18350080
    s_cmp_lg_u32 s16, 2
    s_cbranch_scc1 m_n0
    v_lshlrev_b32 v4, 7, v2
    s_sub_u32 s69, s69, 2048
    s_mov_b32 exec_hi, 0
    buffer_load_dword v5, v4, s[12:15], s69 offen sc1
    s_mov_b32 exec_hi, -1
m_n0:
    s_cmp_ge_u32 s16, 2
    s_cbranch_scc1 m_n1
    v_lshlrev_b32 v4, 7, v2
    s_mov_b64 exec, 0xffff
    buffer_load_dword v5, v4, s[12:15], s70 offen sc1
    s_mov_b64 exec, -1
m_n1:
    v_mov_b32 v216, s32
    v_mov_b32 v217, s33
    v_and_b32 v218, 1, v0
    v_cmp_eq_u32 vcc, 1, v218
    s_nop 1
    v_cndmask_b32 v216, v216, v217, vcc
    v_bfe_u32 v217, v216, 8, 8
    v_bfe_u32 v218, v216, 16, 8
    v_lshrrev_b32 v219, 24, v216
    v_and_b32 v216, 0xff, v216
    s_and_b32 s60, s32, 0xffff
    s_lshr_b32 s61, s32, 16
    s_and_b32 s62, s33, 0xffff
    s_lshr_b32 s63, s33, 16
    s_movk_i32 s74, 0xff00
    s_waitcnt vmcnt(0)
    s_barrier
    s_cmp_ge_u32 s16, 2
    s_cselect_b64 exec, 1, -1
    buffer_load_dwordx4 v[176:179], v3, s[12:15], s70 offen sc1
    buffer_load_dwordx4 v[180:183], v3, s[12:15], s70 offen offset:1024 sc1
    s_mov_b64 exec, -1
    ds_read_b64_tr_b16 v[96:97], v21 offset:0
    ds_read_b64_tr_b16 v[98:99], v21 offset:2048
    ds_read_b64_tr_b16 v[100:101], v21 offset:4096
    ds_read_b64_tr_b16 v[102:103], v21 offset:6144
    ds_read_b64_tr_b16 v[104:105], v21 offset:8192
    ds_read_b64_tr_b16 v[106:107], v21 offset:10240
    ds_read_b64_tr_b16 v[108:109], v21 offset:12288
    ds_read_b64_tr_b16 v[110:111], v21 offset:14336
    ds_read_b64_tr_b16 v[112:113], v21 offset:16384
    ds_read_b64_tr_b16 v[114:115], v21 offset:18432
    ds_read_b64_tr_b16 v[116:117], v21 offset:20480
    ds_read_b64_tr_b16 v[118:119], v21 offset:22528
    ds_read_b64_tr_b16 v[120:121], v21 offset:24576
    ds_read_b64_tr_b16 v[122:123], v21 offset:26624
    ds_read_b64_tr_b16 v[124:125], v21 offset:28672
    ds_read_b64_tr_b16 v[126:127], v21 offset:30720
    v_mov_b32 v160, 0
    v_mov_b32 v161, 0
    v_mov_b32 v162, 0
    v_mov_b32 v163, 0
    v_mov_b32 v164, 0
    v_mov_b32 v165, 0
    v_mov_b32 v166, 0
    v_mov_b32 v167, 0
    s_cbranch_scc1 m_nk
    s_mov_b32 s83, 0
    s_branch m_ph
m_pr:
    s_and_b32 s42, s83, 63
    s_cmp_eq_u32 s42, 63
    s_cselect_b32 s42, 131072, 0
    s_add_u32 s42, s42, s70
    buffer_load_dwordx4 v[176:179], v3, s[12:15], s42 offen sc1
    buffer_load_dwordx4 v[180:183], v3, s[12:15], s42 offen offset:1024 sc1
    s_add_u32 s83, s83, 1
    s_cmp_ge_u32 s83, 0x40000
    s_cbranch_scc1 m_phx
m_ph:
    s_waitcnt vmcnt(0)
    v_cmp_ne_u16 vcc, s63, v183
    s_cbranch_vccnz m_pr
    v_perm_b32 v184, v177, v176, s71
    v_perm_b32 v186, v179, v178, s71
    v_perm_b32 v185, v181, v180, s71
    v_perm_b32 v187, v183, v182, s71
    ds_write2_b64 v13, v[184:185], v[186:187] offset0:0 offset1:144
    v_xor_b32 v176, s60, v176
    v_xor_b32 v177, s61, v177
    v_xor_b32 v178, s62, v178
    v_xor_b32 v179, s63, v179
    v_xor_b32 v180, s60, v180
    v_xor_b32 v181, s61, v181
    v_xor_b32 v182, s62, v182
    v_xor_b32 v183, s63, v183
    v_or3_b32 v4, v176, v177, 0
    v_or3_b32 v4, v178, v179, v4
    v_or3_b32 v4, v180, v181, v4
    v_or3_b32 v4, v182, v183, v4
    v_cmp_ne_u16 vcc, 0, v4
    s_cbranch_vccnz m_pr
m_phx:
m_nk:
    s_waitcnt lgkmcnt(0)
    s_barrier
    ds_read_b128 v[128:131], v17 offset:0
    ds_read_b128 v[132:135], v17 offset:64
    ds_read_b128 v[136:139], v17 offset:128
    ds_read_b128 v[140:143], v17 offset:192
    s_waitcnt lgkmcnt(3)
    v_smfmac_f32_16x16x64_bf16 v[160:163], v[128:131], v[64:71], v19
    v_smfmac_f32_16x16x64_bf16 v[164:167], v[128:131], v[96:103], v19
    s_waitcnt lgkmcnt(2)
    v_smfmac_f32_16x16x64_bf16 v[160:163], v[132:135], v[72:79], v19
    v_smfmac_f32_16x16x64_bf16 v[164:167], v[132:135], v[104:111], v19
    s_waitcnt lgkmcnt(1)
    v_smfmac_f32_16x16x64_bf16 v[160:163], v[136:139], v[80:87], v19
    v_smfmac_f32_16x16x64_bf16 v[164:167], v[136:139], v[112:119], v19
    s_waitcnt lgkmcnt(0)
    v_smfmac_f32_16x16x64_bf16 v[160:163], v[140:143], v[88:95], v19
    v_smfmac_f32_16x16x64_bf16 v[164:167], v[140:143], v[120:127], v19
    s_nop 6
    v_pk_add_f32 v[160:161], v[160:161], v[162:163]
    v_pk_add_f32 v[164:165], v[164:165], v[166:167]
    v_and_or_b32 v184, v160, s74, v216
    v_and_or_b32 v185, v161, s74, v217
    v_and_or_b32 v186, v164, s74, v218
    v_and_or_b32 v187, v165, s74, v219
    s_mov_b64 exec, 0xffff
    buffer_store_dwordx4 v[184:187], v3, s[12:15], s76 offen
    buffer_store_dwordx4 v[184:187], v3, s[12:15], s77 offen sc1
    s_mov_b64 exec, -1
    s_cmp_eq_u32 s16, 0
    s_cbranch_scc1 r_start
g_end:
    s_endpgm
x_start:
    s_mov_b32 s83, 0
x_g0:
    s_and_b32 s42, s83, 63
    s_cmp_eq_u32 s42, 63
    s_cselect_b32 s42, 524288, 0
    s_add_u32 s42, s42, s81
    s_add_u32 s43, s42, 4096
    buffer_load_dwordx4 v[32:35], v3, s[12:15], s42 offen sc1
    buffer_load_dwordx4 v[36:39], v3, s[12:15], s43 offen sc1
    s_waitcnt vmcnt(0)
    v_xor_b32 v32, v216, v32
    v_xor_b32 v33, v217, v33
    v_xor_b32 v34, v218, v34
    v_xor_b32 v35, v219, v35
    v_xor_b32 v36, v216, v36
    v_xor_b32 v37, v217, v37
    v_xor_b32 v38, v218, v38
    v_xor_b32 v39, v219, v39
    v_or3_b32 v17, v32, v33, 0
    v_or3_b32 v17, v34, v35, v17
    v_or3_b32 v17, v36, v37, v17
    v_or3_b32 v17, v38, v39, v17
    v_and_b32 v17, 0xff, v17
    v_cmp_ne_u32 vcc, 0, v17
    s_cbranch_vccz x_g0x
    s_and_b32 s42, s83, 63
    s_cmp_lg_u32 s42, 48
    s_cbranch_scc1 x_g0n
    s_add_u32 s43, s39, 524288
    buffer_load_dwordx4 v[44:47], v3, s[12:15], s39 offen offset:0 sc1
    s_waitcnt vmcnt(0)
    buffer_store_dwordx4 v[44:47], v3, s[12:15], s43 offen offset:0 sc1
    s_waitcnt vmcnt(0)
    buffer_load_dwordx4 v[44:47], v3, s[12:15], s39 offen offset:1024 sc1
    s_waitcnt vmcnt(0)
    buffer_store_dwordx4 v[44:47], v3, s[12:15], s43 offen offset:1024 sc1
    s_waitcnt vmcnt(0)
x_g0n:
    s_add_u32 s83, s83, 1
    s_cmp_lt_u32 s83, 0x40000
    s_cbranch_scc1 x_g0
x_g0x:
    v_pk_add_f32 v[32:33], v[32:33], v[36:37]
    v_pk_add_f32 v[34:35], v[34:35], v[38:39]
    ds_write_b128 v222, v[32:35] offset:0
    s_waitcnt lgkmcnt(0)
    s_barrier
    s_cmp_lg_u32 s16, 0
    s_cbranch_scc1 x_g0e
    ds_read_b128 v[160:163], v221 offset:0
    ds_read_b128 v[164:167], v221 offset:1024
    ds_read_b128 v[168:171], v221 offset:2048
    ds_read_b128 v[172:175], v221 offset:3072
    ds_read_b128 v[176:179], v221 offset:4096
    ds_read_b128 v[180:183], v221 offset:5120
    ds_read_b128 v[184:187], v221 offset:6144
    ds_read_b128 v[188:191], v221 offset:7168
    s_waitcnt lgkmcnt(6)
    v_pk_add_f32 v[160:161], v[160:161], v[164:165]
    v_pk_add_f32 v[162:163], v[162:163], v[166:167]
    s_waitcnt lgkmcnt(4)
    v_pk_add_f32 v[168:169], v[168:169], v[172:173]
    v_pk_add_f32 v[170:171], v[170:171], v[174:175]
    s_waitcnt lgkmcnt(2)
    v_pk_add_f32 v[176:177], v[176:177], v[180:181]
    v_pk_add_f32 v[178:179], v[178:179], v[182:183]
    s_waitcnt lgkmcnt(0)
    v_pk_add_f32 v[184:185], v[184:185], v[188:189]
    v_pk_add_f32 v[186:187], v[186:187], v[190:191]
    v_pk_add_f32 v[160:161], v[160:161], v[168:169]
    v_pk_add_f32 v[176:177], v[176:177], v[184:185]
    v_pk_add_f32 v[162:163], v[162:163], v[170:171]
    v_pk_add_f32 v[178:179], v[178:179], v[186:187]
    v_pk_add_f32 v[160:161], v[160:161], v[176:177]
    v_pk_add_f32 v[162:163], v[162:163], v[178:179]
    v_cvt_pk_bf16_f32 v17, v160, v161
    v_lshlrev_b32 v160, 16, v17
    v_and_b32 v161, 0xffff0000, v17
    v_cvt_pk_bf16_f32 v18, v162, v163
    v_lshlrev_b32 v162, 16, v18
    v_and_b32 v163, 0xffff0000, v18
    v_add_f32 v160, s28, v160
    v_add_f32 v161, s28, v161
    v_add_f32 v162, s28, v162
    v_add_f32 v163, s28, v163
    v_cvt_pk_bf16_f32 v17, v160, v161
    v_lshlrev_b32 v160, 16, v17
    v_and_b32 v161, 0xffff0000, v17
    v_cvt_pk_bf16_f32 v18, v162, v163
    v_lshlrev_b32 v162, 16, v18
    v_and_b32 v163, 0xffff0000, v18
    v_mov_b32 v48, s32
    v_mov_b32 v49, s33
    s_cmp_ge_u32 s64, 8
    s_cbranch_scc1 x_q
    v_and_or_b32 v168, v160, s74, v216
    v_and_or_b32 v169, v161, s74, v217
    v_and_or_b32 v170, v162, s74, v218
    v_and_or_b32 v171, v163, s74, v219
    buffer_store_dwordx4 v[168:171], v220, s[12:15], s22 offen sc1
    v_max3_f32 v50, abs(v160), abs(v161), abs(v162)
    v_max_f32_e64 v50, v50, abs(v163)
    s_nop 1
    v_max_f32_dpp v50, v50, v50 row_ror:8 row_mask:0xf bank_mask:0xf
    s_nop 1
    v_max_f32_dpp v50, v50, v50 row_ror:4 row_mask:0xf bank_mask:0xf
    s_nop 1
    v_max_f32_dpp v50, v50, v50 row_ror:2 row_mask:0xf bank_mask:0xf
    s_nop 1
    v_max_f32_dpp v50, v50, v50 row_ror:1 row_mask:0xf bank_mask:0xf
    s_nop 1
    v_max_f32_dpp v50, v50, v50 row_bcast:15 row_mask:0xa bank_mask:0xf
    s_nop 1
    v_max_f32_dpp v50, v50, v50 row_bcast:31 row_mask:0xc bank_mask:0xf
    s_nop 0
    v_readlane_b32 s42, v50, 63
    s_nop 1
    v_mov_b32 v50, s42
    s_mov_b64 exec, 0xff
    buffer_store_dwordx4 v[48:51], v3, s[12:15], s79 offen sc1
    s_mov_b64 exec, -1
    s_branch x_g0e
x_q:
    s_cmp_lt_u32 s64, 12
    s_cbranch_scc1 x_nq
    v_lshlrev_b32 v164, 16, v52
    v_and_b32 v165, 0xffff0000, v52
    v_lshlrev_b32 v166, 16, v53
    v_and_b32 v167, 0xffff0000, v53
    v_pk_mul_f32 v[164:165], v[164:165], v[160:161]
    v_pk_mul_f32 v[166:167], v[166:167], v[162:163]
    ds_bpermute_b32 v180, v232, v164
    v_and_or_b32 v176, v164, s74, v216
    v_and_or_b32 v177, v165, s74, v217
    v_and_or_b32 v178, v166, s74, v218
    v_and_or_b32 v179, v167, s74, v219
    buffer_store_dwordx4 v[176:179], v220, s[12:15], s75 offen sc1
    v_and_or_b32 v181, v167, s74, v229
    v_and_or_b32 v182, v166, s74, v230
    v_and_or_b32 v183, v165, s74, v231
    s_waitcnt lgkmcnt(0)
    v_and_or_b32 v180, v180, s74, v228
    buffer_store_dwordx4 v[180:183], v234, s[12:15], s75 offen sc1
    v_and_b32 v164, s74, v164
    v_and_b32 v165, s74, v165
    v_and_b32 v166, s74, v166
    v_and_b32 v167, s74, v167
    v_pk_add_f32 v[164:165], v[164:165], v[166:167]
    v_add_f32 v50, v164, v165
    s_nop 1
    v_add_f32_dpp v50, v50, v50 row_ror:8 row_mask:0xf bank_mask:0xf
    s_nop 1
    v_add_f32_dpp v50, v50, v50 row_ror:4 row_mask:0xf bank_mask:0xf
    s_nop 1
    v_add_f32_dpp v50, v50, v50 row_ror:2 row_mask:0xf bank_mask:0xf
    s_nop 1
    v_add_f32_dpp v50, v50, v50 row_ror:1 row_mask:0xf bank_mask:0xf
    s_nop 1
    v_add_f32_dpp v50, v50, v50 row_bcast:15 row_mask:0xa bank_mask:0xf
    s_nop 1
    v_add_f32_dpp v50, v50, v50 row_bcast:31 row_mask:0xc bank_mask:0xf
    s_nop 0
    v_readlane_b32 s42, v50, 63
    s_nop 1
    v_mov_b32 v50, s42
    s_mov_b64 exec, 0xff
    buffer_store_dwordx4 v[48:51], v3, s[12:15], s79 offen sc1
    s_mov_b64 exec, -1
x_nq:
    ds_bpermute_b32 v172, v232, v160
    v_and_or_b32 v168, v160, s74, v216
    v_and_or_b32 v169, v161, s74, v217
    v_and_or_b32 v170, v162, s74, v218
    v_and_or_b32 v171, v163, s74, v219
    buffer_store_dwordx4 v[168:171], v220, s[12:15], s22 offen sc1
    v_and_or_b32 v173, v163, s74, v229
    v_and_or_b32 v174, v162, s74, v230
    v_and_or_b32 v175, v161, s74, v231
    s_waitcnt lgkmcnt(0)
    v_and_or_b32 v172, v172, s74, v228
    buffer_store_dwordx4 v[172:175], v234, s[12:15], s22 offen sc1
x_g0e:
    s_barrier
    s_cmp_lt_u32 s16, 4
    s_cbranch_scc1 x_t1
    v_xor_b32 v4, 0, v14
    s_add_u32 s43, s68, 98304
    s_mov_b32 m0, s43
    s_add_u32 s42, s19, 0
    buffer_load_dwordx4 v4, s[8:11], s42 offen nt lds
    v_xor_b32 v4, 64, v14
    s_add_u32 s43, s68, 99328
    s_mov_b32 m0, s43
    s_add_u32 s42, s19, 24576
    buffer_load_dwordx4 v4, s[8:11], s42 offen nt lds
    v_xor_b32 v4, 0, v14
    s_add_u32 s43, s68, 100352
    s_mov_b32 m0, s43
    s_add_u32 s42, s19, 49152
    buffer_load_dwordx4 v4, s[8:11], s42 offen nt lds
    v_xor_b32 v4, 64, v14
    s_add_u32 s43, s68, 101376
    s_mov_b32 m0, s43
    s_add_u32 s42, s19, 73728
    buffer_load_dwordx4 v4, s[8:11], s42 offen nt lds
    v_xor_b32 v4, 128, v14
    s_add_u32 s43, s68, 102400
    s_mov_b32 m0, s43
    s_add_u32 s42, s19, 98304
    buffer_load_dwordx4 v4, s[8:11], s42 offen nt lds
    v_xor_b32 v4, 192, v14
    s_add_u32 s43, s68, 103424
    s_mov_b32 m0, s43
    s_add_u32 s42, s19, 122880
    buffer_load_dwordx4 v4, s[8:11], s42 offen nt lds
    v_xor_b32 v4, 128, v14
    s_add_u32 s43, s68, 104448
    s_mov_b32 m0, s43
    s_add_u32 s42, s19, 147456
    buffer_load_dwordx4 v4, s[8:11], s42 offen nt lds
    v_xor_b32 v4, 192, v14
    s_add_u32 s43, s68, 105472
    s_mov_b32 m0, s43
    s_add_u32 s42, s19, 172032
    buffer_load_dwordx4 v4, s[8:11], s42 offen nt lds
    s_waitcnt vmcnt(0)
    s_barrier
    s_branch x_t2
x_t1:
    s_barrier
    ds_read_b64_tr_b16 v[128:129], v208 offset:0
    ds_read_b64_tr_b16 v[130:131], v208 offset:2048
    ds_read_b64_tr_b16 v[132:133], v209 offset:0
    ds_read_b64_tr_b16 v[134:135], v209 offset:2048
    ds_read_b64_tr_b16 v[136:137], v210 offset:0
    ds_read_b64_tr_b16 v[138:139], v210 offset:2048
    ds_read_b64_tr_b16 v[140:141], v211 offset:0
    ds_read_b64_tr_b16 v[142:143], v211 offset:2048
    ds_read_b64_tr_b16 v[144:145], v208 offset:16384
    ds_read_b64_tr_b16 v[146:147], v208 offset:18432
    ds_read_b64_tr_b16 v[148:149], v209 offset:16384
    ds_read_b64_tr_b16 v[150:151], v209 offset:18432
    ds_read_b64_tr_b16 v[152:153], v210 offset:16384
    ds_read_b64_tr_b16 v[154:155], v210 offset:18432
    s_waitcnt lgkmcnt(12)
    v_mfma_f32_16x16x32_bf16 v[64:67], v[120:123], v[128:131], 0
    ds_read_b64_tr_b16 v[156:157], v211 offset:16384
    ds_read_b64_tr_b16 v[158:159], v211 offset:18432
    s_waitcnt lgkmcnt(12)
    v_mfma_f32_16x16x32_bf16 v[68:71], v[120:123], v[132:135], 0
    s_waitcnt lgkmcnt(10)
    v_mfma_f32_16x16x32_bf16 v[72:75], v[120:123], v[136:139], 0
    s_waitcnt lgkmcnt(8)
    v_mfma_f32_16x16x32_bf16 v[76:79], v[120:123], v[140:143], 0
    s_waitcnt lgkmcnt(6)
    v_mfma_f32_16x16x32_bf16 v[64:67], v[124:127], v[144:147], v[64:67]
    s_waitcnt lgkmcnt(4)
    v_mfma_f32_16x16x32_bf16 v[68:71], v[124:127], v[148:151], v[68:71]
    s_waitcnt lgkmcnt(2)
    v_mfma_f32_16x16x32_bf16 v[72:75], v[124:127], v[152:155], v[72:75]
    s_waitcnt lgkmcnt(0)
    v_mfma_f32_16x16x32_bf16 v[76:79], v[124:127], v[156:159], v[76:79]
    s_nop 3
    v_cndmask_b32 v64, v64, v68, s[60:61]
    s_nop 0
    v_cndmask_b32 v64, v64, v72, s[62:63]
    s_nop 0
    v_cndmask_b32 v64, v64, v76, s[72:73]
    v_and_or_b32 v226, v64, s74, v212
    buffer_store_dword v226, v13, s[12:15], s31 offen offset:0
x_t2:
    s_mov_b32 s83, 0
x_g1:
    s_and_b32 s42, s83, 63
    s_cmp_eq_u32 s42, 63
    s_cselect_b32 s42, 524288, 0
    s_add_u32 s42, s42, s80
    buffer_load_dwordx4 v[32:35], v223, s[12:15], s42 offen offset:2048 sc1
    s_waitcnt vmcnt(0)
    v_xor_b32 v32, v216, v32
    v_xor_b32 v33, v217, v33
    v_xor_b32 v34, v218, v34
    v_xor_b32 v35, v219, v35
    v_or3_b32 v17, v32, v33, 0
    v_or3_b32 v17, v34, v35, v17
    v_and_b32 v17, 0xff, v17
    v_cmp_ne_u32 vcc, 0, v17
    s_cbranch_vccz x_g1x
    s_and_b32 s42, s83, 63
    s_cmp_lg_u32 s42, 48
    s_cbranch_scc1 x_g1n
    s_add_u32 s43, s39, 524288
    buffer_load_dwordx4 v[44:47], v3, s[12:15], s39 offen offset:0 sc1
    s_waitcnt vmcnt(0)
    buffer_store_dwordx4 v[44:47], v3, s[12:15], s43 offen offset:0 sc1
    s_waitcnt vmcnt(0)
    buffer_load_dwordx4 v[44:47], v3, s[12:15], s39 offen offset:1024 sc1
    s_waitcnt vmcnt(0)
    buffer_store_dwordx4 v[44:47], v3, s[12:15], s43 offen offset:1024 sc1
    s_waitcnt vmcnt(0)
    buffer_load_dwordx4 v[44:47], v3, s[12:15], s39 offen offset:2048 sc1
    s_waitcnt vmcnt(0)
    buffer_store_dwordx4 v[44:47], v3, s[12:15], s43 offen offset:2048 sc1
    s_waitcnt vmcnt(0)
x_g1n:
    s_add_u32 s83, s83, 1
    s_cmp_lt_u32 s83, 0x40000
    s_cbranch_scc1 x_g1
x_g1x:
    ds_write_b128 v222, v[32:35] offset:8192
    s_waitcnt lgkmcnt(0)
    s_barrier
    s_cmp_lg_u32 s16, 0
    s_cbranch_scc1 x_g1e
    ds_read_b128 v[160:163], v221 offset:8192
    ds_read_b128 v[164:167], v221 offset:9216
    ds_read_b128 v[168:171], v221 offset:10240
    ds_read_b128 v[172:175], v221 offset:11264
    ds_read_b128 v[176:179], v221 offset:12288
    ds_read_b128 v[180:183], v221 offset:13312
    ds_read_b128 v[184:187], v221 offset:14336
    ds_read_b128 v[188:191], v221 offset:15360
    s_waitcnt lgkmcnt(6)
    v_pk_add_f32 v[160:161], v[160:161], v[164:165]
    v_pk_add_f32 v[162:163], v[162:163], v[166:167]
    s_waitcnt lgkmcnt(4)
    v_pk_add_f32 v[168:169], v[168:169], v[172:173]
    v_pk_add_f32 v[170:171], v[170:171], v[174:175]
    s_waitcnt lgkmcnt(2)
    v_pk_add_f32 v[176:177], v[176:177], v[180:181]
    v_pk_add_f32 v[178:179], v[178:179], v[182:183]
    s_waitcnt lgkmcnt(0)
    v_pk_add_f32 v[184:185], v[184:185], v[188:189]
    v_pk_add_f32 v[186:187], v[186:187], v[190:191]
    v_pk_add_f32 v[160:161], v[160:161], v[168:169]
    v_pk_add_f32 v[176:177], v[176:177], v[184:185]
    v_pk_add_f32 v[162:163], v[162:163], v[170:171]
    v_pk_add_f32 v[178:179], v[178:179], v[186:187]
    v_pk_add_f32 v[160:161], v[160:161], v[176:177]
    v_pk_add_f32 v[162:163], v[162:163], v[178:179]
    v_mov_b32 v164, v160
    v_mov_b32 v165, v161
    v_mov_b32 v166, v162
    v_mov_b32 v167, v163
    v_permlane32_swap_b32 v160, v164
    v_permlane32_swap_b32 v161, v165
    v_permlane32_swap_b32 v162, v166
    v_permlane32_swap_b32 v163, v167
    v_pk_add_f32 v[160:161], v[160:161], v[164:165]
    v_pk_add_f32 v[162:163], v[162:163], v[166:167]
    v_cvt_pk_bf16_f32 v17, v160, v161
    v_lshlrev_b32 v160, 16, v17
    v_and_b32 v161, 0xffff0000, v17
    v_cvt_pk_bf16_f32 v18, v162, v163
    v_lshlrev_b32 v162, 16, v18
    v_and_b32 v163, 0xffff0000, v18
    s_mov_b32 exec_hi, 0
    ds_bpermute_b32 v172, v232, v160
    v_and_or_b32 v168, v160, s74, v216
    v_and_or_b32 v169, v161, s74, v217
    v_and_or_b32 v170, v162, s74, v218
    v_and_or_b32 v171, v163, s74, v219
    buffer_store_dwordx4 v[168:171], v233, s[12:15], s23 offen sc1
    v_and_or_b32 v173, v163, s74, v229
    v_and_or_b32 v174, v162, s74, v230
    v_and_or_b32 v175, v161, s74, v231
    s_waitcnt lgkmcnt(0)
    v_and_or_b32 v172, v172, s74, v228
    buffer_store_dwordx4 v[172:175], v235, s[12:15], s23 offen sc1
    s_mov_b32 exec_hi, -1
x_g1e:
    s_sub_u32 s42, s16, 1
    s_cmp_ge_u32 s42, 3
    s_cbranch_scc1 x_nb
    s_lshl_b32 s42, s42, 10
    s_add_u32 s42, s42, s29
    s_add_u32 s43, s42, 524288
    buffer_load_dwordx4 v[44:47], v3, s[12:15], s42 offen sc1
    s_waitcnt vmcnt(0)
    buffer_store_dwordx4 v[44:47], v3, s[12:15], s43 offen sc1
x_nb:
    s_cmp_lg_u32 s16, 0
    s_cbranch_scc1 g_end
    s_lshl_b32 s78, s34, 14
    s_add_u32 s78, s78, 17039360
    s_lshl_b32 s79, s34, 11
    s_add_u32 s79, s79, s78
    s_add_u32 s79, s79, 1800
    v_mov_b32 v22, 0
    s_mov_b32 s56, s48
    s_mov_b32 s57, s49
    s_mov_b32 s58, 2048
    s_mov_b32 s59, 0x00020000
    s_and_b32 s60, s32, 0xffff
    s_lshr_b32 s61, s32, 16
    s_and_b32 s62, s33, 0xffff
    s_lshr_b32 s63, s33, 16
    s_bfe_u32 s44, s32, 524288
    s_bfe_u32 s45, s32, 524296
    s_bfe_u32 s46, s32, 524304
    s_bfe_u32 s47, s32, 524312
    s_bfe_u32 s48, s33, 524288
    s_bfe_u32 s49, s33, 524296
    s_bfe_u32 s50, s33, 524304
    s_bfe_u32 s51, s33, 524312
    v_and_b32 v9, 15, v0
    v_lshlrev_b32 v9, 6, v9
    v_bfe_u32 v19, v0, 4, 1
    v_lshl_add_u32 v9, v19, 5, v9
    v_lshlrev_b32 v18, 9, v19
    v_bfe_u32 v19, v0, 5, 1
    v_lshl_add_u32 v9, v19, 4, v9
    v_lshl_add_u32 v18, v19, 11, v18
    v_bfe_u32 v19, v0, 2, 2
    v_lshl_add_u32 v18, v19, 7, v18
    v_lshl_add_u32 v18, v15, 4, v18
    s_mov_b32 s43, 16908288
    s_lshl_b32 s70, s64, 13
    s_add_u32 s70, s70, 17301504
    s_add_u32 s71, s70, 131072
    s_add_u32 s72, s70, 4096
    s_add_u32 s73, s71, 4096
    v_mov_b32 v21, 0xffff0000
    buffer_load_dwordx4 v[92:95], v9, s[56:59], 0 offen offset:0
    buffer_load_dwordx4 v[96:99], v9, s[56:59], 0 offen offset:1024
    s_mov_b32 s76, s43
    s_sub_u32 s42, s43, 8192
    s_mov_b32 s83, 0
x_cb:
    buffer_load_dwordx4 v[116:119], v18, s[12:15], s42 offen offset:0 sc1
    buffer_load_dwordx4 v[120:123], v18, s[12:15], s42 offen offset:1024 sc1
    buffer_load_dwordx4 v[124:127], v18, s[12:15], s42 offen offset:64 sc1
    buffer_load_dwordx4 v[128:131], v18, s[12:15], s42 offen offset:1088 sc1
    s_mov_b64 exec, 1
    buffer_load_dwordx2 v[28:29], v22, s[12:15], s79 offen sc1
    s_mov_b64 exec, -1
    s_waitcnt vmcnt(0)
    v_xor_b32 v116, v216, v116
    v_xor_b32 v117, v217, v117
    v_xor_b32 v118, v218, v118
    v_xor_b32 v119, v219, v119
    v_xor_b32 v120, v216, v120
    v_xor_b32 v121, v217, v121
    v_xor_b32 v122, v218, v122
    v_xor_b32 v123, v219, v123
    v_xor_b32 v124, v216, v124
    v_xor_b32 v125, v217, v125
    v_xor_b32 v126, v218, v126
    v_xor_b32 v127, v219, v127
    v_xor_b32 v128, v216, v128
    v_xor_b32 v129, v217, v129
    v_xor_b32 v130, v218, v130
    v_xor_b32 v131, v219, v131
    v_or3_b32 v19, v116, v117, 0
    v_or3_b32 v19, v118, v119, v19
    v_or3_b32 v19, v120, v121, v19
    v_or3_b32 v19, v122, v123, v19
    v_or3_b32 v19, v124, v125, v19
    v_or3_b32 v19, v126, v127, v19
    v_or3_b32 v19, v128, v129, v19
    v_or3_b32 v19, v130, v131, v19
    v_and_b32 v19, 0xff, v19
    v_cmp_ne_u32 vcc, 0, v19
    s_cbranch_vccz x_cbx
    s_sleep 8
    s_add_u32 s83, s83, 1
    s_cmp_lt_u32 s83, 0x40000
    s_cbranch_scc1 x_cb
x_cbx:
    v_lshlrev_b32 v48, 16, v92
    v_and_b32 v49, 0xffff0000, v92
    v_lshlrev_b32 v50, 16, v93
    v_and_b32 v51, 0xffff0000, v93
    v_lshlrev_b32 v52, 16, v94
    v_and_b32 v53, 0xffff0000, v94
    v_lshlrev_b32 v54, 16, v95
    v_and_b32 v55, 0xffff0000, v95
    v_lshlrev_b32 v56, 16, v96
    v_and_b32 v57, 0xffff0000, v96
    v_lshlrev_b32 v58, 16, v97
    v_and_b32 v59, 0xffff0000, v97
    v_lshlrev_b32 v60, 16, v98
    v_and_b32 v61, 0xffff0000, v98
    v_lshlrev_b32 v62, 16, v99
    v_and_b32 v63, 0xffff0000, v99
    s_mov_b64 exec, 1
    v_cmp_ne_u64 vcc, s[32:33], v[28:29]
    s_cbranch_vccz x_goy
    s_mov_b32 s83, 0
    s_mov_b64 exec, 1
x_go:
    buffer_load_dwordx2 v[28:29], v22, s[12:15], s79 offen sc1
    s_waitcnt vmcnt(0)
    v_cmp_ne_u64 vcc, s[32:33], v[28:29]
    s_cbranch_vccz x_goy
    s_sleep 1
    s_add_u32 s83, s83, 1
    s_cmp_lt_u32 s83, 0x40000
    s_cbranch_scc1 x_go
x_goy:
    s_mov_b64 exec, -1
x_gox:
    s_lshl_b32 s42, s65, 13
    s_add_u32 s78, s78, s42
    buffer_load_dwordx4 v[100:103], v18, s[12:15], s76 offen offset:0 sc1
    buffer_load_dwordx4 v[104:107], v18, s[12:15], s76 offen offset:1024 sc1
    buffer_load_dwordx4 v[108:111], v18, s[12:15], s76 offen offset:64 sc1
    buffer_load_dwordx4 v[112:115], v18, s[12:15], s76 offen offset:1088 sc1
    v_lshlrev_b32 v32, 7, v2
    s_xor_b32 s77, s78, 8192
    buffer_load_dwordx4 v[24:27], v32, s[12:15], s78 offen sc1
    buffer_load_dwordx4 v[28:31], v32, s[12:15], s77 offen sc1
    s_mov_b32 s83, 0
    s_waitcnt vmcnt(2)
x_sb:
    v_xor_b32 v100, v216, v100
    v_xor_b32 v101, v217, v101
    v_xor_b32 v102, v218, v102
    v_xor_b32 v103, v219, v103
    v_xor_b32 v104, v216, v104
    v_xor_b32 v105, v217, v105
    v_xor_b32 v106, v218, v106
    v_xor_b32 v107, v219, v107
    v_xor_b32 v108, v216, v108
    v_xor_b32 v109, v217, v109
    v_xor_b32 v110, v218, v110
    v_xor_b32 v111, v219, v111
    v_xor_b32 v112, v216, v112
    v_xor_b32 v113, v217, v113
    v_xor_b32 v114, v218, v114
    v_xor_b32 v115, v219, v115
    v_or3_b32 v19, v100, v101, 0
    v_or3_b32 v19, v102, v103, v19
    v_or3_b32 v19, v104, v105, v19
    v_or3_b32 v19, v106, v107, v19
    v_or3_b32 v19, v108, v109, v19
    v_or3_b32 v19, v110, v111, v19
    v_or3_b32 v19, v112, v113, v19
    v_or3_b32 v19, v114, v115, v19
    v_and_b32 v19, 0xff, v19
    v_cmp_ne_u32 vcc, 0, v19
    s_cbranch_vccnz x_sr
x_sbx:
    s_mov_b32 s41, 0
    s_mov_b32 s83, 0
    s_waitcnt vmcnt(0)
    v_cmp_ne_u64 s[52:53], s[32:33], v[26:27]
    v_cmp_ne_u64 s[54:55], s[32:33], v[30:31]
    s_or_b64 s[20:21], s[52:53], s[54:55]
    s_cbranch_scc0 x_all
x_pk:
    s_mov_b64 exec, s[52:53]
    s_cbranch_execz x_p2a
    buffer_load_dwordx4 v[24:27], v32, s[12:15], s78 offen sc1
x_p2a:
    s_mov_b64 exec, s[54:55]
    s_cbranch_execz x_p2b
    buffer_load_dwordx4 v[28:31], v32, s[12:15], s77 offen sc1
x_p2b:
    s_mov_b64 exec, -1
x_pc:
    s_waitcnt vmcnt(0)
    v_cmp_ne_u64 s[52:53], s[32:33], v[26:27]
    v_cmp_ne_u64 s[54:55], s[32:33], v[30:31]
    v_cmp_lt_u32 s[4:5], s41, v24
    v_cmp_lt_u32 s[6:7], s41, v25
    v_cmp_lt_u32 s[8:9], s41, v28
    v_cmp_lt_u32 s[10:11], s41, v29
    s_or_b64 s[20:21], s[52:53], s[54:55]
    s_cbranch_scc0 x_pkx
    s_add_u32 s83, s83, 1
    s_cmp_lt_u32 s83, 0x40000
    s_cbranch_scc1 x_pk
x_pkx:
    s_bcnt1_i32_b64 s4, s[4:5]
    s_bcnt1_i32_b64 s6, s[6:7]
    s_bcnt1_i32_b64 s8, s[8:9]
    s_bcnt1_i32_b64 s10, s[10:11]
    s_add_u32 s4, s4, s6
    s_add_u32 s8, s8, s10
    s_add_u32 s4, s4, s8
    s_cmp_lg_u32 s4, s65
    s_cbranch_scc1 x_all
    buffer_store_dwordx4 v[64:67], v3, s[12:15], s70 offen offset:0
    buffer_store_dwordx4 v[68:71], v3, s[12:15], s70 offen offset:1024
    buffer_store_dwordx4 v[72:75], v3, s[12:15], s70 offen offset:2048
    buffer_store_dwordx4 v[76:79], v3, s[12:15], s70 offen offset:3072
    s_branch x_phx
x_all:
    v_max_u32 v33, v24, v28
    v_min_u32 v34, v24, v28
    v_mov_b32 v35, v33
    v_max3_u32 v34, v34, v25, v29
    s_nop 0
    v_max_u32_dpp v35, v35, v35 row_ror:8 row_mask:0xf bank_mask:0xf
    s_nop 1
    v_max_u32_dpp v35, v35, v35 row_ror:4 row_mask:0xf bank_mask:0xf
    s_nop 1
    v_max_u32_dpp v35, v35, v35 row_ror:2 row_mask:0xf bank_mask:0xf
    s_nop 1
    v_max_u32_dpp v35, v35, v35 row_ror:1 row_mask:0xf bank_mask:0xf
    s_nop 1
    v_max_u32_dpp v35, v35, v35 row_bcast:15 row_mask:0xa bank_mask:0xf
    s_nop 1
    v_max_u32_dpp v35, v35, v35 row_bcast:31 row_mask:0xc bank_mask:0xf
    s_nop 0
    v_readlane_b32 s40, v35, 63
    s_cmp_eq_u32 s65, 0
    s_cbranch_scc1 x_b2
    v_cmp_eq_u32 vcc, s40, v33
    s_nop 1
    v_cndmask_b32 v35, v33, v34, vcc
    s_nop 1
    v_max_u32_dpp v35, v35, v35 row_ror:8 row_mask:0xf bank_mask:0xf
    s_nop 1
    v_max_u32_dpp v35, v35, v35 row_ror:4 row_mask:0xf bank_mask:0xf
    s_nop 1
    v_max_u32_dpp v35, v35, v35 row_ror:2 row_mask:0xf bank_mask:0xf
    s_nop 1
    v_max_u32_dpp v35, v35, v35 row_ror:1 row_mask:0xf bank_mask:0xf
    s_nop 1
    v_max_u32_dpp v35, v35, v35 row_bcast:15 row_mask:0xa bank_mask:0xf
    s_nop 1
    v_max_u32_dpp v35, v35, v35 row_bcast:31 row_mask:0xc bank_mask:0xf
    s_nop 0
    v_readlane_b32 s40, v35, 63
x_b2:
    s_bfe_u32 s42, s40, 0x70005
    s_bitcmp1_b32 s40, 0
    s_addc_u32 s42, s42, s42
    s_lshl_b32 s43, s42, 7
    s_lshl_b32 s42, s42, 12
    s_add_u32 s42, s42, 18874368
    s_add_u32 s43, s43, 17170432
    s_mov_b32 s83, 0
x_ph:
    s_mov_b64 exec, 1
    buffer_load_dwordx4 v[132:135], v22, s[12:15], s43 offen sc1
    s_mov_b64 exec, -1
    buffer_load_dwordx4 v[64:67], v3, s[12:15], s42 offen offset:0 sc1
    buffer_load_dwordx4 v[68:71], v3, s[12:15], s42 offen offset:1024 sc1
    buffer_load_dwordx4 v[72:75], v3, s[12:15], s42 offen offset:2048 sc1
    buffer_load_dwordx4 v[76:79], v3, s[12:15], s42 offen offset:3072 sc1
    s_waitcnt vmcnt(4)
    v_readfirstlane_b32 s22, v132
    v_readfirstlane_b32 s23, v133
    v_readfirstlane_b32 s20, v134
    v_readfirstlane_b32 s21, v135
    s_xor_b64 s[22:23], s[22:23], s[32:33]
    s_cbranch_scc1 x_pr
    s_waitcnt vmcnt(3)
    v_xor_b32 v64, s44, v64
    v_xor_b32 v65, s45, v65
    v_xor_b32 v66, s46, v66
    v_xor_b32 v67, s47, v67
    v_or3_b32 v19, v64, v65, v66
    v_or_b32 v19, v19, v67
    v_pk_fma_f32 v[64:65], v[64:65], s[20:21], s[20:21] op_sel:[0,1,0] op_sel_hi:[1,1,0]
    v_pk_fma_f32 v[66:67], v[66:67], s[20:21], s[20:21] op_sel:[0,1,0] op_sel_hi:[1,1,0]
    v_cmp_ne_u16_sdwa vcc, v19, v22 src0_sel:BYTE_0 src1_sel:DWORD
    v_pk_fma_f32 v[64:65], v[64:65], v[116:117], v[100:101]
    v_pk_fma_f32 v[66:67], v[66:67], v[118:119], v[102:103]
    v_cvt_pk_bf16_f32 v136, v64, v65
    v_cvt_pk_bf16_f32 v137, v66, v67
    s_cbranch_vccnz x_pr
    v_lshl_or_b32 v64, v136, 16, s60
    v_and_or_b32 v65, v136, v21, s61
    v_lshl_or_b32 v66, v137, 16, s62
    v_and_or_b32 v67, v137, v21, s63
    buffer_store_dwordx4 v[64:67], v3, s[12:15], s70 offen offset:0
    s_waitcnt vmcnt(3)
    v_xor_b32 v68, s48, v68
    v_xor_b32 v69, s49, v69
    v_xor_b32 v70, s50, v70
    v_xor_b32 v71, s51, v71
    v_or3_b32 v19, v68, v69, v70
    v_or_b32 v19, v19, v71
    v_pk_fma_f32 v[68:69], v[68:69], s[20:21], s[20:21] op_sel:[0,1,0] op_sel_hi:[1,1,0]
    v_pk_fma_f32 v[70:71], v[70:71], s[20:21], s[20:21] op_sel:[0,1,0] op_sel_hi:[1,1,0]
    v_cmp_ne_u16_sdwa vcc, v19, v22 src0_sel:BYTE_0 src1_sel:DWORD
    v_pk_fma_f32 v[68:69], v[68:69], v[120:121], v[104:105]
    v_pk_fma_f32 v[70:71], v[70:71], v[122:123], v[106:107]
    v_cvt_pk_bf16_f32 v138, v68, v69
    v_cvt_pk_bf16_f32 v139, v70, v71
    s_cbranch_vccnz x_pr
    v_lshl_or_b32 v68, v138, 16, s60
    v_and_or_b32 v69, v138, v21, s61
    v_lshl_or_b32 v70, v139, 16, s62
    v_and_or_b32 v71, v139, v21, s63
    buffer_store_dwordx4 v[68:71], v3, s[12:15], s70 offen offset:1024
    s_waitcnt vmcnt(3)
    v_xor_b32 v72, s44, v72
    v_xor_b32 v73, s45, v73
    v_xor_b32 v74, s46, v74
    v_xor_b32 v75, s47, v75
    v_or3_b32 v19, v72, v73, v74
    v_or_b32 v19, v19, v75
    v_pk_fma_f32 v[72:73], v[72:73], s[20:21], s[20:21] op_sel:[0,1,0] op_sel_hi:[1,1,0]
    v_pk_fma_f32 v[74:75], v[74:75], s[20:21], s[20:21] op_sel:[0,1,0] op_sel_hi:[1,1,0]
    v_cmp_ne_u16_sdwa vcc, v19, v22 src0_sel:BYTE_0 src1_sel:DWORD
    v_pk_fma_f32 v[72:73], v[72:73], v[124:125], v[108:109]
    v_pk_fma_f32 v[74:75], v[74:75], v[126:127], v[110:111]
    v_cvt_pk_bf16_f32 v140, v72, v73
    v_cvt_pk_bf16_f32 v141, v74, v75
    s_cbranch_vccnz x_pr
    v_lshl_or_b32 v72, v140, 16, s60
    v_and_or_b32 v73, v140, v21, s61
    v_lshl_or_b32 v74, v141, 16, s62
    v_and_or_b32 v75, v141, v21, s63
    buffer_store_dwordx4 v[72:75], v3, s[12:15], s70 offen offset:2048
    s_waitcnt vmcnt(3)
    v_xor_b32 v76, s48, v76
    v_xor_b32 v77, s49, v77
    v_xor_b32 v78, s50, v78
    v_xor_b32 v79, s51, v79
    v_or3_b32 v19, v76, v77, v78
    v_or_b32 v19, v19, v79
    v_pk_fma_f32 v[76:77], v[76:77], s[20:21], s[20:21] op_sel:[0,1,0] op_sel_hi:[1,1,0]
    v_pk_fma_f32 v[78:79], v[78:79], s[20:21], s[20:21] op_sel:[0,1,0] op_sel_hi:[1,1,0]
    v_cmp_ne_u16_sdwa vcc, v19, v22 src0_sel:BYTE_0 src1_sel:DWORD
    v_pk_fma_f32 v[76:77], v[76:77], v[128:129], v[112:113]
    v_pk_fma_f32 v[78:79], v[78:79], v[130:131], v[114:115]
    v_cvt_pk_bf16_f32 v142, v76, v77
    v_cvt_pk_bf16_f32 v143, v78, v79
    s_cbranch_vccnz x_pr
    v_lshl_or_b32 v76, v142, 16, s60
    v_and_or_b32 v77, v142, v21, s61
    v_lshl_or_b32 v78, v143, 16, s62
    v_and_or_b32 v79, v143, v21, s63
    buffer_store_dwordx4 v[76:79], v3, s[12:15], s70 offen offset:3072
x_phx:
    v_mov_b32 v46, s40
    buffer_store_dwordx4 v[64:67], v3, s[12:15], s71 offen offset:0 sc1
    buffer_store_dwordx4 v[68:71], v3, s[12:15], s71 offen offset:1024 sc1
    buffer_store_dwordx4 v[72:75], v3, s[12:15], s71 offen offset:2048 sc1
    buffer_store_dwordx4 v[76:79], v3, s[12:15], s71 offen offset:3072 sc1
    v_lshlrev_b32 v100, 16, v136
    v_and_b32 v101, 0xffff0000, v136
    v_lshlrev_b32 v102, 16, v137
    v_and_b32 v103, 0xffff0000, v137
    v_lshlrev_b32 v104, 16, v138
    v_and_b32 v105, 0xffff0000, v138
    v_lshlrev_b32 v106, 16, v139
    v_and_b32 v107, 0xffff0000, v139
    v_lshlrev_b32 v108, 16, v140
    v_and_b32 v109, 0xffff0000, v140
    v_lshlrev_b32 v110, 16, v141
    v_and_b32 v111, 0xffff0000, v141
    v_lshlrev_b32 v112, 16, v142
    v_and_b32 v113, 0xffff0000, v142
    v_lshlrev_b32 v114, 16, v143
    v_and_b32 v115, 0xffff0000, v143
    v_pk_mul_f32 v[8:9], v[48:49], v[100:101]
    v_pk_fma_f32 v[8:9], v[50:51], v[102:103], v[8:9]
    v_pk_fma_f32 v[8:9], v[52:53], v[104:105], v[8:9]
    v_pk_fma_f32 v[8:9], v[54:55], v[106:107], v[8:9]
    v_pk_fma_f32 v[8:9], v[56:57], v[108:109], v[8:9]
    v_pk_fma_f32 v[8:9], v[58:59], v[110:111], v[8:9]
    v_pk_fma_f32 v[8:9], v[60:61], v[112:113], v[8:9]
    v_pk_fma_f32 v[8:9], v[62:63], v[114:115], v[8:9]
    v_add_f32 v8, v8, v9
    s_nop 1
    v_add_f32_dpp v8, v8, v8 row_ror:8 row_mask:0xf bank_mask:0xf
    s_nop 1
    v_add_f32_dpp v8, v8, v8 row_ror:4 row_mask:0xf bank_mask:0xf
    s_nop 1
    v_add_f32_dpp v8, v8, v8 row_ror:2 row_mask:0xf bank_mask:0xf
    s_nop 1
    v_add_f32_dpp v8, v8, v8 row_ror:1 row_mask:0xf bank_mask:0xf
    s_nop 1
    v_add_f32_dpp v8, v8, v8 row_bcast:15 row_mask:0xa bank_mask:0xf
    s_nop 1
    v_add_f32_dpp v8, v8, v8 row_bcast:31 row_mask:0xc bank_mask:0xf
    v_cvt_pk_bf16_f32 v8, v8, v8
    v_lshlrev_b32 v8, 16, v8
    v_mul_f32 v8, 0xbfb8aa3b, v8
    v_exp_f32 v8, v8
    s_nop 0
    v_add_f32 v8, 1.0, v8
    v_rcp_f32 v8, v8
    s_nop 0
    v_cvt_pk_bf16_f32 v8, v8, v8
    v_lshlrev_b32 v8, 16, v8
    s_nop 0
    v_readlane_b32 s46, v8, 63
    v_mov_b32 v44, s32
    v_mov_b32 v45, s33
    v_mov_b32 v47, s46
    s_mov_b64 exec, 0xff
    buffer_store_dwordx4 v[44:47], v3, s[12:15], s73 offen sc1
    s_mov_b64 exec, -1
    s_sleep 16
r_start:
    s_lshl_b32 s62, s34, 1
    s_lshr_b32 s42, s34, 2
    s_add_u32 s62, s62, s42
    s_lshl_b32 s62, s62, 13
    s_add_u32 s62, s62, 17432576
    s_add_u32 s61, s62, 4096
    s_and_b32 s18, s34, 3
    s_lshl_b32 s18, s18, 4
    s_add_u32 s18, s18, s35
    v_mov_b32 v11, 0
    v_and_b32 v4, 3, v0
    v_lshrrev_b32 v7, 4, v2
    v_lshlrev_b32 v5, 3, v4
    v_lshl_add_u32 v5, v7, 1, v5
    v_lshlrev_b32 v6, 10, v4
    v_lshl_add_u32 v6, v7, 2, v6
    v_lshrrev_b32 v86, 1, v4
    v_lshlrev_b32 v86, 9, v86
    v_and_b32 v87, 1, v4
    v_lshl_add_u32 v85, v87, 10, v86
    v_lshl_add_u32 v85, v7, 2, v85
    s_and_b32 s30, s18, 1
    s_bfe_u32 s31, s18, 0x20001
    s_bfe_u32 s40, s18, 0x20003
    s_lshr_b32 s41, s18, 5
    s_lshl_b32 s45, s41, 11
    s_lshl_b32 s42, s30, 8
    s_add_u32 s45, s45, s42
    s_lshl_b32 s42, s40, 6
    s_add_u32 s45, s45, s42
    s_lshl_b32 s31, s31, 4
    s_add_u32 s45, s45, s31
    s_add_u32 s62, s62, s45
    s_lshl_b32 s30, s30, 9
    s_add_u32 s31, s31, s30
    s_lshl_b32 s40, s40, 7
    s_add_u32 s31, s31, s40
    s_lshl_b32 s41, s41, 6
    s_add_u32 s31, s31, s41
    s_add_u32 s31, s31, 16916480
    s_mov_b32 s83, 0
r_ld:
    s_mov_b64 exec, 1
    buffer_load_dwordx4 v[32:35], v11, s[12:15], s61 offen sc1
    s_mov_b64 exec, -1
    buffer_load_dword v41, v85, s[12:15], s62 offen sc1
    buffer_load_dword v91, v6, s[12:15], s31 offen sc1
    s_bitcmp1_b32 s18, 1
    s_cselect_b32 s42, s33, s32
    v_lshlrev_b32 v88, 3, v7
    v_lshrrev_b32_e64 v88, v88, s42
    v_and_b32 v88, 0xff, v88
    v_lshlrev_b32 v89, 4, v7
    v_lshrrev_b64 v[82:83], v89, s[32:33]
    v_and_b32 v82, 0xffff, v82
    s_waitcnt vmcnt(0)
    v_readfirstlane_b32 s50, v32
    v_readfirstlane_b32 s51, v33
    v_readfirstlane_b32 s40, v34
    v_readfirstlane_b32 s46, v35
    v_xor_b32 v91, v88, v91
    v_xor_b32 v41, v82, v41
    v_or_b32 v19, v91, v41
    v_cmp_ne_u16 vcc, 0, v19
    s_xor_b64 s[50:51], s[50:51], s[32:33]
    s_or_b64 vcc, vcc, s[50:51]
    s_cbranch_vccz r_ldx
    s_sleep 2
    s_add_u32 s83, s83, 1
    s_cmp_lt_u32 s83, 0x40000
    s_cbranch_scc1 r_ld
r_ldx:
    v_mul_f32 v80, s46, v91
    s_bfe_u32 s46, s40, 0x70005
    s_bfe_u32 s47, s40, 0x30002
    s_bfe_u32 s60, s40, 0x10001
    s_bfe_u32 s63, s40, 0x70005
    s_lshl_b32 s63, s63, 13
    s_and_b32 s40, s40, 1
    s_lshl_b32 s40, s40, 12
    s_add_u32 s63, s63, s40
    s_add_u32 s63, s63, s45
    s_add_u32 s63, s63, 18874368
    buffer_load_dword v44, v85, s[12:15], s63 offen sc1
    v_lshrrev_b32 v10, 2, v2
    v_lshlrev_b32 v10, 7, v10
    v_lshl_add_u32 v10, v4, 4, v10
    s_lshl_b32 s44, s18, 13
    s_and_b32 s42, s34, 4
    s_lshl_b32 s42, s42, 4
    s_add_u32 s44, s44, s42
    s_add_u32 s44, s44, 17825792
    s_add_u32 s45, s44, 4096
    s_lshr_b32 s61, s46, 4
    s_and_b32 s41, s46, 15
    s_lshl_b32 s41, s41, 4
    s_add_u32 s41, s41, s61
    s_lshr_b32 s61, s46, 3
    s_cmp_eq_u32 s61, 1
    s_cselect_b32 s61, 8, 0
    s_add_u32 s41, s41, s61
    s_lshl_b32 s61, s47, 8
    s_add_u32 s41, s41, s61
    s_cmp_ge_u32 s47, 4
    s_cselect_b32 s61, 896, 0
    s_cmp_eq_u32 s46, 0
    s_cselect_b32 s61, s61, 0
    s_sub_u32 s41, s41, s61
    s_sub_u32 s61, 2048, s41
    s_cmp_eq_u32 s41, 0
    s_cselect_b32 s61, 1024, s61
    s_cmp_eq_u32 s60, 1
    s_cselect_b32 s41, s61, s41
    s_lshl_b32 s41, s41, 11
    s_lshl_b32 s61, s18, 5
    s_add_u32 s41, s41, s61
    s_waitcnt vmcnt(0)
    v_and_b32 v44, 0xffffff00, v44
    v_fmac_f32 v44, v91, v41
    v_mov_b32 v28, v216
    v_mov_b32 v29, v217
    v_mov_b32 v30, v218
    v_mov_b32 v31, v219
    s_sleep 24
    s_mov_b32 s83, 0
    s_mov_b64 s[64:65], -1
    s_mov_b64 s[66:67], -1
    s_mov_b64 s[68:69], -1
    s_mov_b32 s70, -1
    s_mov_b32 s71, 0
r_p:
    s_mov_b64 exec, s[64:65]
    s_cbranch_execz r_q0
    buffer_load_dwordx4 v[16:19], v10, s[12:15], s44 offen offset:0 sc1
r_q0:
    s_mov_b64 exec, s[66:67]
    s_cbranch_execz r_q1
    buffer_load_dwordx4 v[20:23], v10, s[12:15], s44 offen offset:2048 sc1
r_q1:
    s_mov_b64 exec, s[68:69]
    s_cbranch_execz r_q2
    buffer_load_dwordx4 v[24:27], v10, s[12:15], s45 offen offset:0 sc1
r_q2:
    s_mov_b64 exec, s[70:71]
    s_cbranch_execz r_q3
    buffer_load_dwordx4 v[28:31], v10, s[12:15], s45 offen offset:2048 sc1
r_q3:
    s_mov_b64 exec, -1
    s_waitcnt vmcnt(0)
    v_xor_b32 v48, v216, v16
    v_xor_b32 v49, v217, v17
    v_xor_b32 v50, v218, v18
    v_xor_b32 v51, v219, v19
    v_xor_b32 v52, v216, v20
    v_xor_b32 v53, v217, v21
    v_xor_b32 v54, v218, v22
    v_xor_b32 v55, v219, v23
    v_xor_b32 v56, v216, v24
    v_xor_b32 v57, v217, v25
    v_xor_b32 v58, v218, v26
    v_xor_b32 v59, v219, v27
    v_xor_b32 v60, v216, v28
    v_xor_b32 v61, v217, v29
    v_xor_b32 v62, v218, v30
    v_xor_b32 v63, v219, v31
    v_or3_b32 v12, v48, v49, v50
    v_or3_b32 v13, v52, v53, v54
    v_or3_b32 v14, v56, v57, v58
    v_or3_b32 v15, v60, v61, v62
    v_or_b32 v12, v12, v51
    v_or_b32 v13, v13, v55
    v_or_b32 v14, v14, v59
    v_or_b32 v15, v15, v63
    v_pk_add_f32 v[48:49], v[48:49], v[52:53]
    v_pk_add_f32 v[56:57], v[56:57], v[60:61]
    v_pk_add_f32 v[50:51], v[50:51], v[54:55]
    v_pk_add_f32 v[58:59], v[58:59], v[62:63]
    v_cmp_ne_u16_sdwa s[64:65], v12, v11 src0_sel:BYTE_0 src1_sel:DWORD
    v_cmp_ne_u16_sdwa s[66:67], v13, v11 src0_sel:BYTE_0 src1_sel:DWORD
    v_cmp_ne_u16_sdwa s[68:69], v14, v11 src0_sel:BYTE_0 src1_sel:DWORD
    v_cmp_ne_u16_sdwa s[70:71], v15, v11 src0_sel:BYTE_0 src1_sel:DWORD
    v_pk_add_f32 v[48:49], v[48:49], v[56:57]
    v_pk_add_f32 v[50:51], v[50:51], v[58:59]
    s_or_b64 s[50:51], s[64:65], s[66:67]
    s_or_b64 s[52:53], s[68:69], s[70:71]
    s_or_b64 s[50:51], s[50:51], s[52:53]
    s_cbranch_scc1 r_r
r_x:
    v_permlane32_swap_b32 v48, v50
    v_permlane32_swap_b32 v49, v51
    v_pk_add_f32 v[48:49], v[48:49], v[50:51]
    s_nop 1
    v_permlane16_swap_b32 v48, v49
    v_add_f32 v48, v48, v49
    s_nop 1
    v_add_f32_dpp v48, v48, v48 row_ror:4 row_mask:0xf bank_mask:0xf
    s_nop 1
    v_add_f32_dpp v48, v48, v48 row_ror:8 row_mask:0xf bank_mask:0xf
    v_fmac_f32 v44, v48, v80
    s_mov_b32 exec_lo, 0x000f000f
    s_mov_b32 exec_hi, 0x000f000f
    v_cvt_pk_bf16_f32 v44, v44, v44
    buffer_store_short v44, v5, s[24:27], s41 offen
    s_endpgm
x_pr:
    s_waitcnt vmcnt(0)
    s_add_u32 s83, s83, 1
    s_cmp_lt_u32 s83, 0x40000
    s_cbranch_scc1 x_ph
    s_branch x_phx
x_sr:
    buffer_load_dwordx4 v[100:103], v18, s[12:15], s76 offen offset:0 sc1
    buffer_load_dwordx4 v[104:107], v18, s[12:15], s76 offen offset:1024 sc1
    buffer_load_dwordx4 v[108:111], v18, s[12:15], s76 offen offset:64 sc1
    buffer_load_dwordx4 v[112:115], v18, s[12:15], s76 offen offset:1088 sc1
    s_waitcnt vmcnt(0)
    s_sleep 2
    s_add_u32 s83, s83, 1
    s_cmp_lt_u32 s83, 0x40000
    s_cbranch_scc1 x_sb
    s_branch x_sbx
r_r:
    s_add_u32 s83, s83, 1
    s_cmp_lt_u32 s83, 0x40000
    s_cbranch_scc1 r_p
    s_branch r_x
f_start:
    s_lshl_b32 s62, s34, 11
    s_lshl_b32 s63, s35, 7
    s_add_u32 s62, s62, s63
    s_add_u32 s63, s62, 16809984
    s_lshl_b32 s42, s16, 4
    s_add_u32 s62, s62, s42
    s_add_u32 s62, s62, 16777216
    v_mov_b32 v116, 0
    s_getpc_b64 s[36:37]
h_pc:
    s_mov_b32 s14, 268435456
    s_mov_b32 s15, s11
    s_mov_b64 exec, 1
    buffer_load_dword v215, v116, s[12:15], s62 offen sc1
    s_mov_b64 exec, -1
    s_mov_b32 s20, s26
    s_mov_b32 s21, s27
    s_mov_b32 s26, 4194304
    s_mov_b32 s27, 0x00020000
    s_mov_b32 s22, s50
    s_mov_b32 s23, s51
    s_mov_b32 s28, s54
    s_mov_b32 s29, s55
    s_add_u32 s58, s36, tables-h_pc
    s_addc_u32 s59, s37, 0
    s_lshr_b32 s36, s35, 1
    s_and_b32 s36, s36, 4
    s_xor_b32 s36, s36, s16
    s_and_b32 s37, s34, 4
    s_xor_b32 s37, s37, s16
    s_lshl_b32 s3, s34, 4
    s_add_u32 s3, s3, s35
    v_and_b32 v4, 15, v0
    v_bfe_u32 v5, v0, 4, 2
    v_lshrrev_b32 v248, 3, v2
    v_lshlrev_b32 v248, 18, v248
    v_lshlrev_b32 v249, 1, v5
    v_xor_b32 v249, v249, v0
    v_and_b32 v249, 7, v249
    v_lshl_add_u32 v255, v249, 4, v248
    v_lshlrev_b32 v6, 16, v5
    v_lshl_add_u32 v6, v4, 4, v6
    s_lshl_b32 s60, s16, 15
    s_lshl_b32 s61, s34, 11
    s_add_u32 s60, s60, s61
    s_lshl_b32 s61, s35, 7
    s_add_u32 s60, s60, s61
    s_lshl_b32 s61, s16, 12
    s_add_u32 s61, s61, 61440
    s_lshl_b32 s64, s36, 19
    s_lshl_b32 s65, s35, 3
    s_and_b32 s66, s34, 1
    s_lshl_b32 s66, s66, 2
    s_add_u32 s65, s65, s66
    s_lshr_b32 s66, s34, 1
    s_add_u32 s65, s65, s66
    s_lshl_b32 s65, s65, 8
    s_add_u32 s64, s64, s65
    s_add_u32 s64, s64, 1048576
    s_add_u32 s65, s64, 32768
    s_add_u32 s66, s64, 262144
    s_add_u32 s67, s64, 294912
    s_barrier
    s_cmp_eq_u32 s36, 0
    s_cselect_b32 s42, 2048, 0
    v_add_u32 v248, s42, v3
    global_load_dwordx4 v[236:239], v248, s[58:59]
    global_load_dwordx4 v[240:243], v248, s[58:59] offset:1024
    s_lshr_b32 s42, s3, 4
    s_and_b32 s30, s3, 15
    s_lshl_b32 s30, s30, 4
    s_add_u32 s30, s30, s42
    s_lshr_b32 s42, s3, 3
    s_cmp_eq_u32 s42, 1
    s_cselect_b32 s42, 8, 0
    s_add_u32 s30, s30, s42
    s_lshl_b32 s42, s16, 8
    s_add_u32 s30, s30, s42
    s_cmp_ge_u32 s16, 4
    s_cselect_b32 s42, 896, 0
    s_cmp_eq_u32 s3, 0
    s_cselect_b32 s42, s42, 0
    s_sub_u32 s30, s30, s42
    s_sub_u32 s31, 2048, s30
    s_cmp_eq_u32 s30, 0
    s_cselect_b32 s31, 1024, s31
    s_lshl_b32 s18, s30, 11
    s_lshl_b32 s19, s31, 11
    s_sub_u32 s75, s19, 2048
    s_lshl_b32 s68, s16, 12
    s_add_u32 s68, s68, 126976
    v_bfe_u32 v248, v0, 2, 1
    v_bfe_u32 v249, v0, 3, 2
    v_lshlrev_b32 v249, 2, v249
    v_lshl_add_u32 v248, v248, 4, v249
    v_and_or_b32 v248, v0, 3, v248
    v_bfe_u32 v249, v0, 5, 3
    v_cvt_f32_u32 v248, v248
    v_cvt_f32_u32 v249, v249
    s_cmp_lt_u32 s16, 4
    s_mov_b32 s42, 0x3d000000
    s_cselect_b32 s42, s42, 0x3a800000
    v_mul_f32 v248, s42, v248
    v_mul_f32 v249, 4.0, v249
    v_mul_f32 v152, v248, v249
    v_add_f32 v153, v152, v248
    v_add_f32 v154, v153, v248
    v_add_f32 v155, v154, v248
    v_sin_f32 v156, v152
    v_sin_f32 v157, v153
    v_sin_f32 v158, v154
    v_sin_f32 v159, v155
    v_cos_f32 v152, v152
    v_cos_f32 v153, v153
    v_cos_f32 v154, v154
    v_cos_f32 v155, v155
    s_cbranch_scc0 f_tw
    v_cvt_pk_f16_f32 v160, v152, v156
    v_cvt_pk_f16_f32 v156, -v156, v152
    v_mov_b32 v152, v160
    v_cvt_pk_f16_f32 v160, v153, v157
    v_cvt_pk_f16_f32 v157, -v157, v153
    v_mov_b32 v153, v160
    v_cvt_pk_f16_f32 v160, v154, v158
    v_cvt_pk_f16_f32 v158, -v158, v154
    v_mov_b32 v154, v160
    v_cvt_pk_f16_f32 v160, v155, v159
    v_cvt_pk_f16_f32 v159, -v159, v155
    v_mov_b32 v155, v160
f_tw:
    s_and_b32 s42, s16, 4
    s_add_u32 s42, s42, s16
    s_lshl_b32 s42, s42, 10
    v_add_u32 v248, s42, v3
    ds_write_b128 v248, v[152:155] offset:0
    ds_write_b128 v248, v[156:159] offset:4096
    v_lshrrev_b32 v248, 1, v4
    v_and_b32 v249, 1, v0
    v_cmp_eq_u32 vcc, 1, v4
    s_nop 1
    v_cndmask_b32_e64 v250, v248, 0, vcc
    v_cndmask_b32_e64 v248, v248, 8, vcc
    v_cndmask_b32_e64 v249, v249, 0, vcc
    v_mad_u32_u24 v251, v248, v5, v249
    v_lshlrev_b32 v251, 5, v251
    v_mad_u32_u24 v251, v250, v1, v251
    v_cvt_f32_u32 v248, v248
    v_cvt_f32_u32 v250, v250
    v_cvt_f32_u32 v251, v251
    v_mul_f32 v248, 0x3d800000, v248
    v_mul_f32 v250, 0x3b800000, v250
    v_mul_f32 v216, 0x3c000000, v251
    v_add_f32 v217, v216, v248
    v_add_f32 v218, v217, v248
    v_add_f32 v219, v218, v248
    v_add_f32 v220, v216, v250
    v_add_f32 v221, v217, v250
    v_add_f32 v222, v218, v250
    v_add_f32 v223, v219, v250
    v_cos_f32 v216, v216
    v_cos_f32 v217, v217
    v_cos_f32 v218, v218
    v_cos_f32 v219, v219
    v_cos_f32 v220, v220
    v_cos_f32 v221, v221
    v_cos_f32 v222, v222
    v_cos_f32 v223, v223
    v_lshrrev_b32 v248, 2, v2
    v_lshlrev_b32 v8, 7, v248
    v_bfe_u32 v248, v0, 3, 2
    v_lshl_add_u32 v8, v248, 5, v8
    v_and_b32 v248, 3, v0
    v_lshl_add_u32 v8, v248, 3, v8
    v_lshl_add_u32 v8, v1, 12, v8
    v_xor_b32 v9, 32, v8
    v_xor_b32 v10, 64, v8
    v_xor_b32 v11, 96, v8
    v_lshlrev_b32 v12, 13, v5
    v_lshl_add_u32 v12, v4, 4, v12
    v_lshlrev_b32 v7, 5, v5
    v_and_b32 v248, 1, v0
    v_lshl_add_u32 v7, v248, 10, v7
    v_and_b32 v248, 2, v0
    v_lshl_add_u32 v7, v248, 3, v7
    s_lshl_b32 s70, s34, 11
    s_lshl_b32 s71, s16, 7
    s_add_u32 s71, s71, s70
    s_add_u32 s71, s71, 16777216
    s_lshl_b32 s42, s16, 7
    s_add_u32 s42, s42, 94208
    v_lshlrev_b32 v213, 3, v4
    v_lshl_add_u32 v212, v5, 13, v213
    v_add_u32 v212, s42, v212
    s_lshl_b32 s42, s36, 12
    s_add_u32 s42, s42, 94208
    v_lshl_add_u32 v213, v5, 8, v213
    v_and_b32 v214, 16, v0
    v_lshl_add_u32 v213, v214, 3, v213
    v_add_u32 v213, s42, v213
    v_xor_b32 v214, 128, v213
    s_mov_b32 s4, 0x3f803f80
    s_mov_b32 s5, 0x3a800000
    s_waitcnt vmcnt(6)
    s_load_dwordx2 s[32:33], s[20:21], 0
    v_dot2_f32_bf16 v108, v64, s4, 0
    v_dot2_f32_bf16 v110, v64, v64, 0
    v_dot2_f32_bf16 v108, v65, s4, v108
    v_dot2_f32_bf16 v110, v65, v65, v110
    v_dot2_f32_bf16 v108, v66, s4, v108
    v_dot2_f32_bf16 v110, v66, v66, v110
    v_dot2_f32_bf16 v108, v67, s4, v108
    v_dot2_f32_bf16 v110, v67, v67, v110
    s_waitcnt vmcnt(5)
    v_dot2_f32_bf16 v109, v72, s4, 0
    v_dot2_f32_bf16 v111, v72, v72, 0
    v_dot2_f32_bf16 v109, v73, s4, v109
    v_dot2_f32_bf16 v111, v73, v73, v111
    v_dot2_f32_bf16 v109, v74, s4, v109
    v_dot2_f32_bf16 v111, v74, v74, v111
    v_dot2_f32_bf16 v109, v75, s4, v109
    v_dot2_f32_bf16 v111, v75, v75, v111
    s_waitcnt vmcnt(4)
    v_dot2_f32_bf16 v108, v68, s4, v108
    v_dot2_f32_bf16 v110, v68, v68, v110
    v_dot2_f32_bf16 v108, v69, s4, v108
    v_dot2_f32_bf16 v110, v69, v69, v110
    v_dot2_f32_bf16 v108, v70, s4, v108
    v_dot2_f32_bf16 v110, v70, v70, v110
    v_dot2_f32_bf16 v108, v71, s4, v108
    v_dot2_f32_bf16 v110, v71, v71, v110
    s_waitcnt vmcnt(3)
    v_dot2_f32_bf16 v109, v76, s4, v109
    v_dot2_f32_bf16 v111, v76, v76, v111
    v_dot2_f32_bf16 v109, v77, s4, v109
    v_dot2_f32_bf16 v111, v77, v77, v111
    v_dot2_f32_bf16 v109, v78, s4, v109
    v_dot2_f32_bf16 v111, v78, v78, v111
    v_dot2_f32_bf16 v109, v79, s4, v109
    v_dot2_f32_bf16 v111, v79, v79, v111
    s_nop 1
    v_permlane32_swap_b32 v108, v109
    v_permlane32_swap_b32 v110, v111
    v_add_f32 v108, v108, v109
    v_add_f32 v110, v110, v111
    s_nop 0
    v_add_f32_dpp v108, v108, v108 row_ror:8 row_mask:0xf bank_mask:0xf
    v_add_f32_dpp v110, v110, v110 row_ror:8 row_mask:0xf bank_mask:0xf
    s_nop 0
    v_add_f32_dpp v108, v108, v108 row_ror:4 row_mask:0xf bank_mask:0xf
    v_add_f32_dpp v110, v110, v110 row_ror:4 row_mask:0xf bank_mask:0xf
    s_nop 0
    v_add_f32_dpp v108, v108, v108 row_ror:2 row_mask:0xf bank_mask:0xf
    v_add_f32_dpp v110, v110, v110 row_ror:2 row_mask:0xf bank_mask:0xf
    s_nop 0
    v_add_f32_dpp v108, v108, v108 row_ror:1 row_mask:0xf bank_mask:0xf
    v_add_f32_dpp v110, v110, v110 row_ror:1 row_mask:0xf bank_mask:0xf
    s_nop 0
    v_add_f32_dpp v108, v108, v108 row_bcast:15 row_mask:0xa bank_mask:0xf
    v_add_f32_dpp v110, v110, v110 row_bcast:15 row_mask:0xa bank_mask:0xf
    v_mul_f32 v108, s5, v108
    v_mul_f32 v110, s5, v110
    v_mul_f32 v116, v108, v108
    v_cvt_pk_bf16_f32 v117, -v108, -v108
    v_sub_f32 v110, v110, v116
    v_mul_f32 v118, 0x44000000, v110
    v_cmp_gt_f32 vcc, v116, v118
    v_readlane_b32 s40, v117, 31
    s_or_b32 s41, vcc_lo, vcc_hi
    s_bitcmp1_b32 s41, 31
    s_cbranch_scc1 f_slowvar
f_var:
    v_cvt_pk_bf16_f32 v110, v110, v110
    v_lshlrev_b32 v110, 16, v110
    v_add_f32 v110, 0x3727c5ac, v110
    v_cvt_pk_bf16_f32 v110, v110, v110
    v_lshlrev_b32 v110, 16, v110
    v_sqrt_f32 v110, v110
    s_and_b32 s40, s40, 0xffff
    v_mov_b32 v114, 0xffff0000
    v_cvt_pk_bf16_f32 v110, v110, v110
    v_lshlrev_b32 v110, 16, v110
    v_mul_f32 v110, 0x41800000, v110
    v_and_or_b32 v114, v117, v114, s40
    v_rcp_f32 v113, v110
    s_waitcnt lgkmcnt(0)
    s_cmp_lg_u32 s32, 0
    s_cbranch_scc1 f_nnx
    s_load_dwordx2 s[32:33], s[20:21], 64
    s_mov_b32 s83, 0
    v_mov_b32 v122, 0
    s_waitcnt lgkmcnt(0)
f_nn:
    s_cmp_lg_u32 s32, 0
    s_cbranch_scc1 f_nnx
    global_load_dwordx2 v[120:121], v122, s[20:21] sc1
    s_waitcnt vmcnt(0)
    v_readfirstlane_b32 s32, v120
    v_readfirstlane_b32 s33, v121
    s_add_u32 s83, s83, 1
    s_cmp_lt_u32 s83, 0x40000
    s_cbranch_scc1 f_nn
f_nnx:
    v_mov_b32 v115, s32
    v_mov_b32_dpp v112, v113 row_bcast:31 row_mask:0xc bank_mask:0xf
    v_mov_b32 v116, 0
    s_mov_b32 exec_lo, 0
    s_mov_b32 exec_hi, 0x80000000
    buffer_store_dwordx4 v[112:115], v116, s[12:15], s62 offen
    v_lshlrev_b32 v117, 4, v1
    v_add_u32 v117, 160768, v117
    ds_write_b128 v117, v[112:115]
    s_mov_b64 exec, -1
    s_mov_b32 m0, s61
    s_add_u32 s42, s60, 0
    s_add_u32 s61, s61, 1024
    buffer_load_dwordx4 v255, s[8:11], s42 offen lds
    s_mov_b32 m0, s61
    s_add_u32 s42, s60, 2097152
    s_add_u32 s61, s61, 1024
    buffer_load_dwordx4 v255, s[8:11], s42 offen lds
    s_mov_b32 m0, s61
    s_add_u32 s42, s60, 16384
    s_add_u32 s61, s61, 1024
    buffer_load_dwordx4 v255, s[8:11], s42 offen lds
    s_mov_b32 m0, s61
    s_add_u32 s42, s60, 2113536
    s_add_u32 s61, s61, 1024
    buffer_load_dwordx4 v255, s[8:11], s42 offen lds
    v_add_u32 v248, s68, v3
    s_cmp_lt_u32 s3, 16
    s_cbranch_scc1 f_r0
f_ra:
    ds_write_b128 v248, v[64:67] offset:0
    ds_write_b128 v248, v[68:71] offset:1024
f_nr:
    v_mov_b32 v244, s32
    v_mov_b32 v245, s33
    v_and_b32 v248, 4, v0
    v_cmp_eq_u32 vcc, 4, v248
    v_and_b32 v248, 3, v0
    v_lshlrev_b32 v248, 2, v248
    v_cndmask_b32 v244, v244, v245, vcc
    v_lshrrev_b32 v244, v248, v244
    s_mov_b32 s54, 0x00010001
    s_mov_b32 s55, 0xfffefffe
    s_mov_b32 s46, 0x05040100
    s_mov_b32 s47, 0x07060302
    v_lshrrev_b32 v245, 1, v244
    v_lshrrev_b32 v246, 2, v244
    v_lshrrev_b32 v247, 3, v244
    v_and_b32 v244, s54, v244
    v_and_b32 v245, s54, v245
    v_and_b32 v246, s54, v246
    v_and_b32 v247, s54, v247
    s_waitcnt vmcnt(2)
    s_mov_b32 exec_lo, 0x000f000f
    s_mov_b32 exec_hi, 0x000f000f
    buffer_load_dwordx4 v[24:27], v7, s[12:15], s71 offen sc1
    s_mov_b64 exec, -1
    s_mov_b32 s83, 0
    s_waitcnt vmcnt(1)
    ds_read_b64_tr_b16 v[40:41], v8 offset:61440
    ds_read_b64_tr_b16 v[42:43], v9 offset:61440
    ds_read_b64_tr_b16 v[44:45], v10 offset:61440
    ds_read_b64_tr_b16 v[46:47], v11 offset:61440
    ds_read_b64_tr_b16 v[48:49], v8 offset:63488
    ds_read_b64_tr_b16 v[50:51], v9 offset:63488
    ds_read_b64_tr_b16 v[52:53], v10 offset:63488
    ds_read_b64_tr_b16 v[54:55], v11 offset:63488
    s_mov_b32 exec_lo, 0x000f000f
    s_mov_b32 exec_hi, 0x000f000f
f_st:
    s_waitcnt vmcnt(0)
    v_cmp_ne_u32 vcc, s32, v27
    s_mov_b64 exec, -1
    s_cbranch_vccnz f_str
f_stx:
    s_setprio 3
    v_mov_b32_dpp v32, v26 row_newbcast:0 row_mask:0xf bank_mask:0xf
    v_mov_b32_dpp v33, v26 row_newbcast:1 row_mask:0xf bank_mask:0xf
    v_mov_b32_dpp v34, v26 row_newbcast:2 row_mask:0xf bank_mask:0xf
    v_mov_b32_dpp v35, v26 row_newbcast:3 row_mask:0xf bank_mask:0xf
    v_mul_f32_dpp v216, v24, v216 row_newbcast:0 row_mask:0xf bank_mask:0xf
    v_mul_f32_dpp v217, v24, v217 row_newbcast:1 row_mask:0xf bank_mask:0xf
    v_mul_f32_dpp v218, v24, v218 row_newbcast:2 row_mask:0xf bank_mask:0xf
    v_mul_f32_dpp v219, v24, v219 row_newbcast:3 row_mask:0xf bank_mask:0xf
    v_perm_b32 v28, v33, v32, s46
    v_perm_b32 v29, v35, v34, s46
    v_cvt_pk_bf16_f32 v224, v216, v217
    v_cvt_pk_bf16_f32 v225, v218, v219
    s_nop 1
    v_mfma_f32_16x16x16_bf16 v[228:231], v[224:225], v[28:29], 0
    v_mul_f32_dpp v220, v25, v220 row_newbcast:0 row_mask:0xf bank_mask:0xf
    v_mul_f32_dpp v221, v25, v221 row_newbcast:1 row_mask:0xf bank_mask:0xf
    v_mul_f32_dpp v222, v25, v222 row_newbcast:2 row_mask:0xf bank_mask:0xf
    v_mul_f32_dpp v223, v25, v223 row_newbcast:3 row_mask:0xf bank_mask:0xf
    v_perm_b32 v30, v33, v32, s47
    v_perm_b32 v31, v35, v34, s47
    v_cvt_pk_bf16_f32 v226, v220, v221
    v_cvt_pk_bf16_f32 v227, v222, v223
    s_nop 1
    v_mfma_f32_16x16x16_bf16 v[232:235], v[226:227], v[30:31], 0
    s_waitcnt lgkmcnt(0)
    v_mfma_f32_16x16x16_bf16 v[56:59], v[224:225], v[40:41], v[228:231]
    v_mfma_f32_16x16x16_bf16 v[60:63], v[226:227], v[48:49], v[232:235]
    v_mfma_f32_16x16x16_bf16 v[64:67], v[224:225], v[42:43], v[228:231]
    v_mfma_f32_16x16x16_bf16 v[68:71], v[226:227], v[50:51], v[232:235]
    s_mov_b32 m0, s68
    s_nop 0
    buffer_load_dwordx4 v3, s[8:11], s75 offen offset:2048 lds
    buffer_load_dwordx4 v3, s[8:11], s75 offen offset:3072 lds
    v_mfma_f32_16x16x16_bf16 v[72:75], v[224:225], v[44:45], v[228:231]
    v_mfma_f32_16x16x16_bf16 v[76:79], v[226:227], v[52:53], v[232:235]
    v_cvt_pk_f16_f32 v184, v56, v57
    v_cvt_pk_f16_f32 v185, v60, v61
    ds_write_b64 v212, v[184:185] offset:0
    v_cvt_pk_f16_f32 v186, v58, v59
    v_cvt_pk_f16_f32 v187, v62, v63
    ds_write_b64 v212, v[186:187] offset:4096
    v_mfma_f32_16x16x16_bf16 v[80:83], v[224:225], v[46:47], v[228:231]
    v_mfma_f32_16x16x16_bf16 v[84:87], v[226:227], v[54:55], v[232:235]
    v_cvt_pk_f16_f32 v188, v64, v65
    v_cvt_pk_f16_f32 v189, v68, v69
    ds_write_b64 v212, v[188:189] offset:1024
    v_cvt_pk_f16_f32 v190, v66, v67
    v_cvt_pk_f16_f32 v191, v70, v71
    ds_write_b64 v212, v[190:191] offset:5120
    v_cvt_pk_f16_f32 v192, v72, v73
    v_cvt_pk_f16_f32 v193, v76, v77
    ds_write_b64 v212, v[192:193] offset:2048
    v_cvt_pk_f16_f32 v194, v74, v75
    v_cvt_pk_f16_f32 v195, v78, v79
    ds_write_b64 v212, v[194:195] offset:6144
    v_cvt_pk_f16_f32 v196, v80, v81
    v_cvt_pk_f16_f32 v197, v84, v85
    ds_write_b64 v212, v[196:197] offset:3072
    v_cvt_pk_f16_f32 v198, v82, v83
    v_cvt_pk_f16_f32 v199, v86, v87
    ds_write_b64 v212, v[198:199] offset:7168
    s_waitcnt lgkmcnt(0)
    s_barrier
    ds_read_b64 v[152:153], v213 offset:0
    ds_read_b64 v[154:155], v214 offset:0
    ds_read_b64 v[156:157], v213 offset:1024
    ds_read_b64 v[158:159], v214 offset:1024
    ds_read_b64 v[160:161], v213 offset:2048
    ds_read_b64 v[162:163], v214 offset:2048
    ds_read_b64 v[164:165], v213 offset:3072
    ds_read_b64 v[166:167], v214 offset:3072
    s_waitcnt lgkmcnt(6)
    v_mfma_f32_16x16x32_f16 v[56:59], v[236:239], v[152:155], 0
    s_waitcnt lgkmcnt(4)
    v_mfma_f32_16x16x32_f16 v[60:63], v[236:239], v[156:159], 0
    s_waitcnt lgkmcnt(2)
    v_mfma_f32_16x16x32_f16 v[64:67], v[236:239], v[160:163], 0
    s_waitcnt lgkmcnt(0)
    v_mfma_f32_16x16x32_f16 v[68:71], v[236:239], v[164:167], 0
    v_mfma_f32_16x16x32_f16 v[72:75], v[240:243], v[152:155], 0
    v_mfma_f32_16x16x32_f16 v[76:79], v[240:243], v[156:159], 0
    v_mfma_f32_16x16x32_f16 v[80:83], v[240:243], v[160:163], 0
    v_mfma_f32_16x16x32_f16 v[84:87], v[240:243], v[164:167], 0
    v_cvt_pk_f16_f32 v184, v56, v57
    v_cvt_pk_f16_f32 v185, v60, v61
    v_cvt_pk_f16_f32 v186, v64, v65
    s_nop 0
    v_cvt_pk_f16_f32 v187, v68, v69
    v_and_or_b32 v184, v184, s55, v244
    v_and_or_b32 v185, v185, s55, v245
    v_and_or_b32 v186, v186, s55, v246
    v_and_or_b32 v187, v187, s55, v247
    buffer_store_dwordx4 v[184:187], v6, s[12:15], s64 offen sc1
    v_cvt_pk_f16_f32 v188, v58, v59
    v_cvt_pk_f16_f32 v189, v62, v63
    v_cvt_pk_f16_f32 v190, v66, v67
    v_cvt_pk_f16_f32 v191, v70, v71
    v_and_or_b32 v188, v188, s55, v244
    v_and_or_b32 v189, v189, s55, v245
    v_and_or_b32 v190, v190, s55, v246
    v_and_or_b32 v191, v191, s55, v247
    buffer_store_dwordx4 v[188:191], v6, s[12:15], s65 offen sc1
    v_cvt_pk_f16_f32 v192, v72, v73
    v_cvt_pk_f16_f32 v193, v76, v77
    v_cvt_pk_f16_f32 v194, v80, v81
    v_cvt_pk_f16_f32 v195, v84, v85
    v_and_or_b32 v192, v192, s55, v244
    v_and_or_b32 v193, v193, s55, v245
    v_and_or_b32 v194, v194, s55, v246
    v_and_or_b32 v195, v195, s55, v247
    buffer_store_dwordx4 v[192:195], v6, s[12:15], s66 offen sc1
    v_cvt_pk_f16_f32 v196, v74, v75
    v_cvt_pk_f16_f32 v197, v78, v79
    v_cvt_pk_f16_f32 v198, v82, v83
    v_cvt_pk_f16_f32 v199, v86, v87
    v_and_or_b32 v196, v196, s55, v244
    v_and_or_b32 v197, v197, s55, v245
    v_and_or_b32 v198, v198, s55, v246
    v_and_or_b32 v199, v199, s55, v247
    buffer_store_dwordx4 v[196:199], v6, s[12:15], s67 offen sc1
    s_setprio 0
    s_mov_b32 s43, 0
    s_lshr_b32 s42, s3, 4
    s_and_b32 s40, s3, 15
    s_lshl_b32 s40, s40, 4
    s_add_u32 s40, s40, s42
    s_lshr_b32 s42, s3, 3
    s_cmp_eq_u32 s42, 1
    s_cselect_b32 s42, 8, 0
    s_add_u32 s40, s40, s42
    s_lshl_b32 s42, s43, 8
    s_add_u32 s40, s40, s42
    s_cmp_ge_u32 s43, 4
    s_cselect_b32 s42, 896, 0
    s_cmp_eq_u32 s3, 0
    s_cselect_b32 s42, s42, 0
    s_sub_u32 s40, s40, s42
    v_lshrrev_b32 v248, 1, v4
    v_and_b32 v249, 1, v0
    v_lshlrev_b32 v250, 8, v248
    v_add_u32 v250, s40, v250
    s_cmp_lg_u32 s3, 0
    s_cbranch_scc1 f_a3n
    v_cmp_lt_u32 s[44:45], 3, v248
    v_subrev_u32 v251, 896, v250
    s_nop 0
    v_cndmask_b32 v250, v250, v251, s[44:45]
    v_cmp_eq_u32 vcc, 1, v4
    v_mov_b32 v251, 1024
    s_nop 0
    v_cndmask_b32 v250, v250, v251, vcc
    v_cndmask_b32_e64 v249, v249, 0, vcc
f_a3n:
    v_lshlrev_b32 v251, 1, v5
    v_mul_u32_u24 v251, v251, v250
    v_lshl_add_u32 v251, v249, 9, v251
    v_add_u32 v253, v251, v250
    v_add_u32 v252, 1536, v251
    v_add_u32 v254, 1536, v253
    v_and_b32 v251, 2047, v251
    v_and_b32 v252, 2047, v252
    v_and_b32 v253, 2047, v253
    v_and_b32 v254, 2047, v254
    v_cvt_f32_u32 v251, v251
    v_cvt_f32_u32 v252, v252
    v_cvt_f32_u32 v253, v253
    v_cvt_f32_u32 v254, v254
    v_mul_f32 v251, 0x3a000000, v251
    v_mul_f32 v252, 0x3a000000, v252
    v_mul_f32 v253, 0x3a000000, v253
    v_mul_f32 v254, 0x3a000000, v254
    v_cos_f32 v251, v251
    v_cos_f32 v252, v252
    v_cos_f32 v253, v253
    v_cos_f32 v254, v254
    s_cbranch_scc1 f_a3m
    v_cmp_gt_u32 vcc, 2, v4
    s_nop 1
    v_cndmask_b32_e64 v249, 1.0, 0.5, vcc
    v_mul_f32 v251, v251, v249
    v_mul_f32 v253, v253, v249
    v_cndmask_b32 v252, 0, v251, s[44:45]
    v_cndmask_b32 v254, 0, v253, s[44:45]
    v_cndmask_b32 v251, v251, 0, s[44:45]
    v_cndmask_b32 v253, v253, 0, s[44:45]
f_a3m:
    v_cvt_pk_f16_f32 v22, v251, v252
    v_cvt_pk_f16_f32 v23, v253, v254
    v_and_b32 v248, 3, v0
    v_bfe_u32 v249, v0, 2, 1
    v_bfe_u32 v250, v0, 3, 2
    v_bfe_u32 v251, v0, 5, 1
    v_lshlrev_b32 v13, 10, v249
    v_lshlrev_b32 v15, 11, v249
    v_lshl_add_u32 v15, v251, 8, v15
    v_lshl_add_u32 v15, v250, 6, v15
    v_lshl_add_u32 v15, v248, 4, v15
    v_lshl_add_u32 v13, v250, 8, v13
    v_lshl_add_u32 v13, v248, 6, v13
    v_lshl_add_u32 v13, v251, 5, v13
    v_xor_b32 v14, 2016, v13
    v_add_u32 v13, s68, v13
    v_add_u32 v14, s68, v14
    s_waitcnt vmcnt(4)
    ds_read_b128 v[200:203], v13 offset:0
    ds_read_b128 v[204:207], v13 offset:16
    ds_read_b128 v[208:211], v14 offset:2048
    ds_read_b128 v[212:215], v14 offset:2064
    s_lshl_b32 s72, s3, 15
    s_lshl_b32 s73, s37, 12
    s_add_u32 s72, s72, s73
    s_add_u32 s72, s72, 1048576
    s_waitcnt lgkmcnt(0)
    ds_read_b128 v[88:91], v3 offset:0
    ds_read_b128 v[92:95], v3 offset:1024
    ds_read_b128 v[96:99], v3 offset:2048
    ds_read_b128 v[100:103], v3 offset:3072
    ds_read_b128 v[104:107], v3 offset:4096
    ds_read_b128 v[108:111], v3 offset:5120
    ds_read_b128 v[112:115], v3 offset:6144
    ds_read_b128 v[116:119], v3 offset:7168
    ds_read_b128 v[120:123], v3 offset:8192
    ds_read_b128 v[124:127], v3 offset:9216
    ds_read_b128 v[128:131], v3 offset:10240
    ds_read_b128 v[132:135], v3 offset:11264
    ds_read_b128 v[136:139], v3 offset:12288
    ds_read_b128 v[140:143], v3 offset:13312
    ds_read_b128 v[144:147], v3 offset:14336
    ds_read_b128 v[148:151], v3 offset:15360
    v_lshlrev_b32 v152, 16, v200
    v_and_b32 v153, 0xffff0000, v200
    v_lshlrev_b32 v154, 16, v201
    v_and_b32 v155, 0xffff0000, v201
    v_lshlrev_b32 v156, 16, v202
    v_and_b32 v157, 0xffff0000, v202
    v_lshlrev_b32 v158, 16, v203
    v_and_b32 v159, 0xffff0000, v203
    v_lshlrev_b32 v160, 16, v204
    v_and_b32 v161, 0xffff0000, v204
    v_lshlrev_b32 v162, 16, v205
    v_and_b32 v163, 0xffff0000, v205
    v_lshlrev_b32 v164, 16, v206
    v_and_b32 v165, 0xffff0000, v206
    v_lshlrev_b32 v166, 16, v207
    v_and_b32 v167, 0xffff0000, v207
    v_lshlrev_b32 v168, 16, v208
    v_and_b32 v183, 0xffff0000, v208
    v_lshlrev_b32 v182, 16, v209
    v_and_b32 v181, 0xffff0000, v209
    v_lshlrev_b32 v180, 16, v210
    v_and_b32 v179, 0xffff0000, v210
    v_lshlrev_b32 v178, 16, v211
    v_and_b32 v177, 0xffff0000, v211
    v_lshlrev_b32 v176, 16, v212
    v_and_b32 v175, 0xffff0000, v212
    v_lshlrev_b32 v174, 16, v213
    v_and_b32 v173, 0xffff0000, v213
    v_lshlrev_b32 v172, 16, v214
    v_and_b32 v171, 0xffff0000, v214
    v_lshlrev_b32 v170, 16, v215
    v_and_b32 v169, 0xffff0000, v215
    s_waitcnt vmcnt(0) lgkmcnt(0)
    s_barrier
    buffer_load_dwordx4 v[24:27], v3, s[12:15], s72 offen offset:0 sc1
    buffer_load_dwordx4 v[28:31], v3, s[12:15], s72 offen offset:1024 sc1
    buffer_load_dwordx4 v[32:35], v3, s[12:15], s72 offen offset:2048 sc1
    buffer_load_dwordx4 v[36:39], v3, s[12:15], s72 offen offset:3072 sc1
    s_lshl_b32 s80, s3, 7
    s_add_u32 s80, s80, 17039360
    v_lshrrev_b32 v18, 3, v2
    v_lshlrev_b32 v18, 14, v18
    v_and_b32 v248, 0x70, v3
    v_add_u32 v18, v18, v248
    s_cmp_lg_u32 s16, 0
    s_cbranch_scc1 f_sb2
    v_add_u32 v84, 160768, v3
    s_mov_b64 exec, 0xff
    ds_read_b128 v[80:83], v84
    s_waitcnt lgkmcnt(0)
    buffer_store_dwordx4 v[80:83], v3, s[12:15], s63 offen sc1
    s_mov_b64 exec, -1
    v_not_b32 v250, s32
    buffer_store_dwordx4 v[248:251], v18, s[12:15], s80 offen sc1
f_sb2:
    v_xor_b32 v16, 2544, v15
    s_nop 0
    v_subrev_u32 v248, s68, v13
    v_add_u32 v248, 32, v248
    v_bfe_u32 v19, v248, 5, 1
    v_lshlrev_b32 v19, 5, v19
    v_bfe_u32 v249, v248, 8, 2
    v_lshl_add_u32 v19, v249, 3, v19
    v_bfe_u32 v249, v248, 10, 1
    v_lshl_add_u32 v19, v249, 2, v19
    v_bfe_u32 v249, v248, 6, 2
    v_add_lshl_u32 v19, v249, v19, 2
    s_lshl_b32 s74, s34, 14
    s_add_u32 s74, s74, 17039360
    s_lshl_b32 s42, s37, 9
    s_add_u32 s42, s42, 61440
    v_add_u32 v12, s42, v12
    s_mul_i32 s17, s34, 7
    s_lshr_b32 s42, s35, 1
    s_add_u32 s17, s17, s42
    s_lshl_b32 s42, s17, 6
    s_lshr_b32 s43, s16, 2
    s_lshl_b32 s43, s43, 5
    s_add_u32 s42, s42, s43
    s_and_b32 s43, s16, 1
    s_lshl_b32 s43, s43, 4
    s_add_u32 s42, s42, s43
    s_and_b32 s43, s16, 2
    s_lshl_b32 s43, s43, 1
    s_add_u32 s42, s42, s43
    s_lshl_b32 s38, s42, 11
    s_and_b32 s43, s35, 1
    s_lshl_b32 s43, s43, 10
    s_add_u32 s38, s38, s43
    s_lshl_b32 s39, s16, 13
    s_add_u32 s39, s39, 94208
    s_mov_b32 s48, s28
    s_mov_b32 s49, s29
    s_mov_b32 s50, 7340032
    s_mov_b32 s51, 0x00020000
    s_bfe_u32 s4, s32, 524288
    s_bfe_u32 s5, s32, 524296
    s_bfe_u32 s6, s32, 524304
    s_bfe_u32 s7, s32, 524312
    s_bfe_u32 s8, s33, 524288
    s_bfe_u32 s9, s33, 524296
    s_bfe_u32 s10, s33, 524304
    s_bfe_u32 s11, s33, 524312
    v_lshlrev_b32 v17, 7, v4
    s_and_b32 s40, s16, 3
    s_lshl_b32 s76, s40, 10
    v_subrev_u32 v248, s68, v13
    v_lshrrev_b32 v248, 1, v248
    s_lshl_b32 s42, s40, 2
    v_add_u32 v248, s42, v248
    v_bfe_u32 v235, v248, 7, 1
    v_lshlrev_b32 v235, 9, v235
    v_and_b32 v249, 31, v248
    v_lshl_add_u32 v235, v249, 4, v235
    v_bfe_u32 v249, v248, 8, 1
    v_lshl_add_u32 v235, v249, 3, v235
    v_lshrrev_b32 v249, 9, v248
    v_lshl_add_u32 v235, v249, 10, v235
    v_bfe_u32 v249, v248, 5, 2
    v_lshl_add_u32 v235, v249, 1, v235
    v_mov_b32 v8, s32
    v_mov_b32 v9, s33
    v_and_b32 v10, 1, v0
    v_cmp_eq_u32 vcc, 1, v10
    s_nop 1
    v_cndmask_b32 v8, v8, v9, vcc
    v_bfe_u32 v9, v8, 8, 8
    v_bfe_u32 v10, v8, 16, 8
    v_lshrrev_b32 v11, 24, v8
    v_and_b32 v8, 0xff, v8
    s_add_u32 s76, s76, 16875520
    s_mov_b32 s77, 16850944
    s_add_u32 s65, s76, 4096
    s_lshl_b32 s42, s16, 11
    v_add_u32 v4, s42, v3
    s_add_u32 s64, s42, 16883712
    s_lshl_b32 s42, s16, 12
    s_add_u32 s42, s42, 61440
    v_add_u32 v7, s42, v3
    v_mov_b32 v20, 159808
    s_cmp_eq_u32 s3, 0
    s_cselect_b64 s[52:53], -1, 1
    v_mov_b32 v196, v8
    v_mov_b32 v197, v9
    v_mov_b32 v198, v10
    v_mov_b32 v199, v11
    s_mov_b32 s83, 0
    s_cmp_ge_u32 s16, 4
    s_cbranch_scc1 f_z1
    s_waitcnt vmcnt(6)
    s_mov_b64 exec, 0xf0ff
    buffer_load_dwordx4 v[236:239], v17, s[12:15], s77 offen sc1
    s_mov_b64 exec, s[52:53]
    buffer_load_dwordx4 v[196:199], v3, s[12:15], s76 offen sc1
    s_mov_b64 exec, -1
    buffer_load_dwordx4 v[192:195], v3, s[12:15], s65 offen sc1
    buffer_load_dwordx4 v[184:187], v3, s[12:15], s64 offen offset:0 sc1
    buffer_load_dwordx4 v[188:191], v3, s[12:15], s64 offen offset:1024 sc1
    s_waitcnt vmcnt(7)
    v_xor_b32 v40, v24, v244
    v_xor_b32 v41, v28, v244
    v_xor_b32 v42, v25, v245
    v_xor_b32 v43, v29, v245
    v_xor_b32 v44, v26, v246
    v_xor_b32 v45, v30, v246
    v_xor_b32 v46, v27, v247
    v_xor_b32 v47, v31, v247
    v_mfma_f32_16x16x16_f16 v[56:59], v[22:23], v[40:41], 0
    v_or3_b32 v248, v40, v41, 0
    v_mfma_f32_16x16x16_f16 v[64:67], v[22:23], v[44:45], 0
    v_or3_b32 v248, v44, v45, v248
    v_mfma_f32_16x16x16_f16 v[60:63], v[22:23], v[42:43], 0
    v_or3_b32 v248, v42, v43, v248
    v_mfma_f32_16x16x16_f16 v[68:71], v[22:23], v[46:47], 0
    v_or3_b32 v248, v46, v47, v248
    s_waitcnt vmcnt(5)
    s_branch f_z2
f_z1:
    s_waitcnt vmcnt(4)
    buffer_load_dwordx4 v[184:187], v3, s[12:15], s64 offen offset:0 sc1
    buffer_load_dwordx4 v[188:191], v3, s[12:15], s64 offen offset:1024 sc1
    s_waitcnt vmcnt(4)
f_zc:
    v_xor_b32 v40, v24, v244
    v_xor_b32 v41, v28, v244
    v_xor_b32 v42, v25, v245
    v_xor_b32 v43, v29, v245
    v_xor_b32 v44, v26, v246
    v_xor_b32 v45, v30, v246
    v_xor_b32 v46, v27, v247
    v_xor_b32 v47, v31, v247
    v_mfma_f32_16x16x16_f16 v[56:59], v[22:23], v[40:41], 0
    v_or3_b32 v248, v40, v41, 0
    v_mfma_f32_16x16x16_f16 v[64:67], v[22:23], v[44:45], 0
    v_or3_b32 v248, v44, v45, v248
    v_mfma_f32_16x16x16_f16 v[60:63], v[22:23], v[42:43], 0
    v_or3_b32 v248, v42, v43, v248
    v_mfma_f32_16x16x16_f16 v[68:71], v[22:23], v[46:47], 0
    v_or3_b32 v248, v46, v47, v248
    s_waitcnt vmcnt(2)
f_z2:
    v_xor_b32 v48, v32, v244
    v_xor_b32 v49, v36, v244
    v_xor_b32 v50, v33, v245
    v_xor_b32 v51, v37, v245
    v_xor_b32 v52, v34, v246
    v_xor_b32 v53, v38, v246
    v_xor_b32 v54, v35, v247
    v_xor_b32 v55, v39, v247
    v_mfma_f32_16x16x16_f16 v[72:75], v[22:23], v[48:49], 0
    v_or3_b32 v248, v48, v49, v248
    v_mfma_f32_16x16x16_f16 v[80:83], v[22:23], v[52:53], 0
    v_or3_b32 v248, v52, v53, v248
    v_mfma_f32_16x16x16_f16 v[76:79], v[22:23], v[50:51], 0
    v_or3_b32 v248, v50, v51, v248
    v_mfma_f32_16x16x16_f16 v[84:87], v[22:23], v[54:55], 0
    v_or3_b32 v248, v54, v55, v248
    v_and_b32 v248, s54, v248
    v_cmp_ne_u32 vcc, 0, v248
    s_cbranch_vccnz f_zr
f_zx:
    v_cvt_pk_f16_f32 v24, v56, v57
    v_cvt_pk_f16_f32 v25, v64, v65
    v_cvt_pk_f16_f32 v26, v72, v73
    v_cvt_pk_f16_f32 v27, v80, v81
    ds_write_b128 v12, v[24:27] offset:0
    v_cvt_pk_f16_f32 v28, v58, v59
    v_cvt_pk_f16_f32 v29, v66, v67
    v_cvt_pk_f16_f32 v30, v74, v75
    v_cvt_pk_f16_f32 v31, v82, v83
    ds_write_b128 v12, v[28:31] offset:4096
    v_cvt_pk_f16_f32 v32, v60, v61
    v_cvt_pk_f16_f32 v33, v68, v69
    v_cvt_pk_f16_f32 v34, v76, v77
    v_cvt_pk_f16_f32 v35, v84, v85
    ds_write_b128 v12, v[32:35] offset:256
    v_cvt_pk_f16_f32 v36, v62, v63
    v_cvt_pk_f16_f32 v37, v70, v71
    v_cvt_pk_f16_f32 v38, v78, v79
    v_cvt_pk_f16_f32 v39, v86, v87
    ds_write_b128 v12, v[36:39] offset:4352
    s_mov_b32 s83, 0
    s_cmp_lt_u32 s16, 4
    s_cbranch_scc1 f_pv
f_qv:
    s_waitcnt vmcnt(1)
    v_xor_b32 v184, v8, v184
    v_xor_b32 v185, v9, v185
    v_xor_b32 v186, v10, v186
    v_xor_b32 v187, v11, v187
    v_or3_b32 v248, v184, v185, 0
    v_or3_b32 v248, v186, v187, v248
    ds_write_b128 v4, v[184:187] offset:20480
    s_waitcnt vmcnt(0)
    v_xor_b32 v188, v8, v188
    v_xor_b32 v189, v9, v189
    v_xor_b32 v190, v10, v190
    v_xor_b32 v191, v11, v191
    v_or3_b32 v248, v188, v189, v248
    v_or3_b32 v248, v190, v191, v248
    ds_write_b128 v4, v[188:191] offset:21504
    v_and_b32 v248, 0xff, v248
    v_cmp_ne_u32 vcc, 0, v248
    s_cbranch_vccnz f_qr
    s_branch f_pvx
f_pv:
    s_waitcnt vmcnt(3)
    v_add_f32_dpp v239, v238, v238 quad_perm:[1,0,3,2] row_mask:0xf bank_mask:0xf
    v_max_f32_dpp v238, v238, v238 quad_perm:[1,0,3,2] row_mask:0xf bank_mask:0xf
    v_cmp_ne_u64 s[44:45], s[32:33], v[236:237]
    v_add_f32_dpp v239, v239, v239 quad_perm:[2,3,0,1] row_mask:0xf bank_mask:0xf
    v_max_f32_dpp v238, v238, v238 quad_perm:[2,3,0,1] row_mask:0xf bank_mask:0xf
    v_xor_b32 v196, v8, v196
    v_xor_b32 v197, v9, v197
    v_xor_b32 v198, v10, v198
    v_xor_b32 v199, v11, v199
    v_or3_b32 v248, v196, v197, 0
    v_or3_b32 v248, v198, v199, v248
    v_max_f32_dpp v238, v238, v238 row_half_mirror row_mask:0xf bank_mask:0xf
    s_mov_b64 exec, 0x1000
    ds_write_b32 v20, v239
    s_mov_b64 exec, -1
    v_frexp_exp_i32_f32 v238, v238
    s_waitcnt vmcnt(2)
    v_xor_b32 v192, v8, v192
    v_xor_b32 v193, v9, v193
    v_xor_b32 v194, v10, v194
    v_xor_b32 v195, v11, v195
    v_or3_b32 v248, v192, v193, v248
    v_or3_b32 v248, v194, v195, v248
    v_readfirstlane_b32 s42, v238
    s_sub_u32 s43, -1, s42
    s_add_u32 s45, s42, 5
    s_and_b32 s44, s44, 0xf0ff
    v_ldexp_f32 v192, v192, s43
    v_ldexp_f32 v193, v193, s43
    v_ldexp_f32 v194, v194, s43
    v_ldexp_f32 v195, v195, s43
    v_cvt_pk_f16_f32 v192, v192, v193
    v_cvt_pk_f16_f32 v194, v194, v195
    ds_write_b16 v235, v192 offset:16384
    ds_write_b16_d16_hi v235, v192 offset:16400
    ds_write_b16 v235, v194 offset:16416
    ds_write_b16_d16_hi v235, v194 offset:16432
    s_waitcnt vmcnt(1)
    v_xor_b32 v184, v8, v184
    v_xor_b32 v185, v9, v185
    v_xor_b32 v186, v10, v186
    v_xor_b32 v187, v11, v187
    v_or3_b32 v248, v184, v185, v248
    v_or3_b32 v248, v186, v187, v248
    v_ldexp_f32 v184, v184, s45
    v_ldexp_f32 v185, v185, s45
    v_ldexp_f32 v186, v186, s45
    v_ldexp_f32 v187, v187, s45
    ds_write_b128 v4, v[184:187] offset:20480
    s_waitcnt vmcnt(0)
    v_xor_b32 v188, v8, v188
    v_xor_b32 v189, v9, v189
    v_xor_b32 v190, v10, v190
    v_xor_b32 v191, v11, v191
    v_or3_b32 v248, v188, v189, v248
    v_or3_b32 v248, v190, v191, v248
    v_ldexp_f32 v188, v188, s45
    v_ldexp_f32 v189, v189, s45
    v_ldexp_f32 v190, v190, s45
    v_ldexp_f32 v191, v191, s45
    ds_write_b128 v4, v[188:191] offset:21504
    v_and_b32 v248, 0xff, v248
    v_cmp_ne_u32 vcc, 0, v248
    s_or_b32 vcc_lo, vcc_lo, s44
    s_cbranch_vccnz f_pr
f_pw:
    s_cmp_eq_u32 s3, 0
    s_cbranch_scc1 f_ps
f_pvx:
    s_setprio 2
    s_waitcnt lgkmcnt(0)
    s_barrier
    ds_read_b128 v[248:251], v3 offset:16384
    ds_read_b128 v[24:27], v7 offset:0
    ds_read_b128 v[28:31], v7 offset:1024
    ds_read_b128 v[252:255], v3 offset:17408
    ds_read_b128 v[32:35], v7 offset:2048
    ds_read_b128 v[36:39], v7 offset:3072
    s_cmp_eq_u32 s30, 0
    s_cbranch_scc1 f_sp
    s_waitcnt lgkmcnt(4)
    v_pk_mul_f16 v40, v24, v248 op_sel:[0,0] op_sel_hi:[1,0]
    v_pk_mul_f16 v41, v25, v248 op_sel:[0,1] op_sel_hi:[1,1]
    v_pk_mul_f16 v42, v26, v249 op_sel:[0,0] op_sel_hi:[1,0]
    v_pk_mul_f16 v43, v27, v249 op_sel:[0,1] op_sel_hi:[1,1]
    s_nop 1
    v_mfma_f32_32x32x16_f16 v[56:71], v[40:43], v[88:91], 0
    s_waitcnt lgkmcnt(3)
    v_pk_mul_f16 v44, v28, v250 op_sel:[0,0] op_sel_hi:[1,0]
    v_pk_mul_f16 v45, v29, v250 op_sel:[0,1] op_sel_hi:[1,1]
    v_pk_mul_f16 v46, v30, v251 op_sel:[0,0] op_sel_hi:[1,0]
    v_pk_mul_f16 v47, v31, v251 op_sel:[0,1] op_sel_hi:[1,1]
    v_mfma_f32_32x32x16_f16 v[72:87], v[40:43], v[104:107], 0
    s_waitcnt lgkmcnt(1)
    v_pk_mul_f16 v48, v32, v252 op_sel:[0,0] op_sel_hi:[1,0]
    v_pk_mul_f16 v49, v33, v252 op_sel:[0,1] op_sel_hi:[1,1]
    v_pk_mul_f16 v50, v34, v253 op_sel:[0,0] op_sel_hi:[1,0]
    v_pk_mul_f16 v51, v35, v253 op_sel:[0,1] op_sel_hi:[1,1]
    v_mfma_f32_32x32x16_f16 v[56:71], v[44:47], v[92:95], v[56:71]
    s_waitcnt lgkmcnt(0)
    v_pk_mul_f16 v52, v36, v254 op_sel:[0,0] op_sel_hi:[1,0]
    v_pk_mul_f16 v53, v37, v254 op_sel:[0,1] op_sel_hi:[1,1]
    v_pk_mul_f16 v54, v38, v255 op_sel:[0,0] op_sel_hi:[1,0]
    v_pk_mul_f16 v55, v39, v255 op_sel:[0,1] op_sel_hi:[1,1]
    v_mfma_f32_32x32x16_f16 v[72:87], v[44:47], v[108:111], v[72:87]
f_st1:
    v_mfma_f32_32x32x16_f16 v[56:71], v[48:51], v[96:99], v[56:71]
    ds_read_b128 v[184:187], v3 offset:20480
    ds_read_b128 v[188:191], v3 offset:21504
    v_mfma_f32_32x32x16_f16 v[72:87], v[48:51], v[112:115], v[72:87]
    ds_read_b128 v[192:195], v3 offset:22528
    ds_read_b128 v[196:199], v3 offset:23552
    v_mfma_f32_32x32x16_f16 v[56:71], v[52:55], v[100:103], v[56:71]
    ds_read_b128 v[200:203], v3 offset:24576
    ds_read_b128 v[204:207], v3 offset:25600
    v_mfma_f32_32x32x16_f16 v[72:87], v[52:55], v[116:119], v[72:87]
    ds_read_b128 v[208:211], v3 offset:26624
    ds_read_b128 v[212:215], v3 offset:27648
    v_mov_b32 v22, 159808
    ds_read_b32 v22, v22
    s_cmp_ge_u32 s35, 14
    s_cbranch_scc1 f_nd0
    s_add_u32 s43, s39, 0
    s_mov_b32 m0, s43
    s_add_u32 s42, s38, 0
    buffer_load_dwordx4 v3, s[48:51], s42 offen nt lds
    s_add_u32 s43, s39, 1024
    s_mov_b32 m0, s43
    s_add_u32 s42, s38, 2048
    v_xor_b32 v7, 32, v3
    buffer_load_dwordx4 v7, s[48:51], s42 offen nt lds
    s_add_u32 s43, s39, 2048
    s_mov_b32 m0, s43
    s_add_u32 s42, s38, 4096
    v_xor_b32 v7, 64, v3
    buffer_load_dwordx4 v7, s[48:51], s42 offen nt lds
f_nd0:
    s_cmp_eq_u32 s30, 0
    s_cbranch_scc1 f_sp2
    v_pk_mul_f32 v[24:25], v[56:57], v[120:121]
    v_pk_mul_f32 v[28:29], v[72:73], v[120:121]
    v_pk_mul_f32 v[26:27], v[58:59], v[122:123]
    v_pk_mul_f32 v[30:31], v[74:75], v[122:123]
    v_pk_fma_f32 v[24:25], v[72:73], v[136:137], v[24:25]
    v_pk_fma_f32 v[28:29], v[56:57], v[136:137], v[28:29] neg_lo:[1,0,0] neg_hi:[1,0,0]
    v_pk_fma_f32 v[26:27], v[74:75], v[138:139], v[26:27]
    v_pk_fma_f32 v[30:31], v[58:59], v[138:139], v[30:31] neg_lo:[1,0,0] neg_hi:[1,0,0]
    v_cvt_pk_f16_f32 v40, v24, v28
    v_cvt_pk_f16_f32 v41, v25, v29
    v_cvt_pk_f16_f32 v42, v26, v30
    v_cvt_pk_f16_f32 v43, v27, v31
    ds_read_b128 v[216:219], v3 offset:28672
    ds_read_b128 v[220:223], v3 offset:29696
    ds_read_b128 v[224:227], v3 offset:30720
    ds_read_b128 v[228:231], v3 offset:31744
    v_pk_mul_f32 v[32:33], v[60:61], v[124:125]
    v_pk_mul_f32 v[36:37], v[76:77], v[124:125]
    v_pk_mul_f32 v[34:35], v[62:63], v[126:127]
    v_pk_mul_f32 v[38:39], v[78:79], v[126:127]
    v_pk_fma_f32 v[32:33], v[76:77], v[140:141], v[32:33]
    v_pk_fma_f32 v[36:37], v[60:61], v[140:141], v[36:37] neg_lo:[1,0,0] neg_hi:[1,0,0]
    v_pk_fma_f32 v[34:35], v[78:79], v[142:143], v[34:35]
    v_pk_fma_f32 v[38:39], v[62:63], v[142:143], v[38:39] neg_lo:[1,0,0] neg_hi:[1,0,0]
    v_cvt_pk_f16_f32 v44, v32, v36
    v_cvt_pk_f16_f32 v45, v33, v37
    v_cvt_pk_f16_f32 v46, v34, v38
    v_cvt_pk_f16_f32 v47, v35, v39
    v_mfma_f32_32x32x16_f16 v[104:119], v[40:43], v[88:91], 0
    ds_read_b128 v[232:235], v3 offset:32768
    ds_read_b128 v[236:239], v3 offset:33792
    ds_read_b128 v[240:243], v3 offset:34816
    ds_read_b128 v[244:247], v3 offset:35840
    v_pk_mul_f32 v[24:25], v[64:65], v[128:129]
    v_pk_mul_f32 v[28:29], v[80:81], v[128:129]
    v_pk_mul_f32 v[26:27], v[66:67], v[130:131]
    v_pk_mul_f32 v[30:31], v[82:83], v[130:131]
    v_pk_fma_f32 v[24:25], v[80:81], v[144:145], v[24:25]
    v_pk_fma_f32 v[28:29], v[64:65], v[144:145], v[28:29] neg_lo:[1,0,0] neg_hi:[1,0,0]
    v_pk_fma_f32 v[26:27], v[82:83], v[146:147], v[26:27]
    v_pk_fma_f32 v[30:31], v[66:67], v[146:147], v[30:31] neg_lo:[1,0,0] neg_hi:[1,0,0]
    v_cvt_pk_f16_f32 v48, v24, v28
    v_cvt_pk_f16_f32 v49, v25, v29
    v_cvt_pk_f16_f32 v50, v26, v30
    v_cvt_pk_f16_f32 v51, v27, v31
    v_mfma_f32_32x32x16_f16 v[104:119], v[44:47], v[92:95], v[104:119]
    v_pk_mul_f32 v[32:33], v[68:69], v[132:133]
    v_pk_mul_f32 v[36:37], v[84:85], v[132:133]
    v_pk_mul_f32 v[34:35], v[70:71], v[134:135]
    v_pk_mul_f32 v[38:39], v[86:87], v[134:135]
    v_pk_fma_f32 v[32:33], v[84:85], v[148:149], v[32:33]
    v_pk_fma_f32 v[36:37], v[68:69], v[148:149], v[36:37] neg_lo:[1,0,0] neg_hi:[1,0,0]
    v_pk_fma_f32 v[34:35], v[86:87], v[150:151], v[34:35]
    v_pk_fma_f32 v[38:39], v[70:71], v[150:151], v[38:39] neg_lo:[1,0,0] neg_hi:[1,0,0]
    v_cvt_pk_f16_f32 v52, v32, v36
    v_cvt_pk_f16_f32 v53, v33, v37
    v_cvt_pk_f16_f32 v54, v34, v38
    v_cvt_pk_f16_f32 v55, v35, v39
    v_mfma_f32_32x32x16_f16 v[104:119], v[48:51], v[96:99], v[104:119]
    s_nop 0
    v_mfma_f32_32x32x16_f16 v[104:119], v[52:55], v[100:103], v[104:119]
    s_nop 11
    ds_bpermute_b32 v12, v19, v104
    s_waitcnt lgkmcnt(1)
    v_pk_fma_f32 v[152:153], v[184:185], v[104:105], v[152:153]
    v_pk_fma_f32 v[154:155], v[186:187], v[106:107], v[154:155]
    v_pk_fma_f32 v[156:157], v[188:189], v[108:109], v[156:157]
    v_pk_fma_f32 v[158:159], v[190:191], v[110:111], v[158:159]
    v_pk_fma_f32 v[160:161], v[192:193], v[112:113], v[160:161]
    v_pk_fma_f32 v[162:163], v[194:195], v[114:115], v[162:163]
    v_pk_fma_f32 v[164:165], v[196:197], v[116:117], v[164:165]
    v_pk_fma_f32 v[166:167], v[198:199], v[118:119], v[166:167]
    v_pk_fma_f32 v[170:171], v[202:203], v[106:107], v[170:171]
    v_pk_fma_f32 v[172:173], v[204:205], v[108:109], v[172:173]
    v_pk_fma_f32 v[174:175], v[206:207], v[110:111], v[174:175]
    v_pk_fma_f32 v[176:177], v[208:209], v[112:113], v[176:177]
    v_pk_fma_f32 v[178:179], v[210:211], v[114:115], v[178:179]
    v_pk_fma_f32 v[180:181], v[212:213], v[116:117], v[180:181]
    v_pk_fma_f32 v[182:183], v[214:215], v[118:119], v[182:183]
    v_fmac_f32 v169, v201, v105
    s_waitcnt lgkmcnt(0)
    v_fmac_f32 v168, v200, v12
f_join:
    s_setprio 1
    v_lshrrev_b32 v17, 3, v0
    v_and_b32 v17, 60, v17
    v_add_u32 v17, 159744, v17
    v_and_b32 v7, 0xf0, v3
    v_lshrrev_b32 v7, 2, v7
    v_add_u32 v7, 159744, v7
    v_pk_add_f32 v[40:41], v[166:167], v[164:165]
    v_pk_add_f32 v[48:49], v[182:183], v[180:181]
    v_pk_add_f32 v[40:41], v[40:41], v[162:163]
    v_pk_add_f32 v[48:49], v[48:49], v[178:179]
    v_pk_add_f32 v[40:41], v[40:41], v[160:161]
    v_pk_add_f32 v[48:49], v[48:49], v[176:177]
    v_pk_add_f32 v[40:41], v[40:41], v[158:159]
    v_pk_add_f32 v[48:49], v[48:49], v[174:175]
    v_pk_add_f32 v[40:41], v[40:41], v[156:157]
    v_pk_add_f32 v[48:49], v[48:49], v[172:173]
    v_pk_add_f32 v[40:41], v[40:41], v[154:155]
    v_pk_add_f32 v[48:49], v[48:49], v[170:171]
    v_pk_add_f32 v[40:41], v[40:41], v[152:153]
    v_pk_add_f32 v[48:49], v[48:49], v[168:169]
    v_pk_mul_f32 v[42:43], v[166:167], v[166:167]
    v_pk_mul_f32 v[44:45], v[166:167], v[230:231]
    v_pk_mul_f32 v[50:51], v[182:183], v[182:183]
    v_pk_mul_f32 v[52:53], v[182:183], v[246:247]
    v_pk_fma_f32 v[42:43], v[164:165], v[164:165], v[42:43]
    v_pk_fma_f32 v[44:45], v[164:165], v[228:229], v[44:45]
    v_pk_fma_f32 v[50:51], v[180:181], v[180:181], v[50:51]
    v_pk_fma_f32 v[52:53], v[180:181], v[244:245], v[52:53]
    v_pk_fma_f32 v[42:43], v[162:163], v[162:163], v[42:43]
    v_pk_fma_f32 v[44:45], v[162:163], v[226:227], v[44:45]
    v_pk_fma_f32 v[50:51], v[178:179], v[178:179], v[50:51]
    v_pk_fma_f32 v[52:53], v[178:179], v[242:243], v[52:53]
    v_pk_fma_f32 v[42:43], v[160:161], v[160:161], v[42:43]
    v_pk_fma_f32 v[44:45], v[160:161], v[224:225], v[44:45]
    v_pk_fma_f32 v[50:51], v[176:177], v[176:177], v[50:51]
    v_pk_fma_f32 v[52:53], v[176:177], v[240:241], v[52:53]
    v_pk_fma_f32 v[42:43], v[158:159], v[158:159], v[42:43]
    v_pk_fma_f32 v[44:45], v[158:159], v[222:223], v[44:45]
    v_pk_fma_f32 v[50:51], v[174:175], v[174:175], v[50:51]
    v_pk_fma_f32 v[52:53], v[174:175], v[238:239], v[52:53]
    v_pk_fma_f32 v[42:43], v[156:157], v[156:157], v[42:43]
    v_pk_fma_f32 v[44:45], v[156:157], v[220:221], v[44:45]
    v_pk_fma_f32 v[50:51], v[172:173], v[172:173], v[50:51]
    v_pk_fma_f32 v[52:53], v[172:173], v[236:237], v[52:53]
    v_pk_fma_f32 v[42:43], v[154:155], v[154:155], v[42:43]
    v_pk_fma_f32 v[44:45], v[154:155], v[218:219], v[44:45]
    v_pk_fma_f32 v[50:51], v[170:171], v[170:171], v[50:51]
    v_pk_fma_f32 v[52:53], v[170:171], v[234:235], v[52:53]
    v_pk_fma_f32 v[42:43], v[152:153], v[152:153], v[42:43]
    v_pk_fma_f32 v[44:45], v[152:153], v[216:217], v[44:45]
    v_pk_fma_f32 v[50:51], v[168:169], v[168:169], v[50:51]
    v_pk_fma_f32 v[52:53], v[168:169], v[232:233], v[52:53]
    v_add_f32 v24, v40, v41
    v_add_f32 v25, v42, v43
    v_add_f32 v26, v44, v45
    v_add_f32 v28, v48, v49
    v_add_f32 v29, v50, v51
    v_add_f32 v30, v52, v53
    s_setprio 0
    v_permlane32_swap_b32 v24, v28
    v_permlane32_swap_b32 v25, v29
    v_permlane32_swap_b32 v26, v30
    v_add_f32 v24, v24, v28
    v_add_f32 v25, v25, v29
    v_add_f32 v26, v26, v30
    v_add_f32_dpp v24, v24, v24 row_ror:8 row_mask:0xf bank_mask:0xf
    v_add_f32_dpp v25, v25, v25 row_ror:8 row_mask:0xf bank_mask:0xf
    v_add_f32_dpp v26, v26, v26 row_ror:8 row_mask:0xf bank_mask:0xf
    v_add_f32_dpp v24, v24, v24 row_ror:4 row_mask:0xf bank_mask:0xf
    v_add_f32_dpp v25, v25, v25 row_ror:4 row_mask:0xf bank_mask:0xf
    v_add_f32_dpp v26, v26, v26 row_ror:4 row_mask:0xf bank_mask:0xf
    v_add_f32_dpp v24, v24, v24 row_ror:2 row_mask:0xf bank_mask:0xf
    v_add_f32_dpp v25, v25, v25 row_ror:2 row_mask:0xf bank_mask:0xf
    v_add_f32_dpp v26, v26, v26 row_ror:2 row_mask:0xf bank_mask:0xf
    v_add_f32_dpp v24, v24, v24 row_ror:1 row_mask:0xf bank_mask:0xf
    v_add_f32_dpp v25, v25, v25 row_ror:1 row_mask:0xf bank_mask:0xf
    v_add_f32_dpp v26, v26, v26 row_ror:1 row_mask:0xf bank_mask:0xf
    v_add_f32_dpp v24, v24, v24 row_bcast:15 row_mask:0xa bank_mask:0xf
    v_add_f32_dpp v25, v25, v25 row_bcast:15 row_mask:0xa bank_mask:0xf
    v_add_f32_dpp v26, v26, v26 row_bcast:15 row_mask:0xa bank_mask:0xf
    v_mul_f32 v24, 0x3a800000, v24
    v_mul_f32 v25, 0x3a800000, v25
    v_mul_f32 v28, v24, v24
    v_fma_f32 v26, -v24, v22, v26
    v_sub_f32 v25, v25, v28
    v_mul_f32 v29, 4.0, v25
    v_cmp_gt_f32 vcc, v28, v29
    v_lshrrev_b32 v30, 4, v0
    s_lshl_b32 s43, s3, 5
    v_and_or_b32 v30, v30, 30, s43
    s_or_b32 s42, vcc_lo, vcc_hi
    s_bitcmp1_b32 s42, 31
    s_cbranch_scc1 f_slow2
f_var2:
    v_cvt_pk_bf16_f32 v25, v25, v25
    v_lshlrev_b32 v25, 16, v25
    v_add_f32 v25, 0x3727c5ac, v25
    v_cvt_pk_bf16_f32 v25, v25, v25
    v_lshlrev_b32 v25, 16, v25
    v_sqrt_f32 v25, v25
    s_nop 0
    v_cvt_pk_bf16_f32 v25, v25, v25
    v_lshlrev_b32 v25, 16, v25
    v_rcp_f32 v25, v25
    s_mov_b32 s42, 0x80000000
    s_movk_i32 s43, 0xf000
    s_mov_b32 exec_lo, s42
    s_mov_b32 exec_hi, s42
    v_mul_f32 v26, v26, v25
    v_ashrrev_i32 v28, 31, v26
    v_or_b32 v28, s42, v28
    v_xor_b32 v26, v26, v28
    v_and_or_b32 v26, v26, s43, v30
    ds_write_b32 v17, v26
    v_mul_f32 v24, -v24, v25
    s_mov_b64 exec, -1
    v_readlane_b32 s60, v26, 31
    v_readlane_b32 s56, v24, 31
    v_readlane_b32 s57, v25, 31
    v_readlane_b32 s61, v26, 63
    v_readlane_b32 s58, v24, 63
    v_readlane_b32 s59, v25, 63
    s_waitcnt lgkmcnt(0)
    s_setprio 0
    s_barrier
    ds_read_b32 v32, v7
    s_mul_i32 s42, s16, 3072
    v_add_u32 v4, s42, v3
    s_add_u32 s64, s42, 16900096
    s_waitcnt lgkmcnt(0)
    v_cmp_lt_u32 vcc, s60, v32
    v_cmp_lt_u32 s[44:45], s61, v32
    s_and_b32 s62, vcc_lo, 0xffff
    s_and_b32 s63, s44, 0xffff
    s_bcnt1_i32_b32 s62, s62
    s_bcnt1_i32_b32 s63, s63
    s_min_u32 s42, s62, s63
    s_cmp_lg_u32 s42, 0
    s_cbranch_scc1 f_nkey
    s_setprio 3
    s_max_u32 s42, s60, s61
    v_cmp_ne_u32 vcc, s42, v32
    v_mov_b32 v36, s42
    v_mov_b32 v38, s32
    v_cndmask_b32 v37, 0, v32, vcc
    v_mov_b32 v39, s33
    s_nop 0
    v_max_u32_dpp v37, v37, v37 row_ror:8 row_mask:0xf bank_mask:0xf
    s_nop 1
    v_max_u32_dpp v37, v37, v37 row_ror:4 row_mask:0xf bank_mask:0xf
    s_nop 1
    v_max_u32_dpp v37, v37, v37 row_ror:2 row_mask:0xf bank_mask:0xf
    s_nop 1
    v_max_u32_dpp v37, v37, v37 row_ror:1 row_mask:0xf bank_mask:0xf
    v_or_b32 v37, 1, v37
    buffer_store_dwordx4 v[36:39], v18, s[12:15], s80 offen sc1
f_nkey:
    s_cmp_ge_u32 s62, 2
    s_cbranch_scc1 f_nc0
f_cand0:
    s_setprio 2
    s_lshl_b32 s43, s3, 1
    s_add_u32 s42, s62, s43
    s_lshl_b32 s43, s42, 7
    s_lshl_b32 s42, s42, 12
    s_add_u32 s42, s42, 18874368
    s_add_u32 s43, s43, 17170432
    v_mov_b32 v12, 0xffffff00
    v_and_or_b32 v56, v152, v12, s4
    v_and_or_b32 v57, v153, v12, s5
    v_and_or_b32 v58, v154, v12, s6
    v_and_or_b32 v59, v155, v12, s7
    buffer_store_dwordx4 v[56:59], v15, s[12:15], s42 offen offset:0 sc1
    v_and_or_b32 v60, v156, v12, s8
    v_and_or_b32 v61, v157, v12, s9
    v_and_or_b32 v62, v158, v12, s10
    v_and_or_b32 v63, v159, v12, s11
    buffer_store_dwordx4 v[60:63], v15, s[12:15], s42 offen offset:1024 sc1
    v_and_or_b32 v64, v160, v12, s4
    v_and_or_b32 v65, v161, v12, s5
    v_and_or_b32 v66, v162, v12, s6
    v_and_or_b32 v67, v163, v12, s7
    buffer_store_dwordx4 v[64:67], v15, s[12:15], s42 offen offset:512 sc1
    v_and_or_b32 v68, v164, v12, s8
    v_and_or_b32 v69, v165, v12, s9
    v_and_or_b32 v70, v166, v12, s10
    v_and_or_b32 v71, v167, v12, s11
    buffer_store_dwordx4 v[68:71], v15, s[12:15], s42 offen offset:1536 sc1
    v_mov_b32 v40, s32
    v_mov_b32 v41, s33
    v_mov_b32 v42, s56
    v_mov_b32 v43, s57
    s_mov_b64 exec, 0xff
    buffer_store_dwordx4 v[40:43], v3, s[12:15], s43 offen sc1
    s_mov_b64 exec, -1
    s_setprio 0
f_nc0:
    s_cmp_ge_u32 s63, 2
    s_cbranch_scc1 f_nc1
f_cand1:
    s_setprio 2
    s_lshl_b32 s43, s3, 1
    s_add_u32 s42, s63, s43
    s_lshl_b32 s43, s42, 7
    s_lshl_b32 s42, s42, 12
    s_add_u32 s42, s42, 18874368
    s_add_u32 s43, s43, 17170432
    v_mov_b32 v12, 0xffffff00
    v_and_or_b32 v72, v168, v12, s4
    v_and_or_b32 v73, v183, v12, s5
    v_and_or_b32 v74, v182, v12, s6
    v_and_or_b32 v75, v181, v12, s7
    buffer_store_dwordx4 v[72:75], v16, s[12:15], s42 offen offset:0 sc1
    v_and_or_b32 v76, v180, v12, s8
    v_and_or_b32 v77, v179, v12, s9
    v_and_or_b32 v78, v178, v12, s10
    v_and_or_b32 v79, v177, v12, s11
    buffer_store_dwordx4 v[76:79], v16, s[12:15], s42 offen offset:1024 sc1
    v_and_or_b32 v80, v176, v12, s4
    v_and_or_b32 v81, v175, v12, s5
    v_and_or_b32 v82, v174, v12, s6
    v_and_or_b32 v83, v173, v12, s7
    buffer_store_dwordx4 v[80:83], v16, s[12:15], s42 offen offset:512 sc1
    v_and_or_b32 v84, v172, v12, s8
    v_and_or_b32 v85, v171, v12, s9
    v_and_or_b32 v86, v170, v12, s10
    v_and_or_b32 v87, v169, v12, s11
    buffer_store_dwordx4 v[84:87], v16, s[12:15], s42 offen offset:1536 sc1
    v_mov_b32 v44, s32
    v_mov_b32 v45, s33
    v_mov_b32 v46, s58
    v_mov_b32 v47, s59
    s_mov_b64 exec, 0xff
    buffer_store_dwordx4 v[44:47], v3, s[12:15], s43 offen sc1
    s_mov_b64 exec, -1
    s_setprio 0
f_nc1:
    buffer_load_dwordx4 v[248:251], v3, s[12:15], s64 offen offset:0 sc1
    buffer_load_dwordx4 v[252:255], v3, s[12:15], s64 offen offset:1024 sc1
    buffer_load_dwordx4 v[136:139], v3, s[12:15], s64 offen offset:2048 sc1
    s_barrier
    s_cmp_ge_u32 s35, 14
    s_cbranch_scc1 f_nd2
    s_add_u32 s43, s39, 3072
    s_mov_b32 m0, s43
    s_add_u32 s42, s38, 6144
    v_xor_b32 v7, 96, v3
    buffer_load_dwordx4 v7, s[48:51], s42 offen nt lds
    s_add_u32 s43, s39, 4096
    s_mov_b32 m0, s43
    s_add_u32 s42, s38, 16384
    v_xor_b32 v7, 128, v3
    buffer_load_dwordx4 v7, s[48:51], s42 offen nt lds
    s_add_u32 s43, s39, 5120
    s_mov_b32 m0, s43
    s_add_u32 s42, s38, 18432
    v_xor_b32 v7, 160, v3
    buffer_load_dwordx4 v7, s[48:51], s42 offen nt lds
    s_add_u32 s43, s39, 6144
    s_mov_b32 m0, s43
    s_add_u32 s42, s38, 20480
    v_xor_b32 v7, 192, v3
    buffer_load_dwordx4 v7, s[48:51], s42 offen nt lds
    s_add_u32 s43, s39, 7168
    s_mov_b32 m0, s43
    s_add_u32 s42, s38, 22528
    v_xor_b32 v7, 224, v3
    buffer_load_dwordx4 v7, s[48:51], s42 offen nt lds
f_nd2:
    v_pk_fma_f32 v[56:57], v[152:153], s[56:57], s[56:57] op_sel:[0,1,0] op_sel_hi:[1,1,0]
    v_pk_fma_f32 v[58:59], v[154:155], s[56:57], s[56:57] op_sel:[0,1,0] op_sel_hi:[1,1,0]
    v_pk_fma_f32 v[60:61], v[156:157], s[56:57], s[56:57] op_sel:[0,1,0] op_sel_hi:[1,1,0]
    v_pk_fma_f32 v[62:63], v[158:159], s[56:57], s[56:57] op_sel:[0,1,0] op_sel_hi:[1,1,0]
    v_pk_fma_f32 v[64:65], v[160:161], s[56:57], s[56:57] op_sel:[0,1,0] op_sel_hi:[1,1,0]
    v_pk_fma_f32 v[66:67], v[162:163], s[56:57], s[56:57] op_sel:[0,1,0] op_sel_hi:[1,1,0]
    v_pk_fma_f32 v[68:69], v[164:165], s[56:57], s[56:57] op_sel:[0,1,0] op_sel_hi:[1,1,0]
    v_pk_fma_f32 v[70:71], v[166:167], s[56:57], s[56:57] op_sel:[0,1,0] op_sel_hi:[1,1,0]
    v_pk_fma_f32 v[72:73], v[168:169], s[58:59], s[58:59] op_sel:[0,1,0] op_sel_hi:[1,1,0]
    v_pk_fma_f32 v[74:75], v[170:171], s[58:59], s[58:59] op_sel:[0,1,0] op_sel_hi:[1,1,0]
    v_pk_fma_f32 v[76:77], v[172:173], s[58:59], s[58:59] op_sel:[0,1,0] op_sel_hi:[1,1,0]
    v_pk_fma_f32 v[78:79], v[174:175], s[58:59], s[58:59] op_sel:[0,1,0] op_sel_hi:[1,1,0]
    v_pk_fma_f32 v[80:81], v[176:177], s[58:59], s[58:59] op_sel:[0,1,0] op_sel_hi:[1,1,0]
    v_pk_fma_f32 v[82:83], v[178:179], s[58:59], s[58:59] op_sel:[0,1,0] op_sel_hi:[1,1,0]
    v_pk_fma_f32 v[84:85], v[180:181], s[58:59], s[58:59] op_sel:[0,1,0] op_sel_hi:[1,1,0]
    v_pk_fma_f32 v[86:87], v[182:183], s[58:59], s[58:59] op_sel:[0,1,0] op_sel_hi:[1,1,0]
    v_subrev_u32 v13, s68, v13
    s_sub_u32 s68, s68, 65536
    v_bfe_u32 v12, v0, 1, 2
    v_lshlrev_b32 v12, 4, v12
    v_xor_b32 v13, v13, v12
    v_xor_b32 v14, 2000, v13
    v_add_u32 v13, s68, v13
    v_add_u32 v14, s68, v14
    v_xor_b32 v20, 16, v13
    v_xor_b32 v21, 16, v14
    v_and_b32 v22, 8, v0
    v_lshlrev_b32 v22, 1, v22
    v_xor_b32 v22, v22, v3
    v_add_u32 v22, s68, v22
    v_xor_b32 v23, 32, v22
    s_mov_b32 s83, 0
    s_cmp_ge_u32 s35, 14
    s_cbranch_scc1 f_p2c
    s_waitcnt vmcnt(5)
f_p2e:
    v_xor_b32 v248, v8, v248
    v_xor_b32 v249, v9, v249
    v_xor_b32 v250, v10, v250
    v_xor_b32 v251, v11, v251
    v_xor_b32 v252, v8, v252
    v_xor_b32 v253, v9, v253
    v_xor_b32 v254, v10, v254
    v_xor_b32 v255, v11, v255
    v_xor_b32 v136, v8, v136
    v_xor_b32 v137, v9, v137
    v_xor_b32 v138, v10, v138
    v_xor_b32 v139, v11, v139
    v_or3_b32 v12, v248, v249, 0
    v_or3_b32 v12, v250, v251, v12
    v_or3_b32 v12, v252, v253, v12
    v_or3_b32 v12, v254, v255, v12
    v_or3_b32 v12, v136, v137, v12
    v_or3_b32 v12, v138, v139, v12
    v_and_b32 v12, 0xff, v12
    v_cmp_ne_u32 vcc, 0, v12
    s_cbranch_vccnz f_p2r
f_p2w:
    ds_write_b128 v4, v[248:251] offset:36864
    ds_write_b128 v4, v[252:255] offset:37888
    ds_write_b128 v4, v[136:139] offset:38912
    s_waitcnt lgkmcnt(0)
    s_barrier
    v_not_b32 v24, v8
    v_bfe_u32 v7, v0, 4, 2
    v_lshlrev_b32 v7, 13, v7
    v_and_b32 v25, 0x70, v3
    v_add_u32 v7, v7, v25
    s_and_b32 s42, s35, 1
    s_lshl_b32 s42, s42, 3
    s_add_u32 s42, s42, s16
    s_lshl_b32 s42, s42, 15
    s_lshl_b32 s43, s17, 7
    s_add_u32 s42, s42, s43
    s_add_u32 s42, s42, 17825792
    s_cmp_ge_u32 s35, 14
    s_cbranch_scc1 f_npw
    s_mov_b32 exec_lo, 0x00ff00ff
    s_mov_b32 exec_hi, 0x00ff00ff
    buffer_store_dwordx4 v[24:27], v7, s[12:15], s42 offen sc1
    s_mov_b64 exec, -1
f_npw:
    ds_read_b128 v[88:91], v3 offset:36864
    ds_read_b128 v[92:95], v3 offset:37888
    ds_read_b128 v[96:99], v3 offset:38912
    ds_read_b128 v[100:103], v3 offset:39936
    ds_read_b128 v[136:139], v3 offset:45056
    ds_read_b128 v[140:143], v3 offset:46080
    ds_read_b128 v[144:147], v3 offset:47104
    ds_read_b128 v[148:151], v3 offset:48128
    ds_read_b128 v[184:187], v3 offset:53248
    ds_read_b128 v[188:191], v3 offset:54272
    ds_read_b128 v[192:195], v3 offset:55296
    ds_read_b128 v[196:199], v3 offset:56320
    s_waitcnt lgkmcnt(4)
    v_pk_fma_f32 v[56:57], v[56:57], v[88:89], v[136:137]
    v_pk_fma_f32 v[58:59], v[58:59], v[90:91], v[138:139]
    v_pk_fma_f32 v[60:61], v[60:61], v[92:93], v[140:141]
    v_pk_fma_f32 v[62:63], v[62:63], v[94:95], v[142:143]
    v_pk_fma_f32 v[64:65], v[64:65], v[96:97], v[144:145]
    v_pk_fma_f32 v[66:67], v[66:67], v[98:99], v[146:147]
    v_pk_fma_f32 v[68:69], v[68:69], v[100:101], v[148:149]
    v_pk_fma_f32 v[70:71], v[70:71], v[102:103], v[150:151]
    s_waitcnt lgkmcnt(0)
    ds_read_b128 v[120:123], v3 offset:40960
    ds_read_b128 v[124:127], v3 offset:41984
    ds_read_b128 v[128:131], v3 offset:43008
    ds_read_b128 v[132:135], v3 offset:44032
    ds_read_b128 v[104:107], v3 offset:49152
    ds_read_b128 v[108:111], v3 offset:50176
    ds_read_b128 v[112:115], v3 offset:51200
    ds_read_b128 v[116:119], v3 offset:52224
    ds_read_b128 v[200:203], v3 offset:57344
    ds_read_b128 v[204:207], v3 offset:58368
    ds_read_b128 v[208:211], v3 offset:59392
    ds_read_b128 v[212:215], v3 offset:60416
    v_pk_fma_f32 v[152:153], v[184:185], v[56:57], v[152:153]
    v_pk_fma_f32 v[154:155], v[186:187], v[58:59], v[154:155]
    v_pk_fma_f32 v[156:157], v[188:189], v[60:61], v[156:157]
    v_pk_fma_f32 v[158:159], v[190:191], v[62:63], v[158:159]
    v_pk_fma_f32 v[160:161], v[192:193], v[64:65], v[160:161]
    v_pk_fma_f32 v[162:163], v[194:195], v[66:67], v[162:163]
    v_pk_fma_f32 v[164:165], v[196:197], v[68:69], v[164:165]
    v_pk_fma_f32 v[166:167], v[198:199], v[70:71], v[166:167]
    v_cvt_pk_bf16_f32 v216, v152, v153
    v_cvt_pk_bf16_f32 v217, v154, v155
    v_cvt_pk_bf16_f32 v218, v156, v157
    v_cvt_pk_bf16_f32 v219, v158, v159
    v_cvt_pk_bf16_f32 v220, v160, v161
    v_cvt_pk_bf16_f32 v221, v162, v163
    v_cvt_pk_bf16_f32 v222, v164, v165
    v_cvt_pk_bf16_f32 v223, v166, v167
    ds_write_b128 v13, v[216:219] offset:0
    ds_write_b128 v20, v[220:223] offset:0
    s_waitcnt lgkmcnt(6)
    v_pk_fma_f32 v[72:73], v[72:73], v[120:121], v[104:105]
    v_pk_fma_f32 v[74:75], v[74:75], v[122:123], v[106:107]
    v_pk_fma_f32 v[76:77], v[76:77], v[124:125], v[108:109]
    v_pk_fma_f32 v[78:79], v[78:79], v[126:127], v[110:111]
    v_pk_fma_f32 v[80:81], v[80:81], v[128:129], v[112:113]
    v_pk_fma_f32 v[82:83], v[82:83], v[130:131], v[114:115]
    v_pk_fma_f32 v[84:85], v[84:85], v[132:133], v[116:117]
    v_pk_fma_f32 v[86:87], v[86:87], v[134:135], v[118:119]
    s_waitcnt lgkmcnt(2)
    v_pk_fma_f32 v[168:169], v[200:201], v[72:73], v[168:169]
    v_pk_fma_f32 v[170:171], v[202:203], v[74:75], v[170:171]
    v_pk_fma_f32 v[172:173], v[204:205], v[76:77], v[172:173]
    v_pk_fma_f32 v[174:175], v[206:207], v[78:79], v[174:175]
    v_pk_fma_f32 v[176:177], v[208:209], v[80:81], v[176:177]
    v_pk_fma_f32 v[178:179], v[210:211], v[82:83], v[178:179]
    v_pk_fma_f32 v[180:181], v[212:213], v[84:85], v[180:181]
    v_pk_fma_f32 v[182:183], v[214:215], v[86:87], v[182:183]
    v_cvt_pk_bf16_f32 v224, v168, v183
    v_cvt_pk_bf16_f32 v225, v182, v181
    v_cvt_pk_bf16_f32 v226, v180, v179
    v_cvt_pk_bf16_f32 v227, v178, v177
    v_cvt_pk_bf16_f32 v228, v176, v175
    v_cvt_pk_bf16_f32 v229, v174, v173
    v_cvt_pk_bf16_f32 v230, v172, v171
    v_cvt_pk_bf16_f32 v231, v170, v169
    ds_write_b128 v14, v[224:227] offset:2048
    ds_write_b128 v21, v[228:231] offset:2048
    s_waitcnt lgkmcnt(0)
    ds_read_b128 v[232:235], v22 offset:0
    ds_read_b128 v[236:239], v23 offset:1024
    ds_read_b128 v[240:243], v22 offset:2048
    ds_read_b128 v[244:247], v23 offset:3072
    v_lshrrev_b32 v144, 2, v2
    v_and_b32 v145, 7, v144
    v_and_b32 v146, 3, v0
    v_lshl_add_u32 v148, v1, 2, v146
    v_xor_b32 v148, v148, v145
    v_lshlrev_b32 v148, 5, v148
    v_lshl_add_u32 v148, v144, 10, v148
    v_add_u32 v148, 94208, v148
    v_cmp_eq_u32 s[44:45], 1, v146
    v_cmp_eq_u32 s[46:47], 2, v146
    v_cmp_eq_u32 s[72:73], 3, v146
    v_bfe_u32 v145, v0, 4, 2
    v_and_b32 v144, 1, v144
    v_lshlrev_b32 v153, 7, v144
    v_lshl_add_u32 v153, v145, 4, v153
    v_add_u32 v153, 159872, v153
    v_lshlrev_b32 v154, 4, v146
    v_lshl_add_u32 v154, v144, 6, v154
    v_lshl_add_u32 v154, v1, 15, v154
    v_lshl_add_u32 v154, v145, 13, v154
    v_and_b32 v144, 15, v0
    v_lshlrev_b32 v152, 1, v144
    v_lshl_add_u32 v152, v1, 5, v152
    v_lshl_add_u32 v152, v145, 7, v152
    v_add_u32 v152, 159872, v152
    s_and_b32 s76, s35, 1
    s_lshl_b32 s76, s76, 18
    s_lshl_b32 s77, s17, 7
    s_add_u32 s76, s76, s77
    s_add_u32 s76, s76, 17825792
    s_movk_i32 s77, 0xff00
    s_lshl_b32 s81, s17, 2
    s_and_b32 s42, s16, 3
    s_add_u32 s81, s81, s42
    s_lshl_b32 s81, s81, 10
    s_add_u32 s82, s81, 18612224
    s_add_u32 s81, s81, 18350080
    v_mov_b32 v5, 159848
    s_waitcnt vmcnt(0)
    s_barrier
    ds_read_b64_tr_b16 v[88:89], v148 offset:0
    ds_read_b64_tr_b16 v[90:91], v148 offset:16384
    ds_read_b64_tr_b16 v[92:93], v148 offset:8
    ds_read_b64_tr_b16 v[94:95], v148 offset:16392
    ds_read_b64_tr_b16 v[96:97], v148 offset:16
    ds_read_b64_tr_b16 v[98:99], v148 offset:16400
    ds_read_b64_tr_b16 v[100:101], v148 offset:24
    ds_read_b64_tr_b16 v[102:103], v148 offset:16408
    ds_read_b64_tr_b16 v[104:105], v148 offset:32768
    ds_read_b64_tr_b16 v[106:107], v148 offset:49152
    ds_read_b64_tr_b16 v[108:109], v148 offset:32776
    ds_read_b64_tr_b16 v[110:111], v148 offset:49160
    ds_read_b64_tr_b16 v[112:113], v148 offset:32784
    ds_read_b64_tr_b16 v[114:115], v148 offset:49168
    ds_read_b64_tr_b16 v[116:117], v148 offset:32792
    ds_read_b64_tr_b16 v[118:119], v148 offset:49176
    v_lshlrev_b32 v40, 13, v2
    s_lshl_b32 s74, s34, 14
    s_add_u32 s74, s74, 17436672
    s_min_u32 s75, s62, s63
    s_cmp_ge_u32 s35, 14
    s_cbranch_scc1 f_na
    s_cmp_ge_u32 s16, 4
    s_cbranch_scc1 f_na
    s_mov_b32 s83, 0
f_px:
    s_and_b32 s42, s83, 63
    s_cmp_eq_u32 s42, 63
    s_cselect_b32 s42, s82, s81
    buffer_load_dwordx4 v[144:147], v3, s[12:15], s42 offen sc1
    s_add_u32 s83, s83, 1
    s_cmp_ge_u32 s83, 0x40000
    s_cselect_b32 s43, 0, 0xff
    s_waitcnt vmcnt(0)
    s_cbranch_scc1 f_pxx
    v_cmp_ne_u16_sdwa vcc, v147, v11 src0_sel:BYTE_0 src1_sel:DWORD
    s_cbranch_vccnz f_px
f_pxx:
    v_xor_b32 v144, v8, v144
    v_xor_b32 v145, v9, v145
    v_xor_b32 v146, v10, v146
    v_xor_b32 v147, v11, v147
    v_or3_b32 v4, v144, v145, v146
    v_or_b32 v4, v4, v147
    v_permlane32_swap_b32 v144, v146
    v_permlane32_swap_b32 v145, v147
    v_pk_add_f32 v[144:145], v[144:145], v[146:147]
    v_and_b32 v4, s43, v4
    v_cmp_ne_u32 vcc, 0, v4
    v_permlane16_swap_b32 v144, v145
    s_cbranch_vccnz f_px
    v_add_f32 v144, v144, v145
    v_cvt_pk_bf16_f32 v144, v144, v144
    v_lshlrev_b32 v144, 16, v144
    v_mul_f32 v145, 0xbfb8aa3b, v144
    v_exp_f32 v145, v145
    v_mov_b32 v146, v144
    v_add_f32 v145, 1.0, v145
    v_rcp_f32 v145, v145
    v_mov_b32 v147, v144
    v_mul_f32 v145, v144, v145
    s_nop 0
    v_permlane32_swap_b32 v146, v147
    v_cvt_pk_bf16_f32 v145, v145, v145
    v_lshlrev_b32 v145, 16, v145
    v_mul_f32 v145, v145, v147
    v_cvt_pk_bf16_f32 v145, v145, v145
    ds_write_b16 v152, v145
f_na:
    s_waitcnt lgkmcnt(0)
    s_barrier
    s_cmp_ge_u32 s35, 14
    s_cbranch_scc1 f_fin
    ds_read_b128 v[120:123], v153 offset:0
    ds_read_b128 v[124:127], v153 offset:64
    s_mov_b64 exec, 3
    buffer_load_dwordx4 v[32:35], v40, s[12:15], s74 offen sc1
    s_mov_b64 exec, -1
    s_waitcnt lgkmcnt(1)
    v_mfma_f32_16x16x32_bf16 v[128:131], v[88:91], v[120:123], 0
    v_mfma_f32_16x16x32_bf16 v[132:135], v[92:95], v[120:123], 0
    s_waitcnt lgkmcnt(0)
    v_mfma_f32_16x16x32_bf16 v[128:131], v[104:107], v[124:127], v[128:131]
    v_mfma_f32_16x16x32_bf16 v[132:135], v[108:111], v[124:127], v[132:135]
    v_mfma_f32_16x16x32_bf16 v[136:139], v[96:99], v[120:123], 0
    v_mfma_f32_16x16x32_bf16 v[140:143], v[100:103], v[120:123], 0
    v_mfma_f32_16x16x32_bf16 v[136:139], v[112:115], v[124:127], v[136:139]
    v_mfma_f32_16x16x32_bf16 v[140:143], v[116:119], v[124:127], v[140:143]
    s_mov_b32 exec_lo, 0x00ff00ff
    s_mov_b32 exec_hi, 0x00ff00ff
    s_nop 1
    v_cndmask_b32 v128, v128, v132, s[44:45]
    v_cndmask_b32 v129, v129, v133, s[44:45]
    v_cndmask_b32 v130, v130, v134, s[44:45]
    v_cndmask_b32 v131, v131, v135, s[44:45]
    v_cndmask_b32 v128, v128, v136, s[46:47]
    v_cndmask_b32 v129, v129, v137, s[46:47]
    v_cndmask_b32 v130, v130, v138, s[46:47]
    v_cndmask_b32 v131, v131, v139, s[46:47]
    v_cndmask_b32 v128, v128, v140, s[72:73]
    v_cndmask_b32 v129, v129, v141, s[72:73]
    v_cndmask_b32 v130, v130, v142, s[72:73]
    v_cndmask_b32 v131, v131, v143, s[72:73]
    v_and_or_b32 v128, v128, s77, v8
    v_and_or_b32 v129, v129, s77, v9
    v_and_or_b32 v130, v130, s77, v10
    v_and_or_b32 v131, v131, s77, v11
    buffer_store_dwordx4 v[128:131], v154, s[12:15], s76 offen sc1
    s_mov_b64 exec, -1
    s_barrier
f_fin:
    s_cmp_lt_u32 s75, 2
    s_cbranch_scc1 f_sel
    buffer_store_dwordx4 v[232:235], v3, s[24:27], s18 offen offset:0 sc1
    buffer_store_dwordx4 v[236:239], v3, s[24:27], s18 offen offset:1024 sc1
f_g0:
    buffer_store_dwordx4 v[240:243], v3, s[24:27], s19 offen offset:0 sc1
    buffer_store_dwordx4 v[244:247], v3, s[24:27], s19 offen offset:1024 sc1
f_g1:
f_end:
    s_endpgm
f_sel:
    s_mov_b32 s83, 0
    s_cmp_ge_u32 s35, 14
    s_cbranch_scc1 f_sr
    s_waitcnt vmcnt(1)
f_sc:
    v_cmp_ne_u64 vcc, s[32:33], v[32:33]
    v_readlane_b32 s40, v34, 0
    v_readlane_b32 s41, v34, 1
    s_and_b32 s42, vcc_lo, 3
    s_cbranch_scc0 f_sx
    s_sleep 4
f_sr:
    s_mov_b64 exec, 3
    buffer_load_dwordx4 v[32:35], v40, s[12:15], s74 offen sc1
    s_mov_b64 exec, -1
    s_waitcnt vmcnt(0)
    s_add_u32 s83, s83, 1
    s_cmp_lt_u32 s83, 0x40000
    s_cbranch_scc1 f_sc
f_sx:
    s_andn2_b32 s40, s40, 1
    s_andn2_b32 s41, s41, 1
    s_cmp_eq_u32 s60, s40
    s_cbranch_scc1 f_e0
    s_cmp_eq_u32 s60, s41
    s_cbranch_scc1 f_e0
    buffer_store_dwordx4 v[232:235], v3, s[24:27], s18 offen offset:0 sc1
    buffer_store_dwordx4 v[236:239], v3, s[24:27], s18 offen offset:1024 sc1
f_e0:
    s_cmp_eq_u32 s61, s40
    s_cbranch_scc1 f_e1
    s_cmp_eq_u32 s61, s41
    s_cbranch_scc1 f_e1
    buffer_store_dwordx4 v[240:243], v3, s[24:27], s19 offen offset:0 sc1
    buffer_store_dwordx4 v[244:247], v3, s[24:27], s19 offen offset:1024 sc1
f_e1:
    s_branch f_end
f_p2r:
    s_add_u32 s83, s83, 1
    s_cmp_ge_u32 s83, 0x40000
    s_cbranch_scc1 f_p2w
    s_sleep 12
    buffer_load_dwordx4 v[248:251], v3, s[12:15], s64 offen offset:0 sc1
    buffer_load_dwordx4 v[252:255], v3, s[12:15], s64 offen offset:1024 sc1
    buffer_load_dwordx4 v[136:139], v3, s[12:15], s64 offen offset:2048 sc1
f_p2c:
    s_waitcnt vmcnt(0)
    s_branch f_p2e
f_zr:
    v_or3_b32 v248, v40, v42, v44
    v_or_b32 v248, v248, v46
    v_and_b32 v248, s54, v248
    v_cmp_ne_u32 vcc, 0, v248
    s_cbranch_vccz f_zr0
    buffer_load_dwordx4 v[24:27], v3, s[12:15], s72 offen offset:0 sc1
f_zr0:
    v_or3_b32 v248, v41, v43, v45
    v_or_b32 v248, v248, v47
    v_and_b32 v248, s54, v248
    v_cmp_ne_u32 vcc, 0, v248
    s_cbranch_vccz f_zr1
    buffer_load_dwordx4 v[28:31], v3, s[12:15], s72 offen offset:1024 sc1
f_zr1:
    v_or3_b32 v248, v48, v50, v52
    v_or_b32 v248, v248, v54
    v_and_b32 v248, s54, v248
    v_cmp_ne_u32 vcc, 0, v248
    s_cbranch_vccz f_zr2
    buffer_load_dwordx4 v[32:35], v3, s[12:15], s72 offen offset:2048 sc1
f_zr2:
    v_or3_b32 v248, v49, v51, v53
    v_or_b32 v248, v248, v55
    v_and_b32 v248, s54, v248
    v_cmp_ne_u32 vcc, 0, v248
    s_cbranch_vccz f_zr3
    buffer_load_dwordx4 v[36:39], v3, s[12:15], s72 offen offset:3072 sc1
f_zr3:
    s_waitcnt vmcnt(0)
    s_add_u32 s83, s83, 1
    s_cmp_lt_u32 s83, 0x40000
    s_cbranch_scc1 f_zc
    s_branch f_zx
f_r0:
    s_cmp_ge_u32 s3, 8
    s_cbranch_scc1 f_rb
    s_bitcmp0_b32 s30, 7
    s_cbranch_scc1 f_ra
    s_mov_b32 m0, s68
    s_nop 0
    buffer_load_dwordx4 v3, s[8:11], s18 offen offset:0 lds
    buffer_load_dwordx4 v3, s[8:11], s18 offen offset:1024 lds
    s_branch f_nr
f_rb:
    ds_write_b128 v248, v[72:75] offset:0
    ds_write_b128 v248, v[76:79] offset:1024
    s_branch f_nr
f_str:
    s_and_b32 s42, s83, 31
    s_cmp_lg_u32 s42, 24
    s_cbranch_scc1 f_sb1
    v_add_u32 v84, 160768, v3
    s_mov_b64 exec, 0xff
    ds_read_b128 v[80:83], v84
    s_waitcnt lgkmcnt(0)
    buffer_store_dwordx4 v[80:83], v3, s[12:15], s63 offen sc1
    s_mov_b64 exec, -1
f_sb1:
    s_cmp_eq_u32 s42, 31
    s_cselect_b32 s42, 32768, 0
    s_add_u32 s42, s42, s71
    s_mov_b32 exec_lo, 0x000f000f
    s_mov_b32 exec_hi, 0x000f000f
    buffer_load_dwordx4 v[24:27], v7, s[12:15], s42 offen sc1
    s_add_u32 s83, s83, 1
    s_cmp_lt_u32 s83, 0x40000
    s_cbranch_scc1 f_st
    s_waitcnt vmcnt(0)
    s_mov_b64 exec, -1
    s_branch f_stx
f_pr:
    s_sleep 6
    v_mov_b32 v196, v8
    v_mov_b32 v197, v9
    v_mov_b32 v198, v10
    v_mov_b32 v199, v11
    s_mov_b64 exec, 0xf0ff
    buffer_load_dwordx4 v[236:239], v17, s[12:15], s77 offen sc1
    s_mov_b64 exec, s[52:53]
    buffer_load_dwordx4 v[196:199], v3, s[12:15], s76 offen sc1
    s_mov_b64 exec, -1
    buffer_load_dwordx4 v[192:195], v3, s[12:15], s65 offen sc1
    buffer_load_dwordx4 v[184:187], v3, s[12:15], s64 offen offset:0 sc1
    buffer_load_dwordx4 v[188:191], v3, s[12:15], s64 offen offset:1024 sc1
    s_waitcnt vmcnt(0)
    s_add_u32 s83, s83, 1
    s_cmp_lt_u32 s83, 0x40000
    s_cbranch_scc1 f_pv
    s_waitcnt vmcnt(0)
    s_branch f_pw
f_ps:
    s_sub_u32 s45, 5, s42
    v_ldexp_f32 v196, v196, s45
    v_ldexp_f32 v197, v197, s45
    v_ldexp_f32 v198, v198, s45
    v_ldexp_f32 v199, v199, s45
    v_and_b32 v248, 0x3f0, v235
    v_bfe_u32 v249, v235, 10, 1
    v_lshl_add_u32 v248, v249, 11, v248
    v_bfe_u32 v249, v235, 3, 1
    v_lshl_add_u32 v248, v249, 10, v248
    v_and_b32 v249, 6, v235
    v_lshl_add_u32 v248, v249, 1, v248
    v_cvt_f16_f32 v196, v196
    ds_write_b32 v248, v196 offset:0
    v_cvt_f16_f32 v197, v197
    ds_write_b32 v248, v197 offset:16
    v_cvt_f16_f32 v198, v198
    ds_write_b32 v248, v198 offset:32
    v_cvt_f16_f32 v199, v199
    ds_write_b32 v248, v199 offset:48
    s_branch f_pvx
f_qr:
    s_sleep 6
    buffer_load_dwordx4 v[184:187], v3, s[12:15], s64 offen offset:0 sc1
    buffer_load_dwordx4 v[188:191], v3, s[12:15], s64 offen offset:1024 sc1
    s_add_u32 s83, s83, 1
    s_cmp_lt_u32 s83, 0x40000
    s_cbranch_scc1 f_qv
    s_waitcnt vmcnt(0)
    s_branch f_pvx
f_slow2:
    v_cvt_pk_bf16_f32 v40, v152, v153
    v_lshlrev_b32 v152, 16, v40
    v_and_b32 v153, 0xffff0000, v40
    v_cvt_pk_bf16_f32 v40, v154, v155
    v_lshlrev_b32 v154, 16, v40
    v_and_b32 v155, 0xffff0000, v40
    v_cvt_pk_bf16_f32 v40, v156, v157
    v_lshlrev_b32 v156, 16, v40
    v_and_b32 v157, 0xffff0000, v40
    v_cvt_pk_bf16_f32 v40, v158, v159
    v_lshlrev_b32 v158, 16, v40
    v_and_b32 v159, 0xffff0000, v40
    v_cvt_pk_bf16_f32 v40, v160, v161
    v_lshlrev_b32 v160, 16, v40
    v_and_b32 v161, 0xffff0000, v40
    v_cvt_pk_bf16_f32 v40, v162, v163
    v_lshlrev_b32 v162, 16, v40
    v_and_b32 v163, 0xffff0000, v40
    v_cvt_pk_bf16_f32 v40, v164, v165
    v_lshlrev_b32 v164, 16, v40
    v_and_b32 v165, 0xffff0000, v40
    v_cvt_pk_bf16_f32 v40, v166, v167
    v_lshlrev_b32 v166, 16, v40
    v_and_b32 v167, 0xffff0000, v40
    v_pk_add_f32 v[40:41], v[152:153], v[154:155]
    v_pk_add_f32 v[40:41], v[40:41], v[156:157]
    v_pk_add_f32 v[40:41], v[40:41], v[158:159]
    v_pk_add_f32 v[40:41], v[40:41], v[160:161]
    v_pk_add_f32 v[40:41], v[40:41], v[162:163]
    v_pk_add_f32 v[40:41], v[40:41], v[164:165]
    v_pk_add_f32 v[40:41], v[40:41], v[166:167]
    v_cvt_pk_bf16_f32 v48, v168, v169
    v_lshlrev_b32 v168, 16, v48
    v_and_b32 v169, 0xffff0000, v48
    v_cvt_pk_bf16_f32 v48, v170, v171
    v_lshlrev_b32 v170, 16, v48
    v_and_b32 v171, 0xffff0000, v48
    v_cvt_pk_bf16_f32 v48, v172, v173
    v_lshlrev_b32 v172, 16, v48
    v_and_b32 v173, 0xffff0000, v48
    v_cvt_pk_bf16_f32 v48, v174, v175
    v_lshlrev_b32 v174, 16, v48
    v_and_b32 v175, 0xffff0000, v48
    v_cvt_pk_bf16_f32 v48, v176, v177
    v_lshlrev_b32 v176, 16, v48
    v_and_b32 v177, 0xffff0000, v48
    v_cvt_pk_bf16_f32 v48, v178, v179
    v_lshlrev_b32 v178, 16, v48
    v_and_b32 v179, 0xffff0000, v48
    v_cvt_pk_bf16_f32 v48, v180, v181
    v_lshlrev_b32 v180, 16, v48
    v_and_b32 v181, 0xffff0000, v48
    v_cvt_pk_bf16_f32 v48, v182, v183
    v_lshlrev_b32 v182, 16, v48
    v_and_b32 v183, 0xffff0000, v48
    v_pk_add_f32 v[48:49], v[168:169], v[170:171]
    v_pk_add_f32 v[48:49], v[48:49], v[172:173]
    v_pk_add_f32 v[48:49], v[48:49], v[174:175]
    v_pk_add_f32 v[48:49], v[48:49], v[176:177]
    v_pk_add_f32 v[48:49], v[48:49], v[178:179]
    v_pk_add_f32 v[48:49], v[48:49], v[180:181]
    v_pk_add_f32 v[48:49], v[48:49], v[182:183]
    v_add_f32 v24, v40, v41
    v_add_f32 v28, v48, v49
    s_nop 1
    v_permlane32_swap_b32 v24, v28
    v_add_f32 v24, v24, v28
    s_nop 1
    v_add_f32_dpp v24, v24, v24 row_ror:8 row_mask:0xf bank_mask:0xf
    s_nop 1
    v_add_f32_dpp v24, v24, v24 row_ror:4 row_mask:0xf bank_mask:0xf
    s_nop 1
    v_add_f32_dpp v24, v24, v24 row_ror:2 row_mask:0xf bank_mask:0xf
    s_nop 1
    v_add_f32_dpp v24, v24, v24 row_ror:1 row_mask:0xf bank_mask:0xf
    s_nop 1
    v_add_f32_dpp v24, v24, v24 row_bcast:15 row_mask:0xa bank_mask:0xf
    v_mul_f32 v27, 0x3a800000, v24
    v_cvt_pk_bf16_f32 v24, v27, v27
    v_lshlrev_b32 v24, 16, v24
    v_sub_f32 v27, v27, v24
    v_readlane_b32 s56, v24, 31
    v_readlane_b32 s58, v24, 63
    s_nop 0
    v_pk_add_f32 v[56:57], v[152:153], s[56:57] op_sel:[0,0] op_sel_hi:[1,0] neg_lo:[0,1] neg_hi:[0,1]
    v_pk_add_f32 v[58:59], v[154:155], s[56:57] op_sel:[0,0] op_sel_hi:[1,0] neg_lo:[0,1] neg_hi:[0,1]
    v_pk_add_f32 v[60:61], v[156:157], s[56:57] op_sel:[0,0] op_sel_hi:[1,0] neg_lo:[0,1] neg_hi:[0,1]
    v_pk_add_f32 v[62:63], v[158:159], s[56:57] op_sel:[0,0] op_sel_hi:[1,0] neg_lo:[0,1] neg_hi:[0,1]
    v_pk_add_f32 v[64:65], v[160:161], s[56:57] op_sel:[0,0] op_sel_hi:[1,0] neg_lo:[0,1] neg_hi:[0,1]
    v_pk_add_f32 v[66:67], v[162:163], s[56:57] op_sel:[0,0] op_sel_hi:[1,0] neg_lo:[0,1] neg_hi:[0,1]
    v_pk_add_f32 v[68:69], v[164:165], s[56:57] op_sel:[0,0] op_sel_hi:[1,0] neg_lo:[0,1] neg_hi:[0,1]
    v_pk_add_f32 v[70:71], v[166:167], s[56:57] op_sel:[0,0] op_sel_hi:[1,0] neg_lo:[0,1] neg_hi:[0,1]
    v_pk_add_f32 v[72:73], v[168:169], s[58:59] op_sel:[0,0] op_sel_hi:[1,0] neg_lo:[0,1] neg_hi:[0,1]
    v_pk_add_f32 v[74:75], v[170:171], s[58:59] op_sel:[0,0] op_sel_hi:[1,0] neg_lo:[0,1] neg_hi:[0,1]
    v_pk_add_f32 v[76:77], v[172:173], s[58:59] op_sel:[0,0] op_sel_hi:[1,0] neg_lo:[0,1] neg_hi:[0,1]
    v_pk_add_f32 v[78:79], v[174:175], s[58:59] op_sel:[0,0] op_sel_hi:[1,0] neg_lo:[0,1] neg_hi:[0,1]
    v_pk_add_f32 v[80:81], v[176:177], s[58:59] op_sel:[0,0] op_sel_hi:[1,0] neg_lo:[0,1] neg_hi:[0,1]
    v_pk_add_f32 v[82:83], v[178:179], s[58:59] op_sel:[0,0] op_sel_hi:[1,0] neg_lo:[0,1] neg_hi:[0,1]
    v_pk_add_f32 v[84:85], v[180:181], s[58:59] op_sel:[0,0] op_sel_hi:[1,0] neg_lo:[0,1] neg_hi:[0,1]
    v_pk_add_f32 v[86:87], v[182:183], s[58:59] op_sel:[0,0] op_sel_hi:[1,0] neg_lo:[0,1] neg_hi:[0,1]
    v_mov_b32 v31, v30
    v_pk_mul_f32 v[42:43], v[70:71], v[70:71]
    v_pk_mul_f32 v[44:45], v[70:71], v[230:231]
    v_pk_mul_f32 v[50:51], v[86:87], v[86:87]
    v_pk_mul_f32 v[52:53], v[86:87], v[246:247]
    v_pk_fma_f32 v[42:43], v[68:69], v[68:69], v[42:43]
    v_pk_fma_f32 v[44:45], v[68:69], v[228:229], v[44:45]
    v_pk_fma_f32 v[50:51], v[84:85], v[84:85], v[50:51]
    v_pk_fma_f32 v[52:53], v[84:85], v[244:245], v[52:53]
    v_pk_fma_f32 v[42:43], v[66:67], v[66:67], v[42:43]
    v_pk_fma_f32 v[44:45], v[66:67], v[226:227], v[44:45]
    v_pk_fma_f32 v[50:51], v[82:83], v[82:83], v[50:51]
    v_pk_fma_f32 v[52:53], v[82:83], v[242:243], v[52:53]
    v_pk_fma_f32 v[42:43], v[64:65], v[64:65], v[42:43]
    v_pk_fma_f32 v[44:45], v[64:65], v[224:225], v[44:45]
    v_pk_fma_f32 v[50:51], v[80:81], v[80:81], v[50:51]
    v_pk_fma_f32 v[52:53], v[80:81], v[240:241], v[52:53]
    v_pk_fma_f32 v[42:43], v[62:63], v[62:63], v[42:43]
    v_pk_fma_f32 v[44:45], v[62:63], v[222:223], v[44:45]
    v_pk_fma_f32 v[50:51], v[78:79], v[78:79], v[50:51]
    v_pk_fma_f32 v[52:53], v[78:79], v[238:239], v[52:53]
    v_pk_fma_f32 v[42:43], v[60:61], v[60:61], v[42:43]
    v_pk_fma_f32 v[44:45], v[60:61], v[220:221], v[44:45]
    v_pk_fma_f32 v[50:51], v[76:77], v[76:77], v[50:51]
    v_pk_fma_f32 v[52:53], v[76:77], v[236:237], v[52:53]
    v_pk_fma_f32 v[42:43], v[58:59], v[58:59], v[42:43]
    v_pk_fma_f32 v[44:45], v[58:59], v[218:219], v[44:45]
    v_pk_fma_f32 v[50:51], v[74:75], v[74:75], v[50:51]
    v_pk_fma_f32 v[52:53], v[74:75], v[234:235], v[52:53]
    v_pk_fma_f32 v[42:43], v[56:57], v[56:57], v[42:43]
    v_pk_fma_f32 v[44:45], v[56:57], v[216:217], v[44:45]
    v_pk_fma_f32 v[50:51], v[72:73], v[72:73], v[50:51]
    v_pk_fma_f32 v[52:53], v[72:73], v[232:233], v[52:53]
    v_add_f32 v25, v42, v43
    v_add_f32 v26, v44, v45
    v_add_f32 v29, v50, v51
    v_add_f32 v30, v52, v53
    s_nop 0
    v_permlane32_swap_b32 v25, v29
    v_permlane32_swap_b32 v26, v30
    v_add_f32 v25, v25, v29
    v_add_f32 v26, v26, v30
    s_nop 0
    v_add_f32_dpp v25, v25, v25 row_ror:8 row_mask:0xf bank_mask:0xf
    v_add_f32_dpp v26, v26, v26 row_ror:8 row_mask:0xf bank_mask:0xf
    s_nop 0
    v_add_f32_dpp v25, v25, v25 row_ror:4 row_mask:0xf bank_mask:0xf
    v_add_f32_dpp v26, v26, v26 row_ror:4 row_mask:0xf bank_mask:0xf
    s_nop 0
    v_add_f32_dpp v25, v25, v25 row_ror:2 row_mask:0xf bank_mask:0xf
    v_add_f32_dpp v26, v26, v26 row_ror:2 row_mask:0xf bank_mask:0xf
    s_nop 0
    v_add_f32_dpp v25, v25, v25 row_ror:1 row_mask:0xf bank_mask:0xf
    v_add_f32_dpp v26, v26, v26 row_ror:1 row_mask:0xf bank_mask:0xf
    s_nop 0
    v_add_f32_dpp v25, v25, v25 row_bcast:15 row_mask:0xa bank_mask:0xf
    v_add_f32_dpp v26, v26, v26 row_bcast:15 row_mask:0xa bank_mask:0xf
    v_mul_f32 v25, 0x3a800000, v25
    v_fma_f32 v25, -v27, v27, v25
    v_max_f32 v25, 0, v25
    v_mov_b32 v30, v31
    s_branch f_var2
f_slowvar:
    v_lshlrev_b32 v118, 16, v117
    s_nop 0
    v_readlane_b32 s44, v118, 31
    v_readlane_b32 s46, v118, 63
    v_lshlrev_b32 v120, 16, v64
    v_and_b32 v121, 0xffff0000, v64
    v_pk_add_f32 v[120:121], v[120:121], s[44:45] op_sel_hi:[1,0]
    v_pk_mul_f32 v[122:123], v[120:121], v[120:121]
    v_lshlrev_b32 v120, 16, v65
    v_and_b32 v121, 0xffff0000, v65
    v_pk_add_f32 v[120:121], v[120:121], s[44:45] op_sel_hi:[1,0]
    v_pk_fma_f32 v[122:123], v[120:121], v[120:121], v[122:123]
    v_lshlrev_b32 v120, 16, v66
    v_and_b32 v121, 0xffff0000, v66
    v_pk_add_f32 v[120:121], v[120:121], s[44:45] op_sel_hi:[1,0]
    v_pk_fma_f32 v[122:123], v[120:121], v[120:121], v[122:123]
    v_lshlrev_b32 v120, 16, v67
    v_and_b32 v121, 0xffff0000, v67
    v_pk_add_f32 v[120:121], v[120:121], s[44:45] op_sel_hi:[1,0]
    v_pk_fma_f32 v[122:123], v[120:121], v[120:121], v[122:123]
    v_lshlrev_b32 v120, 16, v68
    v_and_b32 v121, 0xffff0000, v68
    v_pk_add_f32 v[120:121], v[120:121], s[44:45] op_sel_hi:[1,0]
    v_pk_fma_f32 v[122:123], v[120:121], v[120:121], v[122:123]
    v_lshlrev_b32 v120, 16, v69
    v_and_b32 v121, 0xffff0000, v69
    v_pk_add_f32 v[120:121], v[120:121], s[44:45] op_sel_hi:[1,0]
    v_pk_fma_f32 v[122:123], v[120:121], v[120:121], v[122:123]
    v_lshlrev_b32 v120, 16, v70
    v_and_b32 v121, 0xffff0000, v70
    v_pk_add_f32 v[120:121], v[120:121], s[44:45] op_sel_hi:[1,0]
    v_pk_fma_f32 v[122:123], v[120:121], v[120:121], v[122:123]
    v_lshlrev_b32 v120, 16, v71
    v_and_b32 v121, 0xffff0000, v71
    v_pk_add_f32 v[120:121], v[120:121], s[44:45] op_sel_hi:[1,0]
    v_pk_fma_f32 v[122:123], v[120:121], v[120:121], v[122:123]
    v_add_f32 v110, v122, v123
    v_lshlrev_b32 v120, 16, v72
    v_and_b32 v121, 0xffff0000, v72
    v_pk_add_f32 v[120:121], v[120:121], s[46:47] op_sel_hi:[1,0]
    v_pk_mul_f32 v[122:123], v[120:121], v[120:121]
    v_lshlrev_b32 v120, 16, v73
    v_and_b32 v121, 0xffff0000, v73
    v_pk_add_f32 v[120:121], v[120:121], s[46:47] op_sel_hi:[1,0]
    v_pk_fma_f32 v[122:123], v[120:121], v[120:121], v[122:123]
    v_lshlrev_b32 v120, 16, v74
    v_and_b32 v121, 0xffff0000, v74
    v_pk_add_f32 v[120:121], v[120:121], s[46:47] op_sel_hi:[1,0]
    v_pk_fma_f32 v[122:123], v[120:121], v[120:121], v[122:123]
    v_lshlrev_b32 v120, 16, v75
    v_and_b32 v121, 0xffff0000, v75
    v_pk_add_f32 v[120:121], v[120:121], s[46:47] op_sel_hi:[1,0]
    v_pk_fma_f32 v[122:123], v[120:121], v[120:121], v[122:123]
    v_lshlrev_b32 v120, 16, v76
    v_and_b32 v121, 0xffff0000, v76
    v_pk_add_f32 v[120:121], v[120:121], s[46:47] op_sel_hi:[1,0]
    v_pk_fma_f32 v[122:123], v[120:121], v[120:121], v[122:123]
    v_lshlrev_b32 v120, 16, v77
    v_and_b32 v121, 0xffff0000, v77
    v_pk_add_f32 v[120:121], v[120:121], s[46:47] op_sel_hi:[1,0]
    v_pk_fma_f32 v[122:123], v[120:121], v[120:121], v[122:123]
    v_lshlrev_b32 v120, 16, v78
    v_and_b32 v121, 0xffff0000, v78
    v_pk_add_f32 v[120:121], v[120:121], s[46:47] op_sel_hi:[1,0]
    v_pk_fma_f32 v[122:123], v[120:121], v[120:121], v[122:123]
    v_lshlrev_b32 v120, 16, v79
    v_and_b32 v121, 0xffff0000, v79
    v_pk_add_f32 v[120:121], v[120:121], s[46:47] op_sel_hi:[1,0]
    v_pk_fma_f32 v[122:123], v[120:121], v[120:121], v[122:123]
    v_add_f32 v111, v122, v123
    v_add_f32 v118, v118, v108
    s_nop 0
    v_permlane32_swap_b32 v110, v111
    v_add_f32 v110, v110, v111
    s_nop 1
    v_add_f32_dpp v110, v110, v110 row_ror:8 row_mask:0xf bank_mask:0xf
    s_nop 1
    v_add_f32_dpp v110, v110, v110 row_ror:4 row_mask:0xf bank_mask:0xf
    s_nop 1
    v_add_f32_dpp v110, v110, v110 row_ror:2 row_mask:0xf bank_mask:0xf
    s_nop 1
    v_add_f32_dpp v110, v110, v110 row_ror:1 row_mask:0xf bank_mask:0xf
    s_nop 1
    v_add_f32_dpp v110, v110, v110 row_bcast:15 row_mask:0xa bank_mask:0xf
    v_mul_f32 v110, s5, v110
    v_fma_f32 v110, -v118, v118, v110
    v_max_f32 v110, 0, v110
    s_branch f_var
f_sp:
    s_setprio 3
    ds_read_b128 v[56:59], v3 offset:0
    ds_read_b128 v[60:63], v3 offset:1024
    ds_read_b128 v[64:67], v3 offset:2048
    ds_read_b128 v[68:71], v3 offset:3072
    v_and_b32 v12, 31, v0
    v_lshlrev_b32 v12, 2, v12
    v_and_b32 v17, 32, v0
    v_lshl_add_u32 v12, v17, 4, v12
    v_sub_u32 v20, 4096, v12
    v_add_u32 v12, 4096, v12
    v_add_u32 v17, 128, v12
    v_add_u32 v21, 128, v20
    s_waitcnt lgkmcnt(3)
    v_pk_fma_f16 v40, v24, v248, v56 op_sel:[0,0,0] op_sel_hi:[1,0,1]
    v_pk_fma_f16 v41, v25, v248, v57 op_sel:[0,1,0] op_sel_hi:[1,1,1]
    v_pk_fma_f16 v42, v26, v249, v58 op_sel:[0,0,0] op_sel_hi:[1,0,1]
    v_pk_fma_f16 v43, v27, v249, v59 op_sel:[0,1,0] op_sel_hi:[1,1,1]
    ds_write2st64_b32 v12, v40, v42 offset0:0 offset1:1
    ds_write2st64_b32 v17, v41, v43 offset0:0 offset1:1
    s_waitcnt lgkmcnt(4)
    v_pk_fma_f16 v44, v28, v250, v60 op_sel:[0,0,0] op_sel_hi:[1,0,1]
    v_pk_fma_f16 v45, v29, v250, v61 op_sel:[0,1,0] op_sel_hi:[1,1,1]
    v_pk_fma_f16 v46, v30, v251, v62 op_sel:[0,0,0] op_sel_hi:[1,0,1]
    v_pk_fma_f16 v47, v31, v251, v63 op_sel:[0,1,0] op_sel_hi:[1,1,1]
    ds_write2st64_b32 v12, v44, v46 offset0:4 offset1:5
    ds_write2st64_b32 v17, v45, v47 offset0:4 offset1:5
    s_waitcnt lgkmcnt(5)
    v_pk_fma_f16 v48, v32, v252, v64 op_sel:[0,0,0] op_sel_hi:[1,0,1]
    v_pk_fma_f16 v49, v33, v252, v65 op_sel:[0,1,0] op_sel_hi:[1,1,1]
    v_pk_fma_f16 v50, v34, v253, v66 op_sel:[0,0,0] op_sel_hi:[1,0,1]
    v_pk_fma_f16 v51, v35, v253, v67 op_sel:[0,1,0] op_sel_hi:[1,1,1]
    ds_write2st64_b32 v12, v48, v50 offset0:8 offset1:9
    ds_write2st64_b32 v17, v49, v51 offset0:8 offset1:9
    s_waitcnt lgkmcnt(6)
    v_pk_fma_f16 v52, v36, v254, v68 op_sel:[0,0,0] op_sel_hi:[1,0,1]
    v_pk_fma_f16 v53, v37, v254, v69 op_sel:[0,1,0] op_sel_hi:[1,1,1]
    v_pk_fma_f16 v54, v38, v255, v70 op_sel:[0,0,0] op_sel_hi:[1,0,1]
    v_pk_fma_f16 v55, v39, v255, v71 op_sel:[0,1,0] op_sel_hi:[1,1,1]
    ds_write2st64_b32 v12, v52, v54 offset0:12 offset1:13
    ds_write2st64_b32 v17, v53, v55 offset0:12 offset1:13
    s_mov_b64 exec, 1
    ds_write_b32 v12, v40 offset:4096
    s_mov_b64 exec, -1
    ds_read2st64_b32 v[72:73], v20 offset0:16 offset1:15
    ds_read2st64_b32 v[74:75], v21 offset0:15 offset1:14
    ds_read2st64_b32 v[76:77], v20 offset0:12 offset1:11
    ds_read2st64_b32 v[78:79], v21 offset0:11 offset1:10
    ds_read2st64_b32 v[80:81], v20 offset0:8 offset1:7
    ds_read2st64_b32 v[82:83], v21 offset0:7 offset1:6
    ds_read2st64_b32 v[84:85], v20 offset0:4 offset1:3
    ds_read2st64_b32 v[86:87], v21 offset0:3 offset1:2
    s_waitcnt lgkmcnt(6)
    v_pk_add_f16 v40, v40, v72
    v_pk_add_f16 v41, v41, v74
    v_pk_add_f16 v42, v42, v73
    v_pk_add_f16 v43, v43, v75
    s_waitcnt lgkmcnt(4)
    v_pk_add_f16 v44, v44, v76
    v_pk_add_f16 v45, v45, v78
    v_pk_add_f16 v46, v46, v77
    v_pk_add_f16 v47, v47, v79
    s_waitcnt lgkmcnt(2)
    v_pk_add_f16 v48, v48, v80
    v_pk_add_f16 v49, v49, v82
    v_pk_add_f16 v50, v50, v81
    v_pk_add_f16 v51, v51, v83
    s_waitcnt lgkmcnt(0)
    v_pk_add_f16 v52, v52, v84
    v_pk_add_f16 v53, v53, v86
    v_pk_add_f16 v54, v54, v85
    v_pk_add_f16 v55, v55, v87
    v_mfma_f32_32x32x16_f16 v[56:71], v[40:43], v[88:91], 0
    v_mfma_f32_32x32x16_f16 v[72:87], v[40:43], v[104:107], 0
    v_mfma_f32_32x32x16_f16 v[56:71], v[44:47], v[92:95], v[56:71]
    v_mfma_f32_32x32x16_f16 v[72:87], v[44:47], v[108:111], v[72:87]
    s_branch f_st1
f_sp2:
    s_nop 9
    v_pk_mul_f32 v[24:25], v[56:57], v[120:121]
    v_pk_mul_f32 v[28:29], v[72:73], v[120:121]
    v_pk_mul_f32 v[26:27], v[58:59], v[122:123]
    v_pk_mul_f32 v[30:31], v[74:75], v[122:123]
    v_pk_fma_f32 v[24:25], v[72:73], v[136:137], v[24:25]
    v_pk_fma_f32 v[28:29], v[56:57], v[136:137], v[28:29] neg_lo:[1,0,0] neg_hi:[1,0,0]
    v_pk_fma_f32 v[26:27], v[74:75], v[138:139], v[26:27]
    v_pk_fma_f32 v[30:31], v[58:59], v[138:139], v[30:31] neg_lo:[1,0,0] neg_hi:[1,0,0]
    v_cvt_pk_f16_f32 v40, v24, v28
    v_cvt_pk_f16_f32 v41, v25, v29
    v_cvt_pk_f16_f32 v42, v26, v30
    v_cvt_pk_f16_f32 v43, v27, v31
    v_pk_mul_f32 v[32:33], v[60:61], v[124:125]
    v_pk_mul_f32 v[36:37], v[76:77], v[124:125]
    v_pk_mul_f32 v[34:35], v[62:63], v[126:127]
    v_pk_mul_f32 v[38:39], v[78:79], v[126:127]
    v_pk_fma_f32 v[32:33], v[76:77], v[140:141], v[32:33]
    v_pk_fma_f32 v[36:37], v[60:61], v[140:141], v[36:37] neg_lo:[1,0,0] neg_hi:[1,0,0]
    v_pk_fma_f32 v[34:35], v[78:79], v[142:143], v[34:35]
    v_pk_fma_f32 v[38:39], v[62:63], v[142:143], v[38:39] neg_lo:[1,0,0] neg_hi:[1,0,0]
    v_cvt_pk_f16_f32 v44, v32, v36
    v_cvt_pk_f16_f32 v45, v33, v37
    v_cvt_pk_f16_f32 v46, v34, v38
    v_cvt_pk_f16_f32 v47, v35, v39
    v_mfma_f32_32x32x16_f16 v[216:231], v[40:43], v[88:91], 0
    v_mfma_f32_32x32x16_f16 v[232:247], v[40:43], v[104:107], 0
    v_pk_mul_f32 v[24:25], v[64:65], v[128:129]
    v_pk_mul_f32 v[28:29], v[80:81], v[128:129]
    v_pk_mul_f32 v[26:27], v[66:67], v[130:131]
    v_pk_mul_f32 v[30:31], v[82:83], v[130:131]
    v_pk_fma_f32 v[24:25], v[80:81], v[144:145], v[24:25]
    v_pk_fma_f32 v[28:29], v[64:65], v[144:145], v[28:29] neg_lo:[1,0,0] neg_hi:[1,0,0]
    v_pk_fma_f32 v[26:27], v[82:83], v[146:147], v[26:27]
    v_pk_fma_f32 v[30:31], v[66:67], v[146:147], v[30:31] neg_lo:[1,0,0] neg_hi:[1,0,0]
    v_cvt_pk_f16_f32 v48, v24, v28
    v_cvt_pk_f16_f32 v49, v25, v29
    v_cvt_pk_f16_f32 v50, v26, v30
    v_cvt_pk_f16_f32 v51, v27, v31
    v_mfma_f32_32x32x16_f16 v[216:231], v[44:47], v[92:95], v[216:231]
    v_mfma_f32_32x32x16_f16 v[232:247], v[44:47], v[108:111], v[232:247]
    v_pk_mul_f32 v[32:33], v[68:69], v[132:133]
    v_pk_mul_f32 v[36:37], v[84:85], v[132:133]
    v_pk_mul_f32 v[34:35], v[70:71], v[134:135]
    v_pk_mul_f32 v[38:39], v[86:87], v[134:135]
    v_pk_fma_f32 v[32:33], v[84:85], v[148:149], v[32:33]
    v_pk_fma_f32 v[36:37], v[68:69], v[148:149], v[36:37] neg_lo:[1,0,0] neg_hi:[1,0,0]
    v_pk_fma_f32 v[34:35], v[86:87], v[150:151], v[34:35]
    v_pk_fma_f32 v[38:39], v[70:71], v[150:151], v[38:39] neg_lo:[1,0,0] neg_hi:[1,0,0]
    v_cvt_pk_f16_f32 v52, v32, v36
    v_cvt_pk_f16_f32 v53, v33, v37
    v_cvt_pk_f16_f32 v54, v34, v38
    v_cvt_pk_f16_f32 v55, v35, v39
    v_mfma_f32_32x32x16_f16 v[216:231], v[48:51], v[96:99], v[216:231]
    v_mfma_f32_32x32x16_f16 v[232:247], v[48:51], v[112:115], v[232:247]
    v_mfma_f32_32x32x16_f16 v[232:247], v[52:55], v[116:119], v[232:247]
    v_mfma_f32_32x32x16_f16 v[216:231], v[52:55], v[100:103], v[216:231]
    s_nop 10
    ds_bpermute_b32 v12, v19, v232
    s_waitcnt lgkmcnt(1)
    v_pk_fma_f32 v[152:153], v[184:185], v[216:217], v[152:153]
    v_pk_fma_f32 v[154:155], v[186:187], v[218:219], v[154:155]
    v_pk_fma_f32 v[156:157], v[188:189], v[220:221], v[156:157]
    v_pk_fma_f32 v[158:159], v[190:191], v[222:223], v[158:159]
    v_pk_fma_f32 v[160:161], v[192:193], v[224:225], v[160:161]
    v_pk_fma_f32 v[162:163], v[194:195], v[226:227], v[162:163]
    v_pk_fma_f32 v[164:165], v[196:197], v[228:229], v[164:165]
    v_pk_fma_f32 v[166:167], v[198:199], v[230:231], v[166:167]
    v_pk_fma_f32 v[170:171], v[202:203], v[234:235], v[170:171]
    v_pk_fma_f32 v[172:173], v[204:205], v[236:237], v[172:173]
    v_pk_fma_f32 v[174:175], v[206:207], v[238:239], v[174:175]
    v_pk_fma_f32 v[176:177], v[208:209], v[240:241], v[176:177]
    v_pk_fma_f32 v[178:179], v[210:211], v[242:243], v[178:179]
    v_pk_fma_f32 v[180:181], v[212:213], v[244:245], v[180:181]
    v_pk_fma_f32 v[182:183], v[214:215], v[246:247], v[182:183]
    v_fmac_f32 v169, v201, v233
    s_waitcnt lgkmcnt(0)
    v_fmac_f32 v168, v200, v12
    ds_read_b128 v[216:219], v3 offset:28672
    ds_read_b128 v[220:223], v3 offset:29696
    ds_read_b128 v[224:227], v3 offset:30720
    ds_read_b128 v[228:231], v3 offset:31744
    ds_read_b128 v[232:235], v3 offset:32768
    ds_read_b128 v[236:239], v3 offset:33792
    ds_read_b128 v[240:243], v3 offset:34816
    ds_read_b128 v[244:247], v3 offset:35840
    s_waitcnt lgkmcnt(0)
    s_setprio 2
    s_branch f_join
k_done:
    s_endpgm
code_end:
.p2align 8
.type tables,@object
tables:
.long 0x3c00,0x3c00,0x3c00,0x3c00,0x3c008000,0x3c008000,0x3c008000,0x3c008000
.long 0x3c00,0x361f3b64,0x39a839a8,0x3b64361f,0x3c008000,0x3b64b61f,0x39a8b9a8,0x361fbb64
.long 0x3c00,0x39a839a8,0x3c000000,0x39a8b9a8,0x3c008000,0x39a8b9a8,0xbc00,0xb9a8b9a8
.long 0x3c00,0x3b64361f,0x39a8b9a8,0xb61fbb64,0x3c008000,0x361fbb64,0xb9a8b9a8,0xbb64361f
.long 0x3c00,0x3c000000,0xbc00,0xbc008000,0x3c008000,0xbc00,0xbc008000,0x80003c00
.long 0x3c00,0x3b64b61f,0xb9a8b9a8,0xb61f3b64,0x3c008000,0xb61fbb64,0xb9a839a8,0x3b64361f
.long 0x3c00,0x39a8b9a8,0xbc008000,0x39a839a8,0x3c008000,0xb9a8b9a8,0x80003c00,0x39a8b9a8
.long 0x3c00,0x361fbb64,0xb9a839a8,0x3b64b61f,0x3c008000,0xbb64b61f,0x39a839a8,0xb61fbb64
.long 0x3c00,0x3c00,0x3c00,0x3c00,0x3c008000,0x3c008000,0x3c008000,0x3c008000
.long 0x39a8b9a8,0x361fbb64,0x3c000000,0x3b64b61f,0xb9a8b9a8,0xbb64b61f,0xbc00,0xb61fbb64
.long 0xbc008000,0xb9a839a8,0xbc00,0xb9a8b9a8,0x80003c00,0x39a839a8,0xbc008000,0xb9a839a8
.long 0x39a839a8,0x3b64b61f,0xbc008000,0xb61f3b64,0x39a8b9a8,0xb61fbb64,0x80003c00,0x3b64361f
.long 0xbc00,0xbc008000,0x3c00,0x3c000000,0xbc008000,0x80003c00,0x3c008000,0xbc00
.long 0xb9a839a8,0x3b64361f,0x3c000000,0xb61fbb64,0x39a839a8,0x361fbb64,0xbc00,0xbb64361f
.long 0x3c000000,0xb9a8b9a8,0xbc00,0xb9a839a8,0xbc00,0xb9a839a8,0xbc008000,0x39a839a8
.long 0xb9a8b9a8,0x361f3b64,0xbc008000,0x3b64361f,0xb9a839a8,0x3b64b61f,0x80003c00,0x361fbb64
.long 0x3c00,0x3c00,0x3c00,0x3c00,0x3c008000,0x3c008000,0x3c008000,0x3c008000
.long 0xbc00,0xb61fbb64,0xb9a8b9a8,0xbb64b61f,0xbc008000,0xbb64361f,0xb9a839a8,0xb61f3b64
.long 0x3c00,0x39a839a8,0x3c000000,0x39a8b9a8,0x3c008000,0x39a8b9a8,0xbc00,0xb9a8b9a8
.long 0xbc00,0xbb64b61f,0xb9a839a8,0x361f3b64,0xbc008000,0xb61f3b64,0x39a839a8,0x3b64b61f
.long 0x3c00,0x3c000000,0xbc00,0xbc008000,0x3c008000,0xbc00,0xbc008000,0x80003c00
.long 0xbc00,0xbb64361f,0x39a839a8,0x361fbb64,0xbc008000,0x361f3b64,0x39a8b9a8,0xbb64b61f
.long 0x3c00,0x39a8b9a8,0xbc008000,0x39a839a8,0x3c008000,0xb9a8b9a8,0x80003c00,0x39a8b9a8
.long 0xbc00,0xb61f3b64,0x39a8b9a8,0xbb64361f,0xbc008000,0x3b64361f,0xb9a8b9a8,0x361f3b64
.long 0x3c00,0x3c00,0x3c00,0x3c00,0x3c008000,0x3c008000,0x3c008000,0x3c008000
.long 0xb9a839a8,0xb61f3b64,0xbc008000,0xbb64361f,0x39a839a8,0x3b64361f,0x80003c00,0x361f3b64
.long 0xbc008000,0xb9a839a8,0xbc00,0xb9a8b9a8,0x80003c00,0x39a839a8,0xbc008000,0xb9a839a8
.long 0xb9a8b9a8,0xbb64361f,0x3c000000,0x361fbb64,0xb9a839a8,0x361f3b64,0xbc00,0xbb64b61f
.long 0xbc00,0xbc008000,0x3c00,0x3c000000,0xbc008000,0x80003c00,0x3c008000,0xbc00
.long 0x39a8b9a8,0xbb64b61f,0xbc008000,0x361f3b64,0xb9a8b9a8,0xb61f3b64,0x80003c00,0x3b64b61f
.long 0x3c000000,0xb9a8b9a8,0xbc00,0xb9a839a8,0xbc00,0xb9a839a8,0xbc008000,0x39a839a8
.long 0x39a839a8,0xb61fbb64,0x3c000000,0xbb64b61f,0x39a8b9a8,0xbb64361f,0xbc00,0xb61f3b64
.long 0x3c00,0xbc00,0x3c00,0xbc00,0x3c008000,0xbc008000,0x3c008000,0xbc008000
.long 0x3c00,0xb61fbb64,0x39a839a8,0xbb64b61f,0x3c008000,0xbb64361f,0x39a8b9a8,0xb61f3b64
.long 0x3c00,0xb9a8b9a8,0x3c000000,0xb9a839a8,0x3c008000,0xb9a839a8,0xbc00,0x39a839a8
.long 0x3c00,0xbb64b61f,0x39a8b9a8,0x361f3b64,0x3c008000,0xb61f3b64,0xb9a8b9a8,0x3b64b61f
.long 0x3c00,0xbc008000,0xbc00,0x3c000000,0x3c008000,0x80003c00,0xbc008000,0xbc00
.long 0x3c00,0xbb64361f,0xb9a8b9a8,0x361fbb64,0x3c008000,0x361f3b64,0xb9a839a8,0xbb64b61f
.long 0x3c00,0xb9a839a8,0xbc008000,0xb9a8b9a8,0x3c008000,0x39a839a8,0x80003c00,0xb9a839a8
.long 0x3c00,0xb61f3b64,0xb9a839a8,0xbb64361f,0x3c008000,0x3b64361f,0x39a839a8,0x361f3b64
.long 0x3c00,0xbc00,0x3c00,0xbc00,0x3c008000,0xbc008000,0x3c008000,0xbc008000
.long 0x39a8b9a8,0xb61f3b64,0x3c000000,0xbb64361f,0xb9a8b9a8,0x3b64361f,0xbc00,0x361f3b64
.long 0xbc008000,0x39a8b9a8,0xbc00,0x39a839a8,0x80003c00,0xb9a8b9a8,0xbc008000,0x39a8b9a8
.long 0x39a839a8,0xbb64361f,0xbc008000,0x361fbb64,0x39a8b9a8,0x361f3b64,0x80003c00,0xbb64b61f
.long 0xbc00,0x3c000000,0x3c00,0xbc008000,0xbc008000,0xbc00,0x3c008000,0x80003c00
.long 0xb9a839a8,0xbb64b61f,0x3c000000,0x361f3b64,0x39a839a8,0xb61f3b64,0xbc00,0x3b64b61f
.long 0x3c000000,0x39a839a8,0xbc00,0x39a8b9a8,0xbc00,0x39a8b9a8,0xbc008000,0xb9a8b9a8
.long 0xb9a8b9a8,0xb61fbb64,0xbc008000,0xbb64b61f,0xb9a839a8,0xbb64361f,0x80003c00,0xb61f3b64
.long 0x3c00,0xbc00,0x3c00,0xbc00,0x3c008000,0xbc008000,0x3c008000,0xbc008000
.long 0xbc00,0x361f3b64,0xb9a8b9a8,0x3b64361f,0xbc008000,0x3b64b61f,0xb9a839a8,0x361fbb64
.long 0x3c00,0xb9a8b9a8,0x3c000000,0xb9a839a8,0x3c008000,0xb9a839a8,0xbc00,0x39a839a8
.long 0xbc00,0x3b64361f,0xb9a839a8,0xb61fbb64,0xbc008000,0x361fbb64,0x39a839a8,0xbb64361f
.long 0x3c00,0xbc008000,0xbc00,0x3c000000,0x3c008000,0x80003c00,0xbc008000,0xbc00
.long 0xbc00,0x3b64b61f,0x39a839a8,0xb61f3b64,0xbc008000,0xb61fbb64,0x39a8b9a8,0x3b64361f
.long 0x3c00,0xb9a839a8,0xbc008000,0xb9a8b9a8,0x3c008000,0x39a839a8,0x80003c00,0xb9a839a8
.long 0xbc00,0x361fbb64,0x39a8b9a8,0x3b64b61f,0xbc008000,0xbb64b61f,0xb9a8b9a8,0xb61fbb64
.long 0x3c00,0xbc00,0x3c00,0xbc00,0x3c008000,0xbc008000,0x3c008000,0xbc008000
.long 0xb9a839a8,0x361fbb64,0xbc008000,0x3b64b61f,0x39a839a8,0xbb64b61f,0x80003c00,0xb61fbb64
.long 0xbc008000,0x39a8b9a8,0xbc00,0x39a839a8,0x80003c00,0xb9a8b9a8,0xbc008000,0x39a8b9a8
.long 0xb9a8b9a8,0x3b64b61f,0x3c000000,0xb61f3b64,0xb9a839a8,0xb61fbb64,0xbc00,0x3b64361f
.long 0xbc00,0x3c000000,0x3c00,0xbc008000,0xbc008000,0xbc00,0x3c008000,0x80003c00
.long 0x39a8b9a8,0x3b64361f,0xbc008000,0xb61fbb64,0xb9a8b9a8,0x361fbb64,0x80003c00,0xbb64361f
.long 0x3c000000,0x39a839a8,0xbc00,0x39a8b9a8,0xbc00,0x39a8b9a8,0xbc008000,0xb9a8b9a8
.long 0x39a839a8,0x361f3b64,0x3c000000,0x3b64361f,0x39a8b9a8,0x3b64b61f,0xbc00,0x361fbb64
.long 0x3c00,0x3c00,0x3c00,0x3c00,0x3c00,0xbc00,0x3c00,0xbc00
.long 0x3c00,0x3b64,0x39a8,0x361f,0x8000,0xb61f,0xb9a8,0xbb64
.long 0x3c00,0x39a8,0x0,0xb9a8,0x8000,0xb9a8,0xbc00,0xb9a8
.long 0x3c00,0x361f,0xb9a8,0xbb64,0x8000,0xbb64,0xb9a8,0x361f
.long 0x3c00,0x0,0xbc00,0x8000,0x8000,0xbc00,0x8000,0x3c00
.long 0x3c00,0xb61f,0xb9a8,0x3b64,0x8000,0xbb64,0x39a8,0x361f
.long 0x3c00,0xb9a8,0x8000,0x39a8,0x8000,0xb9a8,0x3c00,0xb9a8
.long 0x3c00,0xbb64,0x39a8,0xb61f,0x8000,0xb61f,0x39a8,0xbb64
.long 0x3c00,0x3c00,0x3c00,0x3c00,0x3c00,0xbc00,0x3c00,0xbc00
.long 0xb9a8,0xbb64,0x0,0xb61f,0xb9a8,0xb61f,0xbc00,0xbb64
.long 0x8000,0x39a8,0xbc00,0xb9a8,0x3c00,0x39a8,0x8000,0x39a8
.long 0x39a8,0xb61f,0x8000,0x3b64,0xb9a8,0xbb64,0x3c00,0x361f
.long 0xbc00,0x8000,0x3c00,0x0,0x8000,0x3c00,0x8000,0xbc00
.long 0x39a8,0x361f,0x0,0xbb64,0x39a8,0xbb64,0xbc00,0x361f
.long 0x0,0xb9a8,0xbc00,0x39a8,0xbc00,0x39a8,0x8000,0x39a8
.long 0xb9a8,0x3b64,0x8000,0x361f,0x39a8,0xb61f,0x3c00,0xbb64
.long 0x3c00,0x3c00,0x3c00,0x3c00,0x3c00,0xbc00,0x3c00,0xbc00
.long 0xbc00,0xbb64,0xb9a8,0xb61f,0x8000,0x361f,0x39a8,0x3b64
.long 0x3c00,0x39a8,0x0,0xb9a8,0x8000,0xb9a8,0xbc00,0xb9a8
.long 0xbc00,0xb61f,0x39a8,0x3b64,0x8000,0x3b64,0x39a8,0xb61f
.long 0x3c00,0x0,0xbc00,0x8000,0x8000,0xbc00,0x8000,0x3c00
.long 0xbc00,0x361f,0x39a8,0xbb64,0x8000,0x3b64,0xb9a8,0xb61f
.long 0x3c00,0xb9a8,0x8000,0x39a8,0x8000,0xb9a8,0x3c00,0xb9a8
.long 0xbc00,0x3b64,0xb9a8,0x361f,0x8000,0x361f,0xb9a8,0x3b64
.long 0x3c00,0x3c00,0x3c00,0x3c00,0x3c00,0xbc00,0x3c00,0xbc00
.long 0x39a8,0x3b64,0x8000,0x361f,0x39a8,0x361f,0x3c00,0x3b64
.long 0x8000,0x39a8,0xbc00,0xb9a8,0x3c00,0x39a8,0x8000,0x39a8
.long 0xb9a8,0x361f,0x0,0xbb64,0x39a8,0x3b64,0xbc00,0xb61f
.long 0xbc00,0x8000,0x3c00,0x0,0x8000,0x3c00,0x8000,0xbc00
.long 0xb9a8,0xb61f,0x8000,0x3b64,0xb9a8,0x3b64,0x3c00,0xb61f
.long 0x0,0xb9a8,0xbc00,0x39a8,0xbc00,0x39a8,0x8000,0x39a8
.long 0x39a8,0xbb64,0x0,0xb61f,0xb9a8,0x361f,0xbc00,0x3b64
.long 0x3c000000,0xbbd90000,0x3b640000,0xbaa70000,0x80000000,0x323e0000,0xb61f0000,0x38720000
.long 0x3c000000,0xbaa70000,0x361f0000,0x323e0000,0x80000000,0x38720000,0xbb640000,0x3bd90000
.long 0x3c000000,0xb8720000,0xb61f0000,0x3bd90000,0x80000000,0x3aa70000,0xbb640000,0x323e0000
.long 0x3c000000,0xb23e0000,0xbb640000,0x38720000,0x80000000,0x3bd90000,0xb61f0000,0xbaa70000
.long 0x3c000000,0x323e0000,0xbb640000,0xb8720000,0x80000000,0x3bd90000,0x361f0000,0xbaa70000
.long 0x3c000000,0x38720000,0xb61f0000,0xbbd90000,0x80000000,0x3aa70000,0x3b640000,0x323e0000
.long 0x3c000000,0x3aa70000,0x361f0000,0xb23e0000,0x80000000,0x38720000,0x3b640000,0x3bd90000
.long 0x3c000000,0x3bd90000,0x3b640000,0x3aa70000,0x80000000,0x323e0000,0x361f0000,0x38720000
.long 0x361f0000,0xb23e0000,0x39a80000,0xb8720000,0xbb640000,0x3bd90000,0xb9a80000,0x3aa70000
.long 0xbb640000,0x38720000,0xb9a80000,0x3bd90000,0x361f0000,0xbaa70000,0xb9a80000,0x323e0000
.long 0x3b640000,0xbaa70000,0xb9a80000,0xb23e0000,0x361f0000,0x38720000,0x39a80000,0xbbd90000
.long 0xb61f0000,0x3bd90000,0x39a80000,0xbaa70000,0xbb640000,0xb23e0000,0x39a80000,0x38720000
.long 0xb61f0000,0xbbd90000,0x39a80000,0x3aa70000,0x3b640000,0xb23e0000,0xb9a80000,0x38720000
.long 0x3b640000,0x3aa70000,0xb9a80000,0x323e0000,0xb61f0000,0x38720000,0xb9a80000,0xbbd90000
.long 0xbb640000,0xb8720000,0xb9a80000,0xbbd90000,0xb61f0000,0xbaa70000,0x39a80000,0x323e0000
.long 0x361f0000,0x323e0000,0x39a80000,0x38720000,0x3b640000,0x3bd90000,0x39a80000,0x3aa70000
.long 0x80000000,0x323e0000,0xb61f0000,0x38720000,0xbc000000,0x3bd90000,0xbb640000,0x3aa70000
.long 0x80000000,0xb8720000,0x3b640000,0xbbd90000,0x3c000000,0xbaa70000,0x361f0000,0x323e0000
.long 0x80000000,0x3aa70000,0xbb640000,0x323e0000,0xbc000000,0x38720000,0x361f0000,0xbbd90000
.long 0x80000000,0xbbd90000,0x361f0000,0x3aa70000,0x3c000000,0xb23e0000,0xbb640000,0x38720000
.long 0x80000000,0x3bd90000,0x361f0000,0xbaa70000,0xbc000000,0xb23e0000,0x3b640000,0x38720000
.long 0x80000000,0xbaa70000,0xbb640000,0xb23e0000,0x3c000000,0x38720000,0xb61f0000,0xbbd90000
.long 0x80000000,0x38720000,0x3b640000,0x3bd90000,0xbc000000,0xbaa70000,0xb61f0000,0x323e0000
.long 0x80000000,0xb23e0000,0xb61f0000,0xb8720000,0x3c000000,0x3bd90000,0x3b640000,0x3aa70000
.long 0xbb640000,0x3bd90000,0xb9a80000,0x3aa70000,0xb61f0000,0x323e0000,0xb9a80000,0x38720000
.long 0xb61f0000,0x3aa70000,0x39a80000,0xb23e0000,0xbb640000,0x38720000,0xb9a80000,0x3bd90000
.long 0x361f0000,0x38720000,0x39a80000,0xbbd90000,0xbb640000,0x3aa70000,0x39a80000,0x323e0000
.long 0x3b640000,0x323e0000,0xb9a80000,0xb8720000,0xb61f0000,0x3bd90000,0x39a80000,0xbaa70000
.long 0x3b640000,0xb23e0000,0xb9a80000,0x38720000,0x361f0000,0x3bd90000,0xb9a80000,0xbaa70000
.long 0x361f0000,0xb8720000,0x39a80000,0x3bd90000,0x3b640000,0x3aa70000,0xb9a80000,0x323e0000
.long 0xb61f0000,0xbaa70000,0x39a80000,0x323e0000,0x3b640000,0x38720000,0x39a80000,0x3bd90000
.long 0xbb640000,0xbbd90000,0xb9a80000,0xbaa70000,0x361f0000,0x323e0000,0x39a80000,0x38720000
.size tables, 4096
all_end:
.section .rodata,"a"
.p2align 6
.amdhsa_kernel adaLN_cond__spectral_fnet__moe_arch_mod__prompt_kernel
  .amdhsa_next_free_vgpr 256
  .amdhsa_next_free_sgpr 84
  .amdhsa_accum_offset 256
  .amdhsa_group_segment_fixed_size 0
  .amdhsa_kernarg_size 120
  .amdhsa_user_sgpr_count 2
  .amdhsa_user_sgpr_kernarg_segment_ptr 1
  .amdhsa_system_sgpr_workgroup_id_x 1
  .amdhsa_float_denorm_mode_32 3
  .amdhsa_float_denorm_mode_16_64 3
.end_amdhsa_kernel
```

```asm
; @launch grid=(256,1,1) block=(512,1,1) lds=163840
.amdgcn_target "amdgcn-amd-amdhsa--gfx950"
.text
.globl adaLN_cond__spectral_fnet__moe_arch_mod__prompt_kernel
.p2align 8
.type adaLN_cond__spectral_fnet__moe_arch_mod__prompt_kernel,@function
adaLN_cond__spectral_fnet__moe_arch_mod__prompt_kernel:
    s_cmp_ge_u32 s2, 256
    s_cbranch_scc1 k_done
    s_load_dwordx2 s[8:9], s[0:1], 0
    s_load_dwordx4 s[56:59], s[0:1], 80
    s_load_dwordx4 s[24:27], s[0:1], 96
    s_load_dwordx2 s[12:13], s[0:1], 112
    s_load_dwordx8 s[48:55], s[0:1], 48
    s_memrealtime s[32:33]
    v_lshrrev_b32 v1, 6, v0
    v_and_b32 v2, 63, v0
    v_readfirstlane_b32 s16, v1
    v_lshlrev_b32 v3, 4, v2
    s_and_b32 s34, s2, 7
    s_bfe_u32 s35, s2, 0x40003
    s_mov_b32 s11, 0x00020000
    s_lshl_b32 s60, s35, 4
    s_add_u32 s60, s60, s34
    s_lshl_b32 s60, s60, 11
    s_bitcmp0_b32 s2, 7
    s_cbranch_scc1 g_start
    s_lshl_b32 s61, s16, 19
    s_add_u32 s60, s60, s61
    s_add_u32 s61, s60, 16384
    s_lshl_b32 s10, 1, 22
    s_waitcnt lgkmcnt(0)
    buffer_load_dwordx4 v[64:67], v3, s[8:11], s60 offen offset:0
    buffer_load_dwordx4 v[72:75], v3, s[8:11], s61 offen offset:0
    buffer_load_dwordx4 v[68:71], v3, s[8:11], s60 offen offset:1024
    buffer_load_dwordx4 v[76:79], v3, s[8:11], s61 offen offset:1024
    s_branch f_start
g_start:
    s_cmp_lt_u32 s16, 4
    s_cbranch_scc1 g_load
    s_getpc_b64 s[36:37]
g_pc:
    s_lshl_b32 s42, s35, 2
    s_add_u32 s42, s42, s16
    s_sub_u32 s42, s42, 4
    s_lshl_b32 s42, s42, 10
    v_lshl_add_u32 v4, v2, 7, s42
    v_min_u32 v4, all_end-g_pc-4, v4
    s_mov_b64 exec, 0xff
    global_load_dword v199, v4, s[36:37]
    s_mov_b64 exec, -1
    s_branch g_cons
h_non:
    s_mul_i32 s44, s32, 0x9e3779b1
    s_lshr_b32 s45, s44, 15
    s_xor_b32 s44, s44, s45
    s_mul_i32 s44, s44, 0x85ebca6b
    s_xor_b32 s33, s33, s44
    s_lshr_b32 s45, s44, 13
    s_xor_b32 s44, s44, s45
    s_mul_i32 s33, s33, 0xc2b2ae35
    s_add_u32 s33, s33, s32
    s_lshr_b32 s45, s33, 16
    s_xor_b32 s33, s33, s45
    s_mul_i32 s33, s33, 0x27d4eb2f
    s_or_b32 s32, s44, 1
    s_andn2_b32 s33, s33, 7
    v_mov_b32 v24, s32
    v_mov_b32 v25, s33
    v_lshlrev_b32 v26, 3, v2
    s_mov_b32 exec_hi, 0
    global_store_dwordx2 v26, v[24:25], s[26:27] sc1
    s_mov_b32 exec_hi, -1
    s_branch h_nonx
g_load:
    s_lshl_b32 s42, s16, 7
    s_and_b32 s42, s42, 128
    v_xor_b32 v6, s42, v3
    v_xor_b32 v7, 32, v6
    v_xor_b32 v8, 64, v6
    v_xor_b32 v9, 32, v8
    s_lshl_b32 s41, s35, 3
    s_add_u32 s41, s41, s16
    s_mul_i32 s18, s41, 96
    s_add_u32 s18, s18, s34
    s_cmp_ge_u32 s34, 6
    s_cselect_b32 s42, 2, 0
    s_add_u32 s18, s18, s42
    s_lshl_b32 s18, s18, 10
    s_lshl_b32 s68, s16, 13
    s_or_b32 m0, s68, 32768
    s_movk_i32 s43, 12288
    s_lshl_b32 s66, s43, 10
    s_mov_b32 s67, s11
    s_mov_b32 s42, s18
    s_or_b32 s40, s2, s16
    s_waitcnt lgkmcnt(0)
    s_cbranch_scc0 h_non
h_nonx:
    s_mov_b32 s64, s58
    s_mov_b32 s65, s59
    buffer_load_dwordx4 v6, s[64:67], s42 offen nt lds
    s_addk_i32 m0, 1024
    s_add_u32 s42, s42, s43
    buffer_load_dwordx4 v7, s[64:67], s42 offen nt lds
    s_addk_i32 m0, 1024
    s_add_u32 s42, s42, s43
    buffer_load_dwordx4 v8, s[64:67], s42 offen nt lds
    s_addk_i32 m0, 1024
    s_add_u32 s42, s42, s43
    buffer_load_dwordx4 v9, s[64:67], s42 offen nt lds
    s_addk_i32 m0, 1024
    s_add_u32 s42, s42, s43
    buffer_load_dwordx4 v6, s[64:67], s42 offen nt lds
    s_addk_i32 m0, 1024
    s_add_u32 s42, s42, s43
    buffer_load_dwordx4 v7, s[64:67], s42 offen nt lds
    s_addk_i32 m0, 1024
    s_add_u32 s42, s42, s43
    buffer_load_dwordx4 v8, s[64:67], s42 offen nt lds
    s_addk_i32 m0, 1024
    s_add_u32 s42, s42, s43
    buffer_load_dwordx4 v9, s[64:67], s42 offen nt lds
    s_addk_i32 m0, 1024
    s_add_u32 s42, s42, s43
    s_mov_b32 s69, s16
    s_xor_b32 s16, s16, 4
    v_xor_b32 v1, 4, v1
    v_xor_b32 v0, 0x100, v0
    v_lshlrev_b32 v13, 2, v2
    v_mov_b32 v220, 0
    v_mov_b32 v221, 0
    v_mov_b32 v233, 0
    v_mov_b32 v234, 0
    v_mov_b32 v235, 0
    s_mov_b32 s8, s58
    s_mov_b32 s9, s59
    s_mov_b32 s10, s66
    s_mov_b32 s14, 268435456
    s_mov_b32 s15, s11
    v_mov_b32 v4, 0
    s_lshl_b32 s42, s69, 7
    s_add_u32 s42, s42, 139264
    s_mov_b32 m0, s42
    s_lshl_b32 s42, s35, 7
    v_add_u32 v10, s42, v13
    s_mov_b32 exec_hi, 0
    global_load_lds_dword v10, s[56:57]
    s_mov_b32 exec_hi, -1
    s_lshl_b32 s19, s35, 2
    s_add_u32 s19, s19, s69
    s_mul_i32 s19, s19, 196608
    s_lshl_b32 s42, s34, 9
    s_add_u32 s19, s19, s42
    s_and_b32 s42, s34, 4
    s_lshl_b32 s42, s42, 9
    s_add_u32 s19, s19, s42
    s_add_u32 s19, s19, 6144
    v_lshrrev_b32 v5, 5, v2
    v_and_b32 v14, 0x1f0, v3
    v_lshlrev_b32 v12, 5, v5
    v_xor_b32 v14, v14, v12
    s_movk_i32 s42, 12288
    v_mad_u32_u24 v14, v5, s42, v14
    v_bfe_u32 v5, v0, 5, 1
    v_lshlrev_b32 v5, 3, v5
    v_bfe_u32 v12, v0, 3, 2
    v_add_u32 v5, v5, v12
    v_bfe_u32 v12, v0, 4, 2
    v_lshlrev_b32 v12, 1, v12
    v_xor_b32 v12, v12, v0
    v_and_b32 v12, 7, v12
    v_lshlrev_b32 v12, 4, v12
    s_movk_i32 s42, 7168
    v_mad_u32_u24 v5, v5, s42, v12
    s_mov_b32 s20, s26
    s_mov_b32 s21, s27
    s_mov_b32 s26, 4194304
    s_mov_b32 s27, 0x00020000
    s_and_b32 s65, s35, 1
    s_lshr_b32 s40, s35, 1
    s_mul_i32 s64, s34, 7
    s_add_u32 s64, s64, s40
    s_lshl_b32 s41, s34, 1
    s_add_u32 s41, s41, s65
    s_cmp_ge_u32 s35, 14
    s_cselect_b32 s66, 1, 0
    s_cselect_b32 s64, s41, s64
    v_lshrrev_b32 v10, 2, v2
    v_and_b32 v15, 3, v0
    v_bfe_u32 v11, v0, 3, 2
    v_xor_b32 v12, v11, v1
    v_and_b32 v12, 3, v12
    v_lshlrev_b32 v12, 5, v12
    v_lshl_add_u32 v12, v10, 7, v12
    v_lshl_add_u32 v12, v15, 3, v12
    v_lshrrev_b32 v16, 2, v1
    v_lshl_add_u32 v12, v16, 15, v12
    v_add_u32 v21, 65536, v12
    s_lshl_b32 s67, s65, 3
    s_add_u32 s67, s67, s69
    s_mul_i32 s67, s67, 458752
    s_lshl_b32 s42, s64, 7
    s_add_u32 s67, s67, s42
    s_mov_b32 s56, s50
    s_mov_b32 s57, s51
    s_mov_b32 s58, 7340032
    s_mov_b32 s59, 0x00020000
    s_mov_b32 s44, s52
    s_mov_b32 s45, s53
    s_mov_b32 s46, 7340032
    s_mov_b32 s47, 0x00020000
    s_waitcnt vmcnt(7)
    s_add_u32 s43, s68, 65536
    s_mov_b32 m0, s43
    s_add_u32 s42, s18, 393216
    buffer_load_dwordx4 v6, s[8:11], s42 offen nt lds
    s_waitcnt vmcnt(7)
    s_add_u32 s43, s68, 66560
    s_mov_b32 m0, s43
    s_add_u32 s42, s18, 405504
    buffer_load_dwordx4 v7, s[8:11], s42 offen nt lds
    s_load_dwordx2 s[32:33], s[20:21], 128
    s_waitcnt vmcnt(7)
    s_add_u32 s43, s68, 67584
    s_mov_b32 m0, s43
    s_add_u32 s42, s18, 417792
    buffer_load_dwordx4 v8, s[8:11], s42 offen nt lds
    s_waitcnt vmcnt(7)
    s_add_u32 s43, s68, 68608
    s_mov_b32 m0, s43
    s_add_u32 s42, s18, 430080
    buffer_load_dwordx4 v9, s[8:11], s42 offen nt lds
    s_waitcnt vmcnt(7)
    s_add_u32 s43, s68, 69632
    s_mov_b32 m0, s43
    s_add_u32 s42, s18, 442368
    buffer_load_dwordx4 v6, s[8:11], s42 offen nt lds
    s_waitcnt vmcnt(7)
    s_add_u32 s43, s68, 70656
    s_mov_b32 m0, s43
    s_add_u32 s42, s18, 454656
    buffer_load_dwordx4 v7, s[8:11], s42 offen nt lds
    s_waitcnt vmcnt(7)
    s_add_u32 s43, s68, 71680
    s_mov_b32 m0, s43
    s_add_u32 s42, s18, 466944
    buffer_load_dwordx4 v8, s[8:11], s42 offen nt lds
    s_waitcnt vmcnt(7)
    s_barrier
    s_add_u32 s43, s68, 72704
    s_mov_b32 m0, s43
    s_add_u32 s42, s18, 479232
    buffer_load_dwordx4 v9, s[8:11], s42 offen nt lds
    s_waitcnt lgkmcnt(0)
    s_cmp_lg_u32 s32, 0
    s_cbranch_scc1 g_n2x
    s_load_dwordx2 s[32:33], s[20:21], 192
    s_mov_b32 s83, 0
    v_mov_b32 v122, 0
    s_waitcnt lgkmcnt(0)
g_n2:
    s_cmp_lg_u32 s32, 0
    s_cbranch_scc1 g_n2x
    global_load_dwordx2 v[120:121], v122, s[20:21] sc1
    s_waitcnt vmcnt(0)
    v_readfirstlane_b32 s32, v120
    v_readfirstlane_b32 s33, v121
    s_add_u32 s83, s83, 1
    s_cmp_lt_u32 s83, 0x40000
    s_cbranch_scc1 g_n2
g_n2x:
    s_cmp_eq_u32 s66, 0
    s_cbranch_scc1 m_load
    v_mov_b32 v216, s32
    v_mov_b32 v217, s33
    v_and_b32 v218, 1, v0
    v_cmp_eq_u32 vcc, 1, v218
    s_nop 1
    v_cndmask_b32 v216, v216, v217, vcc
    v_bfe_u32 v217, v216, 8, 8
    v_bfe_u32 v218, v216, 16, 8
    v_lshrrev_b32 v219, 24, v216
    v_and_b32 v216, 0xff, v216
    s_lshl_b32 s81, s34, 16
    s_lshl_b32 s42, s16, 13
    s_add_u32 s81, s81, s42
    s_add_u32 s81, s81, 19922944
    s_lshl_b32 s42, s65, 9
    s_add_u32 s80, s81, s42
    s_add_u32 s81, s80, s42
    v_lshlrev_b32 v222, 4, v0
    v_lshrrev_b32 v223, 5, v2
    v_and_b32 v24, 0x1f0, v3
    v_lshl_add_u32 v223, v223, 12, v24
    s_lshl_b32 s39, s34, 4
    s_add_u32 s39, s39, s35
    s_lshl_b32 s39, s39, 12
    s_add_u32 s39, s39, 19922944
    s_bitcmp1_b32 s64, 2
    s_cselect_b32 s28, 1.0, 0
    s_waitcnt vmcnt(0)
    s_barrier
    s_branch x_start
m_load:
    s_waitcnt vmcnt(7)
    v_xor_b32 v4, 0, v14
    s_add_u32 s43, s68, 98304
    s_mov_b32 m0, s43
    s_add_u32 s42, s19, 0
    buffer_load_dwordx4 v4, s[8:11], s42 offen nt lds
    s_waitcnt vmcnt(7)
    v_xor_b32 v4, 64, v14
    s_add_u32 s43, s68, 99328
    s_mov_b32 m0, s43
    s_add_u32 s42, s19, 24576
    buffer_load_dwordx4 v4, s[8:11], s42 offen nt lds
    s_waitcnt vmcnt(7)
    v_xor_b32 v4, 0, v14
    s_add_u32 s43, s68, 100352
    s_mov_b32 m0, s43
    s_add_u32 s42, s19, 49152
    buffer_load_dwordx4 v4, s[8:11], s42 offen nt lds
    s_waitcnt vmcnt(7)
    v_xor_b32 v4, 64, v14
    s_add_u32 s43, s68, 101376
    s_mov_b32 m0, s43
    s_add_u32 s42, s19, 73728
    buffer_load_dwordx4 v4, s[8:11], s42 offen nt lds
    s_waitcnt vmcnt(4)
    s_barrier
    s_barrier
    s_waitcnt vmcnt(7)
    v_xor_b32 v4, 128, v14
    s_add_u32 s43, s68, 102400
    s_mov_b32 m0, s43
    s_add_u32 s42, s19, 98304
    buffer_load_dwordx4 v4, s[8:11], s42 offen nt lds
    s_waitcnt vmcnt(7)
    v_xor_b32 v4, 192, v14
    s_add_u32 s43, s68, 103424
    s_mov_b32 m0, s43
    s_add_u32 s42, s19, 122880
    buffer_load_dwordx4 v4, s[8:11], s42 offen nt lds
    s_waitcnt vmcnt(7)
    v_xor_b32 v4, 128, v14
    s_add_u32 s43, s68, 104448
    s_mov_b32 m0, s43
    s_add_u32 s42, s19, 147456
    buffer_load_dwordx4 v4, s[8:11], s42 offen nt lds
    s_waitcnt vmcnt(7)
    v_xor_b32 v4, 192, v14
    s_add_u32 s43, s68, 105472
    s_mov_b32 m0, s43
    s_add_u32 s42, s19, 172032
    buffer_load_dwordx4 v4, s[8:11], s42 offen nt lds
    s_waitcnt vmcnt(7)
    s_add_u32 s43, s68, 0
    s_mov_b32 m0, s43
    s_add_u32 s42, s67, 0
    buffer_load_dwordx4 v5, s[56:59], s42 offen nt lds
    s_waitcnt vmcnt(7)
    s_add_u32 s43, s68, 1024
    s_mov_b32 m0, s43
    s_add_u32 s42, s67, 114688
    buffer_load_dwordx4 v5, s[56:59], s42 offen nt lds
    s_waitcnt vmcnt(7)
    s_add_u32 s43, s68, 2048
    s_mov_b32 m0, s43
    s_add_u32 s42, s67, 28672
    buffer_load_dwordx4 v5, s[56:59], s42 offen nt lds
    s_waitcnt vmcnt(7)
    s_add_u32 s43, s68, 3072
    s_mov_b32 m0, s43
    s_add_u32 s42, s67, 143360
    buffer_load_dwordx4 v5, s[56:59], s42 offen nt lds
    s_waitcnt vmcnt(7)
    s_add_u32 s43, s68, 4096
    s_mov_b32 m0, s43
    s_add_u32 s42, s67, 229376
    buffer_load_dwordx4 v5, s[56:59], s42 offen nt lds
    s_waitcnt vmcnt(7)
    s_add_u32 s43, s68, 5120
    s_mov_b32 m0, s43
    s_add_u32 s42, s67, 344064
    buffer_load_dwordx4 v5, s[56:59], s42 offen nt lds
    s_waitcnt vmcnt(6)
    s_barrier
    s_barrier
    s_waitcnt vmcnt(7)
    s_add_u32 s43, s68, 6144
    s_mov_b32 m0, s43
    s_add_u32 s42, s67, 258048
    buffer_load_dwordx4 v5, s[56:59], s42 offen nt lds
    s_waitcnt vmcnt(7)
    s_add_u32 s43, s68, 7168
    s_mov_b32 m0, s43
    s_add_u32 s42, s67, 372736
    buffer_load_dwordx4 v5, s[56:59], s42 offen nt lds
    s_waitcnt vmcnt(9)
    s_add_u32 s43, s68, 32768
    s_mov_b32 m0, s43
    s_add_u32 s42, s67, 1835008
    buffer_load_dwordx4 v5, s[56:59], s42 offen nt lds
    s_waitcnt vmcnt(9)
    s_add_u32 s43, s68, 33792
    s_mov_b32 m0, s43
    s_add_u32 s42, s67, 1949696
    buffer_load_dwordx4 v5, s[56:59], s42 offen nt lds
    s_waitcnt vmcnt(9)
    s_add_u32 s43, s68, 34816
    s_mov_b32 m0, s43
    s_add_u32 s42, s67, 1863680
    buffer_load_dwordx4 v5, s[56:59], s42 offen nt lds
    s_waitcnt vmcnt(9)
    s_add_u32 s43, s68, 35840
    s_mov_b32 m0, s43
    s_add_u32 s42, s67, 1978368
    buffer_load_dwordx4 v5, s[56:59], s42 offen nt lds
    s_waitcnt vmcnt(9)
    s_add_u32 s43, s68, 36864
    s_mov_b32 m0, s43
    s_add_u32 s42, s67, 2064384
    buffer_load_dwordx4 v5, s[56:59], s42 offen nt lds
    s_waitcnt vmcnt(9)
    s_add_u32 s43, s68, 37888
    s_mov_b32 m0, s43
    s_add_u32 s42, s67, 2179072
    buffer_load_dwordx4 v5, s[56:59], s42 offen nt lds
    s_waitcnt vmcnt(9)
    s_add_u32 s43, s68, 38912
    s_mov_b32 m0, s43
    s_add_u32 s42, s67, 2093056
    buffer_load_dwordx4 v5, s[56:59], s42 offen nt lds
    s_waitcnt vmcnt(9)
    s_add_u32 s43, s68, 39936
    s_mov_b32 m0, s43
    s_add_u32 s42, s67, 2207744
    buffer_load_dwordx4 v5, s[56:59], s42 offen nt lds
    s_waitcnt vmcnt(9)
    s_add_u32 s43, s68, 65536
    s_mov_b32 m0, s43
    s_add_u32 s42, s67, 0
    buffer_load_dwordx4 v5, s[44:47], s42 offen nt lds
    s_waitcnt vmcnt(9)
    s_barrier
    s_add_u32 s43, s68, 66560
    s_mov_b32 m0, s43
    s_add_u32 s42, s67, 114688
    buffer_load_dwordx4 v5, s[44:47], s42 offen nt lds
    s_waitcnt vmcnt(9)
    s_add_u32 s43, s68, 67584
    s_mov_b32 m0, s43
    s_add_u32 s42, s67, 28672
    buffer_load_dwordx4 v5, s[44:47], s42 offen nt lds
    s_waitcnt vmcnt(9)
    s_add_u32 s43, s68, 68608
    s_mov_b32 m0, s43
    s_add_u32 s42, s67, 143360
    buffer_load_dwordx4 v5, s[44:47], s42 offen nt lds
    s_waitcnt vmcnt(9)
    s_add_u32 s43, s68, 69632
    s_mov_b32 m0, s43
    s_add_u32 s42, s67, 229376
    buffer_load_dwordx4 v5, s[44:47], s42 offen nt lds
    s_waitcnt vmcnt(9)
    s_add_u32 s43, s68, 70656
    s_mov_b32 m0, s43
    s_add_u32 s42, s67, 344064
    buffer_load_dwordx4 v5, s[44:47], s42 offen nt lds
    s_waitcnt vmcnt(9)
    s_add_u32 s43, s68, 71680
    s_mov_b32 m0, s43
    s_add_u32 s42, s67, 258048
    buffer_load_dwordx4 v5, s[44:47], s42 offen nt lds
    s_waitcnt vmcnt(9)
    s_add_u32 s43, s68, 72704
    s_mov_b32 m0, s43
    s_add_u32 s42, s67, 372736
    buffer_load_dwordx4 v5, s[44:47], s42 offen nt lds
    s_waitcnt vmcnt(9)
    s_add_u32 s43, s68, 98304
    s_mov_b32 m0, s43
    s_add_u32 s42, s67, 1835008
    buffer_load_dwordx4 v5, s[44:47], s42 offen nt lds
    s_waitcnt vmcnt(9)
    s_barrier
    ds_read_b64_tr_b16 v[64:65], v12 offset:0
    ds_read_b64_tr_b16 v[66:67], v12 offset:2048
    ds_read_b64_tr_b16 v[68:69], v12 offset:4096
    ds_read_b64_tr_b16 v[70:71], v12 offset:6144
    ds_read_b64_tr_b16 v[72:73], v12 offset:8192
    ds_read_b64_tr_b16 v[74:75], v12 offset:10240
    ds_read_b64_tr_b16 v[76:77], v12 offset:12288
    ds_read_b64_tr_b16 v[78:79], v12 offset:14336
    ds_read_b64_tr_b16 v[80:81], v12 offset:16384
    ds_read_b64_tr_b16 v[82:83], v12 offset:18432
    ds_read_b64_tr_b16 v[84:85], v12 offset:20480
    ds_read_b64_tr_b16 v[86:87], v12 offset:22528
    ds_read_b64_tr_b16 v[88:89], v12 offset:24576
    ds_read_b64_tr_b16 v[90:91], v12 offset:26624
    ds_read_b64_tr_b16 v[92:93], v12 offset:28672
    ds_read_b64_tr_b16 v[94:95], v12 offset:30720
    s_add_u32 s43, s68, 99328
    s_mov_b32 m0, s43
    s_add_u32 s42, s67, 1949696
    buffer_load_dwordx4 v5, s[44:47], s42 offen nt lds
    s_waitcnt vmcnt(9)
    s_add_u32 s43, s68, 100352
    s_mov_b32 m0, s43
    s_add_u32 s42, s67, 1863680
    buffer_load_dwordx4 v5, s[44:47], s42 offen nt lds
    s_waitcnt vmcnt(9)
    s_add_u32 s43, s68, 101376
    s_mov_b32 m0, s43
    s_add_u32 s42, s67, 1978368
    buffer_load_dwordx4 v5, s[44:47], s42 offen nt lds
    s_waitcnt vmcnt(9)
    s_add_u32 s43, s68, 102400
    s_mov_b32 m0, s43
    s_add_u32 s42, s67, 2064384
    buffer_load_dwordx4 v5, s[44:47], s42 offen nt lds
    s_waitcnt vmcnt(9)
    s_add_u32 s43, s68, 103424
    s_mov_b32 m0, s43
    s_add_u32 s42, s67, 2179072
    buffer_load_dwordx4 v5, s[44:47], s42 offen nt lds
    s_waitcnt vmcnt(9)
    s_add_u32 s43, s68, 104448
    s_mov_b32 m0, s43
    s_add_u32 s42, s67, 2093056
    buffer_load_dwordx4 v5, s[44:47], s42 offen nt lds
    s_waitcnt vmcnt(9)
    s_add_u32 s43, s68, 105472
    s_mov_b32 m0, s43
    s_add_u32 s42, s67, 2207744
    buffer_load_dwordx4 v5, s[44:47], s42 offen nt lds
    s_branch m_join
g_cons:
    s_xor_b32 s16, s16, 4
    v_xor_b32 v1, 4, v1
    v_xor_b32 v0, 0x100, v0
    v_lshlrev_b32 v13, 2, v2
    v_mov_b32 v220, 0
    v_mov_b32 v221, 0
    v_mov_b32 v233, 0
    v_mov_b32 v234, 0
    v_mov_b32 v235, 0
    s_mov_b32 s14, 268435456
    s_mov_b32 s15, s11
    s_lshl_b32 s29, s34, 4
    s_add_u32 s29, s29, s35
    s_lshl_b32 s29, s29, 12
    s_add_u32 s29, s29, 19922944
    s_lshl_b32 s30, s16, 9
    s_add_u32 s30, s30, s29
    s_lshl_b32 s31, s16, 8
    s_add_u32 s31, s31, s29
    s_add_u32 s31, s31, 2048
    v_lshlrev_b32 v8, 1, v2
    v_lshlrev_b32 v9, 7, v2
    v_mov_b32 v104, -1
    v_mov_b32 v105, -1
    v_mov_b32 v106, -1
    v_mov_b32 v107, -1
    s_waitcnt lgkmcnt(0)
    s_cmp_eq_u32 s16, 1
    s_cselect_b64 exec, 0xffffff, 1
    buffer_load_dword v245, v9, s[12:15], s29 offen sc1
    s_mov_b64 exec, -1
    v_mov_b32 v14, 0
    s_mov_b32 s8, s58
    s_mov_b32 s9, s59
    s_mov_b32 s10, 12582912
    s_mov_b32 s11, 0x00020000
    s_mov_b32 s20, s26
    s_mov_b32 s21, s27
    s_mov_b32 s26, 4194304
    s_mov_b32 s27, 0x00020000
    s_and_b32 s65, s35, 1
    s_lshr_b32 s40, s35, 1
    s_mul_i32 s64, s34, 7
    s_add_u32 s64, s64, s40
    s_lshl_b32 s41, s34, 1
    s_add_u32 s41, s41, s65
    s_cmp_ge_u32 s35, 14
    s_cselect_b32 s66, 1, 0
    s_cselect_b32 s64, s41, s64
    v_lshrrev_b32 v10, 2, v2
    v_and_b32 v15, 3, v0
    v_bfe_u32 v11, v0, 3, 2
    v_xor_b32 v12, v11, v1
    v_and_b32 v12, 3, v12
    v_lshlrev_b32 v12, 5, v12
    v_lshl_add_u32 v12, v10, 7, v12
    v_lshl_add_u32 v12, v15, 3, v12
    v_lshrrev_b32 v16, 2, v1
    v_lshl_add_u32 v12, v16, 15, v12
    v_add_u32 v21, 65536, v12
    v_bfe_u32 v22, v0, 2, 3
    v_lshlrev_b32 v22, 5, v22
    v_lshl_add_u32 v22, v15, 3, v22
    v_bfe_u32 v23, v0, 2, 2
    v_bfe_u32 v24, v0, 4, 2
    v_lshl_add_u32 v23, v24, 3, v23
    v_lshl_add_u32 v200, v23, 10, v22
    v_lshl_add_u32 v200, v1, 8, v200
    v_add_u32 v200, 32768, v200
    v_lshlrev_b32 v25, 7, v1
    v_xor_b32 v22, v22, v25
    v_lshl_add_u32 v208, v23, 9, v22
    v_add_u32 v208, 98304, v208
    v_cmp_eq_u32 s[60:61], 1, v24
    v_cmp_eq_u32 s[62:63], 2, v24
    v_cmp_eq_u32 s[72:73], 3, v24
    v_add_u32 v8, v8, v25
    v_add_u32 v8, 139264, v8
    v_lshl_add_u32 v10, v24, 4, v25
    v_add_u32 v10, 139264, v10
    v_xor_b32 v201, 32, v200
    v_xor_b32 v202, 64, v200
    v_xor_b32 v203, 96, v200
    v_xor_b32 v204, 128, v200
    v_xor_b32 v205, 160, v200
    v_xor_b32 v206, 192, v200
    v_xor_b32 v207, 224, v200
    v_xor_b32 v209, 32, v208
    v_xor_b32 v210, 64, v208
    v_xor_b32 v211, 96, v208
    s_sleep 8
    s_load_dwordx2 s[32:33], s[20:21], 128
    s_waitcnt lgkmcnt(0)
    s_cmp_lg_u32 s32, 0
    s_cbranch_scc1 g_nnx
    s_load_dwordx2 s[32:33], s[20:21], 192
    s_mov_b32 s83, 0
    v_mov_b32 v114, 0
    s_waitcnt lgkmcnt(0)
g_nn:
    s_cmp_lg_u32 s32, 0
    s_cbranch_scc1 g_nnx
    global_load_dwordx2 v[112:113], v114, s[20:21] sc1
    s_waitcnt vmcnt(0)
    v_readfirstlane_b32 s32, v112
    v_readfirstlane_b32 s33, v113
    s_add_u32 s83, s83, 1
    s_cmp_lt_u32 s83, 0x40000
    s_cbranch_scc1 g_nn
g_nnx:
    v_mov_b32 v212, s32
    v_mov_b32 v213, s33
    v_and_b32 v214, 7, v0
    v_lshlrev_b32 v214, 3, v214
    v_lshrrev_b64 v[212:213], v214, v[212:213]
    v_and_b32 v212, 0xff, v212
    s_movk_i32 s74, 0xff00
    s_cmp_ge_u32 s16, s66
    s_cbranch_scc1 g_nw
    s_lshr_b32 s22, s64, 2
    s_cmp_eq_u32 s22, 3
    s_cselect_b32 s22, 6, s22
    s_lshl_b32 s22, s22, 12
    s_add_u32 s22, s22, 16875520
    s_lshr_b32 s23, s64, 3
    s_lshl_b32 s23, s23, 13
    s_add_u32 s23, s23, 16908288
    s_mov_b32 s75, 16891904
    v_bfe_u32 v24, v0, 2, 1
    v_bfe_u32 v25, v0, 3, 2
    v_bfe_u32 v26, v0, 5, 1
    v_lshlrev_b32 v220, 4, v15
    v_lshl_add_u32 v220, v24, 9, v220
    v_lshl_add_u32 v220, v25, 10, v220
    s_and_b32 s42, s64, 3
    s_lshl_b32 s42, s42, 7
    s_and_b32 s43, s64, 4
    s_lshl_b32 s43, s43, 4
    s_add_u32 s42, s42, s43
    v_add_u32 v233, s42, v220
    v_lshl_add_u32 v220, v26, 7, v220
    s_and_b32 s42, s64, 1
    s_lshl_b32 s42, s42, 8
    s_and_b32 s43, s64, 2
    s_lshl_b32 s43, s43, 5
    s_add_u32 s42, s42, s43
    v_add_u32 v220, s42, v220
    v_xor_b32 v234, 8176, v220
    v_xor_b32 v235, 8176, v233
    v_lshlrev_b32 v221, 7, v15
    v_lshl_add_u32 v221, v24, 6, v221
    v_lshl_add_u32 v221, v25, 4, v221
    v_lshl_add_u32 v221, v26, 9, v221
    v_add_u32 v232, 8, v2
    v_and_b32 v232, 31, v232
    v_lshl_add_u32 v232, v26, 5, v232
    v_lshlrev_b32 v232, 2, v232
    s_lshl_b32 s79, s64, 7
    s_add_u32 s79, s79, 16850944
    v_xor_b32 v0, 1, v0
    v_mov_b32 v228, s32
    v_mov_b32 v229, s33
    v_and_b32 v230, 1, v0
    v_cmp_eq_u32 vcc, 1, v230
    s_nop 1
    v_cndmask_b32 v228, v228, v229, vcc
    v_bfe_u32 v229, v228, 8, 8
    v_bfe_u32 v230, v228, 16, 8
    v_lshrrev_b32 v231, 24, v228
    v_and_b32 v228, 0xff, v228
    v_xor_b32 v0, 1, v0
    s_mov_b32 s44, s48
    s_mov_b32 s45, s49
    s_mov_b32 s46, 2048
    s_mov_b32 s47, 0x00020000
    v_lshrrev_b32 v11, 1, v221
    s_and_b32 s42, s64, 3
    s_lshl_b32 s42, s42, 9
    buffer_load_dwordx2 v[52:53], v11, s[44:47], s42 offen
    v_mov_b32 v216, s32
    v_mov_b32 v217, s33
    v_and_b32 v218, 1, v0
    v_cmp_eq_u32 vcc, 1, v218
    s_nop 1
    v_cndmask_b32 v216, v216, v217, vcc
    v_bfe_u32 v217, v216, 8, 8
    v_bfe_u32 v218, v216, 16, 8
    v_lshrrev_b32 v219, 24, v216
    v_and_b32 v216, 0xff, v216
    v_not_b32 v24, v216
    v_not_b32 v25, v229
    buffer_store_dwordx4 v[24:27], v220, s[12:15], s22 offen sc1
    s_mov_b32 exec_hi, 0
    buffer_store_dwordx4 v[24:27], v233, s[12:15], s23 offen sc1
    buffer_store_dwordx4 v[24:27], v235, s[12:15], s23 offen sc1
    s_mov_b64 exec, 0xff
    buffer_store_dwordx4 v[104:107], v3, s[12:15], s79 offen sc1
    s_mov_b64 exec, -1
    s_cmp_lt_u32 s64, 8
    s_cbranch_scc1 g_nw
    buffer_store_dwordx4 v[24:27], v234, s[12:15], s22 offen sc1
    s_cmp_lt_u32 s64, 12
    s_cbranch_scc1 g_nw
    buffer_store_dwordx4 v[24:27], v220, s[12:15], s75 offen sc1
    buffer_store_dwordx4 v[24:27], v234, s[12:15], s75 offen sc1
g_nw:
    s_barrier
    ds_read_u16 v6, v8
    s_waitcnt lgkmcnt(0)
    v_lshlrev_b32 v6, 16, v6
    v_mul_f32 v24, 0xbfb8aa3b, v6
    v_exp_f32 v24, v24
    s_nop 0
    v_add_f32 v24, 1.0, v24
    v_rcp_f32 v24, v24
    s_nop 0
    v_mul_f32 v6, v6, v24
    v_cvt_pk_bf16_f32 v6, v6, v6
    ds_write_b16 v8, v6
    ds_read_b128 v[120:123], v10
    ds_read_b128 v[124:127], v10 offset:64
    ds_read_b64_tr_b16 v[128:129], v200 offset:0
    ds_read_b64_tr_b16 v[130:131], v200 offset:4096
    ds_read_b64_tr_b16 v[132:133], v201 offset:0
    ds_read_b64_tr_b16 v[134:135], v201 offset:4096
    ds_read_b64_tr_b16 v[136:137], v202 offset:0
    ds_read_b64_tr_b16 v[138:139], v202 offset:4096
    ds_read_b64_tr_b16 v[140:141], v203 offset:0
    ds_read_b64_tr_b16 v[142:143], v203 offset:4096
    ds_read_b64_tr_b16 v[144:145], v204 offset:0
    ds_read_b64_tr_b16 v[146:147], v204 offset:4096
    ds_read_b64_tr_b16 v[148:149], v205 offset:0
    ds_read_b64_tr_b16 v[150:151], v205 offset:4096
    ds_read_b64_tr_b16 v[152:153], v206 offset:0
    ds_read_b64_tr_b16 v[154:155], v206 offset:4096
    s_waitcnt lgkmcnt(12)
    v_mfma_f32_16x16x32_bf16 v[64:67], v[120:123], v[128:131], 0
    ds_read_b64_tr_b16 v[156:157], v207 offset:0
    ds_read_b64_tr_b16 v[158:159], v207 offset:4096
    s_waitcnt lgkmcnt(12)
    v_mfma_f32_16x16x32_bf16 v[68:71], v[120:123], v[132:135], 0
    s_waitcnt lgkmcnt(10)
    v_mfma_f32_16x16x32_bf16 v[72:75], v[120:123], v[136:139], 0
    s_waitcnt lgkmcnt(8)
    v_mfma_f32_16x16x32_bf16 v[76:79], v[120:123], v[140:143], 0
    s_waitcnt lgkmcnt(6)
    v_mfma_f32_16x16x32_bf16 v[80:83], v[120:123], v[144:147], 0
    s_waitcnt lgkmcnt(4)
    v_mfma_f32_16x16x32_bf16 v[84:87], v[120:123], v[148:151], 0
    s_waitcnt lgkmcnt(2)
    v_mfma_f32_16x16x32_bf16 v[88:91], v[120:123], v[152:155], 0
    s_waitcnt lgkmcnt(0)
    v_mfma_f32_16x16x32_bf16 v[92:95], v[120:123], v[156:159], 0
    v_mov_b32 v216, s32
    v_mov_b32 v217, s33
    v_and_b32 v218, 1, v0
    v_cmp_eq_u32 vcc, 1, v218
    s_nop 1
    v_cndmask_b32 v216, v216, v217, vcc
    v_bfe_u32 v217, v216, 8, 8
    v_bfe_u32 v218, v216, 16, 8
    v_lshrrev_b32 v219, 24, v216
    v_and_b32 v216, 0xff, v216
    s_lshl_b32 s81, s34, 16
    s_lshl_b32 s42, s16, 13
    s_add_u32 s81, s81, s42
    s_add_u32 s81, s81, 19922944
    s_lshl_b32 s42, s65, 9
    s_add_u32 s80, s81, s42
    s_add_u32 s81, s80, s42
    v_lshlrev_b32 v222, 4, v0
    v_lshrrev_b32 v223, 5, v2
    v_and_b32 v24, 0x1f0, v3
    v_lshl_add_u32 v223, v223, 12, v24
    s_lshl_b32 s39, s34, 4
    s_add_u32 s39, s39, s35
    s_lshl_b32 s39, s39, 12
    s_add_u32 s39, s39, 19922944
    s_bitcmp1_b32 s64, 2
    s_cselect_b32 s28, 1.0, 0
    s_barrier
    ds_read_b64_tr_b16 v[128:129], v200 offset:32768
    ds_read_b64_tr_b16 v[130:131], v200 offset:36864
    ds_read_b64_tr_b16 v[132:133], v201 offset:32768
    ds_read_b64_tr_b16 v[134:135], v201 offset:36864
    ds_read_b64_tr_b16 v[136:137], v202 offset:32768
    ds_read_b64_tr_b16 v[138:139], v202 offset:36864
    ds_read_b64_tr_b16 v[140:141], v203 offset:32768
    ds_read_b64_tr_b16 v[142:143], v203 offset:36864
    ds_read_b64_tr_b16 v[144:145], v204 offset:32768
    ds_read_b64_tr_b16 v[146:147], v204 offset:36864
    ds_read_b64_tr_b16 v[148:149], v205 offset:32768
    ds_read_b64_tr_b16 v[150:151], v205 offset:36864
    ds_read_b64_tr_b16 v[152:153], v206 offset:32768
    ds_read_b64_tr_b16 v[154:155], v206 offset:36864
    s_waitcnt lgkmcnt(12)
    v_mfma_f32_16x16x32_bf16 v[64:67], v[124:127], v[128:131], v[64:67]
    ds_read_b64_tr_b16 v[156:157], v207 offset:32768
    ds_read_b64_tr_b16 v[158:159], v207 offset:36864
    s_waitcnt lgkmcnt(12)
    v_mfma_f32_16x16x32_bf16 v[68:71], v[124:127], v[132:135], v[68:71]
    s_waitcnt lgkmcnt(10)
    v_mfma_f32_16x16x32_bf16 v[72:75], v[124:127], v[136:139], v[72:75]
    s_waitcnt lgkmcnt(8)
    v_mfma_f32_16x16x32_bf16 v[76:79], v[124:127], v[140:143], v[76:79]
    s_waitcnt lgkmcnt(6)
    v_mfma_f32_16x16x32_bf16 v[80:83], v[124:127], v[144:147], v[80:83]
    s_waitcnt lgkmcnt(4)
    v_mfma_f32_16x16x32_bf16 v[84:87], v[124:127], v[148:151], v[84:87]
    s_waitcnt lgkmcnt(2)
    v_mfma_f32_16x16x32_bf16 v[88:91], v[124:127], v[152:155], v[88:91]
    s_waitcnt lgkmcnt(0)
    v_mfma_f32_16x16x32_bf16 v[92:95], v[124:127], v[156:159], v[92:95]
    v_cndmask_b32 v64, v64, v68, s[60:61]
    v_cndmask_b32 v64, v64, v72, s[62:63]
    v_cndmask_b32 v64, v64, v76, s[72:73]
    v_and_or_b32 v224, v64, s74, v212
    v_cndmask_b32 v80, v80, v84, s[60:61]
    s_nop 0
    v_cndmask_b32 v80, v80, v88, s[62:63]
    s_nop 0
    v_cndmask_b32 v80, v80, v92, s[72:73]
    v_and_or_b32 v225, v80, s74, v212
    buffer_store_dword v224, v13, s[12:15], s30 offen offset:0
    buffer_store_dword v225, v13, s[12:15], s30 offen offset:256
    s_cmp_eq_u32 s66, 1
    s_cbranch_scc1 x_start
    s_barrier
    s_barrier
    ds_read_b64_tr_b16 v[128:129], v208 offset:0
    ds_read_b64_tr_b16 v[130:131], v208 offset:2048
    ds_read_b64_tr_b16 v[132:133], v209 offset:0
    ds_read_b64_tr_b16 v[134:135], v209 offset:2048
    ds_read_b64_tr_b16 v[136:137], v210 offset:0
    ds_read_b64_tr_b16 v[138:139], v210 offset:2048
    ds_read_b64_tr_b16 v[140:141], v211 offset:0
    ds_read_b64_tr_b16 v[142:143], v211 offset:2048
    ds_read_b64_tr_b16 v[144:145], v208 offset:16384
    ds_read_b64_tr_b16 v[146:147], v208 offset:18432
    ds_read_b64_tr_b16 v[148:149], v209 offset:16384
    ds_read_b64_tr_b16 v[150:151], v209 offset:18432
    ds_read_b64_tr_b16 v[152:153], v210 offset:16384
    ds_read_b64_tr_b16 v[154:155], v210 offset:18432
    s_waitcnt lgkmcnt(12)
    v_mfma_f32_16x16x32_bf16 v[64:67], v[120:123], v[128:131], 0
    ds_read_b64_tr_b16 v[156:157], v211 offset:16384
    ds_read_b64_tr_b16 v[158:159], v211 offset:18432
    s_waitcnt lgkmcnt(12)
    v_mfma_f32_16x16x32_bf16 v[68:71], v[120:123], v[132:135], 0
    s_waitcnt lgkmcnt(10)
    v_mfma_f32_16x16x32_bf16 v[72:75], v[120:123], v[136:139], 0
    s_waitcnt lgkmcnt(8)
    v_mfma_f32_16x16x32_bf16 v[76:79], v[120:123], v[140:143], 0
    s_waitcnt lgkmcnt(6)
    v_mfma_f32_16x16x32_bf16 v[64:67], v[124:127], v[144:147], v[64:67]
    s_waitcnt lgkmcnt(4)
    v_mfma_f32_16x16x32_bf16 v[68:71], v[124:127], v[148:151], v[68:71]
    s_waitcnt lgkmcnt(2)
    v_mfma_f32_16x16x32_bf16 v[72:75], v[124:127], v[152:155], v[72:75]
    s_waitcnt lgkmcnt(0)
    v_mfma_f32_16x16x32_bf16 v[76:79], v[124:127], v[156:159], v[76:79]
    s_nop 3
    v_cndmask_b32 v64, v64, v68, s[60:61]
    s_nop 0
    v_cndmask_b32 v64, v64, v72, s[62:63]
    s_nop 0
    v_cndmask_b32 v64, v64, v76, s[72:73]
    v_and_or_b32 v226, v64, s74, v212
    buffer_store_dword v226, v13, s[12:15], s31 offen offset:0
    s_barrier
    s_bitcmp1_b32 s16, 0
    s_cselect_b32 s8, s52, s50
    s_cselect_b32 s9, s53, s51
    s_mov_b32 s10, 7340032
    s_lshr_b32 s42, s8, 7
    s_sub_u32 s42, 3, s42
    s_add_u32 s42, s42, s34
    s_and_b32 s42, s42, 7
    s_cmp_eq_u32 s42, 7
    s_cbranch_scc1 m_nh2
    s_mul_i32 s43, s34, 7
    s_add_u32 s42, s42, s43
    s_lshl_b32 s42, s42, 7
    s_lshl_b32 s43, s35, 1
    s_lshr_b32 s40, s16, 1
    s_add_u32 s43, s43, s40
    s_mul_i32 s43, s43, 265216
    s_add_u32 s42, s42, s43
    v_mul_u32_u24 v24, 7168, v2
    s_mov_b32 exec_lo, 4294967295
    s_mov_b32 exec_hi, 31
    buffer_load_dword v245, v24, s[8:11], s42 offen
    s_mov_b64 exec, -1
m_nh2:
    s_barrier
    ds_read_b64_tr_b16 v[64:65], v12 offset:0
    ds_read_b64_tr_b16 v[66:67], v12 offset:2048
    ds_read_b64_tr_b16 v[68:69], v12 offset:4096
    ds_read_b64_tr_b16 v[70:71], v12 offset:6144
    ds_read_b64_tr_b16 v[72:73], v12 offset:8192
    ds_read_b64_tr_b16 v[74:75], v12 offset:10240
    ds_read_b64_tr_b16 v[76:77], v12 offset:12288
    ds_read_b64_tr_b16 v[78:79], v12 offset:14336
    ds_read_b64_tr_b16 v[80:81], v12 offset:16384
    ds_read_b64_tr_b16 v[82:83], v12 offset:18432
    ds_read_b64_tr_b16 v[84:85], v12 offset:20480
    ds_read_b64_tr_b16 v[86:87], v12 offset:22528
    ds_read_b64_tr_b16 v[88:89], v12 offset:24576
    ds_read_b64_tr_b16 v[90:91], v12 offset:26624
    ds_read_b64_tr_b16 v[92:93], v12 offset:28672
    ds_read_b64_tr_b16 v[94:95], v12 offset:30720
    s_waitcnt vmcnt(0)
    s_barrier
    s_sub_u32 s42, s16, 1
    s_cmp_ge_u32 s42, 3
    s_cbranch_scc1 m_nb
    s_lshl_b32 s42, s42, 10
    s_add_u32 s42, s42, s29
    s_add_u32 s43, s42, 524288
    buffer_load_dwordx4 v[44:47], v3, s[12:15], s42 offen sc1
    s_waitcnt vmcnt(0)
    buffer_store_dwordx4 v[44:47], v3, s[12:15], s43 offen sc1
m_nb:
m_join:
    v_bfe_u32 v7, v0, 4, 2
    v_and_b32 v6, 3, v0
    v_mul_u32_u24 v17, 576, v6
    v_lshl_add_u32 v17, v16, 8, v17
    v_lshl_add_u32 v17, v7, 4, v17
    v_add_u32 v17, 131072, v17
    v_cmp_lt_u32 vcc, 1, v6
    v_mov_b32 v19, 0x44444444
    v_mov_b32 v22, 0xeeeeeeee
    v_cndmask_b32 v19, v19, v22, vcc
    v_and_b32 v6, 15, v0
    v_lshlrev_b32 v13, 5, v6
    v_bfe_u32 v22, v0, 4, 1
    v_lshl_add_u32 v13, v22, 4, v13
    v_bfe_u32 v22, v0, 5, 1
    v_lshl_add_u32 v13, v22, 3, v13
    v_mul_u32_u24 v22, 576, v1
    v_add_u32 v13, v13, v22
    v_add_u32 v13, 131072, v13
    s_lshl_b32 s70, s34, 1
    s_add_u32 s70, s70, s16
    s_lshl_b32 s70, s70, 13
    s_lshl_b32 s71, s65, 11
    s_add_u32 s70, s70, s71
    s_add_u32 s70, s70, 17301504
    s_mov_b32 s71, 0x07060302
    s_lshl_b32 s69, s64, 2
    s_and_b32 s42, s16, 3
    s_add_u32 s69, s69, s42
    s_lshl_b32 s69, s69, 10
    s_lshl_b32 s76, s65, 1
    s_lshr_b32 s42, s16, 2
    s_add_u32 s76, s76, s42
    s_lshl_b32 s76, s76, 8
    s_add_u32 s76, s76, s69
    s_add_u32 s77, s76, 18612224
    s_add_u32 s76, s76, 18350080
    s_add_u32 s69, s69, 18350080
    s_cmp_lg_u32 s16, 2
    s_cbranch_scc1 m_n0
    v_lshlrev_b32 v4, 7, v2
    s_sub_u32 s69, s69, 2048
    s_mov_b32 exec_hi, 0
    buffer_load_dword v5, v4, s[12:15], s69 offen sc1
    s_mov_b32 exec_hi, -1
m_n0:
    s_cmp_ge_u32 s16, 2
    s_cbranch_scc1 m_n1
    v_lshlrev_b32 v4, 7, v2
    s_mov_b64 exec, 0xffff
    buffer_load_dword v5, v4, s[12:15], s70 offen sc1
    s_mov_b64 exec, -1
m_n1:
    v_mov_b32 v216, s32
    v_mov_b32 v217, s33
    v_and_b32 v218, 1, v0
    v_cmp_eq_u32 vcc, 1, v218
    s_nop 1
    v_cndmask_b32 v216, v216, v217, vcc
    v_bfe_u32 v217, v216, 8, 8
    v_bfe_u32 v218, v216, 16, 8
    v_lshrrev_b32 v219, 24, v216
    v_and_b32 v216, 0xff, v216
    s_and_b32 s60, s32, 0xffff
    s_lshr_b32 s61, s32, 16
    s_and_b32 s62, s33, 0xffff
    s_lshr_b32 s63, s33, 16
    s_movk_i32 s74, 0xff00
    s_waitcnt vmcnt(0)
    s_barrier
    s_cmp_ge_u32 s16, 2
    s_cselect_b64 exec, 1, -1
    buffer_load_dwordx4 v[176:179], v3, s[12:15], s70 offen sc1
    buffer_load_dwordx4 v[180:183], v3, s[12:15], s70 offen offset:1024 sc1
    s_mov_b64 exec, -1
    ds_read_b64_tr_b16 v[96:97], v21 offset:0
    ds_read_b64_tr_b16 v[98:99], v21 offset:2048
    ds_read_b64_tr_b16 v[100:101], v21 offset:4096
    ds_read_b64_tr_b16 v[102:103], v21 offset:6144
    ds_read_b64_tr_b16 v[104:105], v21 offset:8192
    ds_read_b64_tr_b16 v[106:107], v21 offset:10240
    ds_read_b64_tr_b16 v[108:109], v21 offset:12288
    ds_read_b64_tr_b16 v[110:111], v21 offset:14336
    ds_read_b64_tr_b16 v[112:113], v21 offset:16384
    ds_read_b64_tr_b16 v[114:115], v21 offset:18432
    ds_read_b64_tr_b16 v[116:117], v21 offset:20480
    ds_read_b64_tr_b16 v[118:119], v21 offset:22528
    ds_read_b64_tr_b16 v[120:121], v21 offset:24576
    ds_read_b64_tr_b16 v[122:123], v21 offset:26624
    ds_read_b64_tr_b16 v[124:125], v21 offset:28672
    ds_read_b64_tr_b16 v[126:127], v21 offset:30720
    v_mov_b32 v160, 0
    v_mov_b32 v161, 0
    v_mov_b32 v162, 0
    v_mov_b32 v163, 0
    v_mov_b32 v164, 0
    v_mov_b32 v165, 0
    v_mov_b32 v166, 0
    v_mov_b32 v167, 0
    s_cbranch_scc1 m_nk
    s_mov_b32 s83, 0
    s_branch m_ph
m_pr:
    s_and_b32 s42, s83, 63
    s_cmp_eq_u32 s42, 63
    s_cselect_b32 s42, 131072, 0
    s_add_u32 s42, s42, s70
    buffer_load_dwordx4 v[176:179], v3, s[12:15], s42 offen sc1
    buffer_load_dwordx4 v[180:183], v3, s[12:15], s42 offen offset:1024 sc1
    s_add_u32 s83, s83, 1
    s_cmp_ge_u32 s83, 0x40000
    s_cbranch_scc1 m_phx
m_ph:
    s_waitcnt vmcnt(0)
    v_cmp_ne_u16 vcc, s63, v183
    s_cbranch_vccnz m_pr
    v_perm_b32 v184, v177, v176, s71
    v_perm_b32 v186, v179, v178, s71
    v_perm_b32 v185, v181, v180, s71
    v_perm_b32 v187, v183, v182, s71
    ds_write2_b64 v13, v[184:185], v[186:187] offset0:0 offset1:144
    v_xor_b32 v176, s60, v176
    v_xor_b32 v177, s61, v177
    v_xor_b32 v178, s62, v178
    v_xor_b32 v179, s63, v179
    v_xor_b32 v180, s60, v180
    v_xor_b32 v181, s61, v181
    v_xor_b32 v182, s62, v182
    v_xor_b32 v183, s63, v183
    v_or3_b32 v4, v176, v177, 0
    v_or3_b32 v4, v178, v179, v4
    v_or3_b32 v4, v180, v181, v4
    v_or3_b32 v4, v182, v183, v4
    v_cmp_ne_u16 vcc, 0, v4
    s_cbranch_vccnz m_pr
m_phx:
m_nk:
    s_waitcnt lgkmcnt(0)
    s_barrier
    ds_read_b128 v[128:131], v17 offset:0
    ds_read_b128 v[132:135], v17 offset:64
    ds_read_b128 v[136:139], v17 offset:128
    ds_read_b128 v[140:143], v17 offset:192
    s_waitcnt lgkmcnt(3)
    v_smfmac_f32_16x16x64_bf16 v[160:163], v[128:131], v[64:71], v19
    v_smfmac_f32_16x16x64_bf16 v[164:167], v[128:131], v[96:103], v19
    s_waitcnt lgkmcnt(2)
    v_smfmac_f32_16x16x64_bf16 v[160:163], v[132:135], v[72:79], v19
    v_smfmac_f32_16x16x64_bf16 v[164:167], v[132:135], v[104:111], v19
    s_waitcnt lgkmcnt(1)
    v_smfmac_f32_16x16x64_bf16 v[160:163], v[136:139], v[80:87], v19
    v_smfmac_f32_16x16x64_bf16 v[164:167], v[136:139], v[112:119], v19
    s_waitcnt lgkmcnt(0)
    v_smfmac_f32_16x16x64_bf16 v[160:163], v[140:143], v[88:95], v19
    v_smfmac_f32_16x16x64_bf16 v[164:167], v[140:143], v[120:127], v19
    s_nop 6
    v_pk_add_f32 v[160:161], v[160:161], v[162:163]
    v_pk_add_f32 v[164:165], v[164:165], v[166:167]
    v_and_or_b32 v184, v160, s74, v216
    v_and_or_b32 v185, v161, s74, v217
    v_and_or_b32 v186, v164, s74, v218
    v_and_or_b32 v187, v165, s74, v219
    s_mov_b64 exec, 0xffff
    buffer_store_dwordx4 v[184:187], v3, s[12:15], s76 offen
    buffer_store_dwordx4 v[184:187], v3, s[12:15], s77 offen sc1
    s_mov_b64 exec, -1
    s_cmp_eq_u32 s16, 0
    s_cbranch_scc1 r_start
g_end:
    s_endpgm
x_start:
    s_mov_b32 s83, 0
x_g0:
    s_and_b32 s42, s83, 63
    s_cmp_eq_u32 s42, 63
    s_cselect_b32 s42, 524288, 0
    s_add_u32 s42, s42, s81
    s_add_u32 s43, s42, 4096
    buffer_load_dwordx4 v[32:35], v3, s[12:15], s42 offen sc1
    buffer_load_dwordx4 v[36:39], v3, s[12:15], s43 offen sc1
    s_waitcnt vmcnt(0)
    v_xor_b32 v32, v216, v32
    v_xor_b32 v33, v217, v33
    v_xor_b32 v34, v218, v34
    v_xor_b32 v35, v219, v35
    v_xor_b32 v36, v216, v36
    v_xor_b32 v37, v217, v37
    v_xor_b32 v38, v218, v38
    v_xor_b32 v39, v219, v39
    v_or3_b32 v17, v32, v33, 0
    v_or3_b32 v17, v34, v35, v17
    v_or3_b32 v17, v36, v37, v17
    v_or3_b32 v17, v38, v39, v17
    v_and_b32 v17, 0xff, v17
    v_cmp_ne_u32 vcc, 0, v17
    s_cbranch_vccz x_g0x
    s_and_b32 s42, s83, 63
    s_cmp_lg_u32 s42, 48
    s_cbranch_scc1 x_g0n
    s_add_u32 s43, s39, 524288
    buffer_load_dwordx4 v[44:47], v3, s[12:15], s39 offen offset:0 sc1
    s_waitcnt vmcnt(0)
    buffer_store_dwordx4 v[44:47], v3, s[12:15], s43 offen offset:0 sc1
    s_waitcnt vmcnt(0)
    buffer_load_dwordx4 v[44:47], v3, s[12:15], s39 offen offset:1024 sc1
    s_waitcnt vmcnt(0)
    buffer_store_dwordx4 v[44:47], v3, s[12:15], s43 offen offset:1024 sc1
    s_waitcnt vmcnt(0)
x_g0n:
    s_add_u32 s83, s83, 1
    s_cmp_lt_u32 s83, 0x40000
    s_cbranch_scc1 x_g0
x_g0x:
    v_pk_add_f32 v[32:33], v[32:33], v[36:37]
    v_pk_add_f32 v[34:35], v[34:35], v[38:39]
    ds_write_b128 v222, v[32:35] offset:0
    s_waitcnt lgkmcnt(0)
    s_barrier
    s_cmp_lg_u32 s16, 0
    s_cbranch_scc1 x_g0e
    ds_read_b128 v[160:163], v221 offset:0
    ds_read_b128 v[164:167], v221 offset:1024
    ds_read_b128 v[168:171], v221 offset:2048
    ds_read_b128 v[172:175], v221 offset:3072
    ds_read_b128 v[176:179], v221 offset:4096
    ds_read_b128 v[180:183], v221 offset:5120
    ds_read_b128 v[184:187], v221 offset:6144
    ds_read_b128 v[188:191], v221 offset:7168
    s_waitcnt lgkmcnt(6)
    v_pk_add_f32 v[160:161], v[160:161], v[164:165]
    v_pk_add_f32 v[162:163], v[162:163], v[166:167]
    s_waitcnt lgkmcnt(4)
    v_pk_add_f32 v[168:169], v[168:169], v[172:173]
    v_pk_add_f32 v[170:171], v[170:171], v[174:175]
    s_waitcnt lgkmcnt(2)
    v_pk_add_f32 v[176:177], v[176:177], v[180:181]
    v_pk_add_f32 v[178:179], v[178:179], v[182:183]
    s_waitcnt lgkmcnt(0)
    v_pk_add_f32 v[184:185], v[184:185], v[188:189]
    v_pk_add_f32 v[186:187], v[186:187], v[190:191]
    v_pk_add_f32 v[160:161], v[160:161], v[168:169]
    v_pk_add_f32 v[176:177], v[176:177], v[184:185]
    v_pk_add_f32 v[162:163], v[162:163], v[170:171]
    v_pk_add_f32 v[178:179], v[178:179], v[186:187]
    v_pk_add_f32 v[160:161], v[160:161], v[176:177]
    v_pk_add_f32 v[162:163], v[162:163], v[178:179]
    v_cvt_pk_bf16_f32 v17, v160, v161
    v_lshlrev_b32 v160, 16, v17
    v_and_b32 v161, 0xffff0000, v17
    v_cvt_pk_bf16_f32 v18, v162, v163
    v_lshlrev_b32 v162, 16, v18
    v_and_b32 v163, 0xffff0000, v18
    v_add_f32 v160, s28, v160
    v_add_f32 v161, s28, v161
    v_add_f32 v162, s28, v162
    v_add_f32 v163, s28, v163
    v_cvt_pk_bf16_f32 v17, v160, v161
    v_lshlrev_b32 v160, 16, v17
    v_and_b32 v161, 0xffff0000, v17
    v_cvt_pk_bf16_f32 v18, v162, v163
    v_lshlrev_b32 v162, 16, v18
    v_and_b32 v163, 0xffff0000, v18
    v_mov_b32 v48, s32
    v_mov_b32 v49, s33
    s_cmp_ge_u32 s64, 8
    s_cbranch_scc1 x_q
    v_and_or_b32 v168, v160, s74, v216
    v_and_or_b32 v169, v161, s74, v217
    v_and_or_b32 v170, v162, s74, v218
    v_and_or_b32 v171, v163, s74, v219
    buffer_store_dwordx4 v[168:171], v220, s[12:15], s22 offen sc1
    v_max3_f32 v50, abs(v160), abs(v161), abs(v162)
    v_max_f32_e64 v50, v50, abs(v163)
    s_nop 1
    v_max_f32_dpp v50, v50, v50 row_ror:8 row_mask:0xf bank_mask:0xf
    s_nop 1
    v_max_f32_dpp v50, v50, v50 row_ror:4 row_mask:0xf bank_mask:0xf
    s_nop 1
    v_max_f32_dpp v50, v50, v50 row_ror:2 row_mask:0xf bank_mask:0xf
    s_nop 1
    v_max_f32_dpp v50, v50, v50 row_ror:1 row_mask:0xf bank_mask:0xf
    s_nop 1
    v_max_f32_dpp v50, v50, v50 row_bcast:15 row_mask:0xa bank_mask:0xf
    s_nop 1
    v_max_f32_dpp v50, v50, v50 row_bcast:31 row_mask:0xc bank_mask:0xf
    s_nop 0
    v_readlane_b32 s42, v50, 63
    s_nop 1
    v_mov_b32 v50, s42
    s_mov_b64 exec, 0xff
    buffer_store_dwordx4 v[48:51], v3, s[12:15], s79 offen sc1
    s_mov_b64 exec, -1
    s_branch x_g0e
x_q:
    s_cmp_lt_u32 s64, 12
    s_cbranch_scc1 x_nq
    v_lshlrev_b32 v164, 16, v52
    v_and_b32 v165, 0xffff0000, v52
    v_lshlrev_b32 v166, 16, v53
    v_and_b32 v167, 0xffff0000, v53
    v_pk_mul_f32 v[164:165], v[164:165], v[160:161]
    v_pk_mul_f32 v[166:167], v[166:167], v[162:163]
    ds_bpermute_b32 v180, v232, v164
    v_and_or_b32 v176, v164, s74, v216
    v_and_or_b32 v177, v165, s74, v217
    v_and_or_b32 v178, v166, s74, v218
    v_and_or_b32 v179, v167, s74, v219
    buffer_store_dwordx4 v[176:179], v220, s[12:15], s75 offen sc1
    v_and_or_b32 v181, v167, s74, v229
    v_and_or_b32 v182, v166, s74, v230
    v_and_or_b32 v183, v165, s74, v231
    s_waitcnt lgkmcnt(0)
    v_and_or_b32 v180, v180, s74, v228
    buffer_store_dwordx4 v[180:183], v234, s[12:15], s75 offen sc1
    v_and_b32 v164, s74, v164
    v_and_b32 v165, s74, v165
    v_and_b32 v166, s74, v166
    v_and_b32 v167, s74, v167
    v_pk_add_f32 v[164:165], v[164:165], v[166:167]
    v_add_f32 v50, v164, v165
    s_nop 1
    v_add_f32_dpp v50, v50, v50 row_ror:8 row_mask:0xf bank_mask:0xf
    s_nop 1
    v_add_f32_dpp v50, v50, v50 row_ror:4 row_mask:0xf bank_mask:0xf
    s_nop 1
    v_add_f32_dpp v50, v50, v50 row_ror:2 row_mask:0xf bank_mask:0xf
    s_nop 1
    v_add_f32_dpp v50, v50, v50 row_ror:1 row_mask:0xf bank_mask:0xf
    s_nop 1
    v_add_f32_dpp v50, v50, v50 row_bcast:15 row_mask:0xa bank_mask:0xf
    s_nop 1
    v_add_f32_dpp v50, v50, v50 row_bcast:31 row_mask:0xc bank_mask:0xf
    s_nop 0
    v_readlane_b32 s42, v50, 63
    s_nop 1
    v_mov_b32 v50, s42
    s_mov_b64 exec, 0xff
    buffer_store_dwordx4 v[48:51], v3, s[12:15], s79 offen sc1
    s_mov_b64 exec, -1
x_nq:
    ds_bpermute_b32 v172, v232, v160
    v_and_or_b32 v168, v160, s74, v216
    v_and_or_b32 v169, v161, s74, v217
    v_and_or_b32 v170, v162, s74, v218
    v_and_or_b32 v171, v163, s74, v219
    buffer_store_dwordx4 v[168:171], v220, s[12:15], s22 offen sc1
    v_and_or_b32 v173, v163, s74, v229
    v_and_or_b32 v174, v162, s74, v230
    v_and_or_b32 v175, v161, s74, v231
    s_waitcnt lgkmcnt(0)
    v_and_or_b32 v172, v172, s74, v228
    buffer_store_dwordx4 v[172:175], v234, s[12:15], s22 offen sc1
x_g0e:
    s_barrier
    s_cmp_lt_u32 s16, 4
    s_cbranch_scc1 x_t1
    v_xor_b32 v4, 0, v14
    s_add_u32 s43, s68, 98304
    s_mov_b32 m0, s43
    s_add_u32 s42, s19, 0
    buffer_load_dwordx4 v4, s[8:11], s42 offen nt lds
    v_xor_b32 v4, 64, v14
    s_add_u32 s43, s68, 99328
    s_mov_b32 m0, s43
    s_add_u32 s42, s19, 24576
    buffer_load_dwordx4 v4, s[8:11], s42 offen nt lds
    v_xor_b32 v4, 0, v14
    s_add_u32 s43, s68, 100352
    s_mov_b32 m0, s43
    s_add_u32 s42, s19, 49152
    buffer_load_dwordx4 v4, s[8:11], s42 offen nt lds
    v_xor_b32 v4, 64, v14
    s_add_u32 s43, s68, 101376
    s_mov_b32 m0, s43
    s_add_u32 s42, s19, 73728
    buffer_load_dwordx4 v4, s[8:11], s42 offen nt lds
    v_xor_b32 v4, 128, v14
    s_add_u32 s43, s68, 102400
    s_mov_b32 m0, s43
    s_add_u32 s42, s19, 98304
    buffer_load_dwordx4 v4, s[8:11], s42 offen nt lds
    v_xor_b32 v4, 192, v14
    s_add_u32 s43, s68, 103424
    s_mov_b32 m0, s43
    s_add_u32 s42, s19, 122880
    buffer_load_dwordx4 v4, s[8:11], s42 offen nt lds
    v_xor_b32 v4, 128, v14
    s_add_u32 s43, s68, 104448
    s_mov_b32 m0, s43
    s_add_u32 s42, s19, 147456
    buffer_load_dwordx4 v4, s[8:11], s42 offen nt lds
    v_xor_b32 v4, 192, v14
    s_add_u32 s43, s68, 105472
    s_mov_b32 m0, s43
    s_add_u32 s42, s19, 172032
    buffer_load_dwordx4 v4, s[8:11], s42 offen nt lds
    s_waitcnt vmcnt(0)
    s_barrier
    s_branch x_t2
x_t1:
    s_barrier
    ds_read_b64_tr_b16 v[128:129], v208 offset:0
    ds_read_b64_tr_b16 v[130:131], v208 offset:2048
    ds_read_b64_tr_b16 v[132:133], v209 offset:0
    ds_read_b64_tr_b16 v[134:135], v209 offset:2048
    ds_read_b64_tr_b16 v[136:137], v210 offset:0
    ds_read_b64_tr_b16 v[138:139], v210 offset:2048
    ds_read_b64_tr_b16 v[140:141], v211 offset:0
    ds_read_b64_tr_b16 v[142:143], v211 offset:2048
    ds_read_b64_tr_b16 v[144:145], v208 offset:16384
    ds_read_b64_tr_b16 v[146:147], v208 offset:18432
    ds_read_b64_tr_b16 v[148:149], v209 offset:16384
    ds_read_b64_tr_b16 v[150:151], v209 offset:18432
    ds_read_b64_tr_b16 v[152:153], v210 offset:16384
    ds_read_b64_tr_b16 v[154:155], v210 offset:18432
    s_waitcnt lgkmcnt(12)
    v_mfma_f32_16x16x32_bf16 v[64:67], v[120:123], v[128:131], 0
    ds_read_b64_tr_b16 v[156:157], v211 offset:16384
    ds_read_b64_tr_b16 v[158:159], v211 offset:18432
    s_waitcnt lgkmcnt(12)
    v_mfma_f32_16x16x32_bf16 v[68:71], v[120:123], v[132:135], 0
    s_waitcnt lgkmcnt(10)
    v_mfma_f32_16x16x32_bf16 v[72:75], v[120:123], v[136:139], 0
    s_waitcnt lgkmcnt(8)
    v_mfma_f32_16x16x32_bf16 v[76:79], v[120:123], v[140:143], 0
    s_waitcnt lgkmcnt(6)
    v_mfma_f32_16x16x32_bf16 v[64:67], v[124:127], v[144:147], v[64:67]
    s_waitcnt lgkmcnt(4)
    v_mfma_f32_16x16x32_bf16 v[68:71], v[124:127], v[148:151], v[68:71]
    s_waitcnt lgkmcnt(2)
    v_mfma_f32_16x16x32_bf16 v[72:75], v[124:127], v[152:155], v[72:75]
    s_waitcnt lgkmcnt(0)
    v_mfma_f32_16x16x32_bf16 v[76:79], v[124:127], v[156:159], v[76:79]
    s_nop 3
    v_cndmask_b32 v64, v64, v68, s[60:61]
    s_nop 0
    v_cndmask_b32 v64, v64, v72, s[62:63]
    s_nop 0
    v_cndmask_b32 v64, v64, v76, s[72:73]
    v_and_or_b32 v226, v64, s74, v212
    buffer_store_dword v226, v13, s[12:15], s31 offen offset:0
x_t2:
    s_mov_b32 s83, 0
x_g1:
    s_and_b32 s42, s83, 63
    s_cmp_eq_u32 s42, 63
    s_cselect_b32 s42, 524288, 0
    s_add_u32 s42, s42, s80
    buffer_load_dwordx4 v[32:35], v223, s[12:15], s42 offen offset:2048 sc1
    s_waitcnt vmcnt(0)
    v_xor_b32 v32, v216, v32
    v_xor_b32 v33, v217, v33
    v_xor_b32 v34, v218, v34
    v_xor_b32 v35, v219, v35
    v_or3_b32 v17, v32, v33, 0
    v_or3_b32 v17, v34, v35, v17
    v_and_b32 v17, 0xff, v17
    v_cmp_ne_u32 vcc, 0, v17
    s_cbranch_vccz x_g1x
    s_and_b32 s42, s83, 63
    s_cmp_lg_u32 s42, 48
    s_cbranch_scc1 x_g1n
    s_add_u32 s43, s39, 524288
    buffer_load_dwordx4 v[44:47], v3, s[12:15], s39 offen offset:0 sc1
    s_waitcnt vmcnt(0)
    buffer_store_dwordx4 v[44:47], v3, s[12:15], s43 offen offset:0 sc1
    s_waitcnt vmcnt(0)
    buffer_load_dwordx4 v[44:47], v3, s[12:15], s39 offen offset:1024 sc1
    s_waitcnt vmcnt(0)
    buffer_store_dwordx4 v[44:47], v3, s[12:15], s43 offen offset:1024 sc1
    s_waitcnt vmcnt(0)
    buffer_load_dwordx4 v[44:47], v3, s[12:15], s39 offen offset:2048 sc1
    s_waitcnt vmcnt(0)
    buffer_store_dwordx4 v[44:47], v3, s[12:15], s43 offen offset:2048 sc1
    s_waitcnt vmcnt(0)
x_g1n:
    s_add_u32 s83, s83, 1
    s_cmp_lt_u32 s83, 0x40000
    s_cbranch_scc1 x_g1
x_g1x:
    ds_write_b128 v222, v[32:35] offset:8192
    s_waitcnt lgkmcnt(0)
    s_barrier
    s_cmp_lg_u32 s16, 0
    s_cbranch_scc1 x_g1e
    ds_read_b128 v[160:163], v221 offset:8192
    ds_read_b128 v[164:167], v221 offset:9216
    ds_read_b128 v[168:171], v221 offset:10240
    ds_read_b128 v[172:175], v221 offset:11264
    ds_read_b128 v[176:179], v221 offset:12288
    ds_read_b128 v[180:183], v221 offset:13312
    ds_read_b128 v[184:187], v221 offset:14336
    ds_read_b128 v[188:191], v221 offset:15360
    s_waitcnt lgkmcnt(6)
    v_pk_add_f32 v[160:161], v[160:161], v[164:165]
    v_pk_add_f32 v[162:163], v[162:163], v[166:167]
    s_waitcnt lgkmcnt(4)
    v_pk_add_f32 v[168:169], v[168:169], v[172:173]
    v_pk_add_f32 v[170:171], v[170:171], v[174:175]
    s_waitcnt lgkmcnt(2)
    v_pk_add_f32 v[176:177], v[176:177], v[180:181]
    v_pk_add_f32 v[178:179], v[178:179], v[182:183]
    s_waitcnt lgkmcnt(0)
    v_pk_add_f32 v[184:185], v[184:185], v[188:189]
    v_pk_add_f32 v[186:187], v[186:187], v[190:191]
    v_pk_add_f32 v[160:161], v[160:161], v[168:169]
    v_pk_add_f32 v[176:177], v[176:177], v[184:185]
    v_pk_add_f32 v[162:163], v[162:163], v[170:171]
    v_pk_add_f32 v[178:179], v[178:179], v[186:187]
    v_pk_add_f32 v[160:161], v[160:161], v[176:177]
    v_pk_add_f32 v[162:163], v[162:163], v[178:179]
    v_mov_b32 v164, v160
    v_mov_b32 v165, v161
    v_mov_b32 v166, v162
    v_mov_b32 v167, v163
    v_permlane32_swap_b32 v160, v164
    v_permlane32_swap_b32 v161, v165
    v_permlane32_swap_b32 v162, v166
    v_permlane32_swap_b32 v163, v167
    v_pk_add_f32 v[160:161], v[160:161], v[164:165]
    v_pk_add_f32 v[162:163], v[162:163], v[166:167]
    v_cvt_pk_bf16_f32 v17, v160, v161
    v_lshlrev_b32 v160, 16, v17
    v_and_b32 v161, 0xffff0000, v17
    v_cvt_pk_bf16_f32 v18, v162, v163
    v_lshlrev_b32 v162, 16, v18
    v_and_b32 v163, 0xffff0000, v18
    s_mov_b32 exec_hi, 0
    ds_bpermute_b32 v172, v232, v160
    v_and_or_b32 v168, v160, s74, v216
    v_and_or_b32 v169, v161, s74, v217
    v_and_or_b32 v170, v162, s74, v218
    v_and_or_b32 v171, v163, s74, v219
    buffer_store_dwordx4 v[168:171], v233, s[12:15], s23 offen sc1
    v_and_or_b32 v173, v163, s74, v229
    v_and_or_b32 v174, v162, s74, v230
    v_and_or_b32 v175, v161, s74, v231
    s_waitcnt lgkmcnt(0)
    v_and_or_b32 v172, v172, s74, v228
    buffer_store_dwordx4 v[172:175], v235, s[12:15], s23 offen sc1
    s_mov_b32 exec_hi, -1
x_g1e:
    s_sub_u32 s42, s16, 1
    s_cmp_ge_u32 s42, 3
    s_cbranch_scc1 x_nb
    s_lshl_b32 s42, s42, 10
    s_add_u32 s42, s42, s29
    s_add_u32 s43, s42, 524288
    buffer_load_dwordx4 v[44:47], v3, s[12:15], s42 offen sc1
    s_waitcnt vmcnt(0)
    buffer_store_dwordx4 v[44:47], v3, s[12:15], s43 offen sc1
x_nb:
    s_cmp_lg_u32 s16, 0
    s_cbranch_scc1 g_end
    s_lshl_b32 s78, s34, 14
    s_add_u32 s78, s78, 17039360
    s_lshl_b32 s79, s34, 11
    s_add_u32 s79, s79, s78
    s_add_u32 s79, s79, 1800
    v_mov_b32 v22, 0
    s_mov_b32 s56, s48
    s_mov_b32 s57, s49
    s_mov_b32 s58, 2048
    s_mov_b32 s59, 0x00020000
    s_and_b32 s60, s32, 0xffff
    s_lshr_b32 s61, s32, 16
    s_and_b32 s62, s33, 0xffff
    s_lshr_b32 s63, s33, 16
    s_bfe_u32 s44, s32, 524288
    s_bfe_u32 s45, s32, 524296
    s_bfe_u32 s46, s32, 524304
    s_bfe_u32 s47, s32, 524312
    s_bfe_u32 s48, s33, 524288
    s_bfe_u32 s49, s33, 524296
    s_bfe_u32 s50, s33, 524304
    s_bfe_u32 s51, s33, 524312
    v_and_b32 v9, 15, v0
    v_lshlrev_b32 v9, 6, v9
    v_bfe_u32 v19, v0, 4, 1
    v_lshl_add_u32 v9, v19, 5, v9
    v_lshlrev_b32 v18, 9, v19
    v_bfe_u32 v19, v0, 5, 1
    v_lshl_add_u32 v9, v19, 4, v9
    v_lshl_add_u32 v18, v19, 11, v18
    v_bfe_u32 v19, v0, 2, 2
    v_lshl_add_u32 v18, v19, 7, v18
    v_lshl_add_u32 v18, v15, 4, v18
    s_mov_b32 s43, 16908288
    s_lshl_b32 s70, s64, 13
    s_add_u32 s70, s70, 17301504
    s_add_u32 s71, s70, 131072
    s_add_u32 s72, s70, 4096
    s_add_u32 s73, s71, 4096
    v_mov_b32 v21, 0xffff0000
    buffer_load_dwordx4 v[92:95], v9, s[56:59], 0 offen offset:0
    buffer_load_dwordx4 v[96:99], v9, s[56:59], 0 offen offset:1024
    s_mov_b32 s76, s43
    s_sub_u32 s42, s43, 8192
    s_mov_b32 s83, 0
x_cb:
    buffer_load_dwordx4 v[116:119], v18, s[12:15], s42 offen offset:0 sc1
    buffer_load_dwordx4 v[120:123], v18, s[12:15], s42 offen offset:1024 sc1
    buffer_load_dwordx4 v[124:127], v18, s[12:15], s42 offen offset:64 sc1
    buffer_load_dwordx4 v[128:131], v18, s[12:15], s42 offen offset:1088 sc1
    s_mov_b64 exec, 1
    buffer_load_dwordx2 v[28:29], v22, s[12:15], s79 offen sc1
    s_mov_b64 exec, -1
    s_waitcnt vmcnt(0)
    v_xor_b32 v116, v216, v116
    v_xor_b32 v117, v217, v117
    v_xor_b32 v118, v218, v118
    v_xor_b32 v119, v219, v119
    v_xor_b32 v120, v216, v120
    v_xor_b32 v121, v217, v121
    v_xor_b32 v122, v218, v122
    v_xor_b32 v123, v219, v123
    v_xor_b32 v124, v216, v124
    v_xor_b32 v125, v217, v125
    v_xor_b32 v126, v218, v126
    v_xor_b32 v127, v219, v127
    v_xor_b32 v128, v216, v128
    v_xor_b32 v129, v217, v129
    v_xor_b32 v130, v218, v130
    v_xor_b32 v131, v219, v131
    v_or3_b32 v19, v116, v117, 0
    v_or3_b32 v19, v118, v119, v19
    v_or3_b32 v19, v120, v121, v19
    v_or3_b32 v19, v122, v123, v19
    v_or3_b32 v19, v124, v125, v19
    v_or3_b32 v19, v126, v127, v19
    v_or3_b32 v19, v128, v129, v19
    v_or3_b32 v19, v130, v131, v19
    v_and_b32 v19, 0xff, v19
    v_cmp_ne_u32 vcc, 0, v19
    s_cbranch_vccz x_cbx
    s_sleep 8
    s_add_u32 s83, s83, 1
    s_cmp_lt_u32 s83, 0x40000
    s_cbranch_scc1 x_cb
x_cbx:
    v_lshlrev_b32 v48, 16, v92
    v_and_b32 v49, 0xffff0000, v92
    v_lshlrev_b32 v50, 16, v93
    v_and_b32 v51, 0xffff0000, v93
    v_lshlrev_b32 v52, 16, v94
    v_and_b32 v53, 0xffff0000, v94
    v_lshlrev_b32 v54, 16, v95
    v_and_b32 v55, 0xffff0000, v95
    v_lshlrev_b32 v56, 16, v96
    v_and_b32 v57, 0xffff0000, v96
    v_lshlrev_b32 v58, 16, v97
    v_and_b32 v59, 0xffff0000, v97
    v_lshlrev_b32 v60, 16, v98
    v_and_b32 v61, 0xffff0000, v98
    v_lshlrev_b32 v62, 16, v99
    v_and_b32 v63, 0xffff0000, v99
    s_mov_b64 exec, 1
    v_cmp_ne_u64 vcc, s[32:33], v[28:29]
    s_cbranch_vccz x_goy
    s_mov_b32 s83, 0
    s_mov_b64 exec, 1
x_go:
    buffer_load_dwordx2 v[28:29], v22, s[12:15], s79 offen sc1
    s_waitcnt vmcnt(0)
    v_cmp_ne_u64 vcc, s[32:33], v[28:29]
    s_cbranch_vccz x_goy
    s_sleep 1
    s_add_u32 s83, s83, 1
    s_cmp_lt_u32 s83, 0x40000
    s_cbranch_scc1 x_go
x_goy:
    s_mov_b64 exec, -1
x_gox:
    s_lshl_b32 s42, s65, 13
    s_add_u32 s78, s78, s42
    buffer_load_dwordx4 v[100:103], v18, s[12:15], s76 offen offset:0 sc1
    buffer_load_dwordx4 v[104:107], v18, s[12:15], s76 offen offset:1024 sc1
    buffer_load_dwordx4 v[108:111], v18, s[12:15], s76 offen offset:64 sc1
    buffer_load_dwordx4 v[112:115], v18, s[12:15], s76 offen offset:1088 sc1
    v_lshlrev_b32 v32, 7, v2
    s_xor_b32 s77, s78, 8192
    buffer_load_dwordx4 v[24:27], v32, s[12:15], s78 offen sc1
    buffer_load_dwordx4 v[28:31], v32, s[12:15], s77 offen sc1
    s_mov_b32 s83, 0
    s_waitcnt vmcnt(2)
x_sb:
    v_xor_b32 v100, v216, v100
    v_xor_b32 v101, v217, v101
    v_xor_b32 v102, v218, v102
    v_xor_b32 v103, v219, v103
    v_xor_b32 v104, v216, v104
    v_xor_b32 v105, v217, v105
    v_xor_b32 v106, v218, v106
    v_xor_b32 v107, v219, v107
    v_xor_b32 v108, v216, v108
    v_xor_b32 v109, v217, v109
    v_xor_b32 v110, v218, v110
    v_xor_b32 v111, v219, v111
    v_xor_b32 v112, v216, v112
    v_xor_b32 v113, v217, v113
    v_xor_b32 v114, v218, v114
    v_xor_b32 v115, v219, v115
    v_or3_b32 v19, v100, v101, 0
    v_or3_b32 v19, v102, v103, v19
    v_or3_b32 v19, v104, v105, v19
    v_or3_b32 v19, v106, v107, v19
    v_or3_b32 v19, v108, v109, v19
    v_or3_b32 v19, v110, v111, v19
    v_or3_b32 v19, v112, v113, v19
    v_or3_b32 v19, v114, v115, v19
    v_and_b32 v19, 0xff, v19
    v_cmp_ne_u32 vcc, 0, v19
    s_cbranch_vccnz x_sr
x_sbx:
    s_mov_b32 s41, 0
    s_mov_b32 s83, 0
    s_waitcnt vmcnt(0)
    v_cmp_ne_u64 s[52:53], s[32:33], v[26:27]
    v_cmp_ne_u64 s[54:55], s[32:33], v[30:31]
    s_or_b64 s[20:21], s[52:53], s[54:55]
    s_cbranch_scc0 x_all
x_pk:
    s_mov_b64 exec, s[52:53]
    s_cbranch_execz x_p2a
    buffer_load_dwordx4 v[24:27], v32, s[12:15], s78 offen sc1
x_p2a:
    s_mov_b64 exec, s[54:55]
    s_cbranch_execz x_p2b
    buffer_load_dwordx4 v[28:31], v32, s[12:15], s77 offen sc1
x_p2b:
    s_mov_b64 exec, -1
x_pc:
    s_waitcnt vmcnt(0)
    v_cmp_ne_u64 s[52:53], s[32:33], v[26:27]
    v_cmp_ne_u64 s[54:55], s[32:33], v[30:31]
    v_cmp_lt_u32 s[4:5], s41, v24
    v_cmp_lt_u32 s[6:7], s41, v25
    v_cmp_lt_u32 s[8:9], s41, v28
    v_cmp_lt_u32 s[10:11], s41, v29
    s_or_b64 s[20:21], s[52:53], s[54:55]
    s_cbranch_scc0 x_pkx
    s_add_u32 s83, s83, 1
    s_cmp_lt_u32 s83, 0x40000
    s_cbranch_scc1 x_pk
x_pkx:
    s_bcnt1_i32_b64 s4, s[4:5]
    s_bcnt1_i32_b64 s6, s[6:7]
    s_bcnt1_i32_b64 s8, s[8:9]
    s_bcnt1_i32_b64 s10, s[10:11]
    s_add_u32 s4, s4, s6
    s_add_u32 s8, s8, s10
    s_add_u32 s4, s4, s8
    s_cmp_lg_u32 s4, s65
    s_cbranch_scc1 x_all
    buffer_store_dwordx4 v[64:67], v3, s[12:15], s70 offen offset:0
    buffer_store_dwordx4 v[68:71], v3, s[12:15], s70 offen offset:1024
    buffer_store_dwordx4 v[72:75], v3, s[12:15], s70 offen offset:2048
    buffer_store_dwordx4 v[76:79], v3, s[12:15], s70 offen offset:3072
    s_branch x_phx
x_all:
    v_max_u32 v33, v24, v28
    v_min_u32 v34, v24, v28
    v_mov_b32 v35, v33
    v_max3_u32 v34, v34, v25, v29
    s_nop 0
    v_max_u32_dpp v35, v35, v35 row_ror:8 row_mask:0xf bank_mask:0xf
    s_nop 1
    v_max_u32_dpp v35, v35, v35 row_ror:4 row_mask:0xf bank_mask:0xf
    s_nop 1
    v_max_u32_dpp v35, v35, v35 row_ror:2 row_mask:0xf bank_mask:0xf
    s_nop 1
    v_max_u32_dpp v35, v35, v35 row_ror:1 row_mask:0xf bank_mask:0xf
    s_nop 1
    v_max_u32_dpp v35, v35, v35 row_bcast:15 row_mask:0xa bank_mask:0xf
    s_nop 1
    v_max_u32_dpp v35, v35, v35 row_bcast:31 row_mask:0xc bank_mask:0xf
    s_nop 0
    v_readlane_b32 s40, v35, 63
    s_cmp_eq_u32 s65, 0
    s_cbranch_scc1 x_b2
    v_cmp_eq_u32 vcc, s40, v33
    s_nop 1
    v_cndmask_b32 v35, v33, v34, vcc
    s_nop 1
    v_max_u32_dpp v35, v35, v35 row_ror:8 row_mask:0xf bank_mask:0xf
    s_nop 1
    v_max_u32_dpp v35, v35, v35 row_ror:4 row_mask:0xf bank_mask:0xf
    s_nop 1
    v_max_u32_dpp v35, v35, v35 row_ror:2 row_mask:0xf bank_mask:0xf
    s_nop 1
    v_max_u32_dpp v35, v35, v35 row_ror:1 row_mask:0xf bank_mask:0xf
    s_nop 1
    v_max_u32_dpp v35, v35, v35 row_bcast:15 row_mask:0xa bank_mask:0xf
    s_nop 1
    v_max_u32_dpp v35, v35, v35 row_bcast:31 row_mask:0xc bank_mask:0xf
    s_nop 0
    v_readlane_b32 s40, v35, 63
x_b2:
    s_bfe_u32 s42, s40, 0x70005
    s_bitcmp1_b32 s40, 0
    s_addc_u32 s42, s42, s42
    s_lshl_b32 s43, s42, 7
    s_lshl_b32 s42, s42, 12
    s_add_u32 s42, s42, 18874368
    s_add_u32 s43, s43, 17170432
    s_mov_b32 s83, 0
x_ph:
    s_mov_b64 exec, 1
    buffer_load_dwordx4 v[132:135], v22, s[12:15], s43 offen sc1
    s_mov_b64 exec, -1
    buffer_load_dwordx4 v[64:67], v3, s[12:15], s42 offen offset:0 sc1
    buffer_load_dwordx4 v[68:71], v3, s[12:15], s42 offen offset:1024 sc1
    buffer_load_dwordx4 v[72:75], v3, s[12:15], s42 offen offset:2048 sc1
    buffer_load_dwordx4 v[76:79], v3, s[12:15], s42 offen offset:3072 sc1
    s_waitcnt vmcnt(4)
    v_readfirstlane_b32 s22, v132
    v_readfirstlane_b32 s23, v133
    v_readfirstlane_b32 s20, v134
    v_readfirstlane_b32 s21, v135
    s_xor_b64 s[22:23], s[22:23], s[32:33]
    s_cbranch_scc1 x_pr
    s_waitcnt vmcnt(3)
    v_xor_b32 v64, s44, v64
    v_xor_b32 v65, s45, v65
    v_xor_b32 v66, s46, v66
    v_xor_b32 v67, s47, v67
    v_or3_b32 v19, v64, v65, v66
    v_or_b32 v19, v19, v67
    v_pk_fma_f32 v[64:65], v[64:65], s[20:21], s[20:21] op_sel:[0,1,0] op_sel_hi:[1,1,0]
    v_pk_fma_f32 v[66:67], v[66:67], s[20:21], s[20:21] op_sel:[0,1,0] op_sel_hi:[1,1,0]
    v_cmp_ne_u16_sdwa vcc, v19, v22 src0_sel:BYTE_0 src1_sel:DWORD
    v_pk_fma_f32 v[64:65], v[64:65], v[116:117], v[100:101]
    v_pk_fma_f32 v[66:67], v[66:67], v[118:119], v[102:103]
    v_cvt_pk_bf16_f32 v136, v64, v65
    v_cvt_pk_bf16_f32 v137, v66, v67
    s_cbranch_vccnz x_pr
    v_lshl_or_b32 v64, v136, 16, s60
    v_and_or_b32 v65, v136, v21, s61
    v_lshl_or_b32 v66, v137, 16, s62
    v_and_or_b32 v67, v137, v21, s63
    buffer_store_dwordx4 v[64:67], v3, s[12:15], s70 offen offset:0
    s_waitcnt vmcnt(3)
    v_xor_b32 v68, s48, v68
    v_xor_b32 v69, s49, v69
    v_xor_b32 v70, s50, v70
    v_xor_b32 v71, s51, v71
    v_or3_b32 v19, v68, v69, v70
    v_or_b32 v19, v19, v71
    v_pk_fma_f32 v[68:69], v[68:69], s[20:21], s[20:21] op_sel:[0,1,0] op_sel_hi:[1,1,0]
    v_pk_fma_f32 v[70:71], v[70:71], s[20:21], s[20:21] op_sel:[0,1,0] op_sel_hi:[1,1,0]
    v_cmp_ne_u16_sdwa vcc, v19, v22 src0_sel:BYTE_0 src1_sel:DWORD
    v_pk_fma_f32 v[68:69], v[68:69], v[120:121], v[104:105]
    v_pk_fma_f32 v[70:71], v[70:71], v[122:123], v[106:107]
    v_cvt_pk_bf16_f32 v138, v68, v69
    v_cvt_pk_bf16_f32 v139, v70, v71
    s_cbranch_vccnz x_pr
    v_lshl_or_b32 v68, v138, 16, s60
    v_and_or_b32 v69, v138, v21, s61
    v_lshl_or_b32 v70, v139, 16, s62
    v_and_or_b32 v71, v139, v21, s63
    buffer_store_dwordx4 v[68:71], v3, s[12:15], s70 offen offset:1024
    s_waitcnt vmcnt(3)
    v_xor_b32 v72, s44, v72
    v_xor_b32 v73, s45, v73
    v_xor_b32 v74, s46, v74
    v_xor_b32 v75, s47, v75
    v_or3_b32 v19, v72, v73, v74
    v_or_b32 v19, v19, v75
    v_pk_fma_f32 v[72:73], v[72:73], s[20:21], s[20:21] op_sel:[0,1,0] op_sel_hi:[1,1,0]
    v_pk_fma_f32 v[74:75], v[74:75], s[20:21], s[20:21] op_sel:[0,1,0] op_sel_hi:[1,1,0]
    v_cmp_ne_u16_sdwa vcc, v19, v22 src0_sel:BYTE_0 src1_sel:DWORD
    v_pk_fma_f32 v[72:73], v[72:73], v[124:125], v[108:109]
    v_pk_fma_f32 v[74:75], v[74:75], v[126:127], v[110:111]
    v_cvt_pk_bf16_f32 v140, v72, v73
    v_cvt_pk_bf16_f32 v141, v74, v75
    s_cbranch_vccnz x_pr
    v_lshl_or_b32 v72, v140, 16, s60
    v_and_or_b32 v73, v140, v21, s61
    v_lshl_or_b32 v74, v141, 16, s62
    v_and_or_b32 v75, v141, v21, s63
    buffer_store_dwordx4 v[72:75], v3, s[12:15], s70 offen offset:2048
    s_waitcnt vmcnt(3)
    v_xor_b32 v76, s48, v76
    v_xor_b32 v77, s49, v77
    v_xor_b32 v78, s50, v78
    v_xor_b32 v79, s51, v79
    v_or3_b32 v19, v76, v77, v78
    v_or_b32 v19, v19, v79
    v_pk_fma_f32 v[76:77], v[76:77], s[20:21], s[20:21] op_sel:[0,1,0] op_sel_hi:[1,1,0]
    v_pk_fma_f32 v[78:79], v[78:79], s[20:21], s[20:21] op_sel:[0,1,0] op_sel_hi:[1,1,0]
    v_cmp_ne_u16_sdwa vcc, v19, v22 src0_sel:BYTE_0 src1_sel:DWORD
    v_pk_fma_f32 v[76:77], v[76:77], v[128:129], v[112:113]
    v_pk_fma_f32 v[78:79], v[78:79], v[130:131], v[114:115]
    v_cvt_pk_bf16_f32 v142, v76, v77
    v_cvt_pk_bf16_f32 v143, v78, v79
    s_cbranch_vccnz x_pr
    v_lshl_or_b32 v76, v142, 16, s60
    v_and_or_b32 v77, v142, v21, s61
    v_lshl_or_b32 v78, v143, 16, s62
    v_and_or_b32 v79, v143, v21, s63
    buffer_store_dwordx4 v[76:79], v3, s[12:15], s70 offen offset:3072
x_phx:
    v_mov_b32 v46, s40
    buffer_store_dwordx4 v[64:67], v3, s[12:15], s71 offen offset:0 sc1
    buffer_store_dwordx4 v[68:71], v3, s[12:15], s71 offen offset:1024 sc1
    buffer_store_dwordx4 v[72:75], v3, s[12:15], s71 offen offset:2048 sc1
    buffer_store_dwordx4 v[76:79], v3, s[12:15], s71 offen offset:3072 sc1
    v_lshlrev_b32 v100, 16, v136
    v_and_b32 v101, 0xffff0000, v136
    v_lshlrev_b32 v102, 16, v137
    v_and_b32 v103, 0xffff0000, v137
    v_lshlrev_b32 v104, 16, v138
    v_and_b32 v105, 0xffff0000, v138
    v_lshlrev_b32 v106, 16, v139
    v_and_b32 v107, 0xffff0000, v139
    v_lshlrev_b32 v108, 16, v140
    v_and_b32 v109, 0xffff0000, v140
    v_lshlrev_b32 v110, 16, v141
    v_and_b32 v111, 0xffff0000, v141
    v_lshlrev_b32 v112, 16, v142
    v_and_b32 v113, 0xffff0000, v142
    v_lshlrev_b32 v114, 16, v143
    v_and_b32 v115, 0xffff0000, v143
    v_pk_mul_f32 v[8:9], v[48:49], v[100:101]
    v_pk_fma_f32 v[8:9], v[50:51], v[102:103], v[8:9]
    v_pk_fma_f32 v[8:9], v[52:53], v[104:105], v[8:9]
    v_pk_fma_f32 v[8:9], v[54:55], v[106:107], v[8:9]
    v_pk_fma_f32 v[8:9], v[56:57], v[108:109], v[8:9]
    v_pk_fma_f32 v[8:9], v[58:59], v[110:111], v[8:9]
    v_pk_fma_f32 v[8:9], v[60:61], v[112:113], v[8:9]
    v_pk_fma_f32 v[8:9], v[62:63], v[114:115], v[8:9]
    v_add_f32 v8, v8, v9
    s_nop 1
    v_add_f32_dpp v8, v8, v8 row_ror:8 row_mask:0xf bank_mask:0xf
    s_nop 1
    v_add_f32_dpp v8, v8, v8 row_ror:4 row_mask:0xf bank_mask:0xf
    s_nop 1
    v_add_f32_dpp v8, v8, v8 row_ror:2 row_mask:0xf bank_mask:0xf
    s_nop 1
    v_add_f32_dpp v8, v8, v8 row_ror:1 row_mask:0xf bank_mask:0xf
    s_nop 1
    v_add_f32_dpp v8, v8, v8 row_bcast:15 row_mask:0xa bank_mask:0xf
    s_nop 1
    v_add_f32_dpp v8, v8, v8 row_bcast:31 row_mask:0xc bank_mask:0xf
    v_cvt_pk_bf16_f32 v8, v8, v8
    v_lshlrev_b32 v8, 16, v8
    v_mul_f32 v8, 0xbfb8aa3b, v8
    v_exp_f32 v8, v8
    s_nop 0
    v_add_f32 v8, 1.0, v8
    v_rcp_f32 v8, v8
    s_nop 0
    v_cvt_pk_bf16_f32 v8, v8, v8
    v_lshlrev_b32 v8, 16, v8
    s_nop 0
    v_readlane_b32 s46, v8, 63
    v_mov_b32 v44, s32
    v_mov_b32 v45, s33
    v_mov_b32 v47, s46
    s_mov_b64 exec, 0xff
    buffer_store_dwordx4 v[44:47], v3, s[12:15], s73 offen sc1
    s_mov_b64 exec, -1
    s_sleep 16
r_start:
    s_lshl_b32 s62, s34, 1
    s_lshr_b32 s42, s34, 2
    s_add_u32 s62, s62, s42
    s_lshl_b32 s62, s62, 13
    s_add_u32 s62, s62, 17432576
    s_add_u32 s61, s62, 4096
    s_and_b32 s18, s34, 3
    s_lshl_b32 s18, s18, 4
    s_add_u32 s18, s18, s35
    v_mov_b32 v11, 0
    v_and_b32 v4, 3, v0
    v_lshrrev_b32 v7, 4, v2
    v_lshlrev_b32 v5, 3, v4
    v_lshl_add_u32 v5, v7, 1, v5
    v_lshlrev_b32 v6, 10, v4
    v_lshl_add_u32 v6, v7, 2, v6
    v_lshrrev_b32 v86, 1, v4
    v_lshlrev_b32 v86, 9, v86
    v_and_b32 v87, 1, v4
    v_lshl_add_u32 v85, v87, 10, v86
    v_lshl_add_u32 v85, v7, 2, v85
    s_and_b32 s30, s18, 1
    s_bfe_u32 s31, s18, 0x20001
    s_bfe_u32 s40, s18, 0x20003
    s_lshr_b32 s41, s18, 5
    s_lshl_b32 s45, s41, 11
    s_lshl_b32 s42, s30, 8
    s_add_u32 s45, s45, s42
    s_lshl_b32 s42, s40, 6
    s_add_u32 s45, s45, s42
    s_lshl_b32 s31, s31, 4
    s_add_u32 s45, s45, s31
    s_add_u32 s62, s62, s45
    s_lshl_b32 s30, s30, 9
    s_add_u32 s31, s31, s30
    s_lshl_b32 s40, s40, 7
    s_add_u32 s31, s31, s40
    s_lshl_b32 s41, s41, 6
    s_add_u32 s31, s31, s41
    s_add_u32 s31, s31, 16916480
    s_mov_b32 s83, 0
r_ld:
    s_mov_b64 exec, 1
    buffer_load_dwordx4 v[32:35], v11, s[12:15], s61 offen sc1
    s_mov_b64 exec, -1
    buffer_load_dword v41, v85, s[12:15], s62 offen sc1
    buffer_load_dword v91, v6, s[12:15], s31 offen sc1
    s_bitcmp1_b32 s18, 1
    s_cselect_b32 s42, s33, s32
    v_lshlrev_b32 v88, 3, v7
    v_lshrrev_b32_e64 v88, v88, s42
    v_and_b32 v88, 0xff, v88
    v_lshlrev_b32 v89, 4, v7
    v_lshrrev_b64 v[82:83], v89, s[32:33]
    v_and_b32 v82, 0xffff, v82
    s_waitcnt vmcnt(0)
    v_readfirstlane_b32 s50, v32
    v_readfirstlane_b32 s51, v33
    v_readfirstlane_b32 s40, v34
    v_readfirstlane_b32 s46, v35
    v_xor_b32 v91, v88, v91
    v_xor_b32 v41, v82, v41
    v_or_b32 v19, v91, v41
    v_cmp_ne_u16 vcc, 0, v19
    s_xor_b64 s[50:51], s[50:51], s[32:33]
    s_or_b64 vcc, vcc, s[50:51]
    s_cbranch_vccz r_ldx
    s_sleep 2
    s_add_u32 s83, s83, 1
    s_cmp_lt_u32 s83, 0x40000
    s_cbranch_scc1 r_ld
r_ldx:
    v_mul_f32 v80, s46, v91
    s_bfe_u32 s46, s40, 0x70005
    s_bfe_u32 s47, s40, 0x30002
    s_bfe_u32 s60, s40, 0x10001
    s_bfe_u32 s63, s40, 0x70005
    s_lshl_b32 s63, s63, 13
    s_and_b32 s40, s40, 1
    s_lshl_b32 s40, s40, 12
    s_add_u32 s63, s63, s40
    s_add_u32 s63, s63, s45
    s_add_u32 s63, s63, 18874368
    buffer_load_dword v44, v85, s[12:15], s63 offen sc1
    v_lshrrev_b32 v10, 2, v2
    v_lshlrev_b32 v10, 7, v10
    v_lshl_add_u32 v10, v4, 4, v10
    s_lshl_b32 s44, s18, 13
    s_and_b32 s42, s34, 4
    s_lshl_b32 s42, s42, 4
    s_add_u32 s44, s44, s42
    s_add_u32 s44, s44, 17825792
    s_add_u32 s45, s44, 4096
    s_lshr_b32 s61, s46, 4
    s_and_b32 s41, s46, 15
    s_lshl_b32 s41, s41, 4
    s_add_u32 s41, s41, s61
    s_lshr_b32 s61, s46, 3
    s_cmp_eq_u32 s61, 1
    s_cselect_b32 s61, 8, 0
    s_add_u32 s41, s41, s61
    s_lshl_b32 s61, s47, 8
    s_add_u32 s41, s41, s61
    s_cmp_ge_u32 s47, 4
    s_cselect_b32 s61, 896, 0
    s_cmp_eq_u32 s46, 0
    s_cselect_b32 s61, s61, 0
    s_sub_u32 s41, s41, s61
    s_sub_u32 s61, 2048, s41
    s_cmp_eq_u32 s41, 0
    s_cselect_b32 s61, 1024, s61
    s_cmp_eq_u32 s60, 1
    s_cselect_b32 s41, s61, s41
    s_lshl_b32 s41, s41, 11
    s_lshl_b32 s61, s18, 5
    s_add_u32 s41, s41, s61
    s_waitcnt vmcnt(0)
    v_and_b32 v44, 0xffffff00, v44
    v_fmac_f32 v44, v91, v41
    v_mov_b32 v28, v216
    v_mov_b32 v29, v217
    v_mov_b32 v30, v218
    v_mov_b32 v31, v219
    s_sleep 24
    s_mov_b32 s83, 0
    s_mov_b64 s[64:65], -1
    s_mov_b64 s[66:67], -1
    s_mov_b64 s[68:69], -1
    s_mov_b32 s70, -1
    s_mov_b32 s71, 0
r_p:
    s_mov_b64 exec, s[64:65]
    s_cbranch_execz r_q0
    buffer_load_dwordx4 v[16:19], v10, s[12:15], s44 offen offset:0 sc1
r_q0:
    s_mov_b64 exec, s[66:67]
    s_cbranch_execz r_q1
    buffer_load_dwordx4 v[20:23], v10, s[12:15], s44 offen offset:2048 sc1
r_q1:
    s_mov_b64 exec, s[68:69]
    s_cbranch_execz r_q2
    buffer_load_dwordx4 v[24:27], v10, s[12:15], s45 offen offset:0 sc1
r_q2:
    s_mov_b64 exec, s[70:71]
    s_cbranch_execz r_q3
    buffer_load_dwordx4 v[28:31], v10, s[12:15], s45 offen offset:2048 sc1
r_q3:
    s_mov_b64 exec, -1
    s_waitcnt vmcnt(0)
    v_xor_b32 v48, v216, v16
    v_xor_b32 v49, v217, v17
    v_xor_b32 v50, v218, v18
    v_xor_b32 v51, v219, v19
    v_xor_b32 v52, v216, v20
    v_xor_b32 v53, v217, v21
    v_xor_b32 v54, v218, v22
    v_xor_b32 v55, v219, v23
    v_xor_b32 v56, v216, v24
    v_xor_b32 v57, v217, v25
    v_xor_b32 v58, v218, v26
    v_xor_b32 v59, v219, v27
    v_xor_b32 v60, v216, v28
    v_xor_b32 v61, v217, v29
    v_xor_b32 v62, v218, v30
    v_xor_b32 v63, v219, v31
    v_or3_b32 v12, v48, v49, v50
    v_or3_b32 v13, v52, v53, v54
    v_or3_b32 v14, v56, v57, v58
    v_or3_b32 v15, v60, v61, v62
    v_or_b32 v12, v12, v51
    v_or_b32 v13, v13, v55
    v_or_b32 v14, v14, v59
    v_or_b32 v15, v15, v63
    v_pk_add_f32 v[48:49], v[48:49], v[52:53]
    v_pk_add_f32 v[56:57], v[56:57], v[60:61]
    v_pk_add_f32 v[50:51], v[50:51], v[54:55]
    v_pk_add_f32 v[58:59], v[58:59], v[62:63]
    v_cmp_ne_u16_sdwa s[64:65], v12, v11 src0_sel:BYTE_0 src1_sel:DWORD
    v_cmp_ne_u16_sdwa s[66:67], v13, v11 src0_sel:BYTE_0 src1_sel:DWORD
    v_cmp_ne_u16_sdwa s[68:69], v14, v11 src0_sel:BYTE_0 src1_sel:DWORD
    v_cmp_ne_u16_sdwa s[70:71], v15, v11 src0_sel:BYTE_0 src1_sel:DWORD
    v_pk_add_f32 v[48:49], v[48:49], v[56:57]
    v_pk_add_f32 v[50:51], v[50:51], v[58:59]
    s_or_b64 s[50:51], s[64:65], s[66:67]
    s_or_b64 s[52:53], s[68:69], s[70:71]
    s_or_b64 s[50:51], s[50:51], s[52:53]
    s_cbranch_scc1 r_r
r_x:
    v_permlane32_swap_b32 v48, v50
    v_permlane32_swap_b32 v49, v51
    v_pk_add_f32 v[48:49], v[48:49], v[50:51]
    s_nop 1
    v_permlane16_swap_b32 v48, v49
    v_add_f32 v48, v48, v49
    s_nop 1
    v_add_f32_dpp v48, v48, v48 row_ror:4 row_mask:0xf bank_mask:0xf
    s_nop 1
    v_add_f32_dpp v48, v48, v48 row_ror:8 row_mask:0xf bank_mask:0xf
    v_fmac_f32 v44, v48, v80
    s_mov_b32 exec_lo, 0x000f000f
    s_mov_b32 exec_hi, 0x000f000f
    v_cvt_pk_bf16_f32 v44, v44, v44
    buffer_store_short v44, v5, s[24:27], s41 offen
    s_endpgm
x_pr:
    s_waitcnt vmcnt(0)
    s_add_u32 s83, s83, 1
    s_cmp_lt_u32 s83, 0x40000
    s_cbranch_scc1 x_ph
    s_branch x_phx
x_sr:
    buffer_load_dwordx4 v[100:103], v18, s[12:15], s76 offen offset:0 sc1
    buffer_load_dwordx4 v[104:107], v18, s[12:15], s76 offen offset:1024 sc1
    buffer_load_dwordx4 v[108:111], v18, s[12:15], s76 offen offset:64 sc1
    buffer_load_dwordx4 v[112:115], v18, s[12:15], s76 offen offset:1088 sc1
    s_waitcnt vmcnt(0)
    s_sleep 2
    s_add_u32 s83, s83, 1
    s_cmp_lt_u32 s83, 0x40000
    s_cbranch_scc1 x_sb
    s_branch x_sbx
r_r:
    s_add_u32 s83, s83, 1
    s_cmp_lt_u32 s83, 0x40000
    s_cbranch_scc1 r_p
    s_branch r_x
f_start:
    s_lshl_b32 s62, s34, 11
    s_lshl_b32 s63, s35, 7
    s_add_u32 s62, s62, s63
    s_add_u32 s63, s62, 16809984
    s_lshl_b32 s42, s16, 4
    s_add_u32 s62, s62, s42
    s_add_u32 s62, s62, 16777216
    v_mov_b32 v116, 0
    s_getpc_b64 s[36:37]
h_pc:
    s_mov_b32 s14, 268435456
    s_mov_b32 s15, s11
    s_mov_b64 exec, 1
    buffer_load_dword v215, v116, s[12:15], s62 offen sc1
    s_mov_b64 exec, -1
    s_mov_b32 s20, s26
    s_mov_b32 s21, s27
    s_mov_b32 s26, 4194304
    s_mov_b32 s27, 0x00020000
    s_mov_b32 s22, s50
    s_mov_b32 s23, s51
    s_mov_b32 s28, s54
    s_mov_b32 s29, s55
    s_add_u32 s58, s36, tables-h_pc
    s_addc_u32 s59, s37, 0
    s_lshr_b32 s36, s35, 1
    s_and_b32 s36, s36, 4
    s_xor_b32 s36, s36, s16
    s_and_b32 s37, s34, 4
    s_xor_b32 s37, s37, s16
    s_lshl_b32 s3, s34, 4
    s_add_u32 s3, s3, s35
    v_and_b32 v4, 15, v0
    v_bfe_u32 v5, v0, 4, 2
    v_lshrrev_b32 v248, 3, v2
    v_lshlrev_b32 v248, 18, v248
    v_lshlrev_b32 v249, 1, v5
    v_xor_b32 v249, v249, v0
    v_and_b32 v249, 7, v249
    v_lshl_add_u32 v255, v249, 4, v248
    v_lshlrev_b32 v6, 16, v5
    v_lshl_add_u32 v6, v4, 4, v6
    s_lshl_b32 s60, s16, 15
    s_lshl_b32 s61, s34, 11
    s_add_u32 s60, s60, s61
    s_lshl_b32 s61, s35, 7
    s_add_u32 s60, s60, s61
    s_lshl_b32 s61, s16, 12
    s_add_u32 s61, s61, 61440
    s_lshl_b32 s64, s36, 19
    s_lshl_b32 s65, s35, 3
    s_and_b32 s66, s34, 1
    s_lshl_b32 s66, s66, 2
    s_add_u32 s65, s65, s66
    s_lshr_b32 s66, s34, 1
    s_add_u32 s65, s65, s66
    s_lshl_b32 s65, s65, 8
    s_add_u32 s64, s64, s65
    s_add_u32 s64, s64, 1048576
    s_add_u32 s65, s64, 32768
    s_add_u32 s66, s64, 262144
    s_add_u32 s67, s64, 294912
    s_barrier
    s_cmp_eq_u32 s36, 0
    s_cselect_b32 s42, 2048, 0
    v_add_u32 v248, s42, v3
    global_load_dwordx4 v[236:239], v248, s[58:59]
    global_load_dwordx4 v[240:243], v248, s[58:59] offset:1024
    s_lshr_b32 s42, s3, 4
    s_and_b32 s30, s3, 15
    s_lshl_b32 s30, s30, 4
    s_add_u32 s30, s30, s42
    s_lshr_b32 s42, s3, 3
    s_cmp_eq_u32 s42, 1
    s_cselect_b32 s42, 8, 0
    s_add_u32 s30, s30, s42
    s_lshl_b32 s42, s16, 8
    s_add_u32 s30, s30, s42
    s_cmp_ge_u32 s16, 4
    s_cselect_b32 s42, 896, 0
    s_cmp_eq_u32 s3, 0
    s_cselect_b32 s42, s42, 0
    s_sub_u32 s30, s30, s42
    s_sub_u32 s31, 2048, s30
    s_cmp_eq_u32 s30, 0
    s_cselect_b32 s31, 1024, s31
    s_lshl_b32 s18, s30, 11
    s_lshl_b32 s19, s31, 11
    s_sub_u32 s75, s19, 2048
    s_lshl_b32 s68, s16, 12
    s_add_u32 s68, s68, 126976
    v_bfe_u32 v248, v0, 2, 1
    v_bfe_u32 v249, v0, 3, 2
    v_lshlrev_b32 v249, 2, v249
    v_lshl_add_u32 v248, v248, 4, v249
    v_and_or_b32 v248, v0, 3, v248
    v_bfe_u32 v249, v0, 5, 3
    v_cvt_f32_u32 v248, v248
    v_cvt_f32_u32 v249, v249
    s_cmp_lt_u32 s16, 4
    s_mov_b32 s42, 0x3d000000
    s_cselect_b32 s42, s42, 0x3a800000
    v_mul_f32 v248, s42, v248
    v_mul_f32 v249, 4.0, v249
    v_mul_f32 v152, v248, v249
    v_add_f32 v153, v152, v248
    v_add_f32 v154, v153, v248
    v_add_f32 v155, v154, v248
    v_sin_f32 v156, v152
    v_sin_f32 v157, v153
    v_sin_f32 v158, v154
    v_sin_f32 v159, v155
    v_cos_f32 v152, v152
    v_cos_f32 v153, v153
    v_cos_f32 v154, v154
    v_cos_f32 v155, v155
    s_cbranch_scc0 f_tw
    v_cvt_pk_f16_f32 v160, v152, v156
    v_cvt_pk_f16_f32 v156, -v156, v152
    v_mov_b32 v152, v160
    v_cvt_pk_f16_f32 v160, v153, v157
    v_cvt_pk_f16_f32 v157, -v157, v153
    v_mov_b32 v153, v160
    v_cvt_pk_f16_f32 v160, v154, v158
    v_cvt_pk_f16_f32 v158, -v158, v154
    v_mov_b32 v154, v160
    v_cvt_pk_f16_f32 v160, v155, v159
    v_cvt_pk_f16_f32 v159, -v159, v155
    v_mov_b32 v155, v160
f_tw:
    s_and_b32 s42, s16, 4
    s_add_u32 s42, s42, s16
    s_lshl_b32 s42, s42, 10
    v_add_u32 v248, s42, v3
    ds_write_b128 v248, v[152:155] offset:0
    ds_write_b128 v248, v[156:159] offset:4096
    v_lshrrev_b32 v248, 1, v4
    v_and_b32 v249, 1, v0
    v_cmp_eq_u32 vcc, 1, v4
    s_nop 1
    v_cndmask_b32_e64 v250, v248, 0, vcc
    v_cndmask_b32_e64 v248, v248, 8, vcc
    v_cndmask_b32_e64 v249, v249, 0, vcc
    v_mad_u32_u24 v251, v248, v5, v249
    v_lshlrev_b32 v251, 5, v251
    v_mad_u32_u24 v251, v250, v1, v251
    v_cvt_f32_u32 v248, v248
    v_cvt_f32_u32 v250, v250
    v_cvt_f32_u32 v251, v251
    v_mul_f32 v248, 0x3d800000, v248
    v_mul_f32 v250, 0x3b800000, v250
    v_mul_f32 v216, 0x3c000000, v251
    v_add_f32 v217, v216, v248
    v_add_f32 v218, v217, v248
    v_add_f32 v219, v218, v248
    v_add_f32 v220, v216, v250
    v_add_f32 v221, v217, v250
    v_add_f32 v222, v218, v250
    v_add_f32 v223, v219, v250
    v_cos_f32 v216, v216
    v_cos_f32 v217, v217
    v_cos_f32 v218, v218
    v_cos_f32 v219, v219
    v_cos_f32 v220, v220
    v_cos_f32 v221, v221
    v_cos_f32 v222, v222
    v_cos_f32 v223, v223
    v_lshrrev_b32 v248, 2, v2
    v_lshlrev_b32 v8, 7, v248
    v_bfe_u32 v248, v0, 3, 2
    v_lshl_add_u32 v8, v248, 5, v8
    v_and_b32 v248, 3, v0
    v_lshl_add_u32 v8, v248, 3, v8
    v_lshl_add_u32 v8, v1, 12, v8
    v_xor_b32 v9, 32, v8
    v_xor_b32 v10, 64, v8
    v_xor_b32 v11, 96, v8
    v_lshlrev_b32 v12, 13, v5
    v_lshl_add_u32 v12, v4, 4, v12
    v_lshlrev_b32 v7, 5, v5
    v_and_b32 v248, 1, v0
    v_lshl_add_u32 v7, v248, 10, v7
    v_and_b32 v248, 2, v0
    v_lshl_add_u32 v7, v248, 3, v7
    s_lshl_b32 s70, s34, 11
    s_lshl_b32 s71, s16, 7
    s_add_u32 s71, s71, s70
    s_add_u32 s71, s71, 16777216
    s_lshl_b32 s42, s16, 7
    s_add_u32 s42, s42, 94208
    v_lshlrev_b32 v213, 3, v4
    v_lshl_add_u32 v212, v5, 13, v213
    v_add_u32 v212, s42, v212
    s_lshl_b32 s42, s36, 12
    s_add_u32 s42, s42, 94208
    v_lshl_add_u32 v213, v5, 8, v213
    v_and_b32 v214, 16, v0
    v_lshl_add_u32 v213, v214, 3, v213
    v_add_u32 v213, s42, v213
    v_xor_b32 v214, 128, v213
    s_mov_b32 s4, 0x3f803f80
    s_mov_b32 s5, 0x3a800000
    s_waitcnt vmcnt(6)
    s_load_dwordx2 s[32:33], s[20:21], 0
    v_dot2_f32_bf16 v108, v64, s4, 0
    v_dot2_f32_bf16 v110, v64, v64, 0
    v_dot2_f32_bf16 v108, v65, s4, v108
    v_dot2_f32_bf16 v110, v65, v65, v110
    v_dot2_f32_bf16 v108, v66, s4, v108
    v_dot2_f32_bf16 v110, v66, v66, v110
    v_dot2_f32_bf16 v108, v67, s4, v108
    v_dot2_f32_bf16 v110, v67, v67, v110
    s_waitcnt vmcnt(5)
    v_dot2_f32_bf16 v109, v72, s4, 0
    v_dot2_f32_bf16 v111, v72, v72, 0
    v_dot2_f32_bf16 v109, v73, s4, v109
    v_dot2_f32_bf16 v111, v73, v73, v111
    v_dot2_f32_bf16 v109, v74, s4, v109
    v_dot2_f32_bf16 v111, v74, v74, v111
    v_dot2_f32_bf16 v109, v75, s4, v109
    v_dot2_f32_bf16 v111, v75, v75, v111
    s_waitcnt vmcnt(4)
    v_dot2_f32_bf16 v108, v68, s4, v108
    v_dot2_f32_bf16 v110, v68, v68, v110
    v_dot2_f32_bf16 v108, v69, s4, v108
    v_dot2_f32_bf16 v110, v69, v69, v110
    v_dot2_f32_bf16 v108, v70, s4, v108
    v_dot2_f32_bf16 v110, v70, v70, v110
    v_dot2_f32_bf16 v108, v71, s4, v108
    v_dot2_f32_bf16 v110, v71, v71, v110
    s_waitcnt vmcnt(3)
    v_dot2_f32_bf16 v109, v76, s4, v109
    v_dot2_f32_bf16 v111, v76, v76, v111
    v_dot2_f32_bf16 v109, v77, s4, v109
    v_dot2_f32_bf16 v111, v77, v77, v111
    v_dot2_f32_bf16 v109, v78, s4, v109
    v_dot2_f32_bf16 v111, v78, v78, v111
    v_dot2_f32_bf16 v109, v79, s4, v109
    v_dot2_f32_bf16 v111, v79, v79, v111
    s_nop 1
    v_permlane32_swap_b32 v108, v109
    v_permlane32_swap_b32 v110, v111
    v_add_f32 v108, v108, v109
    v_add_f32 v110, v110, v111
    s_nop 0
    v_add_f32_dpp v108, v108, v108 row_ror:8 row_mask:0xf bank_mask:0xf
    v_add_f32_dpp v110, v110, v110 row_ror:8 row_mask:0xf bank_mask:0xf
    s_nop 0
    v_add_f32_dpp v108, v108, v108 row_ror:4 row_mask:0xf bank_mask:0xf
    v_add_f32_dpp v110, v110, v110 row_ror:4 row_mask:0xf bank_mask:0xf
    s_nop 0
    v_add_f32_dpp v108, v108, v108 row_ror:2 row_mask:0xf bank_mask:0xf
    v_add_f32_dpp v110, v110, v110 row_ror:2 row_mask:0xf bank_mask:0xf
    s_nop 0
    v_add_f32_dpp v108, v108, v108 row_ror:1 row_mask:0xf bank_mask:0xf
    v_add_f32_dpp v110, v110, v110 row_ror:1 row_mask:0xf bank_mask:0xf
    s_nop 0
    v_add_f32_dpp v108, v108, v108 row_bcast:15 row_mask:0xa bank_mask:0xf
    v_add_f32_dpp v110, v110, v110 row_bcast:15 row_mask:0xa bank_mask:0xf
    v_mul_f32 v108, s5, v108
    v_mul_f32 v110, s5, v110
    v_mul_f32 v116, v108, v108
    v_cvt_pk_bf16_f32 v117, -v108, -v108
    v_sub_f32 v110, v110, v116
    v_mul_f32 v118, 0x44000000, v110
    v_cmp_gt_f32 vcc, v116, v118
    v_readlane_b32 s40, v117, 31
    s_or_b32 s41, vcc_lo, vcc_hi
    s_bitcmp1_b32 s41, 31
    s_cbranch_scc1 f_slowvar
f_var:
    v_cvt_pk_bf16_f32 v110, v110, v110
    v_lshlrev_b32 v110, 16, v110
    v_add_f32 v110, 0x3727c5ac, v110
    v_cvt_pk_bf16_f32 v110, v110, v110
    v_lshlrev_b32 v110, 16, v110
    v_sqrt_f32 v110, v110
    s_and_b32 s40, s40, 0xffff
    v_mov_b32 v114, 0xffff0000
    v_cvt_pk_bf16_f32 v110, v110, v110
    v_lshlrev_b32 v110, 16, v110
    v_mul_f32 v110, 0x41800000, v110
    v_and_or_b32 v114, v117, v114, s40
    v_rcp_f32 v113, v110
    s_waitcnt lgkmcnt(0)
    s_cmp_lg_u32 s32, 0
    s_cbranch_scc1 f_nnx
    s_load_dwordx2 s[32:33], s[20:21], 64
    s_mov_b32 s83, 0
    v_mov_b32 v122, 0
    s_waitcnt lgkmcnt(0)
f_nn:
    s_cmp_lg_u32 s32, 0
    s_cbranch_scc1 f_nnx
    global_load_dwordx2 v[120:121], v122, s[20:21] sc1
    s_waitcnt vmcnt(0)
    v_readfirstlane_b32 s32, v120
    v_readfirstlane_b32 s33, v121
    s_add_u32 s83, s83, 1
    s_cmp_lt_u32 s83, 0x40000
    s_cbranch_scc1 f_nn
f_nnx:
    v_mov_b32 v115, s32
    v_mov_b32_dpp v112, v113 row_bcast:31 row_mask:0xc bank_mask:0xf
    v_mov_b32 v116, 0
    s_mov_b32 exec_lo, 0
    s_mov_b32 exec_hi, 0x80000000
    buffer_store_dwordx4 v[112:115], v116, s[12:15], s62 offen
    v_lshlrev_b32 v117, 4, v1
    v_add_u32 v117, 160768, v117
    ds_write_b128 v117, v[112:115]
    s_mov_b64 exec, -1
    s_mov_b32 m0, s61
    s_add_u32 s42, s60, 0
    s_add_u32 s61, s61, 1024
    buffer_load_dwordx4 v255, s[8:11], s42 offen lds
    s_mov_b32 m0, s61
    s_add_u32 s42, s60, 2097152
    s_add_u32 s61, s61, 1024
    buffer_load_dwordx4 v255, s[8:11], s42 offen lds
    s_mov_b32 m0, s61
    s_add_u32 s42, s60, 16384
    s_add_u32 s61, s61, 1024
    buffer_load_dwordx4 v255, s[8:11], s42 offen lds
    s_mov_b32 m0, s61
    s_add_u32 s42, s60, 2113536
    s_add_u32 s61, s61, 1024
    buffer_load_dwordx4 v255, s[8:11], s42 offen lds
    v_add_u32 v248, s68, v3
    s_cmp_lt_u32 s3, 16
    s_cbranch_scc1 f_r0
f_ra:
    ds_write_b128 v248, v[64:67] offset:0
    ds_write_b128 v248, v[68:71] offset:1024
f_nr:
    v_mov_b32 v244, s32
    v_mov_b32 v245, s33
    v_and_b32 v248, 4, v0
    v_cmp_eq_u32 vcc, 4, v248
    v_and_b32 v248, 3, v0
    v_lshlrev_b32 v248, 2, v248
    v_cndmask_b32 v244, v244, v245, vcc
    v_lshrrev_b32 v244, v248, v244
    s_mov_b32 s54, 0x00010001
    s_mov_b32 s55, 0xfffefffe
    s_mov_b32 s46, 0x05040100
    s_mov_b32 s47, 0x07060302
    v_lshrrev_b32 v245, 1, v244
    v_lshrrev_b32 v246, 2, v244
    v_lshrrev_b32 v247, 3, v244
    v_and_b32 v244, s54, v244
    v_and_b32 v245, s54, v245
    v_and_b32 v246, s54, v246
    v_and_b32 v247, s54, v247
    s_waitcnt vmcnt(2)
    s_mov_b32 exec_lo, 0x000f000f
    s_mov_b32 exec_hi, 0x000f000f
    buffer_load_dwordx4 v[24:27], v7, s[12:15], s71 offen sc1
    s_mov_b64 exec, -1
    s_mov_b32 s83, 0
    s_waitcnt vmcnt(1)
    ds_read_b64_tr_b16 v[40:41], v8 offset:61440
    ds_read_b64_tr_b16 v[42:43], v9 offset:61440
    ds_read_b64_tr_b16 v[44:45], v10 offset:61440
    ds_read_b64_tr_b16 v[46:47], v11 offset:61440
    ds_read_b64_tr_b16 v[48:49], v8 offset:63488
    ds_read_b64_tr_b16 v[50:51], v9 offset:63488
    ds_read_b64_tr_b16 v[52:53], v10 offset:63488
    ds_read_b64_tr_b16 v[54:55], v11 offset:63488
    s_mov_b32 exec_lo, 0x000f000f
    s_mov_b32 exec_hi, 0x000f000f
    s_branch f_st
f_str:
    s_add_u32 s83, s83, 1
    s_and_b32 s42, s83, 31
    s_cbranch_scc0 f_sb1
    s_mov_b32 exec_lo, 0x000f000f
    s_mov_b32 exec_hi, 0x000f000f
    buffer_load_dwordx4 v[24:27], v7, s[12:15], s71 offen sc1
f_st:
    s_waitcnt vmcnt(0)
    v_cmp_ne_u32 vcc, s32, v27
    s_mov_b64 exec, -1
    s_cbranch_vccnz f_str
f_stx:
    s_setprio 3
    v_mov_b32_dpp v32, v26 row_newbcast:0 row_mask:0xf bank_mask:0xf
    v_mov_b32_dpp v33, v26 row_newbcast:1 row_mask:0xf bank_mask:0xf
    v_mov_b32_dpp v34, v26 row_newbcast:2 row_mask:0xf bank_mask:0xf
    v_mov_b32_dpp v35, v26 row_newbcast:3 row_mask:0xf bank_mask:0xf
    v_mul_f32_dpp v216, v24, v216 row_newbcast:0 row_mask:0xf bank_mask:0xf
    v_mul_f32_dpp v217, v24, v217 row_newbcast:1 row_mask:0xf bank_mask:0xf
    v_mul_f32_dpp v218, v24, v218 row_newbcast:2 row_mask:0xf bank_mask:0xf
    v_mul_f32_dpp v219, v24, v219 row_newbcast:3 row_mask:0xf bank_mask:0xf
    v_perm_b32 v28, v33, v32, s46
    v_perm_b32 v29, v35, v34, s46
    v_cvt_pk_bf16_f32 v224, v216, v217
    v_cvt_pk_bf16_f32 v225, v218, v219
    s_nop 1
    v_mfma_f32_16x16x16_bf16 v[228:231], v[224:225], v[28:29], 0
    v_mul_f32_dpp v220, v25, v220 row_newbcast:0 row_mask:0xf bank_mask:0xf
    v_mul_f32_dpp v221, v25, v221 row_newbcast:1 row_mask:0xf bank_mask:0xf
    v_mul_f32_dpp v222, v25, v222 row_newbcast:2 row_mask:0xf bank_mask:0xf
    v_mul_f32_dpp v223, v25, v223 row_newbcast:3 row_mask:0xf bank_mask:0xf
    v_perm_b32 v30, v33, v32, s47
    v_perm_b32 v31, v35, v34, s47
    v_cvt_pk_bf16_f32 v226, v220, v221
    v_cvt_pk_bf16_f32 v227, v222, v223
    s_nop 1
    v_mfma_f32_16x16x16_bf16 v[232:235], v[226:227], v[30:31], 0
    s_waitcnt lgkmcnt(0)
    v_mfma_f32_16x16x16_bf16 v[56:59], v[224:225], v[40:41], v[228:231]
    v_mfma_f32_16x16x16_bf16 v[60:63], v[226:227], v[48:49], v[232:235]
    v_mfma_f32_16x16x16_bf16 v[64:67], v[224:225], v[42:43], v[228:231]
    v_mfma_f32_16x16x16_bf16 v[68:71], v[226:227], v[50:51], v[232:235]
    s_mov_b32 m0, s68
    s_nop 0
    buffer_load_dwordx4 v3, s[8:11], s75 offen offset:2048 lds
    buffer_load_dwordx4 v3, s[8:11], s75 offen offset:3072 lds
    v_mfma_f32_16x16x16_bf16 v[72:75], v[224:225], v[44:45], v[228:231]
    v_mfma_f32_16x16x16_bf16 v[76:79], v[226:227], v[52:53], v[232:235]
    v_cvt_pk_f16_f32 v184, v56, v57
    v_cvt_pk_f16_f32 v185, v60, v61
    ds_write_b64 v212, v[184:185] offset:0
    v_cvt_pk_f16_f32 v186, v58, v59
    v_cvt_pk_f16_f32 v187, v62, v63
    ds_write_b64 v212, v[186:187] offset:4096
    v_mfma_f32_16x16x16_bf16 v[80:83], v[224:225], v[46:47], v[228:231]
    v_mfma_f32_16x16x16_bf16 v[84:87], v[226:227], v[54:55], v[232:235]
    v_cvt_pk_f16_f32 v188, v64, v65
    v_cvt_pk_f16_f32 v189, v68, v69
    ds_write_b64 v212, v[188:189] offset:1024
    v_cvt_pk_f16_f32 v190, v66, v67
    v_cvt_pk_f16_f32 v191, v70, v71
    ds_write_b64 v212, v[190:191] offset:5120
    v_cvt_pk_f16_f32 v192, v72, v73
    v_cvt_pk_f16_f32 v193, v76, v77
    ds_write_b64 v212, v[192:193] offset:2048
    v_cvt_pk_f16_f32 v194, v74, v75
    v_cvt_pk_f16_f32 v195, v78, v79
    ds_write_b64 v212, v[194:195] offset:6144
    v_cvt_pk_f16_f32 v196, v80, v81
    v_cvt_pk_f16_f32 v197, v84, v85
    ds_write_b64 v212, v[196:197] offset:3072
    v_cvt_pk_f16_f32 v198, v82, v83
    v_cvt_pk_f16_f32 v199, v86, v87
    ds_write_b64 v212, v[198:199] offset:7168
    s_waitcnt lgkmcnt(0)
    s_barrier
    ds_read_b64 v[152:153], v213 offset:0
    ds_read_b64 v[154:155], v214 offset:0
    ds_read_b64 v[156:157], v213 offset:1024
    ds_read_b64 v[158:159], v214 offset:1024
    ds_read_b64 v[160:161], v213 offset:2048
    ds_read_b64 v[162:163], v214 offset:2048
    ds_read_b64 v[164:165], v213 offset:3072
    ds_read_b64 v[166:167], v214 offset:3072
    s_waitcnt lgkmcnt(6)
    v_mfma_f32_16x16x32_f16 v[56:59], v[236:239], v[152:155], 0
    s_waitcnt lgkmcnt(4)
    v_mfma_f32_16x16x32_f16 v[60:63], v[236:239], v[156:159], 0
    s_waitcnt lgkmcnt(2)
    v_mfma_f32_16x16x32_f16 v[64:67], v[236:239], v[160:163], 0
    s_waitcnt lgkmcnt(0)
    v_mfma_f32_16x16x32_f16 v[68:71], v[236:239], v[164:167], 0
    v_mfma_f32_16x16x32_f16 v[72:75], v[240:243], v[152:155], 0
    v_mfma_f32_16x16x32_f16 v[76:79], v[240:243], v[156:159], 0
    v_mfma_f32_16x16x32_f16 v[80:83], v[240:243], v[160:163], 0
    v_mfma_f32_16x16x32_f16 v[84:87], v[240:243], v[164:167], 0
    v_cvt_pk_f16_f32 v184, v56, v57
    v_cvt_pk_f16_f32 v185, v60, v61
    v_cvt_pk_f16_f32 v186, v64, v65
    s_nop 0
    v_cvt_pk_f16_f32 v187, v68, v69
    v_and_or_b32 v184, v184, s55, v244
    v_and_or_b32 v185, v185, s55, v245
    v_and_or_b32 v186, v186, s55, v246
    v_and_or_b32 v187, v187, s55, v247
    buffer_store_dwordx4 v[184:187], v6, s[12:15], s64 offen sc1
    v_cvt_pk_f16_f32 v188, v58, v59
    v_cvt_pk_f16_f32 v189, v62, v63
    v_cvt_pk_f16_f32 v190, v66, v67
    v_cvt_pk_f16_f32 v191, v70, v71
    v_and_or_b32 v188, v188, s55, v244
    v_and_or_b32 v189, v189, s55, v245
    v_and_or_b32 v190, v190, s55, v246
    v_and_or_b32 v191, v191, s55, v247
    buffer_store_dwordx4 v[188:191], v6, s[12:15], s65 offen sc1
    v_cvt_pk_f16_f32 v192, v72, v73
    v_cvt_pk_f16_f32 v193, v76, v77
    v_cvt_pk_f16_f32 v194, v80, v81
    v_cvt_pk_f16_f32 v195, v84, v85
    v_and_or_b32 v192, v192, s55, v244
    v_and_or_b32 v193, v193, s55, v245
    v_and_or_b32 v194, v194, s55, v246
    v_and_or_b32 v195, v195, s55, v247
    buffer_store_dwordx4 v[192:195], v6, s[12:15], s66 offen sc1
    v_cvt_pk_f16_f32 v196, v74, v75
    v_cvt_pk_f16_f32 v197, v78, v79
    v_cvt_pk_f16_f32 v198, v82, v83
    v_cvt_pk_f16_f32 v199, v86, v87
    v_and_or_b32 v196, v196, s55, v244
    v_and_or_b32 v197, v197, s55, v245
    v_and_or_b32 v198, v198, s55, v246
    v_and_or_b32 v199, v199, s55, v247
    buffer_store_dwordx4 v[196:199], v6, s[12:15], s67 offen sc1
    s_setprio 0
    s_mov_b32 s43, 0
    s_lshr_b32 s42, s3, 4
    s_and_b32 s40, s3, 15
    s_lshl_b32 s40, s40, 4
    s_add_u32 s40, s40, s42
    s_lshr_b32 s42, s3, 3
    s_cmp_eq_u32 s42, 1
    s_cselect_b32 s42, 8, 0
    s_add_u32 s40, s40, s42
    s_lshl_b32 s42, s43, 8
    s_add_u32 s40, s40, s42
    s_cmp_ge_u32 s43, 4
    s_cselect_b32 s42, 896, 0
    s_cmp_eq_u32 s3, 0
    s_cselect_b32 s42, s42, 0
    s_sub_u32 s40, s40, s42
    v_lshrrev_b32 v248, 1, v4
    v_and_b32 v249, 1, v0
    v_lshlrev_b32 v250, 8, v248
    v_add_u32 v250, s40, v250
    s_cmp_lg_u32 s3, 0
    s_cbranch_scc1 f_a3n
    v_cmp_lt_u32 s[44:45], 3, v248
    v_subrev_u32 v251, 896, v250
    s_nop 0
    v_cndmask_b32 v250, v250, v251, s[44:45]
    v_cmp_eq_u32 vcc, 1, v4
    v_mov_b32 v251, 1024
    s_nop 0
    v_cndmask_b32 v250, v250, v251, vcc
    v_cndmask_b32_e64 v249, v249, 0, vcc
f_a3n:
    v_lshlrev_b32 v251, 1, v5
    v_mul_u32_u24 v251, v251, v250
    v_lshl_add_u32 v251, v249, 9, v251
    v_add_u32 v253, v251, v250
    v_add_u32 v252, 1536, v251
    v_add_u32 v254, 1536, v253
    v_and_b32 v251, 2047, v251
    v_and_b32 v252, 2047, v252
    v_and_b32 v253, 2047, v253
    v_and_b32 v254, 2047, v254
    v_cvt_f32_u32 v251, v251
    v_cvt_f32_u32 v252, v252
    v_cvt_f32_u32 v253, v253
    v_cvt_f32_u32 v254, v254
    v_mul_f32 v251, 0x3a000000, v251
    v_mul_f32 v252, 0x3a000000, v252
    v_mul_f32 v253, 0x3a000000, v253
    v_mul_f32 v254, 0x3a000000, v254
    v_cos_f32 v251, v251
    v_cos_f32 v252, v252
    v_cos_f32 v253, v253
    v_cos_f32 v254, v254
    s_cbranch_scc1 f_a3m
    v_cmp_gt_u32 vcc, 2, v4
    s_nop 1
    v_cndmask_b32_e64 v249, 1.0, 0.5, vcc
    v_mul_f32 v251, v251, v249
    v_mul_f32 v253, v253, v249
    v_cndmask_b32 v252, 0, v251, s[44:45]
    v_cndmask_b32 v254, 0, v253, s[44:45]
    v_cndmask_b32 v251, v251, 0, s[44:45]
    v_cndmask_b32 v253, v253, 0, s[44:45]
f_a3m:
    v_cvt_pk_f16_f32 v22, v251, v252
    v_cvt_pk_f16_f32 v23, v253, v254
    v_and_b32 v248, 3, v0
    v_bfe_u32 v249, v0, 2, 1
    v_bfe_u32 v250, v0, 3, 2
    v_bfe_u32 v251, v0, 5, 1
    v_lshlrev_b32 v13, 10, v249
    v_lshlrev_b32 v15, 11, v249
    v_lshl_add_u32 v15, v251, 8, v15
    v_lshl_add_u32 v15, v250, 6, v15
    v_lshl_add_u32 v15, v248, 4, v15
    v_lshl_add_u32 v13, v250, 8, v13
    v_lshl_add_u32 v13, v248, 6, v13
    v_lshl_add_u32 v13, v251, 5, v13
    v_xor_b32 v14, 2016, v13
    v_add_u32 v13, s68, v13
    v_add_u32 v14, s68, v14
    s_waitcnt vmcnt(4)
    ds_read_b128 v[200:203], v13 offset:0
    ds_read_b128 v[204:207], v13 offset:16
    ds_read_b128 v[208:211], v14 offset:2048
    ds_read_b128 v[212:215], v14 offset:2064
    s_lshl_b32 s72, s3, 15
    s_lshl_b32 s73, s37, 12
    s_add_u32 s72, s72, s73
    s_add_u32 s72, s72, 1048576
    s_waitcnt lgkmcnt(0)
    ds_read_b128 v[88:91], v3 offset:0
    ds_read_b128 v[92:95], v3 offset:1024
    ds_read_b128 v[96:99], v3 offset:2048
    ds_read_b128 v[100:103], v3 offset:3072
    ds_read_b128 v[104:107], v3 offset:4096
    ds_read_b128 v[108:111], v3 offset:5120
    ds_read_b128 v[112:115], v3 offset:6144
    ds_read_b128 v[116:119], v3 offset:7168
    ds_read_b128 v[120:123], v3 offset:8192
    ds_read_b128 v[124:127], v3 offset:9216
    ds_read_b128 v[128:131], v3 offset:10240
    ds_read_b128 v[132:135], v3 offset:11264
    ds_read_b128 v[136:139], v3 offset:12288
    ds_read_b128 v[140:143], v3 offset:13312
    ds_read_b128 v[144:147], v3 offset:14336
    ds_read_b128 v[148:151], v3 offset:15360
    v_lshlrev_b32 v152, 16, v200
    v_and_b32 v153, 0xffff0000, v200
    v_lshlrev_b32 v154, 16, v201
    v_and_b32 v155, 0xffff0000, v201
    v_lshlrev_b32 v156, 16, v202
    v_and_b32 v157, 0xffff0000, v202
    v_lshlrev_b32 v158, 16, v203
    v_and_b32 v159, 0xffff0000, v203
    v_lshlrev_b32 v160, 16, v204
    v_and_b32 v161, 0xffff0000, v204
    v_lshlrev_b32 v162, 16, v205
    v_and_b32 v163, 0xffff0000, v205
    v_lshlrev_b32 v164, 16, v206
    v_and_b32 v165, 0xffff0000, v206
    v_lshlrev_b32 v166, 16, v207
    v_and_b32 v167, 0xffff0000, v207
    v_lshlrev_b32 v168, 16, v208
    v_and_b32 v183, 0xffff0000, v208
    v_lshlrev_b32 v182, 16, v209
    v_and_b32 v181, 0xffff0000, v209
    v_lshlrev_b32 v180, 16, v210
    v_and_b32 v179, 0xffff0000, v210
    v_lshlrev_b32 v178, 16, v211
    v_and_b32 v177, 0xffff0000, v211
    v_lshlrev_b32 v176, 16, v212
    v_and_b32 v175, 0xffff0000, v212
    v_lshlrev_b32 v174, 16, v213
    v_and_b32 v173, 0xffff0000, v213
    v_lshlrev_b32 v172, 16, v214
    v_and_b32 v171, 0xffff0000, v214
    v_lshlrev_b32 v170, 16, v215
    v_and_b32 v169, 0xffff0000, v215
    s_waitcnt vmcnt(0) lgkmcnt(0)
    s_barrier
    buffer_load_dwordx4 v[24:27], v3, s[12:15], s72 offen offset:0 sc1
    buffer_load_dwordx4 v[28:31], v3, s[12:15], s72 offen offset:1024 sc1
    buffer_load_dwordx4 v[32:35], v3, s[12:15], s72 offen offset:2048 sc1
    buffer_load_dwordx4 v[36:39], v3, s[12:15], s72 offen offset:3072 sc1
    s_lshl_b32 s80, s3, 7
    s_add_u32 s80, s80, 17039360
    v_lshrrev_b32 v18, 3, v2
    v_lshlrev_b32 v18, 14, v18
    v_and_b32 v248, 0x70, v3
    v_add_u32 v18, v18, v248
    s_cmp_lg_u32 s16, 0
    s_cbranch_scc1 f_sb2
    v_add_u32 v84, 160768, v3
    s_mov_b64 exec, 0xff
    ds_read_b128 v[80:83], v84
    s_waitcnt lgkmcnt(0)
    buffer_store_dwordx4 v[80:83], v3, s[12:15], s63 offen sc1
    s_mov_b64 exec, -1
    v_not_b32 v250, s32
    buffer_store_dwordx4 v[248:251], v18, s[12:15], s80 offen sc1
f_sb2:
    v_xor_b32 v16, 2544, v15
    s_nop 0
    v_subrev_u32 v248, s68, v13
    v_add_u32 v248, 32, v248
    v_bfe_u32 v19, v248, 5, 1
    v_lshlrev_b32 v19, 5, v19
    v_bfe_u32 v249, v248, 8, 2
    v_lshl_add_u32 v19, v249, 3, v19
    v_bfe_u32 v249, v248, 10, 1
    v_lshl_add_u32 v19, v249, 2, v19
    v_bfe_u32 v249, v248, 6, 2
    v_add_lshl_u32 v19, v249, v19, 2
    s_lshl_b32 s74, s34, 14
    s_add_u32 s74, s74, 17039360
    s_lshl_b32 s42, s37, 9
    s_add_u32 s42, s42, 61440
    v_add_u32 v12, s42, v12
    s_mul_i32 s17, s34, 7
    s_lshr_b32 s42, s35, 1
    s_add_u32 s17, s17, s42
    s_lshl_b32 s42, s17, 6
    s_lshr_b32 s43, s16, 2
    s_lshl_b32 s43, s43, 5
    s_add_u32 s42, s42, s43
    s_and_b32 s43, s16, 1
    s_lshl_b32 s43, s43, 4
    s_add_u32 s42, s42, s43
    s_and_b32 s43, s16, 2
    s_lshl_b32 s43, s43, 1
    s_add_u32 s42, s42, s43
    s_lshl_b32 s38, s42, 11
    s_and_b32 s43, s35, 1
    s_lshl_b32 s43, s43, 10
    s_add_u32 s38, s38, s43
    s_lshl_b32 s39, s16, 13
    s_add_u32 s39, s39, 94208
    s_mov_b32 s48, s28
    s_mov_b32 s49, s29
    s_mov_b32 s50, 7340032
    s_mov_b32 s51, 0x00020000
    s_bfe_u32 s4, s32, 524288
    s_bfe_u32 s5, s32, 524296
    s_bfe_u32 s6, s32, 524304
    s_bfe_u32 s7, s32, 524312
    s_bfe_u32 s8, s33, 524288
    s_bfe_u32 s9, s33, 524296
    s_bfe_u32 s10, s33, 524304
    s_bfe_u32 s11, s33, 524312
    v_lshlrev_b32 v17, 7, v4
    s_and_b32 s40, s16, 3
    s_lshl_b32 s76, s40, 10
    v_subrev_u32 v248, s68, v13
    v_lshrrev_b32 v248, 1, v248
    s_lshl_b32 s42, s40, 2
    v_add_u32 v248, s42, v248
    v_bfe_u32 v235, v248, 7, 1
    v_lshlrev_b32 v235, 9, v235
    v_and_b32 v249, 31, v248
    v_lshl_add_u32 v235, v249, 4, v235
    v_bfe_u32 v249, v248, 8, 1
    v_lshl_add_u32 v235, v249, 3, v235
    v_lshrrev_b32 v249, 9, v248
    v_lshl_add_u32 v235, v249, 10, v235
    v_bfe_u32 v249, v248, 5, 2
    v_lshl_add_u32 v235, v249, 1, v235
    v_mov_b32 v8, s32
    v_mov_b32 v9, s33
    v_and_b32 v10, 1, v0
    v_cmp_eq_u32 vcc, 1, v10
    s_nop 1
    v_cndmask_b32 v8, v8, v9, vcc
    v_bfe_u32 v9, v8, 8, 8
    v_bfe_u32 v10, v8, 16, 8
    v_lshrrev_b32 v11, 24, v8
    v_and_b32 v8, 0xff, v8
    s_add_u32 s76, s76, 16875520
    s_mov_b32 s77, 16850944
f_wx:
    s_add_u32 s65, s76, 4096
    s_lshl_b32 s42, s16, 11
    v_add_u32 v4, s42, v3
    s_add_u32 s64, s42, 16883712
    s_lshl_b32 s42, s16, 12
    s_add_u32 s42, s42, 61440
    v_add_u32 v7, s42, v3
    v_mov_b32 v20, 159808
    s_cmp_eq_u32 s3, 0
    s_cselect_b64 s[52:53], -1, 1
    v_mov_b32 v196, v8
    v_mov_b32 v197, v9
    v_mov_b32 v198, v10
    v_mov_b32 v199, v11
    s_mov_b32 s83, 0
    s_cmp_ge_u32 s16, 4
    s_cbranch_scc1 f_z1
    s_waitcnt vmcnt(6)
    s_mov_b64 exec, 0xf0ff
    buffer_load_dwordx4 v[236:239], v17, s[12:15], s77 offen sc1
    s_mov_b64 exec, s[52:53]
    buffer_load_dwordx4 v[196:199], v3, s[12:15], s76 offen sc1
    s_mov_b64 exec, -1
    buffer_load_dwordx4 v[192:195], v3, s[12:15], s65 offen sc1
    buffer_load_dwordx4 v[184:187], v3, s[12:15], s64 offen offset:0 sc1
    buffer_load_dwordx4 v[188:191], v3, s[12:15], s64 offen offset:1024 sc1
    s_waitcnt vmcnt(7)
    v_xor_b32 v40, v24, v244
    v_xor_b32 v41, v28, v244
    v_xor_b32 v42, v25, v245
    v_xor_b32 v43, v29, v245
    v_xor_b32 v44, v26, v246
    v_xor_b32 v45, v30, v246
    v_xor_b32 v46, v27, v247
    v_xor_b32 v47, v31, v247
    v_mfma_f32_16x16x16_f16 v[56:59], v[22:23], v[40:41], 0
    v_or3_b32 v248, v40, v41, 0
    v_mfma_f32_16x16x16_f16 v[64:67], v[22:23], v[44:45], 0
    v_or3_b32 v248, v44, v45, v248
    v_mfma_f32_16x16x16_f16 v[60:63], v[22:23], v[42:43], 0
    v_or3_b32 v248, v42, v43, v248
    v_mfma_f32_16x16x16_f16 v[68:71], v[22:23], v[46:47], 0
    v_or3_b32 v248, v46, v47, v248
    s_waitcnt vmcnt(5)
    s_branch f_z2
f_z1:
    s_waitcnt vmcnt(4)
    buffer_load_dwordx4 v[184:187], v3, s[12:15], s64 offen offset:0 sc1
    buffer_load_dwordx4 v[188:191], v3, s[12:15], s64 offen offset:1024 sc1
    s_waitcnt vmcnt(4)
f_zc:
    v_xor_b32 v40, v24, v244
    v_xor_b32 v41, v28, v244
    v_xor_b32 v42, v25, v245
    v_xor_b32 v43, v29, v245
    v_xor_b32 v44, v26, v246
    v_xor_b32 v45, v30, v246
    v_xor_b32 v46, v27, v247
    v_xor_b32 v47, v31, v247
    v_mfma_f32_16x16x16_f16 v[56:59], v[22:23], v[40:41], 0
    v_or3_b32 v248, v40, v41, 0
    v_mfma_f32_16x16x16_f16 v[64:67], v[22:23], v[44:45], 0
    v_or3_b32 v248, v44, v45, v248
    v_mfma_f32_16x16x16_f16 v[60:63], v[22:23], v[42:43], 0
    v_or3_b32 v248, v42, v43, v248
    v_mfma_f32_16x16x16_f16 v[68:71], v[22:23], v[46:47], 0
    v_or3_b32 v248, v46, v47, v248
    s_waitcnt vmcnt(2)
f_z2:
    v_xor_b32 v48, v32, v244
    v_xor_b32 v49, v36, v244
    v_xor_b32 v50, v33, v245
    v_xor_b32 v51, v37, v245
    v_xor_b32 v52, v34, v246
    v_xor_b32 v53, v38, v246
    v_xor_b32 v54, v35, v247
    v_xor_b32 v55, v39, v247
    v_mfma_f32_16x16x16_f16 v[72:75], v[22:23], v[48:49], 0
    v_or3_b32 v248, v48, v49, v248
    v_mfma_f32_16x16x16_f16 v[80:83], v[22:23], v[52:53], 0
    v_or3_b32 v248, v52, v53, v248
    v_mfma_f32_16x16x16_f16 v[76:79], v[22:23], v[50:51], 0
    v_or3_b32 v248, v50, v51, v248
    v_mfma_f32_16x16x16_f16 v[84:87], v[22:23], v[54:55], 0
    v_or3_b32 v248, v54, v55, v248
    v_and_b32 v248, s54, v248
    v_cmp_ne_u32 vcc, 0, v248
    s_cbranch_vccnz f_zr
f_zx:
    v_cvt_pk_f16_f32 v24, v56, v57
    v_cvt_pk_f16_f32 v25, v64, v65
    v_cvt_pk_f16_f32 v26, v72, v73
    v_cvt_pk_f16_f32 v27, v80, v81
    ds_write_b128 v12, v[24:27] offset:0
    v_cvt_pk_f16_f32 v28, v58, v59
    v_cvt_pk_f16_f32 v29, v66, v67
    v_cvt_pk_f16_f32 v30, v74, v75
    v_cvt_pk_f16_f32 v31, v82, v83
    ds_write_b128 v12, v[28:31] offset:4096
    v_cvt_pk_f16_f32 v32, v60, v61
    v_cvt_pk_f16_f32 v33, v68, v69
    v_cvt_pk_f16_f32 v34, v76, v77
    v_cvt_pk_f16_f32 v35, v84, v85
    ds_write_b128 v12, v[32:35] offset:256
    v_cvt_pk_f16_f32 v36, v62, v63
    v_cvt_pk_f16_f32 v37, v70, v71
    v_cvt_pk_f16_f32 v38, v78, v79
    v_cvt_pk_f16_f32 v39, v86, v87
    ds_write_b128 v12, v[36:39] offset:4352
    s_mov_b32 s83, 0
    s_cmp_lt_u32 s16, 4
    s_cbranch_scc1 f_pv
f_qv:
    s_waitcnt vmcnt(1)
    v_xor_b32 v184, v8, v184
    v_xor_b32 v185, v9, v185
    v_xor_b32 v186, v10, v186
    v_xor_b32 v187, v11, v187
    v_or3_b32 v248, v184, v185, 0
    v_or3_b32 v248, v186, v187, v248
    ds_write_b128 v4, v[184:187] offset:20480
    s_waitcnt vmcnt(0)
    v_xor_b32 v188, v8, v188
    v_xor_b32 v189, v9, v189
    v_xor_b32 v190, v10, v190
    v_xor_b32 v191, v11, v191
    v_or3_b32 v248, v188, v189, v248
    v_or3_b32 v248, v190, v191, v248
    ds_write_b128 v4, v[188:191] offset:21504
    v_and_b32 v248, 0xff, v248
    v_cmp_ne_u32 vcc, 0, v248
    s_cbranch_vccnz f_qr
    s_branch f_pvx
f_pv:
    s_waitcnt vmcnt(3)
    v_add_f32_dpp v239, v238, v238 quad_perm:[1,0,3,2] row_mask:0xf bank_mask:0xf
    v_max_f32_dpp v238, v238, v238 quad_perm:[1,0,3,2] row_mask:0xf bank_mask:0xf
    v_cmp_ne_u64 s[44:45], s[32:33], v[236:237]
    v_add_f32_dpp v239, v239, v239 quad_perm:[2,3,0,1] row_mask:0xf bank_mask:0xf
    v_max_f32_dpp v238, v238, v238 quad_perm:[2,3,0,1] row_mask:0xf bank_mask:0xf
    v_xor_b32 v196, v8, v196
    v_xor_b32 v197, v9, v197
    v_xor_b32 v198, v10, v198
    v_xor_b32 v199, v11, v199
    v_or3_b32 v248, v196, v197, 0
    v_or3_b32 v248, v198, v199, v248
    v_max_f32_dpp v238, v238, v238 row_half_mirror row_mask:0xf bank_mask:0xf
    s_mov_b64 exec, 0x1000
    ds_write_b32 v20, v239
    s_mov_b64 exec, -1
    v_frexp_exp_i32_f32 v238, v238
    s_waitcnt vmcnt(2)
    v_xor_b32 v192, v8, v192
    v_xor_b32 v193, v9, v193
    v_xor_b32 v194, v10, v194
    v_xor_b32 v195, v11, v195
    v_or3_b32 v248, v192, v193, v248
    v_or3_b32 v248, v194, v195, v248
    v_readfirstlane_b32 s42, v238
    s_sub_u32 s43, -1, s42
    s_add_u32 s45, s42, 5
    s_and_b32 s44, s44, 0xf0ff
    v_ldexp_f32 v192, v192, s43
    v_ldexp_f32 v193, v193, s43
    v_ldexp_f32 v194, v194, s43
    v_ldexp_f32 v195, v195, s43
    v_cvt_pk_f16_f32 v192, v192, v193
    v_cvt_pk_f16_f32 v194, v194, v195
    ds_write_b16 v235, v192 offset:16384
    ds_write_b16_d16_hi v235, v192 offset:16400
    ds_write_b16 v235, v194 offset:16416
    ds_write_b16_d16_hi v235, v194 offset:16432
    s_waitcnt vmcnt(1)
    v_xor_b32 v184, v8, v184
    v_xor_b32 v185, v9, v185
    v_xor_b32 v186, v10, v186
    v_xor_b32 v187, v11, v187
    v_or3_b32 v248, v184, v185, v248
    v_or3_b32 v248, v186, v187, v248
    v_ldexp_f32 v184, v184, s45
    v_ldexp_f32 v185, v185, s45
    v_ldexp_f32 v186, v186, s45
    v_ldexp_f32 v187, v187, s45
    ds_write_b128 v4, v[184:187] offset:20480
    s_waitcnt vmcnt(0)
    v_xor_b32 v188, v8, v188
    v_xor_b32 v189, v9, v189
    v_xor_b32 v190, v10, v190
    v_xor_b32 v191, v11, v191
    v_or3_b32 v248, v188, v189, v248
    v_or3_b32 v248, v190, v191, v248
    v_ldexp_f32 v188, v188, s45
    v_ldexp_f32 v189, v189, s45
    v_ldexp_f32 v190, v190, s45
    v_ldexp_f32 v191, v191, s45
    ds_write_b128 v4, v[188:191] offset:21504
    v_and_b32 v248, 0xff, v248
    v_cmp_ne_u32 vcc, 0, v248
    s_or_b32 vcc_lo, vcc_lo, s44
    s_cbranch_vccnz f_pr
f_pw:
    s_cmp_eq_u32 s3, 0
    s_cbranch_scc1 f_ps
f_pvx:
    s_setprio 2
    s_waitcnt lgkmcnt(0)
    s_barrier
    ds_read_b128 v[248:251], v3 offset:16384
    ds_read_b128 v[24:27], v7 offset:0
    ds_read_b128 v[28:31], v7 offset:1024
    ds_read_b128 v[252:255], v3 offset:17408
    ds_read_b128 v[32:35], v7 offset:2048
    ds_read_b128 v[36:39], v7 offset:3072
    s_cmp_eq_u32 s30, 0
    s_cbranch_scc1 f_sp
    s_waitcnt lgkmcnt(4)
    v_pk_mul_f16 v40, v24, v248 op_sel:[0,0] op_sel_hi:[1,0]
    v_pk_mul_f16 v41, v25, v248 op_sel:[0,1] op_sel_hi:[1,1]
    v_pk_mul_f16 v42, v26, v249 op_sel:[0,0] op_sel_hi:[1,0]
    v_pk_mul_f16 v43, v27, v249 op_sel:[0,1] op_sel_hi:[1,1]
    s_nop 1
    v_mfma_f32_32x32x16_f16 v[56:71], v[40:43], v[88:91], 0
    s_waitcnt lgkmcnt(3)
    v_pk_mul_f16 v44, v28, v250 op_sel:[0,0] op_sel_hi:[1,0]
    v_pk_mul_f16 v45, v29, v250 op_sel:[0,1] op_sel_hi:[1,1]
    v_pk_mul_f16 v46, v30, v251 op_sel:[0,0] op_sel_hi:[1,0]
    v_pk_mul_f16 v47, v31, v251 op_sel:[0,1] op_sel_hi:[1,1]
    v_mfma_f32_32x32x16_f16 v[72:87], v[40:43], v[104:107], 0
    s_waitcnt lgkmcnt(1)
    v_pk_mul_f16 v48, v32, v252 op_sel:[0,0] op_sel_hi:[1,0]
    v_pk_mul_f16 v49, v33, v252 op_sel:[0,1] op_sel_hi:[1,1]
    v_pk_mul_f16 v50, v34, v253 op_sel:[0,0] op_sel_hi:[1,0]
    v_pk_mul_f16 v51, v35, v253 op_sel:[0,1] op_sel_hi:[1,1]
    v_mfma_f32_32x32x16_f16 v[56:71], v[44:47], v[92:95], v[56:71]
    s_waitcnt lgkmcnt(0)
    v_pk_mul_f16 v52, v36, v254 op_sel:[0,0] op_sel_hi:[1,0]
    v_pk_mul_f16 v53, v37, v254 op_sel:[0,1] op_sel_hi:[1,1]
    v_pk_mul_f16 v54, v38, v255 op_sel:[0,0] op_sel_hi:[1,0]
    v_pk_mul_f16 v55, v39, v255 op_sel:[0,1] op_sel_hi:[1,1]
    v_mfma_f32_32x32x16_f16 v[72:87], v[44:47], v[108:111], v[72:87]
f_st1:
    v_mfma_f32_32x32x16_f16 v[56:71], v[48:51], v[96:99], v[56:71]
    ds_read_b128 v[184:187], v3 offset:20480
    ds_read_b128 v[188:191], v3 offset:21504
    v_mfma_f32_32x32x16_f16 v[72:87], v[48:51], v[112:115], v[72:87]
    ds_read_b128 v[192:195], v3 offset:22528
    ds_read_b128 v[196:199], v3 offset:23552
    v_mfma_f32_32x32x16_f16 v[56:71], v[52:55], v[100:103], v[56:71]
    ds_read_b128 v[200:203], v3 offset:24576
    ds_read_b128 v[204:207], v3 offset:25600
    v_mfma_f32_32x32x16_f16 v[72:87], v[52:55], v[116:119], v[72:87]
    ds_read_b128 v[208:211], v3 offset:26624
    ds_read_b128 v[212:215], v3 offset:27648
    v_mov_b32 v22, 159808
    ds_read_b32 v22, v22
    s_cmp_ge_u32 s35, 14
    s_cbranch_scc1 f_nd0
    s_add_u32 s43, s39, 0
    s_mov_b32 m0, s43
    s_add_u32 s42, s38, 0
    buffer_load_dwordx4 v3, s[48:51], s42 offen nt lds
    s_add_u32 s43, s39, 1024
    s_mov_b32 m0, s43
    s_add_u32 s42, s38, 2048
    v_xor_b32 v7, 32, v3
    buffer_load_dwordx4 v7, s[48:51], s42 offen nt lds
    s_add_u32 s43, s39, 2048
    s_mov_b32 m0, s43
    s_add_u32 s42, s38, 4096
    v_xor_b32 v7, 64, v3
    buffer_load_dwordx4 v7, s[48:51], s42 offen nt lds
f_nd0:
    s_cmp_eq_u32 s30, 0
    s_cbranch_scc1 f_sp2
    v_pk_mul_f32 v[24:25], v[56:57], v[120:121]
    v_pk_mul_f32 v[28:29], v[72:73], v[120:121]
    v_pk_mul_f32 v[26:27], v[58:59], v[122:123]
    v_pk_mul_f32 v[30:31], v[74:75], v[122:123]
    v_pk_fma_f32 v[24:25], v[72:73], v[136:137], v[24:25]
    v_pk_fma_f32 v[28:29], v[56:57], v[136:137], v[28:29] neg_lo:[1,0,0] neg_hi:[1,0,0]
    v_pk_fma_f32 v[26:27], v[74:75], v[138:139], v[26:27]
    v_pk_fma_f32 v[30:31], v[58:59], v[138:139], v[30:31] neg_lo:[1,0,0] neg_hi:[1,0,0]
    v_cvt_pk_f16_f32 v40, v24, v28
    v_cvt_pk_f16_f32 v41, v25, v29
    v_cvt_pk_f16_f32 v42, v26, v30
    v_cvt_pk_f16_f32 v43, v27, v31
    ds_read_b128 v[216:219], v3 offset:28672
    ds_read_b128 v[220:223], v3 offset:29696
    ds_read_b128 v[224:227], v3 offset:30720
    ds_read_b128 v[228:231], v3 offset:31744
    v_pk_mul_f32 v[32:33], v[60:61], v[124:125]
    v_pk_mul_f32 v[36:37], v[76:77], v[124:125]
    v_pk_mul_f32 v[34:35], v[62:63], v[126:127]
    v_pk_mul_f32 v[38:39], v[78:79], v[126:127]
    v_pk_fma_f32 v[32:33], v[76:77], v[140:141], v[32:33]
    v_pk_fma_f32 v[36:37], v[60:61], v[140:141], v[36:37] neg_lo:[1,0,0] neg_hi:[1,0,0]
    v_pk_fma_f32 v[34:35], v[78:79], v[142:143], v[34:35]
    v_pk_fma_f32 v[38:39], v[62:63], v[142:143], v[38:39] neg_lo:[1,0,0] neg_hi:[1,0,0]
    v_cvt_pk_f16_f32 v44, v32, v36
    v_cvt_pk_f16_f32 v45, v33, v37
    v_cvt_pk_f16_f32 v46, v34, v38
    v_cvt_pk_f16_f32 v47, v35, v39
    v_mfma_f32_32x32x16_f16 v[104:119], v[40:43], v[88:91], 0
    ds_read_b128 v[232:235], v3 offset:32768
    ds_read_b128 v[236:239], v3 offset:33792
    ds_read_b128 v[240:243], v3 offset:34816
    ds_read_b128 v[244:247], v3 offset:35840
    v_pk_mul_f32 v[24:25], v[64:65], v[128:129]
    v_pk_mul_f32 v[28:29], v[80:81], v[128:129]
    v_pk_mul_f32 v[26:27], v[66:67], v[130:131]
    v_pk_mul_f32 v[30:31], v[82:83], v[130:131]
    v_pk_fma_f32 v[24:25], v[80:81], v[144:145], v[24:25]
    v_pk_fma_f32 v[28:29], v[64:65], v[144:145], v[28:29] neg_lo:[1,0,0] neg_hi:[1,0,0]
    v_pk_fma_f32 v[26:27], v[82:83], v[146:147], v[26:27]
    v_pk_fma_f32 v[30:31], v[66:67], v[146:147], v[30:31] neg_lo:[1,0,0] neg_hi:[1,0,0]
    v_cvt_pk_f16_f32 v48, v24, v28
    v_cvt_pk_f16_f32 v49, v25, v29
    v_cvt_pk_f16_f32 v50, v26, v30
    v_cvt_pk_f16_f32 v51, v27, v31
    v_mfma_f32_32x32x16_f16 v[104:119], v[44:47], v[92:95], v[104:119]
    v_pk_mul_f32 v[32:33], v[68:69], v[132:133]
    v_pk_mul_f32 v[36:37], v[84:85], v[132:133]
    v_pk_mul_f32 v[34:35], v[70:71], v[134:135]
    v_pk_mul_f32 v[38:39], v[86:87], v[134:135]
    v_pk_fma_f32 v[32:33], v[84:85], v[148:149], v[32:33]
    v_pk_fma_f32 v[36:37], v[68:69], v[148:149], v[36:37] neg_lo:[1,0,0] neg_hi:[1,0,0]
    v_pk_fma_f32 v[34:35], v[86:87], v[150:151], v[34:35]
    v_pk_fma_f32 v[38:39], v[70:71], v[150:151], v[38:39] neg_lo:[1,0,0] neg_hi:[1,0,0]
    v_cvt_pk_f16_f32 v52, v32, v36
    v_cvt_pk_f16_f32 v53, v33, v37
    v_cvt_pk_f16_f32 v54, v34, v38
    v_cvt_pk_f16_f32 v55, v35, v39
    v_mfma_f32_32x32x16_f16 v[104:119], v[48:51], v[96:99], v[104:119]
    s_nop 0
    v_mfma_f32_32x32x16_f16 v[104:119], v[52:55], v[100:103], v[104:119]
    s_nop 11
    ds_bpermute_b32 v12, v19, v104
    s_waitcnt lgkmcnt(1)
    v_pk_fma_f32 v[152:153], v[184:185], v[104:105], v[152:153]
    v_pk_fma_f32 v[154:155], v[186:187], v[106:107], v[154:155]
    v_pk_fma_f32 v[156:157], v[188:189], v[108:109], v[156:157]
    v_pk_fma_f32 v[158:159], v[190:191], v[110:111], v[158:159]
    v_pk_fma_f32 v[160:161], v[192:193], v[112:113], v[160:161]
    v_pk_fma_f32 v[162:163], v[194:195], v[114:115], v[162:163]
    v_pk_fma_f32 v[164:165], v[196:197], v[116:117], v[164:165]
    v_pk_fma_f32 v[166:167], v[198:199], v[118:119], v[166:167]
    v_pk_fma_f32 v[170:171], v[202:203], v[106:107], v[170:171]
    v_pk_fma_f32 v[172:173], v[204:205], v[108:109], v[172:173]
    v_pk_fma_f32 v[174:175], v[206:207], v[110:111], v[174:175]
    v_pk_fma_f32 v[176:177], v[208:209], v[112:113], v[176:177]
    v_pk_fma_f32 v[178:179], v[210:211], v[114:115], v[178:179]
    v_pk_fma_f32 v[180:181], v[212:213], v[116:117], v[180:181]
    v_pk_fma_f32 v[182:183], v[214:215], v[118:119], v[182:183]
    v_fmac_f32 v169, v201, v105
    s_waitcnt lgkmcnt(0)
    v_fmac_f32 v168, v200, v12
f_join:
    s_setprio 1
    v_lshrrev_b32 v17, 3, v0
    v_and_b32 v17, 60, v17
    v_add_u32 v17, 159744, v17
    v_and_b32 v7, 0xf0, v3
    v_lshrrev_b32 v7, 2, v7
    v_add_u32 v7, 159744, v7
    v_pk_add_f32 v[40:41], v[166:167], v[164:165]
    v_pk_add_f32 v[48:49], v[182:183], v[180:181]
    v_pk_add_f32 v[40:41], v[40:41], v[162:163]
    v_pk_add_f32 v[48:49], v[48:49], v[178:179]
    v_pk_add_f32 v[40:41], v[40:41], v[160:161]
    v_pk_add_f32 v[48:49], v[48:49], v[176:177]
    v_pk_add_f32 v[40:41], v[40:41], v[158:159]
    v_pk_add_f32 v[48:49], v[48:49], v[174:175]
    v_pk_add_f32 v[40:41], v[40:41], v[156:157]
    v_pk_add_f32 v[48:49], v[48:49], v[172:173]
    v_pk_add_f32 v[40:41], v[40:41], v[154:155]
    v_pk_add_f32 v[48:49], v[48:49], v[170:171]
    v_pk_add_f32 v[40:41], v[40:41], v[152:153]
    v_pk_add_f32 v[48:49], v[48:49], v[168:169]
    v_pk_mul_f32 v[42:43], v[166:167], v[166:167]
    v_pk_mul_f32 v[44:45], v[166:167], v[230:231]
    v_pk_mul_f32 v[50:51], v[182:183], v[182:183]
    v_pk_mul_f32 v[52:53], v[182:183], v[246:247]
    v_pk_fma_f32 v[42:43], v[164:165], v[164:165], v[42:43]
    v_pk_fma_f32 v[44:45], v[164:165], v[228:229], v[44:45]
    v_pk_fma_f32 v[50:51], v[180:181], v[180:181], v[50:51]
    v_pk_fma_f32 v[52:53], v[180:181], v[244:245], v[52:53]
    v_pk_fma_f32 v[42:43], v[162:163], v[162:163], v[42:43]
    v_pk_fma_f32 v[44:45], v[162:163], v[226:227], v[44:45]
    v_pk_fma_f32 v[50:51], v[178:179], v[178:179], v[50:51]
    v_pk_fma_f32 v[52:53], v[178:179], v[242:243], v[52:53]
    v_pk_fma_f32 v[42:43], v[160:161], v[160:161], v[42:43]
    v_pk_fma_f32 v[44:45], v[160:161], v[224:225], v[44:45]
    v_pk_fma_f32 v[50:51], v[176:177], v[176:177], v[50:51]
    v_pk_fma_f32 v[52:53], v[176:177], v[240:241], v[52:53]
    v_pk_fma_f32 v[42:43], v[158:159], v[158:159], v[42:43]
    v_pk_fma_f32 v[44:45], v[158:159], v[222:223], v[44:45]
    v_pk_fma_f32 v[50:51], v[174:175], v[174:175], v[50:51]
    v_pk_fma_f32 v[52:53], v[174:175], v[238:239], v[52:53]
    v_pk_fma_f32 v[42:43], v[156:157], v[156:157], v[42:43]
    v_pk_fma_f32 v[44:45], v[156:157], v[220:221], v[44:45]
    v_pk_fma_f32 v[50:51], v[172:173], v[172:173], v[50:51]
    v_pk_fma_f32 v[52:53], v[172:173], v[236:237], v[52:53]
    v_pk_fma_f32 v[42:43], v[154:155], v[154:155], v[42:43]
    v_pk_fma_f32 v[44:45], v[154:155], v[218:219], v[44:45]
    v_pk_fma_f32 v[50:51], v[170:171], v[170:171], v[50:51]
    v_pk_fma_f32 v[52:53], v[170:171], v[234:235], v[52:53]
    v_pk_fma_f32 v[42:43], v[152:153], v[152:153], v[42:43]
    v_pk_fma_f32 v[44:45], v[152:153], v[216:217], v[44:45]
    v_pk_fma_f32 v[50:51], v[168:169], v[168:169], v[50:51]
    v_pk_fma_f32 v[52:53], v[168:169], v[232:233], v[52:53]
    v_add_f32 v24, v40, v41
    v_add_f32 v25, v42, v43
    v_add_f32 v26, v44, v45
    v_add_f32 v28, v48, v49
    v_add_f32 v29, v50, v51
    v_add_f32 v30, v52, v53
    s_setprio 0
    v_permlane32_swap_b32 v24, v28
    v_permlane32_swap_b32 v25, v29
    v_permlane32_swap_b32 v26, v30
    v_add_f32 v24, v24, v28
    v_add_f32 v25, v25, v29
    v_add_f32 v26, v26, v30
    v_add_f32_dpp v24, v24, v24 row_ror:8 row_mask:0xf bank_mask:0xf
    v_add_f32_dpp v25, v25, v25 row_ror:8 row_mask:0xf bank_mask:0xf
    v_add_f32_dpp v26, v26, v26 row_ror:8 row_mask:0xf bank_mask:0xf
    v_add_f32_dpp v24, v24, v24 row_ror:4 row_mask:0xf bank_mask:0xf
    v_add_f32_dpp v25, v25, v25 row_ror:4 row_mask:0xf bank_mask:0xf
    v_add_f32_dpp v26, v26, v26 row_ror:4 row_mask:0xf bank_mask:0xf
    v_add_f32_dpp v24, v24, v24 row_ror:2 row_mask:0xf bank_mask:0xf
    v_add_f32_dpp v25, v25, v25 row_ror:2 row_mask:0xf bank_mask:0xf
    v_add_f32_dpp v26, v26, v26 row_ror:2 row_mask:0xf bank_mask:0xf
    v_add_f32_dpp v24, v24, v24 row_ror:1 row_mask:0xf bank_mask:0xf
    v_add_f32_dpp v25, v25, v25 row_ror:1 row_mask:0xf bank_mask:0xf
    v_add_f32_dpp v26, v26, v26 row_ror:1 row_mask:0xf bank_mask:0xf
    v_add_f32_dpp v24, v24, v24 row_bcast:15 row_mask:0xa bank_mask:0xf
    v_add_f32_dpp v25, v25, v25 row_bcast:15 row_mask:0xa bank_mask:0xf
    v_add_f32_dpp v26, v26, v26 row_bcast:15 row_mask:0xa bank_mask:0xf
    v_mul_f32 v24, 0x3a800000, v24
    v_mul_f32 v25, 0x3a800000, v25
    v_mul_f32 v28, v24, v24
    v_fma_f32 v26, -v24, v22, v26
    v_sub_f32 v25, v25, v28
    v_mul_f32 v29, 4.0, v25
    v_cmp_gt_f32 vcc, v28, v29
    v_lshrrev_b32 v30, 4, v0
    s_lshl_b32 s43, s3, 5
    v_and_or_b32 v30, v30, 30, s43
    s_or_b32 s42, vcc_lo, vcc_hi
    s_bitcmp1_b32 s42, 31
    s_cbranch_scc1 f_slow2
f_var2:
    v_cvt_pk_bf16_f32 v25, v25, v25
    v_lshlrev_b32 v25, 16, v25
    v_add_f32 v25, 0x3727c5ac, v25
    v_cvt_pk_bf16_f32 v25, v25, v25
    v_lshlrev_b32 v25, 16, v25
    v_sqrt_f32 v25, v25
    s_nop 0
    v_cvt_pk_bf16_f32 v25, v25, v25
    v_lshlrev_b32 v25, 16, v25
    v_rcp_f32 v25, v25
    s_mov_b32 s42, 0x80000000
    s_movk_i32 s43, 0xf000
    s_mov_b32 exec_lo, s42
    s_mov_b32 exec_hi, s42
    v_mul_f32 v26, v26, v25
    v_ashrrev_i32 v28, 31, v26
    v_or_b32 v28, s42, v28
    v_xor_b32 v26, v26, v28
    v_and_or_b32 v26, v26, s43, v30
    ds_write_b32 v17, v26
    v_mul_f32 v24, -v24, v25
    s_mov_b64 exec, -1
    v_readlane_b32 s60, v26, 31
    v_readlane_b32 s56, v24, 31
    v_readlane_b32 s57, v25, 31
    v_readlane_b32 s61, v26, 63
    v_readlane_b32 s58, v24, 63
    v_readlane_b32 s59, v25, 63
    s_waitcnt lgkmcnt(0)
    s_setprio 0
    s_barrier
    ds_read_b32 v32, v7
    s_mul_i32 s42, s16, 3072
    v_add_u32 v4, s42, v3
    s_add_u32 s64, s42, 16900096
    s_waitcnt lgkmcnt(0)
    v_cmp_lt_u32 vcc, s60, v32
    v_cmp_lt_u32 s[44:45], s61, v32
    s_and_b32 s62, vcc_lo, 0xffff
    s_and_b32 s63, s44, 0xffff
    s_bcnt1_i32_b32 s62, s62
    s_bcnt1_i32_b32 s63, s63
    s_min_u32 s42, s62, s63
    s_cmp_lg_u32 s42, 0
    s_cbranch_scc1 f_nkey
    s_setprio 3
    s_max_u32 s42, s60, s61
    v_cmp_ne_u32 vcc, s42, v32
    v_mov_b32 v36, s42
    v_mov_b32 v38, s32
    v_cndmask_b32 v37, 0, v32, vcc
    v_mov_b32 v39, s33
    s_nop 0
    v_max_u32_dpp v37, v37, v37 row_ror:8 row_mask:0xf bank_mask:0xf
    s_nop 1
    v_max_u32_dpp v37, v37, v37 row_ror:4 row_mask:0xf bank_mask:0xf
    s_nop 1
    v_max_u32_dpp v37, v37, v37 row_ror:2 row_mask:0xf bank_mask:0xf
    s_nop 1
    v_max_u32_dpp v37, v37, v37 row_ror:1 row_mask:0xf bank_mask:0xf
    v_or_b32 v37, 1, v37
    buffer_store_dwordx4 v[36:39], v18, s[12:15], s80 offen sc1
f_nkey:
    s_cmp_ge_u32 s62, 2
    s_cbranch_scc1 f_nc0
f_cand0:
    s_setprio 2
    s_lshl_b32 s43, s3, 1
    s_add_u32 s42, s62, s43
    s_lshl_b32 s43, s42, 7
    s_lshl_b32 s42, s42, 12
    s_add_u32 s42, s42, 18874368
    s_add_u32 s43, s43, 17170432
    v_mov_b32 v12, 0xffffff00
    v_and_or_b32 v56, v152, v12, s4
    v_and_or_b32 v57, v153, v12, s5
    v_and_or_b32 v58, v154, v12, s6
    v_and_or_b32 v59, v155, v12, s7
    buffer_store_dwordx4 v[56:59], v15, s[12:15], s42 offen offset:0 sc1
    v_and_or_b32 v60, v156, v12, s8
    v_and_or_b32 v61, v157, v12, s9
    v_and_or_b32 v62, v158, v12, s10
    v_and_or_b32 v63, v159, v12, s11
    buffer_store_dwordx4 v[60:63], v15, s[12:15], s42 offen offset:1024 sc1
    v_and_or_b32 v64, v160, v12, s4
    v_and_or_b32 v65, v161, v12, s5
    v_and_or_b32 v66, v162, v12, s6
    v_and_or_b32 v67, v163, v12, s7
    buffer_store_dwordx4 v[64:67], v15, s[12:15], s42 offen offset:512 sc1
    v_and_or_b32 v68, v164, v12, s8
    v_and_or_b32 v69, v165, v12, s9
    v_and_or_b32 v70, v166, v12, s10
    v_and_or_b32 v71, v167, v12, s11
    buffer_store_dwordx4 v[68:71], v15, s[12:15], s42 offen offset:1536 sc1
    v_mov_b32 v40, s32
    v_mov_b32 v41, s33
    v_mov_b32 v42, s56
    v_mov_b32 v43, s57
    s_mov_b64 exec, 0xff
    buffer_store_dwordx4 v[40:43], v3, s[12:15], s43 offen sc1
    s_mov_b64 exec, -1
    s_setprio 0
f_nc0:
    s_cmp_ge_u32 s63, 2
    s_cbranch_scc1 f_nc1
f_cand1:
    s_setprio 2
    s_lshl_b32 s43, s3, 1
    s_add_u32 s42, s63, s43
    s_lshl_b32 s43, s42, 7
    s_lshl_b32 s42, s42, 12
    s_add_u32 s42, s42, 18874368
    s_add_u32 s43, s43, 17170432
    v_mov_b32 v12, 0xffffff00
    v_and_or_b32 v72, v168, v12, s4
    v_and_or_b32 v73, v183, v12, s5
    v_and_or_b32 v74, v182, v12, s6
    v_and_or_b32 v75, v181, v12, s7
    buffer_store_dwordx4 v[72:75], v16, s[12:15], s42 offen offset:0 sc1
    v_and_or_b32 v76, v180, v12, s8
    v_and_or_b32 v77, v179, v12, s9
    v_and_or_b32 v78, v178, v12, s10
    v_and_or_b32 v79, v177, v12, s11
    buffer_store_dwordx4 v[76:79], v16, s[12:15], s42 offen offset:1024 sc1
    v_and_or_b32 v80, v176, v12, s4
    v_and_or_b32 v81, v175, v12, s5
    v_and_or_b32 v82, v174, v12, s6
    v_and_or_b32 v83, v173, v12, s7
    buffer_store_dwordx4 v[80:83], v16, s[12:15], s42 offen offset:512 sc1
    v_and_or_b32 v84, v172, v12, s8
    v_and_or_b32 v85, v171, v12, s9
    v_and_or_b32 v86, v170, v12, s10
    v_and_or_b32 v87, v169, v12, s11
    buffer_store_dwordx4 v[84:87], v16, s[12:15], s42 offen offset:1536 sc1
    v_mov_b32 v44, s32
    v_mov_b32 v45, s33
    v_mov_b32 v46, s58
    v_mov_b32 v47, s59
    s_mov_b64 exec, 0xff
    buffer_store_dwordx4 v[44:47], v3, s[12:15], s43 offen sc1
    s_mov_b64 exec, -1
    s_setprio 0
f_nc1:
    buffer_load_dwordx4 v[248:251], v3, s[12:15], s64 offen offset:0 sc1
    buffer_load_dwordx4 v[252:255], v3, s[12:15], s64 offen offset:1024 sc1
    buffer_load_dwordx4 v[136:139], v3, s[12:15], s64 offen offset:2048 sc1
    s_barrier
    s_cmp_ge_u32 s35, 14
    s_cbranch_scc1 f_nd2
    s_add_u32 s43, s39, 3072
    s_mov_b32 m0, s43
    s_add_u32 s42, s38, 6144
    v_xor_b32 v7, 96, v3
    buffer_load_dwordx4 v7, s[48:51], s42 offen nt lds
    s_add_u32 s43, s39, 4096
    s_mov_b32 m0, s43
    s_add_u32 s42, s38, 16384
    v_xor_b32 v7, 128, v3
    buffer_load_dwordx4 v7, s[48:51], s42 offen nt lds
    s_add_u32 s43, s39, 5120
    s_mov_b32 m0, s43
    s_add_u32 s42, s38, 18432
    v_xor_b32 v7, 160, v3
    buffer_load_dwordx4 v7, s[48:51], s42 offen nt lds
    s_add_u32 s43, s39, 6144
    s_mov_b32 m0, s43
    s_add_u32 s42, s38, 20480
    v_xor_b32 v7, 192, v3
    buffer_load_dwordx4 v7, s[48:51], s42 offen nt lds
    s_add_u32 s43, s39, 7168
    s_mov_b32 m0, s43
    s_add_u32 s42, s38, 22528
    v_xor_b32 v7, 224, v3
    buffer_load_dwordx4 v7, s[48:51], s42 offen nt lds
f_nd2:
    v_pk_fma_f32 v[56:57], v[152:153], s[56:57], s[56:57] op_sel:[0,1,0] op_sel_hi:[1,1,0]
    v_pk_fma_f32 v[58:59], v[154:155], s[56:57], s[56:57] op_sel:[0,1,0] op_sel_hi:[1,1,0]
    v_pk_fma_f32 v[60:61], v[156:157], s[56:57], s[56:57] op_sel:[0,1,0] op_sel_hi:[1,1,0]
    v_pk_fma_f32 v[62:63], v[158:159], s[56:57], s[56:57] op_sel:[0,1,0] op_sel_hi:[1,1,0]
    v_pk_fma_f32 v[64:65], v[160:161], s[56:57], s[56:57] op_sel:[0,1,0] op_sel_hi:[1,1,0]
    v_pk_fma_f32 v[66:67], v[162:163], s[56:57], s[56:57] op_sel:[0,1,0] op_sel_hi:[1,1,0]
    v_pk_fma_f32 v[68:69], v[164:165], s[56:57], s[56:57] op_sel:[0,1,0] op_sel_hi:[1,1,0]
    v_pk_fma_f32 v[70:71], v[166:167], s[56:57], s[56:57] op_sel:[0,1,0] op_sel_hi:[1,1,0]
    v_pk_fma_f32 v[72:73], v[168:169], s[58:59], s[58:59] op_sel:[0,1,0] op_sel_hi:[1,1,0]
    v_pk_fma_f32 v[74:75], v[170:171], s[58:59], s[58:59] op_sel:[0,1,0] op_sel_hi:[1,1,0]
    v_pk_fma_f32 v[76:77], v[172:173], s[58:59], s[58:59] op_sel:[0,1,0] op_sel_hi:[1,1,0]
    v_pk_fma_f32 v[78:79], v[174:175], s[58:59], s[58:59] op_sel:[0,1,0] op_sel_hi:[1,1,0]
    v_pk_fma_f32 v[80:81], v[176:177], s[58:59], s[58:59] op_sel:[0,1,0] op_sel_hi:[1,1,0]
    v_pk_fma_f32 v[82:83], v[178:179], s[58:59], s[58:59] op_sel:[0,1,0] op_sel_hi:[1,1,0]
    v_pk_fma_f32 v[84:85], v[180:181], s[58:59], s[58:59] op_sel:[0,1,0] op_sel_hi:[1,1,0]
    v_pk_fma_f32 v[86:87], v[182:183], s[58:59], s[58:59] op_sel:[0,1,0] op_sel_hi:[1,1,0]
    v_subrev_u32 v13, s68, v13
    s_sub_u32 s68, s68, 65536
    v_bfe_u32 v12, v0, 1, 2
    v_lshlrev_b32 v12, 4, v12
    v_xor_b32 v13, v13, v12
    v_xor_b32 v14, 2000, v13
    v_add_u32 v13, s68, v13
    v_add_u32 v14, s68, v14
    v_xor_b32 v20, 16, v13
    v_xor_b32 v21, 16, v14
    v_and_b32 v22, 8, v0
    v_lshlrev_b32 v22, 1, v22
    v_xor_b32 v22, v22, v3
    v_add_u32 v22, s68, v22
    v_xor_b32 v23, 32, v22
    s_mov_b32 s83, 0
    s_cmp_ge_u32 s35, 14
    s_cbranch_scc1 f_p2c
    s_waitcnt vmcnt(5)
f_p2e:
    v_xor_b32 v248, v8, v248
    v_xor_b32 v249, v9, v249
    v_xor_b32 v250, v10, v250
    v_xor_b32 v251, v11, v251
    v_xor_b32 v252, v8, v252
    v_xor_b32 v253, v9, v253
    v_xor_b32 v254, v10, v254
    v_xor_b32 v255, v11, v255
    v_xor_b32 v136, v8, v136
    v_xor_b32 v137, v9, v137
    v_xor_b32 v138, v10, v138
    v_xor_b32 v139, v11, v139
    v_or3_b32 v12, v248, v249, 0
    v_or3_b32 v12, v250, v251, v12
    v_or3_b32 v12, v252, v253, v12
    v_or3_b32 v12, v254, v255, v12
    v_or3_b32 v12, v136, v137, v12
    v_or3_b32 v12, v138, v139, v12
    v_and_b32 v12, 0xff, v12
    v_cmp_ne_u32 vcc, 0, v12
    s_cbranch_vccnz f_p2r
f_p2w:
    ds_write_b128 v4, v[248:251] offset:36864
    ds_write_b128 v4, v[252:255] offset:37888
    ds_write_b128 v4, v[136:139] offset:38912
    s_waitcnt lgkmcnt(0)
    s_barrier
    v_not_b32 v24, v8
    v_bfe_u32 v7, v0, 4, 2
    v_lshlrev_b32 v7, 13, v7
    v_and_b32 v25, 0x70, v3
    v_add_u32 v7, v7, v25
    s_and_b32 s42, s35, 1
    s_lshl_b32 s42, s42, 3
    s_add_u32 s42, s42, s16
    s_lshl_b32 s42, s42, 15
    s_lshl_b32 s43, s17, 7
    s_add_u32 s42, s42, s43
    s_add_u32 s42, s42, 17825792
    s_cmp_ge_u32 s35, 14
    s_cbranch_scc1 f_npw
    s_mov_b32 exec_lo, 0x00ff00ff
    s_mov_b32 exec_hi, 0x00ff00ff
    buffer_store_dwordx4 v[24:27], v7, s[12:15], s42 offen sc1
    s_mov_b64 exec, -1
f_npw:
    ds_read_b128 v[88:91], v3 offset:36864
    ds_read_b128 v[92:95], v3 offset:37888
    ds_read_b128 v[96:99], v3 offset:38912
    ds_read_b128 v[100:103], v3 offset:39936
    ds_read_b128 v[136:139], v3 offset:45056
    ds_read_b128 v[140:143], v3 offset:46080
    ds_read_b128 v[144:147], v3 offset:47104
    ds_read_b128 v[148:151], v3 offset:48128
    ds_read_b128 v[184:187], v3 offset:53248
    ds_read_b128 v[188:191], v3 offset:54272
    ds_read_b128 v[192:195], v3 offset:55296
    ds_read_b128 v[196:199], v3 offset:56320
    s_waitcnt lgkmcnt(4)
    v_pk_fma_f32 v[56:57], v[56:57], v[88:89], v[136:137]
    v_pk_fma_f32 v[58:59], v[58:59], v[90:91], v[138:139]
    v_pk_fma_f32 v[60:61], v[60:61], v[92:93], v[140:141]
    v_pk_fma_f32 v[62:63], v[62:63], v[94:95], v[142:143]
    v_pk_fma_f32 v[64:65], v[64:65], v[96:97], v[144:145]
    v_pk_fma_f32 v[66:67], v[66:67], v[98:99], v[146:147]
    v_pk_fma_f32 v[68:69], v[68:69], v[100:101], v[148:149]
    v_pk_fma_f32 v[70:71], v[70:71], v[102:103], v[150:151]
    s_waitcnt lgkmcnt(0)
    ds_read_b128 v[120:123], v3 offset:40960
    ds_read_b128 v[124:127], v3 offset:41984
    ds_read_b128 v[128:131], v3 offset:43008
    ds_read_b128 v[132:135], v3 offset:44032
    ds_read_b128 v[104:107], v3 offset:49152
    ds_read_b128 v[108:111], v3 offset:50176
    ds_read_b128 v[112:115], v3 offset:51200
    ds_read_b128 v[116:119], v3 offset:52224
    ds_read_b128 v[200:203], v3 offset:57344
    ds_read_b128 v[204:207], v3 offset:58368
    ds_read_b128 v[208:211], v3 offset:59392
    ds_read_b128 v[212:215], v3 offset:60416
    v_pk_fma_f32 v[152:153], v[184:185], v[56:57], v[152:153]
    v_pk_fma_f32 v[154:155], v[186:187], v[58:59], v[154:155]
    v_pk_fma_f32 v[156:157], v[188:189], v[60:61], v[156:157]
    v_pk_fma_f32 v[158:159], v[190:191], v[62:63], v[158:159]
    v_pk_fma_f32 v[160:161], v[192:193], v[64:65], v[160:161]
    v_pk_fma_f32 v[162:163], v[194:195], v[66:67], v[162:163]
    v_pk_fma_f32 v[164:165], v[196:197], v[68:69], v[164:165]
    v_pk_fma_f32 v[166:167], v[198:199], v[70:71], v[166:167]
    v_cvt_pk_bf16_f32 v216, v152, v153
    v_cvt_pk_bf16_f32 v217, v154, v155
    v_cvt_pk_bf16_f32 v218, v156, v157
    v_cvt_pk_bf16_f32 v219, v158, v159
    v_cvt_pk_bf16_f32 v220, v160, v161
    v_cvt_pk_bf16_f32 v221, v162, v163
    v_cvt_pk_bf16_f32 v222, v164, v165
    v_cvt_pk_bf16_f32 v223, v166, v167
    ds_write_b128 v13, v[216:219] offset:0
    ds_write_b128 v20, v[220:223] offset:0
    s_waitcnt lgkmcnt(6)
    v_pk_fma_f32 v[72:73], v[72:73], v[120:121], v[104:105]
    v_pk_fma_f32 v[74:75], v[74:75], v[122:123], v[106:107]
    v_pk_fma_f32 v[76:77], v[76:77], v[124:125], v[108:109]
    v_pk_fma_f32 v[78:79], v[78:79], v[126:127], v[110:111]
    v_pk_fma_f32 v[80:81], v[80:81], v[128:129], v[112:113]
    v_pk_fma_f32 v[82:83], v[82:83], v[130:131], v[114:115]
    v_pk_fma_f32 v[84:85], v[84:85], v[132:133], v[116:117]
    v_pk_fma_f32 v[86:87], v[86:87], v[134:135], v[118:119]
    s_waitcnt lgkmcnt(2)
    v_pk_fma_f32 v[168:169], v[200:201], v[72:73], v[168:169]
    v_pk_fma_f32 v[170:171], v[202:203], v[74:75], v[170:171]
    v_pk_fma_f32 v[172:173], v[204:205], v[76:77], v[172:173]
    v_pk_fma_f32 v[174:175], v[206:207], v[78:79], v[174:175]
    v_pk_fma_f32 v[176:177], v[208:209], v[80:81], v[176:177]
    v_pk_fma_f32 v[178:179], v[210:211], v[82:83], v[178:179]
    v_pk_fma_f32 v[180:181], v[212:213], v[84:85], v[180:181]
    v_pk_fma_f32 v[182:183], v[214:215], v[86:87], v[182:183]
    v_cvt_pk_bf16_f32 v224, v168, v183
    v_cvt_pk_bf16_f32 v225, v182, v181
    v_cvt_pk_bf16_f32 v226, v180, v179
    v_cvt_pk_bf16_f32 v227, v178, v177
    v_cvt_pk_bf16_f32 v228, v176, v175
    v_cvt_pk_bf16_f32 v229, v174, v173
    v_cvt_pk_bf16_f32 v230, v172, v171
    v_cvt_pk_bf16_f32 v231, v170, v169
    ds_write_b128 v14, v[224:227] offset:2048
    ds_write_b128 v21, v[228:231] offset:2048
    s_waitcnt lgkmcnt(0)
    ds_read_b128 v[232:235], v22 offset:0
    ds_read_b128 v[236:239], v23 offset:1024
    ds_read_b128 v[240:243], v22 offset:2048
    ds_read_b128 v[244:247], v23 offset:3072
    v_lshrrev_b32 v144, 2, v2
    v_and_b32 v145, 7, v144
    v_and_b32 v146, 3, v0
    v_lshl_add_u32 v148, v1, 2, v146
    v_xor_b32 v148, v148, v145
    v_lshlrev_b32 v148, 5, v148
    v_lshl_add_u32 v148, v144, 10, v148
    v_add_u32 v148, 94208, v148
    v_cmp_eq_u32 s[44:45], 1, v146
    v_cmp_eq_u32 s[46:47], 2, v146
    v_cmp_eq_u32 s[72:73], 3, v146
    v_bfe_u32 v145, v0, 4, 2
    v_and_b32 v144, 1, v144
    v_lshlrev_b32 v153, 7, v144
    v_lshl_add_u32 v153, v145, 4, v153
    v_add_u32 v153, 159872, v153
    v_lshlrev_b32 v154, 4, v146
    v_lshl_add_u32 v154, v144, 6, v154
    v_lshl_add_u32 v154, v1, 15, v154
    v_lshl_add_u32 v154, v145, 13, v154
    v_and_b32 v144, 15, v0
    v_lshlrev_b32 v152, 1, v144
    v_lshl_add_u32 v152, v1, 5, v152
    v_lshl_add_u32 v152, v145, 7, v152
    v_add_u32 v152, 159872, v152
    s_and_b32 s76, s35, 1
    s_lshl_b32 s76, s76, 18
    s_lshl_b32 s77, s17, 7
    s_add_u32 s76, s76, s77
    s_add_u32 s76, s76, 17825792
    s_movk_i32 s77, 0xff00
    s_lshl_b32 s81, s17, 2
    s_and_b32 s42, s16, 3
    s_add_u32 s81, s81, s42
    s_lshl_b32 s81, s81, 10
    s_add_u32 s82, s81, 18612224
    s_add_u32 s81, s81, 18350080
    v_mov_b32 v5, 159848
    s_waitcnt vmcnt(0)
    s_barrier
    ds_read_b64_tr_b16 v[88:89], v148 offset:0
    ds_read_b64_tr_b16 v[90:91], v148 offset:16384
    ds_read_b64_tr_b16 v[92:93], v148 offset:8
    ds_read_b64_tr_b16 v[94:95], v148 offset:16392
    ds_read_b64_tr_b16 v[96:97], v148 offset:16
    ds_read_b64_tr_b16 v[98:99], v148 offset:16400
    ds_read_b64_tr_b16 v[100:101], v148 offset:24
    ds_read_b64_tr_b16 v[102:103], v148 offset:16408
    ds_read_b64_tr_b16 v[104:105], v148 offset:32768
    ds_read_b64_tr_b16 v[106:107], v148 offset:49152
    ds_read_b64_tr_b16 v[108:109], v148 offset:32776
    ds_read_b64_tr_b16 v[110:111], v148 offset:49160
    ds_read_b64_tr_b16 v[112:113], v148 offset:32784
    ds_read_b64_tr_b16 v[114:115], v148 offset:49168
    ds_read_b64_tr_b16 v[116:117], v148 offset:32792
    ds_read_b64_tr_b16 v[118:119], v148 offset:49176
    v_lshlrev_b32 v40, 13, v2
    s_lshl_b32 s74, s34, 14
    s_add_u32 s74, s74, 17436672
    s_min_u32 s75, s62, s63
    s_cmp_ge_u32 s35, 14
    s_cbranch_scc1 f_na
    s_cmp_ge_u32 s16, 4
    s_cbranch_scc1 f_na
    s_mov_b32 s83, 0
f_px:
    s_and_b32 s42, s83, 63
    s_cmp_eq_u32 s42, 63
    s_cselect_b32 s42, s82, s81
    buffer_load_dwordx4 v[144:147], v3, s[12:15], s42 offen sc1
    s_add_u32 s83, s83, 1
    s_cmp_ge_u32 s83, 0x40000
    s_cselect_b32 s43, 0, 0xff
    s_waitcnt vmcnt(0)
    s_cbranch_scc1 f_pxx
    v_cmp_ne_u16_sdwa vcc, v147, v11 src0_sel:BYTE_0 src1_sel:DWORD
    s_cbranch_vccnz f_px
f_pxx:
    v_xor_b32 v144, v8, v144
    v_xor_b32 v145, v9, v145
    v_xor_b32 v146, v10, v146
    v_xor_b32 v147, v11, v147
    v_or3_b32 v4, v144, v145, v146
    v_or_b32 v4, v4, v147
    v_permlane32_swap_b32 v144, v146
    v_permlane32_swap_b32 v145, v147
    v_pk_add_f32 v[144:145], v[144:145], v[146:147]
    v_and_b32 v4, s43, v4
    v_cmp_ne_u32 vcc, 0, v4
    v_permlane16_swap_b32 v144, v145
    s_cbranch_vccnz f_px
    v_add_f32 v144, v144, v145
    v_cvt_pk_bf16_f32 v144, v144, v144
    v_lshlrev_b32 v144, 16, v144
    v_mul_f32 v145, 0xbfb8aa3b, v144
    v_exp_f32 v145, v145
    v_mov_b32 v146, v144
    v_add_f32 v145, 1.0, v145
    v_rcp_f32 v145, v145
    v_mov_b32 v147, v144
    v_mul_f32 v145, v144, v145
    s_nop 0
    v_permlane32_swap_b32 v146, v147
    v_cvt_pk_bf16_f32 v145, v145, v145
    v_lshlrev_b32 v145, 16, v145
    v_mul_f32 v145, v145, v147
    v_cvt_pk_bf16_f32 v145, v145, v145
    ds_write_b16 v152, v145
f_na:
    s_waitcnt lgkmcnt(0)
    s_barrier
    s_cmp_ge_u32 s35, 14
    s_cbranch_scc1 f_fin
    ds_read_b128 v[120:123], v153 offset:0
    ds_read_b128 v[124:127], v153 offset:64
    s_mov_b64 exec, 3
    buffer_load_dwordx4 v[32:35], v40, s[12:15], s74 offen sc1
    s_mov_b64 exec, -1
    s_waitcnt lgkmcnt(1)
    v_mfma_f32_16x16x32_bf16 v[128:131], v[88:91], v[120:123], 0
    v_mfma_f32_16x16x32_bf16 v[132:135], v[92:95], v[120:123], 0
    s_waitcnt lgkmcnt(0)
    v_mfma_f32_16x16x32_bf16 v[128:131], v[104:107], v[124:127], v[128:131]
    v_mfma_f32_16x16x32_bf16 v[132:135], v[108:111], v[124:127], v[132:135]
    v_mfma_f32_16x16x32_bf16 v[136:139], v[96:99], v[120:123], 0
    v_mfma_f32_16x16x32_bf16 v[140:143], v[100:103], v[120:123], 0
    v_mfma_f32_16x16x32_bf16 v[136:139], v[112:115], v[124:127], v[136:139]
    v_mfma_f32_16x16x32_bf16 v[140:143], v[116:119], v[124:127], v[140:143]
    s_mov_b32 exec_lo, 0x00ff00ff
    s_mov_b32 exec_hi, 0x00ff00ff
    s_nop 1
    v_cndmask_b32 v128, v128, v132, s[44:45]
    v_cndmask_b32 v129, v129, v133, s[44:45]
    v_cndmask_b32 v130, v130, v134, s[44:45]
    v_cndmask_b32 v131, v131, v135, s[44:45]
    v_cndmask_b32 v128, v128, v136, s[46:47]
    v_cndmask_b32 v129, v129, v137, s[46:47]
    v_cndmask_b32 v130, v130, v138, s[46:47]
    v_cndmask_b32 v131, v131, v139, s[46:47]
    v_cndmask_b32 v128, v128, v140, s[72:73]
    v_cndmask_b32 v129, v129, v141, s[72:73]
    v_cndmask_b32 v130, v130, v142, s[72:73]
    v_cndmask_b32 v131, v131, v143, s[72:73]
    v_and_or_b32 v128, v128, s77, v8
    v_and_or_b32 v129, v129, s77, v9
    v_and_or_b32 v130, v130, s77, v10
    v_and_or_b32 v131, v131, s77, v11
    buffer_store_dwordx4 v[128:131], v154, s[12:15], s76 offen sc1
    s_mov_b64 exec, -1
    s_barrier
f_fin:
    s_cmp_lt_u32 s75, 2
    s_cbranch_scc1 f_sel
    buffer_store_dwordx4 v[232:235], v3, s[24:27], s18 offen offset:0 sc1
    buffer_store_dwordx4 v[236:239], v3, s[24:27], s18 offen offset:1024 sc1
f_g0:
    buffer_store_dwordx4 v[240:243], v3, s[24:27], s19 offen offset:0 sc1
    buffer_store_dwordx4 v[244:247], v3, s[24:27], s19 offen offset:1024 sc1
f_g1:
f_end:
    s_endpgm
f_sel:
    s_mov_b32 s83, 0
    s_cmp_ge_u32 s35, 14
    s_cbranch_scc1 f_sr
    s_waitcnt vmcnt(1)
f_sc:
    v_cmp_ne_u64 vcc, s[32:33], v[32:33]
    v_readlane_b32 s40, v34, 0
    v_readlane_b32 s41, v34, 1
    s_and_b32 s42, vcc_lo, 3
    s_cbranch_scc0 f_sx
    s_sleep 4
f_sr:
    s_mov_b64 exec, 3
    buffer_load_dwordx4 v[32:35], v40, s[12:15], s74 offen sc1
    s_mov_b64 exec, -1
    s_waitcnt vmcnt(0)
    s_add_u32 s83, s83, 1
    s_cmp_lt_u32 s83, 0x40000
    s_cbranch_scc1 f_sc
f_sx:
    s_andn2_b32 s40, s40, 1
    s_andn2_b32 s41, s41, 1
    s_cmp_eq_u32 s60, s40
    s_cbranch_scc1 f_e0
    s_cmp_eq_u32 s60, s41
    s_cbranch_scc1 f_e0
    buffer_store_dwordx4 v[232:235], v3, s[24:27], s18 offen offset:0 sc1
    buffer_store_dwordx4 v[236:239], v3, s[24:27], s18 offen offset:1024 sc1
f_e0:
    s_cmp_eq_u32 s61, s40
    s_cbranch_scc1 f_e1
    s_cmp_eq_u32 s61, s41
    s_cbranch_scc1 f_e1
    buffer_store_dwordx4 v[240:243], v3, s[24:27], s19 offen offset:0 sc1
    buffer_store_dwordx4 v[244:247], v3, s[24:27], s19 offen offset:1024 sc1
f_e1:
    s_branch f_end
f_p2r:
    s_add_u32 s83, s83, 1
    s_cmp_ge_u32 s83, 0x40000
    s_cbranch_scc1 f_p2w
    s_sleep 12
    buffer_load_dwordx4 v[248:251], v3, s[12:15], s64 offen offset:0 sc1
    buffer_load_dwordx4 v[252:255], v3, s[12:15], s64 offen offset:1024 sc1
    buffer_load_dwordx4 v[136:139], v3, s[12:15], s64 offen offset:2048 sc1
f_p2c:
    s_waitcnt vmcnt(0)
    s_branch f_p2e
f_zr:
    v_or3_b32 v248, v40, v42, v44
    v_or_b32 v248, v248, v46
    v_and_b32 v248, s54, v248
    v_cmp_ne_u32 vcc, 0, v248
    s_cbranch_vccz f_zr0
    buffer_load_dwordx4 v[24:27], v3, s[12:15], s72 offen offset:0 sc1
f_zr0:
    v_or3_b32 v248, v41, v43, v45
    v_or_b32 v248, v248, v47
    v_and_b32 v248, s54, v248
    v_cmp_ne_u32 vcc, 0, v248
    s_cbranch_vccz f_zr1
    buffer_load_dwordx4 v[28:31], v3, s[12:15], s72 offen offset:1024 sc1
f_zr1:
    v_or3_b32 v248, v48, v50, v52
    v_or_b32 v248, v248, v54
    v_and_b32 v248, s54, v248
    v_cmp_ne_u32 vcc, 0, v248
    s_cbranch_vccz f_zr2
    buffer_load_dwordx4 v[32:35], v3, s[12:15], s72 offen offset:2048 sc1
f_zr2:
    v_or3_b32 v248, v49, v51, v53
    v_or_b32 v248, v248, v55
    v_and_b32 v248, s54, v248
    v_cmp_ne_u32 vcc, 0, v248
    s_cbranch_vccz f_zr3
    buffer_load_dwordx4 v[36:39], v3, s[12:15], s72 offen offset:3072 sc1
f_zr3:
    s_waitcnt vmcnt(0)
    s_add_u32 s83, s83, 1
    s_cmp_lt_u32 s83, 0x40000
    s_cbranch_scc1 f_zc
    s_branch f_zx
f_r0:
    s_cmp_ge_u32 s3, 8
    s_cbranch_scc1 f_rb
    s_bitcmp0_b32 s30, 7
    s_cbranch_scc1 f_ra
    s_mov_b32 m0, s68
    s_nop 0
    buffer_load_dwordx4 v3, s[8:11], s18 offen offset:0 lds
    buffer_load_dwordx4 v3, s[8:11], s18 offen offset:1024 lds
    s_branch f_nr
f_rb:
    ds_write_b128 v248, v[72:75] offset:0
    ds_write_b128 v248, v[76:79] offset:1024
    s_branch f_nr
f_sb1:
    s_cmp_ge_u32 s83, 0x40000
    s_cbranch_scc1 f_stx
    v_add_u32 v84, 160768, v3
    s_mov_b64 exec, 0xff
    ds_read_b128 v[80:83], v84
    s_waitcnt lgkmcnt(0)
    buffer_store_dwordx4 v[80:83], v3, s[12:15], s63 offen sc1
    s_mov_b64 exec, -1
    s_add_u32 s42, s71, 32768
    s_mov_b32 exec_lo, 0x000f000f
    s_mov_b32 exec_hi, 0x000f000f
    buffer_load_dwordx4 v[24:27], v7, s[12:15], s42 offen sc1
    s_branch f_st
f_pr:
    s_sleep 6
    v_mov_b32 v196, v8
    v_mov_b32 v197, v9
    v_mov_b32 v198, v10
    v_mov_b32 v199, v11
    s_mov_b64 exec, 0xf0ff
    buffer_load_dwordx4 v[236:239], v17, s[12:15], s77 offen sc1
    s_mov_b64 exec, s[52:53]
    buffer_load_dwordx4 v[196:199], v3, s[12:15], s76 offen sc1
    s_mov_b64 exec, -1
    buffer_load_dwordx4 v[192:195], v3, s[12:15], s65 offen sc1
    buffer_load_dwordx4 v[184:187], v3, s[12:15], s64 offen offset:0 sc1
    buffer_load_dwordx4 v[188:191], v3, s[12:15], s64 offen offset:1024 sc1
    s_waitcnt vmcnt(0)
    s_add_u32 s83, s83, 1
    s_cmp_lt_u32 s83, 0x40000
    s_cbranch_scc1 f_pv
    s_waitcnt vmcnt(0)
    s_branch f_pw
f_ps:
    s_sub_u32 s45, 5, s42
    v_ldexp_f32 v196, v196, s45
    v_ldexp_f32 v197, v197, s45
    v_ldexp_f32 v198, v198, s45
    v_ldexp_f32 v199, v199, s45
    v_and_b32 v248, 0x3f0, v235
    v_bfe_u32 v249, v235, 10, 1
    v_lshl_add_u32 v248, v249, 11, v248
    v_bfe_u32 v249, v235, 3, 1
    v_lshl_add_u32 v248, v249, 10, v248
    v_and_b32 v249, 6, v235
    v_lshl_add_u32 v248, v249, 1, v248
    v_cvt_f16_f32 v196, v196
    ds_write_b32 v248, v196 offset:0
    v_cvt_f16_f32 v197, v197
    ds_write_b32 v248, v197 offset:16
    v_cvt_f16_f32 v198, v198
    ds_write_b32 v248, v198 offset:32
    v_cvt_f16_f32 v199, v199
    ds_write_b32 v248, v199 offset:48
    s_branch f_pvx
f_qr:
    s_sleep 6
    buffer_load_dwordx4 v[184:187], v3, s[12:15], s64 offen offset:0 sc1
    buffer_load_dwordx4 v[188:191], v3, s[12:15], s64 offen offset:1024 sc1
    s_add_u32 s83, s83, 1
    s_cmp_lt_u32 s83, 0x40000
    s_cbranch_scc1 f_qv
    s_waitcnt vmcnt(0)
    s_branch f_pvx
f_slow2:
    v_cvt_pk_bf16_f32 v40, v152, v153
    v_lshlrev_b32 v152, 16, v40
    v_and_b32 v153, 0xffff0000, v40
    v_cvt_pk_bf16_f32 v40, v154, v155
    v_lshlrev_b32 v154, 16, v40
    v_and_b32 v155, 0xffff0000, v40
    v_cvt_pk_bf16_f32 v40, v156, v157
    v_lshlrev_b32 v156, 16, v40
    v_and_b32 v157, 0xffff0000, v40
    v_cvt_pk_bf16_f32 v40, v158, v159
    v_lshlrev_b32 v158, 16, v40
    v_and_b32 v159, 0xffff0000, v40
    v_cvt_pk_bf16_f32 v40, v160, v161
    v_lshlrev_b32 v160, 16, v40
    v_and_b32 v161, 0xffff0000, v40
    v_cvt_pk_bf16_f32 v40, v162, v163
    v_lshlrev_b32 v162, 16, v40
    v_and_b32 v163, 0xffff0000, v40
    v_cvt_pk_bf16_f32 v40, v164, v165
    v_lshlrev_b32 v164, 16, v40
    v_and_b32 v165, 0xffff0000, v40
    v_cvt_pk_bf16_f32 v40, v166, v167
    v_lshlrev_b32 v166, 16, v40
    v_and_b32 v167, 0xffff0000, v40
    v_pk_add_f32 v[40:41], v[152:153], v[154:155]
    v_pk_add_f32 v[40:41], v[40:41], v[156:157]
    v_pk_add_f32 v[40:41], v[40:41], v[158:159]
    v_pk_add_f32 v[40:41], v[40:41], v[160:161]
    v_pk_add_f32 v[40:41], v[40:41], v[162:163]
    v_pk_add_f32 v[40:41], v[40:41], v[164:165]
    v_pk_add_f32 v[40:41], v[40:41], v[166:167]
    v_cvt_pk_bf16_f32 v48, v168, v169
    v_lshlrev_b32 v168, 16, v48
    v_and_b32 v169, 0xffff0000, v48
    v_cvt_pk_bf16_f32 v48, v170, v171
    v_lshlrev_b32 v170, 16, v48
    v_and_b32 v171, 0xffff0000, v48
    v_cvt_pk_bf16_f32 v48, v172, v173
    v_lshlrev_b32 v172, 16, v48
    v_and_b32 v173, 0xffff0000, v48
    v_cvt_pk_bf16_f32 v48, v174, v175
    v_lshlrev_b32 v174, 16, v48
    v_and_b32 v175, 0xffff0000, v48
    v_cvt_pk_bf16_f32 v48, v176, v177
    v_lshlrev_b32 v176, 16, v48
    v_and_b32 v177, 0xffff0000, v48
    v_cvt_pk_bf16_f32 v48, v178, v179
    v_lshlrev_b32 v178, 16, v48
    v_and_b32 v179, 0xffff0000, v48
    v_cvt_pk_bf16_f32 v48, v180, v181
    v_lshlrev_b32 v180, 16, v48
    v_and_b32 v181, 0xffff0000, v48
    v_cvt_pk_bf16_f32 v48, v182, v183
    v_lshlrev_b32 v182, 16, v48
    v_and_b32 v183, 0xffff0000, v48
    v_pk_add_f32 v[48:49], v[168:169], v[170:171]
    v_pk_add_f32 v[48:49], v[48:49], v[172:173]
    v_pk_add_f32 v[48:49], v[48:49], v[174:175]
    v_pk_add_f32 v[48:49], v[48:49], v[176:177]
    v_pk_add_f32 v[48:49], v[48:49], v[178:179]
    v_pk_add_f32 v[48:49], v[48:49], v[180:181]
    v_pk_add_f32 v[48:49], v[48:49], v[182:183]
    v_add_f32 v24, v40, v41
    v_add_f32 v28, v48, v49
    s_nop 1
    v_permlane32_swap_b32 v24, v28
    v_add_f32 v24, v24, v28
    s_nop 1
    v_add_f32_dpp v24, v24, v24 row_ror:8 row_mask:0xf bank_mask:0xf
    s_nop 1
    v_add_f32_dpp v24, v24, v24 row_ror:4 row_mask:0xf bank_mask:0xf
    s_nop 1
    v_add_f32_dpp v24, v24, v24 row_ror:2 row_mask:0xf bank_mask:0xf
    s_nop 1
    v_add_f32_dpp v24, v24, v24 row_ror:1 row_mask:0xf bank_mask:0xf
    s_nop 1
    v_add_f32_dpp v24, v24, v24 row_bcast:15 row_mask:0xa bank_mask:0xf
    v_mul_f32 v27, 0x3a800000, v24
    v_cvt_pk_bf16_f32 v24, v27, v27
    v_lshlrev_b32 v24, 16, v24
    v_sub_f32 v27, v27, v24
    v_readlane_b32 s56, v24, 31
    v_readlane_b32 s58, v24, 63
    s_nop 0
    v_pk_add_f32 v[56:57], v[152:153], s[56:57] op_sel:[0,0] op_sel_hi:[1,0] neg_lo:[0,1] neg_hi:[0,1]
    v_pk_add_f32 v[58:59], v[154:155], s[56:57] op_sel:[0,0] op_sel_hi:[1,0] neg_lo:[0,1] neg_hi:[0,1]
    v_pk_add_f32 v[60:61], v[156:157], s[56:57] op_sel:[0,0] op_sel_hi:[1,0] neg_lo:[0,1] neg_hi:[0,1]
    v_pk_add_f32 v[62:63], v[158:159], s[56:57] op_sel:[0,0] op_sel_hi:[1,0] neg_lo:[0,1] neg_hi:[0,1]
    v_pk_add_f32 v[64:65], v[160:161], s[56:57] op_sel:[0,0] op_sel_hi:[1,0] neg_lo:[0,1] neg_hi:[0,1]
    v_pk_add_f32 v[66:67], v[162:163], s[56:57] op_sel:[0,0] op_sel_hi:[1,0] neg_lo:[0,1] neg_hi:[0,1]
    v_pk_add_f32 v[68:69], v[164:165], s[56:57] op_sel:[0,0] op_sel_hi:[1,0] neg_lo:[0,1] neg_hi:[0,1]
    v_pk_add_f32 v[70:71], v[166:167], s[56:57] op_sel:[0,0] op_sel_hi:[1,0] neg_lo:[0,1] neg_hi:[0,1]
    v_pk_add_f32 v[72:73], v[168:169], s[58:59] op_sel:[0,0] op_sel_hi:[1,0] neg_lo:[0,1] neg_hi:[0,1]
    v_pk_add_f32 v[74:75], v[170:171], s[58:59] op_sel:[0,0] op_sel_hi:[1,0] neg_lo:[0,1] neg_hi:[0,1]
    v_pk_add_f32 v[76:77], v[172:173], s[58:59] op_sel:[0,0] op_sel_hi:[1,0] neg_lo:[0,1] neg_hi:[0,1]
    v_pk_add_f32 v[78:79], v[174:175], s[58:59] op_sel:[0,0] op_sel_hi:[1,0] neg_lo:[0,1] neg_hi:[0,1]
    v_pk_add_f32 v[80:81], v[176:177], s[58:59] op_sel:[0,0] op_sel_hi:[1,0] neg_lo:[0,1] neg_hi:[0,1]
    v_pk_add_f32 v[82:83], v[178:179], s[58:59] op_sel:[0,0] op_sel_hi:[1,0] neg_lo:[0,1] neg_hi:[0,1]
    v_pk_add_f32 v[84:85], v[180:181], s[58:59] op_sel:[0,0] op_sel_hi:[1,0] neg_lo:[0,1] neg_hi:[0,1]
    v_pk_add_f32 v[86:87], v[182:183], s[58:59] op_sel:[0,0] op_sel_hi:[1,0] neg_lo:[0,1] neg_hi:[0,1]
    v_mov_b32 v31, v30
    v_pk_mul_f32 v[42:43], v[70:71], v[70:71]
    v_pk_mul_f32 v[44:45], v[70:71], v[230:231]
    v_pk_mul_f32 v[50:51], v[86:87], v[86:87]
    v_pk_mul_f32 v[52:53], v[86:87], v[246:247]
    v_pk_fma_f32 v[42:43], v[68:69], v[68:69], v[42:43]
    v_pk_fma_f32 v[44:45], v[68:69], v[228:229], v[44:45]
    v_pk_fma_f32 v[50:51], v[84:85], v[84:85], v[50:51]
    v_pk_fma_f32 v[52:53], v[84:85], v[244:245], v[52:53]
    v_pk_fma_f32 v[42:43], v[66:67], v[66:67], v[42:43]
    v_pk_fma_f32 v[44:45], v[66:67], v[226:227], v[44:45]
    v_pk_fma_f32 v[50:51], v[82:83], v[82:83], v[50:51]
    v_pk_fma_f32 v[52:53], v[82:83], v[242:243], v[52:53]
    v_pk_fma_f32 v[42:43], v[64:65], v[64:65], v[42:43]
    v_pk_fma_f32 v[44:45], v[64:65], v[224:225], v[44:45]
    v_pk_fma_f32 v[50:51], v[80:81], v[80:81], v[50:51]
    v_pk_fma_f32 v[52:53], v[80:81], v[240:241], v[52:53]
    v_pk_fma_f32 v[42:43], v[62:63], v[62:63], v[42:43]
    v_pk_fma_f32 v[44:45], v[62:63], v[222:223], v[44:45]
    v_pk_fma_f32 v[50:51], v[78:79], v[78:79], v[50:51]
    v_pk_fma_f32 v[52:53], v[78:79], v[238:239], v[52:53]
    v_pk_fma_f32 v[42:43], v[60:61], v[60:61], v[42:43]
    v_pk_fma_f32 v[44:45], v[60:61], v[220:221], v[44:45]
    v_pk_fma_f32 v[50:51], v[76:77], v[76:77], v[50:51]
    v_pk_fma_f32 v[52:53], v[76:77], v[236:237], v[52:53]
    v_pk_fma_f32 v[42:43], v[58:59], v[58:59], v[42:43]
    v_pk_fma_f32 v[44:45], v[58:59], v[218:219], v[44:45]
    v_pk_fma_f32 v[50:51], v[74:75], v[74:75], v[50:51]
    v_pk_fma_f32 v[52:53], v[74:75], v[234:235], v[52:53]
    v_pk_fma_f32 v[42:43], v[56:57], v[56:57], v[42:43]
    v_pk_fma_f32 v[44:45], v[56:57], v[216:217], v[44:45]
    v_pk_fma_f32 v[50:51], v[72:73], v[72:73], v[50:51]
    v_pk_fma_f32 v[52:53], v[72:73], v[232:233], v[52:53]
    v_add_f32 v25, v42, v43
    v_add_f32 v26, v44, v45
    v_add_f32 v29, v50, v51
    v_add_f32 v30, v52, v53
    s_nop 0
    v_permlane32_swap_b32 v25, v29
    v_permlane32_swap_b32 v26, v30
    v_add_f32 v25, v25, v29
    v_add_f32 v26, v26, v30
    s_nop 0
    v_add_f32_dpp v25, v25, v25 row_ror:8 row_mask:0xf bank_mask:0xf
    v_add_f32_dpp v26, v26, v26 row_ror:8 row_mask:0xf bank_mask:0xf
    s_nop 0
    v_add_f32_dpp v25, v25, v25 row_ror:4 row_mask:0xf bank_mask:0xf
    v_add_f32_dpp v26, v26, v26 row_ror:4 row_mask:0xf bank_mask:0xf
    s_nop 0
    v_add_f32_dpp v25, v25, v25 row_ror:2 row_mask:0xf bank_mask:0xf
    v_add_f32_dpp v26, v26, v26 row_ror:2 row_mask:0xf bank_mask:0xf
    s_nop 0
    v_add_f32_dpp v25, v25, v25 row_ror:1 row_mask:0xf bank_mask:0xf
    v_add_f32_dpp v26, v26, v26 row_ror:1 row_mask:0xf bank_mask:0xf
    s_nop 0
    v_add_f32_dpp v25, v25, v25 row_bcast:15 row_mask:0xa bank_mask:0xf
    v_add_f32_dpp v26, v26, v26 row_bcast:15 row_mask:0xa bank_mask:0xf
    v_mul_f32 v25, 0x3a800000, v25
    v_fma_f32 v25, -v27, v27, v25
    v_max_f32 v25, 0, v25
    v_mov_b32 v30, v31
    s_branch f_var2
f_slowvar:
    v_lshlrev_b32 v118, 16, v117
    s_nop 0
    v_readlane_b32 s44, v118, 31
    v_readlane_b32 s46, v118, 63
    v_lshlrev_b32 v120, 16, v64
    v_and_b32 v121, 0xffff0000, v64
    v_pk_add_f32 v[120:121], v[120:121], s[44:45] op_sel_hi:[1,0]
    v_pk_mul_f32 v[122:123], v[120:121], v[120:121]
    v_lshlrev_b32 v120, 16, v65
    v_and_b32 v121, 0xffff0000, v65
    v_pk_add_f32 v[120:121], v[120:121], s[44:45] op_sel_hi:[1,0]
    v_pk_fma_f32 v[122:123], v[120:121], v[120:121], v[122:123]
    v_lshlrev_b32 v120, 16, v66
    v_and_b32 v121, 0xffff0000, v66
    v_pk_add_f32 v[120:121], v[120:121], s[44:45] op_sel_hi:[1,0]
    v_pk_fma_f32 v[122:123], v[120:121], v[120:121], v[122:123]
    v_lshlrev_b32 v120, 16, v67
    v_and_b32 v121, 0xffff0000, v67
    v_pk_add_f32 v[120:121], v[120:121], s[44:45] op_sel_hi:[1,0]
    v_pk_fma_f32 v[122:123], v[120:121], v[120:121], v[122:123]
    v_lshlrev_b32 v120, 16, v68
    v_and_b32 v121, 0xffff0000, v68
    v_pk_add_f32 v[120:121], v[120:121], s[44:45] op_sel_hi:[1,0]
    v_pk_fma_f32 v[122:123], v[120:121], v[120:121], v[122:123]
    v_lshlrev_b32 v120, 16, v69
    v_and_b32 v121, 0xffff0000, v69
    v_pk_add_f32 v[120:121], v[120:121], s[44:45] op_sel_hi:[1,0]
    v_pk_fma_f32 v[122:123], v[120:121], v[120:121], v[122:123]
    v_lshlrev_b32 v120, 16, v70
    v_and_b32 v121, 0xffff0000, v70
    v_pk_add_f32 v[120:121], v[120:121], s[44:45] op_sel_hi:[1,0]
    v_pk_fma_f32 v[122:123], v[120:121], v[120:121], v[122:123]
    v_lshlrev_b32 v120, 16, v71
    v_and_b32 v121, 0xffff0000, v71
    v_pk_add_f32 v[120:121], v[120:121], s[44:45] op_sel_hi:[1,0]
    v_pk_fma_f32 v[122:123], v[120:121], v[120:121], v[122:123]
    v_add_f32 v110, v122, v123
    v_lshlrev_b32 v120, 16, v72
    v_and_b32 v121, 0xffff0000, v72
    v_pk_add_f32 v[120:121], v[120:121], s[46:47] op_sel_hi:[1,0]
    v_pk_mul_f32 v[122:123], v[120:121], v[120:121]
    v_lshlrev_b32 v120, 16, v73
    v_and_b32 v121, 0xffff0000, v73
    v_pk_add_f32 v[120:121], v[120:121], s[46:47] op_sel_hi:[1,0]
    v_pk_fma_f32 v[122:123], v[120:121], v[120:121], v[122:123]
    v_lshlrev_b32 v120, 16, v74
    v_and_b32 v121, 0xffff0000, v74
    v_pk_add_f32 v[120:121], v[120:121], s[46:47] op_sel_hi:[1,0]
    v_pk_fma_f32 v[122:123], v[120:121], v[120:121], v[122:123]
    v_lshlrev_b32 v120, 16, v75
    v_and_b32 v121, 0xffff0000, v75
    v_pk_add_f32 v[120:121], v[120:121], s[46:47] op_sel_hi:[1,0]
    v_pk_fma_f32 v[122:123], v[120:121], v[120:121], v[122:123]
    v_lshlrev_b32 v120, 16, v76
    v_and_b32 v121, 0xffff0000, v76
    v_pk_add_f32 v[120:121], v[120:121], s[46:47] op_sel_hi:[1,0]
    v_pk_fma_f32 v[122:123], v[120:121], v[120:121], v[122:123]
    v_lshlrev_b32 v120, 16, v77
    v_and_b32 v121, 0xffff0000, v77
    v_pk_add_f32 v[120:121], v[120:121], s[46:47] op_sel_hi:[1,0]
    v_pk_fma_f32 v[122:123], v[120:121], v[120:121], v[122:123]
    v_lshlrev_b32 v120, 16, v78
    v_and_b32 v121, 0xffff0000, v78
    v_pk_add_f32 v[120:121], v[120:121], s[46:47] op_sel_hi:[1,0]
    v_pk_fma_f32 v[122:123], v[120:121], v[120:121], v[122:123]
    v_lshlrev_b32 v120, 16, v79
    v_and_b32 v121, 0xffff0000, v79
    v_pk_add_f32 v[120:121], v[120:121], s[46:47] op_sel_hi:[1,0]
    v_pk_fma_f32 v[122:123], v[120:121], v[120:121], v[122:123]
    v_add_f32 v111, v122, v123
    v_add_f32 v118, v118, v108
    s_nop 0
    v_permlane32_swap_b32 v110, v111
    v_add_f32 v110, v110, v111
    s_nop 1
    v_add_f32_dpp v110, v110, v110 row_ror:8 row_mask:0xf bank_mask:0xf
    s_nop 1
    v_add_f32_dpp v110, v110, v110 row_ror:4 row_mask:0xf bank_mask:0xf
    s_nop 1
    v_add_f32_dpp v110, v110, v110 row_ror:2 row_mask:0xf bank_mask:0xf
    s_nop 1
    v_add_f32_dpp v110, v110, v110 row_ror:1 row_mask:0xf bank_mask:0xf
    s_nop 1
    v_add_f32_dpp v110, v110, v110 row_bcast:15 row_mask:0xa bank_mask:0xf
    v_mul_f32 v110, s5, v110
    v_fma_f32 v110, -v118, v118, v110
    v_max_f32 v110, 0, v110
    s_branch f_var
f_sp:
    s_setprio 3
    ds_read_b128 v[56:59], v3 offset:0
    ds_read_b128 v[60:63], v3 offset:1024
    ds_read_b128 v[64:67], v3 offset:2048
    ds_read_b128 v[68:71], v3 offset:3072
    v_and_b32 v12, 31, v0
    v_lshlrev_b32 v12, 2, v12
    v_and_b32 v17, 32, v0
    v_lshl_add_u32 v12, v17, 4, v12
    v_sub_u32 v20, 4096, v12
    v_add_u32 v12, 4096, v12
    v_add_u32 v17, 128, v12
    v_add_u32 v21, 128, v20
    s_waitcnt lgkmcnt(3)
    v_pk_fma_f16 v40, v24, v248, v56 op_sel:[0,0,0] op_sel_hi:[1,0,1]
    v_pk_fma_f16 v41, v25, v248, v57 op_sel:[0,1,0] op_sel_hi:[1,1,1]
    v_pk_fma_f16 v42, v26, v249, v58 op_sel:[0,0,0] op_sel_hi:[1,0,1]
    v_pk_fma_f16 v43, v27, v249, v59 op_sel:[0,1,0] op_sel_hi:[1,1,1]
    ds_write2st64_b32 v12, v40, v42 offset0:0 offset1:1
    ds_write2st64_b32 v17, v41, v43 offset0:0 offset1:1
    s_waitcnt lgkmcnt(4)
    v_pk_fma_f16 v44, v28, v250, v60 op_sel:[0,0,0] op_sel_hi:[1,0,1]
    v_pk_fma_f16 v45, v29, v250, v61 op_sel:[0,1,0] op_sel_hi:[1,1,1]
    v_pk_fma_f16 v46, v30, v251, v62 op_sel:[0,0,0] op_sel_hi:[1,0,1]
    v_pk_fma_f16 v47, v31, v251, v63 op_sel:[0,1,0] op_sel_hi:[1,1,1]
    ds_write2st64_b32 v12, v44, v46 offset0:4 offset1:5
    ds_write2st64_b32 v17, v45, v47 offset0:4 offset1:5
    s_waitcnt lgkmcnt(5)
    v_pk_fma_f16 v48, v32, v252, v64 op_sel:[0,0,0] op_sel_hi:[1,0,1]
    v_pk_fma_f16 v49, v33, v252, v65 op_sel:[0,1,0] op_sel_hi:[1,1,1]
    v_pk_fma_f16 v50, v34, v253, v66 op_sel:[0,0,0] op_sel_hi:[1,0,1]
    v_pk_fma_f16 v51, v35, v253, v67 op_sel:[0,1,0] op_sel_hi:[1,1,1]
    ds_write2st64_b32 v12, v48, v50 offset0:8 offset1:9
    ds_write2st64_b32 v17, v49, v51 offset0:8 offset1:9
    s_waitcnt lgkmcnt(6)
    v_pk_fma_f16 v52, v36, v254, v68 op_sel:[0,0,0] op_sel_hi:[1,0,1]
    v_pk_fma_f16 v53, v37, v254, v69 op_sel:[0,1,0] op_sel_hi:[1,1,1]
    v_pk_fma_f16 v54, v38, v255, v70 op_sel:[0,0,0] op_sel_hi:[1,0,1]
    v_pk_fma_f16 v55, v39, v255, v71 op_sel:[0,1,0] op_sel_hi:[1,1,1]
    ds_write2st64_b32 v12, v52, v54 offset0:12 offset1:13
    ds_write2st64_b32 v17, v53, v55 offset0:12 offset1:13
    s_mov_b64 exec, 1
    ds_write_b32 v12, v40 offset:4096
    s_mov_b64 exec, -1
    ds_read2st64_b32 v[72:73], v20 offset0:16 offset1:15
    ds_read2st64_b32 v[74:75], v21 offset0:15 offset1:14
    ds_read2st64_b32 v[76:77], v20 offset0:12 offset1:11
    ds_read2st64_b32 v[78:79], v21 offset0:11 offset1:10
    ds_read2st64_b32 v[80:81], v20 offset0:8 offset1:7
    ds_read2st64_b32 v[82:83], v21 offset0:7 offset1:6
    ds_read2st64_b32 v[84:85], v20 offset0:4 offset1:3
    ds_read2st64_b32 v[86:87], v21 offset0:3 offset1:2
    s_waitcnt lgkmcnt(6)
    v_pk_add_f16 v40, v40, v72
    v_pk_add_f16 v41, v41, v74
    v_pk_add_f16 v42, v42, v73
    v_pk_add_f16 v43, v43, v75
    s_waitcnt lgkmcnt(4)
    v_pk_add_f16 v44, v44, v76
    v_pk_add_f16 v45, v45, v78
    v_pk_add_f16 v46, v46, v77
    v_pk_add_f16 v47, v47, v79
    s_waitcnt lgkmcnt(2)
    v_pk_add_f16 v48, v48, v80
    v_pk_add_f16 v49, v49, v82
    v_pk_add_f16 v50, v50, v81
    v_pk_add_f16 v51, v51, v83
    s_waitcnt lgkmcnt(0)
    v_pk_add_f16 v52, v52, v84
    v_pk_add_f16 v53, v53, v86
    v_pk_add_f16 v54, v54, v85
    v_pk_add_f16 v55, v55, v87
    v_mfma_f32_32x32x16_f16 v[56:71], v[40:43], v[88:91], 0
    v_mfma_f32_32x32x16_f16 v[72:87], v[40:43], v[104:107], 0
    v_mfma_f32_32x32x16_f16 v[56:71], v[44:47], v[92:95], v[56:71]
    v_mfma_f32_32x32x16_f16 v[72:87], v[44:47], v[108:111], v[72:87]
    s_branch f_st1
f_sp2:
    s_nop 9
    v_pk_mul_f32 v[24:25], v[56:57], v[120:121]
    v_pk_mul_f32 v[28:29], v[72:73], v[120:121]
    v_pk_mul_f32 v[26:27], v[58:59], v[122:123]
    v_pk_mul_f32 v[30:31], v[74:75], v[122:123]
    v_pk_fma_f32 v[24:25], v[72:73], v[136:137], v[24:25]
    v_pk_fma_f32 v[28:29], v[56:57], v[136:137], v[28:29] neg_lo:[1,0,0] neg_hi:[1,0,0]
    v_pk_fma_f32 v[26:27], v[74:75], v[138:139], v[26:27]
    v_pk_fma_f32 v[30:31], v[58:59], v[138:139], v[30:31] neg_lo:[1,0,0] neg_hi:[1,0,0]
    v_cvt_pk_f16_f32 v40, v24, v28
    v_cvt_pk_f16_f32 v41, v25, v29
    v_cvt_pk_f16_f32 v42, v26, v30
    v_cvt_pk_f16_f32 v43, v27, v31
    v_pk_mul_f32 v[32:33], v[60:61], v[124:125]
    v_pk_mul_f32 v[36:37], v[76:77], v[124:125]
    v_pk_mul_f32 v[34:35], v[62:63], v[126:127]
    v_pk_mul_f32 v[38:39], v[78:79], v[126:127]
    v_pk_fma_f32 v[32:33], v[76:77], v[140:141], v[32:33]
    v_pk_fma_f32 v[36:37], v[60:61], v[140:141], v[36:37] neg_lo:[1,0,0] neg_hi:[1,0,0]
    v_pk_fma_f32 v[34:35], v[78:79], v[142:143], v[34:35]
    v_pk_fma_f32 v[38:39], v[62:63], v[142:143], v[38:39] neg_lo:[1,0,0] neg_hi:[1,0,0]
    v_cvt_pk_f16_f32 v44, v32, v36
    v_cvt_pk_f16_f32 v45, v33, v37
    v_cvt_pk_f16_f32 v46, v34, v38
    v_cvt_pk_f16_f32 v47, v35, v39
    v_mfma_f32_32x32x16_f16 v[216:231], v[40:43], v[88:91], 0
    v_mfma_f32_32x32x16_f16 v[232:247], v[40:43], v[104:107], 0
    v_pk_mul_f32 v[24:25], v[64:65], v[128:129]
    v_pk_mul_f32 v[28:29], v[80:81], v[128:129]
    v_pk_mul_f32 v[26:27], v[66:67], v[130:131]
    v_pk_mul_f32 v[30:31], v[82:83], v[130:131]
    v_pk_fma_f32 v[24:25], v[80:81], v[144:145], v[24:25]
    v_pk_fma_f32 v[28:29], v[64:65], v[144:145], v[28:29] neg_lo:[1,0,0] neg_hi:[1,0,0]
    v_pk_fma_f32 v[26:27], v[82:83], v[146:147], v[26:27]
    v_pk_fma_f32 v[30:31], v[66:67], v[146:147], v[30:31] neg_lo:[1,0,0] neg_hi:[1,0,0]
    v_cvt_pk_f16_f32 v48, v24, v28
    v_cvt_pk_f16_f32 v49, v25, v29
    v_cvt_pk_f16_f32 v50, v26, v30
    v_cvt_pk_f16_f32 v51, v27, v31
    v_mfma_f32_32x32x16_f16 v[216:231], v[44:47], v[92:95], v[216:231]
    v_mfma_f32_32x32x16_f16 v[232:247], v[44:47], v[108:111], v[232:247]
    v_pk_mul_f32 v[32:33], v[68:69], v[132:133]
    v_pk_mul_f32 v[36:37], v[84:85], v[132:133]
    v_pk_mul_f32 v[34:35], v[70:71], v[134:135]
    v_pk_mul_f32 v[38:39], v[86:87], v[134:135]
    v_pk_fma_f32 v[32:33], v[84:85], v[148:149], v[32:33]
    v_pk_fma_f32 v[36:37], v[68:69], v[148:149], v[36:37] neg_lo:[1,0,0] neg_hi:[1,0,0]
    v_pk_fma_f32 v[34:35], v[86:87], v[150:151], v[34:35]
    v_pk_fma_f32 v[38:39], v[70:71], v[150:151], v[38:39] neg_lo:[1,0,0] neg_hi:[1,0,0]
    v_cvt_pk_f16_f32 v52, v32, v36
    v_cvt_pk_f16_f32 v53, v33, v37
    v_cvt_pk_f16_f32 v54, v34, v38
    v_cvt_pk_f16_f32 v55, v35, v39
    v_mfma_f32_32x32x16_f16 v[216:231], v[48:51], v[96:99], v[216:231]
    v_mfma_f32_32x32x16_f16 v[232:247], v[48:51], v[112:115], v[232:247]
    v_mfma_f32_32x32x16_f16 v[232:247], v[52:55], v[116:119], v[232:247]
    v_mfma_f32_32x32x16_f16 v[216:231], v[52:55], v[100:103], v[216:231]
    s_nop 10
    ds_bpermute_b32 v12, v19, v232
    s_waitcnt lgkmcnt(1)
    v_pk_fma_f32 v[152:153], v[184:185], v[216:217], v[152:153]
    v_pk_fma_f32 v[154:155], v[186:187], v[218:219], v[154:155]
    v_pk_fma_f32 v[156:157], v[188:189], v[220:221], v[156:157]
    v_pk_fma_f32 v[158:159], v[190:191], v[222:223], v[158:159]
    v_pk_fma_f32 v[160:161], v[192:193], v[224:225], v[160:161]
    v_pk_fma_f32 v[162:163], v[194:195], v[226:227], v[162:163]
    v_pk_fma_f32 v[164:165], v[196:197], v[228:229], v[164:165]
    v_pk_fma_f32 v[166:167], v[198:199], v[230:231], v[166:167]
    v_pk_fma_f32 v[170:171], v[202:203], v[234:235], v[170:171]
    v_pk_fma_f32 v[172:173], v[204:205], v[236:237], v[172:173]
    v_pk_fma_f32 v[174:175], v[206:207], v[238:239], v[174:175]
    v_pk_fma_f32 v[176:177], v[208:209], v[240:241], v[176:177]
    v_pk_fma_f32 v[178:179], v[210:211], v[242:243], v[178:179]
    v_pk_fma_f32 v[180:181], v[212:213], v[244:245], v[180:181]
    v_pk_fma_f32 v[182:183], v[214:215], v[246:247], v[182:183]
    v_fmac_f32 v169, v201, v233
    s_waitcnt lgkmcnt(0)
    v_fmac_f32 v168, v200, v12
    ds_read_b128 v[216:219], v3 offset:28672
    ds_read_b128 v[220:223], v3 offset:29696
    ds_read_b128 v[224:227], v3 offset:30720
    ds_read_b128 v[228:231], v3 offset:31744
    ds_read_b128 v[232:235], v3 offset:32768
    ds_read_b128 v[236:239], v3 offset:33792
    ds_read_b128 v[240:243], v3 offset:34816
    ds_read_b128 v[244:247], v3 offset:35840
    s_waitcnt lgkmcnt(0)
    s_setprio 2
    s_branch f_join
k_done:
    s_endpgm
code_end:
.p2align 8
.type tables,@object
tables:
.long 0x3c00,0x3c00,0x3c00,0x3c00,0x3c008000,0x3c008000,0x3c008000,0x3c008000
.long 0x3c00,0x361f3b64,0x39a839a8,0x3b64361f,0x3c008000,0x3b64b61f,0x39a8b9a8,0x361fbb64
.long 0x3c00,0x39a839a8,0x3c000000,0x39a8b9a8,0x3c008000,0x39a8b9a8,0xbc00,0xb9a8b9a8
.long 0x3c00,0x3b64361f,0x39a8b9a8,0xb61fbb64,0x3c008000,0x361fbb64,0xb9a8b9a8,0xbb64361f
.long 0x3c00,0x3c000000,0xbc00,0xbc008000,0x3c008000,0xbc00,0xbc008000,0x80003c00
.long 0x3c00,0x3b64b61f,0xb9a8b9a8,0xb61f3b64,0x3c008000,0xb61fbb64,0xb9a839a8,0x3b64361f
.long 0x3c00,0x39a8b9a8,0xbc008000,0x39a839a8,0x3c008000,0xb9a8b9a8,0x80003c00,0x39a8b9a8
.long 0x3c00,0x361fbb64,0xb9a839a8,0x3b64b61f,0x3c008000,0xbb64b61f,0x39a839a8,0xb61fbb64
.long 0x3c00,0x3c00,0x3c00,0x3c00,0x3c008000,0x3c008000,0x3c008000,0x3c008000
.long 0x39a8b9a8,0x361fbb64,0x3c000000,0x3b64b61f,0xb9a8b9a8,0xbb64b61f,0xbc00,0xb61fbb64
.long 0xbc008000,0xb9a839a8,0xbc00,0xb9a8b9a8,0x80003c00,0x39a839a8,0xbc008000,0xb9a839a8
.long 0x39a839a8,0x3b64b61f,0xbc008000,0xb61f3b64,0x39a8b9a8,0xb61fbb64,0x80003c00,0x3b64361f
.long 0xbc00,0xbc008000,0x3c00,0x3c000000,0xbc008000,0x80003c00,0x3c008000,0xbc00
.long 0xb9a839a8,0x3b64361f,0x3c000000,0xb61fbb64,0x39a839a8,0x361fbb64,0xbc00,0xbb64361f
.long 0x3c000000,0xb9a8b9a8,0xbc00,0xb9a839a8,0xbc00,0xb9a839a8,0xbc008000,0x39a839a8
.long 0xb9a8b9a8,0x361f3b64,0xbc008000,0x3b64361f,0xb9a839a8,0x3b64b61f,0x80003c00,0x361fbb64
.long 0x3c00,0x3c00,0x3c00,0x3c00,0x3c008000,0x3c008000,0x3c008000,0x3c008000
.long 0xbc00,0xb61fbb64,0xb9a8b9a8,0xbb64b61f,0xbc008000,0xbb64361f,0xb9a839a8,0xb61f3b64
.long 0x3c00,0x39a839a8,0x3c000000,0x39a8b9a8,0x3c008000,0x39a8b9a8,0xbc00,0xb9a8b9a8
.long 0xbc00,0xbb64b61f,0xb9a839a8,0x361f3b64,0xbc008000,0xb61f3b64,0x39a839a8,0x3b64b61f
.long 0x3c00,0x3c000000,0xbc00,0xbc008000,0x3c008000,0xbc00,0xbc008000,0x80003c00
.long 0xbc00,0xbb64361f,0x39a839a8,0x361fbb64,0xbc008000,0x361f3b64,0x39a8b9a8,0xbb64b61f
.long 0x3c00,0x39a8b9a8,0xbc008000,0x39a839a8,0x3c008000,0xb9a8b9a8,0x80003c00,0x39a8b9a8
.long 0xbc00,0xb61f3b64,0x39a8b9a8,0xbb64361f,0xbc008000,0x3b64361f,0xb9a8b9a8,0x361f3b64
.long 0x3c00,0x3c00,0x3c00,0x3c00,0x3c008000,0x3c008000,0x3c008000,0x3c008000
.long 0xb9a839a8,0xb61f3b64,0xbc008000,0xbb64361f,0x39a839a8,0x3b64361f,0x80003c00,0x361f3b64
.long 0xbc008000,0xb9a839a8,0xbc00,0xb9a8b9a8,0x80003c00,0x39a839a8,0xbc008000,0xb9a839a8
.long 0xb9a8b9a8,0xbb64361f,0x3c000000,0x361fbb64,0xb9a839a8,0x361f3b64,0xbc00,0xbb64b61f
.long 0xbc00,0xbc008000,0x3c00,0x3c000000,0xbc008000,0x80003c00,0x3c008000,0xbc00
.long 0x39a8b9a8,0xbb64b61f,0xbc008000,0x361f3b64,0xb9a8b9a8,0xb61f3b64,0x80003c00,0x3b64b61f
.long 0x3c000000,0xb9a8b9a8,0xbc00,0xb9a839a8,0xbc00,0xb9a839a8,0xbc008000,0x39a839a8
.long 0x39a839a8,0xb61fbb64,0x3c000000,0xbb64b61f,0x39a8b9a8,0xbb64361f,0xbc00,0xb61f3b64
.long 0x3c00,0xbc00,0x3c00,0xbc00,0x3c008000,0xbc008000,0x3c008000,0xbc008000
.long 0x3c00,0xb61fbb64,0x39a839a8,0xbb64b61f,0x3c008000,0xbb64361f,0x39a8b9a8,0xb61f3b64
.long 0x3c00,0xb9a8b9a8,0x3c000000,0xb9a839a8,0x3c008000,0xb9a839a8,0xbc00,0x39a839a8
.long 0x3c00,0xbb64b61f,0x39a8b9a8,0x361f3b64,0x3c008000,0xb61f3b64,0xb9a8b9a8,0x3b64b61f
.long 0x3c00,0xbc008000,0xbc00,0x3c000000,0x3c008000,0x80003c00,0xbc008000,0xbc00
.long 0x3c00,0xbb64361f,0xb9a8b9a8,0x361fbb64,0x3c008000,0x361f3b64,0xb9a839a8,0xbb64b61f
.long 0x3c00,0xb9a839a8,0xbc008000,0xb9a8b9a8,0x3c008000,0x39a839a8,0x80003c00,0xb9a839a8
.long 0x3c00,0xb61f3b64,0xb9a839a8,0xbb64361f,0x3c008000,0x3b64361f,0x39a839a8,0x361f3b64
.long 0x3c00,0xbc00,0x3c00,0xbc00,0x3c008000,0xbc008000,0x3c008000,0xbc008000
.long 0x39a8b9a8,0xb61f3b64,0x3c000000,0xbb64361f,0xb9a8b9a8,0x3b64361f,0xbc00,0x361f3b64
.long 0xbc008000,0x39a8b9a8,0xbc00,0x39a839a8,0x80003c00,0xb9a8b9a8,0xbc008000,0x39a8b9a8
.long 0x39a839a8,0xbb64361f,0xbc008000,0x361fbb64,0x39a8b9a8,0x361f3b64,0x80003c00,0xbb64b61f
.long 0xbc00,0x3c000000,0x3c00,0xbc008000,0xbc008000,0xbc00,0x3c008000,0x80003c00
.long 0xb9a839a8,0xbb64b61f,0x3c000000,0x361f3b64,0x39a839a8,0xb61f3b64,0xbc00,0x3b64b61f
.long 0x3c000000,0x39a839a8,0xbc00,0x39a8b9a8,0xbc00,0x39a8b9a8,0xbc008000,0xb9a8b9a8
.long 0xb9a8b9a8,0xb61fbb64,0xbc008000,0xbb64b61f,0xb9a839a8,0xbb64361f,0x80003c00,0xb61f3b64
.long 0x3c00,0xbc00,0x3c00,0xbc00,0x3c008000,0xbc008000,0x3c008000,0xbc008000
.long 0xbc00,0x361f3b64,0xb9a8b9a8,0x3b64361f,0xbc008000,0x3b64b61f,0xb9a839a8,0x361fbb64
.long 0x3c00,0xb9a8b9a8,0x3c000000,0xb9a839a8,0x3c008000,0xb9a839a8,0xbc00,0x39a839a8
.long 0xbc00,0x3b64361f,0xb9a839a8,0xb61fbb64,0xbc008000,0x361fbb64,0x39a839a8,0xbb64361f
.long 0x3c00,0xbc008000,0xbc00,0x3c000000,0x3c008000,0x80003c00,0xbc008000,0xbc00
.long 0xbc00,0x3b64b61f,0x39a839a8,0xb61f3b64,0xbc008000,0xb61fbb64,0x39a8b9a8,0x3b64361f
.long 0x3c00,0xb9a839a8,0xbc008000,0xb9a8b9a8,0x3c008000,0x39a839a8,0x80003c00,0xb9a839a8
.long 0xbc00,0x361fbb64,0x39a8b9a8,0x3b64b61f,0xbc008000,0xbb64b61f,0xb9a8b9a8,0xb61fbb64
.long 0x3c00,0xbc00,0x3c00,0xbc00,0x3c008000,0xbc008000,0x3c008000,0xbc008000
.long 0xb9a839a8,0x361fbb64,0xbc008000,0x3b64b61f,0x39a839a8,0xbb64b61f,0x80003c00,0xb61fbb64
.long 0xbc008000,0x39a8b9a8,0xbc00,0x39a839a8,0x80003c00,0xb9a8b9a8,0xbc008000,0x39a8b9a8
.long 0xb9a8b9a8,0x3b64b61f,0x3c000000,0xb61f3b64,0xb9a839a8,0xb61fbb64,0xbc00,0x3b64361f
.long 0xbc00,0x3c000000,0x3c00,0xbc008000,0xbc008000,0xbc00,0x3c008000,0x80003c00
.long 0x39a8b9a8,0x3b64361f,0xbc008000,0xb61fbb64,0xb9a8b9a8,0x361fbb64,0x80003c00,0xbb64361f
.long 0x3c000000,0x39a839a8,0xbc00,0x39a8b9a8,0xbc00,0x39a8b9a8,0xbc008000,0xb9a8b9a8
.long 0x39a839a8,0x361f3b64,0x3c000000,0x3b64361f,0x39a8b9a8,0x3b64b61f,0xbc00,0x361fbb64
.long 0x3c00,0x3c00,0x3c00,0x3c00,0x3c00,0xbc00,0x3c00,0xbc00
.long 0x3c00,0x3b64,0x39a8,0x361f,0x8000,0xb61f,0xb9a8,0xbb64
.long 0x3c00,0x39a8,0x0,0xb9a8,0x8000,0xb9a8,0xbc00,0xb9a8
.long 0x3c00,0x361f,0xb9a8,0xbb64,0x8000,0xbb64,0xb9a8,0x361f
.long 0x3c00,0x0,0xbc00,0x8000,0x8000,0xbc00,0x8000,0x3c00
.long 0x3c00,0xb61f,0xb9a8,0x3b64,0x8000,0xbb64,0x39a8,0x361f
.long 0x3c00,0xb9a8,0x8000,0x39a8,0x8000,0xb9a8,0x3c00,0xb9a8
.long 0x3c00,0xbb64,0x39a8,0xb61f,0x8000,0xb61f,0x39a8,0xbb64
.long 0x3c00,0x3c00,0x3c00,0x3c00,0x3c00,0xbc00,0x3c00,0xbc00
.long 0xb9a8,0xbb64,0x0,0xb61f,0xb9a8,0xb61f,0xbc00,0xbb64
.long 0x8000,0x39a8,0xbc00,0xb9a8,0x3c00,0x39a8,0x8000,0x39a8
.long 0x39a8,0xb61f,0x8000,0x3b64,0xb9a8,0xbb64,0x3c00,0x361f
.long 0xbc00,0x8000,0x3c00,0x0,0x8000,0x3c00,0x8000,0xbc00
.long 0x39a8,0x361f,0x0,0xbb64,0x39a8,0xbb64,0xbc00,0x361f
.long 0x0,0xb9a8,0xbc00,0x39a8,0xbc00,0x39a8,0x8000,0x39a8
.long 0xb9a8,0x3b64,0x8000,0x361f,0x39a8,0xb61f,0x3c00,0xbb64
.long 0x3c00,0x3c00,0x3c00,0x3c00,0x3c00,0xbc00,0x3c00,0xbc00
.long 0xbc00,0xbb64,0xb9a8,0xb61f,0x8000,0x361f,0x39a8,0x3b64
.long 0x3c00,0x39a8,0x0,0xb9a8,0x8000,0xb9a8,0xbc00,0xb9a8
.long 0xbc00,0xb61f,0x39a8,0x3b64,0x8000,0x3b64,0x39a8,0xb61f
.long 0x3c00,0x0,0xbc00,0x8000,0x8000,0xbc00,0x8000,0x3c00
.long 0xbc00,0x361f,0x39a8,0xbb64,0x8000,0x3b64,0xb9a8,0xb61f
.long 0x3c00,0xb9a8,0x8000,0x39a8,0x8000,0xb9a8,0x3c00,0xb9a8
.long 0xbc00,0x3b64,0xb9a8,0x361f,0x8000,0x361f,0xb9a8,0x3b64
.long 0x3c00,0x3c00,0x3c00,0x3c00,0x3c00,0xbc00,0x3c00,0xbc00
.long 0x39a8,0x3b64,0x8000,0x361f,0x39a8,0x361f,0x3c00,0x3b64
.long 0x8000,0x39a8,0xbc00,0xb9a8,0x3c00,0x39a8,0x8000,0x39a8
.long 0xb9a8,0x361f,0x0,0xbb64,0x39a8,0x3b64,0xbc00,0xb61f
.long 0xbc00,0x8000,0x3c00,0x0,0x8000,0x3c00,0x8000,0xbc00
.long 0xb9a8,0xb61f,0x8000,0x3b64,0xb9a8,0x3b64,0x3c00,0xb61f
.long 0x0,0xb9a8,0xbc00,0x39a8,0xbc00,0x39a8,0x8000,0x39a8
.long 0x39a8,0xbb64,0x0,0xb61f,0xb9a8,0x361f,0xbc00,0x3b64
.long 0x3c000000,0xbbd90000,0x3b640000,0xbaa70000,0x80000000,0x323e0000,0xb61f0000,0x38720000
.long 0x3c000000,0xbaa70000,0x361f0000,0x323e0000,0x80000000,0x38720000,0xbb640000,0x3bd90000
.long 0x3c000000,0xb8720000,0xb61f0000,0x3bd90000,0x80000000,0x3aa70000,0xbb640000,0x323e0000
.long 0x3c000000,0xb23e0000,0xbb640000,0x38720000,0x80000000,0x3bd90000,0xb61f0000,0xbaa70000
.long 0x3c000000,0x323e0000,0xbb640000,0xb8720000,0x80000000,0x3bd90000,0x361f0000,0xbaa70000
.long 0x3c000000,0x38720000,0xb61f0000,0xbbd90000,0x80000000,0x3aa70000,0x3b640000,0x323e0000
.long 0x3c000000,0x3aa70000,0x361f0000,0xb23e0000,0x80000000,0x38720000,0x3b640000,0x3bd90000
.long 0x3c000000,0x3bd90000,0x3b640000,0x3aa70000,0x80000000,0x323e0000,0x361f0000,0x38720000
.long 0x361f0000,0xb23e0000,0x39a80000,0xb8720000,0xbb640000,0x3bd90000,0xb9a80000,0x3aa70000
.long 0xbb640000,0x38720000,0xb9a80000,0x3bd90000,0x361f0000,0xbaa70000,0xb9a80000,0x323e0000
.long 0x3b640000,0xbaa70000,0xb9a80000,0xb23e0000,0x361f0000,0x38720000,0x39a80000,0xbbd90000
.long 0xb61f0000,0x3bd90000,0x39a80000,0xbaa70000,0xbb640000,0xb23e0000,0x39a80000,0x38720000
.long 0xb61f0000,0xbbd90000,0x39a80000,0x3aa70000,0x3b640000,0xb23e0000,0xb9a80000,0x38720000
.long 0x3b640000,0x3aa70000,0xb9a80000,0x323e0000,0xb61f0000,0x38720000,0xb9a80000,0xbbd90000
.long 0xbb640000,0xb8720000,0xb9a80000,0xbbd90000,0xb61f0000,0xbaa70000,0x39a80000,0x323e0000
.long 0x361f0000,0x323e0000,0x39a80000,0x38720000,0x3b640000,0x3bd90000,0x39a80000,0x3aa70000
.long 0x80000000,0x323e0000,0xb61f0000,0x38720000,0xbc000000,0x3bd90000,0xbb640000,0x3aa70000
.long 0x80000000,0xb8720000,0x3b640000,0xbbd90000,0x3c000000,0xbaa70000,0x361f0000,0x323e0000
.long 0x80000000,0x3aa70000,0xbb640000,0x323e0000,0xbc000000,0x38720000,0x361f0000,0xbbd90000
.long 0x80000000,0xbbd90000,0x361f0000,0x3aa70000,0x3c000000,0xb23e0000,0xbb640000,0x38720000
.long 0x80000000,0x3bd90000,0x361f0000,0xbaa70000,0xbc000000,0xb23e0000,0x3b640000,0x38720000
.long 0x80000000,0xbaa70000,0xbb640000,0xb23e0000,0x3c000000,0x38720000,0xb61f0000,0xbbd90000
.long 0x80000000,0x38720000,0x3b640000,0x3bd90000,0xbc000000,0xbaa70000,0xb61f0000,0x323e0000
.long 0x80000000,0xb23e0000,0xb61f0000,0xb8720000,0x3c000000,0x3bd90000,0x3b640000,0x3aa70000
.long 0xbb640000,0x3bd90000,0xb9a80000,0x3aa70000,0xb61f0000,0x323e0000,0xb9a80000,0x38720000
.long 0xb61f0000,0x3aa70000,0x39a80000,0xb23e0000,0xbb640000,0x38720000,0xb9a80000,0x3bd90000
.long 0x361f0000,0x38720000,0x39a80000,0xbbd90000,0xbb640000,0x3aa70000,0x39a80000,0x323e0000
.long 0x3b640000,0x323e0000,0xb9a80000,0xb8720000,0xb61f0000,0x3bd90000,0x39a80000,0xbaa70000
.long 0x3b640000,0xb23e0000,0xb9a80000,0x38720000,0x361f0000,0x3bd90000,0xb9a80000,0xbaa70000
.long 0x361f0000,0xb8720000,0x39a80000,0x3bd90000,0x3b640000,0x3aa70000,0xb9a80000,0x323e0000
.long 0xb61f0000,0xbaa70000,0x39a80000,0x323e0000,0x3b640000,0x38720000,0x39a80000,0x3bd90000
.long 0xbb640000,0xbbd90000,0xb9a80000,0xbaa70000,0x361f0000,0x323e0000,0x39a80000,0x38720000
.size tables, 4096
all_end:
.section .rodata,"a"
.p2align 6
.amdhsa_kernel adaLN_cond__spectral_fnet__moe_arch_mod__prompt_kernel
  .amdhsa_next_free_vgpr 256
  .amdhsa_next_free_sgpr 84
  .amdhsa_accum_offset 256
  .amdhsa_group_segment_fixed_size 0
  .amdhsa_kernarg_size 120
  .amdhsa_user_sgpr_count 2
  .amdhsa_user_sgpr_kernarg_segment_ptr 1
  .amdhsa_system_sgpr_workgroup_id_x 1
  .amdhsa_float_denorm_mode_32 3
  .amdhsa_float_denorm_mode_16_64 3
.end_amdhsa_kernel
```
